```python
import torch

def _softmax(x, axis=-1):
    return torch.softmax(x, dim=axis)
def _gelu(x):
    return torch.nn.functional.gelu(x, approximate="tanh")
def _silu(x):
    return torch.nn.functional.silu(x)
def _sigmoid(x):
    return torch.sigmoid(x)
def _layernorm(x, axis=-1, eps=1e-5):
    m = x.mean(dim=axis, keepdim=True)
    v = x.var(dim=axis, keepdim=True, unbiased=False)
    return (x - m) / torch.sqrt(v + eps)
def _scatter_add(tgt, idx, src, axis=0):
    return tgt.clone().index_add_(axis, idx, src)
def _segment_sum(src, seg, n):
    out = torch.zeros((n,) + src.shape[1:], dtype=src.dtype)
    return out.index_add_(0, seg, src)
def _pad(x, pw):
    flat = tuple(v for pair in reversed(pw) for v in pair)
    return torch.nn.functional.pad(x, flat)

kernel_name = 'recurrent_scan__linear_kernel_hedgehog__glu_gated_geglu__prompt'

def setup_inputs():

    _w = (lambda a: (lambda t: t.to(torch.bfloat16) if t.is_floating_point() else t)(torch.as_tensor(a)))
    def _A_setup():
        B, S, D, H = 1, 2048, 1024, 32
        Dh = D // H
        return {
            "x": _w((lambda *s: torch.randn(*s, dtype=torch.bfloat16) * 0.05)(B, S, D)),
            "wqkv": _w((lambda *s: torch.randn(*s, dtype=torch.bfloat16) * 0.8)(D, 3 * D)),
            "w_phi": _w((lambda *s: torch.randn(*s, dtype=torch.bfloat16) * 0.8)(H, Dh, Dh) * (Dh ** -0.5)),
            "wo": _w((lambda *s: torch.randn(*s, dtype=torch.bfloat16) * 0.8)(D, D)),
        }
    _A_in = _A_setup()

    def _B_setup():
        B, S, Dm, Df = 1, 2048, 1024, 3584
        return {
            "x": _w((lambda *s: torch.randn(*s, dtype=torch.bfloat16) * 0.05)(B, S, Dm)),
            "w_gate": _w((lambda *s: torch.randn(*s, dtype=torch.bfloat16) * 0.2)(Dm, Df) * (Dm ** -0.5)),
            "w_up": _w((lambda *s: torch.randn(*s, dtype=torch.bfloat16) * 0.2)(Dm, Df) * (Dm ** -0.5)),
            "w_down": _w((lambda *s: torch.randn(*s, dtype=torch.bfloat16) * 0.2)(Df, Dm) * (Df ** -0.5)),
        }
    _B_in = _B_setup()

    return {
        "A_x": _A_in["x"],
        "A_wqkv": _A_in["wqkv"],
        "A_w_phi": _A_in["w_phi"],
        "A_wo": _A_in["wo"],
        "B_x": _B_in["x"],
        "B_w_gate": _B_in["w_gate"],
        "B_w_up": _B_in["w_up"],
        "B_w_down": _B_in["w_down"],
    }

def reference(A_x, A_wqkv, A_w_phi, A_wo, B_x, B_w_gate, B_w_up, B_w_down):
    def _A_ref(x, wqkv, w_phi, wo):
        B, S, D = x.shape
        H = 32; Dh = D // H
        qkv = (lambda x, *d: x.permute(*d))((x @ wqkv).reshape(B, S, 3, H, Dh), 2, 0, 3, 1, 4)
        q, k, v = qkv[0], qkv[1], qkv[2]
        pq = torch.einsum("bhsd,hdf->bhsf", q, w_phi)
        pk = torch.einsum("bhsd,hdf->bhsf", k, w_phi)
        phi_q = torch.concatenate([_softmax(pq, axis=-1), _softmax(-pq, axis=-1)], axis=-1)
        phi_k = torch.concatenate([_softmax(pk, axis=-1), _softmax(-pk, axis=-1)], axis=-1)
        kv = torch.einsum("bhsf,bhsd->bhfd", phi_k, v)
        z  = torch.einsum("bhsf->bhf", phi_k)
        num = torch.einsum("bhqf,bhfd->bhqd", phi_q, kv)
        den = torch.einsum("bhqf,bhf->bhq", phi_q, z)[..., None] + 1e-6
        o = num / den
        return (lambda x, *d: x.permute(*d))(o, 0, 2, 1, 3).reshape(B, S, D) @ wo

    def _B_ref(x, w_gate, w_up, w_down):
        g = torch.einsum("bsd,df->bsf", x, w_gate)
        u = torch.einsum("bsd,df->bsf", x, w_up)
        h = _gelu(g) * u
        return torch.einsum("bsf,fd->bsd", h, w_down)

    x = A_x
    xn = _layernorm(x, axis=-1)
    s = _A_ref(xn, A_wqkv, A_w_phi, A_wo)
    g = _silu(_B_ref(xn, B_w_gate, B_w_up, B_w_down))
    return x + s * g
```

```asm
; @launch grid=(256,1,1) block=(256,1,1) lds=163840
.amdgcn_target "amdgcn-amd-amdhsa--gfx950"
.text
.globl recurrent_scan__linear_kernel_hedgehog__glu_gated_geglu__prompt_kernel
.p2align 8
.type recurrent_scan__linear_kernel_hedgehog__glu_gated_geglu__prompt_kernel,@function
recurrent_scan__linear_kernel_hedgehog__glu_gated_geglu__prompt_kernel:
    s_cmp_ge_u32 s2, 256
    s_cbranch_scc1 L_exit
    s_load_dwordx2 s[4:5], s[0:1], 0
    s_load_dwordx2 s[8:9], s[0:1], 8
    s_load_dwordx2 s[12:13], s[0:1], 40
    s_load_dwordx2 s[16:17], s[0:1], 48
    s_load_dwordx2 s[20:21], s[0:1], 80
    s_load_dwordx2 s[40:41], s[0:1], 16
    s_load_dwordx2 s[36:37], s[0:1], 72
    s_load_dwordx2 s[24:25], s[0:1], 56
    s_load_dwordx2 s[28:29], s[0:1], 24
    s_load_dwordx2 s[32:33], s[0:1], 64
    s_getpc_b64 s[70:71]
L_pc:
    s_lshr_b32 s72, s2, 3
    v_lshl_add_u32 v2, v0, 5, s72
    v_lshlrev_b32 v2, 7, v2
    v_cmp_gt_u32 vcc, L_code_end-L_pc-4, v2
    v_mov_b32 v3, 0
    v_lshl_add_u64 v[2:3], v[2:3], 0, s[70:71]
    s_and_saveexec_b64 s[72:73], vcc
    s_cbranch_execz L_nopf
    global_load_dword a254, v[2:3], off
L_nopf:
    s_mov_b64 exec, -1
    v_lshrrev_b32 v1, 6, v0
    v_and_b32 v0, 63, v0
    v_readfirstlane_b32 s44, v1
    v_lshrrev_b32 v14, 3, v0
    v_lshrrev_b32 v15, 4, v0
    v_and_b32 v16, 7, v0
    s_mov_b32 s6, 4194304
    s_mov_b32 s7, 0x00020000
    s_mov_b32 s10, 6291456
    s_mov_b32 s11, 0x00020000
    s_lshr_b32 s45, s44, 1
    s_and_b32 s46, s44, 1
    s_lshr_b32 s47, s2, 5
    s_lshl4_add_u32 s70, s45, s46
    s_lshl_b32 s71, s70, 10
    s_add_u32 s67, s71, 81920
    s_lshl_b32 s71, s47, 5
    s_add_u32 s70, s70, s71
    v_lshl_add_u32 v17, s46, 2, v15
    v_xor_b32 v17, v17, v16
    v_lshl_add_u32 v18, s70, 3, v14
    v_lshlrev_b32 v18, 11, v18
    v_lshl_add_u32 v9, v17, 4, v18
    s_lshl_b32 s66, s44, 10
    s_bfe_u32 s52, s2, 0x10003
    s_bfe_u32 s70, s2, 0x10004
    s_and_b32 s71, s2, 7
    s_lshl1_add_u32 s48, s71, s70
    s_xor_b32 s70, s52, 1
    s_lshl4_add_u32 s70, s70, s48
    s_lshl_b32 s61, s70, 7
    v_and_b32 v17, 1, v15
    v_lshl_or_b32 v17, s46, 1, v17
    v_lshlrev_b32 v17, 1, v17
    v_xor_b32 v17, v17, v16
    v_lshlrev_b32 v17, 4, v17
    v_lshl_add_u32 v18, s44, 3, v14
    v_mul_u32_u24 v19, 6144, v18
    v_add_u32 v10, v19, v17
    s_waitcnt lgkmcnt(0)
    s_add_u32 m0, s66, 0
    s_add_u32 s74, s61, 0
    buffer_load_dwordx4 v10, s[8:11], s74 offen lds
    s_add_u32 m0, s66, 40960
    s_add_u32 s74, s74, 196608
    buffer_load_dwordx4 v10, s[8:11], s74 offen lds
    s_add_u32 m0, s67, 0
    s_mov_b32 s74, 0
    buffer_load_dwordx4 v9, s[4:7], s74 offen lds
    s_add_u32 m0, s67, 2048
    s_mov_b32 s74, 32768
    buffer_load_dwordx4 v9, s[4:7], s74 offen lds
    s_add_u32 m0, s67, 4096
    s_mov_b32 s74, 65536
    buffer_load_dwordx4 v9, s[4:7], s74 offen lds
    s_add_u32 m0, s67, 6144
    s_mov_b32 s74, 98304
    buffer_load_dwordx4 v9, s[4:7], s74 offen lds
    s_add_u32 m0, s67, 8192
    s_mov_b32 s74, 131072
    buffer_load_dwordx4 v9, s[4:7], s74 offen lds
    s_add_u32 m0, s67, 10240
    s_mov_b32 s74, 163840
    buffer_load_dwordx4 v9, s[4:7], s74 offen lds
    s_add_u32 m0, s67, 12288
    s_mov_b32 s74, 196608
    buffer_load_dwordx4 v9, s[4:7], s74 offen lds
    s_add_u32 m0, s67, 14336
    s_mov_b32 s74, 229376
    buffer_load_dwordx4 v9, s[4:7], s74 offen lds
    s_mov_b32 s14, 7340032
    s_mov_b32 s15, 0x00020000
    s_mov_b32 s18, 7340032
    s_mov_b32 s19, 0x00020000
    s_mov_b32 s22, 268435456
    s_mov_b32 s23, 0x00020000
    s_mov_b32 s42, 65536
    s_mov_b32 s43, 0x00020000
    s_mov_b32 s38, 256
    s_mov_b32 s39, 0x00020000
    s_mov_b32 s26, 7340032
    s_mov_b32 s27, 0x00020000
    s_mov_b32 s30, 2097152
    s_mov_b32 s31, 0x00020000
    s_mov_b32 s34, 4194304
    s_mov_b32 s35, 0x00020000
    v_lshlrev_b32 v13, 4, v0
    v_mul_u32_u24 v19, 7168, v18
    v_add_u32 v11, v19, v17
    s_lshl1_add_u32 s49, s48, s52
    s_lshr_b32 s50, s48, 2
    s_and_b32 s51, s48, 3
    s_mul_i32 s72, s50, 1792
    s_cmp_eq_u32 s52, 1
    s_cbranch_scc1 L_type1
    s_branch L_type0
L_exit:
    s_endpgm
.p2align 12
L_type0:
    s_lshl_b32 s70, s48, 7
    s_add_u32 s62, s70, 4096
    s_lshl_b32 s71, s51, 7
    s_add_u32 s71, s71, s72
    s_add_u32 s63, s71, 1024
    s_mov_b32 s64, s63
    s_lshl_b32 s71, s51, 6
    s_add_u32 s71, s71, s72
    s_add_u32 s65, s71, 1536
    s_cmp_eq_u32 s44, 0
    s_cselect_b32 s70, s61, s63
    s_cselect_b32 s71, s62, s65
    s_cselect_b32 s72, 6, 7
    s_lshl_b32 s79, s72, 16
    s_lshl_b32 s72, s72, 10
    s_sub_u32 s71, s71, s70
    v_lshrrev_b32_e64 v22, 2, v0
    s_and_b32 s73, s47, 3
    v_lshl_add_u32 v22, v22, 2, s73
    v_mul_lo_u32 v22, v22, s72
    v_bfe_u32 v23, v0, 1, 1
    v_mad_u32_u24 v22, v23, s71, v22
    v_add_u32 v22, s70, v22
    s_lshl_b32 s73, s47, 5
    s_add_u32 s73, s73, s49
    s_lshl_b32 s73, s73, 14
    v_lshrrev_b32 v23, 3, v0
    v_lshl_add_u32 v23, v23, 11, s73
    v_bfe_u32 v24, v0, 1, 2
    v_min_u32 v24, 1, v24
    v_lshl_add_u32 v23, v24, 7, v23
    s_lshr_b32 s70, s47, 2
    s_mul_i32 s69, s70, s79
    s_lshl_b32 s76, s79, 1
    s_mul_i32 s70, s69, 14
    s_add_u32 s76, s76, s70
    s_mul_i32 s70, s69, 9
    s_sub_u32 s77, s79, s70
    s_add_u32 s69, s69, s79
    s_cmp_ge_u32 s47, 5
    s_cselect_b32 s71, 7, 2
    s_mov_b32 s70, 2
    s_lshl_b32 s70, s70, 7
    s_lshl_b32 s71, s71, 7
    s_cmp_eq_u32 s44, 3
    s_cselect_b64 vcc, -1, 0
    s_cselect_b32 s69, 128, s69
    s_cselect_b32 s79, 256, s79
    s_cselect_b32 s76, s70, s76
    s_cselect_b32 s77, s71, s77
    s_cselect_b32 s3, 0x7ff, -1
    v_cndmask_b32 v28, v22, v23, vcc
    s_mov_b64 s[92:93], s[8:9]
    s_mov_b32 s94, s10
    s_cmp_ge_u32 s44, 1
    s_cselect_b64 s[92:93], s[12:13], s[92:93]
    s_cselect_b32 s94, s14, s94
    s_cmp_ge_u32 s44, 2
    s_cselect_b64 s[92:93], s[16:17], s[92:93]
    s_cselect_b32 s94, s18, s94
    s_cmp_ge_u32 s44, 3
    s_cselect_b64 s[92:93], s[4:5], s[92:93]
    s_cselect_b32 s94, s6, s94
    s_mov_b32 s95, 0x00020000
    s_lshl_b32 s70, s45, 2
    v_add_u32 v22, s70, v15
    v_bfe_u32 v23, v0, 1, 3
    v_xor_b32 v22, v22, v23
    v_and_b32 v23, 15, v0
    v_lshlrev_b32 v23, 7, v23
    v_lshl_add_u32 v22, v22, 4, v23
    s_lshl_b32 s70, s45, 14
    s_add_u32 s70, s70, 81920
    v_add_u32 v1, s70, v22
    v_xor_b32 v2, 64, v1
    v_bfe_u32 v22, v0, 2, 2
    v_lshl_add_u32 v22, v15, 3, v22
    v_and_b32 v23, 3, v0
    v_lshlrev_b32 v23, 3, v23
    v_bfe_u32 v24, v0, 3, 2
    s_lshl_b32 s70, s46, 1
    v_xor_b32_e64 v24, s70, v24
    v_lshl_add_u32 v24, v24, 5, v23
    v_lshl_add_u32 v24, v22, 7, v24
    s_mul_i32 s70, s45, 40960
    s_sub_u32 s71, 40960, s70
    v_add_u32 v3, s70, v24
    v_add_u32 v5, s71, v24
    v_xor_b32 v4, 32, v3
    v_xor_b32 v6, 32, v5
    v_and_b32 v25, 1, v15
    v_xor_b32 v25, s46, v25
    v_lshl_add_u32 v25, v25, 5, v23
    v_lshl_add_u32 v25, v22, 6, v25
    v_add_u32 v7, s70, v25
    v_add_u32 v8, s71, v25
    s_cmp_ge_u32 s47, 5
    s_cselect_b32 s70, 3, 0
    s_sub_u32 s54, s47, s70
    s_lshl1_add_u32 s60, s70, 4
    s_lshl_b32 s57, s60, 7
    s_mov_b32 s58, 1179648
    s_mov_b32 s59, 1376256
    s_mov_b32 s53, 1
    s_cmp_eq_u32 s44, 0
    s_cselect_b32 s70, 5, 1
    s_lshl_b32 s70, s70, s54
    s_or_b32 s56, s70, 0x90
    s_mul_i32 s70, s45, 40960
    s_lshl_b32 s71, s46, 10
    s_add_u32 s70, s70, s71
    s_add_u32 s68, s70, 16384
    v_lshrrev_b32 v17, 5, v0
    v_lshlrev_b32 v17, 1, v17
    v_and_b32 v18, 3, v0
    v_xor_b32 v17, v17, v18
    v_lshrrev_b32 v19, 2, v0
    v_lshl_add_u32 v19, s44, 4, v19
    v_mul_u32_u24 v19, 7168, v19
    v_lshl_add_u32 v12, v17, 4, v19
    v_mov_b32_e64 v0, v28
    v_and_b32 v14, 0xf0, v13
    v_cmp_eq_u32 vcc, 0x90, v14
    v_mov_b32 v14, 0x3f803f80
    s_nop 0
    v_cndmask_b32 v28, 0, v14, vcc
    v_cndmask_b32 v29, 0, v14, vcc
    v_cndmask_b32 v30, 0, v14, vcc
    v_cndmask_b32 v31, 0, v14, vcc
    v_mov_b32 v26, 0
    s_add_u32 m0, s66, 4096
    s_add_u32 s74, s62, 0
    buffer_load_dwordx4 v10, s[8:11], s74 offen lds
    s_add_u32 m0, s66, 45056
    s_add_u32 s74, s74, 196608
    buffer_load_dwordx4 v10, s[8:11], s74 offen lds
    s_add_u32 m0, s66, 8192
    s_add_u32 s74, s63, 0
    buffer_load_dwordx4 v11, s[12:15], s74 offen lds
    s_add_u32 m0, s66, 49152
    s_add_u32 s74, s74, 229376
    buffer_load_dwordx4 v11, s[12:15], s74 offen lds
    buffer_load_dword a254, v0, s[92:95], s69 offen
    s_add_u32 s69, s69, s76
    s_and_b32 s69, s69, s3
    s_mov_b64 exec, 0
    s_cmp_eq_u32 s44, 0
    s_cbranch_scc1 L_chain0_0
    s_cmp_eq_u32 s44, 1
    s_cbranch_scc1 L_chain0_1
    s_cmp_eq_u32 s44, 2
    s_cbranch_scc1 L_chain0_2
    s_branch L_chain0_3
L_back0:
    s_mov_b64 exec, -1
    s_waitcnt vmcnt(5)
    s_barrier
    s_nop 0
    ds_read_b64_tr_b16 a[224:225], v3
    ds_read_b64_tr_b16 a[226:227], v3 offset:512
    ds_read_b64_tr_b16 a[228:229], v5
    ds_read_b64_tr_b16 a[230:231], v5 offset:512
    ds_read_b128 a[96:99], v1
    ds_read_b128 a[100:103], v2
    ds_read_b128 a[104:107], v1 offset:2048
    ds_read_b128 a[108:111], v2 offset:2048
    ds_read_b128 a[112:115], v1 offset:4096
    ds_read_b128 a[116:119], v2 offset:4096
    ds_read_b128 a[120:123], v1 offset:6144
    ds_read_b128 a[124:127], v2 offset:6144
    ds_read_b128 a[128:131], v1 offset:8192
    ds_read_b128 a[132:135], v2 offset:8192
    ds_read_b128 a[136:139], v1 offset:10240
    ds_read_b128 a[140:143], v2 offset:10240
    ds_read_b128 a[144:147], v1 offset:12288
    ds_read_b128 a[148:151], v2 offset:12288
    ds_read_b128 a[152:155], v1 offset:14336
    ds_read_b128 a[156:159], v2 offset:14336
    s_cmp_eq_u32 s47, 0
    s_cbranch_scc1 L_first0
    s_waitcnt lgkmcnt(15)
    v_mfma_f32_16x16x32_bf16 v[32:35], a[224:227], a[96:99], 0
    ds_read_b64_tr_b16 a[232:233], v4
    s_add_u32 m0, s66, 12288
    s_waitcnt lgkmcnt(15)
    v_mfma_f32_16x16x32_bf16 v[32:35], a[228:231], a[100:103], v[32:35]
    ds_read_b64_tr_b16 a[234:235], v4 offset:512
    s_add_u32 s74, s64, 0
    s_waitcnt lgkmcnt(15)
    v_mfma_f32_16x16x32_bf16 v[36:39], a[224:227], a[104:107], 0
    ds_read_b64_tr_b16 a[236:237], v6
    buffer_load_dwordx4 v11, s[16:19], s74 offen lds
    s_waitcnt lgkmcnt(15)
    v_mfma_f32_16x16x32_bf16 v[36:39], a[228:231], a[108:111], v[36:39]
    ds_read_b64_tr_b16 a[238:239], v6 offset:512
    s_waitcnt lgkmcnt(15)
    v_mfma_f32_16x16x32_bf16 v[40:43], a[224:227], a[112:115], 0
    s_add_u32 m0, s66, 53248
    s_add_u32 s74, s74, 229376
    s_lshl2_add_u32 s70, s47, s50
    s_waitcnt lgkmcnt(14)
    v_mfma_f32_16x16x32_bf16 v[40:43], a[228:231], a[116:119], v[40:43]
    buffer_load_dwordx4 v11, s[16:19], s74 offen lds
    s_lshl_b32 s70, s70, 7
    s_waitcnt lgkmcnt(13)
    v_mfma_f32_16x16x32_bf16 v[44:47], a[224:227], a[120:123], 0
    s_waitcnt lgkmcnt(12)
    v_mfma_f32_16x16x32_bf16 v[44:47], a[228:231], a[124:127], v[44:47]
    s_lshl2_add_u32 s70, s51, s70
    s_waitcnt lgkmcnt(11)
    v_mfma_f32_16x16x32_bf16 v[48:51], a[224:227], a[128:131], 0
    s_waitcnt lgkmcnt(10)
    v_mfma_f32_16x16x32_bf16 v[48:51], a[228:231], a[132:135], v[48:51]
    s_add_u32 s81, s70, 34148384
    s_waitcnt lgkmcnt(9)
    v_mfma_f32_16x16x32_bf16 v[52:55], a[224:227], a[136:139], 0
    s_add_u32 m0, s68, 0
    s_add_u32 s74, s65, 0
    buffer_load_dwordx4 v12, s[12:15], s74 offen lds
    s_waitcnt lgkmcnt(8)
    v_mfma_f32_16x16x32_bf16 v[52:55], a[228:231], a[140:143], v[52:55]
    s_lshl_b32 s70, s48, 7
    s_waitcnt lgkmcnt(7)
    v_mfma_f32_16x16x32_bf16 v[56:59], a[224:227], a[144:147], 0
    s_lshl2_add_u32 s70, s47, s70
    s_waitcnt lgkmcnt(6)
    v_mfma_f32_16x16x32_bf16 v[56:59], a[228:231], a[148:151], v[56:59]
    s_waitcnt lgkmcnt(5)
    v_mfma_f32_16x16x32_bf16 v[60:63], a[224:227], a[152:155], 0
    s_add_u32 s82, s70, 34152448
    s_waitcnt lgkmcnt(4)
    v_mfma_f32_16x16x32_bf16 v[60:63], a[228:231], a[156:159], v[60:63]
    s_waitcnt vmcnt(6) lgkmcnt(0)
    s_barrier
    v_mfma_f32_16x16x32_bf16 v[64:67], a[232:235], a[96:99], 0
    ds_read_b64_tr_b16 a[224:225], v3 offset:4096
    v_mfma_f32_16x16x32_bf16 v[64:67], a[236:239], a[100:103], v[64:67]
    ds_read_b64_tr_b16 a[226:227], v3 offset:4608
    v_mfma_f32_16x16x32_bf16 v[68:71], a[232:235], a[104:107], 0
    ds_read_b64_tr_b16 a[228:229], v5 offset:4096
    v_mfma_f32_16x16x32_bf16 v[68:71], a[236:239], a[108:111], v[68:71]
    ds_read_b64_tr_b16 a[230:231], v5 offset:4608
    v_mfma_f32_16x16x32_bf16 v[72:75], a[232:235], a[112:115], 0
    s_add_u32 m0, s68, 2048
    s_nop 0
    buffer_load_dwordx4 v12, s[16:19], s74 offen lds
    s_add_u32 s83, s70, 34152448
    v_mfma_f32_16x16x32_bf16 v[72:75], a[236:239], a[116:119], v[72:75]
    s_lshl_b32 s70, s2, 7
    s_lshl2_add_u32 s70, s44, s70
    s_add_u32 s84, s70, 34177024
    v_mfma_f32_16x16x32_bf16 v[76:79], a[232:235], a[120:123], 0
    s_add_u32 m0, s67, 32768
    s_mov_b32 s74, 128
    v_mfma_f32_16x16x32_bf16 v[76:79], a[236:239], a[124:127], v[76:79]
    buffer_load_dwordx4 v9, s[4:7], s74 offen lds
    s_and_b32 s70, s2, 31
    v_mfma_f32_16x16x32_bf16 v[80:83], a[232:235], a[128:131], 0
    s_lshl_b32 s70, s70, 7
    v_mfma_f32_16x16x32_bf16 v[80:83], a[236:239], a[132:135], v[80:83]
    v_mfma_f32_16x16x32_bf16 v[84:87], a[232:235], a[136:139], 0
    s_lshl2_add_u32 s70, s47, s70
    v_mfma_f32_16x16x32_bf16 v[84:87], a[236:239], a[140:143], v[84:87]
    v_mfma_f32_16x16x32_bf16 v[88:91], a[232:235], a[144:147], 0
    s_add_u32 m0, s67, 34816
    s_mov_b32 s74, 32896
    buffer_load_dwordx4 v9, s[4:7], s74 offen lds
    v_mfma_f32_16x16x32_bf16 v[88:91], a[236:239], a[148:151], v[88:91]
    s_add_u32 s50, s70, 34164736
    s_lshl_b32 s70, s2, 3
    v_mfma_f32_16x16x32_bf16 v[92:95], a[232:235], a[152:155], 0
    v_mfma_f32_16x16x32_bf16 v[92:95], a[236:239], a[156:159], v[92:95]
    s_lshl1_add_u32 s70, s44, s70
    s_waitcnt lgkmcnt(0)
    v_mfma_f32_16x16x32_bf16 v[96:99], a[96:99], a[224:227], 0
    ds_read_b64_tr_b16 a[232:233], v4 offset:4096
    v_mfma_f32_16x16x32_bf16 v[96:99], a[100:103], a[228:231], v[96:99]
    ds_read_b64_tr_b16 a[234:235], v4 offset:4608
    s_add_u32 m0, s67, 36864
    v_mfma_f32_16x16x32_bf16 v[100:103], a[104:107], a[224:227], 0
    ds_read_b64_tr_b16 a[236:237], v6 offset:4096
    s_mov_b32 s74, 65664
    v_mfma_f32_16x16x32_bf16 v[100:103], a[108:111], a[228:231], v[100:103]
    ds_read_b64_tr_b16 a[238:239], v6 offset:4608
    buffer_load_dwordx4 v9, s[4:7], s74 offen lds
    v_mfma_f32_16x16x32_bf16 v[104:107], a[112:115], a[224:227], 0
    s_lshl_b32 s101, s70, 11
    s_lshl_b32 s71, s70, 3
    s_add_u32 s85, s71, 34111488
    v_mfma_f32_16x16x32_bf16 v[104:107], a[116:119], a[228:231], v[104:107]
    v_mfma_f32_16x16x32_bf16 v[108:111], a[120:123], a[224:227], 0
    s_lshr_b32 s71, s70, 7
    v_mfma_f32_16x16x32_bf16 v[108:111], a[124:127], a[228:231], v[108:111]
    s_add_u32 m0, s67, 38912
    s_mov_b32 s74, 98432
    buffer_load_dwordx4 v9, s[4:7], s74 offen lds
    v_mfma_f32_16x16x32_bf16 v[112:115], a[128:131], a[224:227], 0
    s_lshl_b32 s71, s71, 4
    v_mfma_f32_16x16x32_bf16 v[112:115], a[132:135], a[228:231], v[112:115]
    v_mfma_f32_16x16x32_bf16 v[116:119], a[136:139], a[224:227], 0
    s_and_b32 s72, s70, 15
    v_mfma_f32_16x16x32_bf16 v[116:119], a[140:143], a[228:231], v[116:119]
    s_add_u32 s71, s71, s72
    v_mfma_f32_16x16x32_bf16 v[120:123], a[144:147], a[224:227], 0
    v_mfma_f32_16x16x32_bf16 v[120:123], a[148:151], a[228:231], v[120:123]
    s_add_u32 m0, s67, 40960
    s_mov_b32 s74, 131200
    buffer_load_dwordx4 v9, s[4:7], s74 offen lds
    v_mfma_f32_16x16x32_bf16 v[124:127], a[152:155], a[224:227], 0
    s_bfe_u32 s72, s70, 0x30004
    v_mfma_f32_16x16x32_bf16 v[124:127], a[156:159], a[228:231], v[124:127]
    s_waitcnt vmcnt(10) lgkmcnt(0)
    s_barrier
    v_mfma_f32_16x16x32_bf16 v[128:131], a[96:99], a[232:235], 0
    ds_read_b64_tr_b16 a[224:225], v3 offset:8192
    v_mfma_f32_16x16x32_bf16 v[128:131], a[100:103], a[236:239], v[128:131]
    ds_read_b64_tr_b16 a[226:227], v3 offset:8704
    v_mfma_f32_16x16x32_bf16 v[132:135], a[104:107], a[232:235], 0
    ds_read_b64_tr_b16 a[228:229], v5 offset:8192
    v_mfma_f32_16x16x32_bf16 v[132:135], a[108:111], a[236:239], v[132:135]
    ds_read_b64_tr_b16 a[230:231], v5 offset:8704
    v_mfma_f32_16x16x32_bf16 v[136:139], a[112:115], a[232:235], 0
    s_add_u32 m0, s67, 43008
    s_mov_b32 s74, 163968
    buffer_load_dwordx4 v9, s[4:7], s74 offen lds
    v_mfma_f32_16x16x32_bf16 v[136:139], a[116:119], a[236:239], v[136:139]
    s_lshl3_add_u32 s71, s71, s72
    s_lshl_b32 s71, s71, 2
    s_add_u32 s99, s71, 34086912
    v_mfma_f32_16x16x32_bf16 v[140:143], a[120:123], a[232:235], 0
    s_lshr_b32 s71, s70, 5
    s_bfe_u32 s72, s70, 0x20002
    v_mfma_f32_16x16x32_bf16 v[140:143], a[124:127], a[236:239], v[140:143]
    s_lshl2_add_u32 s71, s71, s72
    v_mfma_f32_16x16x32_bf16 v[144:147], a[128:131], a[232:235], 0
    v_mfma_f32_16x16x32_bf16 v[144:147], a[132:135], a[236:239], v[144:147]
    s_add_u32 m0, s67, 45056
    s_mov_b32 s74, 196736
    buffer_load_dwordx4 v9, s[4:7], s74 offen lds
    v_mfma_f32_16x16x32_bf16 v[148:151], a[136:139], a[232:235], 0
    s_bfe_u32 s72, s70, 0x10004
    v_mfma_f32_16x16x32_bf16 v[148:151], a[140:143], a[236:239], v[148:151]
    s_lshl1_add_u32 s71, s71, s72
    v_mfma_f32_16x16x32_bf16 v[152:155], a[144:147], a[232:235], 0
    v_mfma_f32_16x16x32_bf16 v[152:155], a[148:151], a[236:239], v[152:155]
    s_and_b32 s72, s70, 3
    v_mfma_f32_16x16x32_bf16 v[156:159], a[152:155], a[232:235], 0
    s_add_u32 m0, s67, 47104
    s_mov_b32 s74, 229504
    buffer_load_dwordx4 v9, s[4:7], s74 offen lds
    v_mfma_f32_16x16x32_bf16 v[156:159], a[156:159], a[236:239], v[156:159]
    s_lshl2_add_u32 s71, s71, s72
    s_waitcnt lgkmcnt(0)
    v_mfma_f32_16x16x32_bf16 v[160:163], a[224:227], a[96:99], 0
    ds_read_b64_tr_b16 a[232:233], v4 offset:8192
    s_lshl_b32 s71, s71, 1
    v_mfma_f32_16x16x32_bf16 v[160:163], a[228:231], a[100:103], v[160:163]
    ds_read_b64_tr_b16 a[234:235], v4 offset:8704
    v_mfma_f32_16x16x32_bf16 v[164:167], a[224:227], a[104:107], 0
    ds_read_b64_tr_b16 a[236:237], v6 offset:8192
    s_add_u32 s100, s71, 34095104
    v_mfma_f32_16x16x32_bf16 v[164:167], a[228:231], a[108:111], v[164:167]
    ds_read_b64_tr_b16 a[238:239], v6 offset:8704
    v_mfma_f32_16x16x32_bf16 v[168:171], a[224:227], a[112:115], 0
    s_add_u32 m0, s66, 20480
    s_add_u32 s74, s61, 393216
    buffer_load_dwordx4 v10, s[8:11], s74 offen lds
    v_mfma_f32_16x16x32_bf16 v[168:171], a[228:231], a[116:119], v[168:171]
    v_mfma_f32_16x16x32_bf16 v[172:175], a[224:227], a[120:123], 0
    v_mfma_f32_16x16x32_bf16 v[172:175], a[228:231], a[124:127], v[172:175]
    v_mfma_f32_16x16x32_bf16 v[176:179], a[224:227], a[128:131], 0
    v_mfma_f32_16x16x32_bf16 v[176:179], a[228:231], a[132:135], v[176:179]
    v_mfma_f32_16x16x32_bf16 v[180:183], a[224:227], a[136:139], 0
    s_add_u32 m0, s66, 61440
    s_add_u32 s74, s74, 196608
    buffer_load_dwordx4 v10, s[8:11], s74 offen lds
    v_mfma_f32_16x16x32_bf16 v[180:183], a[228:231], a[140:143], v[180:183]
    v_mfma_f32_16x16x32_bf16 v[184:187], a[224:227], a[144:147], 0
    v_mfma_f32_16x16x32_bf16 v[184:187], a[228:231], a[148:151], v[184:187]
    v_mfma_f32_16x16x32_bf16 v[188:191], a[224:227], a[152:155], 0
    v_mfma_f32_16x16x32_bf16 v[188:191], a[228:231], a[156:159], v[188:191]
    s_waitcnt vmcnt(12) lgkmcnt(0)
    s_barrier
    v_mfma_f32_16x16x32_bf16 v[192:195], a[232:235], a[96:99], 0
    ds_read_b64_tr_b16 a[224:225], v3 offset:12288
    v_mfma_f32_16x16x32_bf16 v[192:195], a[236:239], a[100:103], v[192:195]
    ds_read_b64_tr_b16 a[226:227], v3 offset:12800
    v_mfma_f32_16x16x32_bf16 v[196:199], a[232:235], a[104:107], 0
    ds_read_b64_tr_b16 a[228:229], v5 offset:12288
    v_mfma_f32_16x16x32_bf16 v[196:199], a[236:239], a[108:111], v[196:199]
    ds_read_b64_tr_b16 a[230:231], v5 offset:12800
    v_mfma_f32_16x16x32_bf16 v[200:203], a[232:235], a[112:115], 0
    s_add_u32 m0, s66, 24576
    s_add_u32 s74, s62, 393216
    buffer_load_dwordx4 v10, s[8:11], s74 offen lds
    v_mfma_f32_16x16x32_bf16 v[200:203], a[236:239], a[116:119], v[200:203]
    v_mfma_f32_16x16x32_bf16 v[204:207], a[232:235], a[120:123], 0
    s_add_u32 m0, s66, 65536
    s_add_u32 s74, s74, 196608
    v_mfma_f32_16x16x32_bf16 v[204:207], a[236:239], a[124:127], v[204:207]
    buffer_load_dwordx4 v10, s[8:11], s74 offen lds
    v_mfma_f32_16x16x32_bf16 v[208:211], a[232:235], a[128:131], 0
    v_mfma_f32_16x16x32_bf16 v[208:211], a[236:239], a[132:135], v[208:211]
    v_mfma_f32_16x16x32_bf16 v[212:215], a[232:235], a[136:139], 0
    v_mfma_f32_16x16x32_bf16 v[212:215], a[236:239], a[140:143], v[212:215]
    s_add_u32 m0, s66, 28672
    s_add_u32 s74, s63, 458752
    buffer_load_dwordx4 v11, s[12:15], s74 offen lds
    v_mfma_f32_16x16x32_bf16 v[216:219], a[232:235], a[144:147], 0
    v_mfma_f32_16x16x32_bf16 v[216:219], a[236:239], a[148:151], v[216:219]
    v_mfma_f32_16x16x32_bf16 v[220:223], a[232:235], a[152:155], 0
    v_mfma_f32_16x16x32_bf16 v[220:223], a[236:239], a[156:159], v[220:223]
    s_waitcnt lgkmcnt(0)
    v_mfma_f32_16x16x32_bf16 a[0:3], a[224:227], a[96:99], 0
    ds_read_b64_tr_b16 a[232:233], v4 offset:12288
    v_mfma_f32_16x16x32_bf16 a[0:3], a[228:231], a[100:103], a[0:3]
    ds_read_b64_tr_b16 a[234:235], v4 offset:12800
    s_add_u32 m0, s66, 69632
    v_mfma_f32_16x16x32_bf16 a[4:7], a[224:227], a[104:107], 0
    ds_read_b64_tr_b16 a[236:237], v6 offset:12288
    s_add_u32 s74, s74, 229376
    v_mfma_f32_16x16x32_bf16 a[4:7], a[228:231], a[108:111], a[4:7]
    ds_read_b64_tr_b16 a[238:239], v6 offset:12800
    buffer_load_dwordx4 v11, s[12:15], s74 offen lds
    v_mfma_f32_16x16x32_bf16 a[8:11], a[224:227], a[112:115], 0
    v_mfma_f32_16x16x32_bf16 a[8:11], a[228:231], a[116:119], a[8:11]
    v_mfma_f32_16x16x32_bf16 a[12:15], a[224:227], a[120:123], 0
    v_mfma_f32_16x16x32_bf16 a[12:15], a[228:231], a[124:127], a[12:15]
    s_add_u32 m0, s67, 0
    s_mov_b32 s74, 256
    buffer_load_dwordx4 v9, s[4:7], s74 offen lds
    v_mfma_f32_16x16x32_bf16 a[16:19], a[224:227], a[128:131], 0
    v_mfma_f32_16x16x32_bf16 a[16:19], a[228:231], a[132:135], a[16:19]
    v_mfma_f32_16x16x32_bf16 a[20:23], a[224:227], a[136:139], 0
    v_mfma_f32_16x16x32_bf16 a[20:23], a[228:231], a[140:143], a[20:23]
    v_mfma_f32_16x16x32_bf16 a[24:27], a[224:227], a[144:147], 0
    v_mfma_f32_16x16x32_bf16 a[24:27], a[228:231], a[148:151], a[24:27]
    s_add_u32 m0, s67, 2048
    s_mov_b32 s74, 33024
    buffer_load_dwordx4 v9, s[4:7], s74 offen lds
    v_mfma_f32_16x16x32_bf16 a[28:31], a[224:227], a[152:155], 0
    v_mfma_f32_16x16x32_bf16 a[28:31], a[228:231], a[156:159], a[28:31]
    s_waitcnt vmcnt(11) lgkmcnt(0)
    s_barrier
    v_mfma_f32_16x16x32_bf16 a[32:35], a[232:235], a[96:99], 0
    ds_read_b64_tr_b16 a[224:225], v7 offset:16384
    v_mfma_f32_16x16x32_bf16 a[32:35], a[236:239], a[100:103], a[32:35]
    ds_read_b64_tr_b16 a[226:227], v7 offset:16640
    v_mfma_f32_16x16x32_bf16 a[36:39], a[232:235], a[104:107], 0
    ds_read_b64_tr_b16 a[228:229], v8 offset:16384
    v_mfma_f32_16x16x32_bf16 a[36:39], a[236:239], a[108:111], a[36:39]
    ds_read_b64_tr_b16 a[230:231], v8 offset:16640
    v_mfma_f32_16x16x32_bf16 a[40:43], a[232:235], a[112:115], 0
    ds_read_b128 a[160:163], v1 offset:32768
    v_mfma_f32_16x16x32_bf16 a[40:43], a[236:239], a[116:119], a[40:43]
    ds_read_b128 a[164:167], v2 offset:32768
    v_mfma_f32_16x16x32_bf16 a[44:47], a[232:235], a[120:123], 0
    ds_read_b128 a[168:171], v1 offset:34816
    v_mfma_f32_16x16x32_bf16 a[44:47], a[236:239], a[124:127], a[44:47]
    ds_read_b128 a[172:175], v2 offset:34816
    v_mfma_f32_16x16x32_bf16 a[48:51], a[232:235], a[128:131], 0
    ds_read_b128 a[176:179], v1 offset:36864
    buffer_load_dword a254, v0, s[92:95], s69 offen
    v_mfma_f32_16x16x32_bf16 a[48:51], a[236:239], a[132:135], a[48:51]
    s_add_u32 s69, s69, s77
    s_and_b32 s69, s69, s3
    s_add_u32 m0, s67, 4096
    v_mfma_f32_16x16x32_bf16 a[52:55], a[232:235], a[136:139], 0
    s_mov_b32 s74, 65792
    buffer_load_dwordx4 v9, s[4:7], s74 offen lds
    v_mfma_f32_16x16x32_bf16 a[52:55], a[236:239], a[140:143], a[52:55]
    v_mfma_f32_16x16x32_bf16 a[56:59], a[232:235], a[144:147], 0
    v_mfma_f32_16x16x32_bf16 a[56:59], a[236:239], a[148:151], a[56:59]
    v_mfma_f32_16x16x32_bf16 a[60:63], a[232:235], a[152:155], 0
    s_add_u32 m0, s66, 32768
    s_add_u32 s74, s64, 458752
    buffer_load_dwordx4 v11, s[16:19], s74 offen lds
    v_mfma_f32_16x16x32_bf16 a[60:63], a[236:239], a[156:159], a[60:63]
    s_waitcnt lgkmcnt(5)
    v_mfma_f32_16x16x32_bf16 v[224:227], a[224:227], a[96:99], 0
    ds_read_b64_tr_b16 a[232:233], v7 offset:18432
    v_mfma_f32_16x16x32_bf16 v[224:227], a[228:231], a[100:103], v[224:227]
    ds_read_b64_tr_b16 a[234:235], v7 offset:18688
    v_mfma_f32_16x16x32_bf16 v[228:231], a[224:227], a[104:107], 0
    ds_read_b64_tr_b16 a[236:237], v8 offset:18432
    v_mfma_f32_16x16x32_bf16 v[228:231], a[228:231], a[108:111], v[228:231]
    ds_read_b64_tr_b16 a[238:239], v8 offset:18688
    v_mfma_f32_16x16x32_bf16 v[232:235], a[224:227], a[112:115], 0
    ds_read_b128 a[180:183], v2 offset:36864
    s_add_u32 m0, s66, 73728
    v_mfma_f32_16x16x32_bf16 v[232:235], a[228:231], a[116:119], v[232:235]
    ds_read_b128 a[184:187], v1 offset:38912
    s_add_u32 s74, s74, 229376
    v_mfma_f32_16x16x32_bf16 v[236:239], a[224:227], a[120:123], 0
    ds_read_b128 a[188:191], v2 offset:38912
    buffer_load_dwordx4 v11, s[16:19], s74 offen lds
    v_mfma_f32_16x16x32_bf16 v[236:239], a[228:231], a[124:127], v[236:239]
    ds_read_b128 a[192:195], v1 offset:40960
    v_mfma_f32_16x16x32_bf16 v[240:243], a[224:227], a[128:131], 0
    ds_read_b128 a[196:199], v2 offset:40960
    v_mfma_f32_16x16x32_bf16 v[240:243], a[228:231], a[132:135], v[240:243]
    v_mfma_f32_16x16x32_bf16 v[244:247], a[224:227], a[136:139], 0
    s_add_u32 m0, s68, 20480
    s_add_u32 s74, s65, 458752
    buffer_load_dwordx4 v12, s[12:15], s74 offen lds
    v_mfma_f32_16x16x32_bf16 v[244:247], a[228:231], a[140:143], v[244:247]
    v_mfma_f32_16x16x32_bf16 v[248:251], a[224:227], a[144:147], 0
    v_mfma_f32_16x16x32_bf16 v[248:251], a[228:231], a[148:151], v[248:251]
    v_mfma_f32_16x16x32_bf16 v[252:255], a[224:227], a[152:155], 0
    v_mfma_f32_16x16x32_bf16 v[252:255], a[228:231], a[156:159], v[252:255]
    s_waitcnt vmcnt(11) lgkmcnt(0)
    s_barrier
    v_mfma_f32_16x16x32_bf16 a[64:67], a[232:235], a[96:99], 0
    ds_read_b64_tr_b16 a[224:225], v3 offset:20480
    v_mfma_f32_16x16x32_bf16 a[64:67], a[236:239], a[100:103], a[64:67]
    ds_read_b64_tr_b16 a[226:227], v3 offset:20992
    v_mfma_f32_16x16x32_bf16 a[68:71], a[232:235], a[104:107], 0
    ds_read_b64_tr_b16 a[228:229], v5 offset:20480
    v_mfma_f32_16x16x32_bf16 a[68:71], a[236:239], a[108:111], a[68:71]
    ds_read_b64_tr_b16 a[230:231], v5 offset:20992
    v_mfma_f32_16x16x32_bf16 a[72:75], a[232:235], a[112:115], 0
    ds_read_b128 a[200:203], v1 offset:43008
    v_mfma_f32_16x16x32_bf16 a[72:75], a[236:239], a[116:119], a[72:75]
    ds_read_b128 a[204:207], v2 offset:43008
    v_mfma_f32_16x16x32_bf16 a[76:79], a[232:235], a[120:123], 0
    ds_read_b128 a[208:211], v1 offset:45056
    v_mfma_f32_16x16x32_bf16 a[76:79], a[236:239], a[124:127], a[76:79]
    ds_read_b128 a[212:215], v2 offset:45056
    v_mfma_f32_16x16x32_bf16 a[80:83], a[232:235], a[128:131], 0
    ds_read_b128 a[216:219], v1 offset:47104
    s_add_u32 m0, s68, 22528
    v_mfma_f32_16x16x32_bf16 a[80:83], a[236:239], a[132:135], a[80:83]
    ds_read_b128 a[220:223], v2 offset:47104
    buffer_load_dwordx4 v12, s[16:19], s74 offen lds
    v_mfma_f32_16x16x32_bf16 a[84:87], a[232:235], a[136:139], 0
    s_add_u32 m0, s67, 6144
    s_mov_b32 s74, 98560
    v_mfma_f32_16x16x32_bf16 a[84:87], a[236:239], a[140:143], a[84:87]
    s_cmp_eq_u32 s46, 0
    s_cselect_b32 s70, s81, s82
    s_cselect_b32 s71, s83, s50
    s_cmp_eq_u32 s45, 0
    s_cselect_b32 s70, s70, s71
    s_mov_b64 exec, 1
    buffer_store_dword v26, off, s[20:23], s70 sc1
    buffer_store_dword v26, off, s[20:23], s84 sc1
    s_mov_b64 exec, -1
    v_mfma_f32_16x16x32_bf16 a[88:91], a[232:235], a[144:147], 0
    buffer_load_dwordx4 v9, s[4:7], s74 offen lds
    s_add_u32 m0, s67, 8192
    s_mov_b32 s74, 131328
    v_mfma_f32_16x16x32_bf16 a[88:91], a[236:239], a[148:151], a[88:91]
    v_mfma_f32_16x16x32_bf16 a[92:95], a[232:235], a[152:155], 0
    v_mfma_f32_16x16x32_bf16 a[92:95], a[236:239], a[156:159], a[92:95]
    buffer_load_dwordx4 v9, s[4:7], s74 offen lds
    s_waitcnt lgkmcnt(0)
    v_mfma_f32_16x16x32_bf16 v[32:35], a[224:227], a[160:163], v[32:35]
    ds_read_b64_tr_b16 a[232:233], v4 offset:20480
    v_mfma_f32_16x16x32_bf16 v[32:35], a[228:231], a[164:167], v[32:35]
    ds_read_b64_tr_b16 a[234:235], v4 offset:20992
    s_add_u32 m0, s67, 10240
    v_mfma_f32_16x16x32_bf16 v[36:39], a[224:227], a[168:171], v[36:39]
    ds_read_b64_tr_b16 a[236:237], v6 offset:20480
    s_mov_b32 s74, 164096
    v_mfma_f32_16x16x32_bf16 v[36:39], a[228:231], a[172:175], v[36:39]
    ds_read_b64_tr_b16 a[238:239], v6 offset:20992
    buffer_load_dwordx4 v9, s[4:7], s74 offen lds
    v_mfma_f32_16x16x32_bf16 v[40:43], a[224:227], a[176:179], v[40:43]
    v_mfma_f32_16x16x32_bf16 v[40:43], a[228:231], a[180:183], v[40:43]
    v_mfma_f32_16x16x32_bf16 v[44:47], a[224:227], a[184:187], v[44:47]
    v_mfma_f32_16x16x32_bf16 v[44:47], a[228:231], a[188:191], v[44:47]
    s_add_u32 m0, s67, 12288
    s_mov_b32 s74, 196864
    buffer_load_dwordx4 v9, s[4:7], s74 offen lds
    v_mfma_f32_16x16x32_bf16 v[48:51], a[224:227], a[192:195], v[48:51]
    v_mfma_f32_16x16x32_bf16 v[48:51], a[228:231], a[196:199], v[48:51]
    v_mfma_f32_16x16x32_bf16 v[52:55], a[224:227], a[200:203], v[52:55]
    v_mfma_f32_16x16x32_bf16 v[52:55], a[228:231], a[204:207], v[52:55]
    v_mfma_f32_16x16x32_bf16 v[56:59], a[224:227], a[208:211], v[56:59]
    v_mfma_f32_16x16x32_bf16 v[56:59], a[228:231], a[212:215], v[56:59]
    s_add_u32 m0, s67, 14336
    s_mov_b32 s74, 229632
    buffer_load_dwordx4 v9, s[4:7], s74 offen lds
    v_mfma_f32_16x16x32_bf16 v[60:63], a[224:227], a[216:219], v[60:63]
    v_mfma_f32_16x16x32_bf16 v[60:63], a[228:231], a[220:223], v[60:63]
    s_waitcnt vmcnt(17) lgkmcnt(0)
    s_barrier
    v_mfma_f32_16x16x32_bf16 v[64:67], a[232:235], a[160:163], v[64:67]
    ds_read_b64_tr_b16 a[224:225], v3 offset:24576
    v_mfma_f32_16x16x32_bf16 v[64:67], a[236:239], a[164:167], v[64:67]
    ds_read_b64_tr_b16 a[226:227], v3 offset:25088
    v_mfma_f32_16x16x32_bf16 v[68:71], a[232:235], a[168:171], v[68:71]
    ds_read_b64_tr_b16 a[228:229], v5 offset:24576
    v_mfma_f32_16x16x32_bf16 v[68:71], a[236:239], a[172:175], v[68:71]
    ds_read_b64_tr_b16 a[230:231], v5 offset:25088
    v_mfma_f32_16x16x32_bf16 v[72:75], a[232:235], a[176:179], v[72:75]
    s_add_u32 m0, s66, 0
    s_add_u32 s74, s61, 786432
    buffer_load_dwordx4 v10, s[8:11], s74 offen lds
    v_mfma_f32_16x16x32_bf16 v[72:75], a[236:239], a[180:183], v[72:75]
    v_mfma_f32_16x16x32_bf16 v[76:79], a[232:235], a[184:187], v[76:79]
    v_mfma_f32_16x16x32_bf16 v[76:79], a[236:239], a[188:191], v[76:79]
    v_mfma_f32_16x16x32_bf16 v[80:83], a[232:235], a[192:195], v[80:83]
    s_add_u32 m0, s66, 40960
L_chain0_0:
L_pad0_0:
    s_cbranch_execz L_pad0_4
    s_add_u32 s74, s74, 196608
    buffer_load_dwordx4 v10, s[8:11], s74 offen lds
    v_mfma_f32_16x16x32_bf16 v[80:83], a[236:239], a[196:199], v[80:83]
    v_mfma_f32_16x16x32_bf16 v[84:87], a[232:235], a[200:203], v[84:87]
    v_mfma_f32_16x16x32_bf16 v[84:87], a[236:239], a[204:207], v[84:87]
    v_mfma_f32_16x16x32_bf16 v[88:91], a[232:235], a[208:211], v[88:91]
    v_mfma_f32_16x16x32_bf16 v[88:91], a[236:239], a[212:215], v[88:91]
    v_mfma_f32_16x16x32_bf16 v[92:95], a[232:235], a[216:219], v[92:95]
    s_add_u32 m0, s66, 4096
    s_add_u32 s74, s62, 786432
    buffer_load_dwordx4 v10, s[8:11], s74 offen lds
    v_mfma_f32_16x16x32_bf16 v[92:95], a[236:239], a[220:223], v[92:95]
    s_waitcnt lgkmcnt(0)
    v_mfma_f32_16x16x32_bf16 v[96:99], a[160:163], a[224:227], v[96:99]
    ds_read_b64_tr_b16 a[232:233], v4 offset:24576
    v_mfma_f32_16x16x32_bf16 v[96:99], a[164:167], a[228:231], v[96:99]
    ds_read_b64_tr_b16 a[234:235], v4 offset:25088
    v_mfma_f32_16x16x32_bf16 v[100:103], a[168:171], a[224:227], v[100:103]
    ds_read_b64_tr_b16 a[236:237], v6 offset:24576
    v_mfma_f32_16x16x32_bf16 v[100:103], a[172:175], a[228:231], v[100:103]
    ds_read_b64_tr_b16 a[238:239], v6 offset:25088
    v_mfma_f32_16x16x32_bf16 v[104:107], a[176:179], a[224:227], v[104:107]
    s_add_u32 m0, s66, 45056
    s_add_u32 s74, s74, 196608
    buffer_load_dwordx4 v10, s[8:11], s74 offen lds
    v_mfma_f32_16x16x32_bf16 v[104:107], a[180:183], a[228:231], v[104:107]
    v_mfma_f32_16x16x32_bf16 v[108:111], a[184:187], a[224:227], v[108:111]
    v_mfma_f32_16x16x32_bf16 v[108:111], a[188:191], a[228:231], v[108:111]
    v_mfma_f32_16x16x32_bf16 v[112:115], a[192:195], a[224:227], v[112:115]
    v_mfma_f32_16x16x32_bf16 v[112:115], a[196:199], a[228:231], v[112:115]
    v_mfma_f32_16x16x32_bf16 v[116:119], a[200:203], a[224:227], v[116:119]
    s_add_u32 m0, s66, 8192
    s_add_u32 s74, s63, 917504
    buffer_load_dwordx4 v11, s[12:15], s74 offen lds
    v_mfma_f32_16x16x32_bf16 v[116:119], a[204:207], a[228:231], v[116:119]
    v_mfma_f32_16x16x32_bf16 v[120:123], a[208:211], a[224:227], v[120:123]
    v_mfma_f32_16x16x32_bf16 v[120:123], a[212:215], a[228:231], v[120:123]
    v_mfma_f32_16x16x32_bf16 v[124:127], a[216:219], a[224:227], v[124:127]
    v_mfma_f32_16x16x32_bf16 v[124:127], a[220:223], a[228:231], v[124:127]
    s_waitcnt vmcnt(16) lgkmcnt(0)
    s_barrier
    v_mfma_f32_16x16x32_bf16 v[128:131], a[160:163], a[232:235], v[128:131]
    ds_read_b64_tr_b16 a[224:225], v3 offset:28672
    v_mfma_f32_16x16x32_bf16 v[128:131], a[164:167], a[236:239], v[128:131]
    ds_read_b64_tr_b16 a[226:227], v3 offset:29184
    v_mfma_f32_16x16x32_bf16 v[132:135], a[168:171], a[232:235], v[132:135]
    ds_read_b64_tr_b16 a[228:229], v5 offset:28672
    v_mfma_f32_16x16x32_bf16 v[132:135], a[172:175], a[236:239], v[132:135]
    ds_read_b64_tr_b16 a[230:231], v5 offset:29184
    v_mfma_f32_16x16x32_bf16 v[136:139], a[176:179], a[232:235], v[136:139]
    ds_read_b128 a[96:99], v1
    v_mfma_f32_16x16x32_bf16 v[136:139], a[180:183], a[236:239], v[136:139]
    ds_read_b128 a[100:103], v2
    v_mfma_f32_16x16x32_bf16 v[140:143], a[184:187], a[232:235], v[140:143]
    ds_read_b128 a[104:107], v1 offset:2048
    v_mfma_f32_16x16x32_bf16 v[140:143], a[188:191], a[236:239], v[140:143]
    s_add_u32 m0, s66, 49152
    s_add_u32 s74, s74, 229376
    buffer_load_dwordx4 v11, s[12:15], s74 offen lds
    v_mfma_f32_16x16x32_bf16 v[144:147], a[192:195], a[232:235], v[144:147]
    s_add_u32 m0, s66, 147456
    s_lshl2_add_u32 s73, s48, s44
    s_lshl_b32 s73, s73, 10
    v_mfma_f32_16x16x32_bf16 v[144:147], a[196:199], a[236:239], v[144:147]
    v_mfma_f32_16x16x32_bf16 v[148:151], a[200:203], a[232:235], v[148:151]
    buffer_load_dwordx4 v13, s[40:43], s73 offen lds
    v_mfma_f32_16x16x32_bf16 v[148:151], a[204:207], a[236:239], v[148:151]
    s_add_u32 m0, s67, 32768
    s_mov_b32 s74, 384
    v_mfma_f32_16x16x32_bf16 v[152:155], a[208:211], a[232:235], v[152:155]
    v_mfma_f32_16x16x32_bf16 v[152:155], a[212:215], a[236:239], v[152:155]
    buffer_load_dwordx4 v9, s[4:7], s74 offen lds
    v_mfma_f32_16x16x32_bf16 v[156:159], a[216:219], a[232:235], v[156:159]
    v_mfma_f32_16x16x32_bf16 v[156:159], a[220:223], a[236:239], v[156:159]
    s_waitcnt lgkmcnt(3)
    v_mfma_f32_16x16x32_bf16 v[160:163], a[224:227], a[160:163], v[160:163]
    ds_read_b64_tr_b16 a[232:233], v4 offset:28672
    v_mfma_f32_16x16x32_bf16 v[160:163], a[228:231], a[164:167], v[160:163]
    ds_read_b64_tr_b16 a[234:235], v4 offset:29184
    s_add_u32 m0, s67, 34816
    v_mfma_f32_16x16x32_bf16 v[164:167], a[224:227], a[168:171], v[164:167]
    ds_read_b64_tr_b16 a[236:237], v6 offset:28672
    s_mov_b32 s74, 33152
    v_mfma_f32_16x16x32_bf16 v[164:167], a[228:231], a[172:175], v[164:167]
    ds_read_b64_tr_b16 a[238:239], v6 offset:29184
    buffer_load_dwordx4 v9, s[4:7], s74 offen lds
    v_mfma_f32_16x16x32_bf16 v[168:171], a[224:227], a[176:179], v[168:171]
    ds_read_b128 a[108:111], v2 offset:2048
    v_mfma_f32_16x16x32_bf16 v[168:171], a[228:231], a[180:183], v[168:171]
    ds_read_b128 a[112:115], v1 offset:4096
    v_mfma_f32_16x16x32_bf16 v[172:175], a[224:227], a[184:187], v[172:175]
    ds_read_b128 a[116:119], v2 offset:4096
    v_mfma_f32_16x16x32_bf16 v[172:175], a[228:231], a[188:191], v[172:175]
    s_add_u32 m0, s67, 36864
    s_mov_b32 s74, 65920
    buffer_load_dwordx4 v9, s[4:7], s74 offen lds
    v_mfma_f32_16x16x32_bf16 v[176:179], a[224:227], a[192:195], v[176:179]
    v_mfma_f32_16x16x32_bf16 v[176:179], a[228:231], a[196:199], v[176:179]
    v_mfma_f32_16x16x32_bf16 v[180:183], a[224:227], a[200:203], v[180:183]
    v_mfma_f32_16x16x32_bf16 v[180:183], a[228:231], a[204:207], v[180:183]
    v_mfma_f32_16x16x32_bf16 v[184:187], a[224:227], a[208:211], v[184:187]
    s_add_u32 m0, s66, 12288
    s_add_u32 s74, s64, 917504
    buffer_load_dwordx4 v11, s[16:19], s74 offen lds
    v_mfma_f32_16x16x32_bf16 v[184:187], a[228:231], a[212:215], v[184:187]
    v_mfma_f32_16x16x32_bf16 v[188:191], a[224:227], a[216:219], v[188:191]
    v_mfma_f32_16x16x32_bf16 v[188:191], a[228:231], a[220:223], v[188:191]
    s_waitcnt vmcnt(11) lgkmcnt(0)
    s_barrier
    v_mfma_f32_16x16x32_bf16 v[192:195], a[232:235], a[160:163], v[192:195]
    ds_read_b64_tr_b16 a[224:225], v3 offset:32768
    v_mfma_f32_16x16x32_bf16 v[192:195], a[236:239], a[164:167], v[192:195]
    ds_read_b64_tr_b16 a[226:227], v3 offset:33280
    v_mfma_f32_16x16x32_bf16 v[196:199], a[232:235], a[168:171], v[196:199]
    ds_read_b64_tr_b16 a[228:229], v5 offset:32768
    v_mfma_f32_16x16x32_bf16 v[196:199], a[236:239], a[172:175], v[196:199]
    ds_read_b64_tr_b16 a[230:231], v5 offset:33280
    v_mfma_f32_16x16x32_bf16 v[200:203], a[232:235], a[176:179], v[200:203]
    ds_read_b128 a[120:123], v1 offset:6144
    v_mfma_f32_16x16x32_bf16 v[200:203], a[236:239], a[180:183], v[200:203]
    ds_read_b128 a[124:127], v2 offset:6144
    v_mfma_f32_16x16x32_bf16 v[204:207], a[232:235], a[184:187], v[204:207]
    ds_read_b128 a[128:131], v1 offset:8192
    v_mfma_f32_16x16x32_bf16 v[204:207], a[236:239], a[188:191], v[204:207]
    s_add_u32 m0, s66, 53248
    s_add_u32 s74, s74, 229376
    buffer_load_dwordx4 v11, s[16:19], s74 offen lds
    v_mfma_f32_16x16x32_bf16 v[208:211], a[232:235], a[192:195], v[208:211]
    s_add_u32 m0, s68, 0
    s_add_u32 s74, s65, 917504
    v_mfma_f32_16x16x32_bf16 v[208:211], a[236:239], a[196:199], v[208:211]
    v_mfma_f32_16x16x32_bf16 v[212:215], a[232:235], a[200:203], v[212:215]
    buffer_load_dwordx4 v12, s[12:15], s74 offen lds
    s_mov_b32 s42, 0
    v_mfma_f32_16x16x32_bf16 v[212:215], a[236:239], a[204:207], v[212:215]
    v_mfma_f32_16x16x32_bf16 v[216:219], a[232:235], a[208:211], v[216:219]
    v_mfma_f32_16x16x32_bf16 v[216:219], a[236:239], a[212:215], v[216:219]
    v_mfma_f32_16x16x32_bf16 v[220:223], a[232:235], a[216:219], v[220:223]
    s_add_u32 m0, s68, 2048
    s_nop 0
    buffer_load_dwordx4 v12, s[16:19], s74 offen lds
    v_mfma_f32_16x16x32_bf16 v[220:223], a[236:239], a[220:223], v[220:223]
    s_waitcnt lgkmcnt(3)
    v_mfma_f32_16x16x32_bf16 a[0:3], a[224:227], a[160:163], a[0:3]
    ds_read_b64_tr_b16 a[232:233], v4 offset:32768
    v_mfma_f32_16x16x32_bf16 a[0:3], a[228:231], a[164:167], a[0:3]
    ds_read_b64_tr_b16 a[234:235], v4 offset:33280
    v_mfma_f32_16x16x32_bf16 a[4:7], a[224:227], a[168:171], a[4:7]
    ds_read_b64_tr_b16 a[236:237], v6 offset:32768
    v_mfma_f32_16x16x32_bf16 a[4:7], a[228:231], a[172:175], a[4:7]
    ds_read_b64_tr_b16 a[238:239], v6 offset:33280
    v_mfma_f32_16x16x32_bf16 a[8:11], a[224:227], a[176:179], a[8:11]
    ds_read_b128 a[132:135], v2 offset:8192
    s_add_u32 m0, s67, 38912
    v_mfma_f32_16x16x32_bf16 a[8:11], a[228:231], a[180:183], a[8:11]
    ds_read_b128 a[136:139], v1 offset:10240
    s_mov_b32 s74, 98688
    v_mfma_f32_16x16x32_bf16 a[12:15], a[224:227], a[184:187], a[12:15]
    ds_read_b128 a[140:143], v2 offset:10240
    buffer_load_dwordx4 v9, s[4:7], s74 offen lds
    v_mfma_f32_16x16x32_bf16 a[12:15], a[228:231], a[188:191], a[12:15]
    v_mfma_f32_16x16x32_bf16 a[16:19], a[224:227], a[192:195], a[16:19]
    v_mfma_f32_16x16x32_bf16 a[16:19], a[228:231], a[196:199], a[16:19]
    s_add_u32 m0, s67, 40960
    s_mov_b32 s74, 131456
    buffer_load_dwordx4 v9, s[4:7], s74 offen lds
    v_mfma_f32_16x16x32_bf16 a[20:23], a[224:227], a[200:203], a[20:23]
    v_mfma_f32_16x16x32_bf16 a[20:23], a[228:231], a[204:207], a[20:23]
    v_mfma_f32_16x16x32_bf16 a[24:27], a[224:227], a[208:211], a[24:27]
    v_mfma_f32_16x16x32_bf16 a[24:27], a[228:231], a[212:215], a[24:27]
    v_mfma_f32_16x16x32_bf16 a[28:31], a[224:227], a[216:219], a[28:31]
    v_mfma_f32_16x16x32_bf16 a[28:31], a[228:231], a[220:223], a[28:31]
    s_add_u32 m0, s67, 43008
    s_mov_b32 s74, 164224
    s_waitcnt lgkmcnt(3)
    v_mfma_f32_16x16x32_bf16 a[32:35], a[232:235], a[160:163], a[32:35]
    ds_read_b64_tr_b16 a[224:225], v7 offset:36864
    buffer_load_dwordx4 v9, s[4:7], s74 offen lds
    v_mfma_f32_16x16x32_bf16 a[32:35], a[236:239], a[164:167], a[32:35]
    ds_read_b64_tr_b16 a[226:227], v7 offset:37120
    v_mfma_f32_16x16x32_bf16 a[36:39], a[232:235], a[168:171], a[36:39]
    ds_read_b64_tr_b16 a[228:229], v8 offset:36864
    v_mfma_f32_16x16x32_bf16 a[36:39], a[236:239], a[172:175], a[36:39]
    ds_read_b64_tr_b16 a[230:231], v8 offset:37120
    v_mfma_f32_16x16x32_bf16 a[40:43], a[232:235], a[176:179], a[40:43]
    ds_read_b128 a[144:147], v1 offset:12288
    v_mfma_f32_16x16x32_bf16 a[40:43], a[236:239], a[180:183], a[40:43]
    ds_read_b128 a[148:151], v2 offset:12288
    s_add_u32 m0, s67, 45056
    v_mfma_f32_16x16x32_bf16 a[44:47], a[232:235], a[184:187], a[44:47]
    ds_read_b128 a[152:155], v1 offset:14336
    s_mov_b32 s74, 196992
    v_mfma_f32_16x16x32_bf16 a[44:47], a[236:239], a[188:191], a[44:47]
    buffer_load_dwordx4 v9, s[4:7], s74 offen lds
    v_mfma_f32_16x16x32_bf16 a[48:51], a[232:235], a[192:195], a[48:51]
    v_mfma_f32_16x16x32_bf16 a[48:51], a[236:239], a[196:199], a[48:51]
    v_mfma_f32_16x16x32_bf16 a[52:55], a[232:235], a[200:203], a[52:55]
    v_mfma_f32_16x16x32_bf16 a[52:55], a[236:239], a[204:207], a[52:55]
    s_add_u32 m0, s67, 47104
    s_mov_b32 s74, 229760
    buffer_load_dwordx4 v9, s[4:7], s74 offen lds
    v_mfma_f32_16x16x32_bf16 a[56:59], a[232:235], a[208:211], a[56:59]
    v_mfma_f32_16x16x32_bf16 a[56:59], a[236:239], a[212:215], a[56:59]
    v_mfma_f32_16x16x32_bf16 a[60:63], a[232:235], a[216:219], a[60:63]
    v_mfma_f32_16x16x32_bf16 a[60:63], a[236:239], a[220:223], a[60:63]
    s_waitcnt lgkmcnt(3)
    v_mfma_f32_16x16x32_bf16 v[224:227], a[224:227], a[160:163], v[224:227]
    ds_read_b64_tr_b16 a[232:233], v7 offset:38912
    v_mfma_f32_16x16x32_bf16 v[224:227], a[228:231], a[164:167], v[224:227]
    ds_read_b64_tr_b16 a[234:235], v7 offset:39168
    v_mfma_f32_16x16x32_bf16 v[228:231], a[224:227], a[168:171], v[228:231]
    ds_read_b64_tr_b16 a[236:237], v8 offset:38912
    v_mfma_f32_16x16x32_bf16 v[228:231], a[228:231], a[172:175], v[228:231]
    ds_read_b64_tr_b16 a[238:239], v8 offset:39168
    v_mfma_f32_16x16x32_bf16 v[232:235], a[224:227], a[176:179], v[232:235]
    ds_read_b128 a[156:159], v2 offset:14336
    v_mfma_f32_16x16x32_bf16 v[232:235], a[228:231], a[180:183], v[232:235]
    v_mfma_f32_16x16x32_bf16 v[236:239], a[224:227], a[184:187], v[236:239]
    v_mfma_f32_16x16x32_bf16 v[236:239], a[228:231], a[188:191], v[236:239]
    v_mfma_f32_16x16x32_bf16 v[240:243], a[224:227], a[192:195], v[240:243]
    v_mfma_f32_16x16x32_bf16 v[240:243], a[228:231], a[196:199], v[240:243]
    v_mfma_f32_16x16x32_bf16 v[244:247], a[224:227], a[200:203], v[244:247]
    v_mfma_f32_16x16x32_bf16 v[244:247], a[228:231], a[204:207], v[244:247]
    v_mfma_f32_16x16x32_bf16 v[248:251], a[224:227], a[208:211], v[248:251]
    v_mfma_f32_16x16x32_bf16 v[248:251], a[228:231], a[212:215], v[248:251]
    v_mfma_f32_16x16x32_bf16 v[252:255], a[224:227], a[216:219], v[252:255]
    v_mfma_f32_16x16x32_bf16 v[252:255], a[228:231], a[220:223], v[252:255]
    s_waitcnt vmcnt(9) lgkmcnt(0)
    s_barrier
    v_mfma_f32_16x16x32_bf16 a[64:67], a[232:235], a[160:163], a[64:67]
    ds_read_b64_tr_b16 a[224:225], v3
    v_mfma_f32_16x16x32_bf16 a[64:67], a[236:239], a[164:167], a[64:67]
    ds_read_b64_tr_b16 a[226:227], v3 offset:512
    v_mfma_f32_16x16x32_bf16 a[68:71], a[232:235], a[168:171], a[68:71]
    ds_read_b64_tr_b16 a[228:229], v5
    v_mfma_f32_16x16x32_bf16 a[68:71], a[236:239], a[172:175], a[68:71]
    ds_read_b64_tr_b16 a[230:231], v5 offset:512
    v_mfma_f32_16x16x32_bf16 a[72:75], a[232:235], a[176:179], a[72:75]
    s_add_u32 m0, s66, 20480
    s_add_u32 s74, s61, 1179648
    buffer_load_dwordx4 v10, s[8:11], s74 offen lds
    v_mfma_f32_16x16x32_bf16 a[72:75], a[236:239], a[180:183], a[72:75]
    s_add_u32 m0, s66, 61440
    s_add_u32 s74, s74, 196608
    v_mfma_f32_16x16x32_bf16 a[76:79], a[232:235], a[184:187], a[76:79]
    v_mfma_f32_16x16x32_bf16 a[76:79], a[236:239], a[188:191], a[76:79]
    buffer_load_dwordx4 v10, s[8:11], s74 offen lds
    v_mfma_f32_16x16x32_bf16 a[80:83], a[232:235], a[192:195], a[80:83]
    v_mfma_f32_16x16x32_bf16 a[80:83], a[236:239], a[196:199], a[80:83]
    v_mfma_f32_16x16x32_bf16 a[84:87], a[232:235], a[200:203], a[84:87]
    v_mfma_f32_16x16x32_bf16 a[84:87], a[236:239], a[204:207], a[84:87]
    v_mfma_f32_16x16x32_bf16 a[88:91], a[232:235], a[208:211], a[88:91]
    v_mfma_f32_16x16x32_bf16 a[88:91], a[236:239], a[212:215], a[88:91]
    v_mfma_f32_16x16x32_bf16 a[92:95], a[232:235], a[216:219], a[92:95]
    v_mfma_f32_16x16x32_bf16 a[92:95], a[236:239], a[220:223], a[92:95]
    s_branch L_next0
    .p2align 3
L_main0:
    s_waitcnt lgkmcnt(0)
    v_mfma_f32_16x16x32_bf16 v[32:35], a[224:227], a[96:99], v[32:35]
    ds_read_b64_tr_b16 a[232:233], v4
    v_mfma_f32_16x16x32_bf16 v[32:35], a[228:231], a[100:103], v[32:35]
    ds_read_b64_tr_b16 a[234:235], v4 offset:512
    v_mfma_f32_16x16x32_bf16 v[36:39], a[224:227], a[104:107], v[36:39]
    ds_read_b64_tr_b16 a[236:237], v6
    v_mfma_f32_16x16x32_bf16 v[36:39], a[228:231], a[108:111], v[36:39]
    ds_read_b64_tr_b16 a[238:239], v6 offset:512
    v_mfma_f32_16x16x32_bf16 v[40:43], a[224:227], a[112:115], v[40:43]
    ds_read_b128 a[160:163], v1 offset:32768
    v_mfma_f32_16x16x32_bf16 v[40:43], a[228:231], a[116:119], v[40:43]
    ds_read_b128 a[164:167], v2 offset:32768
    v_mfma_f32_16x16x32_bf16 v[44:47], a[224:227], a[120:123], v[44:47]
    v_mfma_f32_16x16x32_bf16 v[44:47], a[228:231], a[124:127], v[44:47]
    s_add_u32 m0, s66, 24576
    s_add_u32 s74, s62, s58
    v_mfma_f32_16x16x32_bf16 v[48:51], a[224:227], a[128:131], v[48:51]
    buffer_load_dwordx4 v10, s[8:11], s74 offen lds
    v_mfma_f32_16x16x32_bf16 v[48:51], a[228:231], a[132:135], v[48:51]
    buffer_load_dword a254, v0, s[92:95], s69 offen
    v_mfma_f32_16x16x32_bf16 v[52:55], a[224:227], a[136:139], v[52:55]
    s_add_u32 s69, s69, s79
    v_mfma_f32_16x16x32_bf16 v[52:55], a[228:231], a[140:143], v[52:55]
    s_and_b32 s69, s69, s3
    v_mfma_f32_16x16x32_bf16 v[56:59], a[224:227], a[144:147], v[56:59]
    v_mfma_f32_16x16x32_bf16 v[56:59], a[228:231], a[148:151], v[56:59]
    s_add_u32 m0, s66, 65536
    s_add_u32 s74, s74, 196608
    v_mfma_f32_16x16x32_bf16 v[60:63], a[224:227], a[152:155], v[60:63]
    buffer_load_dwordx4 v10, s[8:11], s74 offen lds
    v_mfma_f32_16x16x32_bf16 v[60:63], a[228:231], a[156:159], v[60:63]
    s_waitcnt lgkmcnt(2)
    v_mfma_f32_16x16x32_bf16 v[64:67], a[232:235], a[96:99], v[64:67]
    ds_read_b64_tr_b16 a[224:225], v3 offset:4096
    v_mfma_f32_16x16x32_bf16 v[64:67], a[236:239], a[100:103], v[64:67]
    ds_read_b64_tr_b16 a[226:227], v3 offset:4608
    v_mfma_f32_16x16x32_bf16 v[68:71], a[232:235], a[104:107], v[68:71]
    ds_read_b64_tr_b16 a[228:229], v5 offset:4096
    v_mfma_f32_16x16x32_bf16 v[68:71], a[236:239], a[108:111], v[68:71]
    ds_read_b64_tr_b16 a[230:231], v5 offset:4608
    v_mfma_f32_16x16x32_bf16 v[72:75], a[232:235], a[112:115], v[72:75]
    ds_read_b128 a[168:171], v1 offset:34816
    v_mfma_f32_16x16x32_bf16 v[72:75], a[236:239], a[116:119], v[72:75]
    ds_read_b128 a[172:175], v2 offset:34816
    v_mfma_f32_16x16x32_bf16 v[76:79], a[232:235], a[120:123], v[76:79]
    v_mfma_f32_16x16x32_bf16 v[76:79], a[236:239], a[124:127], v[76:79]
    v_mfma_f32_16x16x32_bf16 v[80:83], a[232:235], a[128:131], v[80:83]
    v_mfma_f32_16x16x32_bf16 v[80:83], a[236:239], a[132:135], v[80:83]
    v_mfma_f32_16x16x32_bf16 v[84:87], a[232:235], a[136:139], v[84:87]
    s_add_u32 m0, s66, 28672
    s_add_u32 s74, s63, s59
    v_mfma_f32_16x16x32_bf16 v[84:87], a[236:239], a[140:143], v[84:87]
    buffer_load_dwordx4 v11, s[12:15], s74 offen lds
    v_mfma_f32_16x16x32_bf16 v[88:91], a[232:235], a[144:147], v[88:91]
    v_mfma_f32_16x16x32_bf16 v[88:91], a[236:239], a[148:151], v[88:91]
    v_mfma_f32_16x16x32_bf16 v[92:95], a[232:235], a[152:155], v[92:95]
    v_mfma_f32_16x16x32_bf16 v[92:95], a[236:239], a[156:159], v[92:95]
    s_waitcnt lgkmcnt(2)
    v_mfma_f32_16x16x32_bf16 v[96:99], a[96:99], a[224:227], v[96:99]
    ds_read_b64_tr_b16 a[232:233], v4 offset:4096
    v_mfma_f32_16x16x32_bf16 v[96:99], a[100:103], a[228:231], v[96:99]
    ds_read_b64_tr_b16 a[234:235], v4 offset:4608
    v_mfma_f32_16x16x32_bf16 v[100:103], a[104:107], a[224:227], v[100:103]
    ds_read_b64_tr_b16 a[236:237], v6 offset:4096
    v_mfma_f32_16x16x32_bf16 v[100:103], a[108:111], a[228:231], v[100:103]
    ds_read_b64_tr_b16 a[238:239], v6 offset:4608
    v_mfma_f32_16x16x32_bf16 v[104:107], a[112:115], a[224:227], v[104:107]
    ds_read_b128 a[176:179], v1 offset:36864
    v_mfma_f32_16x16x32_bf16 v[104:107], a[116:119], a[228:231], v[104:107]
    v_mfma_f32_16x16x32_bf16 v[108:111], a[120:123], a[224:227], v[108:111]
    v_mfma_f32_16x16x32_bf16 v[108:111], a[124:127], a[228:231], v[108:111]
    s_add_u32 m0, s66, 69632
    s_add_u32 s74, s74, 229376
    v_mfma_f32_16x16x32_bf16 v[112:115], a[128:131], a[224:227], v[112:115]
    buffer_load_dwordx4 v11, s[12:15], s74 offen lds
    v_mfma_f32_16x16x32_bf16 v[112:115], a[132:135], a[228:231], v[112:115]
    v_mfma_f32_16x16x32_bf16 v[116:119], a[136:139], a[224:227], v[116:119]
    v_mfma_f32_16x16x32_bf16 v[116:119], a[140:143], a[228:231], v[116:119]
    v_mfma_f32_16x16x32_bf16 v[120:123], a[144:147], a[224:227], v[120:123]
    v_mfma_f32_16x16x32_bf16 v[120:123], a[148:151], a[228:231], v[120:123]
    s_add_u32 m0, s67, 0
    s_add_u32 s74, s57, 0
    v_mfma_f32_16x16x32_bf16 v[124:127], a[152:155], a[224:227], v[124:127]
    buffer_load_dwordx4 v9, s[4:7], s74 offen lds
    v_mfma_f32_16x16x32_bf16 v[124:127], a[156:159], a[228:231], v[124:127]
    s_waitcnt lgkmcnt(1)
    v_mfma_f32_16x16x32_bf16 v[128:131], a[96:99], a[232:235], v[128:131]
    ds_read_b64_tr_b16 a[224:225], v3 offset:8192
    v_mfma_f32_16x16x32_bf16 v[128:131], a[100:103], a[236:239], v[128:131]
    ds_read_b64_tr_b16 a[226:227], v3 offset:8704
    v_mfma_f32_16x16x32_bf16 v[132:135], a[104:107], a[232:235], v[132:135]
    ds_read_b64_tr_b16 a[228:229], v5 offset:8192
    v_mfma_f32_16x16x32_bf16 v[132:135], a[108:111], a[236:239], v[132:135]
    ds_read_b64_tr_b16 a[230:231], v5 offset:8704
    v_mfma_f32_16x16x32_bf16 v[136:139], a[112:115], a[232:235], v[136:139]
    ds_read_b128 a[180:183], v2 offset:36864
    v_mfma_f32_16x16x32_bf16 v[136:139], a[116:119], a[236:239], v[136:139]
    v_mfma_f32_16x16x32_bf16 v[140:143], a[120:123], a[232:235], v[140:143]
    v_mfma_f32_16x16x32_bf16 v[140:143], a[124:127], a[236:239], v[140:143]
    v_mfma_f32_16x16x32_bf16 v[144:147], a[128:131], a[232:235], v[144:147]
    v_mfma_f32_16x16x32_bf16 v[144:147], a[132:135], a[236:239], v[144:147]
    v_mfma_f32_16x16x32_bf16 v[148:151], a[136:139], a[232:235], v[148:151]
    s_add_u32 m0, s67, 2048
    s_add_u32 s74, s57, 32768
    v_mfma_f32_16x16x32_bf16 v[148:151], a[140:143], a[236:239], v[148:151]
    buffer_load_dwordx4 v9, s[4:7], s74 offen lds
    v_mfma_f32_16x16x32_bf16 v[152:155], a[144:147], a[232:235], v[152:155]
    v_mfma_f32_16x16x32_bf16 v[152:155], a[148:151], a[236:239], v[152:155]
    v_mfma_f32_16x16x32_bf16 v[156:159], a[152:155], a[232:235], v[156:159]
    v_mfma_f32_16x16x32_bf16 v[156:159], a[156:159], a[236:239], v[156:159]
    s_waitcnt lgkmcnt(1)
    v_mfma_f32_16x16x32_bf16 v[160:163], a[224:227], a[96:99], v[160:163]
    ds_read_b64_tr_b16 a[232:233], v4 offset:8192
    v_mfma_f32_16x16x32_bf16 v[160:163], a[228:231], a[100:103], v[160:163]
    ds_read_b64_tr_b16 a[234:235], v4 offset:8704
    v_mfma_f32_16x16x32_bf16 v[164:167], a[224:227], a[104:107], v[164:167]
    ds_read_b64_tr_b16 a[236:237], v6 offset:8192
    v_mfma_f32_16x16x32_bf16 v[164:167], a[228:231], a[108:111], v[164:167]
    ds_read_b64_tr_b16 a[238:239], v6 offset:8704
    v_mfma_f32_16x16x32_bf16 v[168:171], a[224:227], a[112:115], v[168:171]
    v_mfma_f32_16x16x32_bf16 v[168:171], a[228:231], a[116:119], v[168:171]
    v_mfma_f32_16x16x32_bf16 v[172:175], a[224:227], a[120:123], v[172:175]
    v_mfma_f32_16x16x32_bf16 v[172:175], a[228:231], a[124:127], v[172:175]
    s_add_u32 m0, s67, 4096
    s_add_u32 s74, s57, 65536
    v_mfma_f32_16x16x32_bf16 v[176:179], a[224:227], a[128:131], v[176:179]
    buffer_load_dwordx4 v9, s[4:7], s74 offen lds
    v_mfma_f32_16x16x32_bf16 v[176:179], a[228:231], a[132:135], v[176:179]
    v_mfma_f32_16x16x32_bf16 v[180:183], a[224:227], a[136:139], v[180:183]
    v_mfma_f32_16x16x32_bf16 v[180:183], a[228:231], a[140:143], v[180:183]
    v_mfma_f32_16x16x32_bf16 v[184:187], a[224:227], a[144:147], v[184:187]
    v_mfma_f32_16x16x32_bf16 v[184:187], a[228:231], a[148:151], v[184:187]
    v_mfma_f32_16x16x32_bf16 v[188:191], a[224:227], a[152:155], v[188:191]
    v_mfma_f32_16x16x32_bf16 v[188:191], a[228:231], a[156:159], v[188:191]
    s_waitcnt vmcnt(10) lgkmcnt(0)
    s_barrier
    v_mfma_f32_16x16x32_bf16 v[192:195], a[232:235], a[96:99], v[192:195]
    ds_read_b64_tr_b16 a[224:225], v3 offset:12288
    v_mfma_f32_16x16x32_bf16 v[192:195], a[236:239], a[100:103], v[192:195]
    ds_read_b64_tr_b16 a[226:227], v3 offset:12800
    v_mfma_f32_16x16x32_bf16 v[196:199], a[232:235], a[104:107], v[196:199]
    ds_read_b64_tr_b16 a[228:229], v5 offset:12288
    v_mfma_f32_16x16x32_bf16 v[196:199], a[236:239], a[108:111], v[196:199]
    ds_read_b64_tr_b16 a[230:231], v5 offset:12800
    v_mfma_f32_16x16x32_bf16 v[200:203], a[232:235], a[112:115], v[200:203]
    ds_read_b128 a[184:187], v1 offset:38912
    v_mfma_f32_16x16x32_bf16 v[200:203], a[236:239], a[116:119], v[200:203]
    ds_read_b128 a[188:191], v2 offset:38912
    v_mfma_f32_16x16x32_bf16 v[204:207], a[232:235], a[120:123], v[204:207]
    ds_read_b128 a[192:195], v1 offset:40960
    v_mfma_f32_16x16x32_bf16 v[204:207], a[236:239], a[124:127], v[204:207]
    s_add_u32 m0, s66, 32768
    s_add_u32 s74, s64, s59
    v_mfma_f32_16x16x32_bf16 v[208:211], a[232:235], a[128:131], v[208:211]
    buffer_load_dwordx4 v11, s[16:19], s74 offen lds
    v_mfma_f32_16x16x32_bf16 v[208:211], a[236:239], a[132:135], v[208:211]
    v_mfma_f32_16x16x32_bf16 v[212:215], a[232:235], a[136:139], v[212:215]
    s_add_u32 m0, s66, 73728
    s_add_u32 s74, s74, 229376
    v_mfma_f32_16x16x32_bf16 v[212:215], a[236:239], a[140:143], v[212:215]
    buffer_load_dwordx4 v11, s[16:19], s74 offen lds
    v_mfma_f32_16x16x32_bf16 v[216:219], a[232:235], a[144:147], v[216:219]
    v_mfma_f32_16x16x32_bf16 v[216:219], a[236:239], a[148:151], v[216:219]
    s_add_u32 m0, s68, 20480
    s_add_u32 s74, s65, s59
    v_mfma_f32_16x16x32_bf16 v[220:223], a[232:235], a[152:155], v[220:223]
    buffer_load_dwordx4 v12, s[12:15], s74 offen lds
    v_mfma_f32_16x16x32_bf16 v[220:223], a[236:239], a[156:159], v[220:223]
    s_waitcnt lgkmcnt(3)
    v_mfma_f32_16x16x32_bf16 a[0:3], a[224:227], a[96:99], a[0:3]
    ds_read_b64_tr_b16 a[232:233], v4 offset:12288
    v_mfma_f32_16x16x32_bf16 a[0:3], a[228:231], a[100:103], a[0:3]
    ds_read_b64_tr_b16 a[234:235], v4 offset:12800
    v_mfma_f32_16x16x32_bf16 a[4:7], a[224:227], a[104:107], a[4:7]
    ds_read_b64_tr_b16 a[236:237], v6 offset:12288
    v_mfma_f32_16x16x32_bf16 a[4:7], a[228:231], a[108:111], a[4:7]
    ds_read_b64_tr_b16 a[238:239], v6 offset:12800
    v_mfma_f32_16x16x32_bf16 a[8:11], a[224:227], a[112:115], a[8:11]
    ds_read_b128 a[196:199], v2 offset:40960
    v_mfma_f32_16x16x32_bf16 a[8:11], a[228:231], a[116:119], a[8:11]
    ds_read_b128 a[200:203], v1 offset:43008
    v_mfma_f32_16x16x32_bf16 a[12:15], a[224:227], a[120:123], a[12:15]
    ds_read_b128 a[204:207], v2 offset:43008
    v_mfma_f32_16x16x32_bf16 a[12:15], a[228:231], a[124:127], a[12:15]
    s_add_u32 m0, s68, 22528
    v_mfma_f32_16x16x32_bf16 a[16:19], a[224:227], a[128:131], a[16:19]
    buffer_load_dwordx4 v12, s[16:19], s74 offen lds
    v_mfma_f32_16x16x32_bf16 a[16:19], a[228:231], a[132:135], a[16:19]
    v_mfma_f32_16x16x32_bf16 a[20:23], a[224:227], a[136:139], a[20:23]
    v_mfma_f32_16x16x32_bf16 a[20:23], a[228:231], a[140:143], a[20:23]
    v_mfma_f32_16x16x32_bf16 a[24:27], a[224:227], a[144:147], a[24:27]
    v_mfma_f32_16x16x32_bf16 a[24:27], a[228:231], a[148:151], a[24:27]
    s_add_u32 m0, s67, 6144
    s_add_u32 s74, s57, 98304
    v_mfma_f32_16x16x32_bf16 a[28:31], a[224:227], a[152:155], a[28:31]
    buffer_load_dwordx4 v9, s[4:7], s74 offen lds
    v_mfma_f32_16x16x32_bf16 a[28:31], a[228:231], a[156:159], a[28:31]
    s_waitcnt lgkmcnt(3)
    v_mfma_f32_16x16x32_bf16 a[32:35], a[232:235], a[96:99], a[32:35]
    ds_read_b64_tr_b16 a[224:225], v7 offset:16384
    v_mfma_f32_16x16x32_bf16 a[32:35], a[236:239], a[100:103], a[32:35]
    ds_read_b64_tr_b16 a[226:227], v7 offset:16640
    v_mfma_f32_16x16x32_bf16 a[36:39], a[232:235], a[104:107], a[36:39]
    ds_read_b64_tr_b16 a[228:229], v8 offset:16384
    v_mfma_f32_16x16x32_bf16 a[36:39], a[236:239], a[108:111], a[36:39]
    ds_read_b64_tr_b16 a[230:231], v8 offset:16640
    v_mfma_f32_16x16x32_bf16 a[40:43], a[232:235], a[112:115], a[40:43]
    ds_read_b128 a[208:211], v1 offset:45056
    v_mfma_f32_16x16x32_bf16 a[40:43], a[236:239], a[116:119], a[40:43]
    ds_read_b128 a[212:215], v2 offset:45056
    v_mfma_f32_16x16x32_bf16 a[44:47], a[232:235], a[120:123], a[44:47]
    v_mfma_f32_16x16x32_bf16 a[44:47], a[236:239], a[124:127], a[44:47]
    s_add_u32 m0, s67, 8192
    s_add_u32 s74, s57, 131072
    v_mfma_f32_16x16x32_bf16 a[48:51], a[232:235], a[128:131], a[48:51]
    buffer_load_dwordx4 v9, s[4:7], s74 offen lds
    v_mfma_f32_16x16x32_bf16 a[48:51], a[236:239], a[132:135], a[48:51]
    v_mfma_f32_16x16x32_bf16 a[52:55], a[232:235], a[136:139], a[52:55]
    s_mul_i32 s58, s60, 393216
    v_mfma_f32_16x16x32_bf16 a[52:55], a[236:239], a[140:143], a[52:55]
    s_mul_i32 s59, s60, 458752
    v_mfma_f32_16x16x32_bf16 a[56:59], a[232:235], a[144:147], a[56:59]
    v_mfma_f32_16x16x32_bf16 a[56:59], a[236:239], a[148:151], a[56:59]
    s_add_u32 m0, s67, 10240
    s_add_u32 s74, s57, 163840
    v_mfma_f32_16x16x32_bf16 a[60:63], a[232:235], a[152:155], a[60:63]
    buffer_load_dwordx4 v9, s[4:7], s74 offen lds
    v_mfma_f32_16x16x32_bf16 a[60:63], a[236:239], a[156:159], a[60:63]
    s_waitcnt lgkmcnt(2)
    v_mfma_f32_16x16x32_bf16 v[224:227], a[224:227], a[96:99], v[224:227]
    ds_read_b64_tr_b16 a[232:233], v7 offset:18432
    v_mfma_f32_16x16x32_bf16 v[224:227], a[228:231], a[100:103], v[224:227]
    ds_read_b64_tr_b16 a[234:235], v7 offset:18688
    v_mfma_f32_16x16x32_bf16 v[228:231], a[224:227], a[104:107], v[228:231]
    ds_read_b64_tr_b16 a[236:237], v8 offset:18432
    v_mfma_f32_16x16x32_bf16 v[228:231], a[228:231], a[108:111], v[228:231]
    ds_read_b64_tr_b16 a[238:239], v8 offset:18688
    v_mfma_f32_16x16x32_bf16 v[232:235], a[224:227], a[112:115], v[232:235]
    ds_read_b128 a[216:219], v1 offset:47104
    v_mfma_f32_16x16x32_bf16 v[232:235], a[228:231], a[116:119], v[232:235]
    ds_read_b128 a[220:223], v2 offset:47104
    v_mfma_f32_16x16x32_bf16 v[236:239], a[224:227], a[120:123], v[236:239]
    v_mfma_f32_16x16x32_bf16 v[236:239], a[228:231], a[124:127], v[236:239]
    s_add_u32 m0, s67, 12288
    s_add_u32 s74, s57, 196608
    v_mfma_f32_16x16x32_bf16 v[240:243], a[224:227], a[128:131], v[240:243]
    buffer_load_dwordx4 v9, s[4:7], s74 offen lds
    v_mfma_f32_16x16x32_bf16 v[240:243], a[228:231], a[132:135], v[240:243]
    v_mfma_f32_16x16x32_bf16 v[244:247], a[224:227], a[136:139], v[244:247]
    s_add_u32 s60, s60, 1
    v_mfma_f32_16x16x32_bf16 v[244:247], a[228:231], a[140:143], v[244:247]
    s_cmp_eq_u32 s60, 16
    s_cselect_b32 s60, 4, s60
    v_mfma_f32_16x16x32_bf16 v[248:251], a[224:227], a[144:147], v[248:251]
    v_mfma_f32_16x16x32_bf16 v[248:251], a[228:231], a[148:151], v[248:251]
    s_add_u32 m0, s67, 14336
    s_add_u32 s74, s57, 229376
    v_mfma_f32_16x16x32_bf16 v[252:255], a[224:227], a[152:155], v[252:255]
    buffer_load_dwordx4 v9, s[4:7], s74 offen lds
    v_mfma_f32_16x16x32_bf16 v[252:255], a[228:231], a[156:159], v[252:255]
    s_waitcnt vmcnt(9) lgkmcnt(0)
    s_barrier
    v_mfma_f32_16x16x32_bf16 a[64:67], a[232:235], a[96:99], a[64:67]
    ds_read_b64_tr_b16 a[224:225], v3 offset:20480
    v_mfma_f32_16x16x32_bf16 a[64:67], a[236:239], a[100:103], a[64:67]
    ds_read_b64_tr_b16 a[226:227], v3 offset:20992
    v_mfma_f32_16x16x32_bf16 a[68:71], a[232:235], a[104:107], a[68:71]
    ds_read_b64_tr_b16 a[228:229], v5 offset:20480
    v_mfma_f32_16x16x32_bf16 a[68:71], a[236:239], a[108:111], a[68:71]
    ds_read_b64_tr_b16 a[230:231], v5 offset:20992
    v_mfma_f32_16x16x32_bf16 a[72:75], a[232:235], a[112:115], a[72:75]
    v_mfma_f32_16x16x32_bf16 a[72:75], a[236:239], a[116:119], a[72:75]
    s_lshl_b32 s57, s60, 7
    v_mfma_f32_16x16x32_bf16 a[76:79], a[232:235], a[120:123], a[76:79]
    v_mfma_f32_16x16x32_bf16 a[76:79], a[236:239], a[124:127], a[76:79]
L_chain0_1:
L_pad0_1:
    s_cbranch_execz L_pad0_5
    s_add_u32 m0, s66, 0
    s_add_u32 s74, s61, s58
    v_mfma_f32_16x16x32_bf16 a[80:83], a[232:235], a[128:131], a[80:83]
    buffer_load_dwordx4 v10, s[8:11], s74 offen lds
    v_mfma_f32_16x16x32_bf16 a[80:83], a[236:239], a[132:135], a[80:83]
    v_mfma_f32_16x16x32_bf16 a[84:87], a[232:235], a[136:139], a[84:87]
    v_mfma_f32_16x16x32_bf16 a[84:87], a[236:239], a[140:143], a[84:87]
    v_mfma_f32_16x16x32_bf16 a[88:91], a[232:235], a[144:147], a[88:91]
    v_mfma_f32_16x16x32_bf16 a[88:91], a[236:239], a[148:151], a[88:91]
    s_add_u32 m0, s66, 40960
    s_add_u32 s74, s74, 196608
    v_mfma_f32_16x16x32_bf16 a[92:95], a[232:235], a[152:155], a[92:95]
    buffer_load_dwordx4 v10, s[8:11], s74 offen lds
    v_mfma_f32_16x16x32_bf16 a[92:95], a[236:239], a[156:159], a[92:95]
    s_waitcnt lgkmcnt(0)
    v_mfma_f32_16x16x32_bf16 v[32:35], a[224:227], a[160:163], v[32:35]
    ds_read_b64_tr_b16 a[232:233], v4 offset:20480
    v_mfma_f32_16x16x32_bf16 v[32:35], a[228:231], a[164:167], v[32:35]
    ds_read_b64_tr_b16 a[234:235], v4 offset:20992
    v_mfma_f32_16x16x32_bf16 v[36:39], a[224:227], a[168:171], v[36:39]
    ds_read_b64_tr_b16 a[236:237], v6 offset:20480
    v_mfma_f32_16x16x32_bf16 v[36:39], a[228:231], a[172:175], v[36:39]
    ds_read_b64_tr_b16 a[238:239], v6 offset:20992
    v_mfma_f32_16x16x32_bf16 v[40:43], a[224:227], a[176:179], v[40:43]
    ds_read_b128 a[96:99], v1
    v_mfma_f32_16x16x32_bf16 v[40:43], a[228:231], a[180:183], v[40:43]
    ds_read_b128 a[100:103], v2
    v_mfma_f32_16x16x32_bf16 v[44:47], a[224:227], a[184:187], v[44:47]
    v_mfma_f32_16x16x32_bf16 v[44:47], a[228:231], a[188:191], v[44:47]
    s_add_u32 m0, s66, 4096
    s_add_u32 s74, s62, s58
    v_mfma_f32_16x16x32_bf16 v[48:51], a[224:227], a[192:195], v[48:51]
    buffer_load_dwordx4 v10, s[8:11], s74 offen lds
    v_mfma_f32_16x16x32_bf16 v[48:51], a[228:231], a[196:199], v[48:51]
    buffer_load_dword a254, v0, s[92:95], s69 offen
    v_mfma_f32_16x16x32_bf16 v[52:55], a[224:227], a[200:203], v[52:55]
    s_add_u32 s69, s69, s79
    v_mfma_f32_16x16x32_bf16 v[52:55], a[228:231], a[204:207], v[52:55]
    s_and_b32 s69, s69, s3
    v_mfma_f32_16x16x32_bf16 v[56:59], a[224:227], a[208:211], v[56:59]
    v_mfma_f32_16x16x32_bf16 v[56:59], a[228:231], a[212:215], v[56:59]
    s_add_u32 m0, s66, 45056
    s_add_u32 s74, s74, 196608
    v_mfma_f32_16x16x32_bf16 v[60:63], a[224:227], a[216:219], v[60:63]
    buffer_load_dwordx4 v10, s[8:11], s74 offen lds
    v_mfma_f32_16x16x32_bf16 v[60:63], a[228:231], a[220:223], v[60:63]
    s_waitcnt lgkmcnt(2)
    v_mfma_f32_16x16x32_bf16 v[64:67], a[232:235], a[160:163], v[64:67]
    ds_read_b64_tr_b16 a[224:225], v3 offset:24576
    v_mfma_f32_16x16x32_bf16 v[64:67], a[236:239], a[164:167], v[64:67]
    ds_read_b64_tr_b16 a[226:227], v3 offset:25088
    v_mfma_f32_16x16x32_bf16 v[68:71], a[232:235], a[168:171], v[68:71]
    ds_read_b64_tr_b16 a[228:229], v5 offset:24576
    v_mfma_f32_16x16x32_bf16 v[68:71], a[236:239], a[172:175], v[68:71]
    ds_read_b64_tr_b16 a[230:231], v5 offset:25088
    v_mfma_f32_16x16x32_bf16 v[72:75], a[232:235], a[176:179], v[72:75]
    ds_read_b128 a[104:107], v1 offset:2048
    v_mfma_f32_16x16x32_bf16 v[72:75], a[236:239], a[180:183], v[72:75]
    ds_read_b128 a[108:111], v2 offset:2048
    v_mfma_f32_16x16x32_bf16 v[76:79], a[232:235], a[184:187], v[76:79]
    v_mfma_f32_16x16x32_bf16 v[76:79], a[236:239], a[188:191], v[76:79]
    v_mfma_f32_16x16x32_bf16 v[80:83], a[232:235], a[192:195], v[80:83]
    v_mfma_f32_16x16x32_bf16 v[80:83], a[236:239], a[196:199], v[80:83]
    v_mfma_f32_16x16x32_bf16 v[84:87], a[232:235], a[200:203], v[84:87]
    s_add_u32 m0, s66, 8192
    s_add_u32 s74, s63, s59
    v_mfma_f32_16x16x32_bf16 v[84:87], a[236:239], a[204:207], v[84:87]
    buffer_load_dwordx4 v11, s[12:15], s74 offen lds
    v_mfma_f32_16x16x32_bf16 v[88:91], a[232:235], a[208:211], v[88:91]
    v_mfma_f32_16x16x32_bf16 v[88:91], a[236:239], a[212:215], v[88:91]
    v_mfma_f32_16x16x32_bf16 v[92:95], a[232:235], a[216:219], v[92:95]
    v_mfma_f32_16x16x32_bf16 v[92:95], a[236:239], a[220:223], v[92:95]
    s_waitcnt lgkmcnt(2)
    v_mfma_f32_16x16x32_bf16 v[96:99], a[160:163], a[224:227], v[96:99]
    ds_read_b64_tr_b16 a[232:233], v4 offset:24576
    v_mfma_f32_16x16x32_bf16 v[96:99], a[164:167], a[228:231], v[96:99]
    ds_read_b64_tr_b16 a[234:235], v4 offset:25088
    v_mfma_f32_16x16x32_bf16 v[100:103], a[168:171], a[224:227], v[100:103]
    ds_read_b64_tr_b16 a[236:237], v6 offset:24576
    v_mfma_f32_16x16x32_bf16 v[100:103], a[172:175], a[228:231], v[100:103]
    ds_read_b64_tr_b16 a[238:239], v6 offset:25088
    v_mfma_f32_16x16x32_bf16 v[104:107], a[176:179], a[224:227], v[104:107]
    ds_read_b128 a[112:115], v1 offset:4096
    v_mfma_f32_16x16x32_bf16 v[104:107], a[180:183], a[228:231], v[104:107]
    v_mfma_f32_16x16x32_bf16 v[108:111], a[184:187], a[224:227], v[108:111]
    v_mfma_f32_16x16x32_bf16 v[108:111], a[188:191], a[228:231], v[108:111]
    s_add_u32 m0, s66, 49152
    s_add_u32 s74, s74, 229376
    v_mfma_f32_16x16x32_bf16 v[112:115], a[192:195], a[224:227], v[112:115]
    buffer_load_dwordx4 v11, s[12:15], s74 offen lds
    v_mfma_f32_16x16x32_bf16 v[112:115], a[196:199], a[228:231], v[112:115]
    v_mfma_f32_16x16x32_bf16 v[116:119], a[200:203], a[224:227], v[116:119]
    v_mfma_f32_16x16x32_bf16 v[116:119], a[204:207], a[228:231], v[116:119]
    v_mfma_f32_16x16x32_bf16 v[120:123], a[208:211], a[224:227], v[120:123]
    v_mfma_f32_16x16x32_bf16 v[120:123], a[212:215], a[228:231], v[120:123]
    s_add_u32 m0, s67, 32768
    s_add_u32 s74, s57, 0
    v_mfma_f32_16x16x32_bf16 v[124:127], a[216:219], a[224:227], v[124:127]
    buffer_load_dwordx4 v9, s[4:7], s74 offen lds
    v_mfma_f32_16x16x32_bf16 v[124:127], a[220:223], a[228:231], v[124:127]
    s_waitcnt lgkmcnt(1)
    v_mfma_f32_16x16x32_bf16 v[128:131], a[160:163], a[232:235], v[128:131]
    ds_read_b64_tr_b16 a[224:225], v3 offset:28672
    v_mfma_f32_16x16x32_bf16 v[128:131], a[164:167], a[236:239], v[128:131]
    ds_read_b64_tr_b16 a[226:227], v3 offset:29184
    v_mfma_f32_16x16x32_bf16 v[132:135], a[168:171], a[232:235], v[132:135]
    ds_read_b64_tr_b16 a[228:229], v5 offset:28672
    v_mfma_f32_16x16x32_bf16 v[132:135], a[172:175], a[236:239], v[132:135]
    ds_read_b64_tr_b16 a[230:231], v5 offset:29184
    v_mfma_f32_16x16x32_bf16 v[136:139], a[176:179], a[232:235], v[136:139]
    ds_read_b128 a[116:119], v2 offset:4096
    v_mfma_f32_16x16x32_bf16 v[136:139], a[180:183], a[236:239], v[136:139]
    v_mfma_f32_16x16x32_bf16 v[140:143], a[184:187], a[232:235], v[140:143]
    v_mfma_f32_16x16x32_bf16 v[140:143], a[188:191], a[236:239], v[140:143]
    v_mfma_f32_16x16x32_bf16 v[144:147], a[192:195], a[232:235], v[144:147]
    v_mfma_f32_16x16x32_bf16 v[144:147], a[196:199], a[236:239], v[144:147]
    v_mfma_f32_16x16x32_bf16 v[148:151], a[200:203], a[232:235], v[148:151]
    s_add_u32 m0, s67, 34816
    s_add_u32 s74, s57, 32768
    v_mfma_f32_16x16x32_bf16 v[148:151], a[204:207], a[236:239], v[148:151]
    buffer_load_dwordx4 v9, s[4:7], s74 offen lds
    v_mfma_f32_16x16x32_bf16 v[152:155], a[208:211], a[232:235], v[152:155]
    v_mfma_f32_16x16x32_bf16 v[152:155], a[212:215], a[236:239], v[152:155]
    v_mfma_f32_16x16x32_bf16 v[156:159], a[216:219], a[232:235], v[156:159]
    v_mfma_f32_16x16x32_bf16 v[156:159], a[220:223], a[236:239], v[156:159]
    s_waitcnt lgkmcnt(1)
    v_mfma_f32_16x16x32_bf16 v[160:163], a[224:227], a[160:163], v[160:163]
    ds_read_b64_tr_b16 a[232:233], v4 offset:28672
    v_mfma_f32_16x16x32_bf16 v[160:163], a[228:231], a[164:167], v[160:163]
    ds_read_b64_tr_b16 a[234:235], v4 offset:29184
    v_mfma_f32_16x16x32_bf16 v[164:167], a[224:227], a[168:171], v[164:167]
    ds_read_b64_tr_b16 a[236:237], v6 offset:28672
    v_mfma_f32_16x16x32_bf16 v[164:167], a[228:231], a[172:175], v[164:167]
    ds_read_b64_tr_b16 a[238:239], v6 offset:29184
    v_mfma_f32_16x16x32_bf16 v[168:171], a[224:227], a[176:179], v[168:171]
    v_mfma_f32_16x16x32_bf16 v[168:171], a[228:231], a[180:183], v[168:171]
    v_mfma_f32_16x16x32_bf16 v[172:175], a[224:227], a[184:187], v[172:175]
    v_mfma_f32_16x16x32_bf16 v[172:175], a[228:231], a[188:191], v[172:175]
    s_add_u32 m0, s67, 36864
    s_add_u32 s74, s57, 65536
    v_mfma_f32_16x16x32_bf16 v[176:179], a[224:227], a[192:195], v[176:179]
    buffer_load_dwordx4 v9, s[4:7], s74 offen lds
    v_mfma_f32_16x16x32_bf16 v[176:179], a[228:231], a[196:199], v[176:179]
    v_mfma_f32_16x16x32_bf16 v[180:183], a[224:227], a[200:203], v[180:183]
    v_mfma_f32_16x16x32_bf16 v[180:183], a[228:231], a[204:207], v[180:183]
    v_mfma_f32_16x16x32_bf16 v[184:187], a[224:227], a[208:211], v[184:187]
    v_mfma_f32_16x16x32_bf16 v[184:187], a[228:231], a[212:215], v[184:187]
    v_mfma_f32_16x16x32_bf16 v[188:191], a[224:227], a[216:219], v[188:191]
    v_mfma_f32_16x16x32_bf16 v[188:191], a[228:231], a[220:223], v[188:191]
    s_waitcnt vmcnt(10) lgkmcnt(0)
    s_barrier
    v_mfma_f32_16x16x32_bf16 v[192:195], a[232:235], a[160:163], v[192:195]
    ds_read_b64_tr_b16 a[224:225], v3 offset:32768
    v_mfma_f32_16x16x32_bf16 v[192:195], a[236:239], a[164:167], v[192:195]
    ds_read_b64_tr_b16 a[226:227], v3 offset:33280
    v_mfma_f32_16x16x32_bf16 v[196:199], a[232:235], a[168:171], v[196:199]
    ds_read_b64_tr_b16 a[228:229], v5 offset:32768
    v_mfma_f32_16x16x32_bf16 v[196:199], a[236:239], a[172:175], v[196:199]
    ds_read_b64_tr_b16 a[230:231], v5 offset:33280
    v_mfma_f32_16x16x32_bf16 v[200:203], a[232:235], a[176:179], v[200:203]
    ds_read_b128 a[120:123], v1 offset:6144
    v_mfma_f32_16x16x32_bf16 v[200:203], a[236:239], a[180:183], v[200:203]
    ds_read_b128 a[124:127], v2 offset:6144
    v_mfma_f32_16x16x32_bf16 v[204:207], a[232:235], a[184:187], v[204:207]
    ds_read_b128 a[128:131], v1 offset:8192
    v_mfma_f32_16x16x32_bf16 v[204:207], a[236:239], a[188:191], v[204:207]
    s_add_u32 m0, s66, 12288
    s_add_u32 s74, s64, s59
    v_mfma_f32_16x16x32_bf16 v[208:211], a[232:235], a[192:195], v[208:211]
    buffer_load_dwordx4 v11, s[16:19], s74 offen lds
    v_mfma_f32_16x16x32_bf16 v[208:211], a[236:239], a[196:199], v[208:211]
    v_mfma_f32_16x16x32_bf16 v[212:215], a[232:235], a[200:203], v[212:215]
    s_add_u32 m0, s66, 53248
    s_add_u32 s74, s74, 229376
    v_mfma_f32_16x16x32_bf16 v[212:215], a[236:239], a[204:207], v[212:215]
    buffer_load_dwordx4 v11, s[16:19], s74 offen lds
    v_mfma_f32_16x16x32_bf16 v[216:219], a[232:235], a[208:211], v[216:219]
    v_mfma_f32_16x16x32_bf16 v[216:219], a[236:239], a[212:215], v[216:219]
    s_add_u32 m0, s68, 0
    s_add_u32 s74, s65, s59
    v_mfma_f32_16x16x32_bf16 v[220:223], a[232:235], a[216:219], v[220:223]
    buffer_load_dwordx4 v12, s[12:15], s74 offen lds
    v_mfma_f32_16x16x32_bf16 v[220:223], a[236:239], a[220:223], v[220:223]
    s_waitcnt lgkmcnt(3)
    v_mfma_f32_16x16x32_bf16 a[0:3], a[224:227], a[160:163], a[0:3]
    ds_read_b64_tr_b16 a[232:233], v4 offset:32768
    v_mfma_f32_16x16x32_bf16 a[0:3], a[228:231], a[164:167], a[0:3]
    ds_read_b64_tr_b16 a[234:235], v4 offset:33280
    v_mfma_f32_16x16x32_bf16 a[4:7], a[224:227], a[168:171], a[4:7]
    ds_read_b64_tr_b16 a[236:237], v6 offset:32768
    v_mfma_f32_16x16x32_bf16 a[4:7], a[228:231], a[172:175], a[4:7]
    ds_read_b64_tr_b16 a[238:239], v6 offset:33280
    v_mfma_f32_16x16x32_bf16 a[8:11], a[224:227], a[176:179], a[8:11]
    ds_read_b128 a[132:135], v2 offset:8192
    v_mfma_f32_16x16x32_bf16 a[8:11], a[228:231], a[180:183], a[8:11]
    ds_read_b128 a[136:139], v1 offset:10240
    v_mfma_f32_16x16x32_bf16 a[12:15], a[224:227], a[184:187], a[12:15]
    ds_read_b128 a[140:143], v2 offset:10240
    v_mfma_f32_16x16x32_bf16 a[12:15], a[228:231], a[188:191], a[12:15]
    s_add_u32 m0, s68, 2048
    v_mfma_f32_16x16x32_bf16 a[16:19], a[224:227], a[192:195], a[16:19]
    buffer_load_dwordx4 v12, s[16:19], s74 offen lds
    v_mfma_f32_16x16x32_bf16 a[16:19], a[228:231], a[196:199], a[16:19]
    v_mfma_f32_16x16x32_bf16 a[20:23], a[224:227], a[200:203], a[20:23]
    v_mfma_f32_16x16x32_bf16 a[20:23], a[228:231], a[204:207], a[20:23]
    v_mfma_f32_16x16x32_bf16 a[24:27], a[224:227], a[208:211], a[24:27]
    v_mfma_f32_16x16x32_bf16 a[24:27], a[228:231], a[212:215], a[24:27]
    s_add_u32 m0, s67, 38912
    s_add_u32 s74, s57, 98304
    v_mfma_f32_16x16x32_bf16 a[28:31], a[224:227], a[216:219], a[28:31]
    buffer_load_dwordx4 v9, s[4:7], s74 offen lds
    v_mfma_f32_16x16x32_bf16 a[28:31], a[228:231], a[220:223], a[28:31]
    s_waitcnt lgkmcnt(3)
    v_mfma_f32_16x16x32_bf16 a[32:35], a[232:235], a[160:163], a[32:35]
    ds_read_b64_tr_b16 a[224:225], v7 offset:36864
    v_mfma_f32_16x16x32_bf16 a[32:35], a[236:239], a[164:167], a[32:35]
    ds_read_b64_tr_b16 a[226:227], v7 offset:37120
    v_mfma_f32_16x16x32_bf16 a[36:39], a[232:235], a[168:171], a[36:39]
    ds_read_b64_tr_b16 a[228:229], v8 offset:36864
    v_mfma_f32_16x16x32_bf16 a[36:39], a[236:239], a[172:175], a[36:39]
    ds_read_b64_tr_b16 a[230:231], v8 offset:37120
    v_mfma_f32_16x16x32_bf16 a[40:43], a[232:235], a[176:179], a[40:43]
    ds_read_b128 a[144:147], v1 offset:12288
    v_mfma_f32_16x16x32_bf16 a[40:43], a[236:239], a[180:183], a[40:43]
    ds_read_b128 a[148:151], v2 offset:12288
    v_mfma_f32_16x16x32_bf16 a[44:47], a[232:235], a[184:187], a[44:47]
    v_mfma_f32_16x16x32_bf16 a[44:47], a[236:239], a[188:191], a[44:47]
    s_add_u32 m0, s67, 40960
    s_add_u32 s74, s57, 131072
    v_mfma_f32_16x16x32_bf16 a[48:51], a[232:235], a[192:195], a[48:51]
    buffer_load_dwordx4 v9, s[4:7], s74 offen lds
    v_mfma_f32_16x16x32_bf16 a[48:51], a[236:239], a[196:199], a[48:51]
    v_mfma_f32_16x16x32_bf16 a[52:55], a[232:235], a[200:203], a[52:55]
    s_mul_i32 s58, s60, 393216
    v_mfma_f32_16x16x32_bf16 a[52:55], a[236:239], a[204:207], a[52:55]
    s_mul_i32 s59, s60, 458752
    v_mfma_f32_16x16x32_bf16 a[56:59], a[232:235], a[208:211], a[56:59]
    v_mfma_f32_16x16x32_bf16 a[56:59], a[236:239], a[212:215], a[56:59]
    s_add_u32 m0, s67, 43008
    s_add_u32 s74, s57, 163840
    v_mfma_f32_16x16x32_bf16 a[60:63], a[232:235], a[216:219], a[60:63]
    buffer_load_dwordx4 v9, s[4:7], s74 offen lds
    v_mfma_f32_16x16x32_bf16 a[60:63], a[236:239], a[220:223], a[60:63]
    s_waitcnt lgkmcnt(2)
    v_mfma_f32_16x16x32_bf16 v[224:227], a[224:227], a[160:163], v[224:227]
    ds_read_b64_tr_b16 a[232:233], v7 offset:38912
    v_mfma_f32_16x16x32_bf16 v[224:227], a[228:231], a[164:167], v[224:227]
    ds_read_b64_tr_b16 a[234:235], v7 offset:39168
    v_mfma_f32_16x16x32_bf16 v[228:231], a[224:227], a[168:171], v[228:231]
    ds_read_b64_tr_b16 a[236:237], v8 offset:38912
    v_mfma_f32_16x16x32_bf16 v[228:231], a[228:231], a[172:175], v[228:231]
    ds_read_b64_tr_b16 a[238:239], v8 offset:39168
    v_mfma_f32_16x16x32_bf16 v[232:235], a[224:227], a[176:179], v[232:235]
    ds_read_b128 a[152:155], v1 offset:14336
    v_mfma_f32_16x16x32_bf16 v[232:235], a[228:231], a[180:183], v[232:235]
    ds_read_b128 a[156:159], v2 offset:14336
    v_mfma_f32_16x16x32_bf16 v[236:239], a[224:227], a[184:187], v[236:239]
    v_mfma_f32_16x16x32_bf16 v[236:239], a[228:231], a[188:191], v[236:239]
    s_add_u32 m0, s67, 45056
    s_add_u32 s74, s57, 196608
    v_mfma_f32_16x16x32_bf16 v[240:243], a[224:227], a[192:195], v[240:243]
    buffer_load_dwordx4 v9, s[4:7], s74 offen lds
    v_mfma_f32_16x16x32_bf16 v[240:243], a[228:231], a[196:199], v[240:243]
    v_mfma_f32_16x16x32_bf16 v[244:247], a[224:227], a[200:203], v[244:247]
    s_add_u32 s60, s60, 1
    v_mfma_f32_16x16x32_bf16 v[244:247], a[228:231], a[204:207], v[244:247]
    s_cmp_eq_u32 s60, 16
    s_cselect_b32 s60, 4, s60
    v_mfma_f32_16x16x32_bf16 v[248:251], a[224:227], a[208:211], v[248:251]
    v_mfma_f32_16x16x32_bf16 v[248:251], a[228:231], a[212:215], v[248:251]
    s_add_u32 m0, s67, 47104
    s_add_u32 s74, s57, 229376
    v_mfma_f32_16x16x32_bf16 v[252:255], a[224:227], a[216:219], v[252:255]
    buffer_load_dwordx4 v9, s[4:7], s74 offen lds
    v_mfma_f32_16x16x32_bf16 v[252:255], a[228:231], a[220:223], v[252:255]
    s_waitcnt vmcnt(9) lgkmcnt(0)
    s_barrier
    v_mfma_f32_16x16x32_bf16 a[64:67], a[232:235], a[160:163], a[64:67]
    ds_read_b64_tr_b16 a[224:225], v3
    v_mfma_f32_16x16x32_bf16 a[64:67], a[236:239], a[164:167], a[64:67]
    ds_read_b64_tr_b16 a[226:227], v3 offset:512
    v_mfma_f32_16x16x32_bf16 a[68:71], a[232:235], a[168:171], a[68:71]
    ds_read_b64_tr_b16 a[228:229], v5
    v_mfma_f32_16x16x32_bf16 a[68:71], a[236:239], a[172:175], a[68:71]
    ds_read_b64_tr_b16 a[230:231], v5 offset:512
    v_mfma_f32_16x16x32_bf16 a[72:75], a[232:235], a[176:179], a[72:75]
    v_mfma_f32_16x16x32_bf16 a[72:75], a[236:239], a[180:183], a[72:75]
    s_lshl_b32 s57, s60, 7
    v_mfma_f32_16x16x32_bf16 a[76:79], a[232:235], a[184:187], a[76:79]
    v_mfma_f32_16x16x32_bf16 a[76:79], a[236:239], a[188:191], a[76:79]
    s_add_u32 m0, s66, 20480
    s_add_u32 s74, s61, s58
    v_mfma_f32_16x16x32_bf16 a[80:83], a[232:235], a[192:195], a[80:83]
    buffer_load_dwordx4 v10, s[8:11], s74 offen lds
    v_mfma_f32_16x16x32_bf16 a[80:83], a[236:239], a[196:199], a[80:83]
    s_add_u32 s53, s53, 1
    v_mfma_f32_16x16x32_bf16 a[84:87], a[232:235], a[200:203], a[84:87]
    v_mfma_f32_16x16x32_bf16 a[84:87], a[236:239], a[204:207], a[84:87]
    v_mfma_f32_16x16x32_bf16 a[88:91], a[232:235], a[208:211], a[88:91]
    v_mfma_f32_16x16x32_bf16 a[88:91], a[236:239], a[212:215], a[88:91]
    s_add_u32 m0, s66, 61440
    s_add_u32 s74, s74, 196608
    v_mfma_f32_16x16x32_bf16 a[92:95], a[232:235], a[216:219], a[92:95]
    buffer_load_dwordx4 v10, s[8:11], s74 offen lds
    s_bitcmp0_b32 s56, s53
    v_mfma_f32_16x16x32_bf16 a[92:95], a[236:239], a[220:223], a[92:95]
    s_cbranch_scc1 L_main0
L_next0:
L_chain0_2:
L_pad0_2:
    s_cbranch_execz L_pad0_6
    s_cmp_eq_u32 s53, 4
    s_cbranch_scc1 L_sw0
L_swdone0:
    s_sub_u32 s70, s53, s54
    s_lshl4_add_u32 s71, s44, s70
    s_cmp_eq_u32 s71, 2
    s_cbranch_scc1 L_ev0
L_evdone0:
    s_cmp_eq_u32 s53, 7
    s_cbranch_scc1 L_tail0
    s_cmp_lg_u32 s70, 0
    s_cbranch_scc1 L_main0
    .p2align 3
L_cs0:
L_chain0_3:
L_pad0_3:
    s_cbranch_execz L_pad0_7
    s_waitcnt lgkmcnt(0)
    v_mfma_f32_16x16x32_bf16 v[32:35], a[224:227], a[96:99], v[32:35]
    ds_read_b64_tr_b16 a[232:233], v4
    v_mov_b32_dpp v28, v28 row_ror:7 row_mask:0xf bank_mask:0xf
    v_mfma_f32_16x16x32_bf16 v[32:35], a[228:231], a[100:103], v[32:35]
    ds_read_b64_tr_b16 a[234:235], v4 offset:512
    v_mov_b32_dpp v29, v29 row_ror:7 row_mask:0xf bank_mask:0xf
    v_mfma_f32_16x16x32_bf16 v[36:39], a[224:227], a[104:107], v[36:39]
    ds_read_b64_tr_b16 a[236:237], v6
    v_mov_b32_dpp v30, v30 row_ror:7 row_mask:0xf bank_mask:0xf
    v_mfma_f32_16x16x32_bf16 v[36:39], a[228:231], a[108:111], v[36:39]
    ds_read_b64_tr_b16 a[238:239], v6 offset:512
    v_mov_b32_dpp v31, v31 row_ror:7 row_mask:0xf bank_mask:0xf
    v_mfma_f32_16x16x32_bf16 v[40:43], a[224:227], a[112:115], v[40:43]
    ds_read_b128 a[160:163], v1 offset:32768
    v_lshrrev_b32 v27, 9, v13
    v_mfma_f32_16x16x32_bf16 v[40:43], a[228:231], a[116:119], v[40:43]
    ds_read_b128 a[164:167], v2 offset:32768
    v_mfma_f32_16x16x32_bf16 v[44:47], a[224:227], a[120:123], v[44:47]
    v_mfma_f32_16x16x32_bf16 v[44:47], a[228:231], a[124:127], v[44:47]
    s_add_u32 m0, s66, 24576
    s_add_u32 s74, s62, s58
    v_mfma_f32_16x16x32_bf16 v[48:51], a[224:227], a[128:131], v[48:51]
    buffer_load_dwordx4 v10, s[8:11], s74 offen lds
    v_mfma_f32_16x16x32_bf16 v[48:51], a[228:231], a[132:135], v[48:51]
    buffer_load_dword a254, v0, s[92:95], s69 offen
    v_mfma_f32_16x16x32_bf16 v[52:55], a[224:227], a[136:139], v[52:55]
    s_add_u32 s69, s69, s79
    v_mfma_f32_16x16x32_bf16 v[52:55], a[228:231], a[140:143], v[52:55]
    s_and_b32 s69, s69, s3
    v_mul_u32_u24 v22, 1536, v27
    v_mfma_f32_16x16x32_bf16 v[56:59], a[224:227], a[144:147], v[56:59]
    v_mfma_f32_16x16x32_bf16 v[56:59], a[228:231], a[148:151], v[56:59]
    s_add_u32 m0, s66, 65536
    s_add_u32 s74, s74, 196608
    v_mfma_f32_16x16x32_bf16 v[60:63], a[224:227], a[152:155], v[60:63]
    buffer_load_dwordx4 v10, s[8:11], s74 offen lds
    v_mfma_f32_16x16x32_bf16 a[240:243], v[28:31], a[224:227], 0
    v_mfma_f32_16x16x32_bf16 v[60:63], a[228:231], a[156:159], v[60:63]
    s_waitcnt lgkmcnt(2)
    v_mfma_f32_16x16x32_bf16 v[64:67], a[232:235], a[96:99], v[64:67]
    ds_read_b64_tr_b16 a[224:225], v3 offset:4096
    v_mov_b32_dpp v28, v28 row_ror:1 row_mask:0xf bank_mask:0xf
    v_mfma_f32_16x16x32_bf16 v[64:67], a[236:239], a[100:103], v[64:67]
    ds_read_b64_tr_b16 a[226:227], v3 offset:4608
    v_mov_b32_dpp v29, v29 row_ror:1 row_mask:0xf bank_mask:0xf
    v_mfma_f32_16x16x32_bf16 v[68:71], a[232:235], a[104:107], v[68:71]
    ds_read_b64_tr_b16 a[228:229], v5 offset:4096
    v_mov_b32_dpp v30, v30 row_ror:1 row_mask:0xf bank_mask:0xf
    v_mfma_f32_16x16x32_bf16 v[68:71], a[236:239], a[108:111], v[68:71]
    ds_read_b64_tr_b16 a[230:231], v5 offset:4608
    v_mov_b32_dpp v31, v31 row_ror:1 row_mask:0xf bank_mask:0xf
    v_mfma_f32_16x16x32_bf16 v[72:75], a[232:235], a[112:115], v[72:75]
    ds_read_b128 a[168:171], v1 offset:34816
    v_lshlrev_b32 v27, 11, v27
    v_mfma_f32_16x16x32_bf16 v[72:75], a[236:239], a[116:119], v[72:75]
    ds_read_b128 a[172:175], v2 offset:34816
    v_mfma_f32_16x16x32_bf16 v[76:79], a[232:235], a[120:123], v[76:79]
    v_mfma_f32_16x16x32_bf16 v[76:79], a[236:239], a[124:127], v[76:79]
    v_mfma_f32_16x16x32_bf16 v[80:83], a[232:235], a[128:131], v[80:83]
    v_mfma_f32_16x16x32_bf16 v[80:83], a[236:239], a[132:135], v[80:83]
    v_mfma_f32_16x16x32_bf16 v[84:87], a[232:235], a[136:139], v[84:87]
    s_add_u32 m0, s66, 28672
    s_add_u32 s74, s63, s59
    v_add_u32 v22, v22, v13
    v_mfma_f32_16x16x32_bf16 v[84:87], a[236:239], a[140:143], v[84:87]
    buffer_load_dwordx4 v11, s[12:15], s74 offen lds
    v_mfma_f32_16x16x32_bf16 v[88:91], a[232:235], a[144:147], v[88:91]
    v_mfma_f32_16x16x32_bf16 v[88:91], a[236:239], a[148:151], v[88:91]
    v_mfma_f32_16x16x32_bf16 v[92:95], a[232:235], a[152:155], v[92:95]
    v_mfma_f32_16x16x32_bf16 a[240:243], v[28:31], a[232:235], a[240:243]
    v_mfma_f32_16x16x32_bf16 v[92:95], a[236:239], a[156:159], v[92:95]
    s_waitcnt lgkmcnt(2)
    v_mfma_f32_16x16x32_bf16 v[96:99], a[96:99], a[224:227], v[96:99]
    ds_read_b64_tr_b16 a[232:233], v4 offset:4096
    v_mov_b32_dpp v28, v28 row_ror:1 row_mask:0xf bank_mask:0xf
    v_mfma_f32_16x16x32_bf16 v[96:99], a[100:103], a[228:231], v[96:99]
    ds_read_b64_tr_b16 a[234:235], v4 offset:4608
    v_mov_b32_dpp v29, v29 row_ror:1 row_mask:0xf bank_mask:0xf
    v_mfma_f32_16x16x32_bf16 v[100:103], a[104:107], a[224:227], v[100:103]
    ds_read_b64_tr_b16 a[236:237], v6 offset:4096
    v_mov_b32_dpp v30, v30 row_ror:1 row_mask:0xf bank_mask:0xf
    v_mfma_f32_16x16x32_bf16 v[100:103], a[108:111], a[228:231], v[100:103]
    ds_read_b64_tr_b16 a[238:239], v6 offset:4608
    v_mov_b32_dpp v31, v31 row_ror:1 row_mask:0xf bank_mask:0xf
    v_mfma_f32_16x16x32_bf16 v[104:107], a[112:115], a[224:227], v[104:107]
    ds_read_b128 a[176:179], v1 offset:36864
    buffer_load_ushort v27, v27, s[4:7], s101 offen
    v_mfma_f32_16x16x32_bf16 v[104:107], a[116:119], a[228:231], v[104:107]
    v_mfma_f32_16x16x32_bf16 v[108:111], a[120:123], a[224:227], v[108:111]
    v_mfma_f32_16x16x32_bf16 v[108:111], a[124:127], a[228:231], v[108:111]
    s_add_u32 m0, s66, 69632
    s_add_u32 s74, s74, 229376
    v_mfma_f32_16x16x32_bf16 v[112:115], a[128:131], a[224:227], v[112:115]
    buffer_load_dwordx4 v11, s[12:15], s74 offen lds
    v_mfma_f32_16x16x32_bf16 v[112:115], a[132:135], a[228:231], v[112:115]
    v_mfma_f32_16x16x32_bf16 v[116:119], a[136:139], a[224:227], v[116:119]
    buffer_load_dwordx4 v[14:17], v22, s[4:7], s101 offen
    v_mfma_f32_16x16x32_bf16 v[116:119], a[140:143], a[228:231], v[116:119]
    v_mfma_f32_16x16x32_bf16 v[120:123], a[144:147], a[224:227], v[120:123]
    v_mfma_f32_16x16x32_bf16 v[120:123], a[148:151], a[228:231], v[120:123]
    s_add_u32 m0, s67, 0
    s_add_u32 s74, s57, 0
    v_mfma_f32_16x16x32_bf16 v[124:127], a[152:155], a[224:227], v[124:127]
    buffer_load_dwordx4 v9, s[4:7], s74 offen lds
    v_mfma_f32_16x16x32_bf16 a[240:243], v[28:31], a[224:227], a[240:243]
    v_mfma_f32_16x16x32_bf16 v[124:127], a[156:159], a[228:231], v[124:127]
    s_waitcnt lgkmcnt(1)
    v_mfma_f32_16x16x32_bf16 v[128:131], a[96:99], a[232:235], v[128:131]
    ds_read_b64_tr_b16 a[224:225], v3 offset:8192
    v_mov_b32_dpp v28, v28 row_ror:1 row_mask:0xf bank_mask:0xf
    v_mfma_f32_16x16x32_bf16 v[128:131], a[100:103], a[236:239], v[128:131]
    ds_read_b64_tr_b16 a[226:227], v3 offset:8704
    v_mov_b32_dpp v29, v29 row_ror:1 row_mask:0xf bank_mask:0xf
    v_mfma_f32_16x16x32_bf16 v[132:135], a[104:107], a[232:235], v[132:135]
    ds_read_b64_tr_b16 a[228:229], v5 offset:8192
    v_mov_b32_dpp v30, v30 row_ror:1 row_mask:0xf bank_mask:0xf
    v_mfma_f32_16x16x32_bf16 v[132:135], a[108:111], a[236:239], v[132:135]
    ds_read_b64_tr_b16 a[230:231], v5 offset:8704
    v_mov_b32_dpp v31, v31 row_ror:1 row_mask:0xf bank_mask:0xf
    v_mfma_f32_16x16x32_bf16 v[136:139], a[112:115], a[232:235], v[136:139]
    ds_read_b128 a[180:183], v2 offset:36864
    buffer_load_dwordx4 v[18:21], v22, s[4:7], s101 offen offset:512
    v_mfma_f32_16x16x32_bf16 v[136:139], a[116:119], a[236:239], v[136:139]
    v_mfma_f32_16x16x32_bf16 v[140:143], a[120:123], a[232:235], v[140:143]
    v_mfma_f32_16x16x32_bf16 v[140:143], a[124:127], a[236:239], v[140:143]
    buffer_load_dwordx4 a[244:247], v22, s[4:7], s101 offen offset:1024
    v_mfma_f32_16x16x32_bf16 v[144:147], a[128:131], a[232:235], v[144:147]
    v_mfma_f32_16x16x32_bf16 v[144:147], a[132:135], a[236:239], v[144:147]
    v_mfma_f32_16x16x32_bf16 v[148:151], a[136:139], a[232:235], v[148:151]
    s_add_u32 m0, s67, 2048
    s_add_u32 s74, s57, 32768
    v_mfma_f32_16x16x32_bf16 v[148:151], a[140:143], a[236:239], v[148:151]
    buffer_load_dwordx4 v9, s[4:7], s74 offen lds
    v_mfma_f32_16x16x32_bf16 v[152:155], a[144:147], a[232:235], v[152:155]
    s_lshl1_add_u32 s70, s49, s46
    v_mfma_f32_16x16x32_bf16 v[152:155], a[148:151], a[236:239], v[152:155]
    v_mfma_f32_16x16x32_bf16 v[156:159], a[152:155], a[232:235], v[156:159]
    v_mfma_f32_16x16x32_bf16 a[240:243], v[28:31], a[232:235], a[240:243]
    buffer_load_dwordx4 a[248:251], v22, s[4:7], s101 offen offset:1536
    v_mfma_f32_16x16x32_bf16 v[156:159], a[156:159], a[236:239], v[156:159]
    s_waitcnt lgkmcnt(1)
    v_mfma_f32_16x16x32_bf16 v[160:163], a[224:227], a[96:99], v[160:163]
    ds_read_b64_tr_b16 a[232:233], v4 offset:8192
    v_mov_b32_dpp v28, v28 row_ror:1 row_mask:0xf bank_mask:0xf
    v_mfma_f32_16x16x32_bf16 v[160:163], a[228:231], a[100:103], v[160:163]
    ds_read_b64_tr_b16 a[234:235], v4 offset:8704
    v_mov_b32_dpp v29, v29 row_ror:1 row_mask:0xf bank_mask:0xf
    v_mfma_f32_16x16x32_bf16 v[164:167], a[224:227], a[104:107], v[164:167]
    ds_read_b64_tr_b16 a[236:237], v6 offset:8192
    v_mov_b32_dpp v30, v30 row_ror:1 row_mask:0xf bank_mask:0xf
    v_mfma_f32_16x16x32_bf16 v[164:167], a[228:231], a[108:111], v[164:167]
    ds_read_b64_tr_b16 a[238:239], v6 offset:8704
    v_mov_b32_dpp v31, v31 row_ror:1 row_mask:0xf bank_mask:0xf
    v_mfma_f32_16x16x32_bf16 v[168:171], a[224:227], a[112:115], v[168:171]
    s_lshl1_add_u32 s70, s70, s45
    v_mfma_f32_16x16x32_bf16 v[168:171], a[228:231], a[116:119], v[168:171]
    v_mfma_f32_16x16x32_bf16 v[172:175], a[224:227], a[120:123], v[172:175]
    v_mfma_f32_16x16x32_bf16 v[172:175], a[228:231], a[124:127], v[172:175]
    s_add_u32 m0, s67, 4096
    s_add_u32 s74, s57, 65536
    v_mfma_f32_16x16x32_bf16 v[176:179], a[224:227], a[128:131], v[176:179]
    buffer_load_dwordx4 v9, s[4:7], s74 offen lds
    v_mfma_f32_16x16x32_bf16 v[176:179], a[228:231], a[132:135], v[176:179]
    s_lshl3_add_u32 s70, s70, s47
    v_mfma_f32_16x16x32_bf16 v[180:183], a[224:227], a[136:139], v[180:183]
    v_mfma_f32_16x16x32_bf16 v[180:183], a[228:231], a[140:143], v[180:183]
    v_mfma_f32_16x16x32_bf16 v[184:187], a[224:227], a[144:147], v[184:187]
    v_mfma_f32_16x16x32_bf16 v[184:187], a[228:231], a[148:151], v[184:187]
    v_mfma_f32_16x16x32_bf16 v[188:191], a[224:227], a[152:155], v[188:191]
    v_mfma_f32_16x16x32_bf16 a[240:243], v[28:31], a[224:227], a[240:243]
    v_mfma_f32_16x16x32_bf16 v[188:191], a[228:231], a[156:159], v[188:191]
    s_waitcnt vmcnt(15) lgkmcnt(0)
    s_barrier
    v_mfma_f32_16x16x32_bf16 v[192:195], a[232:235], a[96:99], v[192:195]
    ds_read_b64_tr_b16 a[224:225], v3 offset:12288
    v_mfma_f32_16x16x32_bf16 v[192:195], a[236:239], a[100:103], v[192:195]
    ds_read_b64_tr_b16 a[226:227], v3 offset:12800
    v_mfma_f32_16x16x32_bf16 v[196:199], a[232:235], a[104:107], v[196:199]
    ds_read_b64_tr_b16 a[228:229], v5 offset:12288
    v_mfma_f32_16x16x32_bf16 v[196:199], a[236:239], a[108:111], v[196:199]
    ds_read_b64_tr_b16 a[230:231], v5 offset:12800
    v_mfma_f32_16x16x32_bf16 v[200:203], a[232:235], a[112:115], v[200:203]
    ds_read_b128 a[184:187], v1 offset:38912
    v_mfma_f32_16x16x32_bf16 v[200:203], a[236:239], a[116:119], v[200:203]
    ds_read_b128 a[188:191], v2 offset:38912
    v_mfma_f32_16x16x32_bf16 v[204:207], a[232:235], a[120:123], v[204:207]
    ds_read_b128 a[192:195], v1 offset:40960
    v_mfma_f32_16x16x32_bf16 v[204:207], a[236:239], a[124:127], v[204:207]
    s_add_u32 m0, s66, 32768
    s_add_u32 s74, s64, s59
    v_mov_b32_dpp v28, v28 row_ror:1 row_mask:0xf bank_mask:0xf
    v_mfma_f32_16x16x32_bf16 v[208:211], a[232:235], a[128:131], v[208:211]
    buffer_load_dwordx4 v11, s[16:19], s74 offen lds
    v_mov_b32_dpp v29, v29 row_ror:1 row_mask:0xf bank_mask:0xf
    s_lshl_b32 s70, s70, 10
    v_mfma_f32_16x16x32_bf16 v[208:211], a[236:239], a[132:135], v[208:211]
    v_mov_b32_dpp v30, v30 row_ror:1 row_mask:0xf bank_mask:0xf
    s_add_u32 s70, s70, 33030144
    v_mfma_f32_16x16x32_bf16 v[212:215], a[232:235], a[136:139], v[212:215]
    s_add_u32 m0, s66, 73728
    s_add_u32 s74, s74, 229376
    v_mov_b32_dpp v31, v31 row_ror:1 row_mask:0xf bank_mask:0xf
    v_mfma_f32_16x16x32_bf16 v[212:215], a[236:239], a[140:143], v[212:215]
    buffer_load_dwordx4 v11, s[16:19], s74 offen lds
    v_mfma_f32_16x16x32_bf16 v[216:219], a[232:235], a[144:147], v[216:219]
    v_mfma_f32_16x16x32_bf16 v[216:219], a[236:239], a[148:151], v[216:219]
    s_add_u32 m0, s68, 20480
    s_add_u32 s74, s65, s59
    s_add_u32 s53, s53, 1
    v_mfma_f32_16x16x32_bf16 v[220:223], a[232:235], a[152:155], v[220:223]
    buffer_load_dwordx4 v12, s[12:15], s74 offen lds
    v_mfma_f32_16x16x32_bf16 a[240:243], v[28:31], a[232:235], a[240:243]
    v_mfma_f32_16x16x32_bf16 v[220:223], a[236:239], a[156:159], v[220:223]
    s_waitcnt lgkmcnt(3)
    v_mfma_f32_16x16x32_bf16 a[0:3], a[224:227], a[96:99], a[0:3]
    ds_read_b64_tr_b16 a[232:233], v4 offset:12288
    v_mov_b32_dpp v28, v28 row_ror:1 row_mask:0xf bank_mask:0xf
    v_mfma_f32_16x16x32_bf16 a[0:3], a[228:231], a[100:103], a[0:3]
    ds_read_b64_tr_b16 a[234:235], v4 offset:12800
    v_mov_b32_dpp v29, v29 row_ror:1 row_mask:0xf bank_mask:0xf
    v_mfma_f32_16x16x32_bf16 a[4:7], a[224:227], a[104:107], a[4:7]
    ds_read_b64_tr_b16 a[236:237], v6 offset:12288
    v_mov_b32_dpp v30, v30 row_ror:1 row_mask:0xf bank_mask:0xf
    v_mfma_f32_16x16x32_bf16 a[4:7], a[228:231], a[108:111], a[4:7]
    ds_read_b64_tr_b16 a[238:239], v6 offset:12800
L_pad0_4:
    s_cbranch_execz L_pad0_8
    v_mov_b32_dpp v31, v31 row_ror:1 row_mask:0xf bank_mask:0xf
    v_mfma_f32_16x16x32_bf16 a[8:11], a[224:227], a[112:115], a[8:11]
    ds_read_b128 a[196:199], v2 offset:40960
    s_waitcnt vmcnt(11)
    v_lshlrev_b32 v27, 16, v27
    v_mfma_f32_16x16x32_bf16 a[8:11], a[228:231], a[116:119], a[8:11]
    ds_read_b128 a[200:203], v1 offset:43008
    s_waitcnt vmcnt(9)
    v_and_b32 v25, 0xffff0000, v14
    v_mfma_f32_16x16x32_bf16 a[12:15], a[224:227], a[120:123], a[12:15]
    ds_read_b128 a[204:207], v2 offset:43008
    v_lshlrev_b32 v24, 16, v14
    v_mfma_f32_16x16x32_bf16 a[12:15], a[228:231], a[124:127], a[12:15]
    s_add_u32 m0, s68, 22528
    v_sub_f32 v24, v24, v27
    v_mfma_f32_16x16x32_bf16 a[16:19], a[224:227], a[128:131], a[16:19]
    buffer_load_dwordx4 v12, s[16:19], s74 offen lds
    v_sub_f32 v25, v25, v27
    v_mfma_f32_16x16x32_bf16 a[16:19], a[228:231], a[132:135], a[16:19]
    v_add_f32 v22, v24, v25
    v_mfma_f32_16x16x32_bf16 a[20:23], a[224:227], a[136:139], a[20:23]
    v_mfma_f32_16x16x32_bf16 a[20:23], a[228:231], a[140:143], a[20:23]
    v_mul_f32 v23, v24, v24
    v_mfma_f32_16x16x32_bf16 a[24:27], a[224:227], a[144:147], a[24:27]
    v_fmac_f32 v23, v25, v25
    v_mfma_f32_16x16x32_bf16 a[24:27], a[228:231], a[148:151], a[24:27]
    s_add_u32 m0, s67, 6144
    s_add_u32 s74, s57, 98304
    v_and_b32 v25, 0xffff0000, v15
    v_mfma_f32_16x16x32_bf16 a[28:31], a[224:227], a[152:155], a[28:31]
    buffer_load_dwordx4 v9, s[4:7], s74 offen lds
    v_mfma_f32_16x16x32_bf16 a[240:243], v[28:31], a[224:227], a[240:243]
    v_lshlrev_b32 v24, 16, v15
    v_mfma_f32_16x16x32_bf16 a[28:31], a[228:231], a[156:159], a[28:31]
    v_sub_f32 v24, v24, v27
    s_waitcnt lgkmcnt(3)
    v_mfma_f32_16x16x32_bf16 a[32:35], a[232:235], a[96:99], a[32:35]
    ds_read_b64_tr_b16 a[224:225], v7 offset:16384
    v_mov_b32_dpp v28, v28 row_ror:1 row_mask:0xf bank_mask:0xf
    v_mfma_f32_16x16x32_bf16 a[32:35], a[236:239], a[100:103], a[32:35]
    ds_read_b64_tr_b16 a[226:227], v7 offset:16640
    v_mov_b32_dpp v29, v29 row_ror:1 row_mask:0xf bank_mask:0xf
    v_mfma_f32_16x16x32_bf16 a[36:39], a[232:235], a[104:107], a[36:39]
    ds_read_b64_tr_b16 a[228:229], v8 offset:16384
    v_mov_b32_dpp v30, v30 row_ror:1 row_mask:0xf bank_mask:0xf
    v_mfma_f32_16x16x32_bf16 a[36:39], a[236:239], a[108:111], a[36:39]
    ds_read_b64_tr_b16 a[230:231], v8 offset:16640
    v_mov_b32_dpp v31, v31 row_ror:1 row_mask:0xf bank_mask:0xf
    v_mfma_f32_16x16x32_bf16 a[40:43], a[232:235], a[112:115], a[40:43]
    ds_read_b128 a[208:211], v1 offset:45056
    v_sub_f32 v25, v25, v27
    v_mfma_f32_16x16x32_bf16 a[40:43], a[236:239], a[116:119], a[40:43]
    ds_read_b128 a[212:215], v2 offset:45056
    v_add_f32 v22, v22, v24
    v_mfma_f32_16x16x32_bf16 a[44:47], a[232:235], a[120:123], a[44:47]
    v_fmac_f32 v23, v24, v24
    v_mfma_f32_16x16x32_bf16 a[44:47], a[236:239], a[124:127], a[44:47]
    s_add_u32 m0, s67, 8192
    s_add_u32 s74, s57, 131072
    v_add_f32 v22, v22, v25
    v_mfma_f32_16x16x32_bf16 a[48:51], a[232:235], a[128:131], a[48:51]
    buffer_load_dwordx4 v9, s[4:7], s74 offen lds
    v_fmac_f32 v23, v25, v25
    v_and_b32 v25, 0xffff0000, v16
    v_mfma_f32_16x16x32_bf16 a[48:51], a[236:239], a[132:135], a[48:51]
    v_lshlrev_b32 v24, 16, v16
    v_mfma_f32_16x16x32_bf16 a[52:55], a[232:235], a[136:139], a[52:55]
    s_mul_i32 s58, s60, 393216
    v_sub_f32 v24, v24, v27
    v_mfma_f32_16x16x32_bf16 a[52:55], a[236:239], a[140:143], a[52:55]
    s_mul_i32 s59, s60, 458752
    v_sub_f32 v25, v25, v27
    v_add_f32 v22, v22, v24
    v_mfma_f32_16x16x32_bf16 a[56:59], a[232:235], a[144:147], a[56:59]
    v_fmac_f32 v23, v24, v24
    v_mfma_f32_16x16x32_bf16 a[56:59], a[236:239], a[148:151], a[56:59]
    s_add_u32 m0, s67, 10240
    s_add_u32 s74, s57, 163840
    v_add_f32 v22, v22, v25
    v_mfma_f32_16x16x32_bf16 a[60:63], a[232:235], a[152:155], a[60:63]
    buffer_load_dwordx4 v9, s[4:7], s74 offen lds
    v_mfma_f32_16x16x32_bf16 a[240:243], v[28:31], a[232:235], a[240:243]
    v_fmac_f32 v23, v25, v25
    v_mfma_f32_16x16x32_bf16 a[60:63], a[236:239], a[156:159], a[60:63]
    s_waitcnt lgkmcnt(2)
    v_mfma_f32_16x16x32_bf16 v[224:227], a[224:227], a[96:99], v[224:227]
    ds_read_b64_tr_b16 a[232:233], v7 offset:18432
    v_mov_b32_dpp v28, v28 row_ror:1 row_mask:0xf bank_mask:0xf
    v_mfma_f32_16x16x32_bf16 v[224:227], a[228:231], a[100:103], v[224:227]
    ds_read_b64_tr_b16 a[234:235], v7 offset:18688
    v_mov_b32_dpp v29, v29 row_ror:1 row_mask:0xf bank_mask:0xf
    v_mfma_f32_16x16x32_bf16 v[228:231], a[224:227], a[104:107], v[228:231]
    ds_read_b64_tr_b16 a[236:237], v8 offset:18432
    v_mov_b32_dpp v30, v30 row_ror:1 row_mask:0xf bank_mask:0xf
    v_mfma_f32_16x16x32_bf16 v[228:231], a[228:231], a[108:111], v[228:231]
    ds_read_b64_tr_b16 a[238:239], v8 offset:18688
    v_mov_b32_dpp v31, v31 row_ror:1 row_mask:0xf bank_mask:0xf
    v_mfma_f32_16x16x32_bf16 v[232:235], a[224:227], a[112:115], v[232:235]
    ds_read_b128 a[216:219], v1 offset:47104
    v_and_b32 v25, 0xffff0000, v17
    v_mfma_f32_16x16x32_bf16 v[232:235], a[228:231], a[116:119], v[232:235]
    ds_read_b128 a[220:223], v2 offset:47104
    v_lshlrev_b32 v24, 16, v17
    v_mfma_f32_16x16x32_bf16 v[236:239], a[224:227], a[120:123], v[236:239]
    v_sub_f32 v24, v24, v27
    v_mfma_f32_16x16x32_bf16 v[236:239], a[228:231], a[124:127], v[236:239]
    s_add_u32 m0, s67, 12288
    s_add_u32 s74, s57, 196608
    v_sub_f32 v25, v25, v27
    v_mfma_f32_16x16x32_bf16 v[240:243], a[224:227], a[128:131], v[240:243]
    buffer_load_dwordx4 v9, s[4:7], s74 offen lds
    v_add_f32 v22, v22, v24
    v_mfma_f32_16x16x32_bf16 v[240:243], a[228:231], a[132:135], v[240:243]
    v_fmac_f32 v23, v24, v24
    v_mfma_f32_16x16x32_bf16 v[244:247], a[224:227], a[136:139], v[244:247]
    s_add_u32 s60, s60, 1
    v_add_f32 v22, v22, v25
    v_mfma_f32_16x16x32_bf16 v[244:247], a[228:231], a[140:143], v[244:247]
    s_cmp_eq_u32 s60, 16
    s_cselect_b32 s60, 4, s60
    v_fmac_f32 v23, v25, v25
    v_mfma_f32_16x16x32_bf16 v[248:251], a[224:227], a[144:147], v[248:251]
    s_waitcnt vmcnt(12)
    v_and_b32 v25, 0xffff0000, v18
    v_mfma_f32_16x16x32_bf16 v[248:251], a[228:231], a[148:151], v[248:251]
    s_add_u32 m0, s67, 14336
    s_add_u32 s74, s57, 229376
    v_lshlrev_b32 v24, 16, v18
    v_mfma_f32_16x16x32_bf16 v[252:255], a[224:227], a[152:155], v[252:255]
    buffer_load_dwordx4 v9, s[4:7], s74 offen lds
    v_mfma_f32_16x16x32_bf16 a[240:243], v[28:31], a[224:227], a[240:243]
    v_sub_f32 v24, v24, v27
    v_mfma_f32_16x16x32_bf16 v[252:255], a[228:231], a[156:159], v[252:255]
    s_waitcnt vmcnt(9) lgkmcnt(0)
    s_barrier
    v_mfma_f32_16x16x32_bf16 a[64:67], a[232:235], a[96:99], a[64:67]
    ds_read_b64_tr_b16 a[224:225], v3 offset:20480
    v_mfma_f32_16x16x32_bf16 a[64:67], a[236:239], a[100:103], a[64:67]
    ds_read_b64_tr_b16 a[226:227], v3 offset:20992
    v_mfma_f32_16x16x32_bf16 a[68:71], a[232:235], a[104:107], a[68:71]
    ds_read_b64_tr_b16 a[228:229], v5 offset:20480
    v_mfma_f32_16x16x32_bf16 a[68:71], a[236:239], a[108:111], a[68:71]
    ds_read_b64_tr_b16 a[230:231], v5 offset:20992
    v_mfma_f32_16x16x32_bf16 a[72:75], a[232:235], a[112:115], a[72:75]
    v_mov_b32_dpp v28, v28 row_ror:1 row_mask:0xf bank_mask:0xf
    v_mfma_f32_16x16x32_bf16 a[72:75], a[236:239], a[116:119], a[72:75]
    s_lshl_b32 s57, s60, 7
    v_sub_f32 v25, v25, v27
    v_add_f32 v22, v22, v24
    v_mfma_f32_16x16x32_bf16 a[76:79], a[232:235], a[120:123], a[76:79]
    v_mov_b32_dpp v29, v29 row_ror:1 row_mask:0xf bank_mask:0xf
    v_mfma_f32_16x16x32_bf16 a[76:79], a[236:239], a[124:127], a[76:79]
    s_add_u32 m0, s66, 0
    s_add_u32 s74, s61, s58
    v_fmac_f32 v23, v24, v24
    v_mfma_f32_16x16x32_bf16 a[80:83], a[232:235], a[128:131], a[80:83]
    buffer_load_dwordx4 v10, s[8:11], s74 offen lds
    v_mov_b32_dpp v30, v30 row_ror:1 row_mask:0xf bank_mask:0xf
    v_mfma_f32_16x16x32_bf16 a[80:83], a[236:239], a[132:135], a[80:83]
    v_add_f32 v22, v22, v25
    v_mfma_f32_16x16x32_bf16 a[84:87], a[232:235], a[136:139], a[84:87]
    v_mov_b32_dpp v31, v31 row_ror:1 row_mask:0xf bank_mask:0xf
    v_mfma_f32_16x16x32_bf16 a[84:87], a[236:239], a[140:143], a[84:87]
    v_fmac_f32 v23, v25, v25
    v_and_b32 v25, 0xffff0000, v19
    v_mfma_f32_16x16x32_bf16 a[88:91], a[232:235], a[144:147], a[88:91]
    v_lshlrev_b32 v24, 16, v19
    v_mfma_f32_16x16x32_bf16 a[88:91], a[236:239], a[148:151], a[88:91]
    s_add_u32 m0, s66, 40960
    s_add_u32 s74, s74, 196608
    v_sub_f32 v24, v24, v27
    v_mfma_f32_16x16x32_bf16 a[92:95], a[232:235], a[152:155], a[92:95]
    buffer_load_dwordx4 v10, s[8:11], s74 offen lds
    v_mfma_f32_16x16x32_bf16 a[240:243], v[28:31], a[232:235], a[240:243]
    v_sub_f32 v25, v25, v27
    v_add_f32 v22, v22, v24
    v_mfma_f32_16x16x32_bf16 a[92:95], a[236:239], a[156:159], a[92:95]
    v_fmac_f32 v23, v24, v24
    s_waitcnt lgkmcnt(0)
    v_mfma_f32_16x16x32_bf16 v[32:35], a[224:227], a[160:163], v[32:35]
    ds_read_b64_tr_b16 a[232:233], v4 offset:20480
    v_mov_b32_dpp v28, v28 row_ror:7 row_mask:0xf bank_mask:0xf
    v_mfma_f32_16x16x32_bf16 v[32:35], a[228:231], a[164:167], v[32:35]
    ds_read_b64_tr_b16 a[234:235], v4 offset:20992
    v_mov_b32_dpp v29, v29 row_ror:7 row_mask:0xf bank_mask:0xf
    v_mfma_f32_16x16x32_bf16 v[36:39], a[224:227], a[168:171], v[36:39]
    ds_read_b64_tr_b16 a[236:237], v6 offset:20480
    v_mov_b32_dpp v30, v30 row_ror:7 row_mask:0xf bank_mask:0xf
    v_mfma_f32_16x16x32_bf16 v[36:39], a[228:231], a[172:175], v[36:39]
    ds_read_b64_tr_b16 a[238:239], v6 offset:20992
    v_mov_b32_dpp v31, v31 row_ror:7 row_mask:0xf bank_mask:0xf
    v_mfma_f32_16x16x32_bf16 v[40:43], a[224:227], a[176:179], v[40:43]
    ds_read_b128 a[96:99], v1
    v_add_f32 v22, v22, v25
    v_mfma_f32_16x16x32_bf16 v[40:43], a[228:231], a[180:183], v[40:43]
    ds_read_b128 a[100:103], v2
    v_fmac_f32 v23, v25, v25
    v_mfma_f32_16x16x32_bf16 v[44:47], a[224:227], a[184:187], v[44:47]
    v_and_b32 v25, 0xffff0000, v20
    v_mfma_f32_16x16x32_bf16 v[44:47], a[228:231], a[188:191], v[44:47]
    s_add_u32 m0, s66, 4096
    s_add_u32 s74, s62, s58
    v_lshlrev_b32 v24, 16, v20
    v_mfma_f32_16x16x32_bf16 v[48:51], a[224:227], a[192:195], v[48:51]
    buffer_load_dwordx4 v10, s[8:11], s74 offen lds
    v_sub_f32 v24, v24, v27
    v_mfma_f32_16x16x32_bf16 v[48:51], a[228:231], a[196:199], v[48:51]
    buffer_load_dword a254, v0, s[92:95], s69 offen
    v_sub_f32 v25, v25, v27
    v_add_f32 v22, v22, v24
    v_mfma_f32_16x16x32_bf16 v[52:55], a[224:227], a[200:203], v[52:55]
    s_add_u32 s69, s69, s79
    v_fmac_f32 v23, v24, v24
    v_mfma_f32_16x16x32_bf16 v[52:55], a[228:231], a[204:207], v[52:55]
    s_and_b32 s69, s69, s3
    v_add_f32 v22, v22, v25
    v_mfma_f32_16x16x32_bf16 v[56:59], a[224:227], a[208:211], v[56:59]
    v_fmac_f32 v23, v25, v25
    v_and_b32 v25, 0xffff0000, v21
    v_mfma_f32_16x16x32_bf16 v[56:59], a[228:231], a[212:215], v[56:59]
    s_add_u32 m0, s66, 45056
    s_add_u32 s74, s74, 196608
    v_lshlrev_b32 v24, 16, v21
    v_mfma_f32_16x16x32_bf16 v[60:63], a[224:227], a[216:219], v[60:63]
    buffer_load_dwordx4 v10, s[8:11], s74 offen lds
    v_mfma_f32_16x16x32_bf16 a[240:243], v[28:31], a[224:227], a[240:243]
    v_sub_f32 v24, v24, v27
    v_mfma_f32_16x16x32_bf16 v[60:63], a[228:231], a[220:223], v[60:63]
    v_sub_f32 v25, v25, v27
    s_waitcnt lgkmcnt(2)
    v_mfma_f32_16x16x32_bf16 v[64:67], a[232:235], a[160:163], v[64:67]
    ds_read_b64_tr_b16 a[224:225], v3 offset:24576
    v_mov_b32_dpp v28, v28 row_ror:1 row_mask:0xf bank_mask:0xf
    v_mfma_f32_16x16x32_bf16 v[64:67], a[236:239], a[164:167], v[64:67]
    ds_read_b64_tr_b16 a[226:227], v3 offset:25088
    v_mov_b32_dpp v29, v29 row_ror:1 row_mask:0xf bank_mask:0xf
    v_mfma_f32_16x16x32_bf16 v[68:71], a[232:235], a[168:171], v[68:71]
    ds_read_b64_tr_b16 a[228:229], v5 offset:24576
    v_mov_b32_dpp v30, v30 row_ror:1 row_mask:0xf bank_mask:0xf
    v_mfma_f32_16x16x32_bf16 v[68:71], a[236:239], a[172:175], v[68:71]
    ds_read_b64_tr_b16 a[230:231], v5 offset:25088
    v_mov_b32_dpp v31, v31 row_ror:1 row_mask:0xf bank_mask:0xf
    v_mfma_f32_16x16x32_bf16 v[72:75], a[232:235], a[176:179], v[72:75]
    ds_read_b128 a[104:107], v1 offset:2048
    v_add_f32 v22, v22, v24
    v_mfma_f32_16x16x32_bf16 v[72:75], a[236:239], a[180:183], v[72:75]
    ds_read_b128 a[108:111], v2 offset:2048
    v_fmac_f32 v23, v24, v24
    v_mfma_f32_16x16x32_bf16 v[76:79], a[232:235], a[184:187], v[76:79]
    v_add_f32 v22, v22, v25
    v_mfma_f32_16x16x32_bf16 v[76:79], a[236:239], a[188:191], v[76:79]
    v_fmac_f32 v23, v25, v25
    v_accvgpr_read_b32 v24, a244
    v_mfma_f32_16x16x32_bf16 v[80:83], a[232:235], a[192:195], v[80:83]
    v_and_b32 v25, 0xffff0000, v24
    v_mfma_f32_16x16x32_bf16 v[80:83], a[236:239], a[196:199], v[80:83]
    v_lshlrev_b32 v24, 16, v24
    v_mfma_f32_16x16x32_bf16 v[84:87], a[232:235], a[200:203], v[84:87]
    s_add_u32 m0, s66, 8192
    s_add_u32 s74, s63, s59
    v_sub_f32 v24, v24, v27
    v_mfma_f32_16x16x32_bf16 v[84:87], a[236:239], a[204:207], v[84:87]
    buffer_load_dwordx4 v11, s[12:15], s74 offen lds
    v_sub_f32 v25, v25, v27
    v_mfma_f32_16x16x32_bf16 v[88:91], a[232:235], a[208:211], v[88:91]
    v_add_f32 v22, v22, v24
    v_mfma_f32_16x16x32_bf16 v[88:91], a[236:239], a[212:215], v[88:91]
    v_fmac_f32 v23, v24, v24
    v_mfma_f32_16x16x32_bf16 v[92:95], a[232:235], a[216:219], v[92:95]
    v_mfma_f32_16x16x32_bf16 a[240:243], v[28:31], a[232:235], a[240:243]
    v_add_f32 v22, v22, v25
    v_fmac_f32 v23, v25, v25
    v_mfma_f32_16x16x32_bf16 v[92:95], a[236:239], a[220:223], v[92:95]
    v_accvgpr_read_b32 v24, a245
    s_waitcnt lgkmcnt(2)
    v_mfma_f32_16x16x32_bf16 v[96:99], a[160:163], a[224:227], v[96:99]
    ds_read_b64_tr_b16 a[232:233], v4 offset:24576
    v_mov_b32_dpp v28, v28 row_ror:1 row_mask:0xf bank_mask:0xf
    v_mfma_f32_16x16x32_bf16 v[96:99], a[164:167], a[228:231], v[96:99]
    ds_read_b64_tr_b16 a[234:235], v4 offset:25088
    v_mov_b32_dpp v29, v29 row_ror:1 row_mask:0xf bank_mask:0xf
    v_mfma_f32_16x16x32_bf16 v[100:103], a[168:171], a[224:227], v[100:103]
    ds_read_b64_tr_b16 a[236:237], v6 offset:24576
    v_mov_b32_dpp v30, v30 row_ror:1 row_mask:0xf bank_mask:0xf
    v_mfma_f32_16x16x32_bf16 v[100:103], a[172:175], a[228:231], v[100:103]
    ds_read_b64_tr_b16 a[238:239], v6 offset:25088
    v_mov_b32_dpp v31, v31 row_ror:1 row_mask:0xf bank_mask:0xf
    v_mfma_f32_16x16x32_bf16 v[104:107], a[176:179], a[224:227], v[104:107]
    ds_read_b128 a[112:115], v1 offset:4096
    v_and_b32 v25, 0xffff0000, v24
    v_mfma_f32_16x16x32_bf16 v[104:107], a[180:183], a[228:231], v[104:107]
    v_lshlrev_b32 v24, 16, v24
    v_sub_f32 v24, v24, v27
    v_mfma_f32_16x16x32_bf16 v[108:111], a[184:187], a[224:227], v[108:111]
    v_sub_f32 v25, v25, v27
    v_mfma_f32_16x16x32_bf16 v[108:111], a[188:191], a[228:231], v[108:111]
    s_add_u32 m0, s66, 49152
    s_add_u32 s74, s74, 229376
    v_add_f32 v22, v22, v24
    v_mfma_f32_16x16x32_bf16 v[112:115], a[192:195], a[224:227], v[112:115]
    buffer_load_dwordx4 v11, s[12:15], s74 offen lds
    v_fmac_f32 v23, v24, v24
    v_add_f32 v22, v22, v25
    v_mfma_f32_16x16x32_bf16 v[112:115], a[196:199], a[228:231], v[112:115]
    v_fmac_f32 v23, v25, v25
    v_mfma_f32_16x16x32_bf16 v[116:119], a[200:203], a[224:227], v[116:119]
    v_accvgpr_read_b32 v24, a246
    v_mfma_f32_16x16x32_bf16 v[116:119], a[204:207], a[228:231], v[116:119]
    v_and_b32 v25, 0xffff0000, v24
    v_lshlrev_b32 v24, 16, v24
    v_mfma_f32_16x16x32_bf16 v[120:123], a[208:211], a[224:227], v[120:123]
    v_sub_f32 v24, v24, v27
    v_mfma_f32_16x16x32_bf16 v[120:123], a[212:215], a[228:231], v[120:123]
    s_add_u32 m0, s67, 32768
    s_add_u32 s74, s57, 0
    v_sub_f32 v25, v25, v27
    v_mfma_f32_16x16x32_bf16 v[124:127], a[216:219], a[224:227], v[124:127]
    buffer_load_dwordx4 v9, s[4:7], s74 offen lds
    v_mfma_f32_16x16x32_bf16 a[240:243], v[28:31], a[224:227], a[240:243]
    v_add_f32 v22, v22, v24
    v_fmac_f32 v23, v24, v24
    v_mfma_f32_16x16x32_bf16 v[124:127], a[220:223], a[228:231], v[124:127]
    v_add_f32 v22, v22, v25
    s_waitcnt lgkmcnt(1)
    v_mfma_f32_16x16x32_bf16 v[128:131], a[160:163], a[232:235], v[128:131]
    ds_read_b64_tr_b16 a[224:225], v3 offset:28672
    v_mov_b32_dpp v28, v28 row_ror:1 row_mask:0xf bank_mask:0xf
    v_mfma_f32_16x16x32_bf16 v[128:131], a[164:167], a[236:239], v[128:131]
    ds_read_b64_tr_b16 a[226:227], v3 offset:29184
    v_mov_b32_dpp v29, v29 row_ror:1 row_mask:0xf bank_mask:0xf
    v_mfma_f32_16x16x32_bf16 v[132:135], a[168:171], a[232:235], v[132:135]
    ds_read_b64_tr_b16 a[228:229], v5 offset:28672
    v_mov_b32_dpp v30, v30 row_ror:1 row_mask:0xf bank_mask:0xf
    v_mfma_f32_16x16x32_bf16 v[132:135], a[172:175], a[236:239], v[132:135]
    ds_read_b64_tr_b16 a[230:231], v5 offset:29184
    v_mov_b32_dpp v31, v31 row_ror:1 row_mask:0xf bank_mask:0xf
    v_mfma_f32_16x16x32_bf16 v[136:139], a[176:179], a[232:235], v[136:139]
    ds_read_b128 a[116:119], v2 offset:4096
    v_fmac_f32 v23, v25, v25
    v_mfma_f32_16x16x32_bf16 v[136:139], a[180:183], a[236:239], v[136:139]
    v_accvgpr_read_b32 v24, a247
    v_and_b32 v25, 0xffff0000, v24
    v_mfma_f32_16x16x32_bf16 v[140:143], a[184:187], a[232:235], v[140:143]
    v_lshlrev_b32 v24, 16, v24
    v_mfma_f32_16x16x32_bf16 v[140:143], a[188:191], a[236:239], v[140:143]
    v_sub_f32 v24, v24, v27
    v_mfma_f32_16x16x32_bf16 v[144:147], a[192:195], a[232:235], v[144:147]
    v_sub_f32 v25, v25, v27
    v_add_f32 v22, v22, v24
    v_mfma_f32_16x16x32_bf16 v[144:147], a[196:199], a[236:239], v[144:147]
    v_fmac_f32 v23, v24, v24
    v_mfma_f32_16x16x32_bf16 v[148:151], a[200:203], a[232:235], v[148:151]
    s_add_u32 m0, s67, 34816
    s_add_u32 s74, s57, 32768
    v_add_f32 v22, v22, v25
    v_mfma_f32_16x16x32_bf16 v[148:151], a[204:207], a[236:239], v[148:151]
    buffer_load_dwordx4 v9, s[4:7], s74 offen lds
    v_fmac_f32 v23, v25, v25
    v_accvgpr_read_b32 v24, a248
    v_mfma_f32_16x16x32_bf16 v[152:155], a[208:211], a[232:235], v[152:155]
    v_and_b32 v25, 0xffff0000, v24
    v_mfma_f32_16x16x32_bf16 v[152:155], a[212:215], a[236:239], v[152:155]
    v_lshlrev_b32 v24, 16, v24
    v_mfma_f32_16x16x32_bf16 v[156:159], a[216:219], a[232:235], v[156:159]
    v_mfma_f32_16x16x32_bf16 a[240:243], v[28:31], a[232:235], a[240:243]
    v_sub_f32 v24, v24, v27
    v_sub_f32 v25, v25, v27
    v_mfma_f32_16x16x32_bf16 v[156:159], a[220:223], a[236:239], v[156:159]
    v_add_f32 v22, v22, v24
    s_waitcnt lgkmcnt(1)
    v_mfma_f32_16x16x32_bf16 v[160:163], a[224:227], a[160:163], v[160:163]
    ds_read_b64_tr_b16 a[232:233], v4 offset:28672
    v_mov_b32_dpp v28, v28 row_ror:1 row_mask:0xf bank_mask:0xf
    v_mfma_f32_16x16x32_bf16 v[160:163], a[228:231], a[164:167], v[160:163]
    ds_read_b64_tr_b16 a[234:235], v4 offset:29184
    v_mov_b32_dpp v29, v29 row_ror:1 row_mask:0xf bank_mask:0xf
    v_mfma_f32_16x16x32_bf16 v[164:167], a[224:227], a[168:171], v[164:167]
    ds_read_b64_tr_b16 a[236:237], v6 offset:28672
    v_mov_b32_dpp v30, v30 row_ror:1 row_mask:0xf bank_mask:0xf
    v_mfma_f32_16x16x32_bf16 v[164:167], a[228:231], a[172:175], v[164:167]
    ds_read_b64_tr_b16 a[238:239], v6 offset:29184
    v_mov_b32_dpp v31, v31 row_ror:1 row_mask:0xf bank_mask:0xf
    v_mfma_f32_16x16x32_bf16 v[168:171], a[224:227], a[176:179], v[168:171]
    v_fmac_f32 v23, v24, v24
    v_mfma_f32_16x16x32_bf16 v[168:171], a[228:231], a[180:183], v[168:171]
    v_add_f32 v22, v22, v25
    v_fmac_f32 v23, v25, v25
    v_mfma_f32_16x16x32_bf16 v[172:175], a[224:227], a[184:187], v[172:175]
    v_accvgpr_read_b32 v24, a249
    v_mfma_f32_16x16x32_bf16 v[172:175], a[228:231], a[188:191], v[172:175]
    s_add_u32 m0, s67, 36864
    s_add_u32 s74, s57, 65536
    v_and_b32 v25, 0xffff0000, v24
    v_mfma_f32_16x16x32_bf16 v[176:179], a[224:227], a[192:195], v[176:179]
    buffer_load_dwordx4 v9, s[4:7], s74 offen lds
    v_lshlrev_b32 v24, 16, v24
    v_sub_f32 v24, v24, v27
    v_mfma_f32_16x16x32_bf16 v[176:179], a[228:231], a[196:199], v[176:179]
    v_sub_f32 v25, v25, v27
    v_mfma_f32_16x16x32_bf16 v[180:183], a[224:227], a[200:203], v[180:183]
    v_add_f32 v22, v22, v24
    v_mfma_f32_16x16x32_bf16 v[180:183], a[228:231], a[204:207], v[180:183]
    v_fmac_f32 v23, v24, v24
    v_add_f32 v22, v22, v25
    v_mfma_f32_16x16x32_bf16 v[184:187], a[224:227], a[208:211], v[184:187]
    v_mfma_f32_16x16x32_bf16 v[184:187], a[228:231], a[212:215], v[184:187]
    v_fmac_f32 v23, v25, v25
    v_mfma_f32_16x16x32_bf16 v[188:191], a[224:227], a[216:219], v[188:191]
    v_mfma_f32_16x16x32_bf16 a[240:243], v[28:31], a[224:227], a[240:243]
    v_accvgpr_read_b32 v24, a250
    v_mfma_f32_16x16x32_bf16 v[188:191], a[228:231], a[220:223], v[188:191]
    s_waitcnt vmcnt(10) lgkmcnt(0)
    s_barrier
    v_mfma_f32_16x16x32_bf16 v[192:195], a[232:235], a[160:163], v[192:195]
    ds_read_b64_tr_b16 a[224:225], v3 offset:32768
    v_mfma_f32_16x16x32_bf16 v[192:195], a[236:239], a[164:167], v[192:195]
    ds_read_b64_tr_b16 a[226:227], v3 offset:33280
    v_mfma_f32_16x16x32_bf16 v[196:199], a[232:235], a[168:171], v[196:199]
    ds_read_b64_tr_b16 a[228:229], v5 offset:32768
    v_mfma_f32_16x16x32_bf16 v[196:199], a[236:239], a[172:175], v[196:199]
    ds_read_b64_tr_b16 a[230:231], v5 offset:33280
    v_mfma_f32_16x16x32_bf16 v[200:203], a[232:235], a[176:179], v[200:203]
    ds_read_b128 a[120:123], v1 offset:6144
    v_mfma_f32_16x16x32_bf16 v[200:203], a[236:239], a[180:183], v[200:203]
    ds_read_b128 a[124:127], v2 offset:6144
    v_mfma_f32_16x16x32_bf16 v[204:207], a[232:235], a[184:187], v[204:207]
    ds_read_b128 a[128:131], v1 offset:8192
    v_mfma_f32_16x16x32_bf16 v[204:207], a[236:239], a[188:191], v[204:207]
    s_add_u32 m0, s66, 12288
    s_add_u32 s74, s64, s59
    v_mov_b32_dpp v28, v28 row_ror:1 row_mask:0xf bank_mask:0xf
    v_mfma_f32_16x16x32_bf16 v[208:211], a[232:235], a[192:195], v[208:211]
    buffer_load_dwordx4 v11, s[16:19], s74 offen lds
    v_mov_b32_dpp v29, v29 row_ror:1 row_mask:0xf bank_mask:0xf
    v_mfma_f32_16x16x32_bf16 v[208:211], a[236:239], a[196:199], v[208:211]
    v_mov_b32_dpp v30, v30 row_ror:1 row_mask:0xf bank_mask:0xf
    v_mfma_f32_16x16x32_bf16 v[212:215], a[232:235], a[200:203], v[212:215]
    s_add_u32 m0, s66, 53248
    s_add_u32 s74, s74, 229376
    v_mov_b32_dpp v31, v31 row_ror:1 row_mask:0xf bank_mask:0xf
    v_mfma_f32_16x16x32_bf16 v[212:215], a[236:239], a[204:207], v[212:215]
    buffer_load_dwordx4 v11, s[16:19], s74 offen lds
    v_and_b32 v25, 0xffff0000, v24
    v_lshlrev_b32 v24, 16, v24
    v_mfma_f32_16x16x32_bf16 v[216:219], a[232:235], a[208:211], v[216:219]
    v_sub_f32 v24, v24, v27
    v_mfma_f32_16x16x32_bf16 v[216:219], a[236:239], a[212:215], v[216:219]
    s_add_u32 m0, s68, 0
    s_add_u32 s74, s65, s59
    v_sub_f32 v25, v25, v27
    v_mfma_f32_16x16x32_bf16 v[220:223], a[232:235], a[216:219], v[220:223]
    buffer_load_dwordx4 v12, s[12:15], s74 offen lds
    v_mfma_f32_16x16x32_bf16 a[240:243], v[28:31], a[232:235], a[240:243]
    v_add_f32 v22, v22, v24
    v_fmac_f32 v23, v24, v24
    v_mfma_f32_16x16x32_bf16 v[220:223], a[236:239], a[220:223], v[220:223]
    v_add_f32 v22, v22, v25
    s_waitcnt lgkmcnt(3)
    v_mfma_f32_16x16x32_bf16 a[0:3], a[224:227], a[160:163], a[0:3]
    ds_read_b64_tr_b16 a[232:233], v4 offset:32768
    v_mov_b32_dpp v28, v28 row_ror:1 row_mask:0xf bank_mask:0xf
    v_mfma_f32_16x16x32_bf16 a[0:3], a[228:231], a[164:167], a[0:3]
    ds_read_b64_tr_b16 a[234:235], v4 offset:33280
    v_mov_b32_dpp v29, v29 row_ror:1 row_mask:0xf bank_mask:0xf
    v_mfma_f32_16x16x32_bf16 a[4:7], a[224:227], a[168:171], a[4:7]
    ds_read_b64_tr_b16 a[236:237], v6 offset:32768
    v_mov_b32_dpp v30, v30 row_ror:1 row_mask:0xf bank_mask:0xf
    v_mfma_f32_16x16x32_bf16 a[4:7], a[228:231], a[172:175], a[4:7]
    ds_read_b64_tr_b16 a[238:239], v6 offset:33280
    v_mov_b32_dpp v31, v31 row_ror:1 row_mask:0xf bank_mask:0xf
    v_mfma_f32_16x16x32_bf16 a[8:11], a[224:227], a[176:179], a[8:11]
    ds_read_b128 a[132:135], v2 offset:8192
    v_fmac_f32 v23, v25, v25
    v_mfma_f32_16x16x32_bf16 a[8:11], a[228:231], a[180:183], a[8:11]
    ds_read_b128 a[136:139], v1 offset:10240
    v_accvgpr_read_b32 v24, a251
    v_mfma_f32_16x16x32_bf16 a[12:15], a[224:227], a[184:187], a[12:15]
    ds_read_b128 a[140:143], v2 offset:10240
    v_and_b32 v25, 0xffff0000, v24
    v_mfma_f32_16x16x32_bf16 a[12:15], a[228:231], a[188:191], a[12:15]
    s_add_u32 m0, s68, 2048
    v_lshlrev_b32 v24, 16, v24
    v_mfma_f32_16x16x32_bf16 a[16:19], a[224:227], a[192:195], a[16:19]
    buffer_load_dwordx4 v12, s[16:19], s74 offen lds
    v_sub_f32 v24, v24, v27
    v_mfma_f32_16x16x32_bf16 a[16:19], a[228:231], a[196:199], a[16:19]
    v_sub_f32 v25, v25, v27
    v_add_f32 v22, v22, v24
    v_mfma_f32_16x16x32_bf16 a[20:23], a[224:227], a[200:203], a[20:23]
    v_fmac_f32 v23, v24, v24
    v_mfma_f32_16x16x32_bf16 a[20:23], a[228:231], a[204:207], a[20:23]
    v_add_f32 v22, v22, v25
    v_mfma_f32_16x16x32_bf16 a[24:27], a[224:227], a[208:211], a[24:27]
    v_fmac_f32 v23, v25, v25
    v_add_f32_dpp v22, v22, v22 row_ror:8 row_mask:0xf bank_mask:0xf
    v_mfma_f32_16x16x32_bf16 a[24:27], a[228:231], a[212:215], a[24:27]
    s_add_u32 m0, s67, 38912
    s_add_u32 s74, s57, 98304
    v_add_f32_dpp v23, v23, v23 row_ror:8 row_mask:0xf bank_mask:0xf
    v_mfma_f32_16x16x32_bf16 a[28:31], a[224:227], a[216:219], a[28:31]
    buffer_load_dwordx4 v9, s[4:7], s74 offen lds
    v_mfma_f32_16x16x32_bf16 a[240:243], v[28:31], a[224:227], a[240:243]
    v_add_f32_dpp v22, v22, v22 row_ror:4 row_mask:0xf bank_mask:0xf
    v_mfma_f32_16x16x32_bf16 a[28:31], a[228:231], a[220:223], a[28:31]
    v_add_f32_dpp v23, v23, v23 row_ror:4 row_mask:0xf bank_mask:0xf
    s_waitcnt lgkmcnt(3)
    v_mfma_f32_16x16x32_bf16 a[32:35], a[232:235], a[160:163], a[32:35]
    ds_read_b64_tr_b16 a[224:225], v7 offset:36864
    v_mov_b32_dpp v28, v28 row_ror:1 row_mask:0xf bank_mask:0xf
    v_mfma_f32_16x16x32_bf16 a[32:35], a[236:239], a[164:167], a[32:35]
    ds_read_b64_tr_b16 a[226:227], v7 offset:37120
    v_mov_b32_dpp v29, v29 row_ror:1 row_mask:0xf bank_mask:0xf
    v_mfma_f32_16x16x32_bf16 a[36:39], a[232:235], a[168:171], a[36:39]
    ds_read_b64_tr_b16 a[228:229], v8 offset:36864
    v_mov_b32_dpp v30, v30 row_ror:1 row_mask:0xf bank_mask:0xf
    v_mfma_f32_16x16x32_bf16 a[36:39], a[236:239], a[172:175], a[36:39]
    ds_read_b64_tr_b16 a[230:231], v8 offset:37120
    v_mov_b32_dpp v31, v31 row_ror:1 row_mask:0xf bank_mask:0xf
    v_mfma_f32_16x16x32_bf16 a[40:43], a[232:235], a[176:179], a[40:43]
    ds_read_b128 a[144:147], v1 offset:12288
    v_add_f32_dpp v22, v22, v22 row_ror:2 row_mask:0xf bank_mask:0xf
    v_mfma_f32_16x16x32_bf16 a[40:43], a[236:239], a[180:183], a[40:43]
    ds_read_b128 a[148:151], v2 offset:12288
    v_add_f32_dpp v23, v23, v23 row_ror:2 row_mask:0xf bank_mask:0xf
    v_mfma_f32_16x16x32_bf16 a[44:47], a[232:235], a[184:187], a[44:47]
    v_add_f32_dpp v22, v22, v22 row_ror:1 row_mask:0xf bank_mask:0xf
    v_mfma_f32_16x16x32_bf16 a[44:47], a[236:239], a[188:191], a[44:47]
    s_add_u32 m0, s67, 40960
    s_add_u32 s74, s57, 131072
    v_add_f32_dpp v23, v23, v23 row_ror:1 row_mask:0xf bank_mask:0xf
    v_mfma_f32_16x16x32_bf16 a[48:51], a[232:235], a[192:195], a[48:51]
    buffer_load_dwordx4 v9, s[4:7], s74 offen lds
    v_mov_b32 v24, v22
    v_mfma_f32_16x16x32_bf16 a[48:51], a[236:239], a[196:199], a[48:51]
    v_mov_b32 v25, v23
    v_mfma_f32_16x16x32_bf16 a[52:55], a[232:235], a[200:203], a[52:55]
    s_mul_i32 s58, s60, 393216
    v_permlane16_swap_b32 v24, v22
    v_mfma_f32_16x16x32_bf16 a[52:55], a[236:239], a[204:207], a[52:55]
    s_mul_i32 s59, s60, 458752
    v_permlane16_swap_b32 v25, v23
    v_mfma_f32_16x16x32_bf16 a[56:59], a[232:235], a[208:211], a[56:59]
    v_add_f32 v22, v22, v24
    v_mfma_f32_16x16x32_bf16 a[56:59], a[236:239], a[212:215], a[56:59]
    s_add_u32 m0, s67, 43008
    s_add_u32 s74, s57, 163840
    v_add_f32 v23, v23, v25
    v_mfma_f32_16x16x32_bf16 a[60:63], a[232:235], a[216:219], a[60:63]
    buffer_load_dwordx4 v9, s[4:7], s74 offen lds
    v_mfma_f32_16x16x32_bf16 a[240:243], v[28:31], a[232:235], a[240:243]
    v_mul_f32 v22, 0xba800000, v22
    v_mfma_f32_16x16x32_bf16 a[60:63], a[236:239], a[220:223], a[60:63]
    v_mul_f32 v23, 0x3a800000, v23
    s_waitcnt lgkmcnt(2)
    v_mfma_f32_16x16x32_bf16 v[224:227], a[224:227], a[160:163], v[224:227]
    ds_read_b64_tr_b16 a[232:233], v7 offset:38912
    v_mov_b32_dpp v28, v28 row_ror:1 row_mask:0xf bank_mask:0xf
    v_mfma_f32_16x16x32_bf16 v[224:227], a[228:231], a[164:167], v[224:227]
    ds_read_b64_tr_b16 a[234:235], v7 offset:39168
    v_mov_b32_dpp v29, v29 row_ror:1 row_mask:0xf bank_mask:0xf
    v_mfma_f32_16x16x32_bf16 v[228:231], a[224:227], a[168:171], v[228:231]
    ds_read_b64_tr_b16 a[236:237], v8 offset:38912
    v_mov_b32_dpp v30, v30 row_ror:1 row_mask:0xf bank_mask:0xf
    v_mfma_f32_16x16x32_bf16 v[228:231], a[228:231], a[172:175], v[228:231]
    ds_read_b64_tr_b16 a[238:239], v8 offset:39168
    v_mov_b32_dpp v31, v31 row_ror:1 row_mask:0xf bank_mask:0xf
    v_mfma_f32_16x16x32_bf16 v[232:235], a[224:227], a[176:179], v[232:235]
    ds_read_b128 a[152:155], v1 offset:14336
    v_fma_f32 v23, -v22, v22, v23
    v_mfma_f32_16x16x32_bf16 v[232:235], a[228:231], a[180:183], v[232:235]
    ds_read_b128 a[156:159], v2 offset:14336
    v_max_f32 v23, 0, v23
    v_mfma_f32_16x16x32_bf16 v[236:239], a[224:227], a[184:187], v[236:239]
    v_sub_f32_e64 v22, v22, v27
    v_mfma_f32_16x16x32_bf16 v[236:239], a[228:231], a[188:191], v[236:239]
    s_add_u32 m0, s67, 45056
    s_add_u32 s74, s57, 196608
    v_cvt_pk_bf16_f32 v23, v23, v23
    v_mfma_f32_16x16x32_bf16 v[240:243], a[224:227], a[192:195], v[240:243]
    buffer_load_dwordx4 v9, s[4:7], s74 offen lds
    v_lshlrev_b32 v23, 16, v23
    v_mfma_f32_16x16x32_bf16 v[240:243], a[228:231], a[196:199], v[240:243]
    v_add_f32 v23, 0x3727c5ac, v23
    v_mfma_f32_16x16x32_bf16 v[244:247], a[224:227], a[200:203], v[244:247]
    s_add_u32 s60, s60, 1
    v_cvt_pk_bf16_f32 v23, v23, v23
    v_mfma_f32_16x16x32_bf16 v[244:247], a[228:231], a[204:207], v[244:247]
L_pad0_5:
    s_cbranch_execz L_pad0_9
    s_cmp_eq_u32 s60, 16
    s_cselect_b32 s60, 4, s60
    v_lshlrev_b32 v23, 16, v23
    v_mfma_f32_16x16x32_bf16 v[248:251], a[224:227], a[208:211], v[248:251]
    v_sqrt_f32 v23, v23
    v_mfma_f32_16x16x32_bf16 v[248:251], a[228:231], a[212:215], v[248:251]
    s_add_u32 m0, s67, 47104
    s_add_u32 s74, s57, 229376
    v_cvt_pk_bf16_f32 v24, v22, v22
    v_mfma_f32_16x16x32_bf16 v[252:255], a[224:227], a[216:219], v[252:255]
    buffer_load_dwordx4 v9, s[4:7], s74 offen lds
    v_mfma_f32_16x16x32_bf16 a[240:243], v[28:31], a[224:227], a[240:243]
    v_cvt_pk_bf16_f32 v25, v22, v22
    v_mfma_f32_16x16x32_bf16 v[252:255], a[228:231], a[220:223], v[252:255]
    s_waitcnt vmcnt(9) lgkmcnt(0)
    s_barrier
    v_mfma_f32_16x16x32_bf16 a[64:67], a[232:235], a[160:163], a[64:67]
    ds_read_b64_tr_b16 a[224:225], v3
    v_mfma_f32_16x16x32_bf16 a[64:67], a[236:239], a[164:167], a[64:67]
    ds_read_b64_tr_b16 a[226:227], v3 offset:512
    v_mfma_f32_16x16x32_bf16 a[68:71], a[232:235], a[168:171], a[68:71]
    ds_read_b64_tr_b16 a[228:229], v5
    v_mfma_f32_16x16x32_bf16 a[68:71], a[236:239], a[172:175], a[68:71]
    ds_read_b64_tr_b16 a[230:231], v5 offset:512
    v_mfma_f32_16x16x32_bf16 a[72:75], a[232:235], a[176:179], a[72:75]
    v_mov_b32_dpp v28, v28 row_ror:1 row_mask:0xf bank_mask:0xf
    v_mov_b32_dpp v29, v29 row_ror:1 row_mask:0xf bank_mask:0xf
    v_mfma_f32_16x16x32_bf16 a[72:75], a[236:239], a[180:183], a[72:75]
    s_lshl_b32 s57, s60, 7
    v_mov_b32_dpp v30, v30 row_ror:1 row_mask:0xf bank_mask:0xf
    v_mov_b32_dpp v31, v31 row_ror:1 row_mask:0xf bank_mask:0xf
    v_mfma_f32_16x16x32_bf16 a[76:79], a[232:235], a[184:187], a[76:79]
    v_cvt_pk_bf16_f32 v22, v23, v23
    v_lshlrev_b32 v23, 16, v22
    v_mfma_f32_16x16x32_bf16 a[76:79], a[236:239], a[188:191], a[76:79]
    s_add_u32 m0, s66, 20480
    s_add_u32 s74, s61, s58
    v_lshrrev_b32 v14, 6, v13
    v_mfma_f32_16x16x32_bf16 a[80:83], a[232:235], a[192:195], a[80:83]
    buffer_load_dwordx4 v10, s[8:11], s74 offen lds
    v_lshrrev_b32 v15, 4, v13
    v_mfma_f32_16x16x32_bf16 a[80:83], a[236:239], a[196:199], a[80:83]
    v_mfma_f32_16x16x32_bf16 a[240:243], v[28:31], a[232:235], a[240:243]
    v_lshrrev_b32 v16, 8, v13
    v_mfma_f32_16x16x32_bf16 a[84:87], a[232:235], a[200:203], a[84:87]
    s_mov_b32 exec_lo, 1
    s_mov_b32 exec_hi, 1
    buffer_store_dwordx2 v[24:25], v14, s[20:23], s85 offen sc1
    buffer_store_dword v23, v15, s[20:23], s99 offen sc1
    buffer_store_short v22, v16, s[20:23], s100 offen sc1
    s_mov_b64 exec, -1
    v_mfma_f32_16x16x32_bf16 a[84:87], a[236:239], a[204:207], a[84:87]
    v_mfma_f32_16x16x32_bf16 a[88:91], a[232:235], a[208:211], a[88:91]
    v_mfma_f32_16x16x32_bf16 a[88:91], a[236:239], a[212:215], a[88:91]
    s_add_u32 m0, s66, 61440
    s_add_u32 s74, s74, 196608
    v_mfma_f32_16x16x32_bf16 a[92:95], a[232:235], a[216:219], a[92:95]
    buffer_load_dwordx4 v10, s[8:11], s74 offen lds
    v_mfma_f32_16x16x32_bf16 a[92:95], a[236:239], a[220:223], a[92:95]
    buffer_store_dwordx4 a[240:243], v13, s[20:23], s70 offen sc1
    s_branch L_next0
    .p2align 3
L_tail0:
L_pad0_6:
    s_cbranch_execz L_pad0_10
    s_waitcnt lgkmcnt(0)
    v_mfma_f32_16x16x32_bf16 v[32:35], a[224:227], a[96:99], v[32:35]
    ds_read_b64_tr_b16 a[232:233], v4
    v_mfma_f32_16x16x32_bf16 v[32:35], a[228:231], a[100:103], v[32:35]
    ds_read_b64_tr_b16 a[234:235], v4 offset:512
    v_mfma_f32_16x16x32_bf16 v[36:39], a[224:227], a[104:107], v[36:39]
    ds_read_b64_tr_b16 a[236:237], v6
    v_mfma_f32_16x16x32_bf16 v[36:39], a[228:231], a[108:111], v[36:39]
    ds_read_b64_tr_b16 a[238:239], v6 offset:512
    v_mfma_f32_16x16x32_bf16 v[40:43], a[224:227], a[112:115], v[40:43]
    ds_read_b128 a[160:163], v1 offset:32768
    v_mfma_f32_16x16x32_bf16 v[40:43], a[228:231], a[116:119], v[40:43]
    ds_read_b128 a[164:167], v2 offset:32768
    v_mfma_f32_16x16x32_bf16 v[44:47], a[224:227], a[120:123], v[44:47]
    v_mfma_f32_16x16x32_bf16 v[44:47], a[228:231], a[124:127], v[44:47]
    s_add_u32 m0, s66, 24576
    s_add_u32 s74, s62, s58
    v_mfma_f32_16x16x32_bf16 v[48:51], a[224:227], a[128:131], v[48:51]
    buffer_load_dwordx4 v10, s[8:11], s74 offen lds
    v_mfma_f32_16x16x32_bf16 v[48:51], a[228:231], a[132:135], v[48:51]
    buffer_load_dword v27, off, s[36:39], 0 sc1
    v_mfma_f32_16x16x32_bf16 v[52:55], a[224:227], a[136:139], v[52:55]
    s_add_u32 m0, s66, 65536
    s_add_u32 s74, s74, 196608
    v_mfma_f32_16x16x32_bf16 v[52:55], a[228:231], a[140:143], v[52:55]
    buffer_load_dwordx4 v10, s[8:11], s74 offen lds
    v_mfma_f32_16x16x32_bf16 v[56:59], a[224:227], a[144:147], v[56:59]
    v_mfma_f32_16x16x32_bf16 v[56:59], a[228:231], a[148:151], v[56:59]
    s_add_u32 m0, s66, 28672
    s_add_u32 s74, s63, s59
    v_mfma_f32_16x16x32_bf16 v[60:63], a[224:227], a[152:155], v[60:63]
    buffer_load_dwordx4 v11, s[12:15], s74 offen lds
    v_mfma_f32_16x16x32_bf16 v[60:63], a[228:231], a[156:159], v[60:63]
    s_waitcnt lgkmcnt(2)
    v_mfma_f32_16x16x32_bf16 v[64:67], a[232:235], a[96:99], v[64:67]
    ds_read_b64_tr_b16 a[224:225], v3 offset:4096
    v_mfma_f32_16x16x32_bf16 v[64:67], a[236:239], a[100:103], v[64:67]
    ds_read_b64_tr_b16 a[226:227], v3 offset:4608
    v_mfma_f32_16x16x32_bf16 v[68:71], a[232:235], a[104:107], v[68:71]
    ds_read_b64_tr_b16 a[228:229], v5 offset:4096
    v_mfma_f32_16x16x32_bf16 v[68:71], a[236:239], a[108:111], v[68:71]
    ds_read_b64_tr_b16 a[230:231], v5 offset:4608
    v_mfma_f32_16x16x32_bf16 v[72:75], a[232:235], a[112:115], v[72:75]
    ds_read_b128 a[168:171], v1 offset:34816
    v_mfma_f32_16x16x32_bf16 v[72:75], a[236:239], a[116:119], v[72:75]
    ds_read_b128 a[172:175], v2 offset:34816
    v_mfma_f32_16x16x32_bf16 v[76:79], a[232:235], a[120:123], v[76:79]
    v_mfma_f32_16x16x32_bf16 v[76:79], a[236:239], a[124:127], v[76:79]
    s_add_u32 m0, s66, 69632
    s_add_u32 s74, s74, 229376
    v_mfma_f32_16x16x32_bf16 v[80:83], a[232:235], a[128:131], v[80:83]
    buffer_load_dwordx4 v11, s[12:15], s74 offen lds
    v_mfma_f32_16x16x32_bf16 v[80:83], a[236:239], a[132:135], v[80:83]
    v_mfma_f32_16x16x32_bf16 v[84:87], a[232:235], a[136:139], v[84:87]
    s_add_u32 m0, s66, 32768
    s_add_u32 s74, s64, s59
    v_mfma_f32_16x16x32_bf16 v[84:87], a[236:239], a[140:143], v[84:87]
    buffer_load_dwordx4 v11, s[16:19], s74 offen lds
    v_mfma_f32_16x16x32_bf16 v[88:91], a[232:235], a[144:147], v[88:91]
    v_mfma_f32_16x16x32_bf16 v[88:91], a[236:239], a[148:151], v[88:91]
    s_add_u32 m0, s66, 73728
    s_add_u32 s74, s74, 229376
    v_mfma_f32_16x16x32_bf16 v[92:95], a[232:235], a[152:155], v[92:95]
    buffer_load_dwordx4 v11, s[16:19], s74 offen lds
    v_mfma_f32_16x16x32_bf16 v[92:95], a[236:239], a[156:159], v[92:95]
    s_waitcnt lgkmcnt(2)
    v_mfma_f32_16x16x32_bf16 v[96:99], a[96:99], a[224:227], v[96:99]
    ds_read_b64_tr_b16 a[232:233], v4 offset:4096
    v_mfma_f32_16x16x32_bf16 v[96:99], a[100:103], a[228:231], v[96:99]
    ds_read_b64_tr_b16 a[234:235], v4 offset:4608
    v_mfma_f32_16x16x32_bf16 v[100:103], a[104:107], a[224:227], v[100:103]
    ds_read_b64_tr_b16 a[236:237], v6 offset:4096
    v_mfma_f32_16x16x32_bf16 v[100:103], a[108:111], a[228:231], v[100:103]
    ds_read_b64_tr_b16 a[238:239], v6 offset:4608
    v_mfma_f32_16x16x32_bf16 v[104:107], a[112:115], a[224:227], v[104:107]
    ds_read_b128 a[176:179], v1 offset:36864
    v_mfma_f32_16x16x32_bf16 v[104:107], a[116:119], a[228:231], v[104:107]
    v_mfma_f32_16x16x32_bf16 v[108:111], a[120:123], a[224:227], v[108:111]
    v_mfma_f32_16x16x32_bf16 v[108:111], a[124:127], a[228:231], v[108:111]
    s_add_u32 m0, s68, 20480
    s_add_u32 s74, s65, s59
    v_mfma_f32_16x16x32_bf16 v[112:115], a[128:131], a[224:227], v[112:115]
    buffer_load_dwordx4 v12, s[12:15], s74 offen lds
    v_mfma_f32_16x16x32_bf16 v[112:115], a[132:135], a[228:231], v[112:115]
    v_mfma_f32_16x16x32_bf16 v[116:119], a[136:139], a[224:227], v[116:119]
    s_add_u32 m0, s68, 22528
    v_mfma_f32_16x16x32_bf16 v[116:119], a[140:143], a[228:231], v[116:119]
    buffer_load_dwordx4 v12, s[16:19], s74 offen lds
    v_mfma_f32_16x16x32_bf16 v[120:123], a[144:147], a[224:227], v[120:123]
    v_mfma_f32_16x16x32_bf16 v[120:123], a[148:151], a[228:231], v[120:123]
    s_bfe_u32 s70, s2, 0x20001
    s_xor_b32 s60, s70, 2
    v_mfma_f32_16x16x32_bf16 v[124:127], a[152:155], a[224:227], v[124:127]
    s_and_b32 s70, s2, 1
    v_mfma_f32_16x16x32_bf16 v[124:127], a[156:159], a[228:231], v[124:127]
    s_bfe_u32 s71, s2, 0x20003
    s_waitcnt lgkmcnt(1)
    v_mfma_f32_16x16x32_bf16 v[128:131], a[96:99], a[232:235], v[128:131]
    ds_read_b64_tr_b16 a[224:225], v3 offset:8192
    s_lshl2_add_u32 s58, s70, s71
    v_mfma_f32_16x16x32_bf16 v[128:131], a[100:103], a[236:239], v[128:131]
    ds_read_b64_tr_b16 a[226:227], v3 offset:8704
    s_lshr_b32 s70, s2, 5
    v_mfma_f32_16x16x32_bf16 v[132:135], a[104:107], a[232:235], v[132:135]
    ds_read_b64_tr_b16 a[228:229], v5 offset:8192
    s_and_b32 s71, s60, 1
    v_mfma_f32_16x16x32_bf16 v[132:135], a[108:111], a[236:239], v[132:135]
    ds_read_b64_tr_b16 a[230:231], v5 offset:8704
    s_lshl1_add_u32 s70, s70, s71
    v_mfma_f32_16x16x32_bf16 v[136:139], a[112:115], a[232:235], v[136:139]
    ds_read_b128 a[180:183], v2 offset:36864
    s_lshl_b32 s54, s70, 7
    v_mfma_f32_16x16x32_bf16 v[136:139], a[116:119], a[236:239], v[136:139]
    s_lshl_b32 s70, s44, 16
    s_add_u32 s55, s54, s70
    s_lshl_b32 s70, s46, 7
    v_mfma_f32_16x16x32_bf16 v[140:143], a[120:123], a[232:235], v[140:143]
    s_xor_b32 s53, s54, s70
    v_mfma_f32_16x16x32_bf16 v[140:143], a[124:127], a[236:239], v[140:143]
    s_mul_i32 s70, s60, 28
    v_mfma_f32_16x16x32_bf16 v[144:147], a[128:131], a[232:235], v[144:147]
    s_add_u32 s71, s70, s45
    v_mfma_f32_16x16x32_bf16 v[144:147], a[132:135], a[236:239], v[144:147]
    s_lshl_b32 s71, s71, 16
    s_add_u32 s53, s53, s71
    v_mfma_f32_16x16x32_bf16 v[148:151], a[136:139], a[232:235], v[148:151]
    s_mul_i32 s70, s70, 131072
    v_mfma_f32_16x16x32_bf16 v[148:151], a[140:143], a[236:239], v[148:151]
    s_lshl2_add_u32 s71, s58, s44
    v_mfma_f32_16x16x32_bf16 v[152:155], a[144:147], a[232:235], v[152:155]
    s_lshr_b32 s57, s60, 1
    v_mfma_f32_16x16x32_bf16 v[152:155], a[148:151], a[236:239], v[152:155]
    s_lshl1_add_u32 s71, s71, s57
    s_mul_i32 s56, s71, 4096
    v_mfma_f32_16x16x32_bf16 v[156:159], a[152:155], a[232:235], v[156:159]
    s_add_u32 s56, s56, s70
    v_mfma_f32_16x16x32_bf16 v[156:159], a[156:159], a[236:239], v[156:159]
    s_xor_b32 s85, s71, 1
    s_waitcnt lgkmcnt(1)
    v_mfma_f32_16x16x32_bf16 v[160:163], a[224:227], a[96:99], v[160:163]
    ds_read_b64_tr_b16 a[232:233], v4 offset:8192
    s_mul_i32 s85, s85, 4096
    v_mfma_f32_16x16x32_bf16 v[160:163], a[228:231], a[100:103], v[160:163]
    ds_read_b64_tr_b16 a[234:235], v4 offset:8704
    s_add_u32 s85, s85, s70
    v_mfma_f32_16x16x32_bf16 v[164:167], a[224:227], a[104:107], v[164:167]
    ds_read_b64_tr_b16 a[236:237], v6 offset:8192
    s_mul_i32 s57, s71, 4096
    v_mfma_f32_16x16x32_bf16 v[164:167], a[228:231], a[108:111], v[164:167]
    ds_read_b64_tr_b16 a[238:239], v6 offset:8704
    s_add_u32 s57, s57, 15728640
    v_mfma_f32_16x16x32_bf16 v[168:171], a[224:227], a[112:115], v[168:171]
    s_lshl_b32 s71, s71, 16
    s_add_u32 s54, s54, s71
    v_mfma_f32_16x16x32_bf16 v[168:171], a[228:231], a[116:119], v[168:171]
    s_lshl_b32 s59, s44, 12
    s_lshl2_add_u32 s70, s58, s60
    v_mfma_f32_16x16x32_bf16 v[172:175], a[224:227], a[120:123], v[172:175]
    s_lshl_b32 s70, s70, 7
    v_mfma_f32_16x16x32_bf16 v[172:175], a[228:231], a[124:127], v[172:175]
    s_add_u32 s76, s70, 34148352
    v_mfma_f32_16x16x32_bf16 v[176:179], a[224:227], a[128:131], v[176:179]
    s_lshl_b32 s70, s48, 7
    v_mfma_f32_16x16x32_bf16 v[176:179], a[228:231], a[132:135], v[176:179]
    s_add_u32 s77, s70, 34156544
    s_lshl1_add_u32 s70, s49, s46
    v_mfma_f32_16x16x32_bf16 v[180:183], a[224:227], a[136:139], v[180:183]
    s_lshl1_add_u32 s70, s70, s45
    v_mfma_f32_16x16x32_bf16 v[180:183], a[228:231], a[140:143], v[180:183]
    s_lshl_b32 s70, s70, 13
    v_mfma_f32_16x16x32_bf16 v[184:187], a[224:227], a[144:147], v[184:187]
    s_add_u32 s72, s70, 33030144
    v_mfma_f32_16x16x32_bf16 v[184:187], a[228:231], a[148:151], v[184:187]
    s_add_u32 s73, s72, 4096
    v_lshrrev_b32 v0, 4, v13
    v_mfma_f32_16x16x32_bf16 v[188:191], a[224:227], a[152:155], v[188:191]
    v_mfma_f32_16x16x32_bf16 v[188:191], a[228:231], a[156:159], v[188:191]
    s_waitcnt vmcnt(11) lgkmcnt(0)
    s_barrier
    v_mfma_f32_16x16x32_bf16 v[192:195], a[232:235], a[96:99], v[192:195]
    ds_read_b64_tr_b16 a[224:225], v3 offset:12288
    v_mfma_f32_16x16x32_bf16 v[192:195], a[236:239], a[100:103], v[192:195]
    ds_read_b64_tr_b16 a[226:227], v3 offset:12800
    v_mfma_f32_16x16x32_bf16 v[196:199], a[232:235], a[104:107], v[196:199]
    ds_read_b64_tr_b16 a[228:229], v5 offset:12288
    v_mfma_f32_16x16x32_bf16 v[196:199], a[236:239], a[108:111], v[196:199]
    ds_read_b64_tr_b16 a[230:231], v5 offset:12800
    v_mfma_f32_16x16x32_bf16 v[200:203], a[232:235], a[112:115], v[200:203]
    ds_read_b128 a[184:187], v1 offset:38912
    v_mfma_f32_16x16x32_bf16 v[200:203], a[236:239], a[116:119], v[200:203]
    ds_read_b128 a[188:191], v2 offset:38912
    v_mfma_f32_16x16x32_bf16 v[204:207], a[232:235], a[120:123], v[204:207]
    ds_read_b128 a[192:195], v1 offset:40960
    v_mfma_f32_16x16x32_bf16 v[204:207], a[236:239], a[124:127], v[204:207]
    s_waitcnt vmcnt(7)
    v_cmp_le_u32 vcc, 0x100, v27
    s_nop 0
    s_cmp_eq_u64 vcc, -1
    s_cbranch_scc0 L_pc0_spin
L_pc0_ok:
    v_mfma_f32_16x16x32_bf16 v[208:211], a[232:235], a[128:131], v[208:211]
    buffer_load_dwordx4 v[28:31], v13, s[20:23], s72 offen sc1
    v_lshrrev_b32 v27, 5, v13
    v_mfma_f32_16x16x32_bf16 v[208:211], a[236:239], a[132:135], v[208:211]
    v_lshlrev_b32 v27, 13, v27
    v_mfma_f32_16x16x32_bf16 v[212:215], a[232:235], a[136:139], v[212:215]
    v_mfma_f32_16x16x32_bf16 v[212:215], a[236:239], a[140:143], v[212:215]
    v_bfe_u32 v26, v13, 4, 1
    v_mfma_f32_16x16x32_bf16 v[216:219], a[232:235], a[144:147], v[216:219]
    buffer_load_dwordx4 v[14:17], v13, s[20:23], s72 offen offset:1024 sc1
    v_mfma_f32_16x16x32_bf16 v[216:219], a[236:239], a[148:151], v[216:219]
    v_lshl_add_u32 v27, v26, 7, v27
    v_mfma_f32_16x16x32_bf16 v[220:223], a[232:235], a[152:155], v[220:223]
    v_mfma_f32_16x16x32_bf16 v[220:223], a[236:239], a[156:159], v[220:223]
    s_mul_i32 s69, s60, 7
    s_waitcnt lgkmcnt(3)
    v_mfma_f32_16x16x32_bf16 a[0:3], a[224:227], a[96:99], a[0:3]
    ds_read_b64_tr_b16 a[232:233], v4 offset:12288
    buffer_load_dwordx4 v[18:21], v13, s[20:23], s72 offen offset:2048 sc1
    v_mfma_f32_16x16x32_bf16 a[0:3], a[228:231], a[100:103], a[0:3]
    ds_read_b64_tr_b16 a[234:235], v4 offset:12800
    s_add_u32 s69, s69, s44
    v_mfma_f32_16x16x32_bf16 a[4:7], a[224:227], a[104:107], a[4:7]
    ds_read_b64_tr_b16 a[236:237], v6 offset:12288
    s_add_u32 s69, s69, 2
    v_mfma_f32_16x16x32_bf16 a[4:7], a[228:231], a[108:111], a[4:7]
    ds_read_b64_tr_b16 a[238:239], v6 offset:12800
    v_mfma_f32_16x16x32_bf16 a[8:11], a[224:227], a[112:115], a[8:11]
    ds_read_b128 a[196:199], v2 offset:40960
    s_lshl_b32 s69, s69, 7
    v_mfma_f32_16x16x32_bf16 a[8:11], a[228:231], a[116:119], a[8:11]
    ds_read_b128 a[200:203], v1 offset:43008
    buffer_load_dwordx4 v[22:25], v13, s[20:23], s72 offen offset:3072 sc1
    v_mfma_f32_16x16x32_bf16 a[12:15], a[224:227], a[120:123], a[12:15]
    ds_read_b128 a[204:207], v2 offset:43008
    s_and_b32 s70, s58, 3
    v_mfma_f32_16x16x32_bf16 a[12:15], a[228:231], a[124:127], a[12:15]
    s_add_u32 s69, s69, s70
    v_mfma_f32_16x16x32_bf16 a[16:19], a[224:227], a[128:131], a[16:19]
    v_mfma_f32_16x16x32_bf16 a[16:19], a[228:231], a[132:135], a[16:19]
    buffer_load_dwordx4 a[240:243], v13, s[20:23], s73 offen sc1
    s_lshr_b32 s70, s2, 5
    v_mfma_f32_16x16x32_bf16 a[20:23], a[224:227], a[136:139], a[20:23]
    v_mfma_f32_16x16x32_bf16 a[20:23], a[228:231], a[140:143], a[20:23]
    s_lshl3_add_u32 s69, s69, s70
    v_mfma_f32_16x16x32_bf16 a[24:27], a[224:227], a[144:147], a[24:27]
    v_mfma_f32_16x16x32_bf16 a[24:27], a[228:231], a[148:151], a[24:27]
    buffer_load_dwordx4 a[244:247], v13, s[20:23], s73 offen offset:1024 sc1
    s_lshl_b32 s69, s69, 8
    v_mfma_f32_16x16x32_bf16 a[28:31], a[224:227], a[152:155], a[28:31]
    v_mfma_f32_16x16x32_bf16 a[28:31], a[228:231], a[156:159], a[28:31]
    s_waitcnt lgkmcnt(3)
    v_mfma_f32_16x16x32_bf16 a[32:35], a[232:235], a[96:99], a[32:35]
    ds_read_b64_tr_b16 a[224:225], v7 offset:16384
    v_mfma_f32_16x16x32_bf16 a[32:35], a[236:239], a[100:103], a[32:35]
    ds_read_b64_tr_b16 a[226:227], v7 offset:16640
    v_mfma_f32_16x16x32_bf16 a[36:39], a[232:235], a[104:107], a[36:39]
    ds_read_b64_tr_b16 a[228:229], v8 offset:16384
    buffer_load_dwordx4 a[248:251], v13, s[20:23], s73 offen offset:2048 sc1
    v_mfma_f32_16x16x32_bf16 a[36:39], a[236:239], a[108:111], a[36:39]
    ds_read_b64_tr_b16 a[230:231], v8 offset:16640
    v_mfma_f32_16x16x32_bf16 a[40:43], a[232:235], a[112:115], a[40:43]
    ds_read_b128 a[208:211], v1 offset:45056
    v_mfma_f32_16x16x32_bf16 a[40:43], a[236:239], a[116:119], a[40:43]
    ds_read_b128 a[212:215], v2 offset:45056
    v_mfma_f32_16x16x32_bf16 a[44:47], a[232:235], a[120:123], a[44:47]
    buffer_load_dwordx4 a[252:255], v13, s[20:23], s73 offen offset:3072 sc1
    v_mfma_f32_16x16x32_bf16 a[44:47], a[236:239], a[124:127], a[44:47]
    v_mfma_f32_16x16x32_bf16 a[48:51], a[232:235], a[128:131], a[48:51]
    v_bfe_u32 v9, v13, 8, 2
    v_mfma_f32_16x16x32_bf16 a[48:51], a[236:239], a[132:135], a[48:51]
    v_mfma_f32_16x16x32_bf16 a[52:55], a[232:235], a[136:139], a[52:55]
    v_lshlrev_b32 v9, 5, v9
    v_mfma_f32_16x16x32_bf16 a[52:55], a[236:239], a[140:143], a[52:55]
    v_mfma_f32_16x16x32_bf16 a[56:59], a[232:235], a[144:147], a[56:59]
    v_mfma_f32_16x16x32_bf16 a[56:59], a[236:239], a[148:151], a[56:59]
    v_and_b32 v10, 0x70, v13
    v_mfma_f32_16x16x32_bf16 a[60:63], a[232:235], a[152:155], a[60:63]
    buffer_load_dword v27, v27, s[24:27], s69 offen
    v_mfma_f32_16x16x32_bf16 a[60:63], a[236:239], a[156:159], a[60:63]
    s_waitcnt lgkmcnt(2)
    v_mfma_f32_16x16x32_bf16 v[224:227], a[224:227], a[96:99], v[224:227]
    ds_read_b64_tr_b16 a[232:233], v7 offset:18432
    v_xor_b32 v9, v9, v10
    v_mfma_f32_16x16x32_bf16 v[224:227], a[228:231], a[100:103], v[224:227]
    ds_read_b64_tr_b16 a[234:235], v7 offset:18688
    v_mfma_f32_16x16x32_bf16 v[228:231], a[224:227], a[104:107], v[228:231]
    ds_read_b64_tr_b16 a[236:237], v8 offset:18432
    v_lshrrev_b32 v10, 7, v13
    v_mfma_f32_16x16x32_bf16 v[228:231], a[228:231], a[108:111], v[228:231]
    ds_read_b64_tr_b16 a[238:239], v8 offset:18688
    v_mfma_f32_16x16x32_bf16 v[232:235], a[224:227], a[112:115], v[232:235]
    ds_read_b128 a[216:219], v1 offset:47104
    v_mfma_f32_16x16x32_bf16 v[232:235], a[228:231], a[116:119], v[232:235]
    ds_read_b128 a[220:223], v2 offset:47104
    v_lshl_add_u32 v9, v10, 11, v9
    v_mfma_f32_16x16x32_bf16 v[236:239], a[224:227], a[120:123], v[236:239]
    v_mfma_f32_16x16x32_bf16 v[236:239], a[228:231], a[124:127], v[236:239]
    v_mfma_f32_16x16x32_bf16 v[240:243], a[224:227], a[128:131], v[240:243]
    v_add_u32 v10, 15360, v9
    v_mfma_f32_16x16x32_bf16 v[240:243], a[228:231], a[132:135], v[240:243]
    v_mfma_f32_16x16x32_bf16 v[244:247], a[224:227], a[136:139], v[244:247]
    v_add_u32 v11, 30720, v9
    v_mfma_f32_16x16x32_bf16 v[244:247], a[228:231], a[140:143], v[244:247]
    v_mfma_f32_16x16x32_bf16 v[248:251], a[224:227], a[144:147], v[248:251]
    v_mfma_f32_16x16x32_bf16 v[248:251], a[228:231], a[148:151], v[248:251]
    v_add_u32 v12, 46080, v9
    v_mfma_f32_16x16x32_bf16 v[252:255], a[224:227], a[152:155], v[252:255]
    v_mfma_f32_16x16x32_bf16 v[252:255], a[228:231], a[156:159], v[252:255]
    s_waitcnt vmcnt(9) lgkmcnt(0)
    s_barrier
    v_mfma_f32_16x16x32_bf16 a[64:67], a[232:235], a[96:99], a[64:67]
    ds_read_b64_tr_b16 a[224:225], v3 offset:20480
    v_mfma_f32_16x16x32_bf16 a[64:67], a[236:239], a[100:103], a[64:67]
    ds_read_b64_tr_b16 a[226:227], v3 offset:20992
    v_mfma_f32_16x16x32_bf16 a[68:71], a[232:235], a[104:107], a[68:71]
    ds_read_b64_tr_b16 a[228:229], v5 offset:20480
    v_mfma_f32_16x16x32_bf16 a[68:71], a[236:239], a[108:111], a[68:71]
    ds_read_b64_tr_b16 a[230:231], v5 offset:20992
    v_mfma_f32_16x16x32_bf16 a[72:75], a[232:235], a[112:115], a[72:75]
    s_add_u32 m0, s59, 81920
    v_mfma_f32_16x16x32_bf16 a[72:75], a[236:239], a[116:119], a[72:75]
    v_mfma_f32_16x16x32_bf16 a[76:79], a[232:235], a[120:123], a[76:79]
    v_mfma_f32_16x16x32_bf16 a[76:79], a[236:239], a[124:127], a[76:79]
    v_mfma_f32_16x16x32_bf16 a[80:83], a[232:235], a[128:131], a[80:83]
    v_mfma_f32_16x16x32_bf16 a[80:83], a[236:239], a[132:135], a[80:83]
    v_mfma_f32_16x16x32_bf16 a[84:87], a[232:235], a[136:139], a[84:87]
    v_mfma_f32_16x16x32_bf16 a[84:87], a[236:239], a[140:143], a[84:87]
    s_add_u32 s74, s53, 0
    v_mfma_f32_16x16x32_bf16 a[88:91], a[232:235], a[144:147], a[88:91]
    v_mfma_f32_16x16x32_bf16 a[88:91], a[236:239], a[148:151], a[88:91]
    v_mfma_f32_16x16x32_bf16 a[92:95], a[232:235], a[152:155], a[92:95]
    v_mfma_f32_16x16x32_bf16 a[92:95], a[236:239], a[156:159], a[92:95]
    s_waitcnt lgkmcnt(0)
    v_mfma_f32_16x16x32_bf16 v[32:35], a[224:227], a[160:163], v[32:35]
    ds_read_b64_tr_b16 a[232:233], v4 offset:20480
    v_mfma_f32_16x16x32_bf16 v[32:35], a[228:231], a[164:167], v[32:35]
    ds_read_b64_tr_b16 a[234:235], v4 offset:20992
    s_lshl1_add_u32 s71, s47, s45
    s_lshl_b32 s71, s71, 9
    v_mfma_f32_16x16x32_bf16 v[36:39], a[224:227], a[168:171], v[36:39]
    ds_read_b64_tr_b16 a[236:237], v6 offset:20480
    buffer_load_dwordx4 v9, s[24:27], s74 offen lds
    v_mfma_f32_16x16x32_bf16 v[36:39], a[228:231], a[172:175], v[36:39]
    ds_read_b64_tr_b16 a[238:239], v6 offset:20992
    s_lshr_b32 s70, s71, 1
    v_mfma_f32_16x16x32_bf16 v[40:43], a[224:227], a[176:179], v[40:43]
    s_add_u32 s70, s70, 34095104
    v_and_b32 v26, 48, v0
    v_mfma_f32_16x16x32_bf16 v[40:43], a[228:231], a[180:183], v[40:43]
    buffer_load_dwordx4 a[128:131], v26, s[20:23], s70 offen sc1
    v_mfma_f32_16x16x32_bf16 v[44:47], a[224:227], a[184:187], v[44:47]
    v_mfma_f32_16x16x32_bf16 v[44:47], a[228:231], a[188:191], v[44:47]
    v_mfma_f32_16x16x32_bf16 v[48:51], a[224:227], a[192:195], v[48:51]
    v_mfma_f32_16x16x32_bf16 v[48:51], a[228:231], a[196:199], v[48:51]
    v_mfma_f32_16x16x32_bf16 v[52:55], a[224:227], a[200:203], v[52:55]
    buffer_load_dwordx4 v10, s[24:27], s74 offen offset:1024 lds
    v_mfma_f32_16x16x32_bf16 v[52:55], a[228:231], a[204:207], v[52:55]
    v_mfma_f32_16x16x32_bf16 v[56:59], a[224:227], a[208:211], v[56:59]
    v_mfma_f32_16x16x32_bf16 v[56:59], a[228:231], a[212:215], v[56:59]
    buffer_load_dwordx4 a[132:135], v26, s[20:23], s70 offen offset:64 sc1
    v_mfma_f32_16x16x32_bf16 v[60:63], a[224:227], a[216:219], v[60:63]
    v_mfma_f32_16x16x32_bf16 v[60:63], a[228:231], a[220:223], v[60:63]
    s_waitcnt lgkmcnt(0)
    v_mfma_f32_16x16x32_bf16 v[64:67], a[232:235], a[160:163], v[64:67]
    ds_read_b64_tr_b16 a[224:225], v3 offset:24576
    v_mfma_f32_16x16x32_bf16 v[64:67], a[236:239], a[164:167], v[64:67]
    ds_read_b64_tr_b16 a[226:227], v3 offset:25088
    v_mfma_f32_16x16x32_bf16 v[68:71], a[232:235], a[168:171], v[68:71]
    ds_read_b64_tr_b16 a[228:229], v5 offset:24576
    buffer_load_dwordx4 v11, s[24:27], s74 offen offset:2048 lds
    v_mfma_f32_16x16x32_bf16 v[68:71], a[236:239], a[172:175], v[68:71]
    ds_read_b64_tr_b16 a[230:231], v5 offset:25088
    v_mfma_f32_16x16x32_bf16 v[72:75], a[232:235], a[176:179], v[72:75]
    v_mfma_f32_16x16x32_bf16 v[72:75], a[236:239], a[180:183], v[72:75]
    buffer_load_dwordx4 a[136:139], v26, s[20:23], s70 offen offset:128 sc1
    v_mfma_f32_16x16x32_bf16 v[76:79], a[232:235], a[184:187], v[76:79]
    v_mfma_f32_16x16x32_bf16 v[76:79], a[236:239], a[188:191], v[76:79]
    v_mfma_f32_16x16x32_bf16 v[80:83], a[232:235], a[192:195], v[80:83]
    v_mfma_f32_16x16x32_bf16 v[80:83], a[236:239], a[196:199], v[80:83]
    v_mfma_f32_16x16x32_bf16 v[84:87], a[232:235], a[200:203], v[84:87]
    buffer_load_dwordx4 v12, s[24:27], s74 offen offset:3072 lds
    v_mfma_f32_16x16x32_bf16 v[84:87], a[236:239], a[204:207], v[84:87]
    v_mfma_f32_16x16x32_bf16 v[88:91], a[232:235], a[208:211], v[88:91]
    v_mfma_f32_16x16x32_bf16 v[88:91], a[236:239], a[212:215], v[88:91]
    buffer_load_dwordx4 a[140:143], v26, s[20:23], s70 offen offset:192 sc1
    v_and_b32 v2, 0xf0, v13
    v_lshlrev_b32 v2, 1, v2
    v_mfma_f32_16x16x32_bf16 v[92:95], a[232:235], a[216:219], v[92:95]
    s_add_u32 m0, s59, 98304
    v_lshrrev_b32 v1, 1, v13
    s_waitcnt vmcnt(15)
    v_add_f32 v28, v28, v14
    v_add_f32 v29, v29, v15
    v_mfma_f32_16x16x32_bf16 v[92:95], a[236:239], a[220:223], v[92:95]
    v_add_f32 v30, v30, v16
    s_waitcnt lgkmcnt(0)
    v_mfma_f32_16x16x32_bf16 v[96:99], a[160:163], a[224:227], v[96:99]
    ds_read_b64_tr_b16 a[232:233], v4 offset:24576
    v_add_f32 v31, v31, v17
    s_waitcnt vmcnt(14)
    v_add_f32 v28, v28, v18
    v_add_f32 v29, v29, v19
    v_mfma_f32_16x16x32_bf16 v[96:99], a[164:167], a[228:231], v[96:99]
    ds_read_b64_tr_b16 a[234:235], v4 offset:25088
    v_add_f32 v30, v30, v20
    v_mfma_f32_16x16x32_bf16 v[100:103], a[168:171], a[224:227], v[100:103]
    ds_read_b64_tr_b16 a[236:237], v6 offset:24576
    v_add_f32 v31, v31, v21
    s_waitcnt vmcnt(13)
    v_add_f32 v28, v28, v22
    v_add_f32 v29, v29, v23
    v_mfma_f32_16x16x32_bf16 v[100:103], a[172:175], a[228:231], v[100:103]
    ds_read_b64_tr_b16 a[238:239], v6 offset:25088
    v_add_f32 v30, v30, v24
    v_mfma_f32_16x16x32_bf16 v[104:107], a[176:179], a[224:227], v[104:107]
    v_add_f32 v31, v31, v25
    s_add_u32 s70, s71, 34086912
    v_mfma_f32_16x16x32_bf16 v[104:107], a[180:183], a[228:231], v[104:107]
    s_add_u32 s74, s53, 131072
    buffer_load_dwordx4 v[14:17], v2, s[20:23], s70 offen sc1
    v_mfma_f32_16x16x32_bf16 v[108:111], a[184:187], a[224:227], v[108:111]
    v_mfma_f32_16x16x32_bf16 v[108:111], a[188:191], a[228:231], v[108:111]
    v_mfma_f32_16x16x32_bf16 v[112:115], a[192:195], a[224:227], v[112:115]
    buffer_load_dwordx4 v[18:21], v2, s[20:23], s70 offen offset:16 sc1
    s_waitcnt vmcnt(14)
    v_accvgpr_read_b32 v26, a240
    v_add_f32 v28, v28, v26
    v_accvgpr_read_b32 v26, a241
    v_mfma_f32_16x16x32_bf16 v[112:115], a[196:199], a[228:231], v[112:115]
    v_add_f32 v29, v29, v26
    v_accvgpr_read_b32 v26, a242
    v_add_f32 v30, v30, v26
    v_accvgpr_read_b32 v26, a243
    v_mfma_f32_16x16x32_bf16 v[116:119], a[200:203], a[224:227], v[116:119]
    v_add_f32 v31, v31, v26
    s_lshl1_add_u32 s70, s71, 34111488
    v_mfma_f32_16x16x32_bf16 v[116:119], a[204:207], a[228:231], v[116:119]
    buffer_load_dwordx2 a[240:241], v1, s[20:23], s70 offen sc1
    buffer_load_dwordx2 a[242:243], v1, s[20:23], s70 offen offset:512 sc1
    s_waitcnt vmcnt(15)
    v_accvgpr_read_b32 v26, a244
    v_mfma_f32_16x16x32_bf16 v[120:123], a[208:211], a[224:227], v[120:123]
    buffer_load_dwordx4 v9, s[24:27], s74 offen lds
    v_add_f32 v28, v28, v26
    v_accvgpr_read_b32 v26, a245
    v_add_f32 v29, v29, v26
    v_mfma_f32_16x16x32_bf16 v[120:123], a[212:215], a[228:231], v[120:123]
    v_accvgpr_read_b32 v26, a246
    v_add_f32 v30, v30, v26
    v_accvgpr_read_b32 v26, a247
    v_add_f32 v31, v31, v26
    v_mfma_f32_16x16x32_bf16 v[124:127], a[216:219], a[224:227], v[124:127]
    s_waitcnt vmcnt(15)
    v_accvgpr_read_b32 v26, a248
    v_add_f32 v28, v28, v26
    v_accvgpr_read_b32 v26, a249
    v_add_f32 v29, v29, v26
    v_mfma_f32_16x16x32_bf16 v[124:127], a[220:223], a[228:231], v[124:127]
    v_accvgpr_read_b32 v26, a250
    s_waitcnt lgkmcnt(0)
    v_mfma_f32_16x16x32_bf16 v[128:131], a[160:163], a[232:235], v[128:131]
    ds_read_b64_tr_b16 a[224:225], v3 offset:28672
    v_add_f32 v30, v30, v26
    v_accvgpr_read_b32 v26, a251
    v_add_f32 v31, v31, v26
    v_mfma_f32_16x16x32_bf16 v[128:131], a[164:167], a[236:239], v[128:131]
    ds_read_b64_tr_b16 a[226:227], v3 offset:29184
    s_waitcnt vmcnt(14)
    v_accvgpr_read_b32 v26, a252
    v_mfma_f32_16x16x32_bf16 v[132:135], a[168:171], a[232:235], v[132:135]
    ds_read_b64_tr_b16 a[228:229], v5 offset:28672
    v_add_f32 v28, v28, v26
    v_accvgpr_read_b32 v26, a253
    v_add_f32 v29, v29, v26
    v_mfma_f32_16x16x32_bf16 v[132:135], a[172:175], a[236:239], v[132:135]
    ds_read_b64_tr_b16 a[230:231], v5 offset:29184
    v_accvgpr_read_b32 v26, a254
    v_mfma_f32_16x16x32_bf16 v[136:139], a[176:179], a[232:235], v[136:139]
    buffer_load_dwordx4 v10, s[24:27], s74 offen offset:1024 lds
    v_add_f32 v30, v30, v26
    v_accvgpr_read_b32 v26, a255
    v_add_f32 v31, v31, v26
    v_mfma_f32_16x16x32_bf16 v[136:139], a[180:183], a[236:239], v[136:139]
    v_cvt_pk_bf16_f32 v26, v28, v28
    v_lshlrev_b32 v26, 16, v26
    v_sub_f32 v26, v28, v26
    v_cvt_pk_bf16_f32 v28, v28, v26
    v_mfma_f32_16x16x32_bf16 v[140:143], a[184:187], a[232:235], v[140:143]
    v_cvt_pk_bf16_f32 v26, v29, v29
    v_lshlrev_b32 v26, 16, v26
    v_sub_f32 v26, v29, v26
    v_cvt_pk_bf16_f32 v29, v29, v26
    v_mfma_f32_16x16x32_bf16 v[140:143], a[188:191], a[236:239], v[140:143]
    v_cvt_pk_bf16_f32 v26, v30, v30
    v_lshlrev_b32 v26, 16, v26
    v_sub_f32 v26, v30, v26
    v_cvt_pk_bf16_f32 v30, v30, v26
    v_mfma_f32_16x16x32_bf16 v[144:147], a[192:195], a[232:235], v[144:147]
    v_cvt_pk_bf16_f32 v26, v31, v31
    v_lshlrev_b32 v26, 16, v26
    v_sub_f32 v26, v31, v26
    v_cvt_pk_bf16_f32 v31, v31, v26
    v_mfma_f32_16x16x32_bf16 v[144:147], a[196:199], a[236:239], v[144:147]
    s_lshl_b32 s70, s46, 10
    v_mfma_f32_16x16x32_bf16 v[148:151], a[200:203], a[232:235], v[148:151]
    s_add_u32 s71, s70, 151552
    v_lshrrev_b32 v2, 1, v2
    v_mfma_f32_16x16x32_bf16 v[148:151], a[204:207], a[236:239], v[148:151]
    v_add_u32 v2, s71, v2
    v_mfma_f32_16x16x32_bf16 v[152:155], a[208:211], a[232:235], v[152:155]
    buffer_load_dwordx4 v11, s[24:27], s74 offen offset:2048 lds
    s_lshl_b32 s70, s44, 10
    v_mfma_f32_16x16x32_bf16 v[152:155], a[212:215], a[236:239], v[152:155]
    s_add_u32 s71, s70, 151552
    v_add_u32 v26, s71, v13
    v_mfma_f32_16x16x32_bf16 v[156:159], a[216:219], a[232:235], v[156:159]
    ds_write_b128 v26, v[28:31]
    v_mfma_f32_16x16x32_bf16 v[156:159], a[220:223], a[236:239], v[156:159]
    s_lshl_b32 s70, s46, 11
    s_waitcnt lgkmcnt(1)
    v_mfma_f32_16x16x32_bf16 v[160:163], a[224:227], a[160:163], v[160:163]
L_pad0_7:
    s_cbranch_execz L_pad0_11
    ds_read_b64_tr_b16 a[232:233], v4 offset:28672
    v_mfma_f32_16x16x32_bf16 v[160:163], a[228:231], a[164:167], v[160:163]
    ds_read_b64_tr_b16 a[234:235], v4 offset:29184
    v_mfma_f32_16x16x32_bf16 v[164:167], a[224:227], a[168:171], v[164:167]
    ds_read_b64_tr_b16 a[236:237], v6 offset:28672
    v_mfma_f32_16x16x32_bf16 v[164:167], a[228:231], a[172:175], v[164:167]
    ds_read_b64_tr_b16 a[238:239], v6 offset:29184
    v_mfma_f32_16x16x32_bf16 v[168:171], a[224:227], a[176:179], v[168:171]
    buffer_load_dwordx4 v12, s[24:27], s74 offen offset:3072 lds
    v_mfma_f32_16x16x32_bf16 v[168:171], a[228:231], a[180:183], v[168:171]
    v_mfma_f32_16x16x32_bf16 v[172:175], a[224:227], a[184:187], v[172:175]
    v_mfma_f32_16x16x32_bf16 v[172:175], a[228:231], a[188:191], v[172:175]
    v_mfma_f32_16x16x32_bf16 v[176:179], a[224:227], a[192:195], v[176:179]
    s_add_u32 m0, s59, 114688
    v_mfma_f32_16x16x32_bf16 v[176:179], a[228:231], a[196:199], v[176:179]
    v_mfma_f32_16x16x32_bf16 v[180:183], a[224:227], a[200:203], v[180:183]
    v_mfma_f32_16x16x32_bf16 v[180:183], a[228:231], a[204:207], v[180:183]
    v_mfma_f32_16x16x32_bf16 v[184:187], a[224:227], a[208:211], v[184:187]
    v_mfma_f32_16x16x32_bf16 v[184:187], a[228:231], a[212:215], v[184:187]
    v_mfma_f32_16x16x32_bf16 v[188:191], a[224:227], a[216:219], v[188:191]
    v_mfma_f32_16x16x32_bf16 v[188:191], a[228:231], a[220:223], v[188:191]
    s_waitcnt lgkmcnt(0)
    s_barrier
    v_mfma_f32_16x16x32_bf16 v[192:195], a[232:235], a[160:163], v[192:195]
    ds_read_b64_tr_b16 a[224:225], v3 offset:32768
    v_mfma_f32_16x16x32_bf16 v[192:195], a[236:239], a[164:167], v[192:195]
    ds_read_b64_tr_b16 a[226:227], v3 offset:33280
    v_mfma_f32_16x16x32_bf16 v[196:199], a[232:235], a[168:171], v[196:199]
    ds_read_b64_tr_b16 a[228:229], v5 offset:32768
    v_mfma_f32_16x16x32_bf16 v[196:199], a[236:239], a[172:175], v[196:199]
    ds_read_b64_tr_b16 a[230:231], v5 offset:33280
    v_mfma_f32_16x16x32_bf16 v[200:203], a[232:235], a[176:179], v[200:203]
    s_add_u32 s74, s53, 262144
    ds_read2st64_b32 a[96:97], v2 offset0:0 offset1:8
    v_mfma_f32_16x16x32_bf16 v[200:203], a[236:239], a[180:183], v[200:203]
    ds_read2st64_b32 a[104:105], v2 offset0:1 offset1:9
    v_mfma_f32_16x16x32_bf16 v[204:207], a[232:235], a[184:187], v[204:207]
    buffer_load_dwordx4 v9, s[24:27], s74 offen lds
    ds_read2st64_b32 a[112:113], v2 offset0:2 offset1:10
    v_mfma_f32_16x16x32_bf16 v[204:207], a[236:239], a[188:191], v[204:207]
    v_add_u32 v2, 4, v2
    v_mfma_f32_16x16x32_bf16 v[208:211], a[232:235], a[192:195], v[208:211]
    v_mfma_f32_16x16x32_bf16 v[208:211], a[236:239], a[196:199], v[208:211]
    ds_read2st64_b32 a[98:99], v2 offset0:0 offset1:8
    v_mfma_f32_16x16x32_bf16 v[212:215], a[232:235], a[200:203], v[212:215]
    ds_read2st64_b32 a[106:107], v2 offset0:1 offset1:9
    v_mfma_f32_16x16x32_bf16 v[212:215], a[236:239], a[204:207], v[212:215]
    ds_read2st64_b32 a[114:115], v2 offset0:2 offset1:10
    v_mfma_f32_16x16x32_bf16 v[216:219], a[232:235], a[208:211], v[216:219]
    v_add_u32 v2, 4, v2
    v_mfma_f32_16x16x32_bf16 v[216:219], a[236:239], a[212:215], v[216:219]
    v_mfma_f32_16x16x32_bf16 v[220:223], a[232:235], a[216:219], v[220:223]
    buffer_load_dwordx4 v10, s[24:27], s74 offen offset:1024 lds
    ds_read2st64_b32 a[100:101], v2 offset0:0 offset1:8
    v_mfma_f32_16x16x32_bf16 v[220:223], a[236:239], a[220:223], v[220:223]
    ds_read2st64_b32 a[108:109], v2 offset0:1 offset1:9
    s_waitcnt lgkmcnt(8)
    v_mfma_f32_16x16x32_bf16 a[0:3], a[224:227], a[160:163], a[0:3]
    ds_read_b64_tr_b16 a[232:233], v4 offset:32768
    v_add_u32 v2, 4, v2
    v_mfma_f32_16x16x32_bf16 a[0:3], a[228:231], a[164:167], a[0:3]
    ds_read_b64_tr_b16 a[234:235], v4 offset:33280
    v_mfma_f32_16x16x32_bf16 a[4:7], a[224:227], a[168:171], a[4:7]
    ds_read_b64_tr_b16 a[236:237], v6 offset:32768
    v_mfma_f32_16x16x32_bf16 a[4:7], a[228:231], a[172:175], a[4:7]
    ds_read_b64_tr_b16 a[238:239], v6 offset:33280
    v_mfma_f32_16x16x32_bf16 a[8:11], a[224:227], a[176:179], a[8:11]
    ds_read2st64_b32 a[102:103], v2 offset0:0 offset1:8
    v_mfma_f32_16x16x32_bf16 a[8:11], a[228:231], a[180:183], a[8:11]
    ds_read2st64_b32 a[110:111], v2 offset0:1 offset1:9
    v_lshrrev_b32 v1, 2, v0
    v_mfma_f32_16x16x32_bf16 a[12:15], a[224:227], a[184:187], a[12:15]
    buffer_load_dwordx4 v11, s[24:27], s74 offen offset:2048 lds
    v_lshlrev_b32 v1, 6, v1
    v_mfma_f32_16x16x32_bf16 a[12:15], a[228:231], a[188:191], a[12:15]
    v_and_b32 v2, 3, v0
    v_mfma_f32_16x16x32_bf16 a[16:19], a[224:227], a[192:195], a[16:19]
    v_lshl_add_u32 v1, v2, 3, v1
    v_mfma_f32_16x16x32_bf16 a[16:19], a[228:231], a[196:199], a[16:19]
    s_add_u32 s70, s70, 147456
    v_mfma_f32_16x16x32_bf16 a[20:23], a[224:227], a[200:203], a[20:23]
    v_add_u32 v1, s70, v1
    v_mfma_f32_16x16x32_bf16 a[20:23], a[228:231], a[204:207], a[20:23]
    v_mfma_f32_16x16x32_bf16 a[24:27], a[224:227], a[208:211], a[24:27]
    v_bfe_u32 v30, v13, 4, 4
    v_lshl_add_u32 v30, v30, 11, s54
    v_mfma_f32_16x16x32_bf16 a[24:27], a[228:231], a[212:215], a[24:27]
    v_bfe_u32 v31, v13, 8, 1
    v_mfma_f32_16x16x32_bf16 a[28:31], a[224:227], a[216:219], a[28:31]
    buffer_load_dwordx4 v12, s[24:27], s74 offen offset:3072 lds
    v_lshl_add_u32 v30, v31, 5, v30
    v_mfma_f32_16x16x32_bf16 a[28:31], a[228:231], a[220:223], a[28:31]
    v_lshrrev_b32 v31, 9, v13
    s_waitcnt lgkmcnt(2)
    v_mfma_f32_16x16x32_bf16 a[32:35], a[232:235], a[160:163], a[32:35]
    ds_read_b64_tr_b16 a[224:225], v7 offset:36864
    v_lshl_add_u32 v30, v31, 4, v30
    v_mfma_f32_16x16x32_bf16 a[32:35], a[236:239], a[164:167], a[32:35]
    ds_read_b64_tr_b16 a[226:227], v7 offset:37120
    s_mov_b32 s75, 32768
    v_mfma_f32_16x16x32_bf16 a[36:39], a[232:235], a[168:171], a[36:39]
    ds_read_b64_tr_b16 a[228:229], v8 offset:36864
    s_add_u32 m0, s59, 131072
    v_mfma_f32_16x16x32_bf16 a[36:39], a[236:239], a[172:175], a[36:39]
    ds_read_b64_tr_b16 a[230:231], v8 offset:37120
    buffer_load_dwordx4 a[144:147], v30, s[4:7], 0 offen
    v_mfma_f32_16x16x32_bf16 a[40:43], a[232:235], a[176:179], a[40:43]
    v_mfma_f32_16x16x32_bf16 a[40:43], a[236:239], a[180:183], a[40:43]
    v_mfma_f32_16x16x32_bf16 a[44:47], a[232:235], a[184:187], a[44:47]
    v_mfma_f32_16x16x32_bf16 a[44:47], a[236:239], a[188:191], a[44:47]
    buffer_load_dwordx4 a[148:151], v30, s[4:7], 0 offen offset:64
    v_mfma_f32_16x16x32_bf16 a[48:51], a[232:235], a[192:195], a[48:51]
    v_mfma_f32_16x16x32_bf16 a[48:51], a[236:239], a[196:199], a[48:51]
    s_add_u32 s74, s53, 393216
    v_mfma_f32_16x16x32_bf16 a[52:55], a[232:235], a[200:203], a[52:55]
    v_mfma_f32_16x16x32_bf16 a[52:55], a[236:239], a[204:207], a[52:55]
    buffer_load_dwordx4 a[152:155], v30, s[4:7], s75 offen
    v_mfma_f32_16x16x32_bf16 a[56:59], a[232:235], a[208:211], a[56:59]
    v_mfma_f32_16x16x32_bf16 a[56:59], a[236:239], a[212:215], a[56:59]
    v_mfma_f32_16x16x32_bf16 a[60:63], a[232:235], a[216:219], a[60:63]
    v_mfma_f32_16x16x32_bf16 a[60:63], a[236:239], a[220:223], a[60:63]
    s_waitcnt lgkmcnt(0)
    v_mfma_f32_16x16x32_bf16 v[224:227], a[224:227], a[160:163], v[224:227]
    ds_read_b64_tr_b16 a[232:233], v7 offset:38912
    buffer_load_dwordx4 v9, s[24:27], s74 offen lds
    v_mfma_f32_16x16x32_bf16 v[224:227], a[228:231], a[164:167], v[224:227]
    ds_read_b64_tr_b16 a[234:235], v7 offset:39168
    v_mfma_f32_16x16x32_bf16 v[228:231], a[224:227], a[168:171], v[228:231]
    ds_read_b64_tr_b16 a[236:237], v8 offset:38912
    v_mfma_f32_16x16x32_bf16 v[228:231], a[228:231], a[172:175], v[228:231]
    ds_read_b64_tr_b16 a[238:239], v8 offset:39168
    v_mfma_f32_16x16x32_bf16 v[232:235], a[224:227], a[176:179], v[232:235]
    buffer_load_dwordx4 a[156:159], v30, s[4:7], s75 offen offset:64
    s_lshl1_add_u32 s70, s47, s45
    s_mul_i32 s70, s70, 16384
    s_lshl_b32 s71, s46, 11
    v_mfma_f32_16x16x32_bf16 v[232:235], a[228:231], a[180:183], v[232:235]
    s_mul_i32 s90, s63, 2048
    s_add_u32 s90, s90, s70
    s_add_u32 s90, s90, s71
    s_and_b32 s71, s51, 1
    v_mfma_f32_16x16x32_bf16 v[236:239], a[224:227], a[184:187], v[236:239]
    s_lshl1_add_u32 s71, s71, s46
    s_lshl_b32 s71, s71, 10
    s_lshr_b32 s91, s65, 7
    s_mul_i32 s91, s91, 262144
    v_mfma_f32_16x16x32_bf16 v[236:239], a[228:231], a[188:191], v[236:239]
    s_add_u32 s91, s91, s70
    s_add_u32 s91, s91, s71
    s_mov_b32 s86, 0x3c0a3963
    s_mov_b32 s88, 0xbf206c99
    v_mfma_f32_16x16x32_bf16 v[240:243], a[224:227], a[192:195], v[240:243]
    buffer_load_dwordx4 v10, s[24:27], s74 offen offset:1024 lds
    s_lshl3_add_u32 s70, s48, s47
    s_lshl1_add_u32 s70, s70, s46
    s_mul_i32 s70, s70, 10240
    s_add_u32 s70, s70, 27262976
    v_mfma_f32_16x16x32_bf16 v[240:243], a[228:231], a[196:199], v[240:243]
    s_mul_i32 s71, s45, 5120
    s_add_u32 s66, s70, s71
    s_xor_b32 s71, s71, 1024
    s_add_u32 s67, s70, s71
    v_mfma_f32_16x16x32_bf16 v[244:247], a[224:227], a[200:203], v[244:247]
    s_lshl_b32 s71, s45, 10
    s_add_u32 s70, s70, s71
    s_add_u32 s68, s70, 8192
    v_mfma_f32_16x16x32_bf16 v[244:247], a[228:231], a[204:207], v[244:247]
    s_waitcnt vmcnt(17)
    v_rcp_f32 v22, v14
    v_mfma_f32_16x16x32_bf16 v[248:251], a[224:227], a[208:211], v[248:251]
    v_rcp_f32 v23, v15
    v_mfma_f32_16x16x32_bf16 v[248:251], a[228:231], a[212:215], v[248:251]
    v_rcp_f32 v24, v16
    v_mfma_f32_16x16x32_bf16 v[252:255], a[224:227], a[216:219], v[252:255]
    v_rcp_f32 v25, v17
    v_mfma_f32_16x16x32_bf16 v[252:255], a[228:231], a[220:223], v[252:255]
    s_waitcnt vmcnt(16)
    v_rcp_f32 v26, v18
    s_waitcnt lgkmcnt(0)
    v_mfma_f32_16x16x32_bf16 a[64:67], a[232:235], a[160:163], a[64:67]
    buffer_load_dwordx4 v11, s[24:27], s74 offen offset:2048 lds
    ds_read_b64_tr_b16 a[244:245], v1
    v_mfma_f32_16x16x32_bf16 a[64:67], a[236:239], a[164:167], a[64:67]
    ds_read_b64_tr_b16 a[246:247], v1 offset:1024
    v_mfma_f32_16x16x32_bf16 a[68:71], a[232:235], a[168:171], a[68:71]
    ds_read_b64_tr_b16 a[248:249], v1 offset:32
    v_mfma_f32_16x16x32_bf16 a[68:71], a[236:239], a[172:175], a[68:71]
    ds_read_b64_tr_b16 a[250:251], v1 offset:1056
    v_mfma_f32_16x16x32_bf16 a[72:75], a[232:235], a[176:179], a[72:75]
    v_rcp_f32 v27, v19
    v_mfma_f32_16x16x32_bf16 a[72:75], a[236:239], a[180:183], a[72:75]
    v_rcp_f32 v28, v20
    v_mfma_f32_16x16x32_bf16 a[76:79], a[232:235], a[184:187], a[76:79]
    v_rcp_f32 v29, v21
    v_mul_f32 v22, 0xc0135761, v22
    v_mfma_f32_16x16x32_bf16 a[76:79], a[236:239], a[188:191], a[76:79]
    v_mul_f32 v14, v14, v14
    v_mul_f32 v23, 0xc0135761, v23
    v_mul_f32 v15, v15, v15
    v_mul_f32 v24, 0xc0135761, v24
    v_mfma_f32_16x16x32_bf16 a[80:83], a[232:235], a[192:195], a[80:83]
    buffer_load_dwordx4 v12, s[24:27], s74 offen offset:3072 lds
    v_mul_f32 v16, v16, v16
    v_mul_f32 v25, 0xc0135761, v25
    v_mul_f32 v17, v17, v17
    v_mul_f32 v26, 0xc0135761, v26
    v_mfma_f32_16x16x32_bf16 a[80:83], a[236:239], a[196:199], a[80:83]
    v_mul_f32 v18, v18, v18
    v_mul_f32 v27, 0xc0135761, v27
    v_mfma_f32_16x16x32_bf16 a[84:87], a[232:235], a[200:203], a[84:87]
    v_mul_f32 v19, v19, v19
    v_mfma_f32_16x16x32_bf16 a[84:87], a[236:239], a[204:207], a[84:87]
    v_mul_f32 v28, 0xc0135761, v28
    v_mfma_f32_16x16x32_bf16 a[88:91], a[232:235], a[208:211], a[88:91]
    v_mul_f32 v20, v20, v20
    v_mfma_f32_16x16x32_bf16 a[88:91], a[236:239], a[212:215], a[88:91]
    v_mul_f32 v29, 0xc0135761, v29
    v_mfma_f32_16x16x32_bf16 a[92:95], a[232:235], a[216:219], a[92:95]
    v_mul_f32 v21, v21, v21
    v_mfma_f32_16x16x32_bf16 a[92:95], a[236:239], a[220:223], a[92:95]
    s_waitcnt vmcnt(17)
    v_mfma_f32_16x16x4_4b_bf16 v[32:47], a[96:97], a[240:241], v[32:47]
    v_mfma_f32_16x16x4_4b_bf16 v[64:79], a[98:99], a[240:241], v[64:79]
    v_and_b32 v2, 15, v0
    v_lshrrev_b32 v3, 4, v0
    v_bfe_u32 v8, v0, 1, 2
    v_xor_b32 v8, v8, v3
    v_lshlrev_b32 v8, 4, v8
    v_lshl_add_u32 v8, v2, 6, v8
    s_waitcnt vmcnt(16)
    v_mfma_f32_16x16x4_4b_bf16 v[48:63], a[96:97], a[242:243], v[48:63]
    v_and_b32 v2, 3, v0
    v_bfe_u32 v3, v0, 3, 2
    v_xor_b32 v2, v2, v3
    v_lshrrev_b32 v3, 2, v0
    v_lshlrev_b32 v3, 6, v3
    v_lshl_add_u32 v1, v2, 4, v3
    v_mfma_f32_16x16x4_4b_bf16 v[80:95], a[98:99], a[242:243], v[80:95]
    s_add_u32 s70, s59, 147456
    v_add_u32 v8, s70, v8
    v_add_u32 v1, s70, v1
    s_mov_b32 s72, 0xbede652a
    v_cvt_pk_bf16_f32 v32, v32, v33
    v_cvt_pk_bf16_f32 v33, v34, v35
    v_mfma_f32_16x16x4_4b_bf16 v[96:111], a[240:241], a[100:101], v[96:111]
    v_cvt_pk_bf16_f32 v34, v64, v65
    v_cvt_pk_bf16_f32 v35, v66, v67
    v_cvt_pk_bf16_f32 v36, v36, v37
    v_cvt_pk_bf16_f32 v37, v38, v39
    v_cvt_pk_bf16_f32 v38, v68, v69
    v_cvt_pk_bf16_f32 v39, v70, v71
    v_mfma_f32_16x16x4_4b_bf16 v[128:143], a[240:241], a[102:103], v[128:143]
    v_cvt_pk_bf16_f32 v40, v40, v41
    v_cvt_pk_bf16_f32 v41, v42, v43
    v_cvt_pk_bf16_f32 v42, v72, v73
    v_cvt_pk_bf16_f32 v43, v74, v75
    v_cvt_pk_bf16_f32 v44, v44, v45
    v_cvt_pk_bf16_f32 v45, v46, v47
    v_mfma_f32_16x16x4_4b_bf16 v[112:127], a[242:243], a[100:101], v[112:127]
    v_cvt_pk_bf16_f32 v46, v76, v77
    v_cvt_pk_bf16_f32 v47, v78, v79
    v_cvt_pk_bf16_f32 v48, v48, v49
    v_mfma_f32_16x16x4_4b_bf16 v[144:159], a[242:243], a[102:103], v[144:159]
    v_cvt_pk_bf16_f32 v49, v50, v51
    v_cvt_pk_bf16_f32 v50, v80, v81
    v_cvt_pk_bf16_f32 v51, v82, v83
    v_cvt_pk_bf16_f32 v52, v52, v53
    v_cvt_pk_bf16_f32 v53, v54, v55
    v_cvt_pk_bf16_f32 v54, v84, v85
    v_cvt_pk_bf16_f32 v55, v86, v87
    v_cvt_pk_bf16_f32 v56, v56, v57
    v_cvt_pk_bf16_f32 v57, v58, v59
    v_cvt_pk_bf16_f32 v58, v88, v89
    v_cvt_pk_bf16_f32 v59, v90, v91
    v_cvt_pk_bf16_f32 v60, v60, v61
    v_cvt_pk_bf16_f32 v61, v62, v63
    v_cvt_pk_bf16_f32 v62, v92, v93
    v_cvt_pk_bf16_f32 v63, v94, v95
    s_waitcnt lgkmcnt(2)
    v_mfma_f32_16x16x32_bf16 v[64:67], a[244:247], v[32:35], 0
    v_cvt_pk_bf16_f32 v96, v96, v97
    s_waitcnt lgkmcnt(0)
    v_mfma_f32_16x16x32_bf16 v[68:71], a[248:251], v[32:35], 0
    v_cvt_pk_bf16_f32 v97, v98, v99
    v_mfma_f32_16x16x32_bf16 v[72:75], a[244:247], v[36:39], 0
    v_cvt_pk_bf16_f32 v98, v100, v101
    v_mfma_f32_16x16x32_bf16 v[76:79], a[248:251], v[36:39], 0
    v_cvt_pk_bf16_f32 v99, v102, v103
    v_cvt_pk_bf16_f32 v100, v128, v129
    v_cvt_pk_bf16_f32 v101, v130, v131
    v_cvt_pk_bf16_f32 v102, v132, v133
    v_cvt_pk_bf16_f32 v103, v134, v135
    v_cvt_pk_bf16_f32 v104, v104, v105
    v_cvt_pk_bf16_f32 v105, v106, v107
    v_cvt_pk_bf16_f32 v106, v108, v109
    v_cvt_pk_bf16_f32 v107, v110, v111
    v_cvt_pk_bf16_f32 v108, v136, v137
    v_cvt_pk_bf16_f32 v109, v138, v139
    v_cvt_pk_bf16_f32 v110, v140, v141
    v_cvt_pk_bf16_f32 v111, v142, v143
    v_cvt_pk_bf16_f32 v112, v112, v113
    v_cvt_pk_bf16_f32 v113, v114, v115
    v_cvt_pk_bf16_f32 v114, v116, v117
    v_cvt_pk_bf16_f32 v115, v118, v119
    s_mul_i32 s70, s45, 1032
    v_add_u32_e64 v36, s70, v1
    v_mfma_f32_16x16x4_4b_bf16 v[160:175], a[104:105], a[240:241], v[160:175]
    v_max3_f32 v4, v64, v65, v66
    v_max3_f32 v6, -v64, -v65, -v66
    v_max3_f32 v5, v72, v73, v74
    v_max3_f32 v7, -v72, -v73, -v74
    v_max3_f32 v4, v4, v67, v68
    v_max3_f32 v6, v6, -v67, -v68
    v_mfma_f32_16x16x4_4b_bf16 v[192:207], a[106:107], a[240:241], v[192:207]
    v_max3_f32 v5, v5, v75, v76
    v_max3_f32 v7, v7, -v75, -v76
    v_max3_f32 v4, v4, v69, v70
    v_max3_f32 v6, v6, -v69, -v70
    v_max3_f32 v5, v5, v77, v78
    v_max3_f32 v7, v7, -v77, -v78
    v_mfma_f32_16x16x4_4b_bf16 a[0:15], a[108:109], a[240:241], a[0:15]
    v_max_f32_e64 v4, v4, v71
    v_max_f32_e64 v6, v6, -v71
    v_max_f32_e64 v5, v5, v79
    v_max_f32_e64 v7, v7, -v79
    v_cvt_pk_bf16_f32 v116, v144, v145
    v_permlane32_swap_b32 v4, v5
    v_mfma_f32_16x16x4_4b_bf16 a[32:47], a[110:111], a[240:241], a[32:47]
    v_permlane32_swap_b32 v6, v7
    v_max_f32 v4, v4, v5
    v_max_f32 v6, v6, v7
    v_cvt_pk_bf16_f32 v117, v146, v147
    v_cvt_pk_bf16_f32 v118, v148, v149
    v_permlane16_swap_b32 v4, v6
    v_mfma_f32_16x16x4_4b_bf16 v[224:239], a[112:113], a[240:241], v[224:239]
    v_max_f32 v4, v4, v6
    v_mov_b32 v6, v4
    v_cvt_pk_bf16_f32 v119, v150, v151
    v_cvt_pk_bf16_f32 v120, v120, v121
    v_permlane16_swap_b32 v4, v6
    v_mov_b32 v5, v4
    v_mov_b32 v7, v6
    v_cvt_pk_bf16_f32 v121, v122, v123
    v_permlane32_swap_b32 v4, v5
    v_permlane32_swap_b32 v6, v7
    v_cvt_pk_bf16_f32 v122, v124, v125
    v_cvt_pk_bf16_f32 v123, v126, v127
    v_cvt_pk_bf16_f32 v124, v152, v153
    v_cvt_pk_bf16_f32 v125, v154, v155
    v_cvt_pk_bf16_f32 v126, v156, v157
    v_cvt_pk_bf16_f32 v127, v158, v159
    v_xor_b32 v37, 8, v36
    v_xor_b32 v38, 1024, v36
    v_xor_b32 v39, 1032, v36
    s_waitcnt lgkmcnt(0)
    s_barrier
    s_nop 0
    v_pk_mul_f32 v[30:31], v[22:23], s[88:89] op_sel_hi:[1,0]
    v_pk_mul_f32 v[32:33], v[22:23], s[72:73] op_sel_hi:[1,0]
    v_pk_mul_f32 v[4:5], v[4:5], v[30:31] neg_lo:[1,0] neg_hi:[1,0]
    v_pk_mul_f32 v[6:7], v[6:7], v[30:31] neg_lo:[1,0] neg_hi:[1,0]
    v_pk_fma_f32 v[128:129], v[64:65], v[30:31], v[4:5] op_sel:[0,0,0] op_sel_hi:[1,0,0]
    v_pk_fma_f32 v[130:131], v[66:67], v[30:31], v[4:5] op_sel:[0,0,0] op_sel_hi:[1,0,0]
    v_pk_fma_f32 v[132:133], v[68:69], v[30:31], v[4:5] op_sel:[0,0,0] op_sel_hi:[1,0,0]
    v_pk_fma_f32 v[134:135], v[70:71], v[30:31], v[4:5] op_sel:[0,0,0] op_sel_hi:[1,0,0]
    v_pk_fma_f32 v[136:137], v[72:73], v[30:31], v[4:5] op_sel:[0,1,1] op_sel_hi:[1,1,1]
    v_pk_fma_f32 v[138:139], v[74:75], v[30:31], v[4:5] op_sel:[0,1,1] op_sel_hi:[1,1,1]
    v_pk_fma_f32 v[140:141], v[76:77], v[30:31], v[4:5] op_sel:[0,1,1] op_sel_hi:[1,1,1]
    v_pk_fma_f32 v[142:143], v[78:79], v[30:31], v[4:5] op_sel:[0,1,1] op_sel_hi:[1,1,1]
    v_pk_fma_f32 v[64:65], v[64:65], v[30:31], v[6:7] op_sel:[0,0,0] op_sel_hi:[1,0,0] neg_lo:[1,0,0] neg_hi:[1,0,0]
    v_pk_fma_f32 v[66:67], v[66:67], v[30:31], v[6:7] op_sel:[0,0,0] op_sel_hi:[1,0,0] neg_lo:[1,0,0] neg_hi:[1,0,0]
    v_pk_fma_f32 v[68:69], v[68:69], v[30:31], v[6:7] op_sel:[0,0,0] op_sel_hi:[1,0,0] neg_lo:[1,0,0] neg_hi:[1,0,0]
    v_pk_fma_f32 v[70:71], v[70:71], v[30:31], v[6:7] op_sel:[0,0,0] op_sel_hi:[1,0,0] neg_lo:[1,0,0] neg_hi:[1,0,0]
    v_pk_fma_f32 v[72:73], v[72:73], v[30:31], v[6:7] op_sel:[0,1,1] op_sel_hi:[1,1,1] neg_lo:[1,0,0] neg_hi:[1,0,0]
    v_pk_fma_f32 v[74:75], v[74:75], v[30:31], v[6:7] op_sel:[0,1,1] op_sel_hi:[1,1,1] neg_lo:[1,0,0] neg_hi:[1,0,0]
    v_pk_fma_f32 v[76:77], v[76:77], v[30:31], v[6:7] op_sel:[0,1,1] op_sel_hi:[1,1,1] neg_lo:[1,0,0] neg_hi:[1,0,0]
    v_pk_fma_f32 v[78:79], v[78:79], v[30:31], v[6:7] op_sel:[0,1,1] op_sel_hi:[1,1,1] neg_lo:[1,0,0] neg_hi:[1,0,0]
    v_exp_f32 v128, v128
    v_exp_f32 v129, v129
    v_mfma_f32_16x16x32_bf16 v[80:83], a[244:247], v[40:43], 0
    s_add_u32 m0, s59, 0
    s_add_u32 s74, s53, 524288
    buffer_load_dwordx4 v9, s[24:27], s74 offen lds
    v_exp_f32 v130, v130
    v_exp_f32 v131, v131
    v_exp_f32 v132, v132
    v_exp_f32 v133, v133
    v_exp_f32 v134, v134
    v_mfma_f32_16x16x32_bf16 v[84:87], a[248:251], v[40:43], 0
    buffer_load_dwordx4 v10, s[24:27], s74 offen offset:1024 lds
    v_exp_f32 v135, v135
    v_exp_f32 v136, v136
    v_exp_f32 v137, v137
    v_exp_f32 v138, v138
    v_exp_f32 v139, v139
    v_mfma_f32_16x16x32_bf16 v[88:91], a[244:247], v[44:47], 0
    buffer_load_dwordx4 v11, s[24:27], s74 offen offset:2048 lds
    v_exp_f32 v140, v140
    v_exp_f32 v141, v141
    v_exp_f32 v142, v142
    v_exp_f32 v143, v143
    v_exp_f32 v64, v64
    v_mfma_f32_16x16x32_bf16 v[92:95], a[248:251], v[44:47], 0
    buffer_load_dwordx4 v12, s[24:27], s74 offen offset:3072 lds
    v_exp_f32 v65, v65
    v_exp_f32 v66, v66
    v_exp_f32 v67, v67
    v_exp_f32 v68, v68
    v_exp_f32 v69, v69
    v_mfma_f32_16x16x4_4b_bf16 a[64:79], a[114:115], a[240:241], a[64:79]
    v_exp_f32 v70, v70
    v_exp_f32 v71, v71
    v_exp_f32 v72, v72
    v_exp_f32 v73, v73
    v_exp_f32 v74, v74
    v_exp_f32 v75, v75
    v_exp_f32 v76, v76
    v_exp_f32 v77, v77
    v_exp_f32 v78, v78
    v_exp_f32_e64 v79, v79
    v_pk_add_f32 v[0:1], v[128:129], v[130:131]
    v_pk_add_f32 v[2:3], v[136:137], v[138:139]
    v_pk_add_f32 v[4:5], v[64:65], v[66:67]
    v_pk_add_f32 v[6:7], v[72:73], v[74:75]
    v_pk_add_f32 v[0:1], v[0:1], v[132:133]
    v_pk_add_f32 v[2:3], v[2:3], v[140:141]
    v_pk_add_f32 v[4:5], v[4:5], v[68:69]
    v_pk_add_f32 v[6:7], v[6:7], v[76:77]
    v_pk_add_f32 v[0:1], v[0:1], v[134:135]
    v_pk_add_f32 v[2:3], v[2:3], v[142:143]
    v_pk_add_f32 v[4:5], v[4:5], v[70:71]
    v_pk_add_f32 v[6:7], v[6:7], v[78:79]
    v_add_f32 v0, v0, v1
    v_add_f32 v1, v2, v3
    v_add_f32 v2, v4, v5
    v_add_f32 v3, v6, v7
    v_permlane32_swap_b32 v0, v1
    v_max3_f32 v4, v80, v81, v82
    v_permlane32_swap_b32 v2, v3
    v_add_f32 v0, v0, v1
    v_add_f32 v2, v2, v3
    v_max3_f32 v6, -v80, -v81, -v82
    v_max3_f32 v5, v88, v89, v90
    v_permlane16_swap_b32 v0, v2
    v_add_f32 v0, v0, v2
    v_rcp_f32 v0, v0
    v_max3_f32 v7, -v88, -v89, -v90
    v_mov_b32 v2, v0
    v_max3_f32 v4, v4, v83, v84
    v_max3_f32 v6, v6, -v83, -v84
    v_permlane16_swap_b32 v0, v2
    v_mov_b32 v1, v0
    v_mov_b32 v3, v2
    v_max3_f32 v5, v5, v91, v92
    v_permlane32_swap_b32 v0, v1
    v_permlane32_swap_b32_e64 v2, v3
    v_max3_f32 v7, v7, -v91, -v92
    v_max3_f32 v4, v4, v85, v86
    v_max3_f32 v6, v6, -v85, -v86
    v_max3_f32 v5, v5, v93, v94
    v_max3_f32 v7, v7, -v93, -v94
    v_max_f32_e64 v4, v4, v87
    v_max_f32_e64 v6, v6, -v87
    v_max_f32_e64 v5, v5, v95
    v_max_f32_e64 v7, v7, -v95
    v_pk_mul_f32 v[0:1], v[0:1], v[32:33]
    v_permlane32_swap_b32 v4, v5
    v_permlane32_swap_b32 v6, v7
    v_max_f32 v4, v4, v5
    v_max_f32 v6, v6, v7
    v_pk_mul_f32 v[2:3], v[2:3], v[32:33]
    v_pk_mul_f32 v[128:129], v[128:129], v[0:1] op_sel:[0,0] op_sel_hi:[1,0]
    v_permlane16_swap_b32 v4, v6
    v_max_f32 v4, v4, v6
    v_mov_b32 v6, v4
    v_pk_mul_f32 v[130:131], v[130:131], v[0:1] op_sel:[0,0] op_sel_hi:[1,0]
    v_pk_mul_f32 v[132:133], v[132:133], v[0:1] op_sel:[0,0] op_sel_hi:[1,0]
    v_permlane16_swap_b32 v4, v6
    v_mov_b32 v5, v4
    v_mov_b32 v7, v6
    v_pk_mul_f32 v[134:135], v[134:135], v[0:1] op_sel:[0,0] op_sel_hi:[1,0]
    v_permlane32_swap_b32 v4, v5
    v_permlane32_swap_b32 v6, v7
    v_cvt_pk_bf16_f32 v128, v128, v129
    v_cvt_pk_bf16_f32 v129, v130, v131
    v_cvt_pk_bf16_f32 v130, v132, v133
    v_cvt_pk_bf16_f32 v131, v134, v135
    ds_write_b128 v8, v[128:131]
    v_pk_mul_f32 v[136:137], v[136:137], v[0:1] op_sel:[0,1] op_sel_hi:[1,1]
    v_pk_mul_f32 v[138:139], v[138:139], v[0:1] op_sel:[0,1] op_sel_hi:[1,1]
    v_pk_mul_f32 v[140:141], v[140:141], v[0:1] op_sel:[0,1] op_sel_hi:[1,1]
    v_pk_mul_f32 v[142:143], v[142:143], v[0:1] op_sel:[0,1] op_sel_hi:[1,1]
    v_cvt_pk_bf16_f32 v136, v136, v137
    v_cvt_pk_bf16_f32 v137, v138, v139
    v_cvt_pk_bf16_f32 v138, v140, v141
    v_cvt_pk_bf16_f32 v139, v142, v143
    ds_write_b128 v8, v[136:139] offset:2048
    v_pk_mul_f32 v[64:65], v[64:65], v[2:3] op_sel:[0,0] op_sel_hi:[1,0]
    v_pk_mul_f32 v[66:67], v[66:67], v[2:3] op_sel:[0,0] op_sel_hi:[1,0]
    v_pk_mul_f32 v[68:69], v[68:69], v[2:3] op_sel:[0,0] op_sel_hi:[1,0]
    v_pk_mul_f32 v[70:71], v[70:71], v[2:3] op_sel:[0,0] op_sel_hi:[1,0]
    v_cvt_pk_bf16_f32 v64, v64, v65
    v_cvt_pk_bf16_f32 v65, v66, v67
    v_cvt_pk_bf16_f32 v66, v68, v69
    v_cvt_pk_bf16_f32 v67, v70, v71
    ds_write_b128 v8, v[64:67] offset:1024
    v_pk_mul_f32 v[72:73], v[72:73], v[2:3] op_sel:[0,1] op_sel_hi:[1,1]
    v_pk_mul_f32 v[74:75], v[74:75], v[2:3] op_sel:[0,1] op_sel_hi:[1,1]
    v_pk_mul_f32 v[76:77], v[76:77], v[2:3] op_sel:[0,1] op_sel_hi:[1,1]
    v_pk_mul_f32 v[78:79], v[78:79], v[2:3] op_sel:[0,1] op_sel_hi:[1,1]
    v_cvt_pk_bf16_f32 v72, v72, v73
    v_cvt_pk_bf16_f32 v73, v74, v75
    v_cvt_pk_bf16_f32 v74, v76, v77
    v_cvt_pk_bf16_f32 v75, v78, v79
    ds_write_b128 v8, v[72:75] offset:3072
    v_pk_mul_f32 v[30:31], v[24:25], s[88:89] op_sel_hi:[1,0]
    v_pk_mul_f32 v[32:33], v[24:25], s[72:73] op_sel_hi:[1,0]
    v_pk_mul_f32 v[4:5], v[4:5], v[30:31] neg_lo:[1,0] neg_hi:[1,0]
    v_pk_mul_f32 v[6:7], v[6:7], v[30:31] neg_lo:[1,0] neg_hi:[1,0]
    v_pk_fma_f32 v[128:129], v[80:81], v[30:31], v[4:5] op_sel:[0,0,0] op_sel_hi:[1,0,0]
    v_pk_fma_f32 v[130:131], v[82:83], v[30:31], v[4:5] op_sel:[0,0,0] op_sel_hi:[1,0,0]
    v_pk_fma_f32 v[132:133], v[84:85], v[30:31], v[4:5] op_sel:[0,0,0] op_sel_hi:[1,0,0]
    v_pk_fma_f32 v[134:135], v[86:87], v[30:31], v[4:5] op_sel:[0,0,0] op_sel_hi:[1,0,0]
    v_pk_fma_f32 v[136:137], v[88:89], v[30:31], v[4:5] op_sel:[0,1,1] op_sel_hi:[1,1,1]
    v_pk_fma_f32 v[138:139], v[90:91], v[30:31], v[4:5] op_sel:[0,1,1] op_sel_hi:[1,1,1]
    v_pk_fma_f32 v[140:141], v[92:93], v[30:31], v[4:5] op_sel:[0,1,1] op_sel_hi:[1,1,1]
    v_pk_fma_f32 v[142:143], v[94:95], v[30:31], v[4:5] op_sel:[0,1,1] op_sel_hi:[1,1,1]
    v_pk_fma_f32 v[80:81], v[80:81], v[30:31], v[6:7] op_sel:[0,0,0] op_sel_hi:[1,0,0] neg_lo:[1,0,0] neg_hi:[1,0,0]
    v_pk_fma_f32 v[82:83], v[82:83], v[30:31], v[6:7] op_sel:[0,0,0] op_sel_hi:[1,0,0] neg_lo:[1,0,0] neg_hi:[1,0,0]
    v_pk_fma_f32 v[84:85], v[84:85], v[30:31], v[6:7] op_sel:[0,0,0] op_sel_hi:[1,0,0] neg_lo:[1,0,0] neg_hi:[1,0,0]
    v_pk_fma_f32 v[86:87], v[86:87], v[30:31], v[6:7] op_sel:[0,0,0] op_sel_hi:[1,0,0] neg_lo:[1,0,0] neg_hi:[1,0,0]
    v_pk_fma_f32 v[88:89], v[88:89], v[30:31], v[6:7] op_sel:[0,1,1] op_sel_hi:[1,1,1] neg_lo:[1,0,0] neg_hi:[1,0,0]
    v_pk_fma_f32 v[90:91], v[90:91], v[30:31], v[6:7] op_sel:[0,1,1] op_sel_hi:[1,1,1] neg_lo:[1,0,0] neg_hi:[1,0,0]
    v_pk_fma_f32 v[92:93], v[92:93], v[30:31], v[6:7] op_sel:[0,1,1] op_sel_hi:[1,1,1] neg_lo:[1,0,0] neg_hi:[1,0,0]
    v_pk_fma_f32 v[94:95], v[94:95], v[30:31], v[6:7] op_sel:[0,1,1] op_sel_hi:[1,1,1] neg_lo:[1,0,0] neg_hi:[1,0,0]
    v_exp_f32 v128, v128
    v_exp_f32 v129, v129
    v_mfma_f32_16x16x32_bf16 v[64:67], a[244:247], v[48:51], 0
    ds_read_b64_tr_b16 a[200:201], v38
    v_exp_f32 v130, v130
    v_mfma_f32_16x16x32_bf16 v[68:71], a[248:251], v[48:51], 0
    ds_read_b64_tr_b16 a[202:203], v38 offset:2048
    v_exp_f32 v131, v131
    v_mfma_f32_16x16x32_bf16 v[72:75], a[244:247], v[52:55], 0
    ds_read_b64_tr_b16 a[204:205], v39
    v_exp_f32 v132, v132
    v_mfma_f32_16x16x32_bf16 v[76:79], a[248:251], v[52:55], 0
    ds_read_b64_tr_b16 a[206:207], v39 offset:2048
    v_exp_f32 v133, v133
    v_exp_f32 v134, v134
    v_exp_f32 v135, v135
    v_exp_f32 v136, v136
    s_waitcnt lgkmcnt(2)
    v_mfma_f32_16x16x32_bf16 a[160:163], a[200:203], v[96:99], 0
    ds_read_b64_tr_b16 a[192:193], v36
    v_exp_f32 v137, v137
    v_mfma_f32_16x16x32_bf16 a[168:171], a[200:203], v[100:103], 0
    ds_read_b64_tr_b16 a[194:195], v36 offset:2048
    v_exp_f32 v138, v138
    v_mfma_f32_16x16x32_bf16 v[152:155], a[200:203], a[128:131], 0
    ds_read_b64_tr_b16 a[196:197], v37
    v_exp_f32 v139, v139
    s_waitcnt lgkmcnt(3)
    v_mfma_f32_16x16x32_bf16 a[164:167], a[204:207], v[96:99], 0
    ds_read_b64_tr_b16 a[198:199], v37 offset:2048
    v_exp_f32 v140, v140
    v_mfma_f32_16x16x32_bf16 a[172:175], a[204:207], v[100:103], 0
    v_exp_f32 v141, v141
    v_mfma_f32_16x16x32_bf16 v[156:159], a[204:207], a[128:131], 0
    s_add_u32 m0, s59, 16384
    s_add_u32 s74, s53, 655360
    buffer_load_dwordx4 v9, s[24:27], s74 offen lds
    v_exp_f32 v142, v142
    s_waitcnt lgkmcnt(2)
    v_mfma_f32_16x16x32_bf16 v[40:43], a[192:195], v[96:99], 0
    v_exp_f32 v143, v143
    v_mfma_f32_16x16x32_bf16 v[48:51], a[192:195], v[100:103], 0
    buffer_load_dwordx4 v10, s[24:27], s74 offen offset:1024 lds
    v_exp_f32 v80, v80
    v_mfma_f32_16x16x32_bf16 v[144:147], a[192:195], a[128:131], 0
    v_exp_f32 v81, v81
    s_waitcnt lgkmcnt(0)
    v_mfma_f32_16x16x32_bf16 v[44:47], a[196:199], v[96:99], 0
    buffer_load_dwordx4 v11, s[24:27], s74 offen offset:2048 lds
    v_exp_f32 v82, v82
    v_mfma_f32_16x16x32_bf16 v[52:55], a[196:199], v[100:103], 0
    v_exp_f32 v83, v83
    v_mfma_f32_16x16x32_bf16 v[148:151], a[196:199], a[128:131], 0
    buffer_load_dwordx4 v12, s[24:27], s74 offen offset:3072 lds
    v_exp_f32 v84, v84
    v_exp_f32 v85, v85
    v_exp_f32 v86, v86
    v_exp_f32 v87, v87
    v_exp_f32 v88, v88
    v_exp_f32 v89, v89
L_pad0_8:
    s_cbranch_execz L_pad0_12
    v_exp_f32 v90, v90
    v_exp_f32 v91, v91
    v_exp_f32 v92, v92
    v_exp_f32 v93, v93
    v_exp_f32 v94, v94
    v_exp_f32_e64 v95, v95
    v_pk_add_f32 v[0:1], v[128:129], v[130:131]
    v_pk_add_f32 v[2:3], v[136:137], v[138:139]
    v_pk_add_f32 v[4:5], v[80:81], v[82:83]
    v_pk_add_f32 v[6:7], v[88:89], v[90:91]
    v_pk_add_f32 v[0:1], v[0:1], v[132:133]
    v_pk_add_f32 v[2:3], v[2:3], v[140:141]
    v_pk_add_f32 v[4:5], v[4:5], v[84:85]
    v_pk_add_f32 v[6:7], v[6:7], v[92:93]
    v_pk_add_f32 v[0:1], v[0:1], v[134:135]
    v_pk_add_f32 v[2:3], v[2:3], v[142:143]
    v_pk_add_f32 v[4:5], v[4:5], v[86:87]
    v_pk_add_f32 v[6:7], v[6:7], v[94:95]
    v_add_f32 v0, v0, v1
    v_add_f32 v1, v2, v3
    v_add_f32 v2, v4, v5
    v_add_f32 v3, v6, v7
    v_permlane32_swap_b32 v0, v1
    v_max3_f32 v4, v64, v65, v66
    v_permlane32_swap_b32 v2, v3
    v_add_f32 v0, v0, v1
    v_add_f32 v2, v2, v3
    v_max3_f32 v6, -v64, -v65, -v66
    v_max3_f32 v5, v72, v73, v74
    v_permlane16_swap_b32 v0, v2
    v_add_f32 v0, v0, v2
    v_rcp_f32 v0, v0
    v_max3_f32 v7, -v72, -v73, -v74
    v_mov_b32 v2, v0
    v_max3_f32 v4, v4, v67, v68
    v_max3_f32 v6, v6, -v67, -v68
    v_permlane16_swap_b32 v0, v2
    v_mov_b32 v1, v0
    v_mov_b32 v3, v2
    v_max3_f32 v5, v5, v75, v76
    v_permlane32_swap_b32 v0, v1
    v_permlane32_swap_b32_e64 v2, v3
    v_max3_f32 v7, v7, -v75, -v76
    v_max3_f32 v4, v4, v69, v70
    v_max3_f32 v6, v6, -v69, -v70
    v_max3_f32 v5, v5, v77, v78
    v_max3_f32 v7, v7, -v77, -v78
    v_max_f32_e64 v4, v4, v71
    v_max_f32_e64 v6, v6, -v71
    v_max_f32_e64 v5, v5, v79
    v_max_f32_e64 v7, v7, -v79
    v_pk_mul_f32 v[0:1], v[0:1], v[32:33]
    v_permlane32_swap_b32 v4, v5
    v_permlane32_swap_b32 v6, v7
    v_max_f32 v4, v4, v5
    v_max_f32 v6, v6, v7
    v_pk_mul_f32 v[2:3], v[2:3], v[32:33]
    v_pk_mul_f32 v[128:129], v[128:129], v[0:1] op_sel:[0,0] op_sel_hi:[1,0]
    v_permlane16_swap_b32 v4, v6
    v_max_f32 v4, v4, v6
    v_mov_b32 v6, v4
    v_pk_mul_f32 v[130:131], v[130:131], v[0:1] op_sel:[0,0] op_sel_hi:[1,0]
    v_pk_mul_f32 v[132:133], v[132:133], v[0:1] op_sel:[0,0] op_sel_hi:[1,0]
    v_permlane16_swap_b32 v4, v6
    v_mov_b32 v5, v4
    v_mov_b32 v7, v6
    v_pk_mul_f32 v[134:135], v[134:135], v[0:1] op_sel:[0,0] op_sel_hi:[1,0]
    v_permlane32_swap_b32 v4, v5
    v_permlane32_swap_b32 v6, v7
    v_cvt_pk_bf16_f32 v128, v128, v129
    v_cvt_pk_bf16_f32 v129, v130, v131
    v_cvt_pk_bf16_f32 v130, v132, v133
    v_cvt_pk_bf16_f32 v131, v134, v135
    ds_write_b128 v8, v[128:131]
    v_pk_mul_f32 v[136:137], v[136:137], v[0:1] op_sel:[0,1] op_sel_hi:[1,1]
    v_pk_mul_f32 v[138:139], v[138:139], v[0:1] op_sel:[0,1] op_sel_hi:[1,1]
    v_pk_mul_f32 v[140:141], v[140:141], v[0:1] op_sel:[0,1] op_sel_hi:[1,1]
    v_pk_mul_f32 v[142:143], v[142:143], v[0:1] op_sel:[0,1] op_sel_hi:[1,1]
    v_cvt_pk_bf16_f32 v136, v136, v137
    v_cvt_pk_bf16_f32 v137, v138, v139
    v_cvt_pk_bf16_f32 v138, v140, v141
    v_cvt_pk_bf16_f32 v139, v142, v143
    ds_write_b128 v8, v[136:139] offset:2048
    v_pk_mul_f32 v[80:81], v[80:81], v[2:3] op_sel:[0,0] op_sel_hi:[1,0]
    v_pk_mul_f32 v[82:83], v[82:83], v[2:3] op_sel:[0,0] op_sel_hi:[1,0]
    v_pk_mul_f32 v[84:85], v[84:85], v[2:3] op_sel:[0,0] op_sel_hi:[1,0]
    v_pk_mul_f32 v[86:87], v[86:87], v[2:3] op_sel:[0,0] op_sel_hi:[1,0]
    v_cvt_pk_bf16_f32 v80, v80, v81
    v_cvt_pk_bf16_f32 v81, v82, v83
    v_cvt_pk_bf16_f32 v82, v84, v85
    v_cvt_pk_bf16_f32 v83, v86, v87
    ds_write_b128 v8, v[80:83] offset:1024
    v_pk_mul_f32 v[88:89], v[88:89], v[2:3] op_sel:[0,1] op_sel_hi:[1,1]
    v_pk_mul_f32 v[90:91], v[90:91], v[2:3] op_sel:[0,1] op_sel_hi:[1,1]
    v_pk_mul_f32 v[92:93], v[92:93], v[2:3] op_sel:[0,1] op_sel_hi:[1,1]
    v_pk_mul_f32 v[94:95], v[94:95], v[2:3] op_sel:[0,1] op_sel_hi:[1,1]
    v_cvt_pk_bf16_f32 v88, v88, v89
    v_cvt_pk_bf16_f32 v89, v90, v91
    v_cvt_pk_bf16_f32 v90, v92, v93
    v_cvt_pk_bf16_f32 v91, v94, v95
    ds_write_b128 v8, v[88:91] offset:3072
    v_pk_mul_f32 v[30:31], v[26:27], s[88:89] op_sel_hi:[1,0]
    v_pk_mul_f32 v[32:33], v[26:27], s[72:73] op_sel_hi:[1,0]
    v_pk_mul_f32 v[4:5], v[4:5], v[30:31] neg_lo:[1,0] neg_hi:[1,0]
    v_pk_mul_f32 v[6:7], v[6:7], v[30:31] neg_lo:[1,0] neg_hi:[1,0]
    v_pk_fma_f32 v[128:129], v[64:65], v[30:31], v[4:5] op_sel:[0,0,0] op_sel_hi:[1,0,0]
    v_pk_fma_f32 v[130:131], v[66:67], v[30:31], v[4:5] op_sel:[0,0,0] op_sel_hi:[1,0,0]
    v_pk_fma_f32 v[132:133], v[68:69], v[30:31], v[4:5] op_sel:[0,0,0] op_sel_hi:[1,0,0]
    v_pk_fma_f32 v[134:135], v[70:71], v[30:31], v[4:5] op_sel:[0,0,0] op_sel_hi:[1,0,0]
    v_pk_fma_f32 v[136:137], v[72:73], v[30:31], v[4:5] op_sel:[0,1,1] op_sel_hi:[1,1,1]
    v_pk_fma_f32 v[138:139], v[74:75], v[30:31], v[4:5] op_sel:[0,1,1] op_sel_hi:[1,1,1]
    v_pk_fma_f32 v[140:141], v[76:77], v[30:31], v[4:5] op_sel:[0,1,1] op_sel_hi:[1,1,1]
    v_pk_fma_f32 v[142:143], v[78:79], v[30:31], v[4:5] op_sel:[0,1,1] op_sel_hi:[1,1,1]
    v_pk_fma_f32 v[64:65], v[64:65], v[30:31], v[6:7] op_sel:[0,0,0] op_sel_hi:[1,0,0] neg_lo:[1,0,0] neg_hi:[1,0,0]
    v_pk_fma_f32 v[66:67], v[66:67], v[30:31], v[6:7] op_sel:[0,0,0] op_sel_hi:[1,0,0] neg_lo:[1,0,0] neg_hi:[1,0,0]
    v_pk_fma_f32 v[68:69], v[68:69], v[30:31], v[6:7] op_sel:[0,0,0] op_sel_hi:[1,0,0] neg_lo:[1,0,0] neg_hi:[1,0,0]
    v_pk_fma_f32 v[70:71], v[70:71], v[30:31], v[6:7] op_sel:[0,0,0] op_sel_hi:[1,0,0] neg_lo:[1,0,0] neg_hi:[1,0,0]
    v_pk_fma_f32 v[72:73], v[72:73], v[30:31], v[6:7] op_sel:[0,1,1] op_sel_hi:[1,1,1] neg_lo:[1,0,0] neg_hi:[1,0,0]
    v_pk_fma_f32 v[74:75], v[74:75], v[30:31], v[6:7] op_sel:[0,1,1] op_sel_hi:[1,1,1] neg_lo:[1,0,0] neg_hi:[1,0,0]
    v_pk_fma_f32 v[76:77], v[76:77], v[30:31], v[6:7] op_sel:[0,1,1] op_sel_hi:[1,1,1] neg_lo:[1,0,0] neg_hi:[1,0,0]
    v_pk_fma_f32 v[78:79], v[78:79], v[30:31], v[6:7] op_sel:[0,1,1] op_sel_hi:[1,1,1] neg_lo:[1,0,0] neg_hi:[1,0,0]
    v_exp_f32 v128, v128
    v_exp_f32 v129, v129
    v_mfma_f32_16x16x32_bf16 v[80:83], a[244:247], v[56:59], 0
    ds_read_b64_tr_b16 a[200:201], v38
    v_exp_f32 v130, v130
    v_mfma_f32_16x16x32_bf16 v[84:87], a[248:251], v[56:59], 0
    ds_read_b64_tr_b16 a[202:203], v38 offset:2048
    v_exp_f32 v131, v131
    v_mfma_f32_16x16x32_bf16 v[88:91], a[244:247], v[60:63], 0
    ds_read_b64_tr_b16 a[204:205], v39
    v_exp_f32 v132, v132
    v_mfma_f32_16x16x32_bf16 v[92:95], a[248:251], v[60:63], 0
    ds_read_b64_tr_b16 a[206:207], v39 offset:2048
    v_exp_f32 v133, v133
    v_exp_f32 v134, v134
    v_exp_f32 v135, v135
    v_exp_f32 v136, v136
    s_waitcnt lgkmcnt(2)
    v_mfma_f32_16x16x32_bf16 a[160:163], a[200:203], v[104:107], a[160:163]
    ds_read_b64_tr_b16 a[192:193], v36
    v_exp_f32 v137, v137
    v_mfma_f32_16x16x32_bf16 a[168:171], a[200:203], v[108:111], a[168:171]
    ds_read_b64_tr_b16 a[194:195], v36 offset:2048
    v_exp_f32 v138, v138
    v_mfma_f32_16x16x32_bf16 v[152:155], a[200:203], a[132:135], v[152:155]
    ds_read_b64_tr_b16 a[196:197], v37
    v_exp_f32 v139, v139
    s_waitcnt lgkmcnt(3)
    v_mfma_f32_16x16x32_bf16 a[164:167], a[204:207], v[104:107], a[164:167]
    ds_read_b64_tr_b16 a[198:199], v37 offset:2048
    v_exp_f32 v140, v140
    v_mfma_f32_16x16x32_bf16 a[172:175], a[204:207], v[108:111], a[172:175]
    v_exp_f32 v141, v141
    v_mfma_f32_16x16x32_bf16 v[156:159], a[204:207], a[132:135], v[156:159]
    s_add_u32 m0, s59, 32768
    s_add_u32 s74, s53, 786432
    buffer_load_dwordx4 v9, s[24:27], s74 offen lds
    v_exp_f32 v142, v142
    s_waitcnt lgkmcnt(2)
    v_mfma_f32_16x16x32_bf16 v[40:43], a[192:195], v[104:107], v[40:43]
    v_exp_f32 v143, v143
    v_mfma_f32_16x16x32_bf16 v[48:51], a[192:195], v[108:111], v[48:51]
    buffer_load_dwordx4 v10, s[24:27], s74 offen offset:1024 lds
    v_exp_f32 v64, v64
    v_mfma_f32_16x16x32_bf16 v[144:147], a[192:195], a[132:135], v[144:147]
    v_exp_f32 v65, v65
    s_waitcnt lgkmcnt(0)
    v_mfma_f32_16x16x32_bf16 v[44:47], a[196:199], v[104:107], v[44:47]
    buffer_load_dwordx4 v11, s[24:27], s74 offen offset:2048 lds
    v_exp_f32 v66, v66
    v_mfma_f32_16x16x32_bf16 v[52:55], a[196:199], v[108:111], v[52:55]
    v_exp_f32 v67, v67
    v_mfma_f32_16x16x32_bf16 v[148:151], a[196:199], a[132:135], v[148:151]
    buffer_load_dwordx4 v12, s[24:27], s74 offen offset:3072 lds
    v_exp_f32 v68, v68
    v_exp_f32 v69, v69
    v_exp_f32 v70, v70
    v_exp_f32 v71, v71
    v_exp_f32 v72, v72
    v_exp_f32 v73, v73
    v_exp_f32 v74, v74
    v_exp_f32 v75, v75
    v_exp_f32 v76, v76
    v_exp_f32 v77, v77
    v_exp_f32 v78, v78
    v_exp_f32 v79, v79
    v_pk_add_f32 v[0:1], v[128:129], v[130:131]
    v_pk_add_f32 v[2:3], v[136:137], v[138:139]
    v_pk_add_f32 v[4:5], v[64:65], v[66:67]
    v_pk_add_f32 v[6:7], v[72:73], v[74:75]
    v_pk_add_f32 v[0:1], v[0:1], v[132:133]
    v_pk_add_f32 v[2:3], v[2:3], v[140:141]
    v_pk_add_f32 v[4:5], v[4:5], v[68:69]
    v_pk_add_f32 v[6:7], v[6:7], v[76:77]
    v_pk_add_f32 v[0:1], v[0:1], v[134:135]
    v_pk_add_f32 v[2:3], v[2:3], v[142:143]
    v_pk_add_f32 v[4:5], v[4:5], v[70:71]
    v_pk_add_f32 v[6:7], v[6:7], v[78:79]
    v_add_f32 v0, v0, v1
    v_add_f32 v1, v2, v3
    v_add_f32 v2, v4, v5
    v_add_f32 v3, v6, v7
    v_permlane32_swap_b32 v0, v1
    v_max3_f32 v4, v80, v81, v82
    v_permlane32_swap_b32 v2, v3
    v_add_f32 v0, v0, v1
    v_add_f32 v2, v2, v3
    v_max3_f32 v6, -v80, -v81, -v82
    v_max3_f32 v5, v88, v89, v90
    v_permlane16_swap_b32 v0, v2
    v_add_f32 v0, v0, v2
    v_rcp_f32 v0, v0
    v_max3_f32 v7, -v88, -v89, -v90
    v_mov_b32 v2, v0
    v_max3_f32 v4, v4, v83, v84
    v_max3_f32 v6, v6, -v83, -v84
    v_permlane16_swap_b32 v0, v2
    v_mov_b32 v1, v0
    v_mov_b32 v3, v2
    v_max3_f32 v5, v5, v91, v92
    v_permlane32_swap_b32 v0, v1
    v_permlane32_swap_b32_e64 v2, v3
    v_max3_f32 v7, v7, -v91, -v92
    v_max3_f32 v4, v4, v85, v86
    v_max3_f32 v6, v6, -v85, -v86
    v_max3_f32 v5, v5, v93, v94
    v_max3_f32 v7, v7, -v93, -v94
    v_max_f32_e64 v4, v4, v87
    v_max_f32_e64 v6, v6, -v87
    v_max_f32_e64 v5, v5, v95
    v_max_f32_e64 v7, v7, -v95
    v_pk_mul_f32 v[0:1], v[0:1], v[32:33]
    v_permlane32_swap_b32 v4, v5
    v_permlane32_swap_b32 v6, v7
    v_max_f32 v4, v4, v5
    v_max_f32 v6, v6, v7
    v_pk_mul_f32 v[2:3], v[2:3], v[32:33]
    v_pk_mul_f32 v[128:129], v[128:129], v[0:1] op_sel:[0,0] op_sel_hi:[1,0]
    v_permlane16_swap_b32 v4, v6
    v_max_f32 v4, v4, v6
    v_mov_b32 v6, v4
    v_pk_mul_f32 v[130:131], v[130:131], v[0:1] op_sel:[0,0] op_sel_hi:[1,0]
    v_pk_mul_f32 v[132:133], v[132:133], v[0:1] op_sel:[0,0] op_sel_hi:[1,0]
    v_permlane16_swap_b32 v4, v6
    v_mov_b32 v5, v4
    v_mov_b32 v7, v6
    v_pk_mul_f32 v[134:135], v[134:135], v[0:1] op_sel:[0,0] op_sel_hi:[1,0]
    v_permlane32_swap_b32 v4, v5
    v_permlane32_swap_b32 v6, v7
    v_cvt_pk_bf16_f32 v128, v128, v129
    v_cvt_pk_bf16_f32 v129, v130, v131
    v_cvt_pk_bf16_f32 v130, v132, v133
    v_cvt_pk_bf16_f32 v131, v134, v135
    ds_write_b128 v8, v[128:131]
    v_pk_mul_f32 v[136:137], v[136:137], v[0:1] op_sel:[0,1] op_sel_hi:[1,1]
    v_pk_mul_f32 v[138:139], v[138:139], v[0:1] op_sel:[0,1] op_sel_hi:[1,1]
    v_pk_mul_f32 v[140:141], v[140:141], v[0:1] op_sel:[0,1] op_sel_hi:[1,1]
    v_pk_mul_f32 v[142:143], v[142:143], v[0:1] op_sel:[0,1] op_sel_hi:[1,1]
    v_cvt_pk_bf16_f32 v136, v136, v137
    v_cvt_pk_bf16_f32 v137, v138, v139
    v_cvt_pk_bf16_f32 v138, v140, v141
    v_cvt_pk_bf16_f32 v139, v142, v143
    ds_write_b128 v8, v[136:139] offset:2048
    v_pk_mul_f32 v[64:65], v[64:65], v[2:3] op_sel:[0,0] op_sel_hi:[1,0]
    v_pk_mul_f32 v[66:67], v[66:67], v[2:3] op_sel:[0,0] op_sel_hi:[1,0]
    v_pk_mul_f32 v[68:69], v[68:69], v[2:3] op_sel:[0,0] op_sel_hi:[1,0]
    v_pk_mul_f32 v[70:71], v[70:71], v[2:3] op_sel:[0,0] op_sel_hi:[1,0]
    v_cvt_pk_bf16_f32 v64, v64, v65
    v_cvt_pk_bf16_f32 v65, v66, v67
    v_cvt_pk_bf16_f32 v66, v68, v69
    v_cvt_pk_bf16_f32 v67, v70, v71
    ds_write_b128 v8, v[64:67] offset:1024
    v_pk_mul_f32 v[72:73], v[72:73], v[2:3] op_sel:[0,1] op_sel_hi:[1,1]
    v_pk_mul_f32 v[74:75], v[74:75], v[2:3] op_sel:[0,1] op_sel_hi:[1,1]
    v_pk_mul_f32 v[76:77], v[76:77], v[2:3] op_sel:[0,1] op_sel_hi:[1,1]
    v_pk_mul_f32 v[78:79], v[78:79], v[2:3] op_sel:[0,1] op_sel_hi:[1,1]
    v_cvt_pk_bf16_f32 v72, v72, v73
    v_cvt_pk_bf16_f32 v73, v74, v75
    v_cvt_pk_bf16_f32 v74, v76, v77
    v_cvt_pk_bf16_f32 v75, v78, v79
    ds_write_b128 v8, v[72:75] offset:3072
    v_pk_mul_f32 v[30:31], v[28:29], s[88:89] op_sel_hi:[1,0]
    v_pk_mul_f32 v[32:33], v[28:29], s[72:73] op_sel_hi:[1,0]
    v_pk_mul_f32 v[4:5], v[4:5], v[30:31] neg_lo:[1,0] neg_hi:[1,0]
    v_pk_mul_f32 v[6:7], v[6:7], v[30:31] neg_lo:[1,0] neg_hi:[1,0]
    v_pk_fma_f32 v[128:129], v[80:81], v[30:31], v[4:5] op_sel:[0,0,0] op_sel_hi:[1,0,0]
    v_pk_fma_f32 v[130:131], v[82:83], v[30:31], v[4:5] op_sel:[0,0,0] op_sel_hi:[1,0,0]
    v_pk_fma_f32 v[132:133], v[84:85], v[30:31], v[4:5] op_sel:[0,0,0] op_sel_hi:[1,0,0]
    v_pk_fma_f32 v[134:135], v[86:87], v[30:31], v[4:5] op_sel:[0,0,0] op_sel_hi:[1,0,0]
    v_pk_fma_f32 v[136:137], v[88:89], v[30:31], v[4:5] op_sel:[0,1,1] op_sel_hi:[1,1,1]
    v_pk_fma_f32 v[138:139], v[90:91], v[30:31], v[4:5] op_sel:[0,1,1] op_sel_hi:[1,1,1]
    v_pk_fma_f32 v[140:141], v[92:93], v[30:31], v[4:5] op_sel:[0,1,1] op_sel_hi:[1,1,1]
    v_pk_fma_f32 v[142:143], v[94:95], v[30:31], v[4:5] op_sel:[0,1,1] op_sel_hi:[1,1,1]
    v_pk_fma_f32 v[80:81], v[80:81], v[30:31], v[6:7] op_sel:[0,0,0] op_sel_hi:[1,0,0] neg_lo:[1,0,0] neg_hi:[1,0,0]
    v_pk_fma_f32 v[82:83], v[82:83], v[30:31], v[6:7] op_sel:[0,0,0] op_sel_hi:[1,0,0] neg_lo:[1,0,0] neg_hi:[1,0,0]
    v_pk_fma_f32 v[84:85], v[84:85], v[30:31], v[6:7] op_sel:[0,0,0] op_sel_hi:[1,0,0] neg_lo:[1,0,0] neg_hi:[1,0,0]
    v_pk_fma_f32 v[86:87], v[86:87], v[30:31], v[6:7] op_sel:[0,0,0] op_sel_hi:[1,0,0] neg_lo:[1,0,0] neg_hi:[1,0,0]
    v_pk_fma_f32 v[88:89], v[88:89], v[30:31], v[6:7] op_sel:[0,1,1] op_sel_hi:[1,1,1] neg_lo:[1,0,0] neg_hi:[1,0,0]
    v_pk_fma_f32 v[90:91], v[90:91], v[30:31], v[6:7] op_sel:[0,1,1] op_sel_hi:[1,1,1] neg_lo:[1,0,0] neg_hi:[1,0,0]
    v_pk_fma_f32 v[92:93], v[92:93], v[30:31], v[6:7] op_sel:[0,1,1] op_sel_hi:[1,1,1] neg_lo:[1,0,0] neg_hi:[1,0,0]
    v_pk_fma_f32 v[94:95], v[94:95], v[30:31], v[6:7] op_sel:[0,1,1] op_sel_hi:[1,1,1] neg_lo:[1,0,0] neg_hi:[1,0,0]
    ds_read_b64_tr_b16 a[200:201], v38
    ds_read_b64_tr_b16 a[202:203], v38 offset:2048
    ds_read_b64_tr_b16 a[204:205], v39
    ds_read_b64_tr_b16 a[206:207], v39 offset:2048
    v_exp_f32 v128, v128
    v_exp_f32 v129, v129
    v_exp_f32 v130, v130
    v_exp_f32 v131, v131
    v_exp_f32 v132, v132
    v_exp_f32 v133, v133
    v_exp_f32 v134, v134
    s_waitcnt lgkmcnt(2)
    v_mfma_f32_16x16x32_bf16 a[160:163], a[200:203], v[112:115], a[160:163]
    ds_read_b64_tr_b16 a[192:193], v36
    v_exp_f32 v135, v135
    v_mfma_f32_16x16x32_bf16 a[168:171], a[200:203], v[116:119], a[168:171]
    ds_read_b64_tr_b16 a[194:195], v36 offset:2048
    v_exp_f32 v136, v136
    v_mfma_f32_16x16x32_bf16 v[152:155], a[200:203], a[136:139], v[152:155]
    ds_read_b64_tr_b16 a[196:197], v37
    v_exp_f32 v137, v137
    s_waitcnt lgkmcnt(3)
    v_mfma_f32_16x16x32_bf16 a[164:167], a[204:207], v[112:115], a[164:167]
    ds_read_b64_tr_b16 a[198:199], v37 offset:2048
    v_exp_f32 v138, v138
    v_mfma_f32_16x16x32_bf16 a[172:175], a[204:207], v[116:119], a[172:175]
    v_exp_f32 v139, v139
    v_mfma_f32_16x16x32_bf16 v[156:159], a[204:207], a[136:139], v[156:159]
    s_add_u32 m0, s59, 49152
    s_add_u32 s74, s53, 917504
    buffer_load_dwordx4 v9, s[24:27], s74 offen lds
    v_exp_f32 v140, v140
    s_waitcnt lgkmcnt(2)
    v_mfma_f32_16x16x32_bf16 v[40:43], a[192:195], v[112:115], v[40:43]
    v_exp_f32 v141, v141
    v_mfma_f32_16x16x32_bf16 v[48:51], a[192:195], v[116:119], v[48:51]
    buffer_load_dwordx4 v10, s[24:27], s74 offen offset:1024 lds
    v_exp_f32 v142, v142
    v_mfma_f32_16x16x32_bf16 v[144:147], a[192:195], a[136:139], v[144:147]
    v_exp_f32 v143, v143
    s_waitcnt lgkmcnt(0)
    v_mfma_f32_16x16x32_bf16 v[44:47], a[196:199], v[112:115], v[44:47]
    buffer_load_dwordx4 v11, s[24:27], s74 offen offset:2048 lds
    v_exp_f32 v80, v80
    v_mfma_f32_16x16x32_bf16 v[52:55], a[196:199], v[116:119], v[52:55]
    v_exp_f32 v81, v81
    v_mfma_f32_16x16x32_bf16 v[148:151], a[196:199], a[136:139], v[148:151]
    buffer_load_dwordx4 v12, s[24:27], s74 offen offset:3072 lds
    v_exp_f32 v82, v82
    v_exp_f32 v83, v83
    v_exp_f32 v84, v84
    v_exp_f32 v85, v85
    v_exp_f32 v86, v86
    v_exp_f32 v87, v87
    v_exp_f32 v88, v88
    v_exp_f32 v89, v89
    v_exp_f32 v90, v90
    v_exp_f32 v91, v91
    v_exp_f32 v92, v92
    v_exp_f32 v93, v93
    v_exp_f32 v94, v94
    v_exp_f32 v95, v95
    v_pk_add_f32 v[0:1], v[128:129], v[130:131]
    v_pk_add_f32 v[2:3], v[136:137], v[138:139]
    v_pk_add_f32 v[4:5], v[80:81], v[82:83]
    v_pk_add_f32 v[6:7], v[88:89], v[90:91]
    v_pk_add_f32 v[0:1], v[0:1], v[132:133]
    v_pk_add_f32 v[2:3], v[2:3], v[140:141]
    v_pk_add_f32 v[4:5], v[4:5], v[84:85]
    v_pk_add_f32 v[6:7], v[6:7], v[92:93]
    v_pk_add_f32 v[0:1], v[0:1], v[134:135]
    v_pk_add_f32 v[2:3], v[2:3], v[142:143]
    v_pk_add_f32 v[4:5], v[4:5], v[86:87]
    v_pk_add_f32 v[6:7], v[6:7], v[94:95]
    v_add_f32 v0, v0, v1
    v_add_f32 v1, v2, v3
    v_add_f32 v2, v4, v5
    v_add_f32 v3, v6, v7
    v_permlane32_swap_b32 v0, v1
    s_nop 0
    v_permlane32_swap_b32 v2, v3
    v_add_f32 v0, v0, v1
    v_add_f32 v2, v2, v3
    s_nop 1
    v_permlane16_swap_b32 v0, v2
    v_add_f32 v0, v0, v2
    v_rcp_f32 v0, v0
    s_nop 0
    v_mov_b32 v2, v0
    s_nop 1
    v_permlane16_swap_b32 v0, v2
    v_mov_b32 v1, v0
    v_mov_b32 v3, v2
    s_nop 0
    v_permlane32_swap_b32 v0, v1
    v_permlane32_swap_b32 v2, v3
    v_pk_mul_f32 v[0:1], v[0:1], v[32:33]
    v_pk_mul_f32 v[2:3], v[2:3], v[32:33]
    v_pk_mul_f32 v[128:129], v[128:129], v[0:1] op_sel:[0,0] op_sel_hi:[1,0]
    v_pk_mul_f32 v[130:131], v[130:131], v[0:1] op_sel:[0,0] op_sel_hi:[1,0]
    v_pk_mul_f32 v[132:133], v[132:133], v[0:1] op_sel:[0,0] op_sel_hi:[1,0]
    v_pk_mul_f32 v[134:135], v[134:135], v[0:1] op_sel:[0,0] op_sel_hi:[1,0]
    v_cvt_pk_bf16_f32 v128, v128, v129
    v_cvt_pk_bf16_f32 v129, v130, v131
    v_cvt_pk_bf16_f32 v130, v132, v133
    v_cvt_pk_bf16_f32 v131, v134, v135
    ds_write_b128 v8, v[128:131]
    v_pk_mul_f32 v[136:137], v[136:137], v[0:1] op_sel:[0,1] op_sel_hi:[1,1]
    v_pk_mul_f32 v[138:139], v[138:139], v[0:1] op_sel:[0,1] op_sel_hi:[1,1]
    v_pk_mul_f32 v[140:141], v[140:141], v[0:1] op_sel:[0,1] op_sel_hi:[1,1]
    v_pk_mul_f32 v[142:143], v[142:143], v[0:1] op_sel:[0,1] op_sel_hi:[1,1]
    v_cvt_pk_bf16_f32 v136, v136, v137
    v_cvt_pk_bf16_f32 v137, v138, v139
    v_cvt_pk_bf16_f32 v138, v140, v141
    v_cvt_pk_bf16_f32 v139, v142, v143
    ds_write_b128 v8, v[136:139] offset:2048
    v_pk_mul_f32 v[80:81], v[80:81], v[2:3] op_sel:[0,0] op_sel_hi:[1,0]
    v_pk_mul_f32 v[82:83], v[82:83], v[2:3] op_sel:[0,0] op_sel_hi:[1,0]
    v_pk_mul_f32 v[84:85], v[84:85], v[2:3] op_sel:[0,0] op_sel_hi:[1,0]
    v_pk_mul_f32 v[86:87], v[86:87], v[2:3] op_sel:[0,0] op_sel_hi:[1,0]
    v_cvt_pk_bf16_f32 v80, v80, v81
    v_cvt_pk_bf16_f32 v81, v82, v83
    v_cvt_pk_bf16_f32 v82, v84, v85
    v_cvt_pk_bf16_f32 v83, v86, v87
    ds_write_b128 v8, v[80:83] offset:1024
    v_pk_mul_f32 v[88:89], v[88:89], v[2:3] op_sel:[0,1] op_sel_hi:[1,1]
    v_pk_mul_f32 v[90:91], v[90:91], v[2:3] op_sel:[0,1] op_sel_hi:[1,1]
    v_pk_mul_f32 v[92:93], v[92:93], v[2:3] op_sel:[0,1] op_sel_hi:[1,1]
    v_pk_mul_f32 v[94:95], v[94:95], v[2:3] op_sel:[0,1] op_sel_hi:[1,1]
    v_cvt_pk_bf16_f32 v88, v88, v89
    v_cvt_pk_bf16_f32 v89, v90, v91
    v_cvt_pk_bf16_f32 v90, v92, v93
    v_cvt_pk_bf16_f32 v91, v94, v95
    ds_write_b128 v8, v[88:91] offset:3072
    ds_read_b64_tr_b16 a[192:193], v36
    ds_read_b64_tr_b16 a[194:195], v36 offset:2048
    ds_read_b64_tr_b16 a[196:197], v37
    ds_read_b64_tr_b16 a[198:199], v37 offset:2048
    ds_read_b64_tr_b16 a[200:201], v38
    ds_read_b64_tr_b16 a[202:203], v38 offset:2048
    ds_read_b64_tr_b16 a[204:205], v39
    ds_read_b64_tr_b16 a[206:207], v39 offset:2048
    v_pk_mul_f32 v[30:31], v[22:23], s[86:87] op_sel_hi:[1,0]
    v_pk_mul_f32 v[30:31], v[30:31], v[22:23]
    v_pk_mul_f32 v[30:31], v[30:31], v[22:23]
    v_pk_mul_f32 v[0:1], v[160:161], v[160:161]
    v_pk_mul_f32 v[2:3], v[162:163], v[162:163]
    v_pk_mul_f32 v[4:5], v[192:193], v[192:193]
    v_pk_mul_f32 v[6:7], v[194:195], v[194:195]
    v_pk_fma_f32 v[0:1], v[0:1], v[30:31], v[22:23] op_sel:[0,0,0] op_sel_hi:[1,0,0]
    v_pk_fma_f32 v[2:3], v[2:3], v[30:31], v[22:23] op_sel:[0,0,0] op_sel_hi:[1,0,0]
    v_pk_fma_f32 v[4:5], v[4:5], v[30:31], v[22:23] op_sel:[0,0,0] op_sel_hi:[1,0,0]
    v_pk_fma_f32 v[6:7], v[6:7], v[30:31], v[22:23] op_sel:[0,0,0] op_sel_hi:[1,0,0]
    v_pk_mul_f32 v[0:1], v[0:1], v[160:161]
    v_pk_mul_f32 v[2:3], v[2:3], v[162:163]
    v_pk_mul_f32 v[4:5], v[4:5], v[192:193]
    v_pk_mul_f32 v[6:7], v[6:7], v[194:195]
    v_exp_f32 v0, v0
    v_exp_f32 v1, v1
    s_waitcnt lgkmcnt(2)
    v_mfma_f32_16x16x32_bf16 a[160:163], a[200:203], v[120:123], a[160:163]
    v_exp_f32 v2, v2
    v_mfma_f32_16x16x32_bf16 a[168:171], a[200:203], v[124:127], a[168:171]
    v_exp_f32 v3, v3
    v_mfma_f32_16x16x32_bf16 v[152:155], a[200:203], a[140:143], v[152:155]
    v_exp_f32 v4, v4
    s_waitcnt lgkmcnt(0)
    v_mfma_f32_16x16x32_bf16 a[164:167], a[204:207], v[120:123], a[164:167]
    v_exp_f32 v5, v5
    v_mfma_f32_16x16x32_bf16 a[172:175], a[204:207], v[124:127], a[172:175]
    v_exp_f32 v6, v6
    v_mfma_f32_16x16x32_bf16 v[156:159], a[204:207], a[140:143], v[156:159]
    v_exp_f32 v7, v7
    v_mfma_f32_16x16x32_bf16 v[40:43], a[192:195], v[120:123], v[40:43]
    v_accvgpr_read_b32 v64, a0
    v_mfma_f32_16x16x32_bf16 v[48:51], a[192:195], v[124:127], v[48:51]
    v_accvgpr_read_b32 v65, a1
    v_mfma_f32_16x16x32_bf16 v[144:147], a[192:195], a[140:143], v[144:147]
    v_accvgpr_read_b32 v66, a2
    v_mfma_f32_16x16x32_bf16 v[44:47], a[196:199], v[120:123], v[44:47]
    v_accvgpr_read_b32 v67, a3
    v_accvgpr_read_b32 v68, a32
    v_accvgpr_read_b32 v69, a33
    v_accvgpr_read_b32 v70, a34
    v_accvgpr_read_b32 v71, a35
    v_pk_mul_f32 v[64:65], v[160:161], v[64:65]
    v_pk_mul_f32 v[66:67], v[162:163], v[66:67]
    v_pk_mul_f32 v[68:69], v[192:193], v[68:69]
    v_pk_mul_f32 v[70:71], v[194:195], v[70:71]
    v_pk_fma_f32 v[0:1], v[0:1], v[14:15], v[14:15] op_sel:[0,0,0] op_sel_hi:[1,0,0]
    v_pk_fma_f32 v[2:3], v[2:3], v[14:15], v[14:15] op_sel:[0,0,0] op_sel_hi:[1,0,0]
    v_pk_fma_f32 v[4:5], v[4:5], v[14:15], v[14:15] op_sel:[0,0,0] op_sel_hi:[1,0,0]
    v_pk_fma_f32 v[6:7], v[6:7], v[14:15], v[14:15] op_sel:[0,0,0] op_sel_hi:[1,0,0]
    v_rcp_f32 v0, v0
    v_rcp_f32 v1, v1
    v_mfma_f32_16x16x32_bf16 v[52:55], a[196:199], v[124:127], v[52:55]
    v_rcp_f32 v2, v2
    v_mfma_f32_16x16x32_bf16 v[148:151], a[196:199], a[140:143], v[148:151]
    v_rcp_f32 v3, v3
    v_rcp_f32 v4, v4
    v_rcp_f32 v5, v5
    v_rcp_f32 v6, v6
    v_rcp_f32 v7, v7
    v_pk_mul_f32 v[64:65], v[64:65], v[0:1]
    v_pk_mul_f32 v[66:67], v[66:67], v[2:3]
    v_pk_mul_f32 v[68:69], v[68:69], v[4:5]
    v_pk_mul_f32 v[70:71], v[70:71], v[6:7]
    v_cvt_pk_bf16_f32 v160, v64, v65
    v_cvt_pk_bf16_f32 v161, v66, v67
    v_cvt_pk_bf16_f32 v162, v68, v69
    v_cvt_pk_bf16_f32 v163, v70, v71
    buffer_store_dwordx4 v[160:163], v13, s[20:23], s90 offen sc1
    v_pk_mul_f32 v[0:1], v[164:165], v[164:165]
    v_pk_mul_f32 v[2:3], v[166:167], v[166:167]
    v_pk_mul_f32 v[4:5], v[196:197], v[196:197]
    v_pk_mul_f32 v[6:7], v[198:199], v[198:199]
    v_pk_fma_f32 v[0:1], v[0:1], v[30:31], v[22:23] op_sel:[0,1,1] op_sel_hi:[1,1,1]
    v_pk_fma_f32 v[2:3], v[2:3], v[30:31], v[22:23] op_sel:[0,1,1] op_sel_hi:[1,1,1]
    v_pk_fma_f32 v[4:5], v[4:5], v[30:31], v[22:23] op_sel:[0,1,1] op_sel_hi:[1,1,1]
    v_pk_fma_f32 v[6:7], v[6:7], v[30:31], v[22:23] op_sel:[0,1,1] op_sel_hi:[1,1,1]
    v_pk_mul_f32 v[0:1], v[0:1], v[164:165]
    v_pk_mul_f32 v[2:3], v[2:3], v[166:167]
    v_pk_mul_f32 v[4:5], v[4:5], v[196:197]
    v_pk_mul_f32 v[6:7], v[6:7], v[198:199]
    s_add_u32 s70, s59, 65536
    v_add_u32 v32, s70, v13
    s_lshl_b32 s70, s45, 1
    v_add_u32 v33, 32768, v32
    s_lshl_b32 vcc_lo, 0x33333333, s70
    s_mov_b32 vcc_hi, vcc_lo
    v_exp_f32 v0, v0
    v_exp_f32 v1, v1
    v_exp_f32 v2, v2
    v_exp_f32 v3, v3
    ds_write_b128 v32, a[160:163] offset:1024
    v_exp_f32 v4, v4
    v_exp_f32 v5, v5
    v_exp_f32 v6, v6
    v_exp_f32_e64 v7, v7
    ds_write_b128 v32, a[164:167]
    v_accvgpr_read_b32 v64, a4
    v_accvgpr_read_b32 v65, a5
    v_accvgpr_read_b32 v66, a6
    v_accvgpr_read_b32 v67, a7
    ds_write_b128 v32, a[168:171] offset:3072
    v_accvgpr_read_b32 v68, a36
    v_accvgpr_read_b32 v69, a37
    v_accvgpr_read_b32 v70, a38
    v_accvgpr_read_b32 v71, a39
    v_pk_mul_f32 v[64:65], v[164:165], v[64:65]
    v_pk_mul_f32 v[66:67], v[166:167], v[66:67]
    v_pk_mul_f32 v[68:69], v[196:197], v[68:69]
    v_pk_mul_f32 v[70:71], v[198:199], v[70:71]
    v_pk_fma_f32 v[0:1], v[0:1], v[14:15], v[14:15] op_sel:[0,1,1] op_sel_hi:[1,1,1]
    v_pk_fma_f32 v[2:3], v[2:3], v[14:15], v[14:15] op_sel:[0,1,1] op_sel_hi:[1,1,1]
    v_pk_fma_f32 v[4:5], v[4:5], v[14:15], v[14:15] op_sel:[0,1,1] op_sel_hi:[1,1,1]
    v_pk_fma_f32 v[6:7], v[6:7], v[14:15], v[14:15] op_sel:[0,1,1] op_sel_hi:[1,1,1]
    ds_write_b128 v32, a[172:175] offset:2048
    v_rcp_f32 v0, v0
    v_rcp_f32 v1, v1
    v_rcp_f32 v2, v2
    v_rcp_f32 v3, v3
    v_cndmask_b32 v144, v152, v144, vcc
    v_cndmask_b32 v145, v153, v145, vcc
    v_cndmask_b32 v146, v154, v146, vcc
    v_cndmask_b32 v147, v155, v147, vcc
    v_cndmask_b32 v148, v156, v148, vcc
    v_cndmask_b32 v149, v157, v149, vcc
    v_cndmask_b32 v150, v158, v150, vcc
    v_cndmask_b32 v151, v159, v151, vcc
    ds_write_b128 v33, v[148:151] offset:49152
    v_xor_b32 v32, 8192, v32
    v_xor_b32 v33, 8192, v33
    v_rcp_f32 v4, v4
    v_rcp_f32 v5, v5
    v_rcp_f32 v6, v6
    v_rcp_f32 v7, v7
    v_pk_mul_f32 v[64:65], v[64:65], v[0:1]
    v_pk_mul_f32 v[66:67], v[66:67], v[2:3]
    v_pk_mul_f32 v[68:69], v[68:69], v[4:5]
    v_pk_mul_f32 v[70:71], v[70:71], v[6:7]
    v_cvt_pk_bf16_f32 v164, v64, v65
    v_cvt_pk_bf16_f32 v165, v66, v67
    v_cvt_pk_bf16_f32 v166, v68, v69
    v_cvt_pk_bf16_f32 v167, v70, v71
    buffer_store_dwordx4 v[164:167], v13, s[20:23], s90 offen offset:1024 sc1
    s_add_u32 s90, s90, 4096
    s_waitcnt lgkmcnt(0)
    s_barrier
    ds_read_b128 v[72:75], v32
    ds_read_b128 v[76:79], v32 offset:1024
    ds_read_b128 v[80:83], v32 offset:2048
    ds_read_b128 v[84:87], v32 offset:3072
    ds_read_b128 v[88:91], v33 offset:49152
    v_pk_mul_f32 v[30:31], v[24:25], s[86:87] op_sel_hi:[1,0]
    v_pk_mul_f32 v[30:31], v[30:31], v[24:25]
    v_pk_mul_f32 v[30:31], v[30:31], v[24:25]
    v_pk_mul_f32 v[0:1], v[168:169], v[168:169]
    v_pk_mul_f32 v[2:3], v[170:171], v[170:171]
    v_pk_mul_f32 v[4:5], v[200:201], v[200:201]
    v_pk_mul_f32 v[6:7], v[202:203], v[202:203]
    v_pk_fma_f32 v[0:1], v[0:1], v[30:31], v[24:25] op_sel:[0,0,0] op_sel_hi:[1,0,0]
    v_pk_fma_f32 v[2:3], v[2:3], v[30:31], v[24:25] op_sel:[0,0,0] op_sel_hi:[1,0,0]
    v_pk_fma_f32 v[4:5], v[4:5], v[30:31], v[24:25] op_sel:[0,0,0] op_sel_hi:[1,0,0]
    v_pk_fma_f32 v[6:7], v[6:7], v[30:31], v[24:25] op_sel:[0,0,0] op_sel_hi:[1,0,0]
    v_pk_mul_f32 v[0:1], v[0:1], v[168:169]
    v_pk_mul_f32 v[2:3], v[2:3], v[170:171]
    v_pk_mul_f32 v[4:5], v[4:5], v[200:201]
    v_pk_mul_f32 v[6:7], v[6:7], v[202:203]
    v_exp_f32 v0, v0
    v_exp_f32 v1, v1
L_pad0_9:
    s_cbranch_execz L_pad0_13
    v_mfma_f32_16x16x4_4b_bf16 v[176:191], a[104:105], a[242:243], v[176:191]
    v_exp_f32 v2, v2
    v_exp_f32 v3, v3
    v_exp_f32 v4, v4
    v_mfma_f32_16x16x4_4b_bf16 v[208:223], a[106:107], a[242:243], v[208:223]
    v_exp_f32 v5, v5
    v_exp_f32 v6, v6
    v_exp_f32_e64 v7, v7
    v_accvgpr_read_b32 v64, a8
    v_accvgpr_read_b32 v65, a9
    v_accvgpr_read_b32 v66, a10
    v_accvgpr_read_b32 v67, a11
    v_accvgpr_read_b32 v68, a40
    v_accvgpr_read_b32 v69, a41
    v_accvgpr_read_b32 v70, a42
    v_accvgpr_read_b32 v71, a43
    v_pk_mul_f32 v[64:65], v[168:169], v[64:65]
    v_pk_mul_f32 v[66:67], v[170:171], v[66:67]
    v_pk_mul_f32 v[68:69], v[200:201], v[68:69]
    v_pk_mul_f32 v[70:71], v[202:203], v[70:71]
    v_pk_fma_f32 v[0:1], v[0:1], v[16:17], v[16:17] op_sel:[0,0,0] op_sel_hi:[1,0,0]
    v_pk_fma_f32 v[2:3], v[2:3], v[16:17], v[16:17] op_sel:[0,0,0] op_sel_hi:[1,0,0]
    v_pk_fma_f32 v[4:5], v[4:5], v[16:17], v[16:17] op_sel:[0,0,0] op_sel_hi:[1,0,0]
    v_pk_fma_f32 v[6:7], v[6:7], v[16:17], v[16:17] op_sel:[0,0,0] op_sel_hi:[1,0,0]
    v_rcp_f32 v0, v0
    v_rcp_f32 v1, v1
    v_mfma_f32_16x16x4_4b_bf16 a[16:31], a[108:109], a[242:243], a[16:31]
    v_rcp_f32 v2, v2
    v_rcp_f32 v3, v3
    v_rcp_f32 v4, v4
    v_rcp_f32 v5, v5
    v_rcp_f32 v6, v6
    v_rcp_f32 v7, v7
    v_pk_mul_f32 v[64:65], v[64:65], v[0:1]
    v_pk_mul_f32 v[66:67], v[66:67], v[2:3]
    v_pk_mul_f32 v[68:69], v[68:69], v[4:5]
    v_pk_mul_f32 v[70:71], v[70:71], v[6:7]
    v_cvt_pk_bf16_f32 v168, v64, v65
    v_cvt_pk_bf16_f32 v169, v66, v67
    v_cvt_pk_bf16_f32 v170, v68, v69
    v_cvt_pk_bf16_f32 v171, v70, v71
    buffer_store_dwordx4 v[168:171], v13, s[20:23], s90 offen sc1
    s_waitcnt lgkmcnt(4)
    v_pk_add_f32 v[40:41], v[40:41], v[72:73]
    v_pk_add_f32 v[42:43], v[42:43], v[74:75]
    s_waitcnt lgkmcnt(3)
    v_pk_add_f32 v[44:45], v[44:45], v[76:77]
    v_pk_add_f32 v[46:47], v[46:47], v[78:79]
    s_waitcnt lgkmcnt(2)
    v_pk_add_f32 v[48:49], v[48:49], v[80:81]
    v_pk_add_f32 v[50:51], v[50:51], v[82:83]
    s_waitcnt lgkmcnt(1)
    v_pk_add_f32 v[52:53], v[52:53], v[84:85]
    v_pk_add_f32 v[54:55], v[54:55], v[86:87]
    s_waitcnt lgkmcnt(0)
    v_pk_add_f32 v[144:145], v[144:145], v[88:89]
    v_pk_add_f32 v[146:147], v[146:147], v[90:91]
    v_bfe_u32 v73, v13, 4, 2
    v_lshlrev_b32 v73, 2, v73
    buffer_load_dword v74, v73, s[20:23], s76 offen sc1
    v_pk_mul_f32 v[0:1], v[172:173], v[172:173]
    v_pk_mul_f32 v[2:3], v[174:175], v[174:175]
    v_pk_mul_f32 v[4:5], v[204:205], v[204:205]
    v_pk_mul_f32 v[6:7], v[206:207], v[206:207]
    v_pk_fma_f32 v[0:1], v[0:1], v[30:31], v[24:25] op_sel:[0,1,1] op_sel_hi:[1,1,1]
    v_pk_fma_f32 v[2:3], v[2:3], v[30:31], v[24:25] op_sel:[0,1,1] op_sel_hi:[1,1,1]
    v_pk_fma_f32 v[4:5], v[4:5], v[30:31], v[24:25] op_sel:[0,1,1] op_sel_hi:[1,1,1]
    v_pk_fma_f32 v[6:7], v[6:7], v[30:31], v[24:25] op_sel:[0,1,1] op_sel_hi:[1,1,1]
    v_pk_mul_f32 v[0:1], v[0:1], v[172:173]
    v_pk_mul_f32 v[2:3], v[2:3], v[174:175]
    v_pk_mul_f32 v[4:5], v[4:5], v[204:205]
    v_pk_mul_f32 v[6:7], v[6:7], v[206:207]
    v_exp_f32 v0, v0
    v_exp_f32 v1, v1
    v_mfma_f32_16x16x4_4b_bf16 a[48:63], a[110:111], a[242:243], a[48:63]
    v_exp_f32 v2, v2
    buffer_store_dwordx4 v[40:43], v13, s[20:23], s66 offen sc1
    v_exp_f32 v3, v3
    v_exp_f32 v4, v4
    v_exp_f32 v5, v5
    v_exp_f32 v6, v6
    buffer_store_dwordx4 v[44:47], v13, s[20:23], s67 offen sc1
    v_exp_f32 v7, v7
    v_accvgpr_read_b32 v64, a12
    v_accvgpr_read_b32 v65, a13
    v_accvgpr_read_b32 v66, a14
    buffer_store_dwordx4 v[48:51], v13, s[20:23], s66 offen offset:2048 sc1
    v_accvgpr_read_b32 v67, a15
    v_accvgpr_read_b32 v68, a44
    v_accvgpr_read_b32 v69, a45
    v_accvgpr_read_b32 v70, a46
    buffer_store_dwordx4 v[52:55], v13, s[20:23], s67 offen offset:2048 sc1
    v_accvgpr_read_b32 v71, a47
    v_pk_mul_f32 v[64:65], v[172:173], v[64:65]
    v_pk_mul_f32 v[66:67], v[174:175], v[66:67]
    v_pk_mul_f32 v[68:69], v[204:205], v[68:69]
    v_pk_mul_f32 v[70:71], v[206:207], v[70:71]
    v_pk_fma_f32 v[0:1], v[0:1], v[16:17], v[16:17] op_sel:[0,1,1] op_sel_hi:[1,1,1]
    v_pk_fma_f32 v[2:3], v[2:3], v[16:17], v[16:17] op_sel:[0,1,1] op_sel_hi:[1,1,1]
    v_pk_fma_f32 v[4:5], v[4:5], v[16:17], v[16:17] op_sel:[0,1,1] op_sel_hi:[1,1,1]
    v_pk_fma_f32 v[6:7], v[6:7], v[16:17], v[16:17] op_sel:[0,1,1] op_sel_hi:[1,1,1]
    buffer_store_dwordx4 v[144:147], v13, s[20:23], s68 offen sc1
    v_rcp_f32 v0, v0
    v_rcp_f32 v1, v1
    v_rcp_f32 v2, v2
    v_rcp_f32 v3, v3
    v_rcp_f32 v4, v4
    v_rcp_f32 v5, v5
    v_rcp_f32 v6, v6
    v_rcp_f32 v7, v7
    v_pk_mul_f32 v[64:65], v[64:65], v[0:1]
    v_pk_mul_f32 v[66:67], v[66:67], v[2:3]
    v_pk_mul_f32 v[68:69], v[68:69], v[4:5]
    v_pk_mul_f32 v[70:71], v[70:71], v[6:7]
    v_cvt_pk_bf16_f32 v172, v64, v65
    v_cvt_pk_bf16_f32 v173, v66, v67
    v_cvt_pk_bf16_f32 v174, v68, v69
    v_cvt_pk_bf16_f32 v175, v70, v71
    buffer_store_dwordx4 v[172:175], v13, s[20:23], s90 offen offset:1024 sc1
    s_add_u32 s90, s90, 4096
    v_pk_mul_f32 v[30:31], v[26:27], s[86:87] op_sel_hi:[1,0]
    v_pk_mul_f32 v[30:31], v[30:31], v[26:27]
    v_pk_mul_f32 v[30:31], v[30:31], v[26:27]
    v_pk_mul_f32 v[0:1], v[176:177], v[176:177]
    v_pk_mul_f32 v[2:3], v[178:179], v[178:179]
    v_pk_mul_f32 v[4:5], v[208:209], v[208:209]
    v_pk_mul_f32 v[6:7], v[210:211], v[210:211]
    v_pk_fma_f32 v[0:1], v[0:1], v[30:31], v[26:27] op_sel:[0,0,0] op_sel_hi:[1,0,0]
    v_pk_fma_f32 v[2:3], v[2:3], v[30:31], v[26:27] op_sel:[0,0,0] op_sel_hi:[1,0,0]
    v_pk_fma_f32 v[4:5], v[4:5], v[30:31], v[26:27] op_sel:[0,0,0] op_sel_hi:[1,0,0]
    v_pk_fma_f32 v[6:7], v[6:7], v[30:31], v[26:27] op_sel:[0,0,0] op_sel_hi:[1,0,0]
    v_pk_mul_f32 v[0:1], v[0:1], v[176:177]
    v_pk_mul_f32 v[2:3], v[2:3], v[178:179]
    v_pk_mul_f32 v[4:5], v[4:5], v[208:209]
    v_pk_mul_f32 v[6:7], v[6:7], v[210:211]
    v_exp_f32 v0, v0
    v_exp_f32 v1, v1
    v_mfma_f32_16x16x4_4b_bf16 v[240:255], a[112:113], a[242:243], v[240:255]
    v_exp_f32 v2, v2
    v_exp_f32 v3, v3
    v_exp_f32 v4, v4
    v_mfma_f32_16x16x4_4b_bf16 a[80:95], a[114:115], a[242:243], a[80:95]
    v_exp_f32 v5, v5
    v_exp_f32 v6, v6
    v_exp_f32 v7, v7
    v_accvgpr_read_b32 v64, a16
    v_accvgpr_read_b32 v65, a17
    v_accvgpr_read_b32 v66, a18
    v_accvgpr_read_b32 v67, a19
    v_accvgpr_read_b32 v68, a48
    v_accvgpr_read_b32 v69, a49
    v_accvgpr_read_b32 v70, a50
    v_accvgpr_read_b32 v71, a51
    v_pk_mul_f32 v[64:65], v[176:177], v[64:65]
    v_pk_mul_f32 v[66:67], v[178:179], v[66:67]
    v_pk_mul_f32 v[68:69], v[208:209], v[68:69]
    v_pk_mul_f32 v[70:71], v[210:211], v[70:71]
    v_pk_fma_f32 v[0:1], v[0:1], v[18:19], v[18:19] op_sel:[0,0,0] op_sel_hi:[1,0,0]
    v_pk_fma_f32 v[2:3], v[2:3], v[18:19], v[18:19] op_sel:[0,0,0] op_sel_hi:[1,0,0]
    v_pk_fma_f32 v[4:5], v[4:5], v[18:19], v[18:19] op_sel:[0,0,0] op_sel_hi:[1,0,0]
    v_pk_fma_f32 v[6:7], v[6:7], v[18:19], v[18:19] op_sel:[0,0,0] op_sel_hi:[1,0,0]
    v_rcp_f32 v0, v0
    v_rcp_f32 v1, v1
    v_rcp_f32 v2, v2
    v_rcp_f32 v3, v3
    v_rcp_f32 v4, v4
    v_rcp_f32 v5, v5
    v_rcp_f32 v6, v6
    v_rcp_f32 v7, v7
    v_pk_mul_f32 v[64:65], v[64:65], v[0:1]
    v_pk_mul_f32 v[66:67], v[66:67], v[2:3]
    v_pk_mul_f32 v[68:69], v[68:69], v[4:5]
    v_pk_mul_f32 v[70:71], v[70:71], v[6:7]
    v_cvt_pk_bf16_f32 v176, v64, v65
    v_cvt_pk_bf16_f32 v177, v66, v67
    v_cvt_pk_bf16_f32 v178, v68, v69
    v_cvt_pk_bf16_f32 v179, v70, v71
    buffer_store_dwordx4 v[176:179], v13, s[20:23], s90 offen sc1
    v_pk_mul_f32 v[0:1], v[180:181], v[180:181]
    v_pk_mul_f32 v[2:3], v[182:183], v[182:183]
    v_pk_mul_f32 v[4:5], v[212:213], v[212:213]
    v_pk_mul_f32 v[6:7], v[214:215], v[214:215]
    v_pk_fma_f32 v[0:1], v[0:1], v[30:31], v[26:27] op_sel:[0,1,1] op_sel_hi:[1,1,1]
    v_pk_fma_f32 v[2:3], v[2:3], v[30:31], v[26:27] op_sel:[0,1,1] op_sel_hi:[1,1,1]
    v_pk_fma_f32 v[4:5], v[4:5], v[30:31], v[26:27] op_sel:[0,1,1] op_sel_hi:[1,1,1]
    v_pk_fma_f32 v[6:7], v[6:7], v[30:31], v[26:27] op_sel:[0,1,1] op_sel_hi:[1,1,1]
    v_pk_mul_f32 v[0:1], v[0:1], v[180:181]
    v_pk_mul_f32 v[2:3], v[2:3], v[182:183]
    v_pk_mul_f32 v[4:5], v[4:5], v[212:213]
    v_pk_mul_f32 v[6:7], v[6:7], v[214:215]
    v_exp_f32 v0, v0
    v_exp_f32 v1, v1
    v_exp_f32 v2, v2
    v_exp_f32 v3, v3
    v_exp_f32 v4, v4
    v_exp_f32 v5, v5
    v_exp_f32 v6, v6
    v_exp_f32 v7, v7
    v_accvgpr_read_b32 v64, a20
    v_accvgpr_read_b32 v65, a21
    v_accvgpr_read_b32 v66, a22
    v_accvgpr_read_b32 v67, a23
    v_accvgpr_read_b32 v68, a52
    v_accvgpr_read_b32 v69, a53
    v_accvgpr_read_b32 v70, a54
    v_accvgpr_read_b32 v71, a55
    v_pk_mul_f32 v[64:65], v[180:181], v[64:65]
    v_pk_mul_f32 v[66:67], v[182:183], v[66:67]
    v_pk_mul_f32 v[68:69], v[212:213], v[68:69]
    v_pk_mul_f32 v[70:71], v[214:215], v[70:71]
    v_pk_fma_f32 v[0:1], v[0:1], v[18:19], v[18:19] op_sel:[0,1,1] op_sel_hi:[1,1,1]
    v_pk_fma_f32 v[2:3], v[2:3], v[18:19], v[18:19] op_sel:[0,1,1] op_sel_hi:[1,1,1]
    v_pk_fma_f32 v[4:5], v[4:5], v[18:19], v[18:19] op_sel:[0,1,1] op_sel_hi:[1,1,1]
    v_pk_fma_f32 v[6:7], v[6:7], v[18:19], v[18:19] op_sel:[0,1,1] op_sel_hi:[1,1,1]
    v_rcp_f32 v0, v0
    v_rcp_f32 v1, v1
    v_rcp_f32 v2, v2
    v_rcp_f32 v3, v3
    v_rcp_f32 v4, v4
    v_rcp_f32 v5, v5
    v_rcp_f32 v6, v6
    v_rcp_f32 v7, v7
    v_pk_mul_f32 v[64:65], v[64:65], v[0:1]
    v_pk_mul_f32 v[66:67], v[66:67], v[2:3]
    v_pk_mul_f32 v[68:69], v[68:69], v[4:5]
    v_pk_mul_f32 v[70:71], v[70:71], v[6:7]
    v_cvt_pk_bf16_f32 v180, v64, v65
    v_cvt_pk_bf16_f32 v181, v66, v67
    v_cvt_pk_bf16_f32 v182, v68, v69
    v_cvt_pk_bf16_f32 v183, v70, v71
    buffer_store_dwordx4 v[180:183], v13, s[20:23], s90 offen offset:1024 sc1
    s_add_u32 s90, s90, 4096
    s_waitcnt vmcnt(8)
    v_cmp_le_u32 vcc, 1, v74
    s_nop 0
    s_cmp_eq_u64 vcc, -1
    s_cbranch_scc0 L_phba_spin
L_phba_ok:
    s_nop 0
    v_pk_mul_f32 v[30:31], v[28:29], s[86:87] op_sel_hi:[1,0]
    v_pk_mul_f32 v[30:31], v[30:31], v[28:29]
    v_pk_mul_f32 v[30:31], v[30:31], v[28:29]
    v_pk_mul_f32 v[0:1], v[184:185], v[184:185]
    v_pk_mul_f32 v[2:3], v[186:187], v[186:187]
    v_pk_mul_f32 v[4:5], v[216:217], v[216:217]
    v_pk_mul_f32 v[6:7], v[218:219], v[218:219]
    v_pk_fma_f32 v[0:1], v[0:1], v[30:31], v[28:29] op_sel:[0,0,0] op_sel_hi:[1,0,0]
    v_pk_fma_f32 v[2:3], v[2:3], v[30:31], v[28:29] op_sel:[0,0,0] op_sel_hi:[1,0,0]
    v_pk_fma_f32 v[4:5], v[4:5], v[30:31], v[28:29] op_sel:[0,0,0] op_sel_hi:[1,0,0]
    v_pk_fma_f32 v[6:7], v[6:7], v[30:31], v[28:29] op_sel:[0,0,0] op_sel_hi:[1,0,0]
    v_pk_mul_f32 v[0:1], v[0:1], v[184:185]
    v_pk_mul_f32 v[2:3], v[2:3], v[186:187]
    v_pk_mul_f32 v[4:5], v[4:5], v[216:217]
    v_pk_mul_f32 v[6:7], v[6:7], v[218:219]
    s_add_u32 s75, s56, 0
    buffer_load_dwordx4 a[160:163], v13, s[20:23], s75 offen sc1
    v_exp_f32 v0, v0
    v_exp_f32 v1, v1
    v_exp_f32 v2, v2
    v_exp_f32 v3, v3
    v_exp_f32 v4, v4
    v_exp_f32 v5, v5
    buffer_load_dwordx4 a[164:167], v13, s[20:23], s75 offen offset:1024 sc1
    v_exp_f32 v6, v6
    v_exp_f32_e64 v7, v7
    v_accvgpr_read_b32 v64, a24
    v_accvgpr_read_b32 v65, a25
    v_accvgpr_read_b32 v66, a26
    v_accvgpr_read_b32 v67, a27
    buffer_load_dwordx4 a[168:171], v13, s[20:23], s75 offen offset:2048 sc1
    v_accvgpr_read_b32 v68, a56
    v_accvgpr_read_b32 v69, a57
    v_accvgpr_read_b32 v70, a58
    v_accvgpr_read_b32 v71, a59
    v_pk_mul_f32 v[64:65], v[184:185], v[64:65]
    v_pk_mul_f32 v[66:67], v[186:187], v[66:67]
    v_pk_mul_f32 v[68:69], v[216:217], v[68:69]
    v_pk_mul_f32 v[70:71], v[218:219], v[70:71]
    v_pk_fma_f32 v[0:1], v[0:1], v[20:21], v[20:21] op_sel:[0,0,0] op_sel_hi:[1,0,0]
    v_pk_fma_f32 v[2:3], v[2:3], v[20:21], v[20:21] op_sel:[0,0,0] op_sel_hi:[1,0,0]
    v_pk_fma_f32 v[4:5], v[4:5], v[20:21], v[20:21] op_sel:[0,0,0] op_sel_hi:[1,0,0]
    v_pk_fma_f32 v[6:7], v[6:7], v[20:21], v[20:21] op_sel:[0,0,0] op_sel_hi:[1,0,0]
    buffer_load_dwordx4 a[172:175], v13, s[20:23], s75 offen offset:3072 sc1
    v_rcp_f32 v0, v0
    v_rcp_f32 v1, v1
    v_rcp_f32 v2, v2
    v_rcp_f32 v3, v3
    v_rcp_f32 v4, v4
    v_rcp_f32 v5, v5
    v_rcp_f32 v6, v6
    v_rcp_f32 v7, v7
    v_pk_mul_f32 v[64:65], v[64:65], v[0:1]
    v_pk_mul_f32 v[66:67], v[66:67], v[2:3]
    v_pk_mul_f32 v[68:69], v[68:69], v[4:5]
    v_pk_mul_f32 v[70:71], v[70:71], v[6:7]
    v_cvt_pk_bf16_f32 v184, v64, v65
    v_cvt_pk_bf16_f32 v185, v66, v67
    v_cvt_pk_bf16_f32 v186, v68, v69
    v_cvt_pk_bf16_f32 v187, v70, v71
    buffer_store_dwordx4 v[184:187], v13, s[20:23], s90 offen sc1
    v_pk_mul_f32 v[0:1], v[188:189], v[188:189]
    v_pk_mul_f32 v[2:3], v[190:191], v[190:191]
    v_pk_mul_f32 v[4:5], v[220:221], v[220:221]
    v_pk_mul_f32 v[6:7], v[222:223], v[222:223]
    v_pk_fma_f32 v[0:1], v[0:1], v[30:31], v[28:29] op_sel:[0,1,1] op_sel_hi:[1,1,1]
    v_pk_fma_f32 v[2:3], v[2:3], v[30:31], v[28:29] op_sel:[0,1,1] op_sel_hi:[1,1,1]
    v_pk_fma_f32 v[4:5], v[4:5], v[30:31], v[28:29] op_sel:[0,1,1] op_sel_hi:[1,1,1]
    v_pk_fma_f32 v[6:7], v[6:7], v[30:31], v[28:29] op_sel:[0,1,1] op_sel_hi:[1,1,1]
    v_pk_mul_f32 v[0:1], v[0:1], v[188:189]
    v_pk_mul_f32 v[2:3], v[2:3], v[190:191]
    v_pk_mul_f32 v[4:5], v[4:5], v[220:221]
    v_pk_mul_f32 v[6:7], v[6:7], v[222:223]
    s_add_u32 s75, s85, 0
    buffer_load_dwordx4 a[176:179], v13, s[20:23], s75 offen sc1
    v_exp_f32 v0, v0
    v_exp_f32 v1, v1
    v_exp_f32 v2, v2
    v_exp_f32 v3, v3
    v_exp_f32 v4, v4
    v_exp_f32 v5, v5
    buffer_load_dwordx4 a[180:183], v13, s[20:23], s75 offen offset:1024 sc1
    v_exp_f32 v6, v6
    v_exp_f32_e64 v7, v7
    v_accvgpr_read_b32 v64, a28
    v_accvgpr_read_b32 v65, a29
    v_accvgpr_read_b32 v66, a30
    v_accvgpr_read_b32 v67, a31
    buffer_load_dwordx4 a[184:187], v13, s[20:23], s75 offen offset:2048 sc1
    v_accvgpr_read_b32 v68, a60
    v_accvgpr_read_b32 v69, a61
    v_accvgpr_read_b32 v70, a62
    v_accvgpr_read_b32 v71, a63
    v_pk_mul_f32 v[64:65], v[188:189], v[64:65]
    v_pk_mul_f32 v[66:67], v[190:191], v[66:67]
    v_pk_mul_f32 v[68:69], v[220:221], v[68:69]
    v_pk_mul_f32 v[70:71], v[222:223], v[70:71]
    v_pk_fma_f32 v[0:1], v[0:1], v[20:21], v[20:21] op_sel:[0,1,1] op_sel_hi:[1,1,1]
    v_pk_fma_f32 v[2:3], v[2:3], v[20:21], v[20:21] op_sel:[0,1,1] op_sel_hi:[1,1,1]
    v_pk_fma_f32 v[4:5], v[4:5], v[20:21], v[20:21] op_sel:[0,1,1] op_sel_hi:[1,1,1]
    v_pk_fma_f32 v[6:7], v[6:7], v[20:21], v[20:21] op_sel:[0,1,1] op_sel_hi:[1,1,1]
    buffer_load_dwordx4 a[188:191], v13, s[20:23], s75 offen offset:3072 sc1
    v_rcp_f32 v0, v0
    v_rcp_f32 v1, v1
    v_rcp_f32 v2, v2
    v_rcp_f32 v3, v3
    v_rcp_f32 v4, v4
    v_rcp_f32 v5, v5
    v_rcp_f32 v6, v6
    v_rcp_f32 v7, v7
    v_pk_mul_f32 v[64:65], v[64:65], v[0:1]
    v_pk_mul_f32 v[66:67], v[66:67], v[2:3]
    v_pk_mul_f32 v[68:69], v[68:69], v[4:5]
    v_pk_mul_f32 v[70:71], v[70:71], v[6:7]
    v_cvt_pk_bf16_f32 v188, v64, v65
    v_cvt_pk_bf16_f32 v189, v66, v67
    v_cvt_pk_bf16_f32 v190, v68, v69
    v_cvt_pk_bf16_f32 v191, v70, v71
    buffer_store_dwordx4 v[188:191], v13, s[20:23], s90 offen offset:1024 sc1
    s_add_u32 s90, s90, 4096
    s_waitcnt vmcnt(13)
    s_barrier
    s_cmp_lg_u32 s44, 0
    s_cbranch_scc1 L_fkv_skip
    v_accvgpr_write_b32 a254, 1
    s_mov_b64 exec, 1
    buffer_store_dword a254, off, s[20:23], s82 sc1
    s_mov_b64 exec, -1
L_fkv_skip:
    v_lshrrev_b32 v2, 6, v13
    v_lshlrev_b32 v2, 7, v2
    v_bfe_u32 v3, v13, 4, 2
    v_lshl_add_u32 v2, v3, 3, v2
    v_bfe_u32 v3, v13, 7, 2
    v_lshl_add_u32 v192, v3, 5, v2
    v_xor_b32 v196, 65536, v192
    v_xor_b32 v197, 65568, v192
    v_xor_b32 v198, 65600, v192
    v_xor_b32 v199, 65632, v192
    s_add_u32 s75, s56, 262144
    ds_read_b64_tr_b16 a[0:1], v196 offset:16384
    buffer_load_dwordx4 a[192:195], v13, s[20:23], s75 offen sc1
    ds_read_b64_tr_b16 a[2:3], v196 offset:18432
    ds_read_b64_tr_b16 a[4:5], v196 offset:24576
    ds_read_b64_tr_b16 a[6:7], v196 offset:26624
    buffer_load_dwordx4 a[196:199], v13, s[20:23], s75 offen offset:1024 sc1
    ds_read_b64_tr_b16 a[8:9], v197 offset:16384
    ds_read_b64_tr_b16 a[10:11], v197 offset:18432
    buffer_load_dwordx4 a[200:203], v13, s[20:23], s75 offen offset:2048 sc1
    ds_read_b64_tr_b16 a[12:13], v197 offset:24576
    ds_read_b64_tr_b16 a[14:15], v197 offset:26624
    buffer_load_dwordx4 a[204:207], v13, s[20:23], s75 offen offset:3072 sc1
    ds_read_b64_tr_b16 a[16:17], v198 offset:16384
    s_add_u32 s75, s85, 262144
    s_waitcnt vmcnt(5) lgkmcnt(5)
    v_mfma_f32_16x16x32_bf16 v[96:99], a[0:3], a[160:163], 0
    ds_read_b64_tr_b16 a[18:19], v198 offset:18432
    v_bfe_u32 v205, v13, 4, 3
    v_mfma_f32_16x16x32_bf16 v[96:99], a[4:7], a[168:171], v[96:99]
    buffer_load_dwordx4 a[208:211], v13, s[20:23], s75 offen sc1
    v_mfma_f32_16x16x32_bf16 v[100:103], a[0:3], a[164:167], 0
    ds_read_b64_tr_b16 a[20:21], v198 offset:24576
    v_lshlrev_b32 v205, 2, v205
    v_mfma_f32_16x16x32_bf16 v[100:103], a[4:7], a[172:175], v[100:103]
    v_mfma_f32_16x16x32_bf16 v[64:67], a[0:3], a[176:179], 0
    ds_read_b64_tr_b16 a[22:23], v198 offset:26624
    v_mfma_f32_16x16x32_bf16 v[64:67], a[4:7], a[184:187], v[64:67]
    buffer_load_dwordx4 a[212:215], v13, s[20:23], s75 offen offset:1024 sc1
    v_and_b32 v204, 12, v205
    v_mfma_f32_16x16x32_bf16 v[68:71], a[0:3], a[180:183], 0
    ds_read_b64_tr_b16 a[24:25], v199 offset:16384
    v_mfma_f32_16x16x32_bf16 v[68:71], a[4:7], a[188:191], v[68:71]
    s_waitcnt lgkmcnt(5)
    v_mfma_f32_16x16x32_bf16 v[104:107], a[8:11], a[160:163], 0
    ds_read_b64_tr_b16 a[26:27], v199 offset:18432
    v_mfma_f32_16x16x32_bf16 v[104:107], a[12:15], a[168:171], v[104:107]
    buffer_load_dwordx4 a[216:219], v13, s[20:23], s75 offen offset:2048 sc1
    v_mfma_f32_16x16x32_bf16 v[108:111], a[8:11], a[164:167], 0
    ds_read_b64_tr_b16 a[28:29], v199 offset:24576
    v_mfma_f32_16x16x32_bf16 v[108:111], a[12:15], a[172:175], v[108:111]
    v_mfma_f32_16x16x32_bf16 v[72:75], a[8:11], a[176:179], 0
    ds_read_b64_tr_b16 a[30:31], v199 offset:26624
    v_mfma_f32_16x16x32_bf16 v[72:75], a[12:15], a[184:187], v[72:75]
    buffer_load_dwordx4 a[220:223], v13, s[20:23], s75 offen offset:3072 sc1
    v_mfma_f32_16x16x32_bf16 v[76:79], a[8:11], a[180:183], 0
    ds_read_b64_tr_b16 a[32:33], v196 offset:20480
    v_mfma_f32_16x16x32_bf16 v[76:79], a[12:15], a[188:191], v[76:79]
    s_waitcnt lgkmcnt(5)
    v_mfma_f32_16x16x32_bf16 v[112:115], a[16:19], a[160:163], 0
    ds_read_b64_tr_b16 a[34:35], v196 offset:22528
    v_mfma_f32_16x16x32_bf16 v[112:115], a[20:23], a[168:171], v[112:115]
    s_add_u32 s75, s56, 524288
    v_mfma_f32_16x16x32_bf16 v[116:119], a[16:19], a[164:167], 0
    ds_read_b64_tr_b16 a[36:37], v196 offset:28672
    v_mfma_f32_16x16x32_bf16 v[116:119], a[20:23], a[172:175], v[116:119]
    buffer_load_dwordx4 a[224:227], v13, s[20:23], s75 offen sc1
    v_mfma_f32_16x16x32_bf16 v[80:83], a[16:19], a[176:179], 0
    ds_read_b64_tr_b16 a[38:39], v196 offset:30720
    v_mfma_f32_16x16x32_bf16 v[80:83], a[20:23], a[184:187], v[80:83]
    v_mfma_f32_16x16x32_bf16 v[84:87], a[16:19], a[180:183], 0
    ds_read_b64_tr_b16 a[40:41], v197 offset:20480
    v_mfma_f32_16x16x32_bf16 v[84:87], a[20:23], a[188:191], v[84:87]
    s_waitcnt lgkmcnt(5)
    v_mfma_f32_16x16x32_bf16 v[120:123], a[24:27], a[160:163], 0
    ds_read_b64_tr_b16 a[42:43], v197 offset:22528
    v_mfma_f32_16x16x32_bf16 v[120:123], a[28:31], a[168:171], v[120:123]
    buffer_load_dwordx4 a[228:231], v13, s[20:23], s75 offen offset:1024 sc1
    v_mfma_f32_16x16x32_bf16 v[124:127], a[24:27], a[164:167], 0
    ds_read_b64_tr_b16 a[44:45], v197 offset:28672
    v_mfma_f32_16x16x32_bf16 v[124:127], a[28:31], a[172:175], v[124:127]
    buffer_load_dwordx4 a[232:235], v13, s[20:23], s75 offen offset:2048 sc1
    v_mfma_f32_16x16x32_bf16 v[88:91], a[24:27], a[176:179], 0
    ds_read_b64_tr_b16 a[46:47], v197 offset:30720
    v_mfma_f32_16x16x32_bf16 v[88:91], a[28:31], a[184:187], v[88:91]
    v_mfma_f32_16x16x32_bf16 v[92:95], a[24:27], a[180:183], 0
    ds_read_b64_tr_b16 a[48:49], v198 offset:20480
    v_mfma_f32_16x16x32_bf16 v[92:95], a[28:31], a[188:191], v[92:95]
    s_waitcnt lgkmcnt(5)
    v_mfma_f32_16x16x32_bf16 v[128:131], a[32:35], a[160:163], 0
    ds_read_b64_tr_b16 a[50:51], v198 offset:22528
    v_mfma_f32_16x16x32_bf16 v[128:131], a[36:39], a[168:171], v[128:131]
    buffer_load_dwordx4 a[236:239], v13, s[20:23], s75 offen offset:3072 sc1
    v_mfma_f32_16x16x32_bf16 v[132:135], a[32:35], a[164:167], 0
    ds_read_b64_tr_b16 a[52:53], v198 offset:28672
    v_mfma_f32_16x16x32_bf16 v[132:135], a[36:39], a[172:175], v[132:135]
    s_add_u32 s75, s85, 524288
    v_mfma_f32_16x16x32_bf16 v[32:35], a[32:35], a[176:179], 0
    ds_read_b64_tr_b16 a[54:55], v198 offset:30720
    v_mfma_f32_16x16x32_bf16 v[32:35], a[36:39], a[184:187], v[32:35]
    buffer_load_dwordx4 a[128:131], v13, s[20:23], s75 offen sc1
    v_mfma_f32_16x16x32_bf16 v[36:39], a[32:35], a[180:183], 0
    ds_read_b64_tr_b16 a[0:1], v199 offset:20480
    v_mfma_f32_16x16x32_bf16 v[36:39], a[36:39], a[188:191], v[36:39]
    s_waitcnt lgkmcnt(5)
    v_mfma_f32_16x16x32_bf16 v[136:139], a[40:43], a[160:163], 0
    ds_read_b64_tr_b16 a[2:3], v199 offset:22528
    v_mfma_f32_16x16x32_bf16 v[136:139], a[44:47], a[168:171], v[136:139]
    buffer_load_dwordx4 a[132:135], v13, s[20:23], s75 offen offset:1024 sc1
    v_mfma_f32_16x16x32_bf16 v[140:143], a[40:43], a[164:167], 0
    ds_read_b64_tr_b16 a[4:5], v199 offset:28672
    v_mfma_f32_16x16x32_bf16 v[140:143], a[44:47], a[172:175], v[140:143]
    v_mfma_f32_16x16x32_bf16 v[40:43], a[40:43], a[176:179], 0
    ds_read_b64_tr_b16 a[6:7], v199 offset:30720
    v_mfma_f32_16x16x32_bf16 v[40:43], a[44:47], a[184:187], v[40:43]
    buffer_load_dwordx4 a[136:139], v13, s[20:23], s75 offen offset:2048 sc1
    v_mfma_f32_16x16x32_bf16 v[44:47], a[40:43], a[180:183], 0
    ds_read_b64_tr_b16 a[8:9], v196 offset:32768
    v_mfma_f32_16x16x32_bf16 v[44:47], a[44:47], a[188:191], v[44:47]
    s_waitcnt lgkmcnt(5)
    v_mfma_f32_16x16x32_bf16 v[144:147], a[48:51], a[160:163], 0
    ds_read_b64_tr_b16 a[10:11], v196 offset:34816
    v_mfma_f32_16x16x32_bf16 v[144:147], a[52:55], a[168:171], v[144:147]
    buffer_load_dwordx4 a[140:143], v13, s[20:23], s75 offen offset:3072 sc1
    v_mfma_f32_16x16x32_bf16 v[148:151], a[48:51], a[164:167], 0
    ds_read_b64_tr_b16 a[12:13], v196 offset:40960
    v_mfma_f32_16x16x32_bf16 v[148:151], a[52:55], a[172:175], v[148:151]
    s_add_u32 s75, s56, 786432
    v_mfma_f32_16x16x32_bf16 v[48:51], a[48:51], a[176:179], 0
    ds_read_b64_tr_b16 a[14:15], v196 offset:43008
    v_mfma_f32_16x16x32_bf16 v[48:51], a[52:55], a[184:187], v[48:51]
    buffer_load_dwordx4 a[240:243], v13, s[20:23], s75 offen sc1
    v_mfma_f32_16x16x32_bf16 v[52:55], a[48:51], a[180:183], 0
    ds_read_b64_tr_b16 a[16:17], v197 offset:32768
    v_mfma_f32_16x16x32_bf16 v[52:55], a[52:55], a[188:191], v[52:55]
    s_waitcnt lgkmcnt(5)
    v_mfma_f32_16x16x32_bf16 v[152:155], a[0:3], a[160:163], 0
    ds_read_b64_tr_b16 a[18:19], v197 offset:34816
    v_mfma_f32_16x16x32_bf16 v[152:155], a[4:7], a[168:171], v[152:155]
    buffer_load_dwordx4 a[244:247], v13, s[20:23], s75 offen offset:1024 sc1
    v_mfma_f32_16x16x32_bf16 v[156:159], a[0:3], a[164:167], 0
    ds_read_b64_tr_b16 a[20:21], v197 offset:40960
    v_mfma_f32_16x16x32_bf16 v[156:159], a[4:7], a[172:175], v[156:159]
    v_mfma_f32_16x16x32_bf16 v[56:59], a[0:3], a[176:179], 0
    ds_read_b64_tr_b16 a[22:23], v197 offset:43008
    v_pk_mul_f32 v[30:31], v[22:23], s[86:87] op_sel_hi:[1,0]
    v_pk_mul_f32 v[30:31], v[30:31], v[22:23]
    v_pk_mul_f32 v[30:31], v[30:31], v[22:23]
    v_pk_mul_f32 v[0:1], v[224:225], v[224:225]
    v_pk_mul_f32 v[2:3], v[226:227], v[226:227]
    v_pk_mul_f32 v[4:5], v[228:229], v[228:229]
    v_pk_mul_f32 v[6:7], v[230:231], v[230:231]
    v_pk_fma_f32 v[0:1], v[0:1], v[30:31], v[22:23] op_sel:[0,0,0] op_sel_hi:[1,0,0]
    v_pk_fma_f32 v[2:3], v[2:3], v[30:31], v[22:23] op_sel:[0,0,0] op_sel_hi:[1,0,0]
    v_pk_fma_f32 v[4:5], v[4:5], v[30:31], v[22:23] op_sel:[0,1,1] op_sel_hi:[1,1,1]
    v_pk_fma_f32 v[6:7], v[6:7], v[30:31], v[22:23] op_sel:[0,1,1] op_sel_hi:[1,1,1]
    v_pk_mul_f32 v[0:1], v[0:1], v[224:225]
    v_pk_mul_f32 v[2:3], v[2:3], v[226:227]
    v_pk_mul_f32 v[4:5], v[4:5], v[228:229]
    v_pk_mul_f32 v[6:7], v[6:7], v[230:231]
    v_exp_f32 v0, v0
    v_exp_f32 v1, v1
    v_exp_f32 v2, v2
    v_exp_f32 v3, v3
    v_exp_f32 v4, v4
    v_exp_f32 v5, v5
    v_exp_f32 v6, v6
    v_exp_f32 v7, v7
    v_accvgpr_read_b32 v212, a64
    v_accvgpr_read_b32 v213, a65
    v_accvgpr_read_b32 v214, a66
    v_accvgpr_read_b32 v215, a67
    v_accvgpr_read_b32 v216, a68
    v_accvgpr_read_b32 v217, a69
    v_accvgpr_read_b32 v218, a70
    v_accvgpr_read_b32 v219, a71
    v_pk_mul_f32 v[212:213], v[224:225], v[212:213]
    v_pk_mul_f32 v[214:215], v[226:227], v[214:215]
    v_pk_mul_f32 v[216:217], v[228:229], v[216:217]
    v_pk_mul_f32 v[218:219], v[230:231], v[218:219]
    v_pk_fma_f32 v[0:1], v[0:1], v[14:15], v[14:15] op_sel:[0,0,0] op_sel_hi:[1,0,0]
    v_pk_fma_f32 v[2:3], v[2:3], v[14:15], v[14:15] op_sel:[0,0,0] op_sel_hi:[1,0,0]
    v_pk_fma_f32 v[4:5], v[4:5], v[14:15], v[14:15] op_sel:[0,1,1] op_sel_hi:[1,1,1]
    v_pk_fma_f32 v[6:7], v[6:7], v[14:15], v[14:15] op_sel:[0,1,1] op_sel_hi:[1,1,1]
    v_rcp_f32 v0, v0
    v_rcp_f32 v1, v1
    v_rcp_f32 v2, v2
    v_rcp_f32 v3, v3
    v_rcp_f32 v4, v4
    v_rcp_f32 v5, v5
    v_rcp_f32 v6, v6
    v_rcp_f32 v7, v7
    v_pk_mul_f32 v[212:213], v[212:213], v[0:1]
    v_pk_mul_f32 v[214:215], v[214:215], v[2:3]
    v_pk_mul_f32 v[216:217], v[216:217], v[4:5]
    v_pk_mul_f32 v[218:219], v[218:219], v[6:7]
    v_cvt_pk_bf16_f32 v224, v212, v213
    v_cvt_pk_bf16_f32 v225, v214, v215
    v_cvt_pk_bf16_f32 v226, v216, v217
    v_cvt_pk_bf16_f32 v227, v218, v219
    buffer_store_dwordx4 v[224:227], v13, s[20:23], s91 offen sc1
    s_add_u32 s91, s91, 4096
    s_waitcnt vmcnt(19)
    s_barrier
    s_cmp_lg_u32 s44, 0
    s_cbranch_scc1 L_fha_skip
    v_accvgpr_write_b32 a124, 1
    s_mov_b64 exec, 1
    buffer_store_dword a124, off, s[20:23], s81 sc1
    s_mov_b64 exec, -1
L_fha_skip:
    v_mfma_f32_16x16x32_bf16 v[56:59], a[4:7], a[184:187], v[56:59]
    v_mfma_f32_16x16x32_bf16 v[60:63], a[0:3], a[180:183], 0
    ds_read_b64_tr_b16 a[24:25], v198 offset:32768
    v_mfma_f32_16x16x32_bf16 v[60:63], a[4:7], a[188:191], v[60:63]
    s_waitcnt vmcnt(11) lgkmcnt(5)
    v_mfma_f32_16x16x32_bf16 v[96:99], a[8:11], a[192:195], v[96:99]
    ds_read_b64_tr_b16 a[26:27], v198 offset:34816
    v_mfma_f32_16x16x32_bf16 v[96:99], a[12:15], a[200:203], v[96:99]
    buffer_load_dwordx4 a[248:251], v13, s[20:23], s75 offen offset:2048 sc1
L_pad0_10:
    s_cbranch_execz L_pad0_14
    v_mfma_f32_16x16x32_bf16 v[100:103], a[8:11], a[196:199], v[100:103]
    ds_read_b64_tr_b16 a[28:29], v198 offset:40960
    v_mfma_f32_16x16x32_bf16 v[100:103], a[12:15], a[204:207], v[100:103]
    buffer_load_dwordx4 a[252:255], v13, s[20:23], s75 offen offset:3072 sc1
    v_mfma_f32_16x16x32_bf16 v[64:67], a[8:11], a[208:211], v[64:67]
    ds_read_b64_tr_b16 a[30:31], v198 offset:43008
    v_mfma_f32_16x16x32_bf16 v[64:67], a[12:15], a[216:219], v[64:67]
    s_add_u32 s75, s85, 786432
    v_mfma_f32_16x16x32_bf16 v[68:71], a[8:11], a[212:215], v[68:71]
    ds_read_b64_tr_b16 a[32:33], v199 offset:32768
    v_mfma_f32_16x16x32_bf16 v[68:71], a[12:15], a[220:223], v[68:71]
    s_waitcnt lgkmcnt(5)
    v_mfma_f32_16x16x32_bf16 v[104:107], a[16:19], a[192:195], v[104:107]
    ds_read_b64_tr_b16 a[34:35], v199 offset:34816
    v_mfma_f32_16x16x32_bf16 v[104:107], a[20:23], a[200:203], v[104:107]
    buffer_load_dwordx4 a[96:99], v13, s[20:23], s75 offen sc1
    v_mfma_f32_16x16x32_bf16 v[108:111], a[16:19], a[196:199], v[108:111]
    ds_read_b64_tr_b16 a[36:37], v199 offset:40960
    v_mfma_f32_16x16x32_bf16 v[108:111], a[20:23], a[204:207], v[108:111]
    buffer_load_dwordx4 a[100:103], v13, s[20:23], s75 offen offset:1024 sc1
    v_mfma_f32_16x16x32_bf16 v[72:75], a[16:19], a[208:211], v[72:75]
    ds_read_b64_tr_b16 a[38:39], v199 offset:43008
    v_mfma_f32_16x16x32_bf16 v[72:75], a[20:23], a[216:219], v[72:75]
    v_mfma_f32_16x16x32_bf16 v[76:79], a[16:19], a[212:215], v[76:79]
    ds_read_b64_tr_b16 a[40:41], v196 offset:36864
    v_mfma_f32_16x16x32_bf16 v[76:79], a[20:23], a[220:223], v[76:79]
    s_waitcnt lgkmcnt(5)
    v_mfma_f32_16x16x32_bf16 v[112:115], a[24:27], a[192:195], v[112:115]
    ds_read_b64_tr_b16 a[42:43], v196 offset:38912
    v_mfma_f32_16x16x32_bf16 v[112:115], a[28:31], a[200:203], v[112:115]
    buffer_load_dwordx4 a[104:107], v13, s[20:23], s75 offen offset:2048 sc1
    v_mfma_f32_16x16x32_bf16 v[116:119], a[24:27], a[196:199], v[116:119]
    ds_read_b64_tr_b16 a[44:45], v196 offset:45056
    v_mfma_f32_16x16x32_bf16 v[116:119], a[28:31], a[204:207], v[116:119]
    v_mfma_f32_16x16x32_bf16 v[80:83], a[24:27], a[208:211], v[80:83]
    ds_read_b64_tr_b16 a[46:47], v196 offset:47104
    v_mfma_f32_16x16x32_bf16 v[80:83], a[28:31], a[216:219], v[80:83]
    buffer_load_dwordx4 a[108:111], v13, s[20:23], s75 offen offset:3072 sc1
    v_mfma_f32_16x16x32_bf16 v[84:87], a[24:27], a[212:215], v[84:87]
    ds_read_b64_tr_b16 a[48:49], v197 offset:36864
    v_mfma_f32_16x16x32_bf16 v[84:87], a[28:31], a[220:223], v[84:87]
    s_waitcnt lgkmcnt(5)
    v_mfma_f32_16x16x32_bf16 v[120:123], a[32:35], a[192:195], v[120:123]
    ds_read_b64_tr_b16 a[50:51], v197 offset:38912
    v_mfma_f32_16x16x32_bf16 v[120:123], a[36:39], a[200:203], v[120:123]
    s_add_u32 m0, s59, 65536
    v_mfma_f32_16x16x32_bf16 v[124:127], a[32:35], a[196:199], v[124:127]
    ds_read_b64_tr_b16 a[52:53], v197 offset:45056
    v_xor_b32 v200, 131072, v192
    v_mfma_f32_16x16x32_bf16 v[124:127], a[36:39], a[204:207], v[124:127]
    s_add_u32 s74, s53, 1048576
    v_mfma_f32_16x16x32_bf16 v[88:91], a[32:35], a[208:211], v[88:91]
    ds_read_b64_tr_b16 a[54:55], v197 offset:47104
    v_mfma_f32_16x16x32_bf16 v[88:91], a[36:39], a[216:219], v[88:91]
    buffer_load_dwordx4 v9, s[24:27], s74 offen lds
    v_mfma_f32_16x16x32_bf16 v[92:95], a[32:35], a[212:215], v[92:95]
    ds_read_b64_tr_b16 a[0:1], v198 offset:36864
    v_mfma_f32_16x16x32_bf16 v[92:95], a[36:39], a[220:223], v[92:95]
    s_waitcnt lgkmcnt(5)
    v_mfma_f32_16x16x32_bf16 v[128:131], a[40:43], a[192:195], v[128:131]
    ds_read_b64_tr_b16 a[2:3], v198 offset:38912
    v_mfma_f32_16x16x32_bf16 v[128:131], a[44:47], a[200:203], v[128:131]
    buffer_load_dwordx4 v10, s[24:27], s74 offen offset:1024 lds
    v_mfma_f32_16x16x32_bf16 v[132:135], a[40:43], a[196:199], v[132:135]
    ds_read_b64_tr_b16 a[4:5], v198 offset:45056
    v_mfma_f32_16x16x32_bf16 v[132:135], a[44:47], a[204:207], v[132:135]
    buffer_load_dwordx4 v11, s[24:27], s74 offen offset:2048 lds
    v_mfma_f32_16x16x32_bf16 v[32:35], a[40:43], a[208:211], v[32:35]
    ds_read_b64_tr_b16 a[6:7], v198 offset:47104
    v_xor_b32 v201, 131104, v192
    v_mfma_f32_16x16x32_bf16 v[32:35], a[44:47], a[216:219], v[32:35]
    buffer_load_dwordx4 v12, s[24:27], s74 offen offset:3072 lds
    v_mfma_f32_16x16x32_bf16 v[36:39], a[40:43], a[212:215], v[36:39]
    ds_read_b64_tr_b16 a[8:9], v199 offset:36864
    v_mfma_f32_16x16x32_bf16 v[36:39], a[44:47], a[220:223], v[36:39]
    s_waitcnt lgkmcnt(5)
    v_mfma_f32_16x16x32_bf16 v[136:139], a[48:51], a[192:195], v[136:139]
    ds_read_b64_tr_b16 a[10:11], v199 offset:38912
    v_mfma_f32_16x16x32_bf16 v[136:139], a[52:55], a[200:203], v[136:139]
    s_add_u32 m0, s59, 147456
    v_mfma_f32_16x16x32_bf16 v[140:143], a[48:51], a[196:199], v[140:143]
    s_nop 0
    ds_read_b64_tr_b16 a[12:13], v199 offset:45056
    v_pk_mul_f32 v[176:177], v[24:25], s[86:87] op_sel_hi:[1,0]
    v_pk_mul_f32 v[176:177], v[176:177], v[24:25]
    v_pk_mul_f32 v[176:177], v[176:177], v[24:25]
    v_pk_mul_f32 v[168:169], v[232:233], v[232:233]
    v_pk_mul_f32 v[170:171], v[234:235], v[234:235]
    v_pk_mul_f32 v[172:173], v[236:237], v[236:237]
    v_pk_mul_f32 v[174:175], v[238:239], v[238:239]
    v_pk_fma_f32 v[168:169], v[168:169], v[176:177], v[24:25] op_sel:[0,0,0] op_sel_hi:[1,0,0]
    v_pk_fma_f32 v[170:171], v[170:171], v[176:177], v[24:25] op_sel:[0,0,0] op_sel_hi:[1,0,0]
    v_pk_fma_f32 v[172:173], v[172:173], v[176:177], v[24:25] op_sel:[0,1,1] op_sel_hi:[1,1,1]
    v_pk_fma_f32 v[174:175], v[174:175], v[176:177], v[24:25] op_sel:[0,1,1] op_sel_hi:[1,1,1]
    v_pk_mul_f32 v[168:169], v[168:169], v[232:233]
    v_pk_mul_f32 v[170:171], v[170:171], v[234:235]
    v_pk_mul_f32 v[172:173], v[172:173], v[236:237]
    v_pk_mul_f32 v[174:175], v[174:175], v[238:239]
    v_exp_f32 v168, v168
    v_exp_f32 v169, v169
    v_exp_f32 v170, v170
    v_exp_f32 v171, v171
    v_exp_f32 v172, v172
    v_exp_f32 v173, v173
    v_exp_f32 v174, v174
    v_exp_f32 v175, v175
    v_accvgpr_read_b32 v160, a72
    v_accvgpr_read_b32 v161, a73
    v_accvgpr_read_b32 v162, a74
    v_accvgpr_read_b32 v163, a75
    v_accvgpr_read_b32 v164, a76
    v_accvgpr_read_b32 v165, a77
    v_accvgpr_read_b32 v166, a78
    v_accvgpr_read_b32 v167, a79
    v_pk_mul_f32 v[160:161], v[232:233], v[160:161]
    v_pk_mul_f32 v[162:163], v[234:235], v[162:163]
    v_pk_mul_f32 v[164:165], v[236:237], v[164:165]
    v_pk_mul_f32 v[166:167], v[238:239], v[166:167]
    v_pk_fma_f32 v[168:169], v[168:169], v[16:17], v[16:17] op_sel:[0,0,0] op_sel_hi:[1,0,0]
    v_pk_fma_f32 v[170:171], v[170:171], v[16:17], v[16:17] op_sel:[0,0,0] op_sel_hi:[1,0,0]
    v_pk_fma_f32 v[172:173], v[172:173], v[16:17], v[16:17] op_sel:[0,1,1] op_sel_hi:[1,1,1]
    v_pk_fma_f32 v[174:175], v[174:175], v[16:17], v[16:17] op_sel:[0,1,1] op_sel_hi:[1,1,1]
    v_rcp_f32 v168, v168
    v_rcp_f32 v169, v169
    v_rcp_f32 v170, v170
    v_rcp_f32 v171, v171
    v_rcp_f32 v172, v172
    v_rcp_f32 v173, v173
    v_rcp_f32 v174, v174
    v_rcp_f32 v175, v175
    v_pk_mul_f32 v[160:161], v[160:161], v[168:169]
    v_pk_mul_f32 v[162:163], v[162:163], v[170:171]
    v_pk_mul_f32 v[164:165], v[164:165], v[172:173]
    v_pk_mul_f32 v[166:167], v[166:167], v[174:175]
    v_cvt_pk_bf16_f32 v232, v160, v161
    v_cvt_pk_bf16_f32 v233, v162, v163
    v_cvt_pk_bf16_f32 v234, v164, v165
    v_cvt_pk_bf16_f32 v235, v166, v167
    buffer_store_dwordx4 v[232:235], v13, s[20:23], s91 offen sc1
    s_add_u32 s91, s91, 4096
    buffer_load_dword v206, v204, s[20:23], s76 offen sc1
    v_mfma_f32_16x16x32_bf16 v[140:143], a[52:55], a[204:207], v[140:143]
    s_add_u32 s74, s53, 1179648
    v_mfma_f32_16x16x32_bf16 v[40:43], a[48:51], a[208:211], v[40:43]
    ds_read_b64_tr_b16 a[14:15], v199 offset:47104
    v_mfma_f32_16x16x32_bf16 v[40:43], a[52:55], a[216:219], v[40:43]
    buffer_load_dwordx4 v9, s[24:27], s74 offen lds
    s_barrier
    v_mfma_f32_16x16x32_bf16 v[44:47], a[48:51], a[212:215], v[44:47]
    ds_read_b64_tr_b16 a[16:17], v196 offset:49152
    v_xor_b32 v202, 131136, v192
    v_mfma_f32_16x16x32_bf16 v[44:47], a[52:55], a[220:223], v[44:47]
    s_waitcnt lgkmcnt(5)
    v_mfma_f32_16x16x32_bf16 v[144:147], a[0:3], a[192:195], v[144:147]
    ds_read_b64_tr_b16 a[18:19], v196 offset:51200
    v_mfma_f32_16x16x32_bf16 v[144:147], a[4:7], a[200:203], v[144:147]
    buffer_load_dwordx4 v10, s[24:27], s74 offen offset:1024 lds
    v_mfma_f32_16x16x32_bf16 v[148:151], a[0:3], a[196:199], v[148:151]
    ds_read_b64_tr_b16 a[20:21], v196 offset:57344
    v_mfma_f32_16x16x32_bf16 v[148:151], a[4:7], a[204:207], v[148:151]
    buffer_load_dwordx4 v11, s[24:27], s74 offen offset:2048 lds
    v_mfma_f32_16x16x32_bf16 v[48:51], a[0:3], a[208:211], v[48:51]
    ds_read_b64_tr_b16 a[22:23], v196 offset:59392
    v_mfma_f32_16x16x32_bf16 v[48:51], a[4:7], a[216:219], v[48:51]
    v_mfma_f32_16x16x32_bf16 v[52:55], a[0:3], a[212:215], v[52:55]
    ds_read_b64_tr_b16 a[24:25], v197 offset:49152
    v_mfma_f32_16x16x32_bf16 v[52:55], a[4:7], a[220:223], v[52:55]
    s_waitcnt lgkmcnt(5)
    v_mfma_f32_16x16x32_bf16 v[152:155], a[8:11], a[192:195], v[152:155]
    ds_read_b64_tr_b16 a[26:27], v197 offset:51200
    v_xor_b32 v203, 131168, v192
    v_mfma_f32_16x16x32_bf16 v[152:155], a[12:15], a[200:203], v[152:155]
    buffer_load_dwordx4 v12, s[24:27], s74 offen offset:3072 lds
    v_mfma_f32_16x16x32_bf16 v[156:159], a[8:11], a[196:199], v[156:159]
    ds_read_b64_tr_b16 a[28:29], v197 offset:57344
    v_mfma_f32_16x16x32_bf16 v[156:159], a[12:15], a[204:207], v[156:159]
    s_add_u32 m0, s59, 81920
    v_mfma_f32_16x16x32_bf16 v[56:59], a[8:11], a[208:211], v[56:59]
    ds_read_b64_tr_b16 a[30:31], v197 offset:59392
    v_mfma_f32_16x16x32_bf16 v[56:59], a[12:15], a[216:219], v[56:59]
    s_add_u32 s74, s53, 1310720
    v_mfma_f32_16x16x32_bf16 v[60:63], a[8:11], a[212:215], v[60:63]
    ds_read_b64_tr_b16 a[32:33], v198 offset:49152
    v_mfma_f32_16x16x32_bf16 v[60:63], a[12:15], a[220:223], v[60:63]
    s_waitcnt vmcnt(19) lgkmcnt(5)
    v_mfma_f32_16x16x32_bf16 v[96:99], a[16:19], a[224:227], v[96:99]
    ds_read_b64_tr_b16 a[34:35], v198 offset:51200
    v_mfma_f32_16x16x32_bf16 v[96:99], a[20:23], a[232:235], v[96:99]
    buffer_load_dwordx4 v9, s[24:27], s74 offen lds
    v_mfma_f32_16x16x32_bf16 v[100:103], a[16:19], a[228:231], v[100:103]
    ds_read_b64_tr_b16 a[36:37], v198 offset:57344
    v_xor_b32 v193, 32, v192
    v_mfma_f32_16x16x32_bf16 v[100:103], a[20:23], a[236:239], v[100:103]
    buffer_load_dwordx4 v10, s[24:27], s74 offen offset:1024 lds
    v_mfma_f32_16x16x32_bf16 v[64:67], a[16:19], a[128:131], v[64:67]
    ds_read_b64_tr_b16 a[38:39], v198 offset:59392
    v_mfma_f32_16x16x32_bf16 v[64:67], a[20:23], a[136:139], v[64:67]
    buffer_load_dwordx4 v11, s[24:27], s74 offen offset:2048 lds
    v_mfma_f32_16x16x32_bf16 v[68:71], a[16:19], a[132:135], v[68:71]
    ds_read_b64_tr_b16 a[40:41], v199 offset:49152
    v_mfma_f32_16x16x32_bf16 v[68:71], a[20:23], a[140:143], v[68:71]
    s_waitcnt lgkmcnt(5)
    v_mfma_f32_16x16x32_bf16 v[104:107], a[24:27], a[224:227], v[104:107]
    ds_read_b64_tr_b16 a[42:43], v199 offset:51200
    v_mfma_f32_16x16x32_bf16 v[104:107], a[28:31], a[232:235], v[104:107]
    buffer_load_dwordx4 v12, s[24:27], s74 offen offset:3072 lds
    v_mfma_f32_16x16x32_bf16 v[108:111], a[24:27], a[228:231], v[108:111]
    ds_read_b64_tr_b16 a[44:45], v199 offset:57344
    v_mfma_f32_16x16x32_bf16 v[108:111], a[28:31], a[236:239], v[108:111]
    v_mfma_f32_16x16x32_bf16 v[72:75], a[24:27], a[128:131], v[72:75]
    ds_read_b64_tr_b16 a[46:47], v199 offset:59392
    v_xor_b32 v194, 64, v192
    v_mfma_f32_16x16x32_bf16 v[72:75], a[28:31], a[136:139], v[72:75]
    v_mfma_f32_16x16x32_bf16 v[76:79], a[24:27], a[132:135], v[76:79]
    ds_read_b64_tr_b16 a[48:49], v196 offset:53248
    v_mfma_f32_16x16x32_bf16 v[76:79], a[28:31], a[140:143], v[76:79]
    s_waitcnt lgkmcnt(5)
    v_mfma_f32_16x16x32_bf16 v[112:115], a[32:35], a[224:227], v[112:115]
    ds_read_b64_tr_b16 a[50:51], v196 offset:55296
    v_mfma_f32_16x16x32_bf16 v[112:115], a[36:39], a[232:235], v[112:115]
    v_mfma_f32_16x16x32_bf16 v[116:119], a[32:35], a[228:231], v[116:119]
    ds_read_b64_tr_b16 a[52:53], v196 offset:61440
    v_mfma_f32_16x16x32_bf16 v[116:119], a[36:39], a[236:239], v[116:119]
    v_mfma_f32_16x16x32_bf16 v[80:83], a[32:35], a[128:131], v[80:83]
    ds_read_b64_tr_b16 a[54:55], v196 offset:63488
    v_mfma_f32_16x16x32_bf16 v[80:83], a[36:39], a[136:139], v[80:83]
    s_add_u32 s75, s56, 1048576
    v_mfma_f32_16x16x32_bf16 v[84:87], a[32:35], a[132:135], v[84:87]
    ds_read_b64_tr_b16 a[0:1], v197 offset:53248
    s_waitcnt vmcnt(8)
    v_cmp_le_u32 vcc, 2, v206
    s_nop 0
    s_cmp_eq_u64 vcc, -1
    s_cbranch_scc0 L_phb2a_spin
L_phb2a_ok:
    v_mfma_f32_16x16x32_bf16 v[84:87], a[36:39], a[140:143], v[84:87]
    s_waitcnt lgkmcnt(5)
    v_xor_b32 v195, 96, v192
    v_mfma_f32_16x16x32_bf16 v[120:123], a[40:43], a[224:227], v[120:123]
    ds_read_b64_tr_b16 a[2:3], v197 offset:55296
    v_pk_mul_f32 v[30:31], v[26:27], s[86:87] op_sel_hi:[1,0]
    v_pk_mul_f32 v[30:31], v[30:31], v[26:27]
    v_pk_mul_f32 v[30:31], v[30:31], v[26:27]
    v_pk_mul_f32 v[0:1], v[240:241], v[240:241]
    v_pk_mul_f32 v[2:3], v[242:243], v[242:243]
    v_pk_mul_f32 v[4:5], v[244:245], v[244:245]
    v_pk_mul_f32 v[6:7], v[246:247], v[246:247]
    v_pk_fma_f32 v[0:1], v[0:1], v[30:31], v[26:27] op_sel:[0,0,0] op_sel_hi:[1,0,0]
    v_pk_fma_f32 v[2:3], v[2:3], v[30:31], v[26:27] op_sel:[0,0,0] op_sel_hi:[1,0,0]
    v_pk_fma_f32 v[4:5], v[4:5], v[30:31], v[26:27] op_sel:[0,1,1] op_sel_hi:[1,1,1]
    v_pk_fma_f32 v[6:7], v[6:7], v[30:31], v[26:27] op_sel:[0,1,1] op_sel_hi:[1,1,1]
    v_pk_mul_f32 v[0:1], v[0:1], v[240:241]
    v_pk_mul_f32 v[2:3], v[2:3], v[242:243]
    v_pk_mul_f32 v[4:5], v[4:5], v[244:245]
    v_pk_mul_f32 v[6:7], v[6:7], v[246:247]
    v_exp_f32 v0, v0
    v_exp_f32 v1, v1
    v_exp_f32 v2, v2
    v_exp_f32 v3, v3
    v_exp_f32 v4, v4
    v_exp_f32 v5, v5
    v_exp_f32 v6, v6
    v_exp_f32 v7, v7
    v_accvgpr_read_b32 v212, a80
    v_accvgpr_read_b32 v213, a81
    v_accvgpr_read_b32 v214, a82
    v_accvgpr_read_b32 v215, a83
    v_accvgpr_read_b32 v216, a84
    v_accvgpr_read_b32 v217, a85
    v_accvgpr_read_b32 v218, a86
    v_accvgpr_read_b32 v219, a87
    v_pk_mul_f32 v[212:213], v[240:241], v[212:213]
    v_pk_mul_f32 v[214:215], v[242:243], v[214:215]
    v_pk_mul_f32 v[216:217], v[244:245], v[216:217]
    v_pk_mul_f32 v[218:219], v[246:247], v[218:219]
    v_pk_fma_f32 v[0:1], v[0:1], v[18:19], v[18:19] op_sel:[0,0,0] op_sel_hi:[1,0,0]
    v_pk_fma_f32 v[2:3], v[2:3], v[18:19], v[18:19] op_sel:[0,0,0] op_sel_hi:[1,0,0]
    v_pk_fma_f32 v[4:5], v[4:5], v[18:19], v[18:19] op_sel:[0,1,1] op_sel_hi:[1,1,1]
    v_pk_fma_f32 v[6:7], v[6:7], v[18:19], v[18:19] op_sel:[0,1,1] op_sel_hi:[1,1,1]
    v_rcp_f32 v0, v0
    v_rcp_f32 v1, v1
    v_rcp_f32 v2, v2
    v_rcp_f32 v3, v3
    v_rcp_f32 v4, v4
    v_rcp_f32 v5, v5
    v_rcp_f32 v6, v6
    v_rcp_f32 v7, v7
    v_pk_mul_f32 v[212:213], v[212:213], v[0:1]
    v_pk_mul_f32 v[214:215], v[214:215], v[2:3]
    v_pk_mul_f32 v[216:217], v[216:217], v[4:5]
    v_pk_mul_f32 v[218:219], v[218:219], v[6:7]
    v_cvt_pk_bf16_f32 v240, v212, v213
    v_cvt_pk_bf16_f32 v241, v214, v215
    v_cvt_pk_bf16_f32 v242, v216, v217
    v_cvt_pk_bf16_f32 v243, v218, v219
    buffer_store_dwordx4 v[240:243], v13, s[20:23], s91 offen sc1
    s_add_u32 s91, s91, 4096
    v_mfma_f32_16x16x32_bf16 v[120:123], a[44:47], a[232:235], v[120:123]
    buffer_load_dwordx4 a[160:163], v13, s[20:23], s75 offen sc1
    v_mfma_f32_16x16x32_bf16 v[124:127], a[40:43], a[228:231], v[124:127]
    ds_read_b64_tr_b16 a[4:5], v197 offset:61440
    v_mfma_f32_16x16x32_bf16 v[124:127], a[44:47], a[236:239], v[124:127]
    buffer_load_dwordx4 a[164:167], v13, s[20:23], s75 offen offset:1024 sc1
    v_mfma_f32_16x16x32_bf16 v[88:91], a[40:43], a[128:131], v[88:91]
    ds_read_b64_tr_b16 a[6:7], v197 offset:63488
    v_mfma_f32_16x16x32_bf16 v[88:91], a[44:47], a[136:139], v[88:91]
    v_mfma_f32_16x16x32_bf16 v[92:95], a[40:43], a[132:135], v[92:95]
    ds_read_b64_tr_b16 a[8:9], v198 offset:53248
    v_mfma_f32_16x16x32_bf16 v[92:95], a[44:47], a[140:143], v[92:95]
    s_waitcnt lgkmcnt(5)
    v_mfma_f32_16x16x32_bf16 v[128:131], a[48:51], a[224:227], v[128:131]
    ds_read_b64_tr_b16 a[10:11], v198 offset:55296
    v_mfma_f32_16x16x32_bf16 v[128:131], a[52:55], a[232:235], v[128:131]
    buffer_load_dwordx4 a[168:171], v13, s[20:23], s75 offen offset:2048 sc1
    v_mfma_f32_16x16x32_bf16 v[132:135], a[48:51], a[228:231], v[132:135]
    ds_read_b64_tr_b16 a[12:13], v198 offset:61440
    v_mfma_f32_16x16x32_bf16 v[132:135], a[52:55], a[236:239], v[132:135]
    v_mfma_f32_16x16x32_bf16 v[32:35], a[48:51], a[128:131], v[32:35]
    ds_read_b64_tr_b16 a[14:15], v198 offset:63488
    v_mfma_f32_16x16x32_bf16 v[32:35], a[52:55], a[136:139], v[32:35]
    buffer_load_dwordx4 a[172:175], v13, s[20:23], s75 offen offset:3072 sc1
    v_mfma_f32_16x16x32_bf16 v[36:39], a[48:51], a[132:135], v[36:39]
    ds_read_b64_tr_b16 a[16:17], v199 offset:53248
    v_mfma_f32_16x16x32_bf16 v[36:39], a[52:55], a[140:143], v[36:39]
    s_waitcnt lgkmcnt(5)
    v_mfma_f32_16x16x32_bf16 v[136:139], a[0:3], a[224:227], v[136:139]
    ds_read_b64_tr_b16 a[18:19], v199 offset:55296
    v_mfma_f32_16x16x32_bf16 v[136:139], a[4:7], a[232:235], v[136:139]
    s_add_u32 s75, s85, 1048576
    v_mfma_f32_16x16x32_bf16 v[140:143], a[0:3], a[228:231], v[140:143]
    ds_read_b64_tr_b16 a[20:21], v199 offset:61440
    v_mfma_f32_16x16x32_bf16 v[140:143], a[4:7], a[236:239], v[140:143]
    buffer_load_dwordx4 a[176:179], v13, s[20:23], s75 offen sc1
    v_mfma_f32_16x16x32_bf16 v[40:43], a[0:3], a[128:131], v[40:43]
    ds_read_b64_tr_b16 a[22:23], v199 offset:63488
    v_mfma_f32_16x16x32_bf16 v[40:43], a[4:7], a[136:139], v[40:43]
    buffer_load_dwordx4 a[180:183], v13, s[20:23], s75 offen offset:1024 sc1
    v_mfma_f32_16x16x32_bf16 v[44:47], a[0:3], a[132:135], v[44:47]
    ds_read_b64_tr_b16 a[24:25], v200
    v_mfma_f32_16x16x32_bf16 v[44:47], a[4:7], a[140:143], v[44:47]
    s_waitcnt lgkmcnt(5)
    v_mfma_f32_16x16x32_bf16 v[144:147], a[8:11], a[224:227], v[144:147]
    ds_read_b64_tr_b16 a[26:27], v200 offset:2048
    v_mfma_f32_16x16x32_bf16 v[144:147], a[12:15], a[232:235], v[144:147]
    buffer_load_dwordx4 a[184:187], v13, s[20:23], s75 offen offset:2048 sc1
    v_mfma_f32_16x16x32_bf16 v[148:151], a[8:11], a[228:231], v[148:151]
    ds_read_b64_tr_b16 a[28:29], v200 offset:8192
    v_mfma_f32_16x16x32_bf16 v[148:151], a[12:15], a[236:239], v[148:151]
    v_mfma_f32_16x16x32_bf16 v[48:51], a[8:11], a[128:131], v[48:51]
    ds_read_b64_tr_b16 a[30:31], v200 offset:10240
    s_lshl2_add_u32 s70, s58, s44
    v_mfma_f32_16x16x32_bf16 v[48:51], a[12:15], a[136:139], v[48:51]
    v_mfma_f32_16x16x32_bf16 v[52:55], a[8:11], a[132:135], v[52:55]
    ds_read_b64_tr_b16 a[32:33], v201
    v_mfma_f32_16x16x32_bf16 v[52:55], a[12:15], a[140:143], v[52:55]
    s_waitcnt lgkmcnt(5)
    s_mul_i32 s70, s70, 8192
    v_mfma_f32_16x16x32_bf16 v[152:155], a[16:19], a[224:227], v[152:155]
    ds_read_b64_tr_b16 a[34:35], v201 offset:2048
    v_mfma_f32_16x16x32_bf16 v[152:155], a[20:23], a[232:235], v[152:155]
    buffer_load_dwordx4 a[188:191], v13, s[20:23], s75 offen offset:3072 sc1
    v_mfma_f32_16x16x32_bf16 v[156:159], a[16:19], a[228:231], v[156:159]
    ds_read_b64_tr_b16 a[36:37], v201 offset:8192
    v_mfma_f32_16x16x32_bf16 v[156:159], a[20:23], a[236:239], v[156:159]
    s_add_u32 s75, s56, 1310720
    s_mul_i32 s71, s47, 262144
    v_mfma_f32_16x16x32_bf16 v[56:59], a[16:19], a[128:131], v[56:59]
    ds_read_b64_tr_b16 a[38:39], v201 offset:10240
    v_mfma_f32_16x16x32_bf16 v[56:59], a[20:23], a[136:139], v[56:59]
    buffer_load_dwordx4 a[192:195], v13, s[20:23], s75 offen sc1
    v_mfma_f32_16x16x32_bf16 v[60:63], a[16:19], a[132:135], v[60:63]
    ds_read_b64_tr_b16 a[40:41], v202
    v_mfma_f32_16x16x32_bf16 v[60:63], a[20:23], a[140:143], v[60:63]
    s_waitcnt lgkmcnt(5)
    s_add_u32 s70, s70, s71
    v_mfma_f32_16x16x32_bf16 v[96:99], a[24:27], a[240:243], v[96:99]
    ds_read_b64_tr_b16 a[42:43], v202 offset:2048
    v_mfma_f32_16x16x32_bf16 v[96:99], a[28:31], a[248:251], v[96:99]
    buffer_load_dwordx4 a[196:199], v13, s[20:23], s75 offen offset:1024 sc1
    v_mfma_f32_16x16x32_bf16 v[100:103], a[24:27], a[244:247], v[100:103]
    ds_read_b64_tr_b16 a[44:45], v202 offset:8192
    v_mfma_f32_16x16x32_bf16 v[100:103], a[28:31], a[252:255], v[100:103]
    buffer_load_dwordx4 a[200:203], v13, s[20:23], s75 offen offset:2048 sc1
    s_xor_b32 s71, s60, 0
    v_mfma_f32_16x16x32_bf16 v[64:67], a[24:27], a[96:99], v[64:67]
    ds_read_b64_tr_b16 a[46:47], v202 offset:10240
    v_mfma_f32_16x16x32_bf16 v[64:67], a[28:31], a[104:107], v[64:67]
    v_mfma_f32_16x16x32_bf16 v[68:71], a[24:27], a[100:103], v[68:71]
    ds_read_b64_tr_b16 a[48:49], v203
    v_pk_mul_f32 v[176:177], v[28:29], s[86:87] op_sel_hi:[1,0]
    v_pk_mul_f32 v[176:177], v[176:177], v[28:29]
    v_pk_mul_f32 v[176:177], v[176:177], v[28:29]
    v_pk_mul_f32 v[168:169], v[248:249], v[248:249]
    v_pk_mul_f32 v[170:171], v[250:251], v[250:251]
    v_pk_mul_f32 v[172:173], v[252:253], v[252:253]
    v_pk_mul_f32 v[174:175], v[254:255], v[254:255]
    v_pk_fma_f32 v[168:169], v[168:169], v[176:177], v[28:29] op_sel:[0,0,0] op_sel_hi:[1,0,0]
    v_pk_fma_f32 v[170:171], v[170:171], v[176:177], v[28:29] op_sel:[0,0,0] op_sel_hi:[1,0,0]
    v_pk_fma_f32 v[172:173], v[172:173], v[176:177], v[28:29] op_sel:[0,1,1] op_sel_hi:[1,1,1]
    v_pk_fma_f32 v[174:175], v[174:175], v[176:177], v[28:29] op_sel:[0,1,1] op_sel_hi:[1,1,1]
    v_pk_mul_f32 v[168:169], v[168:169], v[248:249]
    v_pk_mul_f32 v[170:171], v[170:171], v[250:251]
    v_pk_mul_f32 v[172:173], v[172:173], v[252:253]
    v_pk_mul_f32 v[174:175], v[174:175], v[254:255]
    v_exp_f32 v168, v168
    v_exp_f32 v169, v169
    v_exp_f32 v170, v170
    v_exp_f32 v171, v171
    v_exp_f32 v172, v172
    v_exp_f32 v173, v173
    v_exp_f32 v174, v174
    v_exp_f32 v175, v175
    v_accvgpr_read_b32 v160, a88
    v_accvgpr_read_b32 v161, a89
    v_accvgpr_read_b32 v162, a90
    v_accvgpr_read_b32 v163, a91
    v_accvgpr_read_b32 v164, a92
    v_accvgpr_read_b32 v165, a93
    v_accvgpr_read_b32 v166, a94
    v_accvgpr_read_b32 v167, a95
    v_pk_mul_f32 v[160:161], v[248:249], v[160:161]
    v_pk_mul_f32 v[162:163], v[250:251], v[162:163]
    v_pk_mul_f32 v[164:165], v[252:253], v[164:165]
    v_pk_mul_f32 v[166:167], v[254:255], v[166:167]
    v_pk_fma_f32 v[168:169], v[168:169], v[20:21], v[20:21] op_sel:[0,0,0] op_sel_hi:[1,0,0]
    v_pk_fma_f32 v[170:171], v[170:171], v[20:21], v[20:21] op_sel:[0,0,0] op_sel_hi:[1,0,0]
    v_pk_fma_f32 v[172:173], v[172:173], v[20:21], v[20:21] op_sel:[0,1,1] op_sel_hi:[1,1,1]
    v_pk_fma_f32 v[174:175], v[174:175], v[20:21], v[20:21] op_sel:[0,1,1] op_sel_hi:[1,1,1]
    v_rcp_f32 v168, v168
    v_rcp_f32 v169, v169
    v_rcp_f32 v170, v170
    v_rcp_f32 v171, v171
    v_rcp_f32 v172, v172
    v_rcp_f32 v173, v173
    v_rcp_f32 v174, v174
    v_rcp_f32 v175, v175
    v_pk_mul_f32 v[160:161], v[160:161], v[168:169]
    v_pk_mul_f32 v[162:163], v[162:163], v[170:171]
    v_pk_mul_f32 v[164:165], v[164:165], v[172:173]
    v_pk_mul_f32 v[166:167], v[166:167], v[174:175]
    v_cvt_pk_bf16_f32 v248, v160, v161
    v_cvt_pk_bf16_f32 v249, v162, v163
    v_cvt_pk_bf16_f32 v250, v164, v165
    v_cvt_pk_bf16_f32 v251, v166, v167
    buffer_store_dwordx4 v[248:251], v13, s[20:23], s91 offen sc1
    s_add_u32 s91, s91, 4096
    v_mfma_f32_16x16x32_bf16 v[68:71], a[28:31], a[108:111], v[68:71]
    s_waitcnt lgkmcnt(5)
    s_mul_i32 s71, s71, 3670016
    v_mfma_f32_16x16x32_bf16 v[104:107], a[32:35], a[240:243], v[104:107]
    ds_read_b64_tr_b16 a[50:51], v203 offset:2048
    v_bfe_u32 v208, v13, 4, 4
    v_mfma_f32_16x16x32_bf16 v[104:107], a[36:39], a[248:251], v[104:107]
    buffer_load_dwordx4 a[204:207], v13, s[20:23], s75 offen offset:3072 sc1
    v_mfma_f32_16x16x32_bf16 v[108:111], a[32:35], a[244:247], v[108:111]
    ds_read_b64_tr_b16 a[52:53], v203 offset:8192
    v_accvgpr_read_b32 v228, a144
    v_mfma_f32_16x16x32_bf16 v[108:111], a[36:39], a[252:255], v[108:111]
    s_add_u32 s75, s85, 1310720
    v_accvgpr_read_b32 v229, a145
    s_add_u32 s62, s70, s71
    v_mfma_f32_16x16x32_bf16 v[72:75], a[32:35], a[96:99], v[72:75]
    ds_read_b64_tr_b16 a[54:55], v203 offset:10240
    v_mfma_f32_16x16x32_bf16 v[72:75], a[36:39], a[104:107], v[72:75]
    buffer_load_dwordx4 a[208:211], v13, s[20:23], s75 offen sc1
    v_accvgpr_read_b32 v230, a146
    v_mfma_f32_16x16x32_bf16 v[76:79], a[32:35], a[100:103], v[76:79]
    ds_read_b64_tr_b16 a[0:1], v200 offset:4096
    s_xor_b32 s71, s60, 3
    v_mfma_f32_16x16x32_bf16 v[76:79], a[36:39], a[108:111], v[76:79]
    s_waitcnt lgkmcnt(5)
    v_accvgpr_read_b32 v231, a147
    v_mfma_f32_16x16x32_bf16 v[112:115], a[40:43], a[240:243], v[112:115]
    ds_read_b64_tr_b16 a[2:3], v200 offset:6144
    v_mfma_f32_16x16x32_bf16 v[112:115], a[44:47], a[248:251], v[112:115]
    buffer_load_dwordx4 a[212:215], v13, s[20:23], s75 offen offset:1024 sc1
    v_accvgpr_read_b32 v236, a148
    v_mfma_f32_16x16x32_bf16 v[116:119], a[40:43], a[244:247], v[116:119]
    ds_read_b64_tr_b16 a[4:5], v200 offset:12288
    s_mul_i32 s71, s71, 3670016
    v_mfma_f32_16x16x32_bf16 v[116:119], a[44:47], a[252:255], v[116:119]
    v_accvgpr_read_b32 v237, a149
    v_mfma_f32_16x16x32_bf16 v[80:83], a[40:43], a[96:99], v[80:83]
    ds_read_b64_tr_b16 a[6:7], v200 offset:14336
    v_mfma_f32_16x16x32_bf16 v[80:83], a[44:47], a[104:107], v[80:83]
    buffer_load_dwordx4 a[216:219], v13, s[20:23], s75 offen offset:2048 sc1
    v_accvgpr_read_b32 v238, a150
    v_mfma_f32_16x16x32_bf16 v[84:87], a[40:43], a[100:103], v[84:87]
    ds_read_b64_tr_b16 a[8:9], v201 offset:4096
    s_add_u32 s63, s70, s71
    v_mfma_f32_16x16x32_bf16 v[84:87], a[44:47], a[108:111], v[84:87]
    s_waitcnt lgkmcnt(5)
    v_accvgpr_read_b32 v239, a151
    v_mfma_f32_16x16x32_bf16 v[120:123], a[48:51], a[240:243], v[120:123]
    ds_read_b64_tr_b16 a[10:11], v201 offset:6144
    v_lshl_add_u32 v208, v208, 11, s54
    v_mfma_f32_16x16x32_bf16 v[120:123], a[52:55], a[248:251], v[120:123]
    buffer_load_dwordx4 a[220:223], v13, s[20:23], s75 offen offset:3072 sc1
    v_accvgpr_read_b32 v244, a152
    v_mfma_f32_16x16x32_bf16 v[124:127], a[48:51], a[244:247], v[124:127]
    ds_read_b64_tr_b16 a[12:13], v201 offset:12288
    v_accvgpr_read_b32 v245, a153
    v_mfma_f32_16x16x32_bf16 v[124:127], a[52:55], a[252:255], v[124:127]
    s_add_u32 s75, s56, 1572864
    s_xor_b32 s71, s60, 2
    v_mfma_f32_16x16x32_bf16 v[88:91], a[48:51], a[96:99], v[88:91]
    ds_read_b64_tr_b16 a[14:15], v201 offset:14336
    v_accvgpr_read_b32 v246, a154
    v_mfma_f32_16x16x32_bf16 v[88:91], a[52:55], a[104:107], v[88:91]
    buffer_load_dwordx4 a[224:227], v13, s[20:23], s75 offen sc1
    v_mfma_f32_16x16x32_bf16 v[92:95], a[48:51], a[100:103], v[92:95]
    ds_read_b64_tr_b16 a[16:17], v202 offset:4096
    v_accvgpr_read_b32 v247, a155
    v_mfma_f32_16x16x32_bf16 v[92:95], a[52:55], a[108:111], v[92:95]
    s_waitcnt lgkmcnt(5)
    s_mul_i32 s71, s71, 3670016
    v_mfma_f32_16x16x32_bf16 v[128:131], a[0:3], a[240:243], v[128:131]
    ds_read_b64_tr_b16 a[18:19], v202 offset:6144
    v_accvgpr_read_b32 v252, a156
    v_mfma_f32_16x16x32_bf16 v[128:131], a[4:7], a[248:251], v[128:131]
    v_mfma_f32_16x16x32_bf16 v[132:135], a[0:3], a[244:247], v[132:135]
    ds_read_b64_tr_b16 a[20:21], v202 offset:12288
    v_accvgpr_read_b32 v253, a157
    v_mfma_f32_16x16x32_bf16 v[132:135], a[4:7], a[252:255], v[132:135]
    buffer_load_dwordx4 a[228:231], v13, s[20:23], s75 offen offset:1024 sc1
    s_add_u32 s64, s70, s71
    v_mfma_f32_16x16x32_bf16 v[32:35], a[0:3], a[96:99], v[32:35]
    ds_read_b64_tr_b16 a[22:23], v202 offset:14336
    v_accvgpr_read_b32 v254, a158
    v_mfma_f32_16x16x32_bf16 v[32:35], a[4:7], a[104:107], v[32:35]
    v_mfma_f32_16x16x32_bf16 v[36:39], a[0:3], a[100:103], v[36:39]
    ds_read_b64_tr_b16 a[24:25], v203 offset:4096
    v_accvgpr_read_b32 v255, a159
    v_mfma_f32_16x16x32_bf16 v[36:39], a[4:7], a[108:111], v[36:39]
    s_waitcnt lgkmcnt(5)
    v_mfma_f32_16x16x32_bf16 v[136:139], a[8:11], a[240:243], v[136:139]
    ds_read_b64_tr_b16 a[26:27], v203 offset:6144
    v_mfma_f32_16x16x32_bf16 v[136:139], a[12:15], a[248:251], v[136:139]
    buffer_load_dwordx4 a[232:235], v13, s[20:23], s75 offen offset:2048 sc1
    v_bfe_u32 v206, v13, 8, 1
    v_mfma_f32_16x16x32_bf16 v[140:143], a[8:11], a[244:247], v[140:143]
    ds_read_b64_tr_b16 a[28:29], v203 offset:12288
    s_mov_b32 s73, 32768
    v_permlane16_swap_b32 v228, v230
    v_permlane16_swap_b32 v229, v231
    v_lshlrev_b32 v224, 16, v228
    v_and_b32 v225, 0xffff0000, v228
    v_lshlrev_b32 v226, 16, v229
    v_and_b32 v227, 0xffff0000, v229
    v_lshlrev_b32 v228, 16, v230
    v_and_b32 v229, 0xffff0000, v230
    v_lshlrev_b32 v230, 16, v231
    v_and_b32 v231, 0xffff0000, v231
    v_permlane16_swap_b32 v236, v238
    v_permlane16_swap_b32 v237, v239
    v_lshlrev_b32 v232, 16, v236
    v_and_b32 v233, 0xffff0000, v236
    v_lshlrev_b32 v234, 16, v237
    v_and_b32 v235, 0xffff0000, v237
    v_lshlrev_b32 v236, 16, v238
    v_and_b32 v237, 0xffff0000, v238
L_pad0_11:
    s_cbranch_execz L_pad0_15
    v_lshlrev_b32 v238, 16, v239
    v_and_b32 v239, 0xffff0000, v239
    v_permlane16_swap_b32 v244, v246
    v_permlane16_swap_b32 v245, v247
    v_lshlrev_b32 v240, 16, v244
    v_and_b32 v241, 0xffff0000, v244
    v_lshlrev_b32 v242, 16, v245
    v_and_b32 v243, 0xffff0000, v245
    v_lshlrev_b32 v244, 16, v246
    v_and_b32 v245, 0xffff0000, v246
    v_lshlrev_b32 v246, 16, v247
    v_mfma_f32_16x16x32_bf16 v[140:143], a[12:15], a[252:255], v[140:143]
    buffer_load_dwordx4 a[236:239], v13, s[20:23], s75 offen offset:3072 sc1
    v_mfma_f32_16x16x32_bf16 v[40:43], a[8:11], a[96:99], v[40:43]
    ds_read_b64_tr_b16 a[30:31], v203 offset:14336
    v_mfma_f32_16x16x32_bf16 v[40:43], a[12:15], a[104:107], v[40:43]
    s_add_u32 s75, s85, 1572864
    s_barrier
    v_mfma_f32_16x16x32_bf16 v[44:47], a[8:11], a[100:103], v[44:47]
    ds_read_b64_tr_b16 a[32:33], v192
    v_mfma_f32_16x16x32_bf16 v[44:47], a[12:15], a[108:111], v[44:47]
    s_waitcnt lgkmcnt(5)
    v_mfma_f32_16x16x32_bf16 v[144:147], a[16:19], a[240:243], v[144:147]
    ds_read_b64_tr_b16 a[34:35], v192 offset:2048
    v_mfma_f32_16x16x32_bf16 v[144:147], a[20:23], a[248:251], v[144:147]
    buffer_load_dwordx4 a[128:131], v13, s[20:23], s75 offen sc1
    v_mfma_f32_16x16x32_bf16 v[148:151], a[16:19], a[244:247], v[148:151]
    ds_read_b64_tr_b16 a[36:37], v192 offset:8192
    v_mfma_f32_16x16x32_bf16 v[148:151], a[20:23], a[252:255], v[148:151]
    buffer_load_dwordx4 a[132:135], v13, s[20:23], s75 offen offset:1024 sc1
    v_mfma_f32_16x16x32_bf16 v[48:51], a[16:19], a[96:99], v[48:51]
    ds_read_b64_tr_b16 a[38:39], v192 offset:10240
    v_mfma_f32_16x16x32_bf16 v[48:51], a[20:23], a[104:107], v[48:51]
    v_mfma_f32_16x16x32_bf16 v[52:55], a[16:19], a[100:103], v[52:55]
    ds_read_b64_tr_b16 a[40:41], v193
    v_mfma_f32_16x16x32_bf16 v[52:55], a[20:23], a[108:111], v[52:55]
    s_waitcnt lgkmcnt(5)
    v_mfma_f32_16x16x32_bf16 v[152:155], a[24:27], a[240:243], v[152:155]
    ds_read_b64_tr_b16 a[42:43], v193 offset:2048
    v_mfma_f32_16x16x32_bf16 v[152:155], a[28:31], a[248:251], v[152:155]
    buffer_load_dwordx4 a[136:139], v13, s[20:23], s75 offen offset:2048 sc1
    v_mfma_f32_16x16x32_bf16 v[156:159], a[24:27], a[244:247], v[156:159]
    ds_read_b64_tr_b16 a[44:45], v193 offset:8192
    v_lshl_add_u32 v208, v206, 5, v208
    v_mfma_f32_16x16x32_bf16 v[156:159], a[28:31], a[252:255], v[156:159]
    v_mfma_f32_16x16x32_bf16 v[56:59], a[24:27], a[96:99], v[56:59]
    ds_read_b64_tr_b16 a[46:47], v193 offset:10240
    v_mfma_f32_16x16x32_bf16 v[56:59], a[28:31], a[104:107], v[56:59]
    buffer_load_dwordx4 a[140:143], v13, s[20:23], s75 offen offset:3072 sc1
    v_mfma_f32_16x16x32_bf16 v[60:63], a[24:27], a[100:103], v[60:63]
    ds_read_b64_tr_b16 a[48:49], v194
    v_mfma_f32_16x16x32_bf16 v[60:63], a[28:31], a[108:111], v[60:63]
    s_waitcnt vmcnt(17) lgkmcnt(5)
    v_mfma_f32_16x16x32_bf16 v[96:99], a[32:35], a[160:163], v[96:99]
    ds_read_b64_tr_b16 a[50:51], v194 offset:2048
    v_mfma_f32_16x16x32_bf16 v[96:99], a[36:39], a[168:171], v[96:99]
    s_add_u32 s75, s56, 1835008
    v_mfma_f32_16x16x32_bf16 v[100:103], a[32:35], a[164:167], v[100:103]
    ds_read_b64_tr_b16 a[52:53], v194 offset:8192
    s_waitcnt vmcnt(13)
    s_barrier
    s_cmp_lg_u32 s44, 0
    s_cbranch_scc1 L_fh2a_skip
    v_accvgpr_write_b32 a124, 2
    s_mov_b64 exec, 1
    buffer_store_dword a124, off, s[20:23], s81 sc1
    s_mov_b64 exec, -1
L_fh2a_skip:
    v_mfma_f32_16x16x32_bf16 v[100:103], a[36:39], a[172:175], v[100:103]
    buffer_load_dwordx4 a[240:243], v13, s[20:23], s75 offen sc1
    v_mfma_f32_16x16x32_bf16 v[64:67], a[32:35], a[176:179], v[64:67]
    ds_read_b64_tr_b16 a[54:55], v194 offset:10240
    v_mfma_f32_16x16x32_bf16 v[64:67], a[36:39], a[184:187], v[64:67]
    buffer_load_dwordx4 a[244:247], v13, s[20:23], s75 offen offset:1024 sc1
    v_mfma_f32_16x16x32_bf16 v[68:71], a[32:35], a[180:183], v[68:71]
    ds_read_b64_tr_b16 a[0:1], v195
    v_mfma_f32_16x16x32_bf16 v[68:71], a[36:39], a[188:191], v[68:71]
    s_waitcnt lgkmcnt(5)
    v_mfma_f32_16x16x32_bf16 v[104:107], a[40:43], a[160:163], v[104:107]
    ds_read_b64_tr_b16 a[2:3], v195 offset:2048
    v_mfma_f32_16x16x32_bf16 v[104:107], a[44:47], a[168:171], v[104:107]
    buffer_load_dwordx4 a[248:251], v13, s[20:23], s75 offen offset:2048 sc1
    v_mfma_f32_16x16x32_bf16 v[108:111], a[40:43], a[164:167], v[108:111]
    ds_read_b64_tr_b16 a[4:5], v195 offset:8192
    v_lshrrev_b32 v206, 9, v13
    v_mfma_f32_16x16x32_bf16 v[108:111], a[44:47], a[172:175], v[108:111]
    v_mfma_f32_16x16x32_bf16 v[72:75], a[40:43], a[176:179], v[72:75]
    ds_read_b64_tr_b16 a[6:7], v195 offset:10240
    v_mfma_f32_16x16x32_bf16 v[72:75], a[44:47], a[184:187], v[72:75]
    v_mfma_f32_16x16x32_bf16 v[76:79], a[40:43], a[180:183], v[76:79]
    ds_read_b64_tr_b16 a[8:9], v192 offset:4096
    v_mfma_f32_16x16x32_bf16 v[76:79], a[44:47], a[188:191], v[76:79]
    s_waitcnt lgkmcnt(5)
    v_mfma_f32_16x16x32_bf16 v[112:115], a[48:51], a[160:163], v[112:115]
    ds_read_b64_tr_b16 a[10:11], v192 offset:6144
    v_mfma_f32_16x16x32_bf16 v[112:115], a[52:55], a[168:171], v[112:115]
    buffer_load_dwordx4 a[252:255], v13, s[20:23], s75 offen offset:3072 sc1
    v_mfma_f32_16x16x32_bf16 v[116:119], a[48:51], a[164:167], v[116:119]
    ds_read_b64_tr_b16 a[12:13], v192 offset:12288
    v_and_b32 v247, 0xffff0000, v247
    v_permlane16_swap_b32 v252, v254
    v_permlane16_swap_b32 v253, v255
    v_lshlrev_b32 v248, 16, v252
    v_and_b32 v249, 0xffff0000, v252
    v_lshlrev_b32 v250, 16, v253
    v_and_b32 v251, 0xffff0000, v253
    v_lshlrev_b32 v252, 16, v254
    v_and_b32 v253, 0xffff0000, v254
    v_lshlrev_b32 v254, 16, v255
    v_and_b32 v255, 0xffff0000, v255
    v_bfe_u32 v2, v13, 5, 3
    v_lshrrev_b32 v3, 8, v13
    v_lshlrev_b32 v3, 1, v3
    v_sub_u32 v2, v2, v3
    v_and_b32 v3, 16, v13
    v_mov_b32 v6, 0x3f80
    v_lshlrev_b32 v6, v3, v6
    v_cmp_eq_u32 vcc, 0, v2
    s_nop 1
    v_cndmask_b32 v4, 0, v6, vcc
    v_cmp_eq_u32 vcc, 1, v2
    s_nop 1
    v_cndmask_b32 v5, 0, v6, vcc
    v_mov_b32 v2, 0
    v_mov_b32 v3, 0
    v_mov_b32 v6, 0
    v_mov_b32 v7, 0
    s_lshl2_add_u32 s72, s2, s44
    s_lshl_b32 s72, s72, 12
    s_add_u32 s72, s72, 50331648
    v_mfma_f32_16x16x32_bf16 v[116:119], a[52:55], a[172:175], v[116:119]
    s_add_u32 s75, s85, 1835008
    v_mfma_f32_16x16x32_bf16 v[80:83], a[48:51], a[176:179], v[80:83]
    ds_read_b64_tr_b16 a[14:15], v192 offset:14336
    v_mfma_f32_16x16x32_bf16 v[80:83], a[52:55], a[184:187], v[80:83]
    buffer_load_dwordx4 a[96:99], v13, s[20:23], s75 offen sc1
    v_mfma_f32_16x16x32_bf16 v[84:87], a[48:51], a[180:183], v[84:87]
    ds_read_b64_tr_b16 a[16:17], v193 offset:4096
    v_mfma_f32_16x16x32_bf16 v[84:87], a[52:55], a[188:191], v[84:87]
    s_waitcnt lgkmcnt(5)
    v_mfma_f32_16x16x32_bf16 v[120:123], a[0:3], a[160:163], v[120:123]
    ds_read_b64_tr_b16 a[18:19], v193 offset:6144
    v_mfma_f32_16x16x32_bf16 v[120:123], a[4:7], a[168:171], v[120:123]
    buffer_load_dwordx4 a[100:103], v13, s[20:23], s75 offen offset:1024 sc1
    v_mfma_f32_16x16x32_bf16 v[124:127], a[0:3], a[164:167], v[124:127]
    ds_read_b64_tr_b16 a[20:21], v193 offset:12288
    v_mfma_f32_16x16x32_bf16 v[124:127], a[4:7], a[172:175], v[124:127]
    buffer_load_dwordx4 a[104:107], v13, s[20:23], s75 offen offset:2048 sc1
    v_lshl_add_u32 v208, v206, 4, v208
    v_mfma_f32_16x16x32_bf16 v[88:91], a[0:3], a[176:179], v[88:91]
    ds_read_b64_tr_b16 a[22:23], v193 offset:14336
    v_mfma_f32_16x16x32_bf16 v[88:91], a[4:7], a[184:187], v[88:91]
    v_mfma_f32_16x16x32_bf16 v[92:95], a[0:3], a[180:183], v[92:95]
    ds_read_b64_tr_b16 a[24:25], v194 offset:4096
    v_mfma_f32_16x16x32_bf16 v[92:95], a[4:7], a[188:191], v[92:95]
    s_waitcnt lgkmcnt(5)
    v_mfma_f32_16x16x32_bf16 v[128:131], a[8:11], a[160:163], v[128:131]
    ds_read_b64_tr_b16 a[26:27], v194 offset:6144
    v_mfma_f32_16x16x32_bf16 v[128:131], a[12:15], a[168:171], v[128:131]
    buffer_load_dwordx4 a[108:111], v13, s[20:23], s75 offen offset:3072 sc1
    v_mfma_f32_16x16x32_bf16 v[132:135], a[8:11], a[164:167], v[132:135]
    ds_read_b64_tr_b16 a[28:29], v194 offset:12288
    v_mfma_f32_16x16x32_bf16 v[132:135], a[12:15], a[172:175], v[132:135]
    s_add_u32 m0, s59, 98304
    v_mfma_f32_16x16x32_bf16 v[32:35], a[8:11], a[176:179], v[32:35]
    ds_read_b64_tr_b16 a[30:31], v194 offset:14336
    v_mfma_f32_16x16x32_bf16 v[32:35], a[12:15], a[184:187], v[32:35]
    s_add_u32 s74, s53, 1441792
    v_mfma_f32_16x16x32_bf16 v[36:39], a[8:11], a[180:183], v[36:39]
    ds_read_b64_tr_b16 a[32:33], v195 offset:4096
    v_mfma_f32_16x16x32_bf16 v[36:39], a[12:15], a[188:191], v[36:39]
    s_waitcnt lgkmcnt(5)
    v_mfma_f32_16x16x32_bf16 v[136:139], a[16:19], a[160:163], v[136:139]
    ds_read_b64_tr_b16 a[34:35], v195 offset:6144
    v_mfma_f32_16x16x32_bf16 v[136:139], a[20:23], a[168:171], v[136:139]
    buffer_load_dwordx4 v9, s[24:27], s74 offen lds
    v_mfma_f32_16x16x32_bf16 v[140:143], a[16:19], a[164:167], v[140:143]
    ds_read_b64_tr_b16 a[36:37], v195 offset:12288
    v_mfma_f32_16x16x32_bf16 v[140:143], a[20:23], a[172:175], v[140:143]
    buffer_load_dwordx4 v10, s[24:27], s74 offen offset:1024 lds
    v_mfma_f32_16x16x32_bf16 v[40:43], a[16:19], a[176:179], v[40:43]
    ds_read_b64_tr_b16 a[38:39], v195 offset:14336
    v_mfma_f32_16x16x32_bf16 v[40:43], a[20:23], a[184:187], v[40:43]
    buffer_load_dwordx4 v11, s[24:27], s74 offen offset:2048 lds
    v_mfma_f32_16x16x32_bf16 v[44:47], a[16:19], a[180:183], v[44:47]
    ds_read_b64_tr_b16 a[40:41], v192 offset:16384
    v_mfma_f32_16x16x32_bf16 v[44:47], a[20:23], a[188:191], v[44:47]
    s_waitcnt lgkmcnt(5)
    v_mfma_f32_16x16x32_bf16 v[144:147], a[24:27], a[160:163], v[144:147]
    ds_read_b64_tr_b16 a[42:43], v192 offset:18432
    v_mfma_f32_16x16x32_bf16 v[144:147], a[28:31], a[168:171], v[144:147]
    buffer_load_dwordx4 v12, s[24:27], s74 offen offset:3072 lds
    v_mfma_f32_16x16x32_bf16 v[148:151], a[24:27], a[164:167], v[148:151]
    ds_read_b64_tr_b16 a[44:45], v192 offset:24576
    v_mfma_f32_16x16x32_bf16 v[148:151], a[28:31], a[172:175], v[148:151]
    s_add_u32 m0, s59, 114688
    v_mfma_f32_16x16x32_bf16 v[48:51], a[24:27], a[176:179], v[48:51]
    ds_read_b64_tr_b16 a[46:47], v192 offset:26624
    v_mfma_f32_16x16x32_bf16 v[48:51], a[28:31], a[184:187], v[48:51]
    s_add_u32 s74, s53, 1572864
    v_mfma_f32_16x16x32_bf16 v[52:55], a[24:27], a[180:183], v[52:55]
    ds_read_b64_tr_b16 a[48:49], v193 offset:16384
    v_mfma_f32_16x16x32_bf16 v[52:55], a[28:31], a[188:191], v[52:55]
    s_waitcnt lgkmcnt(5)
    v_mfma_f32_16x16x32_bf16 v[152:155], a[32:35], a[160:163], v[152:155]
    ds_read_b64_tr_b16 a[50:51], v193 offset:18432
    v_mfma_f32_16x16x32_bf16 v[152:155], a[36:39], a[168:171], v[152:155]
    buffer_load_dwordx4 v9, s[24:27], s74 offen lds
    v_mfma_f32_16x16x32_bf16 v[156:159], a[32:35], a[164:167], v[156:159]
    ds_read_b64_tr_b16 a[52:53], v193 offset:24576
    v_mfma_f32_16x16x32_bf16 v[156:159], a[36:39], a[172:175], v[156:159]
    buffer_load_dwordx4 v10, s[24:27], s74 offen offset:1024 lds
    v_mfma_f32_16x16x32_bf16 v[56:59], a[32:35], a[176:179], v[56:59]
    ds_read_b64_tr_b16 a[54:55], v193 offset:26624
    v_mfma_f32_16x16x32_bf16 v[56:59], a[36:39], a[184:187], v[56:59]
    v_mfma_f32_16x16x32_bf16 v[60:63], a[32:35], a[180:183], v[60:63]
    ds_read_b64_tr_b16 a[0:1], v194 offset:16384
    v_mfma_f32_16x16x32_bf16 v[60:63], a[36:39], a[188:191], v[60:63]
    s_waitcnt vmcnt(22) lgkmcnt(5)
    v_mfma_f32_16x16x32_bf16 v[96:99], a[40:43], a[192:195], v[96:99]
    ds_read_b64_tr_b16 a[2:3], v194 offset:18432
    v_mfma_f32_16x16x32_bf16 v[96:99], a[44:47], a[200:203], v[96:99]
    buffer_load_dwordx4 v11, s[24:27], s74 offen offset:2048 lds
    v_mfma_f32_16x16x32_bf16 v[100:103], a[40:43], a[196:199], v[100:103]
    ds_read_b64_tr_b16 a[4:5], v194 offset:24576
    v_mfma_f32_16x16x32_bf16 v[100:103], a[44:47], a[204:207], v[100:103]
    buffer_load_dwordx4 v12, s[24:27], s74 offen offset:3072 lds
    v_mfma_f32_16x16x32_bf16 v[64:67], a[40:43], a[208:211], v[64:67]
    ds_read_b64_tr_b16 a[6:7], v194 offset:26624
    v_mfma_f32_16x16x32_bf16 v[64:67], a[44:47], a[216:219], v[64:67]
    v_mfma_f32_16x16x32_bf16 v[68:71], a[40:43], a[212:215], v[68:71]
    ds_read_b64_tr_b16 a[8:9], v195 offset:16384
    v_mfma_f32_16x16x32_bf16 v[68:71], a[44:47], a[220:223], v[68:71]
    s_waitcnt lgkmcnt(5)
    v_mfma_f32_16x16x32_bf16 v[104:107], a[48:51], a[192:195], v[104:107]
    ds_read_b64_tr_b16 a[10:11], v195 offset:18432
    v_mfma_f32_16x16x32_bf16 v[104:107], a[52:55], a[200:203], v[104:107]
    v_mfma_f32_16x16x32_bf16 v[108:111], a[48:51], a[196:199], v[108:111]
    ds_read_b64_tr_b16 a[12:13], v195 offset:24576
    v_mfma_f32_16x16x32_bf16 v[108:111], a[52:55], a[204:207], v[108:111]
    v_mfma_f32_16x16x32_bf16 v[72:75], a[48:51], a[208:211], v[72:75]
    ds_read_b64_tr_b16 a[14:15], v195 offset:26624
    v_mfma_f32_16x16x32_bf16 v[72:75], a[52:55], a[216:219], v[72:75]
    v_mfma_f32_16x16x32_bf16 v[76:79], a[48:51], a[212:215], v[76:79]
    ds_read_b64_tr_b16 a[16:17], v192 offset:20480
    v_mfma_f32_16x16x32_bf16 v[76:79], a[52:55], a[220:223], v[76:79]
    s_waitcnt lgkmcnt(5)
    s_add_u32 s76, s76, 32
    v_mfma_f32_16x16x32_bf16 v[112:115], a[0:3], a[192:195], v[112:115]
    ds_read_b64_tr_b16 a[18:19], v192 offset:22528
    buffer_load_dword v206, v204, s[20:23], s76 offen sc1
    v_mfma_f32_16x16x32_bf16 v[112:115], a[4:7], a[200:203], v[112:115]
    v_mfma_f32_16x16x32_bf16 v[116:119], a[0:3], a[196:199], v[116:119]
    ds_read_b64_tr_b16 a[20:21], v192 offset:28672
    v_mfma_f32_16x16x32_bf16 v[116:119], a[4:7], a[204:207], v[116:119]
    v_mfma_f32_16x16x32_bf16 v[80:83], a[0:3], a[208:211], v[80:83]
    ds_read_b64_tr_b16 a[22:23], v192 offset:30720
    v_mfma_f32_16x16x32_bf16 v[80:83], a[4:7], a[216:219], v[80:83]
    v_mfma_f32_16x16x32_bf16 v[84:87], a[0:3], a[212:215], v[84:87]
    ds_read_b64_tr_b16 a[24:25], v193 offset:20480
    v_mfma_f32_16x16x32_bf16 v[84:87], a[4:7], a[220:223], v[84:87]
    s_waitcnt lgkmcnt(5)
    v_mfma_f32_16x16x32_bf16 v[120:123], a[8:11], a[192:195], v[120:123]
    ds_read_b64_tr_b16 a[26:27], v193 offset:22528
    v_mfma_f32_16x16x32_bf16 v[120:123], a[12:15], a[200:203], v[120:123]
    v_mfma_f32_16x16x32_bf16 v[124:127], a[8:11], a[196:199], v[124:127]
    ds_read_b64_tr_b16 a[28:29], v193 offset:28672
    v_mfma_f32_16x16x32_bf16 v[124:127], a[12:15], a[204:207], v[124:127]
    v_mfma_f32_16x16x32_bf16 v[88:91], a[8:11], a[208:211], v[88:91]
    ds_read_b64_tr_b16 a[30:31], v193 offset:30720
    v_mfma_f32_16x16x32_bf16 v[88:91], a[12:15], a[216:219], v[88:91]
    v_mfma_f32_16x16x32_bf16 v[92:95], a[8:11], a[212:215], v[92:95]
    ds_read_b64_tr_b16 a[32:33], v194 offset:20480
    v_mfma_f32_16x16x32_bf16 v[92:95], a[12:15], a[220:223], v[92:95]
    s_waitcnt lgkmcnt(5)
    v_mfma_f32_16x16x32_bf16 v[128:131], a[16:19], a[192:195], v[128:131]
    ds_read_b64_tr_b16 a[34:35], v194 offset:22528
    v_mfma_f32_16x16x32_bf16 v[128:131], a[20:23], a[200:203], v[128:131]
    v_mfma_f32_16x16x32_bf16 v[132:135], a[16:19], a[196:199], v[132:135]
    ds_read_b64_tr_b16 a[36:37], v194 offset:28672
    v_mfma_f32_16x16x32_bf16 v[132:135], a[20:23], a[204:207], v[132:135]
    v_mfma_f32_16x16x32_bf16 v[32:35], a[16:19], a[208:211], v[32:35]
    ds_read_b64_tr_b16 a[38:39], v194 offset:30720
    v_mfma_f32_16x16x32_bf16 v[32:35], a[20:23], a[216:219], v[32:35]
    v_mfma_f32_16x16x32_bf16 v[36:39], a[16:19], a[212:215], v[36:39]
    ds_read_b64_tr_b16 a[40:41], v195 offset:20480
    v_mfma_f32_16x16x32_bf16 v[36:39], a[20:23], a[220:223], v[36:39]
    s_waitcnt lgkmcnt(5)
    v_mfma_f32_16x16x32_bf16 v[136:139], a[24:27], a[192:195], v[136:139]
    ds_read_b64_tr_b16 a[42:43], v195 offset:22528
    v_mfma_f32_16x16x32_bf16 v[136:139], a[28:31], a[200:203], v[136:139]
    v_mfma_f32_16x16x32_bf16 v[140:143], a[24:27], a[196:199], v[140:143]
    ds_read_b64_tr_b16 a[44:45], v195 offset:28672
    v_mfma_f32_16x16x32_bf16 v[140:143], a[28:31], a[204:207], v[140:143]
    v_mfma_f32_16x16x32_bf16 v[40:43], a[24:27], a[208:211], v[40:43]
    ds_read_b64_tr_b16 a[46:47], v195 offset:30720
    v_mfma_f32_16x16x32_bf16 v[40:43], a[28:31], a[216:219], v[40:43]
    s_add_u32 m0, s59, 131072
    s_barrier
    v_mfma_f32_16x16x32_bf16 v[44:47], a[24:27], a[212:215], v[44:47]
    ds_read_b64_tr_b16 a[48:49], v192 offset:32768
    v_mfma_f32_16x16x32_bf16 v[44:47], a[28:31], a[220:223], v[44:47]
    s_waitcnt lgkmcnt(5)
    v_mfma_f32_16x16x32_bf16 v[144:147], a[32:35], a[192:195], v[144:147]
    ds_read_b64_tr_b16 a[50:51], v192 offset:34816
    v_mfma_f32_16x16x32_bf16 v[144:147], a[36:39], a[200:203], v[144:147]
    s_add_u32 s74, s53, 1703936
    v_mfma_f32_16x16x32_bf16 v[148:151], a[32:35], a[196:199], v[148:151]
    ds_read_b64_tr_b16 a[52:53], v192 offset:40960
    v_mfma_f32_16x16x32_bf16 v[148:151], a[36:39], a[204:207], v[148:151]
    buffer_load_dwordx4 v9, s[24:27], s74 offen lds
    v_mfma_f32_16x16x32_bf16 v[48:51], a[32:35], a[208:211], v[48:51]
    ds_read_b64_tr_b16 a[54:55], v192 offset:43008
    v_mfma_f32_16x16x32_bf16 v[48:51], a[36:39], a[216:219], v[48:51]
    buffer_load_dwordx4 v10, s[24:27], s74 offen offset:1024 lds
    v_mfma_f32_16x16x32_bf16 v[52:55], a[32:35], a[212:215], v[52:55]
    ds_read_b64_tr_b16 a[0:1], v193 offset:32768
    v_mfma_f32_16x16x32_bf16 v[52:55], a[36:39], a[220:223], v[52:55]
    s_waitcnt lgkmcnt(5)
    v_mfma_f32_16x16x32_bf16 v[152:155], a[40:43], a[192:195], v[152:155]
    ds_read_b64_tr_b16 a[2:3], v193 offset:34816
    v_mfma_f32_16x16x32_bf16 v[152:155], a[44:47], a[200:203], v[152:155]
    buffer_load_dwordx4 v11, s[24:27], s74 offen offset:2048 lds
    v_mfma_f32_16x16x32_bf16 v[156:159], a[40:43], a[196:199], v[156:159]
    ds_read_b64_tr_b16 a[4:5], v193 offset:40960
    v_mfma_f32_16x16x32_bf16 v[156:159], a[44:47], a[204:207], v[156:159]
    s_add_u32 s75, s56, 2097152
    v_mfma_f32_16x16x32_bf16 v[56:59], a[40:43], a[208:211], v[56:59]
    ds_read_b64_tr_b16 a[6:7], v193 offset:43008
    s_waitcnt vmcnt(3)
    v_cmp_le_u32 vcc, 1, v206
    s_nop 0
    s_cmp_eq_u64 vcc, -1
    s_cbranch_scc0 L_phaa_spin
L_phaa_ok:
    v_mfma_f32_16x16x32_bf16 v[56:59], a[44:47], a[216:219], v[56:59]
    buffer_load_dwordx4 a[160:163], v13, s[20:23], s75 offen sc1
    v_mfma_f32_16x16x32_bf16 v[60:63], a[40:43], a[212:215], v[60:63]
    ds_read_b64_tr_b16 a[8:9], v194 offset:32768
    v_mfma_f32_16x16x32_bf16 v[60:63], a[44:47], a[220:223], v[60:63]
    s_waitcnt lgkmcnt(5)
    v_mfma_f32_16x16x32_bf16 v[96:99], a[48:51], a[224:227], v[96:99]
    ds_read_b64_tr_b16 a[10:11], v194 offset:34816
    v_mfma_f32_16x16x32_bf16 v[96:99], a[52:55], a[232:235], v[96:99]
    buffer_load_dwordx4 a[164:167], v13, s[20:23], s75 offen offset:1024 sc1
    v_mfma_f32_16x16x32_bf16 v[100:103], a[48:51], a[228:231], v[100:103]
    ds_read_b64_tr_b16 a[12:13], v194 offset:40960
    v_mfma_f32_16x16x32_bf16 v[100:103], a[52:55], a[236:239], v[100:103]
    v_mfma_f32_16x16x32_bf16 v[64:67], a[48:51], a[128:131], v[64:67]
    ds_read_b64_tr_b16 a[14:15], v194 offset:43008
    v_mfma_f32_16x16x32_bf16 v[64:67], a[52:55], a[136:139], v[64:67]
    v_mfma_f32_16x16x32_bf16 v[68:71], a[48:51], a[132:135], v[68:71]
    ds_read_b64_tr_b16 a[16:17], v195 offset:32768
    v_mfma_f32_16x16x32_bf16 v[68:71], a[52:55], a[140:143], v[68:71]
    s_waitcnt lgkmcnt(5)
    v_mfma_f32_16x16x32_bf16 v[104:107], a[0:3], a[224:227], v[104:107]
    ds_read_b64_tr_b16 a[18:19], v195 offset:34816
    v_mfma_f32_16x16x32_bf16 v[104:107], a[4:7], a[232:235], v[104:107]
    buffer_load_dwordx4 a[168:171], v13, s[20:23], s75 offen offset:2048 sc1
    v_mfma_f32_16x16x32_bf16 v[108:111], a[0:3], a[228:231], v[108:111]
    ds_read_b64_tr_b16 a[20:21], v195 offset:40960
    v_mfma_f32_16x16x32_bf16 v[108:111], a[4:7], a[236:239], v[108:111]
    buffer_load_dwordx4 a[172:175], v13, s[20:23], s75 offen offset:3072 sc1
    v_mfma_f32_16x16x32_bf16 v[72:75], a[0:3], a[128:131], v[72:75]
    ds_read_b64_tr_b16 a[22:23], v195 offset:43008
    v_mfma_f32_16x16x32_bf16 v[72:75], a[4:7], a[136:139], v[72:75]
    s_add_u32 s75, s85, 2097152
    v_mfma_f32_16x16x32_bf16 v[76:79], a[0:3], a[132:135], v[76:79]
    ds_read_b64_tr_b16 a[24:25], v192 offset:36864
    v_mfma_f32_16x16x32_bf16 v[76:79], a[4:7], a[140:143], v[76:79]
    s_waitcnt lgkmcnt(5)
    v_mfma_f32_16x16x32_bf16 v[112:115], a[8:11], a[224:227], v[112:115]
    ds_read_b64_tr_b16 a[26:27], v192 offset:38912
    v_mfma_f32_16x16x32_bf16 v[112:115], a[12:15], a[232:235], v[112:115]
    buffer_load_dwordx4 a[176:179], v13, s[20:23], s75 offen sc1
    v_mfma_f32_16x16x32_bf16 v[116:119], a[8:11], a[228:231], v[116:119]
    ds_read_b64_tr_b16 a[28:29], v192 offset:45056
    v_mfma_f32_16x16x32_bf16 v[116:119], a[12:15], a[236:239], v[116:119]
    buffer_load_dwordx4 a[180:183], v13, s[20:23], s75 offen offset:1024 sc1
    v_mfma_f32_16x16x32_bf16 v[80:83], a[8:11], a[128:131], v[80:83]
    ds_read_b64_tr_b16 a[30:31], v192 offset:47104
    v_mfma_f32_16x16x32_bf16 v[80:83], a[12:15], a[136:139], v[80:83]
    v_mfma_f32_16x16x32_bf16 v[84:87], a[8:11], a[132:135], v[84:87]
    ds_read_b64_tr_b16 a[32:33], v193 offset:36864
    v_mfma_f32_16x16x32_bf16 v[84:87], a[12:15], a[140:143], v[84:87]
    s_waitcnt lgkmcnt(5)
    v_mfma_f32_16x16x32_bf16 v[120:123], a[16:19], a[224:227], v[120:123]
    ds_read_b64_tr_b16 a[34:35], v193 offset:38912
    v_mfma_f32_16x16x32_bf16 v[120:123], a[20:23], a[232:235], v[120:123]
    buffer_load_dwordx4 a[184:187], v13, s[20:23], s75 offen offset:2048 sc1
    v_mfma_f32_16x16x32_bf16 v[124:127], a[16:19], a[228:231], v[124:127]
    ds_read_b64_tr_b16 a[36:37], v193 offset:45056
    v_mfma_f32_16x16x32_bf16 v[124:127], a[20:23], a[236:239], v[124:127]
    v_mfma_f32_16x16x32_bf16 v[88:91], a[16:19], a[128:131], v[88:91]
    ds_read_b64_tr_b16 a[38:39], v193 offset:47104
    v_mfma_f32_16x16x32_bf16 v[88:91], a[20:23], a[136:139], v[88:91]
    buffer_load_dwordx4 a[188:191], v13, s[20:23], s75 offen offset:3072 sc1
    v_mfma_f32_16x16x32_bf16 v[92:95], a[16:19], a[132:135], v[92:95]
    ds_read_b64_tr_b16 a[40:41], v194 offset:36864
    v_mfma_f32_16x16x32_bf16 v[92:95], a[20:23], a[140:143], v[92:95]
    s_waitcnt lgkmcnt(5)
    v_mfma_f32_16x16x32_bf16 v[128:131], a[24:27], a[224:227], v[128:131]
    ds_read_b64_tr_b16 a[42:43], v194 offset:38912
    v_mfma_f32_16x16x32_bf16 v[128:131], a[28:31], a[232:235], v[128:131]
    s_add_u32 s75, s56, 2359296
    v_mfma_f32_16x16x32_bf16 v[132:135], a[24:27], a[228:231], v[132:135]
    ds_read_b64_tr_b16 a[44:45], v194 offset:45056
    v_mfma_f32_16x16x32_bf16 v[132:135], a[28:31], a[236:239], v[132:135]
    buffer_load_dwordx4 a[192:195], v13, s[20:23], s75 offen sc1
    v_mfma_f32_16x16x32_bf16 v[32:35], a[24:27], a[128:131], v[32:35]
    ds_read_b64_tr_b16 a[46:47], v194 offset:47104
    v_mfma_f32_16x16x32_bf16 v[32:35], a[28:31], a[136:139], v[32:35]
    buffer_load_dwordx4 a[196:199], v13, s[20:23], s75 offen offset:1024 sc1
    v_mfma_f32_16x16x32_bf16 v[36:39], a[24:27], a[132:135], v[36:39]
    ds_read_b64_tr_b16 a[48:49], v195 offset:36864
    v_mfma_f32_16x16x32_bf16 v[36:39], a[28:31], a[140:143], v[36:39]
    s_waitcnt lgkmcnt(5)
    v_mfma_f32_16x16x32_bf16 v[136:139], a[32:35], a[224:227], v[136:139]
    ds_read_b64_tr_b16 a[50:51], v195 offset:38912
    v_mfma_f32_16x16x32_bf16 v[136:139], a[36:39], a[232:235], v[136:139]
    buffer_load_dwordx4 a[200:203], v13, s[20:23], s75 offen offset:2048 sc1
    v_mfma_f32_16x16x32_bf16 v[140:143], a[32:35], a[228:231], v[140:143]
    ds_read_b64_tr_b16 a[52:53], v195 offset:45056
    v_mfma_f32_16x16x32_bf16 v[140:143], a[36:39], a[236:239], v[140:143]
    v_mfma_f32_16x16x32_bf16 v[40:43], a[32:35], a[128:131], v[40:43]
    ds_read_b64_tr_b16 a[54:55], v195 offset:47104
    v_mfma_f32_16x16x32_bf16 v[40:43], a[36:39], a[136:139], v[40:43]
    buffer_load_dwordx4 a[204:207], v13, s[20:23], s75 offen offset:3072 sc1
    v_mfma_f32_16x16x32_bf16 v[44:47], a[32:35], a[132:135], v[44:47]
    ds_read_b64_tr_b16 a[0:1], v192 offset:49152
    v_mfma_f32_16x16x32_bf16 v[44:47], a[36:39], a[140:143], v[44:47]
    s_waitcnt lgkmcnt(5)
    v_mfma_f32_16x16x32_bf16 v[144:147], a[40:43], a[224:227], v[144:147]
    ds_read_b64_tr_b16 a[2:3], v192 offset:51200
    v_mfma_f32_16x16x32_bf16 v[144:147], a[44:47], a[232:235], v[144:147]
    s_add_u32 s75, s85, 2359296
    v_mfma_f32_16x16x32_bf16 v[148:151], a[40:43], a[228:231], v[148:151]
    ds_read_b64_tr_b16 a[4:5], v192 offset:57344
    v_mfma_f32_16x16x32_bf16 v[148:151], a[44:47], a[236:239], v[148:151]
    buffer_load_dwordx4 a[208:211], v13, s[20:23], s75 offen sc1
    v_mfma_f32_16x16x32_bf16 v[48:51], a[40:43], a[128:131], v[48:51]
    ds_read_b64_tr_b16 a[6:7], v192 offset:59392
    v_mfma_f32_16x16x32_bf16 v[48:51], a[44:47], a[136:139], v[48:51]
    v_mfma_f32_16x16x32_bf16 v[52:55], a[40:43], a[132:135], v[52:55]
    ds_read_b64_tr_b16 a[8:9], v193 offset:49152
    v_mfma_f32_16x16x32_bf16 v[52:55], a[44:47], a[140:143], v[52:55]
    s_waitcnt lgkmcnt(5)
    v_mfma_f32_16x16x32_bf16 v[152:155], a[48:51], a[224:227], v[152:155]
    ds_read_b64_tr_b16 a[10:11], v193 offset:51200
    v_mfma_f32_16x16x32_bf16 v[152:155], a[52:55], a[232:235], v[152:155]
    buffer_load_dwordx4 a[212:215], v13, s[20:23], s75 offen offset:1024 sc1
    v_mfma_f32_16x16x32_bf16 v[156:159], a[48:51], a[228:231], v[156:159]
    ds_read_b64_tr_b16 a[12:13], v193 offset:57344
    v_mfma_f32_16x16x32_bf16 v[156:159], a[52:55], a[236:239], v[156:159]
    buffer_load_dwordx4 a[216:219], v13, s[20:23], s75 offen offset:2048 sc1
    v_mfma_f32_16x16x32_bf16 v[56:59], a[48:51], a[128:131], v[56:59]
    ds_read_b64_tr_b16 a[14:15], v193 offset:59392
    v_mfma_f32_16x16x32_bf16 v[56:59], a[52:55], a[136:139], v[56:59]
    v_mfma_f32_16x16x32_bf16 v[60:63], a[48:51], a[132:135], v[60:63]
    ds_read_b64_tr_b16 a[16:17], v194 offset:49152
    v_mfma_f32_16x16x32_bf16 v[60:63], a[52:55], a[140:143], v[60:63]
    s_waitcnt lgkmcnt(5)
    v_mfma_f32_16x16x32_bf16 v[96:99], a[0:3], a[240:243], v[96:99]
    ds_read_b64_tr_b16 a[18:19], v194 offset:51200
    v_mfma_f32_16x16x32_bf16 v[96:99], a[4:7], a[248:251], v[96:99]
    buffer_load_dwordx4 a[220:223], v13, s[20:23], s75 offen offset:3072 sc1
    v_mfma_f32_16x16x32_bf16 v[100:103], a[0:3], a[244:247], v[100:103]
    ds_read_b64_tr_b16 a[20:21], v194 offset:57344
    v_mfma_f32_16x16x32_bf16 v[100:103], a[4:7], a[252:255], v[100:103]
    buffer_load_dwordx4 v12, s[24:27], s74 offen offset:3072 lds
    v_mfma_f32_16x16x32_bf16 v[64:67], a[0:3], a[96:99], v[64:67]
    ds_read_b64_tr_b16 a[22:23], v194 offset:59392
    v_mfma_f32_16x16x32_bf16 v[64:67], a[4:7], a[104:107], v[64:67]
    v_mfma_f32_16x16x32_bf16 v[68:71], a[0:3], a[100:103], v[68:71]
    ds_read_b64_tr_b16 a[24:25], v195 offset:49152
    v_mfma_f32_16x16x32_bf16 v[68:71], a[4:7], a[108:111], v[68:71]
    s_waitcnt lgkmcnt(5)
    v_mfma_f32_16x16x32_bf16 v[104:107], a[8:11], a[240:243], v[104:107]
    ds_read_b64_tr_b16 a[26:27], v195 offset:51200
    v_mfma_f32_16x16x32_bf16 v[104:107], a[12:15], a[248:251], v[104:107]
    s_add_u32 s75, s85, 2621440
    v_mfma_f32_16x16x32_bf16 v[108:111], a[8:11], a[244:247], v[108:111]
    ds_read_b64_tr_b16 a[28:29], v195 offset:57344
    v_mfma_f32_16x16x32_bf16 v[108:111], a[12:15], a[252:255], v[108:111]
    buffer_load_dwordx4 a[224:227], v13, s[20:23], s75 offen sc1
    v_mfma_f32_16x16x32_bf16 v[72:75], a[8:11], a[96:99], v[72:75]
    ds_read_b64_tr_b16 a[30:31], v195 offset:59392
    v_mfma_f32_16x16x32_bf16 v[72:75], a[12:15], a[104:107], v[72:75]
    buffer_load_dwordx4 a[228:231], v13, s[20:23], s75 offen offset:1024 sc1
    v_mfma_f32_16x16x32_bf16 v[76:79], a[8:11], a[100:103], v[76:79]
    ds_read_b64_tr_b16 a[32:33], v192 offset:53248
    v_mfma_f32_16x16x32_bf16 v[76:79], a[12:15], a[108:111], v[76:79]
    s_waitcnt lgkmcnt(5)
    v_mfma_f32_16x16x32_bf16 v[112:115], a[16:19], a[240:243], v[112:115]
    ds_read_b64_tr_b16 a[34:35], v192 offset:55296
    v_mfma_f32_16x16x32_bf16 v[112:115], a[20:23], a[248:251], v[112:115]
    buffer_load_dwordx4 a[232:235], v13, s[20:23], s75 offen offset:2048 sc1
    v_mfma_f32_16x16x32_bf16 v[116:119], a[16:19], a[244:247], v[116:119]
    ds_read_b64_tr_b16 a[36:37], v192 offset:61440
    v_mfma_f32_16x16x32_bf16 v[116:119], a[20:23], a[252:255], v[116:119]
    v_mfma_f32_16x16x32_bf16 v[80:83], a[16:19], a[96:99], v[80:83]
    ds_read_b64_tr_b16 a[38:39], v192 offset:63488
    v_mfma_f32_16x16x32_bf16 v[80:83], a[20:23], a[104:107], v[80:83]
    buffer_load_dwordx4 a[236:239], v13, s[20:23], s75 offen offset:3072 sc1
    v_mfma_f32_16x16x32_bf16 v[84:87], a[16:19], a[100:103], v[84:87]
    ds_read_b64_tr_b16 a[40:41], v193 offset:53248
    v_mfma_f32_16x16x32_bf16 v[84:87], a[20:23], a[108:111], v[84:87]
    s_waitcnt lgkmcnt(5)
    v_mfma_f32_16x16x32_bf16 v[120:123], a[24:27], a[240:243], v[120:123]
    ds_read_b64_tr_b16 a[42:43], v193 offset:55296
    v_mfma_f32_16x16x32_bf16 v[120:123], a[28:31], a[248:251], v[120:123]
    s_add_u32 s75, s85, 2883584
    v_mfma_f32_16x16x32_bf16 v[124:127], a[24:27], a[244:247], v[124:127]
    ds_read_b64_tr_b16 a[44:45], v193 offset:61440
    v_mfma_f32_16x16x32_bf16 v[124:127], a[28:31], a[252:255], v[124:127]
    buffer_load_dwordx4 a[128:131], v13, s[20:23], s75 offen sc1
    v_mfma_f32_16x16x32_bf16 v[88:91], a[24:27], a[96:99], v[88:91]
    ds_read_b64_tr_b16 a[46:47], v193 offset:63488
    v_mfma_f32_16x16x32_bf16 v[88:91], a[28:31], a[104:107], v[88:91]
    v_mfma_f32_16x16x32_bf16 v[92:95], a[24:27], a[100:103], v[92:95]
    ds_read_b64_tr_b16 a[48:49], v194 offset:53248
    v_mfma_f32_16x16x32_bf16 v[92:95], a[28:31], a[108:111], v[92:95]
    s_waitcnt lgkmcnt(5)
    v_mfma_f32_16x16x32_bf16 v[128:131], a[32:35], a[240:243], v[128:131]
    ds_read_b64_tr_b16 a[50:51], v194 offset:55296
    v_mfma_f32_16x16x32_bf16 v[128:131], a[36:39], a[248:251], v[128:131]
    buffer_load_dwordx4 a[132:135], v13, s[20:23], s75 offen offset:1024 sc1
    v_mfma_f32_16x16x32_bf16 v[132:135], a[32:35], a[244:247], v[132:135]
    ds_read_b64_tr_b16 a[52:53], v194 offset:61440
    v_mfma_f32_16x16x32_bf16 v[132:135], a[36:39], a[252:255], v[132:135]
    buffer_load_dwordx4 a[136:139], v13, s[20:23], s75 offen offset:2048 sc1
    v_mfma_f32_16x16x32_bf16 v[32:35], a[32:35], a[96:99], v[32:35]
    ds_read_b64_tr_b16 a[54:55], v194 offset:63488
    v_mfma_f32_16x16x32_bf16 v[32:35], a[36:39], a[104:107], v[32:35]
    v_mfma_f32_16x16x32_bf16 v[36:39], a[32:35], a[100:103], v[36:39]
    ds_read_b64_tr_b16 a[0:1], v195 offset:53248
    v_mfma_f32_16x16x32_bf16 v[36:39], a[36:39], a[108:111], v[36:39]
    s_waitcnt lgkmcnt(5)
    v_mfma_f32_16x16x32_bf16 v[136:139], a[40:43], a[240:243], v[136:139]
    ds_read_b64_tr_b16 a[2:3], v195 offset:55296
    v_mfma_f32_16x16x32_bf16 v[136:139], a[44:47], a[248:251], v[136:139]
    buffer_load_dwordx4 a[140:143], v13, s[20:23], s75 offen offset:3072 sc1
    v_mfma_f32_16x16x32_bf16 v[140:143], a[40:43], a[244:247], v[140:143]
    ds_read_b64_tr_b16 a[4:5], v195 offset:61440
    v_mfma_f32_16x16x32_bf16 v[140:143], a[44:47], a[252:255], v[140:143]
    s_add_u32 m0, s59, 0
    v_mfma_f32_16x16x32_bf16 v[40:43], a[40:43], a[96:99], v[40:43]
    ds_read_b64_tr_b16 a[6:7], v195 offset:63488
    v_mfma_f32_16x16x32_bf16 v[40:43], a[44:47], a[104:107], v[40:43]
    s_add_u32 s74, s55, 0
    s_barrier
    s_cmp_lg_u32 s44, 0
    s_cbranch_scc1 L_fda_skip
    v_accvgpr_write_b32 a124, 1
L_pad0_12:
    s_cbranch_execz L_pad0_16
    s_mov_b64 exec, 1
    buffer_store_dword a124, off, s[20:23], s50 sc1
    s_mov_b64 exec, -1
L_fda_skip:
    v_mfma_f32_16x16x32_bf16 v[44:47], a[40:43], a[100:103], v[44:47]
    ds_read_b64_tr_b16 a[8:9], v196
    v_mfma_f32_16x16x32_bf16 v[44:47], a[44:47], a[108:111], v[44:47]
    s_waitcnt lgkmcnt(5)
    v_mfma_f32_16x16x32_bf16 v[144:147], a[48:51], a[240:243], v[144:147]
    ds_read_b64_tr_b16 a[10:11], v196 offset:2048
    s_andn2_b32 s65, s50, 31
    v_mfma_f32_16x16x32_bf16 v[144:147], a[52:55], a[248:251], v[144:147]
    buffer_load_dwordx4 v9, s[28:31], s74 offen lds
    v_mfma_f32_16x16x32_bf16 v[148:151], a[48:51], a[244:247], v[148:151]
    ds_read_b64_tr_b16 a[12:13], v196 offset:8192
    v_mfma_f32_16x16x32_bf16 v[148:151], a[52:55], a[252:255], v[148:151]
    buffer_load_dwordx4 v10, s[28:31], s74 offen offset:1024 lds
    v_mfma_f32_16x16x32_bf16 v[48:51], a[48:51], a[96:99], v[48:51]
    ds_read_b64_tr_b16 a[14:15], v196 offset:10240
    v_mfma_f32_16x16x32_bf16 v[48:51], a[52:55], a[104:107], v[48:51]
    buffer_load_dwordx4 v11, s[28:31], s74 offen offset:2048 lds
    v_mfma_f32_16x16x32_bf16 v[52:55], a[48:51], a[100:103], v[52:55]
    ds_read_b64_tr_b16 a[16:17], v197
    v_mfma_f32_16x16x32_bf16 v[52:55], a[52:55], a[108:111], v[52:55]
    s_waitcnt lgkmcnt(5)
    v_mfma_f32_16x16x32_bf16 v[152:155], a[0:3], a[240:243], v[152:155]
    ds_read_b64_tr_b16 a[18:19], v197 offset:2048
    v_mfma_f32_16x16x32_bf16 v[152:155], a[4:7], a[248:251], v[152:155]
    buffer_load_dwordx4 v12, s[28:31], s74 offen offset:3072 lds
    v_mfma_f32_16x16x32_bf16 v[156:159], a[0:3], a[244:247], v[156:159]
    ds_read_b64_tr_b16 a[20:21], v197 offset:8192
    v_mfma_f32_16x16x32_bf16 v[156:159], a[4:7], a[252:255], v[156:159]
    s_add_u32 m0, s59, 16384
    v_mfma_f32_16x16x32_bf16 v[56:59], a[0:3], a[96:99], v[56:59]
    ds_read_b64_tr_b16 a[22:23], v197 offset:10240
    v_mfma_f32_16x16x32_bf16 v[56:59], a[4:7], a[104:107], v[56:59]
    s_add_u32 s74, s55, 262144
    v_mfma_f32_16x16x32_bf16 v[60:63], a[0:3], a[100:103], v[60:63]
    ds_read_b64_tr_b16 a[24:25], v198
    v_mfma_f32_16x16x32_bf16 v[60:63], a[4:7], a[108:111], v[60:63]
    s_waitcnt vmcnt(21) lgkmcnt(5)
    v_mfma_f32_16x16x32_bf16 v[96:99], a[8:11], a[160:163], v[96:99]
    ds_read_b64_tr_b16 a[26:27], v198 offset:2048
    v_mfma_f32_16x16x32_bf16 v[96:99], a[12:15], a[168:171], v[96:99]
    buffer_load_dwordx4 v9, s[28:31], s74 offen lds
    v_mfma_f32_16x16x32_bf16 v[100:103], a[8:11], a[164:167], v[100:103]
    ds_read_b64_tr_b16 a[28:29], v198 offset:8192
    v_mfma_f32_16x16x32_bf16 v[100:103], a[12:15], a[172:175], v[100:103]
    buffer_load_dwordx4 v10, s[28:31], s74 offen offset:1024 lds
    v_mfma_f32_16x16x32_bf16 v[64:67], a[8:11], a[176:179], v[64:67]
    ds_read_b64_tr_b16 a[30:31], v198 offset:10240
    v_mfma_f32_16x16x32_bf16 v[64:67], a[12:15], a[184:187], v[64:67]
    buffer_load_dwordx4 v11, s[28:31], s74 offen offset:2048 lds
    v_mfma_f32_16x16x32_bf16 v[68:71], a[8:11], a[180:183], v[68:71]
    ds_read_b64_tr_b16 a[32:33], v199
    buffer_load_dword v206, v204, s[20:23], s76 offen sc1
    v_mfma_f32_16x16x32_bf16 v[68:71], a[12:15], a[188:191], v[68:71]
    s_waitcnt lgkmcnt(5)
    v_mfma_f32_16x16x32_bf16 v[104:107], a[16:19], a[160:163], v[104:107]
    ds_read_b64_tr_b16 a[34:35], v199 offset:2048
    v_mfma_f32_16x16x32_bf16 v[104:107], a[20:23], a[168:171], v[104:107]
    v_mfma_f32_16x16x32_bf16 v[108:111], a[16:19], a[164:167], v[108:111]
    ds_read_b64_tr_b16 a[36:37], v199 offset:8192
    v_mfma_f32_16x16x32_bf16 v[108:111], a[20:23], a[172:175], v[108:111]
    buffer_load_dwordx4 v12, s[28:31], s74 offen offset:3072 lds
    v_mfma_f32_16x16x32_bf16 v[72:75], a[16:19], a[176:179], v[72:75]
    ds_read_b64_tr_b16 a[38:39], v199 offset:10240
    v_mfma_f32_16x16x32_bf16 v[72:75], a[20:23], a[184:187], v[72:75]
    s_add_u32 m0, s59, 32768
    v_mfma_f32_16x16x32_bf16 v[76:79], a[16:19], a[180:183], v[76:79]
    ds_read_b64_tr_b16 a[40:41], v196 offset:4096
    v_mfma_f32_16x16x32_bf16 v[76:79], a[20:23], a[188:191], v[76:79]
    s_waitcnt lgkmcnt(5)
    v_mfma_f32_16x16x32_bf16 v[112:115], a[24:27], a[160:163], v[112:115]
    ds_read_b64_tr_b16 a[42:43], v196 offset:6144
    v_mfma_f32_16x16x32_bf16 v[112:115], a[28:31], a[168:171], v[112:115]
    s_add_u32 s74, s55, 524288
    v_mfma_f32_16x16x32_bf16 v[116:119], a[24:27], a[164:167], v[116:119]
    ds_read_b64_tr_b16 a[44:45], v196 offset:12288
    v_mfma_f32_16x16x32_bf16 v[116:119], a[28:31], a[172:175], v[116:119]
    buffer_load_dwordx4 v9, s[28:31], s74 offen lds
    v_mfma_f32_16x16x32_bf16 v[80:83], a[24:27], a[176:179], v[80:83]
    ds_read_b64_tr_b16 a[46:47], v196 offset:14336
    v_mfma_f32_16x16x32_bf16 v[80:83], a[28:31], a[184:187], v[80:83]
    buffer_load_dwordx4 v10, s[28:31], s74 offen offset:1024 lds
    v_mfma_f32_16x16x32_bf16 v[84:87], a[24:27], a[180:183], v[84:87]
    ds_read_b64_tr_b16 a[48:49], v197 offset:4096
    v_mfma_f32_16x16x32_bf16 v[84:87], a[28:31], a[188:191], v[84:87]
    s_waitcnt lgkmcnt(5)
    v_mfma_f32_16x16x32_bf16 v[120:123], a[32:35], a[160:163], v[120:123]
    ds_read_b64_tr_b16 a[50:51], v197 offset:6144
    v_mfma_f32_16x16x32_bf16 v[120:123], a[36:39], a[168:171], v[120:123]
    buffer_load_dwordx4 v11, s[28:31], s74 offen offset:2048 lds
    v_mfma_f32_16x16x32_bf16 v[124:127], a[32:35], a[164:167], v[124:127]
    ds_read_b64_tr_b16 a[52:53], v197 offset:12288
    v_mfma_f32_16x16x32_bf16 v[124:127], a[36:39], a[172:175], v[124:127]
    buffer_load_dwordx4 v12, s[28:31], s74 offen offset:3072 lds
    v_mfma_f32_16x16x32_bf16 v[88:91], a[32:35], a[176:179], v[88:91]
    ds_read_b64_tr_b16 a[54:55], v197 offset:14336
    v_mfma_f32_16x16x32_bf16 v[88:91], a[36:39], a[184:187], v[88:91]
    v_mfma_f32_16x16x32_bf16 v[92:95], a[32:35], a[180:183], v[92:95]
    ds_read_b64_tr_b16 a[0:1], v198 offset:4096
    v_mfma_f32_16x16x32_bf16 v[92:95], a[36:39], a[188:191], v[92:95]
    s_waitcnt lgkmcnt(5)
    v_mfma_f32_16x16x32_bf16 v[128:131], a[40:43], a[160:163], v[128:131]
    ds_read_b64_tr_b16 a[2:3], v198 offset:6144
    v_mfma_f32_16x16x32_bf16 v[128:131], a[44:47], a[168:171], v[128:131]
    v_mfma_f32_16x16x32_bf16 v[132:135], a[40:43], a[164:167], v[132:135]
    ds_read_b64_tr_b16 a[4:5], v198 offset:12288
    v_mfma_f32_16x16x32_bf16 v[132:135], a[44:47], a[172:175], v[132:135]
    v_mfma_f32_16x16x32_bf16 v[32:35], a[40:43], a[176:179], v[32:35]
    ds_read_b64_tr_b16 a[6:7], v198 offset:14336
    v_mfma_f32_16x16x32_bf16 v[32:35], a[44:47], a[184:187], v[32:35]
    v_mfma_f32_16x16x32_bf16 v[36:39], a[40:43], a[180:183], v[36:39]
    ds_read_b64_tr_b16 a[8:9], v199 offset:4096
    v_mfma_f32_16x16x32_bf16 v[36:39], a[44:47], a[188:191], v[36:39]
    s_waitcnt lgkmcnt(5)
    v_mfma_f32_16x16x32_bf16 v[136:139], a[48:51], a[160:163], v[136:139]
    ds_read_b64_tr_b16 a[10:11], v199 offset:6144
    v_mfma_f32_16x16x32_bf16 v[136:139], a[52:55], a[168:171], v[136:139]
    v_mfma_f32_16x16x32_bf16 v[140:143], a[48:51], a[164:167], v[140:143]
    ds_read_b64_tr_b16 a[12:13], v199 offset:12288
    v_mfma_f32_16x16x32_bf16 v[140:143], a[52:55], a[172:175], v[140:143]
    v_mfma_f32_16x16x32_bf16 v[40:43], a[48:51], a[176:179], v[40:43]
    ds_read_b64_tr_b16 a[14:15], v199 offset:14336
    v_mfma_f32_16x16x32_bf16 v[40:43], a[52:55], a[184:187], v[40:43]
    v_mfma_f32_16x16x32_bf16 v[44:47], a[48:51], a[180:183], v[44:47]
    ds_read_b64_tr_b16 a[16:17], v200 offset:16384
    v_mfma_f32_16x16x32_bf16 v[44:47], a[52:55], a[188:191], v[44:47]
    s_waitcnt lgkmcnt(5)
    v_mfma_f32_16x16x32_bf16 v[144:147], a[0:3], a[160:163], v[144:147]
    ds_read_b64_tr_b16 a[18:19], v200 offset:18432
    v_mfma_f32_16x16x32_bf16 v[144:147], a[4:7], a[168:171], v[144:147]
    s_add_u32 s75, s85, 3145728
    v_mfma_f32_16x16x32_bf16 v[148:151], a[0:3], a[164:167], v[148:151]
    ds_read_b64_tr_b16 a[20:21], v200 offset:24576
    s_waitcnt vmcnt(5)
    v_cmp_le_u32 vcc, 2, v206
    s_nop 0
    s_cmp_eq_u64 vcc, -1
    s_cbranch_scc0 L_pha2a_spin
L_pha2a_ok:
    v_mfma_f32_16x16x32_bf16 v[148:151], a[4:7], a[172:175], v[148:151]
    buffer_load_dwordx4 a[240:243], v13, s[20:23], s75 offen sc1
    v_mfma_f32_16x16x32_bf16 v[48:51], a[0:3], a[176:179], v[48:51]
    ds_read_b64_tr_b16 a[22:23], v200 offset:26624
    s_lshl_b32 s76, s58, 7
    v_mfma_f32_16x16x32_bf16 v[48:51], a[4:7], a[184:187], v[48:51]
    v_mfma_f32_16x16x32_bf16 v[52:55], a[0:3], a[180:183], v[52:55]
    ds_read_b64_tr_b16 a[24:25], v201 offset:16384
    v_mfma_f32_16x16x32_bf16 v[52:55], a[4:7], a[188:191], v[52:55]
    s_waitcnt lgkmcnt(5)
    s_add_u32 s76, s76, 34160640
    v_mfma_f32_16x16x32_bf16 v[152:155], a[8:11], a[160:163], v[152:155]
    ds_read_b64_tr_b16 a[26:27], v201 offset:18432
    v_mfma_f32_16x16x32_bf16 v[152:155], a[12:15], a[168:171], v[152:155]
    buffer_load_dwordx4 a[244:247], v13, s[20:23], s75 offen offset:1024 sc1
    v_mfma_f32_16x16x32_bf16 v[156:159], a[8:11], a[164:167], v[156:159]
    ds_read_b64_tr_b16 a[28:29], v201 offset:24576
    v_bfe_u32 v204, v13, 4, 4
    v_mfma_f32_16x16x32_bf16 v[156:159], a[12:15], a[172:175], v[156:159]
    v_mfma_f32_16x16x32_bf16 v[56:59], a[8:11], a[176:179], v[56:59]
    ds_read_b64_tr_b16 a[30:31], v201 offset:26624
    v_mfma_f32_16x16x32_bf16 v[56:59], a[12:15], a[184:187], v[56:59]
    buffer_load_dwordx4 a[248:251], v13, s[20:23], s75 offen offset:2048 sc1
    v_lshlrev_b32 v204, 2, v204
    v_mfma_f32_16x16x32_bf16 v[60:63], a[8:11], a[180:183], v[60:63]
    ds_read_b64_tr_b16 a[32:33], v202 offset:16384
    v_mfma_f32_16x16x32_bf16 v[60:63], a[12:15], a[188:191], v[60:63]
    s_waitcnt lgkmcnt(5)
    v_mfma_f32_16x16x32_bf16 v[96:99], a[16:19], a[192:195], v[96:99]
    ds_read_b64_tr_b16 a[34:35], v202 offset:18432
    v_mfma_f32_16x16x32_bf16 v[96:99], a[20:23], a[200:203], v[96:99]
    buffer_load_dwordx4 a[252:255], v13, s[20:23], s75 offen offset:3072 sc1
    v_mfma_f32_16x16x32_bf16 v[100:103], a[16:19], a[196:199], v[100:103]
    ds_read_b64_tr_b16 a[36:37], v202 offset:24576
    v_mfma_f32_16x16x32_bf16 v[100:103], a[20:23], a[204:207], v[100:103]
    s_add_u32 s75, s85, 3407872
    v_mfma_f32_16x16x32_bf16 v[64:67], a[16:19], a[208:211], v[64:67]
    ds_read_b64_tr_b16 a[38:39], v202 offset:26624
    v_mfma_f32_16x16x32_bf16 v[64:67], a[20:23], a[216:219], v[64:67]
    buffer_load_dwordx4 a[96:99], v13, s[20:23], s75 offen sc1
    v_mfma_f32_16x16x32_bf16 v[68:71], a[16:19], a[212:215], v[68:71]
    ds_read_b64_tr_b16 a[40:41], v203 offset:16384
    v_mfma_f32_16x16x32_bf16 v[68:71], a[20:23], a[220:223], v[68:71]
    s_waitcnt lgkmcnt(5)
    v_mfma_f32_16x16x32_bf16 v[104:107], a[24:27], a[192:195], v[104:107]
    ds_read_b64_tr_b16 a[42:43], v203 offset:18432
    v_mfma_f32_16x16x32_bf16 v[104:107], a[28:31], a[200:203], v[104:107]
    buffer_load_dwordx4 a[100:103], v13, s[20:23], s75 offen offset:1024 sc1
    v_mfma_f32_16x16x32_bf16 v[108:111], a[24:27], a[196:199], v[108:111]
    ds_read_b64_tr_b16 a[44:45], v203 offset:24576
    v_mfma_f32_16x16x32_bf16 v[108:111], a[28:31], a[204:207], v[108:111]
    v_mfma_f32_16x16x32_bf16 v[72:75], a[24:27], a[208:211], v[72:75]
    ds_read_b64_tr_b16 a[46:47], v203 offset:26624
    v_mfma_f32_16x16x32_bf16 v[72:75], a[28:31], a[216:219], v[72:75]
    buffer_load_dwordx4 a[104:107], v13, s[20:23], s75 offen offset:2048 sc1
    v_mfma_f32_16x16x32_bf16 v[76:79], a[24:27], a[212:215], v[76:79]
    ds_read_b64_tr_b16 a[48:49], v200 offset:20480
    v_mfma_f32_16x16x32_bf16 v[76:79], a[28:31], a[220:223], v[76:79]
    s_waitcnt lgkmcnt(5)
    v_mfma_f32_16x16x32_bf16 v[112:115], a[32:35], a[192:195], v[112:115]
    ds_read_b64_tr_b16 a[50:51], v200 offset:22528
    v_mfma_f32_16x16x32_bf16 v[112:115], a[36:39], a[200:203], v[112:115]
    v_mfma_f32_16x16x32_bf16 v[116:119], a[32:35], a[196:199], v[116:119]
    ds_read_b64_tr_b16 a[52:53], v200 offset:28672
    v_mfma_f32_16x16x32_bf16 v[116:119], a[36:39], a[204:207], v[116:119]
    buffer_load_dwordx4 a[108:111], v13, s[20:23], s75 offen offset:3072 sc1
    v_mfma_f32_16x16x32_bf16 v[80:83], a[32:35], a[208:211], v[80:83]
    ds_read_b64_tr_b16 a[54:55], v200 offset:30720
    v_mfma_f32_16x16x32_bf16 v[80:83], a[36:39], a[216:219], v[80:83]
    s_add_u32 s75, s56, 2621440
    v_mfma_f32_16x16x32_bf16 v[84:87], a[32:35], a[212:215], v[84:87]
    ds_read_b64_tr_b16 a[0:1], v201 offset:20480
    v_mfma_f32_16x16x32_bf16 v[84:87], a[36:39], a[220:223], v[84:87]
    s_waitcnt lgkmcnt(5)
    v_mfma_f32_16x16x32_bf16 v[120:123], a[40:43], a[192:195], v[120:123]
    ds_read_b64_tr_b16 a[2:3], v201 offset:22528
    v_mfma_f32_16x16x32_bf16 v[120:123], a[44:47], a[200:203], v[120:123]
    buffer_load_dwordx4 a[160:163], v13, s[20:23], s75 offen sc1
    v_mfma_f32_16x16x32_bf16 v[124:127], a[40:43], a[196:199], v[124:127]
    ds_read_b64_tr_b16 a[4:5], v201 offset:28672
    v_mfma_f32_16x16x32_bf16 v[124:127], a[44:47], a[204:207], v[124:127]
    buffer_load_dwordx4 a[164:167], v13, s[20:23], s75 offen offset:1024 sc1
    v_mfma_f32_16x16x32_bf16 v[88:91], a[40:43], a[208:211], v[88:91]
    ds_read_b64_tr_b16 a[6:7], v201 offset:30720
    v_mfma_f32_16x16x32_bf16 v[88:91], a[44:47], a[216:219], v[88:91]
    v_mfma_f32_16x16x32_bf16 v[92:95], a[40:43], a[212:215], v[92:95]
    ds_read_b64_tr_b16 a[8:9], v202 offset:20480
    v_mfma_f32_16x16x32_bf16 v[92:95], a[44:47], a[220:223], v[92:95]
    s_waitcnt lgkmcnt(5)
    v_mfma_f32_16x16x32_bf16 v[128:131], a[48:51], a[192:195], v[128:131]
    ds_read_b64_tr_b16 a[10:11], v202 offset:22528
    v_mfma_f32_16x16x32_bf16 v[128:131], a[52:55], a[200:203], v[128:131]
    buffer_load_dwordx4 a[168:171], v13, s[20:23], s75 offen offset:2048 sc1
    v_mfma_f32_16x16x32_bf16 v[132:135], a[48:51], a[196:199], v[132:135]
    ds_read_b64_tr_b16 a[12:13], v202 offset:28672
    v_mfma_f32_16x16x32_bf16 v[132:135], a[52:55], a[204:207], v[132:135]
    buffer_load_dwordx4 a[172:175], v13, s[20:23], s75 offen offset:3072 sc1
    v_mfma_f32_16x16x32_bf16 v[32:35], a[48:51], a[208:211], v[32:35]
    ds_read_b64_tr_b16 a[14:15], v202 offset:30720
    v_mfma_f32_16x16x32_bf16 v[32:35], a[52:55], a[216:219], v[32:35]
    v_mfma_f32_16x16x32_bf16 v[36:39], a[48:51], a[212:215], v[36:39]
    ds_read_b64_tr_b16 a[16:17], v203 offset:20480
    v_mfma_f32_16x16x32_bf16 v[36:39], a[52:55], a[220:223], v[36:39]
    s_waitcnt lgkmcnt(5)
    v_mfma_f32_16x16x32_bf16 v[136:139], a[0:3], a[192:195], v[136:139]
    ds_read_b64_tr_b16 a[18:19], v203 offset:22528
    v_mfma_f32_16x16x32_bf16 v[136:139], a[4:7], a[200:203], v[136:139]
    s_add_u32 s75, s56, 2883584
    v_mfma_f32_16x16x32_bf16 v[140:143], a[0:3], a[196:199], v[140:143]
    ds_read_b64_tr_b16 a[20:21], v203 offset:28672
    v_mfma_f32_16x16x32_bf16 v[140:143], a[4:7], a[204:207], v[140:143]
    buffer_load_dwordx4 a[176:179], v13, s[20:23], s75 offen sc1
    v_mfma_f32_16x16x32_bf16 v[40:43], a[0:3], a[208:211], v[40:43]
    ds_read_b64_tr_b16 a[22:23], v203 offset:30720
    v_mfma_f32_16x16x32_bf16 v[40:43], a[4:7], a[216:219], v[40:43]
    buffer_load_dwordx4 a[180:183], v13, s[20:23], s75 offen offset:1024 sc1
    s_barrier
    v_mfma_f32_16x16x32_bf16 v[44:47], a[0:3], a[212:215], v[44:47]
    ds_read_b64_tr_b16 a[24:25], v196 offset:20480
    v_mfma_f32_16x16x32_bf16 v[44:47], a[4:7], a[220:223], v[44:47]
    ds_read_b64_tr_b16 a[26:27], v196 offset:22528
    s_waitcnt lgkmcnt(6)
    v_mfma_f32_16x16x32_bf16 v[144:147], a[8:11], a[192:195], v[144:147]
    ds_read_b64_tr_b16 a[28:29], v196 offset:28672
    buffer_load_dwordx4 a[184:187], v13, s[20:23], s75 offen offset:2048 sc1
    v_mfma_f32_16x16x32_bf16 v[144:147], a[12:15], a[200:203], v[144:147]
    ds_read_b64_tr_b16 a[30:31], v196 offset:30720
    v_mfma_f32_16x16x32_bf16 v[148:151], a[8:11], a[196:199], v[148:151]
    ds_read_b64_tr_b16 a[32:33], v197 offset:20480
    v_mfma_f32_16x16x32_bf16 v[148:151], a[12:15], a[204:207], v[148:151]
    ds_read_b64_tr_b16 a[34:35], v197 offset:22528
    v_mfma_f32_16x16x32_bf16 v[48:51], a[8:11], a[208:211], v[48:51]
    ds_read_b64_tr_b16 a[36:37], v197 offset:28672
    s_waitcnt vmcnt(11)
    v_mfma_f32_16x16x32_bf16 v[48:51], a[12:15], a[216:219], v[48:51]
    ds_read_b64_tr_b16 a[38:39], v197 offset:30720
    buffer_load_dwordx4 a[188:191], v13, s[20:23], s75 offen offset:3072 sc1
    v_accvgpr_mov_b32 a120, a242
    v_mfma_f32_16x16x32_bf16 v[52:55], a[8:11], a[212:215], v[52:55]
    ds_read_b64_tr_b16 a[40:41], v198 offset:20480
    v_mfma_f32_16x16x32_bf16 v[52:55], a[12:15], a[220:223], v[52:55]
    ds_read_b64_tr_b16 a[42:43], v198 offset:22528
    s_waitcnt lgkmcnt(10)
    v_mfma_f32_16x16x32_bf16 v[152:155], a[16:19], a[192:195], v[152:155]
    ds_read_b64_tr_b16 a[44:45], v198 offset:28672
    s_add_u32 m0, s59, 49152
    v_mfma_f32_16x16x32_bf16 v[152:155], a[20:23], a[200:203], v[152:155]
    ds_read_b64_tr_b16 a[46:47], v198 offset:30720
    s_add_u32 s74, s55, 786432
    v_mfma_f32_16x16x32_bf16 v[156:159], a[16:19], a[196:199], v[156:159]
    ds_read_b64_tr_b16 a[48:49], v199 offset:20480
    buffer_load_dwordx4 v9, s[28:31], s74 offen lds
    v_mfma_f32_16x16x32_bf16 v[156:159], a[20:23], a[204:207], v[156:159]
    ds_read_b64_tr_b16 a[50:51], v199 offset:22528
    v_accvgpr_mov_b32 a121, a243
    v_mfma_f32_16x16x32_bf16 v[56:59], a[16:19], a[208:211], v[56:59]
    ds_read_b64_tr_b16 a[52:53], v199 offset:28672
    v_accvgpr_mov_b32 a242, a244
    v_accvgpr_mov_b32 a243, a245
    v_accvgpr_mov_b32 a244, a120
    v_mfma_f32_16x16x32_bf16 v[56:59], a[20:23], a[216:219], v[56:59]
    ds_read_b64_tr_b16 a[54:55], v199 offset:30720
    s_add_u32 s75, s56, 3145728
    v_mfma_f32_16x16x32_bf16 v[60:63], a[16:19], a[212:215], v[60:63]
    ds_read_b64_tr_b16 a[0:1], v196 offset:36864
    buffer_load_dwordx4 a[192:195], v13, s[20:23], s75 offen sc1
    v_mfma_f32_16x16x32_bf16 v[60:63], a[20:23], a[220:223], v[60:63]
    ds_read_b64_tr_b16 a[2:3], v196 offset:38912
    s_waitcnt lgkmcnt(10)
    v_mfma_f32_16x16x32_bf16 v[32:35], a[24:27], a[224:227], v[32:35]
    ds_read_b64_tr_b16 a[4:5], v196 offset:45056
    v_accvgpr_mov_b32 a245, a121
    v_mfma_f32_16x16x32_bf16 v[32:35], a[28:31], a[232:235], v[32:35]
    ds_read_b64_tr_b16 a[6:7], v196 offset:47104
    v_accvgpr_mov_b32 a120, a250
    v_accvgpr_mov_b32 a121, a251
    v_accvgpr_mov_b32 a250, a252
    v_mfma_f32_16x16x32_bf16 v[36:39], a[24:27], a[228:231], v[36:39]
    ds_read_b64_tr_b16 a[8:9], v197 offset:36864
    buffer_load_dwordx4 a[196:199], v13, s[20:23], s75 offen offset:1024 sc1
    v_mfma_f32_16x16x32_bf16 v[36:39], a[28:31], a[236:239], v[36:39]
    ds_read_b64_tr_b16 a[10:11], v197 offset:38912
    v_accvgpr_mov_b32 a251, a253
    v_mfma_f32_16x16x32_bf16 v[40:43], a[32:35], a[224:227], v[40:43]
    ds_read_b64_tr_b16 a[12:13], v197 offset:45056
    v_accvgpr_mov_b32 a252, a120
    v_mfma_f32_16x16x32_bf16 v[40:43], a[36:39], a[232:235], v[40:43]
    ds_read_b64_tr_b16 a[14:15], v197 offset:47104
    v_mfma_f32_16x16x32_bf16 v[44:47], a[32:35], a[228:231], v[44:47]
    ds_read_b64_tr_b16 a[16:17], v198 offset:36864
    buffer_load_dwordx4 a[200:203], v13, s[20:23], s75 offen offset:2048 sc1
    v_accvgpr_mov_b32 a253, a121
    v_mfma_f32_16x16x32_bf16 v[44:47], a[36:39], a[236:239], v[44:47]
    ds_read_b64_tr_b16 a[18:19], v198 offset:38912
    s_waitcnt lgkmcnt(10)
    v_mfma_f32_16x16x32_bf16 v[48:51], a[40:43], a[224:227], v[48:51]
    ds_read_b64_tr_b16 a[20:21], v198 offset:45056
    s_waitcnt vmcnt(12)
    v_mfma_f32_16x16x32_bf16 v[48:51], a[44:47], a[232:235], v[48:51]
    ds_read_b64_tr_b16 a[22:23], v198 offset:47104
    v_accvgpr_mov_b32 a120, a98
    v_mfma_f32_16x16x32_bf16 v[52:55], a[40:43], a[228:231], v[52:55]
    ds_read_b64_tr_b16 a[24:25], v199 offset:36864
    buffer_load_dword v206, v205, s[20:23], s65 offen sc1
    v_mfma_f32_16x16x32_bf16 v[52:55], a[44:47], a[236:239], v[52:55]
    ds_read_b64_tr_b16 a[26:27], v199 offset:38912
    buffer_load_dwordx4 a[204:207], v13, s[20:23], s75 offen offset:3072 sc1
    v_mfma_f32_16x16x32_bf16 v[56:59], a[48:51], a[224:227], v[56:59]
    ds_read_b64_tr_b16 a[28:29], v199 offset:45056
    v_accvgpr_mov_b32 a121, a99
    v_mfma_f32_16x16x32_bf16 v[56:59], a[52:55], a[232:235], v[56:59]
    ds_read_b64_tr_b16 a[30:31], v199 offset:47104
    v_accvgpr_mov_b32 a98, a100
    v_mfma_f32_16x16x32_bf16 v[60:63], a[48:51], a[228:231], v[60:63]
    ds_read_b64_tr_b16 a[32:33], v196 offset:53248
    s_add_u32 s75, s56, 3407872
    v_accvgpr_mov_b32 a99, a101
    v_mfma_f32_16x16x32_bf16 v[60:63], a[52:55], a[236:239], v[60:63]
    ds_read_b64_tr_b16 a[34:35], v196 offset:55296
    s_waitcnt lgkmcnt(10)
    v_mfma_f32_16x16x32_bf16 v[32:35], a[0:3], a[128:131], v[32:35]
    ds_read_b64_tr_b16 a[36:37], v196 offset:61440
    buffer_load_dwordx4 a[208:211], v13, s[20:23], s75 offen sc1
    v_mfma_f32_16x16x32_bf16 v[32:35], a[4:7], a[136:139], v[32:35]
    ds_read_b64_tr_b16 a[38:39], v196 offset:63488
    v_accvgpr_mov_b32 a100, a120
    v_mfma_f32_16x16x32_bf16 v[36:39], a[0:3], a[132:135], v[36:39]
    ds_read_b64_tr_b16 a[40:41], v197 offset:53248
    v_accvgpr_mov_b32 a101, a121
    v_mfma_f32_16x16x32_bf16 v[36:39], a[4:7], a[140:143], v[36:39]
    ds_read_b64_tr_b16 a[42:43], v197 offset:55296
    v_accvgpr_mov_b32 a120, a106
    v_mfma_f32_16x16x32_bf16 v[40:43], a[8:11], a[128:131], v[40:43]
    ds_read_b64_tr_b16 a[44:45], v197 offset:61440
    buffer_load_dwordx4 a[212:215], v13, s[20:23], s75 offen offset:1024 sc1
    v_accvgpr_mov_b32 a121, a107
    v_mfma_f32_16x16x32_bf16 v[40:43], a[12:15], a[136:139], v[40:43]
    ds_read_b64_tr_b16 a[46:47], v197 offset:63488
    v_accvgpr_mov_b32 a106, a108
    v_mfma_f32_16x16x32_bf16 v[44:47], a[8:11], a[132:135], v[44:47]
    ds_read_b64_tr_b16 a[48:49], v198 offset:53248
    v_mfma_f32_16x16x32_bf16 v[44:47], a[12:15], a[140:143], v[44:47]
    ds_read_b64_tr_b16 a[50:51], v198 offset:55296
    s_waitcnt lgkmcnt(10)
    v_mfma_f32_16x16x32_bf16 v[48:51], a[16:19], a[128:131], v[48:51]
    ds_read_b64_tr_b16 a[52:53], v198 offset:61440
    buffer_load_dwordx4 a[216:219], v13, s[20:23], s75 offen offset:2048 sc1
    v_mfma_f32_16x16x32_bf16 v[48:51], a[20:23], a[136:139], v[48:51]
    ds_read_b64_tr_b16 a[54:55], v198 offset:63488
    v_accvgpr_mov_b32 a107, a109
    v_mfma_f32_16x16x32_bf16 v[52:55], a[16:19], a[132:135], v[52:55]
    ds_read_b64_tr_b16 a[0:1], v199 offset:53248
    v_accvgpr_mov_b32 a108, a120
    v_accvgpr_mov_b32 a109, a121
    v_mfma_f32_16x16x32_bf16 v[52:55], a[20:23], a[140:143], v[52:55]
    ds_read_b64_tr_b16 a[2:3], v199 offset:55296
    v_mfma_f32_16x16x32_bf16 v[56:59], a[24:27], a[128:131], v[56:59]
    ds_read_b64_tr_b16 a[4:5], v199 offset:61440
    buffer_load_dwordx4 a[220:223], v13, s[20:23], s75 offen offset:3072 sc1
    v_mfma_f32_16x16x32_bf16 v[56:59], a[28:31], a[136:139], v[56:59]
    ds_read_b64_tr_b16 a[6:7], v199 offset:63488
    v_mfma_f32_16x16x32_bf16 v[60:63], a[24:27], a[132:135], v[60:63]
    ds_read_b64_tr_b16 a[8:9], v200 offset:4096
    v_mfma_f32_16x16x32_bf16 v[60:63], a[28:31], a[140:143], v[60:63]
    ds_read_b64_tr_b16 a[10:11], v200 offset:6144
    s_waitcnt lgkmcnt(10)
    v_mfma_f32_16x16x32_bf16 v[32:35], a[32:35], a[240:243], v[32:35]
    ds_read_b64_tr_b16 a[12:13], v200 offset:12288
    v_mfma_f32_16x16x32_bf16 v[32:35], a[36:39], a[248:251], v[32:35]
    ds_read_b64_tr_b16 a[14:15], v200 offset:14336
    buffer_load_dwordx4 v10, s[28:31], s74 offen offset:1024 lds
    v_mfma_f32_16x16x32_bf16 v[36:39], a[32:35], a[244:247], v[36:39]
    ds_read_b64_tr_b16 a[16:17], v201 offset:4096
    v_mfma_f32_16x16x32_bf16 v[36:39], a[36:39], a[252:255], v[36:39]
    ds_read_b64_tr_b16 a[18:19], v201 offset:6144
    v_mfma_f32_16x16x32_bf16 v[40:43], a[40:43], a[240:243], v[40:43]
    ds_read_b64_tr_b16 a[20:21], v201 offset:12288
    v_mfma_f32_16x16x32_bf16 v[40:43], a[44:47], a[248:251], v[40:43]
    ds_read_b64_tr_b16 a[22:23], v201 offset:14336
    buffer_load_dwordx4 v11, s[28:31], s74 offen offset:2048 lds
    v_mfma_f32_16x16x32_bf16 v[44:47], a[40:43], a[244:247], v[44:47]
    ds_read_b64_tr_b16 a[24:25], v202 offset:4096
    v_mfma_f32_16x16x32_bf16 v[44:47], a[44:47], a[252:255], v[44:47]
    ds_read_b64_tr_b16 a[26:27], v202 offset:6144
    s_waitcnt lgkmcnt(10)
    v_mfma_f32_16x16x32_bf16 v[48:51], a[48:51], a[240:243], v[48:51]
    ds_read_b64_tr_b16 a[28:29], v202 offset:12288
    v_mfma_f32_16x16x32_bf16 v[48:51], a[52:55], a[248:251], v[48:51]
    ds_read_b64_tr_b16 a[30:31], v202 offset:14336
    v_mfma_f32_16x16x32_bf16 v[52:55], a[48:51], a[244:247], v[52:55]
    ds_read_b64_tr_b16 a[32:33], v203 offset:4096
    buffer_load_dwordx4 v12, s[28:31], s74 offen offset:3072 lds
    v_mfma_f32_16x16x32_bf16 v[52:55], a[52:55], a[252:255], v[52:55]
    ds_read_b64_tr_b16 a[34:35], v203 offset:6144
    v_mfma_f32_16x16x32_bf16 v[56:59], a[0:3], a[240:243], v[56:59]
    ds_read_b64_tr_b16 a[36:37], v203 offset:12288
    s_add_u32 m0, s59, 65536
    v_mfma_f32_16x16x32_bf16 v[56:59], a[4:7], a[248:251], v[56:59]
    ds_read_b64_tr_b16 a[38:39], v203 offset:14336
    s_add_u32 s74, s55, 1048576
    v_mfma_f32_16x16x32_bf16 v[60:63], a[0:3], a[244:247], v[60:63]
    ds_read_b64_tr_b16 a[40:41], v196 offset:16384
    buffer_load_dwordx4 v9, s[28:31], s74 offen lds
    v_mfma_f32_16x16x32_bf16 v[60:63], a[4:7], a[252:255], v[60:63]
    ds_read_b64_tr_b16 a[42:43], v196 offset:18432
    s_waitcnt lgkmcnt(10)
    v_mfma_f32_16x16x32_bf16 v[32:35], a[8:11], a[96:99], v[32:35]
    ds_read_b64_tr_b16 a[44:45], v196 offset:24576
    v_mfma_f32_16x16x32_bf16 v[32:35], a[12:15], a[104:107], v[32:35]
    ds_read_b64_tr_b16 a[46:47], v196 offset:26624
    v_mfma_f32_16x16x32_bf16 v[36:39], a[8:11], a[100:103], v[36:39]
    ds_read_b64_tr_b16 a[48:49], v197 offset:16384
    buffer_load_dwordx4 v10, s[28:31], s74 offen offset:1024 lds
    v_mfma_f32_16x16x32_bf16 v[36:39], a[12:15], a[108:111], v[36:39]
    ds_read_b64_tr_b16 a[50:51], v197 offset:18432
    v_mfma_f32_16x16x32_bf16 v[40:43], a[16:19], a[96:99], v[40:43]
    ds_read_b64_tr_b16 a[52:53], v197 offset:24576
    v_mfma_f32_16x16x32_bf16 v[40:43], a[20:23], a[104:107], v[40:43]
    ds_read_b64_tr_b16 a[54:55], v197 offset:26624
    v_mfma_f32_16x16x32_bf16 v[44:47], a[16:19], a[100:103], v[44:47]
    ds_read_b64_tr_b16 a[0:1], v198 offset:16384
    s_waitcnt vmcnt(10)
    v_cmp_le_u32 vcc, 1, v206
    s_nop 0
    s_cmp_eq_u64 vcc, -1
    s_cbranch_scc0 L_pda_spin
L_pda_ok:
    v_mfma_f32_16x16x32_bf16 v[44:47], a[20:23], a[108:111], v[44:47]
    ds_read_b64_tr_b16 a[2:3], v198 offset:18432
    s_waitcnt lgkmcnt(10)
    v_mfma_f32_16x16x32_bf16 v[48:51], a[24:27], a[96:99], v[48:51]
    ds_read_b64_tr_b16 a[4:5], v198 offset:24576
    buffer_load_dwordx4 v11, s[28:31], s74 offen offset:2048 lds
    v_mfma_f32_16x16x32_bf16 v[48:51], a[28:31], a[104:107], v[48:51]
    ds_read_b64_tr_b16 a[6:7], v198 offset:26624
    s_add_u32 s61, s62, 0
    v_mfma_f32_16x16x32_bf16 v[52:55], a[24:27], a[100:103], v[52:55]
    ds_read_b64_tr_b16 a[8:9], v199 offset:16384
    v_cvt_pk_bf16_f32 v32, v32, v33
    v_mfma_f32_16x16x32_bf16 v[52:55], a[28:31], a[108:111], v[52:55]
    ds_read_b64_tr_b16 a[10:11], v199 offset:18432
    buffer_load_dwordx4 v12, s[28:31], s74 offen offset:3072 lds
    v_mfma_f32_16x16x32_bf16 v[56:59], a[32:35], a[96:99], v[56:59]
    ds_read_b64_tr_b16 a[12:13], v199 offset:24576
    v_cvt_pk_bf16_f32 v33, v34, v35
    v_mfma_f32_16x16x32_bf16 v[56:59], a[36:39], a[104:107], v[56:59]
    ds_read_b64_tr_b16 a[14:15], v199 offset:26624
    v_mfma_f32_16x16x32_bf16 v[60:63], a[32:35], a[100:103], v[60:63]
    ds_read_b64_tr_b16 a[16:17], v196 offset:32768
    v_cvt_pk_bf16_f32 v34, v40, v41
    v_mfma_f32_16x16x32_bf16 v[60:63], a[36:39], a[108:111], v[60:63]
    ds_read_b64_tr_b16 a[18:19], v196 offset:34816
    s_waitcnt lgkmcnt(10)
    v_mfma_f32_16x16x32_bf16 v[64:67], a[40:43], a[224:227], v[64:67]
    ds_read_b64_tr_b16 a[20:21], v196 offset:40960
    v_cvt_pk_bf16_f32 v35, v42, v43
    v_mfma_f32_16x16x32_bf16 v[64:67], a[44:47], a[232:235], v[64:67]
    ds_read_b64_tr_b16 a[22:23], v196 offset:43008
    v_mfma_f32_16x16x32_bf16 v[68:71], a[40:43], a[228:231], v[68:71]
    ds_read_b64_tr_b16 a[24:25], v197 offset:32768
    buffer_store_dwordx4 v[32:35], v13, s[20:23], s61 offen sc1
    v_mfma_f32_16x16x32_bf16 v[68:71], a[44:47], a[236:239], v[68:71]
    ds_read_b64_tr_b16 a[26:27], v197 offset:34816
    v_mfma_f32_16x16x32_bf16 v[72:75], a[48:51], a[224:227], v[72:75]
    ds_read_b64_tr_b16 a[28:29], v197 offset:40960
    v_cvt_pk_bf16_f32 v36, v36, v37
    v_mfma_f32_16x16x32_bf16 v[72:75], a[52:55], a[232:235], v[72:75]
    ds_read_b64_tr_b16 a[30:31], v197 offset:43008
    v_mfma_f32_16x16x32_bf16 v[76:79], a[48:51], a[228:231], v[76:79]
    ds_read_b64_tr_b16 a[32:33], v198 offset:32768
    v_cvt_pk_bf16_f32 v37, v38, v39
    v_mfma_f32_16x16x32_bf16 v[76:79], a[52:55], a[236:239], v[76:79]
    ds_read_b64_tr_b16 a[34:35], v198 offset:34816
    s_waitcnt lgkmcnt(10)
    v_mfma_f32_16x16x32_bf16 v[80:83], a[0:3], a[224:227], v[80:83]
    ds_read_b64_tr_b16 a[36:37], v198 offset:40960
    v_cvt_pk_bf16_f32 v38, v44, v45
    v_mfma_f32_16x16x32_bf16 v[80:83], a[4:7], a[232:235], v[80:83]
    ds_read_b64_tr_b16 a[38:39], v198 offset:43008
    v_mfma_f32_16x16x32_bf16 v[84:87], a[0:3], a[228:231], v[84:87]
    ds_read_b64_tr_b16 a[40:41], v199 offset:32768
    v_cvt_pk_bf16_f32 v39, v46, v47
    v_mfma_f32_16x16x32_bf16 v[84:87], a[4:7], a[236:239], v[84:87]
    ds_read_b64_tr_b16 a[42:43], v199 offset:34816
    v_mfma_f32_16x16x32_bf16 v[88:91], a[8:11], a[224:227], v[88:91]
    ds_read_b64_tr_b16 a[44:45], v199 offset:40960
    buffer_store_dwordx4 v[36:39], v13, s[20:23], s61 offen offset:1024 sc1
    v_mfma_f32_16x16x32_bf16 v[88:91], a[12:15], a[232:235], v[88:91]
    ds_read_b64_tr_b16 a[46:47], v199 offset:43008
    v_mfma_f32_16x16x32_bf16 v[92:95], a[8:11], a[228:231], v[92:95]
    ds_read_b64_tr_b16 a[48:49], v196 offset:49152
    v_cvt_pk_bf16_f32 v48, v48, v49
    v_mfma_f32_16x16x32_bf16 v[92:95], a[12:15], a[236:239], v[92:95]
    ds_read_b64_tr_b16 a[50:51], v196 offset:51200
    s_waitcnt lgkmcnt(10)
    v_mfma_f32_16x16x32_bf16 v[64:67], a[16:19], a[128:131], v[64:67]
    ds_read_b64_tr_b16 a[52:53], v196 offset:57344
    v_cvt_pk_bf16_f32 v49, v50, v51
    v_mfma_f32_16x16x32_bf16 v[64:67], a[20:23], a[136:139], v[64:67]
    ds_read_b64_tr_b16 a[54:55], v196 offset:59392
    v_mfma_f32_16x16x32_bf16 v[68:71], a[16:19], a[132:135], v[68:71]
    ds_read_b64_tr_b16 a[0:1], v197 offset:49152
    v_cvt_pk_bf16_f32 v50, v56, v57
    v_mfma_f32_16x16x32_bf16 v[68:71], a[20:23], a[140:143], v[68:71]
    ds_read_b64_tr_b16 a[2:3], v197 offset:51200
    v_mfma_f32_16x16x32_bf16 v[72:75], a[24:27], a[128:131], v[72:75]
    ds_read_b64_tr_b16 a[4:5], v197 offset:57344
    v_cvt_pk_bf16_f32 v51, v58, v59
    v_mfma_f32_16x16x32_bf16 v[72:75], a[28:31], a[136:139], v[72:75]
L_pad0_13:
    s_cbranch_execz L_pad0_17
    ds_read_b64_tr_b16 a[6:7], v197 offset:59392
    v_mfma_f32_16x16x32_bf16 v[76:79], a[24:27], a[132:135], v[76:79]
    ds_read_b64_tr_b16 a[8:9], v198 offset:49152
    buffer_store_dwordx4 v[48:51], v13, s[20:23], s61 offen offset:2048 sc1
    v_mfma_f32_16x16x32_bf16 v[76:79], a[28:31], a[140:143], v[76:79]
    ds_read_b64_tr_b16 a[10:11], v198 offset:51200
    s_waitcnt lgkmcnt(10)
    v_mfma_f32_16x16x32_bf16 v[80:83], a[32:35], a[128:131], v[80:83]
    ds_read_b64_tr_b16 a[12:13], v198 offset:57344
    v_cvt_pk_bf16_f32 v52, v52, v53
    v_mfma_f32_16x16x32_bf16 v[80:83], a[36:39], a[136:139], v[80:83]
    ds_read_b64_tr_b16 a[14:15], v198 offset:59392
    v_mfma_f32_16x16x32_bf16 v[84:87], a[32:35], a[132:135], v[84:87]
    ds_read_b64_tr_b16 a[16:17], v199 offset:49152
    v_cvt_pk_bf16_f32 v53, v54, v55
    v_mfma_f32_16x16x32_bf16 v[84:87], a[36:39], a[140:143], v[84:87]
    ds_read_b64_tr_b16 a[18:19], v199 offset:51200
    v_mfma_f32_16x16x32_bf16 v[88:91], a[40:43], a[128:131], v[88:91]
    ds_read_b64_tr_b16 a[20:21], v199 offset:57344
    v_cvt_pk_bf16_f32 v54, v60, v61
    v_mfma_f32_16x16x32_bf16 v[88:91], a[44:47], a[136:139], v[88:91]
    ds_read_b64_tr_b16 a[22:23], v199 offset:59392
    v_mfma_f32_16x16x32_bf16 v[92:95], a[40:43], a[132:135], v[92:95]
    ds_read_b64_tr_b16 a[24:25], v200
    v_cvt_pk_bf16_f32 v55, v62, v63
    v_mfma_f32_16x16x32_bf16 v[92:95], a[44:47], a[140:143], v[92:95]
    ds_read_b64_tr_b16 a[26:27], v200 offset:2048
    s_waitcnt lgkmcnt(10)
    v_mfma_f32_16x16x32_bf16 v[64:67], a[48:51], a[240:243], v[64:67]
    ds_read_b64_tr_b16 a[28:29], v200 offset:8192
    buffer_store_dwordx4 v[52:55], v13, s[20:23], s61 offen offset:3072 sc1
    v_mfma_f32_16x16x32_bf16 v[64:67], a[52:55], a[248:251], v[64:67]
    ds_read_b64_tr_b16 a[30:31], v200 offset:10240
    v_mfma_f32_16x16x32_bf16 v[68:71], a[48:51], a[244:247], v[68:71]
    ds_read_b64_tr_b16 a[32:33], v201
    v_mfma_f32_16x16x32_bf16 v[68:71], a[52:55], a[252:255], v[68:71]
    ds_read_b64_tr_b16 a[34:35], v201 offset:2048
    v_mfma_f32_16x16x32_bf16 v[72:75], a[0:3], a[240:243], v[72:75]
    ds_read_b64_tr_b16 a[36:37], v201 offset:8192
    v_mfma_f32_16x16x32_bf16 v[72:75], a[4:7], a[248:251], v[72:75]
    ds_read_b64_tr_b16 a[38:39], v201 offset:10240
    v_mfma_f32_16x16x32_bf16 v[76:79], a[0:3], a[244:247], v[76:79]
    ds_read_b64_tr_b16 a[40:41], v202
    v_mfma_f32_16x16x32_bf16 v[76:79], a[4:7], a[252:255], v[76:79]
    ds_read_b64_tr_b16 a[42:43], v202 offset:2048
    s_waitcnt lgkmcnt(10)
    v_mfma_f32_16x16x32_bf16 v[80:83], a[8:11], a[240:243], v[80:83]
    ds_read_b64_tr_b16 a[44:45], v202 offset:8192
    v_mfma_f32_16x16x32_bf16 v[80:83], a[12:15], a[248:251], v[80:83]
    ds_read_b64_tr_b16 a[46:47], v202 offset:10240
    v_mfma_f32_16x16x32_bf16 v[84:87], a[8:11], a[244:247], v[84:87]
    ds_read_b64_tr_b16 a[48:49], v203
    v_mfma_f32_16x16x32_bf16 v[84:87], a[12:15], a[252:255], v[84:87]
    ds_read_b64_tr_b16 a[50:51], v203 offset:2048
    v_mfma_f32_16x16x32_bf16 v[88:91], a[16:19], a[240:243], v[88:91]
    ds_read_b64_tr_b16 a[52:53], v203 offset:8192
    v_mfma_f32_16x16x32_bf16 v[88:91], a[20:23], a[248:251], v[88:91]
    ds_read_b64_tr_b16 a[54:55], v203 offset:10240
    s_barrier
    v_mfma_f32_16x16x32_bf16 v[92:95], a[16:19], a[244:247], v[92:95]
    ds_read_b64_tr_b16 a[0:1], v196 offset:20480
    s_add_u32 m0, s59, 147456
    v_mfma_f32_16x16x32_bf16 v[92:95], a[20:23], a[252:255], v[92:95]
    ds_read_b64_tr_b16 a[2:3], v196 offset:22528
    s_waitcnt lgkmcnt(10)
    v_mfma_f32_16x16x32_bf16 v[64:67], a[24:27], a[96:99], v[64:67]
    ds_read_b64_tr_b16 a[4:5], v196 offset:28672
    s_add_u32 s74, s55, 1310720
    v_mfma_f32_16x16x32_bf16 v[64:67], a[28:31], a[104:107], v[64:67]
    ds_read_b64_tr_b16 a[6:7], v196 offset:30720
    buffer_load_dwordx4 v9, s[28:31], s74 offen lds
    v_mfma_f32_16x16x32_bf16 v[68:71], a[24:27], a[100:103], v[68:71]
    ds_read_b64_tr_b16 a[8:9], v197 offset:20480
    v_mfma_f32_16x16x32_bf16 v[68:71], a[28:31], a[108:111], v[68:71]
    ds_read_b64_tr_b16 a[10:11], v197 offset:22528
    v_mfma_f32_16x16x32_bf16 v[72:75], a[32:35], a[96:99], v[72:75]
    ds_read_b64_tr_b16 a[12:13], v197 offset:28672
    buffer_load_dwordx4 v10, s[28:31], s74 offen offset:1024 lds
    v_mfma_f32_16x16x32_bf16 v[72:75], a[36:39], a[104:107], v[72:75]
    ds_read_b64_tr_b16 a[14:15], v197 offset:30720
    s_waitcnt vmcnt(17)
    v_mfma_f32_16x16x32_bf16 v[76:79], a[32:35], a[100:103], v[76:79]
    ds_read_b64_tr_b16 a[16:17], v198 offset:20480
    v_accvgpr_mov_b32 a120, a194
    v_mfma_f32_16x16x32_bf16 v[76:79], a[36:39], a[108:111], v[76:79]
    ds_read_b64_tr_b16 a[18:19], v198 offset:22528
    s_waitcnt lgkmcnt(10)
    v_mfma_f32_16x16x32_bf16 v[80:83], a[40:43], a[96:99], v[80:83]
    ds_read_b64_tr_b16 a[20:21], v198 offset:28672
    buffer_load_dwordx4 v11, s[28:31], s74 offen offset:2048 lds
    s_add_u32 s61, s62, 4096
    v_mfma_f32_16x16x32_bf16 v[80:83], a[44:47], a[104:107], v[80:83]
    ds_read_b64_tr_b16 a[22:23], v198 offset:30720
    v_accvgpr_mov_b32 a121, a195
    v_mfma_f32_16x16x32_bf16 v[84:87], a[40:43], a[100:103], v[84:87]
    ds_read_b64_tr_b16 a[24:25], v199 offset:20480
    v_accvgpr_mov_b32 a194, a196
    v_cvt_pk_bf16_f32 v64, v64, v65
    v_mfma_f32_16x16x32_bf16 v[84:87], a[44:47], a[108:111], v[84:87]
    ds_read_b64_tr_b16 a[26:27], v199 offset:22528
    v_accvgpr_mov_b32 a195, a197
    v_mfma_f32_16x16x32_bf16 v[88:91], a[48:51], a[96:99], v[88:91]
    ds_read_b64_tr_b16 a[28:29], v199 offset:28672
    v_accvgpr_mov_b32 a196, a120
    v_cvt_pk_bf16_f32 v65, v66, v67
    v_mfma_f32_16x16x32_bf16 v[88:91], a[52:55], a[104:107], v[88:91]
    ds_read_b64_tr_b16 a[30:31], v199 offset:30720
    buffer_load_dwordx4 v12, s[28:31], s74 offen offset:3072 lds
    v_mfma_f32_16x16x32_bf16 v[92:95], a[48:51], a[100:103], v[92:95]
    ds_read_b64_tr_b16 a[32:33], v196 offset:36864
    v_accvgpr_mov_b32 a197, a121
    v_cvt_pk_bf16_f32 v66, v72, v73
    v_mfma_f32_16x16x32_bf16 v[92:95], a[52:55], a[108:111], v[92:95]
    ds_read_b64_tr_b16 a[34:35], v196 offset:38912
    s_waitcnt lgkmcnt(10)
    v_mfma_f32_16x16x32_bf16 v[128:131], a[0:3], a[160:163], v[128:131]
    ds_read_b64_tr_b16 a[36:37], v196 offset:45056
    v_accvgpr_mov_b32 a120, a202
    v_cvt_pk_bf16_f32 v67, v74, v75
    v_mfma_f32_16x16x32_bf16 v[128:131], a[4:7], a[168:171], v[128:131]
    ds_read_b64_tr_b16 a[38:39], v196 offset:47104
    v_accvgpr_mov_b32 a121, a203
    v_mfma_f32_16x16x32_bf16 v[132:135], a[0:3], a[164:167], v[132:135]
    ds_read_b64_tr_b16 a[40:41], v197 offset:36864
    v_accvgpr_mov_b32 a202, a204
    v_mfma_f32_16x16x32_bf16 v[132:135], a[4:7], a[172:175], v[132:135]
    ds_read_b64_tr_b16 a[42:43], v197 offset:38912
    v_accvgpr_mov_b32 a203, a205
    v_mfma_f32_16x16x32_bf16 v[136:139], a[8:11], a[160:163], v[136:139]
    ds_read_b64_tr_b16 a[44:45], v197 offset:45056
    v_accvgpr_mov_b32 a204, a120
    v_mfma_f32_16x16x32_bf16 v[136:139], a[12:15], a[168:171], v[136:139]
    ds_read_b64_tr_b16 a[46:47], v197 offset:47104
    buffer_store_dwordx4 v[64:67], v13, s[20:23], s61 offen sc1
    v_cvt_pk_bf16_f32 v68, v68, v69
    v_mfma_f32_16x16x32_bf16 v[140:143], a[8:11], a[164:167], v[140:143]
    ds_read_b64_tr_b16 a[48:49], v198 offset:36864
    v_accvgpr_mov_b32 a205, a121
    v_cvt_pk_bf16_f32 v69, v70, v71
    v_mfma_f32_16x16x32_bf16 v[140:143], a[12:15], a[172:175], v[140:143]
    ds_read_b64_tr_b16 a[50:51], v198 offset:38912
    s_waitcnt lgkmcnt(10)
    v_mfma_f32_16x16x32_bf16 v[144:147], a[16:19], a[160:163], v[144:147]
    ds_read_b64_tr_b16 a[52:53], v198 offset:45056
    s_waitcnt vmcnt(16)
    v_cvt_pk_bf16_f32 v70, v76, v77
    v_mfma_f32_16x16x32_bf16 v[144:147], a[20:23], a[168:171], v[144:147]
    ds_read_b64_tr_b16 a[54:55], v198 offset:47104
    v_accvgpr_mov_b32 a120, a210
    v_mfma_f32_16x16x32_bf16 v[148:151], a[16:19], a[164:167], v[148:151]
    ds_read_b64_tr_b16 a[0:1], v199 offset:36864
    v_cvt_pk_bf16_f32 v71, v78, v79
    v_mfma_f32_16x16x32_bf16 v[148:151], a[20:23], a[172:175], v[148:151]
    ds_read_b64_tr_b16 a[2:3], v199 offset:38912
    v_accvgpr_mov_b32 a121, a211
    v_mfma_f32_16x16x32_bf16 v[152:155], a[24:27], a[160:163], v[152:155]
    ds_read_b64_tr_b16 a[4:5], v199 offset:45056
    v_accvgpr_mov_b32 a210, a212
    v_mfma_f32_16x16x32_bf16 v[152:155], a[28:31], a[168:171], v[152:155]
    ds_read_b64_tr_b16 a[6:7], v199 offset:47104
    buffer_store_dwordx4 v[68:71], v13, s[20:23], s61 offen offset:1024 sc1
    v_mfma_f32_16x16x32_bf16 v[156:159], a[24:27], a[164:167], v[156:159]
    ds_read_b64_tr_b16 a[8:9], v196 offset:53248
    v_accvgpr_mov_b32 a211, a213
    v_cvt_pk_bf16_f32 v80, v80, v81
    v_mfma_f32_16x16x32_bf16 v[156:159], a[28:31], a[172:175], v[156:159]
    ds_read_b64_tr_b16 a[10:11], v196 offset:55296
    s_waitcnt lgkmcnt(10)
    v_mfma_f32_16x16x32_bf16 v[128:131], a[32:35], a[176:179], v[128:131]
    ds_read_b64_tr_b16 a[12:13], v196 offset:61440
    v_accvgpr_mov_b32 a212, a120
    v_cvt_pk_bf16_f32 v81, v82, v83
    v_mfma_f32_16x16x32_bf16 v[128:131], a[36:39], a[184:187], v[128:131]
    ds_read_b64_tr_b16 a[14:15], v196 offset:63488
    v_accvgpr_mov_b32 a213, a121
    v_mfma_f32_16x16x32_bf16 v[132:135], a[32:35], a[180:183], v[132:135]
    ds_read_b64_tr_b16 a[16:17], v197 offset:53248
    v_accvgpr_mov_b32 a120, a218
    v_cvt_pk_bf16_f32 v82, v88, v89
    v_mfma_f32_16x16x32_bf16 v[132:135], a[36:39], a[188:191], v[132:135]
    ds_read_b64_tr_b16 a[18:19], v197 offset:55296
    v_mfma_f32_16x16x32_bf16 v[136:139], a[40:43], a[176:179], v[136:139]
    ds_read_b64_tr_b16 a[20:21], v197 offset:61440
    v_accvgpr_mov_b32 a121, a219
    v_cvt_pk_bf16_f32 v83, v90, v91
    v_mfma_f32_16x16x32_bf16 v[136:139], a[44:47], a[184:187], v[136:139]
    ds_read_b64_tr_b16 a[22:23], v197 offset:63488
    v_accvgpr_mov_b32 a218, a220
    v_mfma_f32_16x16x32_bf16 v[140:143], a[40:43], a[180:183], v[140:143]
    ds_read_b64_tr_b16 a[24:25], v198 offset:53248
    buffer_store_dwordx4 v[80:83], v13, s[20:23], s61 offen offset:2048 sc1
    v_mfma_f32_16x16x32_bf16 v[140:143], a[44:47], a[188:191], v[140:143]
    ds_read_b64_tr_b16 a[26:27], v198 offset:55296
    s_waitcnt lgkmcnt(10)
    v_mfma_f32_16x16x32_bf16 v[144:147], a[48:51], a[176:179], v[144:147]
    ds_read_b64_tr_b16 a[28:29], v198 offset:61440
    buffer_load_dword v206, v204, s[20:23], s76 offen sc1
    v_cvt_pk_bf16_f32 v84, v84, v85
    v_mfma_f32_16x16x32_bf16 v[144:147], a[52:55], a[184:187], v[144:147]
    ds_read_b64_tr_b16 a[30:31], v198 offset:63488
    v_accvgpr_mov_b32 a219, a221
    v_mfma_f32_16x16x32_bf16 v[148:151], a[48:51], a[180:183], v[148:151]
    ds_read_b64_tr_b16 a[32:33], v199 offset:53248
    v_accvgpr_mov_b32 a220, a120
    v_cvt_pk_bf16_f32 v85, v86, v87
    v_mfma_f32_16x16x32_bf16 v[148:151], a[52:55], a[188:191], v[148:151]
    ds_read_b64_tr_b16 a[34:35], v199 offset:55296
    v_accvgpr_mov_b32 a221, a121
    v_mfma_f32_16x16x32_bf16 v[152:155], a[0:3], a[176:179], v[152:155]
    ds_read_b64_tr_b16 a[36:37], v199 offset:61440
    v_cvt_pk_bf16_f32 v86, v92, v93
    v_mfma_f32_16x16x32_bf16 v[152:155], a[4:7], a[184:187], v[152:155]
    ds_read_b64_tr_b16 a[38:39], v199 offset:63488
    v_mfma_f32_16x16x32_bf16 v[156:159], a[0:3], a[180:183], v[156:159]
    ds_read_b64_tr_b16 a[40:41], v200 offset:4096
    s_waitcnt vmcnt(8)
    v_accvgpr_write_b32 a124, 1
    s_mov_b64 exec, 1
    buffer_store_dword a124, off, s[20:23], s84 sc1
    s_mov_b64 exec, -1
    v_cvt_pk_bf16_f32 v87, v94, v95
    v_mfma_f32_16x16x32_bf16 v[156:159], a[4:7], a[188:191], v[156:159]
    ds_read_b64_tr_b16 a[42:43], v200 offset:6144
    s_waitcnt lgkmcnt(10)
    v_mfma_f32_16x16x32_bf16 v[128:131], a[8:11], a[192:195], v[128:131]
    ds_read_b64_tr_b16 a[44:45], v200 offset:12288
    buffer_store_dwordx4 v[84:87], v13, s[20:23], s61 offen offset:3072 sc1
    v_mfma_f32_16x16x32_bf16 v[128:131], a[12:15], a[200:203], v[128:131]
    ds_read_b64_tr_b16 a[46:47], v200 offset:14336
    v_mfma_f32_16x16x32_bf16 v[132:135], a[8:11], a[196:199], v[132:135]
    ds_read_b64_tr_b16 a[48:49], v201 offset:4096
    v_mfma_f32_16x16x32_bf16 v[132:135], a[12:15], a[204:207], v[132:135]
    ds_read_b64_tr_b16 a[50:51], v201 offset:6144
    v_mfma_f32_16x16x32_bf16 v[136:139], a[16:19], a[192:195], v[136:139]
    ds_read_b64_tr_b16 a[52:53], v201 offset:12288
    v_mfma_f32_16x16x32_bf16 v[136:139], a[20:23], a[200:203], v[136:139]
    ds_read_b64_tr_b16 a[54:55], v201 offset:14336
    v_mfma_f32_16x16x32_bf16 v[140:143], a[16:19], a[196:199], v[140:143]
    ds_read_b64_tr_b16 a[0:1], v202 offset:4096
    v_mfma_f32_16x16x32_bf16 v[140:143], a[20:23], a[204:207], v[140:143]
    ds_read_b64_tr_b16 a[2:3], v202 offset:6144
    s_waitcnt lgkmcnt(10)
    v_mfma_f32_16x16x32_bf16 v[144:147], a[24:27], a[192:195], v[144:147]
    ds_read_b64_tr_b16 a[4:5], v202 offset:12288
    v_mfma_f32_16x16x32_bf16 v[144:147], a[28:31], a[200:203], v[144:147]
    ds_read_b64_tr_b16 a[6:7], v202 offset:14336
    v_mfma_f32_16x16x32_bf16 v[148:151], a[24:27], a[196:199], v[148:151]
    ds_read_b64_tr_b16 a[8:9], v203 offset:4096
    v_mfma_f32_16x16x32_bf16 v[148:151], a[28:31], a[204:207], v[148:151]
    ds_read_b64_tr_b16 a[10:11], v203 offset:6144
    v_mfma_f32_16x16x32_bf16 v[152:155], a[32:35], a[192:195], v[152:155]
    ds_read_b64_tr_b16 a[12:13], v203 offset:12288
    v_mfma_f32_16x16x32_bf16 v[152:155], a[36:39], a[200:203], v[152:155]
    ds_read_b64_tr_b16 a[14:15], v203 offset:14336
    v_mfma_f32_16x16x32_bf16 v[156:159], a[32:35], a[196:199], v[156:159]
    ds_read_b64_tr_b16 a[16:17], v196 offset:16384
    v_mfma_f32_16x16x32_bf16 v[156:159], a[36:39], a[204:207], v[156:159]
    ds_read_b64_tr_b16 a[18:19], v196 offset:18432
    s_waitcnt lgkmcnt(10)
    v_mfma_f32_16x16x32_bf16 v[128:131], a[40:43], a[208:211], v[128:131]
    ds_read_b64_tr_b16 a[20:21], v196 offset:24576
    v_mfma_f32_16x16x32_bf16 v[128:131], a[44:47], a[216:219], v[128:131]
    ds_read_b64_tr_b16 a[22:23], v196 offset:26624
    v_mfma_f32_16x16x32_bf16 v[132:135], a[40:43], a[212:215], v[132:135]
    ds_read_b64_tr_b16 a[24:25], v197 offset:16384
    v_mfma_f32_16x16x32_bf16 v[132:135], a[44:47], a[220:223], v[132:135]
    ds_read_b64_tr_b16 a[26:27], v197 offset:18432
    v_mfma_f32_16x16x32_bf16 v[136:139], a[48:51], a[208:211], v[136:139]
    ds_read_b64_tr_b16 a[28:29], v197 offset:24576
    v_mfma_f32_16x16x32_bf16 v[136:139], a[52:55], a[216:219], v[136:139]
    ds_read_b64_tr_b16 a[30:31], v197 offset:26624
    v_mfma_f32_16x16x32_bf16 v[140:143], a[48:51], a[212:215], v[140:143]
    ds_read_b64_tr_b16 a[32:33], v198 offset:16384
    v_mfma_f32_16x16x32_bf16 v[140:143], a[52:55], a[220:223], v[140:143]
    ds_read_b64_tr_b16 a[34:35], v198 offset:18432
    s_waitcnt lgkmcnt(10)
    v_mfma_f32_16x16x32_bf16 v[144:147], a[0:3], a[208:211], v[144:147]
    ds_read_b64_tr_b16 a[36:37], v198 offset:24576
    s_xor_b32 s61, s54, 128
    v_mfma_f32_16x16x32_bf16 v[144:147], a[4:7], a[216:219], v[144:147]
    ds_read_b64_tr_b16 a[38:39], v198 offset:26624
    v_cvt_pk_bf16_f32 v128, v128, v129
    v_mfma_f32_16x16x32_bf16 v[148:151], a[0:3], a[212:215], v[148:151]
    ds_read_b64_tr_b16 a[40:41], v199 offset:16384
    v_cvt_pk_bf16_f32 v129, v130, v131
    v_mfma_f32_16x16x32_bf16 v[148:151], a[4:7], a[220:223], v[148:151]
    ds_read_b64_tr_b16 a[42:43], v199 offset:18432
    v_cvt_pk_bf16_f32 v130, v136, v137
    v_mfma_f32_16x16x32_bf16 v[152:155], a[8:11], a[208:211], v[152:155]
    ds_read_b64_tr_b16 a[44:45], v199 offset:24576
    v_cvt_pk_bf16_f32 v131, v138, v139
    v_mfma_f32_16x16x32_bf16 v[152:155], a[12:15], a[216:219], v[152:155]
    ds_read_b64_tr_b16 a[46:47], v199 offset:26624
    buffer_store_dwordx4 v[128:131], v9, s[32:35], s61 offen sc1
    v_mfma_f32_16x16x32_bf16 v[156:159], a[8:11], a[212:215], v[156:159]
    ds_read_b64_tr_b16 a[48:49], v196 offset:32768
    v_cvt_pk_bf16_f32 v132, v132, v133
    v_mfma_f32_16x16x32_bf16 v[156:159], a[12:15], a[220:223], v[156:159]
    ds_read_b64_tr_b16 a[50:51], v196 offset:34816
    s_waitcnt lgkmcnt(10)
    v_mfma_f32_16x16x32_bf16 v[96:99], a[16:19], a[160:163], v[96:99]
    ds_read_b64_tr_b16 a[52:53], v196 offset:40960
    v_cvt_pk_bf16_f32 v133, v134, v135
    v_mfma_f32_16x16x32_bf16 v[96:99], a[20:23], a[168:171], v[96:99]
    ds_read_b64_tr_b16 a[54:55], v196 offset:43008
    v_cvt_pk_bf16_f32 v134, v140, v141
    v_mfma_f32_16x16x32_bf16 v[100:103], a[16:19], a[164:167], v[100:103]
    ds_read_b64_tr_b16 a[0:1], v197 offset:32768
    v_cvt_pk_bf16_f32 v135, v142, v143
    v_mfma_f32_16x16x32_bf16 v[100:103], a[20:23], a[172:175], v[100:103]
    ds_read_b64_tr_b16 a[2:3], v197 offset:34816
    buffer_store_dwordx4 v[132:135], v10, s[32:35], s61 offen offset:1024 sc1
    v_mfma_f32_16x16x32_bf16 v[104:107], a[24:27], a[160:163], v[104:107]
    ds_read_b64_tr_b16 a[4:5], v197 offset:40960
    s_waitcnt vmcnt(4)
    v_cmp_le_u32 vcc, 1, v206
    s_nop 0
    s_cmp_eq_u64 vcc, -1
    s_cbranch_scc0 L_poa_spin
L_poa_ok:
    v_mfma_f32_16x16x32_bf16 v[104:107], a[28:31], a[168:171], v[104:107]
    ds_read_b64_tr_b16 a[6:7], v197 offset:43008
    s_add_u32 s75, s57, 0
    v_mfma_f32_16x16x32_bf16 v[108:111], a[24:27], a[164:167], v[108:111]
    ds_read_b64_tr_b16 a[8:9], v198 offset:32768
    buffer_load_dwordx4 a[224:227], v13, s[20:23], s75 offen sc1
    v_mfma_f32_16x16x32_bf16 v[108:111], a[28:31], a[172:175], v[108:111]
    ds_read_b64_tr_b16 a[10:11], v198 offset:34816
    s_waitcnt lgkmcnt(10)
    v_mfma_f32_16x16x32_bf16 v[112:115], a[32:35], a[160:163], v[112:115]
    ds_read_b64_tr_b16 a[12:13], v198 offset:40960
    buffer_load_dwordx4 a[228:231], v13, s[20:23], s75 offen offset:1024 sc1
    v_mfma_f32_16x16x32_bf16 v[112:115], a[36:39], a[168:171], v[112:115]
    ds_read_b64_tr_b16 a[14:15], v198 offset:43008
    v_cvt_pk_bf16_f32 v144, v144, v145
    v_mfma_f32_16x16x32_bf16 v[116:119], a[32:35], a[164:167], v[116:119]
    ds_read_b64_tr_b16 a[16:17], v199 offset:32768
    v_cvt_pk_bf16_f32 v145, v146, v147
    v_mfma_f32_16x16x32_bf16 v[116:119], a[36:39], a[172:175], v[116:119]
    ds_read_b64_tr_b16 a[18:19], v199 offset:34816
    buffer_load_dwordx4 a[232:235], v13, s[20:23], s75 offen offset:2048 sc1
    v_mfma_f32_16x16x32_bf16 v[120:123], a[40:43], a[160:163], v[120:123]
    ds_read_b64_tr_b16 a[20:21], v199 offset:40960
    v_cvt_pk_bf16_f32 v146, v152, v153
    v_mfma_f32_16x16x32_bf16 v[120:123], a[44:47], a[168:171], v[120:123]
    ds_read_b64_tr_b16 a[22:23], v199 offset:43008
    v_cvt_pk_bf16_f32 v147, v154, v155
    v_mfma_f32_16x16x32_bf16 v[124:127], a[40:43], a[164:167], v[124:127]
    ds_read_b64_tr_b16 a[24:25], v196 offset:49152
    buffer_store_dwordx4 v[144:147], v11, s[32:35], s61 offen offset:2048 sc1
    v_mfma_f32_16x16x32_bf16 v[124:127], a[44:47], a[172:175], v[124:127]
    ds_read_b64_tr_b16 a[26:27], v196 offset:51200
    s_waitcnt lgkmcnt(10)
    v_mfma_f32_16x16x32_bf16 v[96:99], a[48:51], a[176:179], v[96:99]
    ds_read_b64_tr_b16 a[28:29], v196 offset:57344
    buffer_load_dwordx4 a[236:239], v13, s[20:23], s75 offen offset:3072 sc1
    v_mfma_f32_16x16x32_bf16 v[96:99], a[52:55], a[184:187], v[96:99]
    ds_read_b64_tr_b16 a[30:31], v196 offset:59392
    s_add_u32 s75, s57, 262144
    v_mfma_f32_16x16x32_bf16 v[100:103], a[48:51], a[180:183], v[100:103]
    ds_read_b64_tr_b16 a[32:33], v197 offset:49152
    buffer_load_dwordx4 a[128:131], v13, s[20:23], s75 offen sc1
    v_mfma_f32_16x16x32_bf16 v[100:103], a[52:55], a[188:191], v[100:103]
    ds_read_b64_tr_b16 a[34:35], v197 offset:51200
    v_cvt_pk_bf16_f32 v148, v148, v149
    v_mfma_f32_16x16x32_bf16 v[104:107], a[0:3], a[176:179], v[104:107]
    ds_read_b64_tr_b16 a[36:37], v197 offset:57344
    v_cvt_pk_bf16_f32 v149, v150, v151
    v_mfma_f32_16x16x32_bf16 v[104:107], a[4:7], a[184:187], v[104:107]
    ds_read_b64_tr_b16 a[38:39], v197 offset:59392
    buffer_load_dwordx4 a[132:135], v13, s[20:23], s75 offen offset:1024 sc1
    v_mfma_f32_16x16x32_bf16 v[108:111], a[0:3], a[180:183], v[108:111]
    ds_read_b64_tr_b16 a[40:41], v198 offset:49152
    v_cvt_pk_bf16_f32 v150, v156, v157
    v_mfma_f32_16x16x32_bf16 v[108:111], a[4:7], a[188:191], v[108:111]
    ds_read_b64_tr_b16 a[42:43], v198 offset:51200
    s_waitcnt lgkmcnt(10)
    v_mfma_f32_16x16x32_bf16 v[112:115], a[8:11], a[176:179], v[112:115]
    ds_read_b64_tr_b16 a[44:45], v198 offset:57344
    buffer_load_dwordx4 a[136:139], v13, s[20:23], s75 offen offset:2048 sc1
    v_mfma_f32_16x16x32_bf16 v[112:115], a[12:15], a[184:187], v[112:115]
    ds_read_b64_tr_b16 a[46:47], v198 offset:59392
    v_cvt_pk_bf16_f32 v151, v158, v159
    v_mfma_f32_16x16x32_bf16 v[116:119], a[8:11], a[180:183], v[116:119]
    ds_read_b64_tr_b16 a[48:49], v199 offset:49152
    buffer_store_dwordx4 v[148:151], v12, s[32:35], s61 offen offset:3072 sc1
    v_mfma_f32_16x16x32_bf16 v[116:119], a[12:15], a[188:191], v[116:119]
    ds_read_b64_tr_b16 a[50:51], v199 offset:51200
    buffer_load_dwordx4 a[140:143], v13, s[20:23], s75 offen offset:3072 sc1
    v_mfma_f32_16x16x32_bf16 v[120:123], a[16:19], a[176:179], v[120:123]
    ds_read_b64_tr_b16 a[52:53], v199 offset:57344
    v_mfma_f32_16x16x32_bf16 v[120:123], a[20:23], a[184:187], v[120:123]
    ds_read_b64_tr_b16 a[54:55], v199 offset:59392
    s_add_u32 s75, s57, 524288
    v_mfma_f32_16x16x32_bf16 v[124:127], a[16:19], a[180:183], v[124:127]
    ds_read_b64_tr_b16 a[0:1], v200
    s_waitcnt vmcnt(12)
    v_accvgpr_write_b32 a124, 2
    s_mov_b64 exec, 1
    buffer_store_dword a124, off, s[20:23], s84 sc1
    s_mov_b64 exec, -1
    v_mfma_f32_16x16x32_bf16 v[124:127], a[20:23], a[188:191], v[124:127]
    ds_read_b64_tr_b16 a[2:3], v200 offset:2048
    s_xor_b32 s77, s84, 768
    s_waitcnt lgkmcnt(10)
    v_mfma_f32_16x16x32_bf16 v[96:99], a[24:27], a[192:195], v[96:99]
    ds_read_b64_tr_b16 a[4:5], v200 offset:8192
    buffer_load_dword v207, off, s[20:23], s77 sc1
    v_mfma_f32_16x16x32_bf16 v[96:99], a[28:31], a[200:203], v[96:99]
    ds_read_b64_tr_b16 a[6:7], v200 offset:10240
    buffer_load_dwordx4 a[240:243], v13, s[20:23], s75 offen sc1
    v_mfma_f32_16x16x32_bf16 v[100:103], a[24:27], a[196:199], v[100:103]
    ds_read_b64_tr_b16 a[8:9], v201
    buffer_load_dwordx4 a[244:247], v13, s[20:23], s75 offen offset:1024 sc1
    v_mfma_f32_16x16x32_bf16 v[100:103], a[28:31], a[204:207], v[100:103]
    ds_read_b64_tr_b16 a[10:11], v201 offset:2048
    v_mfma_f32_16x16x32_bf16 v[104:107], a[32:35], a[192:195], v[104:107]
    ds_read_b64_tr_b16 a[12:13], v201 offset:8192
    buffer_load_dwordx4 a[248:251], v13, s[20:23], s75 offen offset:2048 sc1
    v_mfma_f32_16x16x32_bf16 v[104:107], a[36:39], a[200:203], v[104:107]
    ds_read_b64_tr_b16 a[14:15], v201 offset:10240
    v_mfma_f32_16x16x32_bf16 v[108:111], a[32:35], a[196:199], v[108:111]
    ds_read_b64_tr_b16 a[16:17], v202
    v_mfma_f32_16x16x32_bf16 v[108:111], a[36:39], a[204:207], v[108:111]
    ds_read_b64_tr_b16 a[18:19], v202 offset:2048
    s_waitcnt lgkmcnt(10)
    v_mfma_f32_16x16x32_bf16 v[112:115], a[40:43], a[192:195], v[112:115]
    ds_read_b64_tr_b16 a[20:21], v202 offset:8192
    buffer_load_dwordx4 a[252:255], v13, s[20:23], s75 offen offset:3072 sc1
    v_mfma_f32_16x16x32_bf16 v[112:115], a[44:47], a[200:203], v[112:115]
    ds_read_b64_tr_b16 a[22:23], v202 offset:10240
    s_add_u32 s75, s57, 786432
    v_mfma_f32_16x16x32_bf16 v[116:119], a[40:43], a[196:199], v[116:119]
    ds_read_b64_tr_b16 a[24:25], v203
    buffer_load_dwordx4 a[96:99], v13, s[20:23], s75 offen sc1
    v_mfma_f32_16x16x32_bf16 v[116:119], a[44:47], a[204:207], v[116:119]
    ds_read_b64_tr_b16 a[26:27], v203 offset:2048
    v_mfma_f32_16x16x32_bf16 v[120:123], a[48:51], a[192:195], v[120:123]
    ds_read_b64_tr_b16 a[28:29], v203 offset:8192
    v_mfma_f32_16x16x32_bf16 v[120:123], a[52:55], a[200:203], v[120:123]
    ds_read_b64_tr_b16 a[30:31], v203 offset:10240
    s_barrier
    v_mfma_f32_16x16x32_bf16 v[124:127], a[48:51], a[196:199], v[124:127]
    ds_read_b64_tr_b16 a[32:33], v192
    buffer_load_dwordx4 a[100:103], v13, s[20:23], s75 offen offset:1024 sc1
    v_mfma_f32_16x16x32_bf16 v[124:127], a[52:55], a[204:207], v[124:127]
    ds_read_b64_tr_b16 a[34:35], v192 offset:2048
    s_waitcnt lgkmcnt(10)
    v_mfma_f32_16x16x32_bf16 v[96:99], a[0:3], a[208:211], v[96:99]
    ds_read_b64_tr_b16 a[36:37], v192 offset:4096
    v_mfma_f32_16x16x32_bf16 v[96:99], a[4:7], a[216:219], v[96:99]
    ds_read_b64_tr_b16 a[38:39], v192 offset:6144
    buffer_load_dwordx4 a[104:107], v13, s[20:23], s75 offen offset:2048 sc1
    v_mfma_f32_16x16x32_bf16 v[100:103], a[0:3], a[212:215], v[100:103]
    ds_read_b64_tr_b16 a[40:41], v193
    v_mfma_f32_16x16x32_bf16 v[100:103], a[4:7], a[220:223], v[100:103]
    ds_read_b64_tr_b16 a[42:43], v193 offset:2048
    v_mfma_f32_16x16x32_bf16 v[104:107], a[8:11], a[208:211], v[104:107]
    ds_read_b64_tr_b16 a[44:45], v193 offset:4096
    buffer_load_dwordx4 a[108:111], v13, s[20:23], s75 offen offset:3072 sc1
    v_mfma_f32_16x16x32_bf16 v[104:107], a[12:15], a[216:219], v[104:107]
    ds_read_b64_tr_b16 a[46:47], v193 offset:6144
    v_mfma_f32_16x16x32_bf16 v[108:111], a[8:11], a[212:215], v[108:111]
    ds_read_b64_tr_b16 a[48:49], v194
    s_add_u32 s75, s57, 1048576
    v_mfma_f32_16x16x32_bf16 v[108:111], a[12:15], a[220:223], v[108:111]
    ds_read_b64_tr_b16 a[50:51], v194 offset:2048
    s_waitcnt lgkmcnt(10)
    v_mfma_f32_16x16x32_bf16 v[112:115], a[16:19], a[208:211], v[112:115]
    ds_read_b64_tr_b16 a[52:53], v194 offset:4096
    buffer_load_dwordx4 a[160:163], v13, s[20:23], s75 offen sc1
    v_mfma_f32_16x16x32_bf16 v[112:115], a[20:23], a[216:219], v[112:115]
    ds_read_b64_tr_b16 a[54:55], v194 offset:6144
    v_mfma_f32_16x16x32_bf16 v[116:119], a[16:19], a[212:215], v[116:119]
    ds_read_b64_tr_b16 a[0:1], v195
    buffer_load_dwordx4 a[164:167], v13, s[20:23], s75 offen offset:1024 sc1
    v_mfma_f32_16x16x32_bf16 v[116:119], a[20:23], a[220:223], v[116:119]
    ds_read_b64_tr_b16 a[2:3], v195 offset:2048
    v_mfma_f32_16x16x32_bf16 v[120:123], a[24:27], a[208:211], v[120:123]
    ds_read_b64_tr_b16 a[4:5], v195 offset:4096
    v_mfma_f32_16x16x32_bf16 v[120:123], a[28:31], a[216:219], v[120:123]
    ds_read_b64_tr_b16 a[6:7], v195 offset:6144
    buffer_load_dwordx4 a[168:171], v13, s[20:23], s75 offen offset:2048 sc1
    v_mfma_f32_16x16x32_bf16 v[124:127], a[24:27], a[212:215], v[124:127]
    ds_read_b64_tr_b16 a[8:9], v192 offset:8192
    v_mfma_f32_16x16x32_bf16 v[124:127], a[28:31], a[220:223], v[124:127]
    ds_read_b64_tr_b16 a[10:11], v192 offset:10240
    s_waitcnt vmcnt(18) lgkmcnt(10)
    v_mfma_f32_16x16x32_bf16 v[160:163], a[32:35], a[224:227], 0
    ds_read_b64_tr_b16 a[12:13], v192 offset:12288
    buffer_load_dwordx4 a[172:175], v13, s[20:23], s75 offen offset:3072 sc1
    v_mfma_f32_16x16x32_bf16 v[160:163], a[36:39], a[232:235], v[160:163]
    ds_read_b64_tr_b16 a[14:15], v192 offset:14336
    v_mfma_f32_16x16x32_bf16 v[164:167], a[32:35], a[228:231], 0
    ds_read_b64_tr_b16 a[16:17], v193 offset:8192
    s_add_u32 s75, s57, 1310720
    v_mfma_f32_16x16x32_bf16 v[164:167], a[36:39], a[236:239], v[164:167]
    ds_read_b64_tr_b16 a[18:19], v193 offset:10240
    buffer_load_dwordx4 a[176:179], v13, s[20:23], s75 offen sc1
    v_mfma_f32_16x16x32_bf16 v[168:171], a[40:43], a[224:227], 0
    ds_read_b64_tr_b16 a[20:21], v193 offset:12288
    v_mfma_f32_16x16x32_bf16 v[168:171], a[44:47], a[232:235], v[168:171]
    ds_read_b64_tr_b16 a[22:23], v193 offset:14336
    v_mfma_f32_16x16x32_bf16 v[172:175], a[40:43], a[228:231], 0
    ds_read_b64_tr_b16 a[24:25], v194 offset:8192
    buffer_load_dwordx4 a[180:183], v13, s[20:23], s75 offen offset:1024 sc1
    v_mfma_f32_16x16x32_bf16 v[172:175], a[44:47], a[236:239], v[172:175]
    ds_read_b64_tr_b16 a[26:27], v194 offset:10240
    s_waitcnt lgkmcnt(10)
    v_mfma_f32_16x16x32_bf16 v[176:179], a[48:51], a[224:227], 0
    ds_read_b64_tr_b16 a[28:29], v194 offset:12288
    v_mfma_f32_16x16x32_bf16 v[176:179], a[52:55], a[232:235], v[176:179]
    ds_read_b64_tr_b16 a[30:31], v194 offset:14336
    buffer_load_dwordx4 a[184:187], v13, s[20:23], s75 offen offset:2048 sc1
    v_mfma_f32_16x16x32_bf16 v[180:183], a[48:51], a[228:231], 0
    ds_read_b64_tr_b16 a[32:33], v195 offset:8192
    v_mfma_f32_16x16x32_bf16 v[180:183], a[52:55], a[236:239], v[180:183]
    ds_read_b64_tr_b16 a[34:35], v195 offset:10240
    v_mfma_f32_16x16x32_bf16 v[184:187], a[0:3], a[224:227], 0
    ds_read_b64_tr_b16 a[36:37], v195 offset:12288
    s_waitcnt vmcnt(15)
    v_cmp_le_u32 vcc, 1, v207
    s_nop 0
    s_cmp_eq_u64 vcc, -1
    s_cbranch_scc0 L_px1a_spin
L_px1a_ok:
    v_mfma_f32_16x16x32_bf16 v[184:187], a[4:7], a[232:235], v[184:187]
    ds_read_b64_tr_b16 a[38:39], v195 offset:14336
    s_add_u32 s100, s63, 0
    v_mfma_f32_16x16x32_bf16 v[188:191], a[0:3], a[228:231], 0
    ds_read_b64_tr_b16 a[40:41], v192 offset:16384
    buffer_load_dwordx4 v[32:35], v13, s[20:23], s100 offen sc1
    v_mfma_f32_16x16x32_bf16 v[188:191], a[4:7], a[236:239], v[188:191]
    ds_read_b64_tr_b16 a[42:43], v192 offset:18432
    s_waitcnt lgkmcnt(10)
    v_mfma_f32_16x16x32_bf16 v[160:163], a[8:11], a[128:131], v[160:163]
    ds_read_b64_tr_b16 a[44:45], v192 offset:20480
    buffer_load_dwordx4 v[36:39], v13, s[20:23], s100 offen offset:1024 sc1
    v_mfma_f32_16x16x32_bf16 v[160:163], a[12:15], a[136:139], v[160:163]
    ds_read_b64_tr_b16 a[46:47], v192 offset:22528
    v_mfma_f32_16x16x32_bf16 v[164:167], a[8:11], a[132:135], v[164:167]
    ds_read_b64_tr_b16 a[48:49], v193 offset:16384
    v_mfma_f32_16x16x32_bf16 v[164:167], a[12:15], a[140:143], v[164:167]
    ds_read_b64_tr_b16 a[50:51], v193 offset:18432
    buffer_load_dwordx4 v[40:43], v13, s[20:23], s100 offen offset:2048 sc1
    v_mfma_f32_16x16x32_bf16 v[168:171], a[16:19], a[128:131], v[168:171]
    ds_read_b64_tr_b16 a[52:53], v193 offset:20480
    v_mfma_f32_16x16x32_bf16 v[168:171], a[20:23], a[136:139], v[168:171]
L_pad0_14:
    s_cbranch_execz L_pad0_18
    ds_read_b64_tr_b16 a[54:55], v193 offset:22528
    v_mfma_f32_16x16x32_bf16 v[172:175], a[16:19], a[132:135], v[172:175]
    ds_read_b64_tr_b16 a[0:1], v194 offset:16384
    buffer_load_dwordx4 v[44:47], v13, s[20:23], s100 offen offset:3072 sc1
    v_mfma_f32_16x16x32_bf16 v[172:175], a[20:23], a[140:143], v[172:175]
    ds_read_b64_tr_b16 a[2:3], v194 offset:18432
    s_waitcnt lgkmcnt(10)
    v_mfma_f32_16x16x32_bf16 v[176:179], a[24:27], a[128:131], v[176:179]
    ds_read_b64_tr_b16 a[4:5], v194 offset:20480
    v_mfma_f32_16x16x32_bf16 v[176:179], a[28:31], a[136:139], v[176:179]
    ds_read_b64_tr_b16 a[6:7], v194 offset:22528
    buffer_load_dwordx4 a[188:191], v13, s[20:23], s75 offen offset:3072 sc1
    v_mfma_f32_16x16x32_bf16 v[180:183], a[24:27], a[132:135], v[180:183]
    ds_read_b64_tr_b16 a[8:9], v195 offset:16384
    v_mfma_f32_16x16x32_bf16 v[180:183], a[28:31], a[140:143], v[180:183]
    ds_read_b64_tr_b16 a[10:11], v195 offset:18432
    s_add_u32 s75, s57, 1572864
    v_mfma_f32_16x16x32_bf16 v[184:187], a[32:35], a[128:131], v[184:187]
    ds_read_b64_tr_b16 a[12:13], v195 offset:20480
    buffer_load_dwordx4 a[192:195], v13, s[20:23], s75 offen sc1
    v_mfma_f32_16x16x32_bf16 v[184:187], a[36:39], a[136:139], v[184:187]
    ds_read_b64_tr_b16 a[14:15], v195 offset:22528
    v_mfma_f32_16x16x32_bf16 v[188:191], a[32:35], a[132:135], v[188:191]
    ds_read_b64_tr_b16 a[16:17], v192 offset:24576
    v_accvgpr_write_b32 a124, 3
    s_mov_b64 exec, 1
    buffer_store_dword a124, off, s[20:23], s84 sc1
    s_mov_b64 exec, -1
    v_mfma_f32_16x16x32_bf16 v[188:191], a[36:39], a[140:143], v[188:191]
    ds_read_b64_tr_b16 a[18:19], v192 offset:26624
    s_xor_b32 s77, s84, 512
    s_waitcnt vmcnt(18) lgkmcnt(10)
    v_mfma_f32_16x16x32_bf16 v[160:163], a[40:43], a[240:243], v[160:163]
    ds_read_b64_tr_b16 a[20:21], v192 offset:28672
    buffer_load_dword v207, off, s[20:23], s77 sc1
    v_mfma_f32_16x16x32_bf16 v[160:163], a[44:47], a[248:251], v[160:163]
    ds_read_b64_tr_b16 a[22:23], v192 offset:30720
    buffer_load_dwordx4 a[196:199], v13, s[20:23], s75 offen offset:1024 sc1
    v_mfma_f32_16x16x32_bf16 v[164:167], a[40:43], a[244:247], v[164:167]
    ds_read_b64_tr_b16 a[24:25], v193 offset:24576
    buffer_load_dwordx4 a[200:203], v13, s[20:23], s75 offen offset:2048 sc1
    v_mfma_f32_16x16x32_bf16 v[164:167], a[44:47], a[252:255], v[164:167]
    ds_read_b64_tr_b16 a[26:27], v193 offset:26624
    v_mfma_f32_16x16x32_bf16 v[168:171], a[48:51], a[240:243], v[168:171]
    ds_read_b64_tr_b16 a[28:29], v193 offset:28672
    v_mfma_f32_16x16x32_bf16 v[168:171], a[52:55], a[248:251], v[168:171]
    ds_read_b64_tr_b16 a[30:31], v193 offset:30720
    buffer_load_dwordx4 a[204:207], v13, s[20:23], s75 offen offset:3072 sc1
    v_mfma_f32_16x16x32_bf16 v[172:175], a[48:51], a[244:247], v[172:175]
    ds_read_b64_tr_b16 a[32:33], v194 offset:24576
    v_mfma_f32_16x16x32_bf16 v[172:175], a[52:55], a[252:255], v[172:175]
    ds_read_b64_tr_b16 a[34:35], v194 offset:26624
    s_waitcnt lgkmcnt(10)
    v_mfma_f32_16x16x32_bf16 v[176:179], a[0:3], a[240:243], v[176:179]
    ds_read_b64_tr_b16 a[36:37], v194 offset:28672
    s_add_u32 s75, s57, 1835008
    v_mfma_f32_16x16x32_bf16 v[176:179], a[4:7], a[248:251], v[176:179]
    ds_read_b64_tr_b16 a[38:39], v194 offset:30720
    buffer_load_dwordx4 a[208:211], v13, s[20:23], s75 offen sc1
    v_mfma_f32_16x16x32_bf16 v[180:183], a[0:3], a[244:247], v[180:183]
    ds_read_b64_tr_b16 a[40:41], v195 offset:24576
    v_mfma_f32_16x16x32_bf16 v[180:183], a[4:7], a[252:255], v[180:183]
    ds_read_b64_tr_b16 a[42:43], v195 offset:26624
    v_mfma_f32_16x16x32_bf16 v[184:187], a[8:11], a[240:243], v[184:187]
    ds_read_b64_tr_b16 a[44:45], v195 offset:28672
    v_mfma_f32_16x16x32_bf16 v[184:187], a[12:15], a[248:251], v[184:187]
    ds_read_b64_tr_b16 a[46:47], v195 offset:30720
    s_barrier
    v_mfma_f32_16x16x32_bf16 v[188:191], a[8:11], a[244:247], v[188:191]
    ds_read_b64_tr_b16 a[48:49], v192 offset:32768
    buffer_load_dwordx4 a[212:215], v13, s[20:23], s75 offen offset:1024 sc1
    v_mfma_f32_16x16x32_bf16 v[188:191], a[12:15], a[252:255], v[188:191]
    ds_read_b64_tr_b16 a[50:51], v192 offset:34816
    s_waitcnt vmcnt(20) lgkmcnt(10)
    v_mfma_f32_16x16x32_bf16 v[160:163], a[16:19], a[96:99], v[160:163]
    ds_read_b64_tr_b16 a[52:53], v192 offset:36864
    buffer_load_dwordx4 a[216:219], v13, s[20:23], s75 offen offset:2048 sc1
    v_mfma_f32_16x16x32_bf16 v[160:163], a[20:23], a[104:107], v[160:163]
    ds_read_b64_tr_b16 a[54:55], v192 offset:38912
    v_mfma_f32_16x16x32_bf16 v[164:167], a[16:19], a[100:103], v[164:167]
    ds_read_b64_tr_b16 a[0:1], v193 offset:32768
    buffer_load_dwordx4 a[220:223], v13, s[20:23], s75 offen offset:3072 sc1
    v_mfma_f32_16x16x32_bf16 v[164:167], a[20:23], a[108:111], v[164:167]
    ds_read_b64_tr_b16 a[2:3], v193 offset:34816
    v_mfma_f32_16x16x32_bf16 v[168:171], a[24:27], a[96:99], v[168:171]
    ds_read_b64_tr_b16 a[4:5], v193 offset:36864
    s_add_u32 s75, s57, 2097152
    v_mfma_f32_16x16x32_bf16 v[168:171], a[28:31], a[104:107], v[168:171]
    ds_read_b64_tr_b16 a[6:7], v193 offset:38912
    buffer_load_dwordx4 a[224:227], v13, s[20:23], s75 offen sc1
    v_mfma_f32_16x16x32_bf16 v[172:175], a[24:27], a[100:103], v[172:175]
    ds_read_b64_tr_b16 a[8:9], v194 offset:32768
    v_mfma_f32_16x16x32_bf16 v[172:175], a[28:31], a[108:111], v[172:175]
    ds_read_b64_tr_b16 a[10:11], v194 offset:34816
    s_waitcnt lgkmcnt(10)
    v_mfma_f32_16x16x32_bf16 v[176:179], a[32:35], a[96:99], v[176:179]
    ds_read_b64_tr_b16 a[12:13], v194 offset:36864
    buffer_load_dwordx4 a[228:231], v13, s[20:23], s75 offen offset:1024 sc1
    v_mfma_f32_16x16x32_bf16 v[176:179], a[36:39], a[104:107], v[176:179]
    ds_read_b64_tr_b16 a[14:15], v194 offset:38912
    v_mfma_f32_16x16x32_bf16 v[180:183], a[32:35], a[100:103], v[180:183]
    ds_read_b64_tr_b16 a[16:17], v195 offset:32768
    v_mfma_f32_16x16x32_bf16 v[180:183], a[36:39], a[108:111], v[180:183]
    ds_read_b64_tr_b16 a[18:19], v195 offset:34816
    buffer_load_dwordx4 a[232:235], v13, s[20:23], s75 offen offset:2048 sc1
    v_mfma_f32_16x16x32_bf16 v[184:187], a[40:43], a[96:99], v[184:187]
    ds_read_b64_tr_b16 a[20:21], v195 offset:36864
    v_mfma_f32_16x16x32_bf16 v[184:187], a[44:47], a[104:107], v[184:187]
    ds_read_b64_tr_b16 a[22:23], v195 offset:38912
    v_mfma_f32_16x16x32_bf16 v[188:191], a[40:43], a[100:103], v[188:191]
    ds_read_b64_tr_b16 a[24:25], v192 offset:40960
    buffer_load_dwordx4 a[236:239], v13, s[20:23], s75 offen offset:3072 sc1
    v_mfma_f32_16x16x32_bf16 v[188:191], a[44:47], a[108:111], v[188:191]
    ds_read_b64_tr_b16 a[26:27], v192 offset:43008
    s_waitcnt vmcnt(22) lgkmcnt(10)
    v_mfma_f32_16x16x32_bf16 v[160:163], a[48:51], a[160:163], v[160:163]
    ds_read_b64_tr_b16 a[28:29], v192 offset:45056
    s_add_u32 s75, s57, 2359296
    v_mfma_f32_16x16x32_bf16 v[160:163], a[52:55], a[168:171], v[160:163]
    ds_read_b64_tr_b16 a[30:31], v192 offset:47104
    buffer_load_dwordx4 a[128:131], v13, s[20:23], s75 offen sc1
    v_mfma_f32_16x16x32_bf16 v[164:167], a[48:51], a[164:167], v[164:167]
    ds_read_b64_tr_b16 a[32:33], v193 offset:40960
    v_mfma_f32_16x16x32_bf16 v[164:167], a[52:55], a[172:175], v[164:167]
    ds_read_b64_tr_b16 a[34:35], v193 offset:43008
    v_mfma_f32_16x16x32_bf16 v[168:171], a[0:3], a[160:163], v[168:171]
    ds_read_b64_tr_b16 a[36:37], v193 offset:45056
    buffer_load_dwordx4 a[132:135], v13, s[20:23], s75 offen offset:1024 sc1
    s_waitcnt vmcnt(20)
    v_mfma_f32_16x16x32_bf16 v[96:99], v[4:7], v[32:35], v[96:99]
    v_mfma_f32_16x16x32_bf16 v[168:171], a[4:7], a[168:171], v[168:171]
    ds_read_b64_tr_b16 a[38:39], v193 offset:47104
    v_mfma_f32_16x16x32_bf16 v[104:107], v[2:5], v[32:35], v[104:107]
    v_mfma_f32_16x16x32_bf16 v[172:175], a[0:3], a[164:167], v[172:175]
    ds_read_b64_tr_b16 a[40:41], v194 offset:40960
    v_mfma_f32_16x16x32_bf16 v[172:175], a[4:7], a[172:175], v[172:175]
    ds_read_b64_tr_b16 a[42:43], v194 offset:43008
    s_waitcnt vmcnt(19)
    v_mfma_f32_16x16x32_bf16 v[100:103], v[4:7], v[36:39], v[100:103]
    s_waitcnt lgkmcnt(10)
    v_mfma_f32_16x16x32_bf16 v[176:179], a[8:11], a[160:163], v[176:179]
    ds_read_b64_tr_b16 a[44:45], v194 offset:45056
    buffer_load_dwordx4 a[136:139], v13, s[20:23], s75 offen offset:2048 sc1
    v_mfma_f32_16x16x32_bf16 v[108:111], v[2:5], v[36:39], v[108:111]
    v_mfma_f32_16x16x32_bf16 v[176:179], a[12:15], a[168:171], v[176:179]
    ds_read_b64_tr_b16 a[46:47], v194 offset:47104
    v_mfma_f32_16x16x32_bf16 v[180:183], a[8:11], a[164:167], v[180:183]
    ds_read_b64_tr_b16 a[48:49], v195 offset:40960
    s_waitcnt vmcnt(19)
    v_mfma_f32_16x16x32_bf16 v[112:115], v[4:7], v[40:43], v[112:115]
    v_mfma_f32_16x16x32_bf16 v[180:183], a[12:15], a[172:175], v[180:183]
    ds_read_b64_tr_b16 a[50:51], v195 offset:43008
    buffer_load_dwordx4 a[140:143], v13, s[20:23], s75 offen offset:3072 sc1
    v_mfma_f32_16x16x32_bf16 v[120:123], v[2:5], v[40:43], v[120:123]
    v_mfma_f32_16x16x32_bf16 v[184:187], a[16:19], a[160:163], v[184:187]
    ds_read_b64_tr_b16 a[52:53], v195 offset:45056
    s_waitcnt vmcnt(15)
    v_cmp_le_u32 vcc, 2, v207
    s_nop 0
    s_cmp_eq_u64 vcc, -1
    s_cbranch_scc0 L_px2a_spin
L_px2a_ok:
    v_mfma_f32_16x16x32_bf16 v[184:187], a[20:23], a[168:171], v[184:187]
    ds_read_b64_tr_b16 a[54:55], v195 offset:47104
    s_add_u32 s100, s64, 4096
    v_mfma_f32_16x16x32_bf16 v[116:119], v[4:7], v[44:47], v[116:119]
    v_mfma_f32_16x16x32_bf16 v[188:191], a[16:19], a[164:167], v[188:191]
    ds_read_b64_tr_b16 a[0:1], v192 offset:49152
    buffer_load_dwordx4 v[48:51], v13, s[20:23], s100 offen sc1
    v_mfma_f32_16x16x32_bf16 v[124:127], v[2:5], v[44:47], v[124:127]
    v_mfma_f32_16x16x32_bf16 v[188:191], a[20:23], a[172:175], v[188:191]
    ds_read_b64_tr_b16 a[2:3], v192 offset:51200
    s_waitcnt lgkmcnt(10)
    v_mfma_f32_16x16x32_bf16 v[160:163], a[24:27], a[176:179], v[160:163]
    ds_read_b64_tr_b16 a[4:5], v192 offset:53248
    v_mfma_f32_16x16x32_bf16 v[160:163], a[28:31], a[184:187], v[160:163]
    ds_read_b64_tr_b16 a[6:7], v192 offset:55296
    buffer_load_dwordx4 v[52:55], v13, s[20:23], s100 offen offset:1024 sc1
    v_mfma_f32_16x16x32_bf16 v[164:167], a[24:27], a[180:183], v[164:167]
    ds_read_b64_tr_b16 a[8:9], v193 offset:49152
    v_mfma_f32_16x16x32_bf16 v[164:167], a[28:31], a[188:191], v[164:167]
    ds_read_b64_tr_b16 a[10:11], v193 offset:51200
    v_mfma_f32_16x16x32_bf16 v[168:171], a[32:35], a[176:179], v[168:171]
    ds_read_b64_tr_b16 a[12:13], v193 offset:53248
    buffer_load_dwordx4 v[56:59], v13, s[20:23], s100 offen offset:2048 sc1
    v_mfma_f32_16x16x32_bf16 v[168:171], a[36:39], a[184:187], v[168:171]
    ds_read_b64_tr_b16 a[14:15], v193 offset:55296
    s_xor_b32 s77, s84, 256
    v_mfma_f32_16x16x32_bf16 v[172:175], a[32:35], a[180:183], v[172:175]
    ds_read_b64_tr_b16 a[16:17], v194 offset:49152
    buffer_load_dword v207, off, s[20:23], s77 sc1
    v_mfma_f32_16x16x32_bf16 v[172:175], a[36:39], a[188:191], v[172:175]
    ds_read_b64_tr_b16 a[18:19], v194 offset:51200
    s_waitcnt lgkmcnt(10)
    v_mfma_f32_16x16x32_bf16 v[176:179], a[40:43], a[176:179], v[176:179]
    ds_read_b64_tr_b16 a[20:21], v194 offset:53248
    buffer_load_dwordx4 v[60:63], v13, s[20:23], s100 offen offset:3072 sc1
    v_mfma_f32_16x16x32_bf16 v[176:179], a[44:47], a[184:187], v[176:179]
    ds_read_b64_tr_b16 a[22:23], v194 offset:55296
    s_add_u32 s75, s57, 2621440
    v_mfma_f32_16x16x32_bf16 v[180:183], a[40:43], a[180:183], v[180:183]
    ds_read_b64_tr_b16 a[24:25], v195 offset:49152
    buffer_load_dwordx4 a[240:243], v13, s[20:23], s75 offen sc1
    v_mfma_f32_16x16x32_bf16 v[180:183], a[44:47], a[188:191], v[180:183]
    ds_read_b64_tr_b16 a[26:27], v195 offset:51200
    v_mfma_f32_16x16x32_bf16 v[184:187], a[48:51], a[176:179], v[184:187]
    ds_read_b64_tr_b16 a[28:29], v195 offset:53248
    v_mfma_f32_16x16x32_bf16 v[184:187], a[52:55], a[184:187], v[184:187]
    ds_read_b64_tr_b16 a[30:31], v195 offset:55296
    buffer_load_dwordx4 a[244:247], v13, s[20:23], s75 offen offset:1024 sc1
    v_mfma_f32_16x16x32_bf16 v[188:191], a[48:51], a[180:183], v[188:191]
    ds_read_b64_tr_b16 a[32:33], v192 offset:57344
    v_mfma_f32_16x16x32_bf16 v[188:191], a[52:55], a[188:191], v[188:191]
    ds_read_b64_tr_b16 a[34:35], v192 offset:59392
    s_waitcnt vmcnt(19) lgkmcnt(10)
    v_mfma_f32_16x16x32_bf16 v[160:163], a[0:3], a[192:195], v[160:163]
    ds_read_b64_tr_b16 a[36:37], v192 offset:61440
    buffer_load_dwordx4 a[248:251], v13, s[20:23], s75 offen offset:2048 sc1
    v_mfma_f32_16x16x32_bf16 v[160:163], a[4:7], a[200:203], v[160:163]
    ds_read_b64_tr_b16 a[38:39], v192 offset:63488
    v_mfma_f32_16x16x32_bf16 v[164:167], a[0:3], a[196:199], v[164:167]
    ds_read_b64_tr_b16 a[40:41], v193 offset:57344
    v_mfma_f32_16x16x32_bf16 v[164:167], a[4:7], a[204:207], v[164:167]
    ds_read_b64_tr_b16 a[42:43], v193 offset:59392
    buffer_load_dwordx4 a[252:255], v13, s[20:23], s75 offen offset:3072 sc1
    v_mfma_f32_16x16x32_bf16 v[168:171], a[8:11], a[192:195], v[168:171]
    ds_read_b64_tr_b16 a[44:45], v193 offset:61440
    s_add_u32 m0, s59, 81920
    v_mfma_f32_16x16x32_bf16 v[168:171], a[12:15], a[200:203], v[168:171]
    ds_read_b64_tr_b16 a[46:47], v193 offset:63488
    s_add_u32 s74, s55, 1572864
    v_mfma_f32_16x16x32_bf16 v[172:175], a[8:11], a[196:199], v[172:175]
    ds_read_b64_tr_b16 a[48:49], v194 offset:57344
    buffer_load_dwordx4 v9, s[28:31], s74 offen lds
    v_mfma_f32_16x16x32_bf16 v[172:175], a[12:15], a[204:207], v[172:175]
    ds_read_b64_tr_b16 a[50:51], v194 offset:59392
    s_waitcnt lgkmcnt(10)
    v_mfma_f32_16x16x32_bf16 v[176:179], a[16:19], a[192:195], v[176:179]
    ds_read_b64_tr_b16 a[52:53], v194 offset:61440
    v_mfma_f32_16x16x32_bf16 v[176:179], a[20:23], a[200:203], v[176:179]
    ds_read_b64_tr_b16 a[54:55], v194 offset:63488
    v_mfma_f32_16x16x32_bf16 v[180:183], a[16:19], a[196:199], v[180:183]
    ds_read_b64_tr_b16 a[0:1], v195 offset:57344
    buffer_load_dwordx4 v10, s[28:31], s74 offen offset:1024 lds
    v_mfma_f32_16x16x32_bf16 v[180:183], a[20:23], a[204:207], v[180:183]
    ds_read_b64_tr_b16 a[2:3], v195 offset:59392
    v_mfma_f32_16x16x32_bf16 v[184:187], a[24:27], a[192:195], v[184:187]
    ds_read_b64_tr_b16 a[4:5], v195 offset:61440
    v_mfma_f32_16x16x32_bf16 v[184:187], a[28:31], a[200:203], v[184:187]
    ds_read_b64_tr_b16 a[6:7], v195 offset:63488
    s_barrier
    v_mfma_f32_16x16x32_bf16 v[188:191], a[24:27], a[196:199], v[188:191]
    ds_read_b64_tr_b16 a[8:9], v196
    buffer_load_dwordx4 v11, s[28:31], s74 offen offset:2048 lds
    v_mfma_f32_16x16x32_bf16 v[188:191], a[28:31], a[204:207], v[188:191]
    ds_read_b64_tr_b16 a[10:11], v196 offset:2048
    s_waitcnt vmcnt(20) lgkmcnt(10)
    v_mfma_f32_16x16x32_bf16 v[160:163], a[32:35], a[208:211], v[160:163]
    ds_read_b64_tr_b16 a[12:13], v196 offset:4096
    buffer_load_dwordx4 v12, s[28:31], s74 offen offset:3072 lds
    v_mfma_f32_16x16x32_bf16 v[160:163], a[36:39], a[216:219], v[160:163]
    ds_read_b64_tr_b16 a[14:15], v196 offset:6144
    s_add_u32 m0, s59, 98304
    v_mfma_f32_16x16x32_bf16 v[164:167], a[32:35], a[212:215], v[164:167]
    ds_read_b64_tr_b16 a[16:17], v197
    s_add_u32 s74, s55, 1835008
    v_mfma_f32_16x16x32_bf16 v[164:167], a[36:39], a[220:223], v[164:167]
    ds_read_b64_tr_b16 a[18:19], v197 offset:2048
    buffer_load_dwordx4 v9, s[28:31], s74 offen lds
    v_mfma_f32_16x16x32_bf16 v[168:171], a[40:43], a[208:211], v[168:171]
    ds_read_b64_tr_b16 a[20:21], v197 offset:4096
    v_mfma_f32_16x16x32_bf16 v[168:171], a[44:47], a[216:219], v[168:171]
    ds_read_b64_tr_b16 a[22:23], v197 offset:6144
    v_mfma_f32_16x16x32_bf16 v[172:175], a[40:43], a[212:215], v[172:175]
    ds_read_b64_tr_b16 a[24:25], v198
    buffer_load_dwordx4 v10, s[28:31], s74 offen offset:1024 lds
    v_mfma_f32_16x16x32_bf16 v[172:175], a[44:47], a[220:223], v[172:175]
    ds_read_b64_tr_b16 a[26:27], v198 offset:2048
    s_waitcnt lgkmcnt(10)
    v_mfma_f32_16x16x32_bf16 v[176:179], a[48:51], a[208:211], v[176:179]
    ds_read_b64_tr_b16 a[28:29], v198 offset:4096
    v_mfma_f32_16x16x32_bf16 v[176:179], a[52:55], a[216:219], v[176:179]
    ds_read_b64_tr_b16 a[30:31], v198 offset:6144
    buffer_load_dwordx4 v11, s[28:31], s74 offen offset:2048 lds
    v_mfma_f32_16x16x32_bf16 v[180:183], a[48:51], a[212:215], v[180:183]
    ds_read_b64_tr_b16 a[32:33], v199
    v_mfma_f32_16x16x32_bf16 v[180:183], a[52:55], a[220:223], v[180:183]
    ds_read_b64_tr_b16 a[34:35], v199 offset:2048
    v_mfma_f32_16x16x32_bf16 v[184:187], a[0:3], a[208:211], v[184:187]
    ds_read_b64_tr_b16 a[36:37], v199 offset:4096
    buffer_load_dwordx4 v12, s[28:31], s74 offen offset:3072 lds
    v_mfma_f32_16x16x32_bf16 v[184:187], a[4:7], a[216:219], v[184:187]
    ds_read_b64_tr_b16 a[38:39], v199 offset:6144
    v_mfma_f32_16x16x32_bf16 v[188:191], a[0:3], a[212:215], v[188:191]
    ds_read_b64_tr_b16 a[40:41], v196 offset:8192
    s_add_u32 s75, s57, 2883584
    v_mfma_f32_16x16x32_bf16 v[188:191], a[4:7], a[220:223], v[188:191]
    ds_read_b64_tr_b16 a[42:43], v196 offset:10240
    s_waitcnt vmcnt(21) lgkmcnt(10)
    v_mfma_f32_16x16x32_bf16 v[160:163], a[8:11], a[224:227], v[160:163]
    ds_read_b64_tr_b16 a[44:45], v196 offset:12288
    buffer_load_dwordx4 a[96:99], v13, s[20:23], s75 offen sc1
    v_mfma_f32_16x16x32_bf16 v[160:163], a[12:15], a[232:235], v[160:163]
    ds_read_b64_tr_b16 a[46:47], v196 offset:14336
    v_mfma_f32_16x16x32_bf16 v[164:167], a[8:11], a[228:231], v[164:167]
    ds_read_b64_tr_b16 a[48:49], v197 offset:8192
    s_waitcnt vmcnt(14)
    v_cmp_le_u32 vcc, 3, v207
    s_nop 0
    s_cmp_eq_u64 vcc, -1
    s_cbranch_scc0 L_px3a_spin
L_px3a_ok:
    v_mfma_f32_16x16x32_bf16 v[164:167], a[12:15], a[236:239], v[164:167]
    ds_read_b64_tr_b16 a[50:51], v197 offset:10240
    buffer_load_dwordx4 a[100:103], v13, s[20:23], s75 offen offset:1024 sc1
    v_mfma_f32_16x16x32_bf16 v[168:171], a[16:19], a[224:227], v[168:171]
    ds_read_b64_tr_b16 a[52:53], v197 offset:12288
    s_mov_b32 s100, s54
    v_mfma_f32_16x16x32_bf16 v[96:99], v[4:7], v[48:51], v[96:99]
    v_mfma_f32_16x16x32_bf16 v[168:171], a[20:23], a[232:235], v[168:171]
    ds_read_b64_tr_b16 a[54:55], v197 offset:14336
    buffer_load_dwordx4 v[64:67], v9, s[32:35], s100 offen sc1
    v_mfma_f32_16x16x32_bf16 v[104:107], v[2:5], v[48:51], v[104:107]
    v_mfma_f32_16x16x32_bf16 v[172:175], a[16:19], a[228:231], v[172:175]
    ds_read_b64_tr_b16 a[0:1], v198 offset:8192
    v_mfma_f32_16x16x32_bf16 v[172:175], a[20:23], a[236:239], v[172:175]
    ds_read_b64_tr_b16 a[2:3], v198 offset:10240
    v_mfma_f32_16x16x32_bf16 v[100:103], v[4:7], v[52:55], v[100:103]
    s_waitcnt lgkmcnt(10)
    v_mfma_f32_16x16x32_bf16 v[176:179], a[24:27], a[224:227], v[176:179]
    ds_read_b64_tr_b16 a[4:5], v198 offset:12288
    v_mfma_f32_16x16x32_bf16 v[108:111], v[2:5], v[52:55], v[108:111]
    v_mfma_f32_16x16x32_bf16 v[176:179], a[28:31], a[232:235], v[176:179]
    ds_read_b64_tr_b16 a[6:7], v198 offset:14336
    buffer_load_dwordx4 v[68:71], v10, s[32:35], s100 offen offset:1024 sc1
    v_mfma_f32_16x16x32_bf16 v[180:183], a[24:27], a[228:231], v[180:183]
    ds_read_b64_tr_b16 a[8:9], v199 offset:8192
    v_mfma_f32_16x16x32_bf16 v[112:115], v[4:7], v[56:59], v[112:115]
    v_mfma_f32_16x16x32_bf16 v[180:183], a[28:31], a[236:239], v[180:183]
    ds_read_b64_tr_b16 a[10:11], v199 offset:10240
    v_mfma_f32_16x16x32_bf16 v[120:123], v[2:5], v[56:59], v[120:123]
    v_mfma_f32_16x16x32_bf16 v[184:187], a[32:35], a[224:227], v[184:187]
    ds_read_b64_tr_b16 a[12:13], v199 offset:12288
    buffer_load_dwordx4 v[72:75], v11, s[32:35], s100 offen offset:2048 sc1
    v_mfma_f32_16x16x32_bf16 v[184:187], a[36:39], a[232:235], v[184:187]
    ds_read_b64_tr_b16 a[14:15], v199 offset:14336
    s_waitcnt vmcnt(17)
    v_mfma_f32_16x16x32_bf16 v[116:119], v[4:7], v[60:63], v[116:119]
    v_mfma_f32_16x16x32_bf16 v[188:191], a[32:35], a[228:231], v[188:191]
    ds_read_b64_tr_b16 a[16:17], v200 offset:16384
    v_mfma_f32_16x16x32_bf16 v[124:127], v[2:5], v[60:63], v[124:127]
    v_mfma_f32_16x16x32_bf16 v[188:191], a[36:39], a[236:239], v[188:191]
    ds_read_b64_tr_b16 a[18:19], v200 offset:18432
    s_waitcnt lgkmcnt(10)
    v_mfma_f32_16x16x32_bf16 v[160:163], a[40:43], a[128:131], v[160:163]
    ds_read_b64_tr_b16 a[20:21], v200 offset:20480
    buffer_load_dwordx4 v[76:79], v12, s[32:35], s100 offen offset:3072 sc1
    v_mfma_f32_16x16x32_bf16 v[160:163], a[44:47], a[136:139], v[160:163]
    ds_read_b64_tr_b16 a[22:23], v200 offset:22528
    v_mfma_f32_16x16x32_bf16 v[164:167], a[40:43], a[132:135], v[164:167]
    ds_read_b64_tr_b16 a[24:25], v201 offset:16384
    buffer_load_dwordx4 a[104:107], v13, s[20:23], s75 offen offset:2048 sc1
    v_mfma_f32_16x16x32_bf16 v[164:167], a[44:47], a[140:143], v[164:167]
    ds_read_b64_tr_b16 a[26:27], v201 offset:18432
    v_mfma_f32_16x16x32_bf16 v[168:171], a[48:51], a[128:131], v[168:171]
    ds_read_b64_tr_b16 a[28:29], v201 offset:20480
    v_mfma_f32_16x16x32_bf16 v[168:171], a[52:55], a[136:139], v[168:171]
    ds_read_b64_tr_b16 a[30:31], v201 offset:22528
    buffer_load_dwordx4 a[108:111], v13, s[20:23], s75 offen offset:3072 sc1
    v_mfma_f32_16x16x32_bf16 v[172:175], a[48:51], a[132:135], v[172:175]
    ds_read_b64_tr_b16 a[32:33], v202 offset:16384
    v_mfma_f32_16x16x32_bf16 v[172:175], a[52:55], a[140:143], v[172:175]
    ds_read_b64_tr_b16 a[34:35], v202 offset:18432
    s_waitcnt lgkmcnt(10)
    v_mfma_f32_16x16x32_bf16 v[176:179], a[0:3], a[128:131], v[176:179]
    ds_read_b64_tr_b16 a[36:37], v202 offset:20480
    s_add_u32 s75, s57, 3145728
    v_mfma_f32_16x16x32_bf16 v[176:179], a[4:7], a[136:139], v[176:179]
    ds_read_b64_tr_b16 a[38:39], v202 offset:22528
    buffer_load_dwordx4 a[160:163], v13, s[20:23], s75 offen sc1
    v_mfma_f32_16x16x32_bf16 v[180:183], a[0:3], a[132:135], v[180:183]
    ds_read_b64_tr_b16 a[40:41], v203 offset:16384
    v_mfma_f32_16x16x32_bf16 v[180:183], a[4:7], a[140:143], v[180:183]
    ds_read_b64_tr_b16 a[42:43], v203 offset:18432
    buffer_load_dwordx4 a[164:167], v13, s[20:23], s75 offen offset:1024 sc1
    v_mfma_f32_16x16x32_bf16 v[184:187], a[8:11], a[128:131], v[184:187]
    ds_read_b64_tr_b16 a[44:45], v203 offset:20480
    v_mfma_f32_16x16x32_bf16 v[184:187], a[12:15], a[136:139], v[184:187]
    ds_read_b64_tr_b16 a[46:47], v203 offset:22528
    v_mfma_f32_16x16x32_bf16 v[188:191], a[8:11], a[132:135], v[188:191]
    ds_read_b64_tr_b16 a[48:49], v200 offset:24576
    buffer_load_dwordx4 a[168:171], v13, s[20:23], s75 offen offset:2048 sc1
    v_mfma_f32_16x16x32_bf16 v[188:191], a[12:15], a[140:143], v[188:191]
    ds_read_b64_tr_b16 a[50:51], v200 offset:26624
    s_waitcnt vmcnt(19) lgkmcnt(10)
    v_mfma_f32_16x16x32_bf16 v[160:163], a[16:19], a[240:243], v[160:163]
    ds_read_b64_tr_b16 a[52:53], v200 offset:28672
    v_mfma_f32_16x16x32_bf16 v[160:163], a[20:23], a[248:251], v[160:163]
    ds_read_b64_tr_b16 a[54:55], v200 offset:30720
    buffer_load_dwordx4 a[172:175], v13, s[20:23], s75 offen offset:3072 sc1
    v_mfma_f32_16x16x32_bf16 v[164:167], a[16:19], a[244:247], v[164:167]
    ds_read_b64_tr_b16 a[0:1], v201 offset:24576
    v_mfma_f32_16x16x32_bf16 v[164:167], a[20:23], a[252:255], v[164:167]
    ds_read_b64_tr_b16 a[2:3], v201 offset:26624
    s_add_u32 s75, s57, 3407872
    v_mfma_f32_16x16x32_bf16 v[168:171], a[24:27], a[240:243], v[168:171]
    ds_read_b64_tr_b16 a[4:5], v201 offset:28672
    buffer_load_dwordx4 a[176:179], v13, s[20:23], s75 offen sc1
    v_mfma_f32_16x16x32_bf16 v[168:171], a[28:31], a[248:251], v[168:171]
    ds_read_b64_tr_b16 a[6:7], v201 offset:30720
    v_mfma_f32_16x16x32_bf16 v[172:175], a[24:27], a[244:247], v[172:175]
    ds_read_b64_tr_b16 a[8:9], v202 offset:24576
    v_mfma_f32_16x16x32_bf16 v[172:175], a[28:31], a[252:255], v[172:175]
    ds_read_b64_tr_b16 a[10:11], v202 offset:26624
    s_waitcnt lgkmcnt(10)
    v_mfma_f32_16x16x32_bf16 v[176:179], a[32:35], a[240:243], v[176:179]
    ds_read_b64_tr_b16 a[12:13], v202 offset:28672
    buffer_load_dwordx4 a[180:183], v13, s[20:23], s75 offen offset:1024 sc1
    v_mfma_f32_16x16x32_bf16 v[176:179], a[36:39], a[248:251], v[176:179]
    ds_read_b64_tr_b16 a[14:15], v202 offset:30720
    v_mfma_f32_16x16x32_bf16 v[180:183], a[32:35], a[244:247], v[180:183]
    ds_read_b64_tr_b16 a[16:17], v203 offset:24576
    v_mfma_f32_16x16x32_bf16 v[180:183], a[36:39], a[252:255], v[180:183]
    ds_read_b64_tr_b16 a[18:19], v203 offset:26624
    buffer_load_dwordx4 a[184:187], v13, s[20:23], s75 offen offset:2048 sc1
    v_mfma_f32_16x16x32_bf16 v[184:187], a[40:43], a[240:243], v[184:187]
    ds_read_b64_tr_b16 a[20:21], v203 offset:28672
    s_waitcnt vmcnt(15)
    v_mfma_f32_16x16x32_bf16 v[184:187], a[44:47], a[248:251], v[184:187]
    ds_read_b64_tr_b16 a[22:23], v203 offset:30720
    s_barrier
    v_mfma_f32_16x16x32_bf16 v[188:191], a[40:43], a[244:247], v[188:191]
    ds_read_b64_tr_b16 a[24:25], v196 offset:16384
    buffer_load_dwordx4 a[188:191], v13, s[20:23], s75 offen offset:3072 sc1
    v_mfma_f32_16x16x32_bf16 v[188:191], a[44:47], a[252:255], v[188:191]
    ds_read_b64_tr_b16 a[26:27], v196 offset:18432
    s_waitcnt vmcnt(8) lgkmcnt(10)
    v_mfma_f32_16x16x32_bf16 v[160:163], a[48:51], a[96:99], v[160:163]
    ds_read_b64_tr_b16 a[28:29], v196 offset:20480
    s_add_u32 s75, s57, 3670016
    v_mfma_f32_16x16x32_bf16 v[160:163], a[52:55], a[104:107], v[160:163]
    ds_read_b64_tr_b16 a[30:31], v196 offset:22528
    buffer_load_dwordx4 a[192:195], v13, s[20:23], s75 offen sc1
    v_mfma_f32_16x16x32_bf16 v[164:167], a[48:51], a[100:103], v[164:167]
    ds_read_b64_tr_b16 a[32:33], v197 offset:16384
    v_mfma_f32_16x16x32_bf16 v[164:167], a[52:55], a[108:111], v[164:167]
    ds_read_b64_tr_b16 a[34:35], v197 offset:18432
    v_mfma_f32_16x16x32_bf16 v[168:171], a[0:3], a[96:99], v[168:171]
    ds_read_b64_tr_b16 a[36:37], v197 offset:20480
    buffer_load_dwordx4 a[196:199], v13, s[20:23], s75 offen offset:1024 sc1
    v_mfma_f32_16x16x32_bf16 v[168:171], a[4:7], a[104:107], v[168:171]
    ds_read_b64_tr_b16 a[38:39], v197 offset:22528
    v_mfma_f32_16x16x32_bf16 v[172:175], a[0:3], a[100:103], v[172:175]
    ds_read_b64_tr_b16 a[40:41], v198 offset:16384
    v_mfma_f32_16x16x32_bf16 v[172:175], a[4:7], a[108:111], v[172:175]
    ds_read_b64_tr_b16 a[42:43], v198 offset:18432
    s_waitcnt lgkmcnt(10)
    v_mfma_f32_16x16x32_bf16 v[176:179], a[8:11], a[96:99], v[176:179]
    ds_read_b64_tr_b16 a[44:45], v198 offset:20480
    buffer_load_dwordx4 a[200:203], v13, s[20:23], s75 offen offset:2048 sc1
    v_mfma_f32_16x16x32_bf16 v[176:179], a[12:15], a[104:107], v[176:179]
    ds_read_b64_tr_b16 a[46:47], v198 offset:22528
    v_mfma_f32_16x16x32_bf16 v[180:183], a[8:11], a[100:103], v[180:183]
    ds_read_b64_tr_b16 a[48:49], v199 offset:16384
    buffer_load_dwordx4 a[204:207], v13, s[20:23], s75 offen offset:3072 sc1
    v_mfma_f32_16x16x32_bf16 v[96:99], v[4:7], v[64:67], v[96:99]
    v_mfma_f32_16x16x32_bf16 v[180:183], a[12:15], a[108:111], v[180:183]
    ds_read_b64_tr_b16 a[50:51], v199 offset:18432
    v_mfma_f32_16x16x32_bf16 v[104:107], v[2:5], v[64:67], v[104:107]
    v_mfma_f32_16x16x32_bf16 v[184:187], a[16:19], a[96:99], v[184:187]
    ds_read_b64_tr_b16 a[52:53], v199 offset:20480
    s_add_u32 s75, s57, 3932160
    v_mfma_f32_16x16x32_bf16 v[184:187], a[20:23], a[104:107], v[184:187]
    ds_read_b64_tr_b16 a[54:55], v199 offset:22528
    buffer_load_dwordx4 a[208:211], v13, s[20:23], s75 offen sc1
    v_mfma_f32_16x16x32_bf16 v[100:103], v[4:7], v[68:71], v[100:103]
    v_mfma_f32_16x16x32_bf16 v[188:191], a[16:19], a[100:103], v[188:191]
    ds_read_b64_tr_b16 a[0:1], v196 offset:24576
    v_mfma_f32_16x16x32_bf16 v[108:111], v[2:5], v[68:71], v[108:111]
    v_mfma_f32_16x16x32_bf16 v[188:191], a[20:23], a[108:111], v[188:191]
    ds_read_b64_tr_b16 a[2:3], v196 offset:26624
    s_waitcnt vmcnt(9) lgkmcnt(10)
    v_mfma_f32_16x16x32_bf16 v[160:163], a[24:27], a[160:163], v[160:163]
    ds_read_b64_tr_b16 a[4:5], v196 offset:28672
    buffer_load_dwordx4 a[212:215], v13, s[20:23], s75 offen offset:1024 sc1
    v_mfma_f32_16x16x32_bf16 v[112:115], v[4:7], v[72:75], v[112:115]
    v_mfma_f32_16x16x32_bf16 v[160:163], a[28:31], a[168:171], v[160:163]
    ds_read_b64_tr_b16 a[6:7], v196 offset:30720
    v_mfma_f32_16x16x32_bf16 v[120:123], v[2:5], v[72:75], v[120:123]
    v_mfma_f32_16x16x32_bf16 v[164:167], a[24:27], a[164:167], v[164:167]
    ds_read_b64_tr_b16 a[8:9], v197 offset:24576
    v_mfma_f32_16x16x32_bf16 v[164:167], a[28:31], a[172:175], v[164:167]
    ds_read_b64_tr_b16 a[10:11], v197 offset:26624
    buffer_load_dwordx4 a[216:219], v13, s[20:23], s75 offen offset:2048 sc1
    v_mfma_f32_16x16x32_bf16 v[116:119], v[4:7], v[76:79], v[116:119]
    v_mfma_f32_16x16x32_bf16 v[168:171], a[32:35], a[160:163], v[168:171]
    ds_read_b64_tr_b16 a[12:13], v197 offset:28672
    v_mfma_f32_16x16x32_bf16 v[124:127], v[2:5], v[76:79], v[124:127]
    v_mfma_f32_16x16x32_bf16 v[168:171], a[36:39], a[168:171], v[168:171]
    ds_read_b64_tr_b16 a[14:15], v197 offset:30720
    v_mfma_f32_16x16x32_bf16 v[172:175], a[32:35], a[164:167], v[172:175]
    ds_read_b64_tr_b16 a[16:17], v198 offset:24576
    v_mfma_f32_16x16x32_bf16 v[172:175], a[36:39], a[172:175], v[172:175]
    ds_read_b64_tr_b16 a[18:19], v198 offset:26624
    s_waitcnt lgkmcnt(10)
    v_mfma_f32_16x16x32_bf16 v[176:179], a[40:43], a[160:163], v[176:179]
    ds_read_b64_tr_b16 a[20:21], v198 offset:28672
    buffer_load_dwordx4 a[220:223], v13, s[20:23], s75 offen offset:3072 sc1
    v_mfma_f32_16x16x32_bf16 v[176:179], a[44:47], a[168:171], v[176:179]
    ds_read_b64_tr_b16 a[22:23], v198 offset:30720
    s_mov_b32 s70, 0xbfb8aa3b
    v_mfma_f32_16x16x32_bf16 v[180:183], a[40:43], a[164:167], v[180:183]
    ds_read_b64_tr_b16 a[24:25], v199 offset:24576
    v_mfma_f32_16x16x32_bf16 v[180:183], a[44:47], a[172:175], v[180:183]
    ds_read_b64_tr_b16 a[26:27], v199 offset:26624
    v_mfma_f32_16x16x32_bf16 v[184:187], a[48:51], a[160:163], v[184:187]
    ds_read_b64_tr_b16 a[28:29], v199 offset:28672
    v_mfma_f32_16x16x32_bf16 v[184:187], a[52:55], a[168:171], v[184:187]
    ds_read_b64_tr_b16 a[30:31], v199 offset:30720
    v_mfma_f32_16x16x32_bf16 v[188:191], a[48:51], a[164:167], v[188:191]
    ds_read_b64_tr_b16 a[32:33], v196 offset:32768
    v_mfma_f32_16x16x32_bf16 v[188:191], a[52:55], a[172:175], v[188:191]
    ds_read_b64_tr_b16 a[34:35], v196 offset:34816
    s_waitcnt vmcnt(8) lgkmcnt(10)
    v_mfma_f32_16x16x32_bf16 v[160:163], a[0:3], a[176:179], v[160:163]
    ds_read_b64_tr_b16 a[36:37], v196 offset:36864
    v_mfma_f32_16x16x32_bf16 v[160:163], a[4:7], a[184:187], v[160:163]
    ds_read_b64_tr_b16 a[38:39], v196 offset:38912
    v_mfma_f32_16x16x32_bf16 v[164:167], a[0:3], a[180:183], v[164:167]
    ds_read_b64_tr_b16 a[40:41], v197 offset:32768
    v_mfma_f32_16x16x32_bf16 v[164:167], a[4:7], a[188:191], v[164:167]
    ds_read_b64_tr_b16 a[42:43], v197 offset:34816
    v_mfma_f32_16x16x32_bf16 v[168:171], a[8:11], a[176:179], v[168:171]
    ds_read_b64_tr_b16 a[44:45], v197 offset:36864
    v_mfma_f32_16x16x32_bf16 v[168:171], a[12:15], a[184:187], v[168:171]
    ds_read_b64_tr_b16 a[46:47], v197 offset:38912
L_pad0_15:
    s_cbranch_execz L_pad0_19
    v_mfma_f32_16x16x32_bf16 v[172:175], a[8:11], a[180:183], v[172:175]
    ds_read_b64_tr_b16 a[48:49], v198 offset:32768
    v_mfma_f32_16x16x32_bf16 v[172:175], a[12:15], a[188:191], v[172:175]
    ds_read_b64_tr_b16 a[50:51], v198 offset:34816
    s_waitcnt lgkmcnt(10)
    v_mfma_f32_16x16x32_bf16 v[176:179], a[16:19], a[176:179], v[176:179]
    ds_read_b64_tr_b16 a[52:53], v198 offset:36864
    v_mfma_f32_16x16x32_bf16 v[176:179], a[20:23], a[184:187], v[176:179]
    ds_read_b64_tr_b16 a[54:55], v198 offset:38912
    v_mfma_f32_16x16x32_bf16 v[180:183], a[16:19], a[180:183], v[180:183]
    ds_read_b64_tr_b16 a[0:1], v199 offset:32768
    v_mfma_f32_16x16x32_bf16 v[180:183], a[20:23], a[188:191], v[180:183]
    ds_read_b64_tr_b16 a[2:3], v199 offset:34816
    v_mfma_f32_16x16x32_bf16 v[184:187], a[24:27], a[176:179], v[184:187]
    ds_read_b64_tr_b16 a[4:5], v199 offset:36864
    v_mfma_f32_16x16x32_bf16 v[184:187], a[28:31], a[184:187], v[184:187]
    ds_read_b64_tr_b16 a[6:7], v199 offset:38912
    v_mfma_f32_16x16x32_bf16 v[188:191], a[24:27], a[180:183], v[188:191]
    ds_read_b64_tr_b16 a[8:9], v196 offset:40960
    v_mfma_f32_16x16x32_bf16 v[188:191], a[28:31], a[188:191], v[188:191]
    ds_read_b64_tr_b16 a[10:11], v196 offset:43008
    s_waitcnt vmcnt(4) lgkmcnt(10)
    v_mfma_f32_16x16x32_bf16 v[160:163], a[32:35], a[192:195], v[160:163]
    ds_read_b64_tr_b16 a[12:13], v196 offset:45056
    v_mfma_f32_16x16x32_bf16 v[160:163], a[36:39], a[200:203], v[160:163]
    ds_read_b64_tr_b16 a[14:15], v196 offset:47104
    v_mfma_f32_16x16x32_bf16 v[164:167], a[32:35], a[196:199], v[164:167]
    ds_read_b64_tr_b16 a[16:17], v197 offset:40960
    v_mfma_f32_16x16x32_bf16 v[164:167], a[36:39], a[204:207], v[164:167]
    ds_read_b64_tr_b16 a[18:19], v197 offset:43008
    v_mfma_f32_16x16x32_bf16 v[168:171], a[40:43], a[192:195], v[168:171]
    ds_read_b64_tr_b16 a[20:21], v197 offset:45056
    v_mfma_f32_16x16x32_bf16 v[168:171], a[44:47], a[200:203], v[168:171]
    ds_read_b64_tr_b16 a[22:23], v197 offset:47104
    v_mfma_f32_16x16x32_bf16 v[172:175], a[40:43], a[196:199], v[172:175]
    ds_read_b64_tr_b16 a[24:25], v198 offset:40960
    v_mfma_f32_16x16x32_bf16 v[172:175], a[44:47], a[204:207], v[172:175]
    ds_read_b64_tr_b16 a[26:27], v198 offset:43008
    s_waitcnt lgkmcnt(10)
    v_mfma_f32_16x16x32_bf16 v[176:179], a[48:51], a[192:195], v[176:179]
    ds_read_b64_tr_b16 a[28:29], v198 offset:45056
    v_mfma_f32_16x16x32_bf16 v[176:179], a[52:55], a[200:203], v[176:179]
    ds_read_b64_tr_b16 a[30:31], v198 offset:47104
    v_mfma_f32_16x16x32_bf16 v[180:183], a[48:51], a[196:199], v[180:183]
    ds_read_b64_tr_b16 a[32:33], v199 offset:40960
    v_mfma_f32_16x16x32_bf16 v[180:183], a[52:55], a[204:207], v[180:183]
    ds_read_b64_tr_b16 a[34:35], v199 offset:43008
    v_mfma_f32_16x16x32_bf16 v[184:187], a[0:3], a[192:195], v[184:187]
    ds_read_b64_tr_b16 a[36:37], v199 offset:45056
    v_mfma_f32_16x16x32_bf16 v[184:187], a[4:7], a[200:203], v[184:187]
    ds_read_b64_tr_b16 a[38:39], v199 offset:47104
    v_mfma_f32_16x16x32_bf16 v[188:191], a[0:3], a[196:199], v[188:191]
    v_mfma_f32_16x16x32_bf16 v[188:191], a[4:7], a[204:207], v[188:191]
    s_waitcnt vmcnt(0) lgkmcnt(8)
    v_mfma_f32_16x16x32_bf16 v[160:163], a[8:11], a[208:211], v[160:163]
    v_mfma_f32_16x16x32_bf16 v[160:163], a[12:15], a[216:219], v[160:163]
    v_mfma_f32_16x16x32_bf16 v[164:167], a[8:11], a[212:215], v[164:167]
    v_mfma_f32_16x16x32_bf16 v[164:167], a[12:15], a[220:223], v[164:167]
    v_mfma_f32_16x16x32_bf16 v[168:171], a[16:19], a[208:211], v[168:171]
    v_mfma_f32_16x16x32_bf16 v[168:171], a[20:23], a[216:219], v[168:171]
    v_mfma_f32_16x16x32_bf16 v[172:175], a[16:19], a[212:215], v[172:175]
    v_mfma_f32_16x16x32_bf16 v[172:175], a[20:23], a[220:223], v[172:175]
    s_waitcnt lgkmcnt(0)
    v_mfma_f32_16x16x32_bf16 v[176:179], a[24:27], a[208:211], v[176:179]
    v_mfma_f32_16x16x32_bf16 v[176:179], a[28:31], a[216:219], v[176:179]
    v_mfma_f32_16x16x32_bf16 v[180:183], a[24:27], a[212:215], v[180:183]
    v_mfma_f32_16x16x32_bf16 v[180:183], a[28:31], a[220:223], v[180:183]
    v_mfma_f32_16x16x32_bf16 v[184:187], a[32:35], a[208:211], v[184:187]
    v_mfma_f32_16x16x32_bf16 v[184:187], a[36:39], a[216:219], v[184:187]
    v_mfma_f32_16x16x32_bf16 v[188:191], a[32:35], a[212:215], v[188:191]
    v_mfma_f32_16x16x32_bf16 v[188:191], a[36:39], a[220:223], v[188:191]
    v_pk_mul_f32 v[128:129], v[96:97], s[70:71] op_sel_hi:[1,0]
    v_pk_mul_f32 v[130:131], v[98:99], s[70:71] op_sel_hi:[1,0]
    v_pk_mul_f32 v[136:137], v[104:105], s[70:71] op_sel_hi:[1,0]
    v_pk_mul_f32 v[138:139], v[106:107], s[70:71] op_sel_hi:[1,0]
    v_exp_f32 v128, v128
    v_exp_f32 v129, v129
    v_exp_f32 v130, v130
    v_exp_f32 v131, v131
    v_exp_f32 v136, v136
    v_exp_f32 v137, v137
    v_exp_f32 v138, v138
    v_exp_f32 v139, v139
    v_pk_mul_f32 v[160:161], v[160:161], v[96:97]
    v_pk_mul_f32 v[162:163], v[162:163], v[98:99]
    v_pk_mul_f32 v[168:169], v[168:169], v[104:105]
    v_pk_mul_f32 v[170:171], v[170:171], v[106:107]
    v_pk_add_f32 v[128:129], v[128:129], 1.0 op_sel_hi:[1,0]
    v_pk_add_f32 v[130:131], v[130:131], 1.0 op_sel_hi:[1,0]
    v_pk_add_f32 v[136:137], v[136:137], 1.0 op_sel_hi:[1,0]
    v_pk_add_f32 v[138:139], v[138:139], 1.0 op_sel_hi:[1,0]
    v_rcp_f32 v128, v128
    v_rcp_f32 v129, v129
    v_rcp_f32 v130, v130
    v_rcp_f32 v131, v131
    v_rcp_f32 v136, v136
    v_rcp_f32 v137, v137
    v_rcp_f32 v138, v138
    v_rcp_f32 v139, v139
    v_pk_fma_f32 v[224:225], v[160:161], v[128:129], v[224:225]
    v_pk_fma_f32 v[226:227], v[162:163], v[130:131], v[226:227]
    v_pk_fma_f32 v[228:229], v[168:169], v[136:137], v[228:229]
    v_pk_fma_f32 v[230:231], v[170:171], v[138:139], v[230:231]
    v_cvt_pk_bf16_f32 v80, v224, v225
    v_cvt_pk_bf16_f32 v82, v228, v229
    v_cvt_pk_bf16_f32 v81, v226, v227
    v_cvt_pk_bf16_f32 v83, v230, v231
    v_permlane16_swap_b32 v80, v82
    s_nop 0
    v_permlane16_swap_b32_e64 v81, v83
    buffer_store_dwordx4 v[80:83], v208, s[32:35], 0 offen
    v_pk_mul_f32 v[132:133], v[100:101], s[70:71] op_sel_hi:[1,0]
    v_pk_mul_f32 v[134:135], v[102:103], s[70:71] op_sel_hi:[1,0]
    v_pk_mul_f32 v[140:141], v[108:109], s[70:71] op_sel_hi:[1,0]
    v_pk_mul_f32 v[142:143], v[110:111], s[70:71] op_sel_hi:[1,0]
    v_exp_f32 v132, v132
    v_exp_f32 v133, v133
    v_exp_f32 v134, v134
    v_exp_f32 v135, v135
    v_exp_f32 v140, v140
    v_exp_f32 v141, v141
    v_exp_f32 v142, v142
    v_exp_f32 v143, v143
    v_pk_mul_f32 v[164:165], v[164:165], v[100:101]
    v_pk_mul_f32 v[166:167], v[166:167], v[102:103]
    v_pk_mul_f32 v[172:173], v[172:173], v[108:109]
    v_pk_mul_f32 v[174:175], v[174:175], v[110:111]
    v_pk_add_f32 v[132:133], v[132:133], 1.0 op_sel_hi:[1,0]
    v_pk_add_f32 v[134:135], v[134:135], 1.0 op_sel_hi:[1,0]
    v_pk_add_f32 v[140:141], v[140:141], 1.0 op_sel_hi:[1,0]
    v_pk_add_f32 v[142:143], v[142:143], 1.0 op_sel_hi:[1,0]
    v_rcp_f32 v132, v132
    v_rcp_f32 v133, v133
    v_rcp_f32 v134, v134
    v_rcp_f32 v135, v135
    v_rcp_f32 v140, v140
    v_rcp_f32 v141, v141
    v_rcp_f32 v142, v142
    v_rcp_f32 v143, v143
    v_pk_fma_f32 v[240:241], v[164:165], v[132:133], v[240:241]
    v_pk_fma_f32 v[242:243], v[166:167], v[134:135], v[242:243]
    v_pk_fma_f32 v[244:245], v[172:173], v[140:141], v[244:245]
    v_pk_fma_f32 v[246:247], v[174:175], v[142:143], v[246:247]
    v_cvt_pk_bf16_f32 v88, v240, v241
    v_cvt_pk_bf16_f32 v90, v244, v245
    v_cvt_pk_bf16_f32 v89, v242, v243
    v_cvt_pk_bf16_f32 v91, v246, v247
    v_permlane16_swap_b32 v88, v90
    s_nop 0
    v_permlane16_swap_b32_e64 v89, v91
    buffer_store_dwordx4 v[88:91], v208, s[32:35], s73 offen
    v_pk_mul_f32 v[144:145], v[112:113], s[70:71] op_sel_hi:[1,0]
    v_pk_mul_f32 v[146:147], v[114:115], s[70:71] op_sel_hi:[1,0]
    v_pk_mul_f32 v[152:153], v[120:121], s[70:71] op_sel_hi:[1,0]
    v_pk_mul_f32 v[154:155], v[122:123], s[70:71] op_sel_hi:[1,0]
    v_exp_f32 v144, v144
    v_exp_f32 v145, v145
    v_exp_f32 v146, v146
    v_exp_f32 v147, v147
    v_exp_f32 v152, v152
    v_exp_f32 v153, v153
    v_exp_f32 v154, v154
    v_exp_f32 v155, v155
    v_pk_mul_f32 v[176:177], v[176:177], v[112:113]
    v_pk_mul_f32 v[178:179], v[178:179], v[114:115]
    v_pk_mul_f32 v[184:185], v[184:185], v[120:121]
    v_pk_mul_f32 v[186:187], v[186:187], v[122:123]
    v_pk_add_f32 v[144:145], v[144:145], 1.0 op_sel_hi:[1,0]
    v_pk_add_f32 v[146:147], v[146:147], 1.0 op_sel_hi:[1,0]
    v_pk_add_f32 v[152:153], v[152:153], 1.0 op_sel_hi:[1,0]
    v_pk_add_f32 v[154:155], v[154:155], 1.0 op_sel_hi:[1,0]
    v_rcp_f32 v144, v144
    v_rcp_f32 v145, v145
    v_rcp_f32 v146, v146
    v_rcp_f32 v147, v147
    v_rcp_f32 v152, v152
    v_rcp_f32 v153, v153
    v_rcp_f32 v154, v154
    v_rcp_f32 v155, v155
    v_pk_fma_f32 v[232:233], v[176:177], v[144:145], v[232:233]
    v_pk_fma_f32 v[234:235], v[178:179], v[146:147], v[234:235]
    v_pk_fma_f32 v[236:237], v[184:185], v[152:153], v[236:237]
    v_pk_fma_f32 v[238:239], v[186:187], v[154:155], v[238:239]
    v_cvt_pk_bf16_f32 v84, v232, v233
    v_cvt_pk_bf16_f32 v86, v236, v237
    v_cvt_pk_bf16_f32 v85, v234, v235
    v_cvt_pk_bf16_f32 v87, v238, v239
    v_permlane16_swap_b32 v84, v86
    s_nop 0
    v_permlane16_swap_b32_e64 v85, v87
    buffer_store_dwordx4 v[84:87], v208, s[32:35], 0 offen offset:64
    v_pk_mul_f32 v[148:149], v[116:117], s[70:71] op_sel_hi:[1,0]
    v_pk_mul_f32 v[150:151], v[118:119], s[70:71] op_sel_hi:[1,0]
    v_pk_mul_f32 v[156:157], v[124:125], s[70:71] op_sel_hi:[1,0]
    v_pk_mul_f32 v[158:159], v[126:127], s[70:71] op_sel_hi:[1,0]
    v_exp_f32 v148, v148
    v_exp_f32 v149, v149
    v_exp_f32 v150, v150
    v_exp_f32 v151, v151
    v_exp_f32 v156, v156
    v_exp_f32 v157, v157
    v_exp_f32 v158, v158
    v_exp_f32 v159, v159
    v_pk_mul_f32 v[180:181], v[180:181], v[116:117]
    v_pk_mul_f32 v[182:183], v[182:183], v[118:119]
    v_pk_mul_f32 v[188:189], v[188:189], v[124:125]
    v_pk_mul_f32 v[190:191], v[190:191], v[126:127]
    v_pk_add_f32 v[148:149], v[148:149], 1.0 op_sel_hi:[1,0]
    v_pk_add_f32 v[150:151], v[150:151], 1.0 op_sel_hi:[1,0]
    v_pk_add_f32 v[156:157], v[156:157], 1.0 op_sel_hi:[1,0]
    v_pk_add_f32 v[158:159], v[158:159], 1.0 op_sel_hi:[1,0]
    v_rcp_f32 v148, v148
    v_rcp_f32 v149, v149
    v_rcp_f32 v150, v150
    v_rcp_f32 v151, v151
    v_rcp_f32 v156, v156
    v_rcp_f32 v157, v157
    v_rcp_f32 v158, v158
    v_rcp_f32 v159, v159
    v_pk_fma_f32 v[248:249], v[180:181], v[148:149], v[248:249]
    v_pk_fma_f32 v[250:251], v[182:183], v[150:151], v[250:251]
    v_pk_fma_f32 v[252:253], v[188:189], v[156:157], v[252:253]
    v_pk_fma_f32 v[254:255], v[190:191], v[158:159], v[254:255]
    v_cvt_pk_bf16_f32 v92, v248, v249
    v_cvt_pk_bf16_f32 v94, v252, v253
    v_cvt_pk_bf16_f32 v93, v250, v251
    v_cvt_pk_bf16_f32 v95, v254, v255
    v_permlane16_swap_b32 v92, v94
    s_nop 0
    v_permlane16_swap_b32 v93, v95
    buffer_store_dwordx4 v[92:95], v208, s[32:35], s73 offen offset:64
    s_endpgm
L_ev0:
L_pad0_16:
    s_cbranch_execz L_back0
    v_mov_b32 v14, 1
    s_mov_b64 exec, 1
    buffer_atomic_add v14, off, s[36:39], 0 sc1
    s_mov_b64 exec, -1
    s_branch L_evdone0
L_sw0:
    s_mov_b64 s[92:93], s[24:25]
    s_mov_b32 s94, s26
    s_cmp_ge_u32 s44, 3
    s_cselect_b64 s[92:93], s[28:29], s[92:93]
    s_cselect_b32 s94, s30, s94
    s_mov_b32 s95, 0x00020000
    s_mul_i32 s70, s2, 3
    s_add_u32 s70, s70, s44
    s_mul_i32 s70, s70, 1664
    s_mul_i32 s71, s2, 1408
    s_cmp_eq_u32 s44, 3
    s_cselect_b32 s69, s71, s70
    s_cselect_b32 s79, 11, 39
    s_cselect_b32 s71, 10, 12
    s_mov_b32 s3, -1
    s_lshl_b32 s79, s79, 15
    s_lshl_b32 s71, s71, 4
    v_min_u32 v0, s71, v13
    v_lshlrev_b32 v0, 3, v0
    s_branch L_swdone0
L_pc0_spin:
    s_mov_b32 s78, 0
L_pc0_loop:
    s_add_u32 s78, s78, 1
    buffer_load_dword v27, off, s[36:39], 0 sc1
    s_waitcnt vmcnt(0)
    v_cmp_le_u32 vcc, 0x100, v27
    s_nop 0
    s_cmp_eq_u64 vcc, -1
    s_cbranch_scc1 L_pc0_ok
    s_sleep 8
    s_cmp_lt_u32 s78, 65536
    s_cbranch_scc1 L_pc0_loop
    s_branch L_pc0_ok
L_phba_spin:
    s_mov_b32 s78, 0
L_phba_loop:
    s_add_u32 s78, s78, 1
    buffer_load_dword v74, v73, s[20:23], s76 offen sc1
    s_waitcnt vmcnt(0)
    v_cmp_le_u32 vcc, 1, v74
    s_nop 0
    s_cmp_eq_u64 vcc, -1
    s_cbranch_scc1 L_phba_ok
    s_sleep 8
    s_cmp_lt_u32 s78, 65536
    s_cbranch_scc1 L_phba_loop
    s_branch L_phba_ok
L_pda_spin:
    s_mov_b32 s78, 0
L_pda_loop:
    s_add_u32 s78, s78, 1
    buffer_load_dword v206, v205, s[20:23], s65 offen sc1
    s_waitcnt vmcnt(0)
    v_cmp_le_u32 vcc, 1, v206
    s_nop 0
    s_cmp_eq_u64 vcc, -1
    s_cbranch_scc1 L_pda_ok
    s_sleep 8
    s_cmp_lt_u32 s78, 65536
    s_cbranch_scc1 L_pda_loop
    s_branch L_pda_ok
L_px1a_spin:
    s_mov_b32 s78, 0
L_px1a_loop:
    s_add_u32 s78, s78, 1
    buffer_load_dword v207, off, s[20:23], s77 sc1
    s_waitcnt vmcnt(0)
    v_cmp_le_u32 vcc, 1, v207
    s_nop 0
    s_cmp_eq_u64 vcc, -1
    s_cbranch_scc1 L_px1a_ok
    s_sleep 8
    s_cmp_lt_u32 s78, 65536
    s_cbranch_scc1 L_px1a_loop
    s_branch L_px1a_ok
L_px2a_spin:
    s_mov_b32 s78, 0
L_px2a_loop:
    s_add_u32 s78, s78, 1
    buffer_load_dword v207, off, s[20:23], s77 sc1
    s_waitcnt vmcnt(0)
    v_cmp_le_u32 vcc, 2, v207
    s_nop 0
    s_cmp_eq_u64 vcc, -1
    s_cbranch_scc1 L_px2a_ok
    s_sleep 8
    s_cmp_lt_u32 s78, 65536
    s_cbranch_scc1 L_px2a_loop
    s_branch L_px2a_ok
L_px3a_spin:
    s_mov_b32 s78, 0
L_px3a_loop:
    s_add_u32 s78, s78, 1
    buffer_load_dword v207, off, s[20:23], s77 sc1
    s_waitcnt vmcnt(0)
    v_cmp_le_u32 vcc, 3, v207
    s_nop 0
    s_cmp_eq_u64 vcc, -1
    s_cbranch_scc1 L_px3a_ok
    s_sleep 8
    s_cmp_lt_u32 s78, 65536
    s_cbranch_scc1 L_px3a_loop
    s_branch L_px3a_ok
L_phb2a_spin:
    s_mov_b32 s78, 0
L_phb2a_loop:
    s_add_u32 s78, s78, 1
    buffer_load_dword v206, v204, s[20:23], s76 offen sc1
    s_waitcnt vmcnt(0)
    v_cmp_le_u32 vcc, 2, v206
    s_nop 0
    s_cmp_eq_u64 vcc, -1
    s_cbranch_scc1 L_phb2a_ok
    s_sleep 8
    s_cmp_lt_u32 s78, 65536
    s_cbranch_scc1 L_phb2a_loop
    s_branch L_phb2a_ok
L_phaa_spin:
    s_mov_b32 s78, 0
L_phaa_loop:
    s_add_u32 s78, s78, 1
    buffer_load_dword v206, v204, s[20:23], s76 offen sc1
    s_waitcnt vmcnt(0)
    v_cmp_le_u32 vcc, 1, v206
    s_nop 0
    s_cmp_eq_u64 vcc, -1
    s_cbranch_scc1 L_phaa_ok
    s_sleep 8
    s_cmp_lt_u32 s78, 65536
    s_cbranch_scc1 L_phaa_loop
    s_branch L_phaa_ok
L_pha2a_spin:
    s_mov_b32 s78, 0
L_pha2a_loop:
    s_add_u32 s78, s78, 1
    buffer_load_dword v206, v204, s[20:23], s76 offen sc1
    s_waitcnt vmcnt(0)
    v_cmp_le_u32 vcc, 2, v206
    s_nop 0
    s_cmp_eq_u64 vcc, -1
    s_cbranch_scc1 L_pha2a_ok
    s_sleep 8
    s_cmp_lt_u32 s78, 65536
    s_cbranch_scc1 L_pha2a_loop
    s_branch L_pha2a_ok
L_poa_spin:
    s_mov_b32 s78, 0
L_poa_loop:
    s_add_u32 s78, s78, 1
    buffer_load_dword v206, v204, s[20:23], s76 offen sc1
    s_waitcnt vmcnt(0)
    v_cmp_le_u32 vcc, 1, v206
    s_nop 0
    s_cmp_eq_u64 vcc, -1
    s_cbranch_scc1 L_poa_ok
    s_sleep 8
    s_cmp_lt_u32 s78, 65536
    s_cbranch_scc1 L_poa_loop
    s_branch L_poa_ok
L_first0:
L_pad0_17:
    s_cbranch_execz L_back0
    s_waitcnt lgkmcnt(15)
    v_mfma_f32_16x16x32_bf16 v[32:35], a[224:227], a[96:99], 0
    ds_read_b64_tr_b16 a[232:233], v4
    v_mov_b32_dpp v28, v28 row_ror:7 row_mask:0xf bank_mask:0xf
    s_waitcnt lgkmcnt(15)
    v_mfma_f32_16x16x32_bf16 v[32:35], a[228:231], a[100:103], v[32:35]
    ds_read_b64_tr_b16 a[234:235], v4 offset:512
    v_mov_b32_dpp v29, v29 row_ror:7 row_mask:0xf bank_mask:0xf
    s_waitcnt lgkmcnt(15)
    v_mfma_f32_16x16x32_bf16 v[36:39], a[224:227], a[104:107], 0
    ds_read_b64_tr_b16 a[236:237], v6
    v_mov_b32_dpp v30, v30 row_ror:7 row_mask:0xf bank_mask:0xf
    s_waitcnt lgkmcnt(15)
    v_mfma_f32_16x16x32_bf16 v[36:39], a[228:231], a[108:111], v[36:39]
    ds_read_b64_tr_b16 a[238:239], v6 offset:512
    v_mov_b32_dpp v31, v31 row_ror:7 row_mask:0xf bank_mask:0xf
    s_waitcnt lgkmcnt(15)
    v_mfma_f32_16x16x32_bf16 v[40:43], a[224:227], a[112:115], 0
    s_add_u32 m0, s66, 12288
    s_add_u32 s74, s64, 0
    buffer_load_dwordx4 v11, s[16:19], s74 offen lds
    s_waitcnt lgkmcnt(14)
    v_mfma_f32_16x16x32_bf16 v[40:43], a[228:231], a[116:119], v[40:43]
    s_add_u32 m0, s66, 53248
    s_add_u32 s74, s74, 229376
    s_lshl2_add_u32 s70, s47, s50
    s_waitcnt lgkmcnt(13)
    v_mfma_f32_16x16x32_bf16 v[44:47], a[224:227], a[120:123], 0
    s_lshl_b32 s70, s70, 7
    s_waitcnt lgkmcnt(12)
    v_mfma_f32_16x16x32_bf16 v[44:47], a[228:231], a[124:127], v[44:47]
    buffer_load_dwordx4 v11, s[16:19], s74 offen lds
    s_lshl2_add_u32 s70, s51, s70
    s_waitcnt lgkmcnt(11)
    v_mfma_f32_16x16x32_bf16 v[48:51], a[224:227], a[128:131], 0
    s_add_u32 s81, s70, 34148384
    s_waitcnt lgkmcnt(10)
    v_mfma_f32_16x16x32_bf16 v[48:51], a[228:231], a[132:135], v[48:51]
    s_waitcnt lgkmcnt(9)
    v_mfma_f32_16x16x32_bf16 v[52:55], a[224:227], a[136:139], 0
    s_add_u32 m0, s68, 0
    s_add_u32 s74, s65, 0
    buffer_load_dwordx4 v12, s[12:15], s74 offen lds
    s_waitcnt lgkmcnt(8)
    v_mfma_f32_16x16x32_bf16 v[52:55], a[228:231], a[140:143], v[52:55]
    s_lshl_b32 s70, s48, 7
    s_waitcnt lgkmcnt(7)
    v_mfma_f32_16x16x32_bf16 v[56:59], a[224:227], a[144:147], 0
    s_lshl2_add_u32 s70, s47, s70
    s_waitcnt lgkmcnt(6)
    v_mfma_f32_16x16x32_bf16 v[56:59], a[228:231], a[148:151], v[56:59]
    s_add_u32 s82, s70, 34152448
    s_waitcnt lgkmcnt(5)
    v_mfma_f32_16x16x32_bf16 v[60:63], a[224:227], a[152:155], 0
    v_mfma_f32_16x16x32_bf16 a[240:243], v[28:31], a[224:227], 0
    s_waitcnt lgkmcnt(4)
    v_mfma_f32_16x16x32_bf16 v[60:63], a[228:231], a[156:159], v[60:63]
    s_waitcnt vmcnt(6) lgkmcnt(0)
    s_barrier
    v_mfma_f32_16x16x32_bf16 v[64:67], a[232:235], a[96:99], 0
    ds_read_b64_tr_b16 a[224:225], v3 offset:4096
    v_mfma_f32_16x16x32_bf16 v[64:67], a[236:239], a[100:103], v[64:67]
    ds_read_b64_tr_b16 a[226:227], v3 offset:4608
    v_mfma_f32_16x16x32_bf16 v[68:71], a[232:235], a[104:107], 0
    ds_read_b64_tr_b16 a[228:229], v5 offset:4096
    v_mfma_f32_16x16x32_bf16 v[68:71], a[236:239], a[108:111], v[68:71]
    ds_read_b64_tr_b16 a[230:231], v5 offset:4608
    v_mfma_f32_16x16x32_bf16 v[72:75], a[232:235], a[112:115], 0
    v_mov_b32_dpp v28, v28 row_ror:1 row_mask:0xf bank_mask:0xf
    s_add_u32 m0, s68, 2048
    v_mfma_f32_16x16x32_bf16 v[72:75], a[236:239], a[116:119], v[72:75]
    buffer_load_dwordx4 v12, s[16:19], s74 offen lds
    s_add_u32 s83, s70, 34152448
    s_lshl_b32 s70, s2, 7
    v_mfma_f32_16x16x32_bf16 v[76:79], a[232:235], a[120:123], 0
    v_mov_b32_dpp v29, v29 row_ror:1 row_mask:0xf bank_mask:0xf
    s_add_u32 m0, s67, 32768
    v_mfma_f32_16x16x32_bf16 v[76:79], a[236:239], a[124:127], v[76:79]
    s_mov_b32 s74, 128
    s_lshl2_add_u32 s70, s44, s70
    s_add_u32 s84, s70, 34177024
    v_mfma_f32_16x16x32_bf16 v[80:83], a[232:235], a[128:131], 0
    v_mov_b32_dpp v30, v30 row_ror:1 row_mask:0xf bank_mask:0xf
    s_and_b32 s70, s2, 31
    v_mfma_f32_16x16x32_bf16 v[80:83], a[236:239], a[132:135], v[80:83]
    buffer_load_dwordx4 v9, s[4:7], s74 offen lds
    s_lshl_b32 s70, s70, 7
    s_lshl2_add_u32 s70, s47, s70
    v_mfma_f32_16x16x32_bf16 v[84:87], a[232:235], a[136:139], 0
    v_mov_b32_dpp v31, v31 row_ror:1 row_mask:0xf bank_mask:0xf
    v_mfma_f32_16x16x32_bf16 v[84:87], a[236:239], a[140:143], v[84:87]
    s_add_u32 s50, s70, 34164736
    v_mfma_f32_16x16x32_bf16 v[88:91], a[232:235], a[144:147], 0
    s_add_u32 m0, s67, 34816
    s_mov_b32 s74, 32896
    buffer_load_dwordx4 v9, s[4:7], s74 offen lds
    v_mfma_f32_16x16x32_bf16 v[88:91], a[236:239], a[148:151], v[88:91]
    s_lshl_b32 s70, s2, 3
    v_mfma_f32_16x16x32_bf16 v[92:95], a[232:235], a[152:155], 0
    v_mfma_f32_16x16x32_bf16 a[240:243], v[28:31], a[232:235], a[240:243]
    s_lshl1_add_u32 s70, s44, s70
    v_mfma_f32_16x16x32_bf16 v[92:95], a[236:239], a[156:159], v[92:95]
    s_lshl_b32 s101, s70, 11
    s_waitcnt lgkmcnt(0)
    v_mfma_f32_16x16x32_bf16 v[96:99], a[96:99], a[224:227], 0
    ds_read_b64_tr_b16 a[232:233], v4 offset:4096
    v_mov_b32_dpp v28, v28 row_ror:1 row_mask:0xf bank_mask:0xf
    v_mfma_f32_16x16x32_bf16 v[96:99], a[100:103], a[228:231], v[96:99]
    ds_read_b64_tr_b16 a[234:235], v4 offset:4608
    v_mov_b32_dpp v29, v29 row_ror:1 row_mask:0xf bank_mask:0xf
    v_mfma_f32_16x16x32_bf16 v[100:103], a[104:107], a[224:227], 0
    ds_read_b64_tr_b16 a[236:237], v6 offset:4096
    v_mov_b32_dpp v30, v30 row_ror:1 row_mask:0xf bank_mask:0xf
    v_mfma_f32_16x16x32_bf16 v[100:103], a[108:111], a[228:231], v[100:103]
    ds_read_b64_tr_b16 a[238:239], v6 offset:4608
    v_mov_b32_dpp v31, v31 row_ror:1 row_mask:0xf bank_mask:0xf
    v_mfma_f32_16x16x32_bf16 v[104:107], a[112:115], a[224:227], 0
    s_add_u32 m0, s67, 36864
    s_mov_b32 s74, 65664
    buffer_load_dwordx4 v9, s[4:7], s74 offen lds
    v_mfma_f32_16x16x32_bf16 v[104:107], a[116:119], a[228:231], v[104:107]
    s_lshl_b32 s71, s70, 3
    s_add_u32 s85, s71, 34111488
    s_lshr_b32 s71, s70, 7
    v_mfma_f32_16x16x32_bf16 v[108:111], a[120:123], a[224:227], 0
    s_lshl_b32 s71, s71, 4
    v_mfma_f32_16x16x32_bf16 v[108:111], a[124:127], a[228:231], v[108:111]
    s_add_u32 m0, s67, 38912
    s_mov_b32 s74, 98432
    buffer_load_dwordx4 v9, s[4:7], s74 offen lds
    v_mfma_f32_16x16x32_bf16 v[112:115], a[128:131], a[224:227], 0
    s_and_b32 s72, s70, 15
    v_mfma_f32_16x16x32_bf16 v[112:115], a[132:135], a[228:231], v[112:115]
    s_add_u32 s71, s71, s72
    v_mfma_f32_16x16x32_bf16 v[116:119], a[136:139], a[224:227], 0
    v_mfma_f32_16x16x32_bf16 v[116:119], a[140:143], a[228:231], v[116:119]
    s_bfe_u32 s72, s70, 0x30004
    v_mfma_f32_16x16x32_bf16 v[120:123], a[144:147], a[224:227], 0
    v_mfma_f32_16x16x32_bf16 v[120:123], a[148:151], a[228:231], v[120:123]
    s_add_u32 m0, s67, 40960
    s_mov_b32 s74, 131200
    buffer_load_dwordx4 v9, s[4:7], s74 offen lds
    v_mfma_f32_16x16x32_bf16 v[124:127], a[152:155], a[224:227], 0
    v_mfma_f32_16x16x32_bf16 a[240:243], v[28:31], a[224:227], a[240:243]
    s_lshl3_add_u32 s71, s71, s72
    s_lshl_b32 s71, s71, 2
    v_mfma_f32_16x16x32_bf16 v[124:127], a[156:159], a[228:231], v[124:127]
    s_waitcnt vmcnt(10) lgkmcnt(0)
    s_barrier
    v_mfma_f32_16x16x32_bf16 v[128:131], a[96:99], a[232:235], 0
    ds_read_b64_tr_b16 a[224:225], v3 offset:8192
    v_mfma_f32_16x16x32_bf16 v[128:131], a[100:103], a[236:239], v[128:131]
    ds_read_b64_tr_b16 a[226:227], v3 offset:8704
    v_mfma_f32_16x16x32_bf16 v[132:135], a[104:107], a[232:235], 0
    ds_read_b64_tr_b16 a[228:229], v5 offset:8192
    v_mfma_f32_16x16x32_bf16 v[132:135], a[108:111], a[236:239], v[132:135]
    ds_read_b64_tr_b16 a[230:231], v5 offset:8704
    v_mfma_f32_16x16x32_bf16 v[136:139], a[112:115], a[232:235], 0
    v_mov_b32_dpp v28, v28 row_ror:1 row_mask:0xf bank_mask:0xf
    s_add_u32 m0, s67, 43008
    v_mfma_f32_16x16x32_bf16 v[136:139], a[116:119], a[236:239], v[136:139]
    s_mov_b32 s74, 163968
    buffer_load_dwordx4 v9, s[4:7], s74 offen lds
    s_add_u32 s99, s71, 34086912
    v_mfma_f32_16x16x32_bf16 v[140:143], a[120:123], a[232:235], 0
    v_mov_b32_dpp v29, v29 row_ror:1 row_mask:0xf bank_mask:0xf
    s_lshr_b32 s71, s70, 5
    v_mfma_f32_16x16x32_bf16 v[140:143], a[124:127], a[236:239], v[140:143]
    s_bfe_u32 s72, s70, 0x20002
    s_lshl2_add_u32 s71, s71, s72
    s_bfe_u32 s72, s70, 0x10004
    v_mfma_f32_16x16x32_bf16 v[144:147], a[128:131], a[232:235], 0
    v_mov_b32_dpp v30, v30 row_ror:1 row_mask:0xf bank_mask:0xf
    s_lshl1_add_u32 s71, s71, s72
    v_mfma_f32_16x16x32_bf16 v[144:147], a[132:135], a[236:239], v[144:147]
    s_add_u32 m0, s67, 45056
    s_mov_b32 s74, 196736
    buffer_load_dwordx4 v9, s[4:7], s74 offen lds
    v_mfma_f32_16x16x32_bf16 v[148:151], a[136:139], a[232:235], 0
    v_mov_b32_dpp v31, v31 row_ror:1 row_mask:0xf bank_mask:0xf
    s_and_b32 s72, s70, 3
    v_mfma_f32_16x16x32_bf16 v[148:151], a[140:143], a[236:239], v[148:151]
    s_lshl2_add_u32 s71, s71, s72
    v_mfma_f32_16x16x32_bf16 v[152:155], a[144:147], a[232:235], 0
    v_mfma_f32_16x16x32_bf16 v[152:155], a[148:151], a[236:239], v[152:155]
    s_lshl_b32 s71, s71, 1
    v_mfma_f32_16x16x32_bf16 v[156:159], a[152:155], a[232:235], 0
    v_mfma_f32_16x16x32_bf16 a[240:243], v[28:31], a[232:235], a[240:243]
    s_add_u32 m0, s67, 47104
    s_mov_b32 s74, 229504
    buffer_load_dwordx4 v9, s[4:7], s74 offen lds
    v_mfma_f32_16x16x32_bf16 v[156:159], a[156:159], a[236:239], v[156:159]
    s_add_u32 s100, s71, 34095104
    s_waitcnt lgkmcnt(0)
    v_mfma_f32_16x16x32_bf16 v[160:163], a[224:227], a[96:99], 0
    ds_read_b64_tr_b16 a[232:233], v4 offset:8192
    v_mov_b32_dpp v28, v28 row_ror:1 row_mask:0xf bank_mask:0xf
    v_mfma_f32_16x16x32_bf16 v[160:163], a[228:231], a[100:103], v[160:163]
    ds_read_b64_tr_b16 a[234:235], v4 offset:8704
    v_mov_b32_dpp v29, v29 row_ror:1 row_mask:0xf bank_mask:0xf
    v_mfma_f32_16x16x32_bf16 v[164:167], a[224:227], a[104:107], 0
    ds_read_b64_tr_b16 a[236:237], v6 offset:8192
    v_mov_b32_dpp v30, v30 row_ror:1 row_mask:0xf bank_mask:0xf
    v_mfma_f32_16x16x32_bf16 v[164:167], a[228:231], a[108:111], v[164:167]
    ds_read_b64_tr_b16 a[238:239], v6 offset:8704
    v_mov_b32_dpp v31, v31 row_ror:1 row_mask:0xf bank_mask:0xf
    v_mfma_f32_16x16x32_bf16 v[168:171], a[224:227], a[112:115], 0
    s_add_u32 m0, s66, 20480
    s_add_u32 s74, s61, 393216
    buffer_load_dwordx4 v10, s[8:11], s74 offen lds
    v_mfma_f32_16x16x32_bf16 v[168:171], a[228:231], a[116:119], v[168:171]
    v_mfma_f32_16x16x32_bf16 v[172:175], a[224:227], a[120:123], 0
    v_lshrrev_b32 v27, 9, v13
    v_mfma_f32_16x16x32_bf16 v[172:175], a[228:231], a[124:127], v[172:175]
    v_mfma_f32_16x16x32_bf16 v[176:179], a[224:227], a[128:131], 0
    v_mfma_f32_16x16x32_bf16 v[176:179], a[228:231], a[132:135], v[176:179]
    v_mul_u32_u24 v22, 1536, v27
    v_mfma_f32_16x16x32_bf16 v[180:183], a[224:227], a[136:139], 0
    s_add_u32 m0, s66, 61440
    s_add_u32 s74, s74, 196608
    buffer_load_dwordx4 v10, s[8:11], s74 offen lds
    v_mfma_f32_16x16x32_bf16 v[180:183], a[228:231], a[140:143], v[180:183]
    v_mfma_f32_16x16x32_bf16 v[184:187], a[224:227], a[144:147], 0
    v_mfma_f32_16x16x32_bf16 v[184:187], a[228:231], a[148:151], v[184:187]
    v_lshlrev_b32 v27, 11, v27
    v_mfma_f32_16x16x32_bf16 v[188:191], a[224:227], a[152:155], 0
    v_mfma_f32_16x16x32_bf16 a[240:243], v[28:31], a[224:227], a[240:243]
    v_mfma_f32_16x16x32_bf16 v[188:191], a[228:231], a[156:159], v[188:191]
    s_waitcnt vmcnt(12) lgkmcnt(0)
    s_barrier
    v_mfma_f32_16x16x32_bf16 v[192:195], a[232:235], a[96:99], 0
    ds_read_b64_tr_b16 a[224:225], v3 offset:12288
    v_mfma_f32_16x16x32_bf16 v[192:195], a[236:239], a[100:103], v[192:195]
    ds_read_b64_tr_b16 a[226:227], v3 offset:12800
    v_mfma_f32_16x16x32_bf16 v[196:199], a[232:235], a[104:107], 0
    ds_read_b64_tr_b16 a[228:229], v5 offset:12288
    v_mfma_f32_16x16x32_bf16 v[196:199], a[236:239], a[108:111], v[196:199]
    ds_read_b64_tr_b16 a[230:231], v5 offset:12800
    v_mfma_f32_16x16x32_bf16 v[200:203], a[232:235], a[112:115], 0
    v_mov_b32_dpp v28, v28 row_ror:1 row_mask:0xf bank_mask:0xf
    s_add_u32 m0, s66, 24576
    v_mfma_f32_16x16x32_bf16 v[200:203], a[236:239], a[116:119], v[200:203]
    s_add_u32 s74, s62, 393216
    buffer_load_dwordx4 v10, s[8:11], s74 offen lds
    v_add_u32 v22, v22, v13
    v_mfma_f32_16x16x32_bf16 v[204:207], a[232:235], a[120:123], 0
    v_mov_b32_dpp v29, v29 row_ror:1 row_mask:0xf bank_mask:0xf
    s_add_u32 m0, s66, 65536
    v_mfma_f32_16x16x32_bf16 v[204:207], a[236:239], a[124:127], v[204:207]
    s_add_u32 s74, s74, 196608
    buffer_load_ushort v27, v27, s[4:7], s101 offen
    buffer_load_dwordx4 v[14:17], v22, s[4:7], s101 offen
    v_mfma_f32_16x16x32_bf16 v[208:211], a[232:235], a[128:131], 0
    v_mov_b32_dpp v30, v30 row_ror:1 row_mask:0xf bank_mask:0xf
    v_mfma_f32_16x16x32_bf16 v[208:211], a[236:239], a[132:135], v[208:211]
    buffer_load_dwordx4 v10, s[8:11], s74 offen lds
    v_mfma_f32_16x16x32_bf16 v[212:215], a[232:235], a[136:139], 0
    v_mov_b32_dpp v31, v31 row_ror:1 row_mask:0xf bank_mask:0xf
    v_mfma_f32_16x16x32_bf16 v[212:215], a[236:239], a[140:143], v[212:215]
    s_add_u32 m0, s66, 28672
    s_add_u32 s74, s63, 458752
L_pad0_18:
    s_cbranch_execz L_back0
    v_mfma_f32_16x16x32_bf16 v[216:219], a[232:235], a[144:147], 0
    buffer_load_dwordx4 v11, s[12:15], s74 offen lds
    v_mfma_f32_16x16x32_bf16 v[216:219], a[236:239], a[148:151], v[216:219]
    v_mfma_f32_16x16x32_bf16 v[220:223], a[232:235], a[152:155], 0
    v_mfma_f32_16x16x32_bf16 a[240:243], v[28:31], a[232:235], a[240:243]
    buffer_load_dwordx4 v[18:21], v22, s[4:7], s101 offen offset:512
    v_mfma_f32_16x16x32_bf16 v[220:223], a[236:239], a[156:159], v[220:223]
    s_waitcnt lgkmcnt(0)
    v_mfma_f32_16x16x32_bf16 a[0:3], a[224:227], a[96:99], 0
    ds_read_b64_tr_b16 a[232:233], v4 offset:12288
    v_mov_b32_dpp v28, v28 row_ror:1 row_mask:0xf bank_mask:0xf
    v_mfma_f32_16x16x32_bf16 a[0:3], a[228:231], a[100:103], a[0:3]
    ds_read_b64_tr_b16 a[234:235], v4 offset:12800
    v_mov_b32_dpp v29, v29 row_ror:1 row_mask:0xf bank_mask:0xf
    v_mfma_f32_16x16x32_bf16 a[4:7], a[224:227], a[104:107], 0
    ds_read_b64_tr_b16 a[236:237], v6 offset:12288
    v_mov_b32_dpp v30, v30 row_ror:1 row_mask:0xf bank_mask:0xf
    v_mfma_f32_16x16x32_bf16 a[4:7], a[228:231], a[108:111], a[4:7]
    ds_read_b64_tr_b16 a[238:239], v6 offset:12800
    v_mov_b32_dpp v31, v31 row_ror:1 row_mask:0xf bank_mask:0xf
    v_mfma_f32_16x16x32_bf16 a[8:11], a[224:227], a[112:115], 0
    s_add_u32 m0, s66, 69632
    s_add_u32 s74, s74, 229376
    buffer_load_dwordx4 v11, s[12:15], s74 offen lds
    v_mfma_f32_16x16x32_bf16 a[8:11], a[228:231], a[116:119], a[8:11]
    v_mfma_f32_16x16x32_bf16 a[12:15], a[224:227], a[120:123], 0
    v_mfma_f32_16x16x32_bf16 a[12:15], a[228:231], a[124:127], a[12:15]
    s_add_u32 m0, s67, 0
    s_mov_b32 s74, 256
    buffer_load_dwordx4 v9, s[4:7], s74 offen lds
    v_mfma_f32_16x16x32_bf16 a[16:19], a[224:227], a[128:131], 0
    v_mfma_f32_16x16x32_bf16 a[16:19], a[228:231], a[132:135], a[16:19]
    buffer_load_dwordx4 a[244:247], v22, s[4:7], s101 offen offset:1024
    v_mfma_f32_16x16x32_bf16 a[20:23], a[224:227], a[136:139], 0
    v_mfma_f32_16x16x32_bf16 a[20:23], a[228:231], a[140:143], a[20:23]
    buffer_load_dwordx4 a[248:251], v22, s[4:7], s101 offen offset:1536
    v_mfma_f32_16x16x32_bf16 a[24:27], a[224:227], a[144:147], 0
    v_mfma_f32_16x16x32_bf16 a[24:27], a[228:231], a[148:151], a[24:27]
    s_add_u32 m0, s67, 2048
    s_mov_b32 s74, 33024
    buffer_load_dwordx4 v9, s[4:7], s74 offen lds
    v_mfma_f32_16x16x32_bf16 a[28:31], a[224:227], a[152:155], 0
    v_mfma_f32_16x16x32_bf16 a[240:243], v[28:31], a[224:227], a[240:243]
    v_mfma_f32_16x16x32_bf16 a[28:31], a[228:231], a[156:159], a[28:31]
    s_waitcnt vmcnt(16) lgkmcnt(0)
    s_barrier
    v_mfma_f32_16x16x32_bf16 a[32:35], a[232:235], a[96:99], 0
    ds_read_b64_tr_b16 a[224:225], v7 offset:16384
    v_mfma_f32_16x16x32_bf16 a[32:35], a[236:239], a[100:103], a[32:35]
    ds_read_b64_tr_b16 a[226:227], v7 offset:16640
    v_mfma_f32_16x16x32_bf16 a[36:39], a[232:235], a[104:107], 0
    ds_read_b64_tr_b16 a[228:229], v8 offset:16384
    v_mfma_f32_16x16x32_bf16 a[36:39], a[236:239], a[108:111], a[36:39]
    ds_read_b64_tr_b16 a[230:231], v8 offset:16640
    v_mfma_f32_16x16x32_bf16 a[40:43], a[232:235], a[112:115], 0
    ds_read_b128 a[160:163], v1 offset:32768
    v_mfma_f32_16x16x32_bf16 a[40:43], a[236:239], a[116:119], a[40:43]
    ds_read_b128 a[164:167], v2 offset:32768
    v_mfma_f32_16x16x32_bf16 a[44:47], a[232:235], a[120:123], 0
    ds_read_b128 a[168:171], v1 offset:34816
    v_mfma_f32_16x16x32_bf16 a[44:47], a[236:239], a[124:127], a[44:47]
    ds_read_b128 a[172:175], v2 offset:34816
    v_mfma_f32_16x16x32_bf16 a[48:51], a[232:235], a[128:131], 0
    ds_read_b128 a[176:179], v1 offset:36864
    v_mov_b32_dpp v28, v28 row_ror:1 row_mask:0xf bank_mask:0xf
    v_mfma_f32_16x16x32_bf16 a[48:51], a[236:239], a[132:135], a[48:51]
    v_mov_b32_dpp v29, v29 row_ror:1 row_mask:0xf bank_mask:0xf
    v_mfma_f32_16x16x32_bf16 a[52:55], a[232:235], a[136:139], 0
    v_mov_b32_dpp v30, v30 row_ror:1 row_mask:0xf bank_mask:0xf
    v_mfma_f32_16x16x32_bf16 a[52:55], a[236:239], a[140:143], a[52:55]
    v_mov_b32_dpp v31, v31 row_ror:1 row_mask:0xf bank_mask:0xf
    v_mfma_f32_16x16x32_bf16 a[56:59], a[232:235], a[144:147], 0
    buffer_load_dword a254, v0, s[92:95], s69 offen
    s_add_u32 s69, s69, s77
    s_and_b32 s69, s69, s3
    v_mfma_f32_16x16x32_bf16 a[56:59], a[236:239], a[148:151], a[56:59]
    s_add_u32 m0, s67, 4096
    s_mov_b32 s74, 65792
    buffer_load_dwordx4 v9, s[4:7], s74 offen lds
    v_mfma_f32_16x16x32_bf16 a[60:63], a[232:235], a[152:155], 0
    v_mfma_f32_16x16x32_bf16 a[240:243], v[28:31], a[232:235], a[240:243]
    s_add_u32 m0, s66, 32768
    s_add_u32 s74, s64, 458752
    v_mfma_f32_16x16x32_bf16 a[60:63], a[236:239], a[156:159], a[60:63]
    s_waitcnt lgkmcnt(5)
    v_mfma_f32_16x16x32_bf16 v[224:227], a[224:227], a[96:99], 0
    ds_read_b64_tr_b16 a[232:233], v7 offset:18432
    v_mov_b32_dpp v28, v28 row_ror:1 row_mask:0xf bank_mask:0xf
    v_mfma_f32_16x16x32_bf16 v[224:227], a[228:231], a[100:103], v[224:227]
    ds_read_b64_tr_b16 a[234:235], v7 offset:18688
    v_mov_b32_dpp v29, v29 row_ror:1 row_mask:0xf bank_mask:0xf
    v_mfma_f32_16x16x32_bf16 v[228:231], a[224:227], a[104:107], 0
    ds_read_b64_tr_b16 a[236:237], v8 offset:18432
    v_mov_b32_dpp v30, v30 row_ror:1 row_mask:0xf bank_mask:0xf
    v_mfma_f32_16x16x32_bf16 v[228:231], a[228:231], a[108:111], v[228:231]
    ds_read_b64_tr_b16 a[238:239], v8 offset:18688
    v_mov_b32_dpp v31, v31 row_ror:1 row_mask:0xf bank_mask:0xf
    v_mfma_f32_16x16x32_bf16 v[232:235], a[224:227], a[112:115], 0
    ds_read_b128 a[180:183], v2 offset:36864
    buffer_load_dwordx4 v11, s[16:19], s74 offen lds
    v_mfma_f32_16x16x32_bf16 v[232:235], a[228:231], a[116:119], v[232:235]
    ds_read_b128 a[184:187], v1 offset:38912
    s_add_u32 m0, s66, 73728
    v_mfma_f32_16x16x32_bf16 v[236:239], a[224:227], a[120:123], 0
    ds_read_b128 a[188:191], v2 offset:38912
    s_add_u32 s74, s74, 229376
    v_mfma_f32_16x16x32_bf16 v[236:239], a[228:231], a[124:127], v[236:239]
    ds_read_b128 a[192:195], v1 offset:40960
    buffer_load_dwordx4 v11, s[16:19], s74 offen lds
    v_mfma_f32_16x16x32_bf16 v[240:243], a[224:227], a[128:131], 0
    ds_read_b128 a[196:199], v2 offset:40960
    v_mfma_f32_16x16x32_bf16 v[240:243], a[228:231], a[132:135], v[240:243]
    v_mfma_f32_16x16x32_bf16 v[244:247], a[224:227], a[136:139], 0
    s_add_u32 m0, s68, 20480
    s_add_u32 s74, s65, 458752
    buffer_load_dwordx4 v12, s[12:15], s74 offen lds
    v_mfma_f32_16x16x32_bf16 v[244:247], a[228:231], a[140:143], v[244:247]
    v_mfma_f32_16x16x32_bf16 v[248:251], a[224:227], a[144:147], 0
    v_mfma_f32_16x16x32_bf16 v[248:251], a[228:231], a[148:151], v[248:251]
    v_mfma_f32_16x16x32_bf16 v[252:255], a[224:227], a[152:155], 0
    v_mfma_f32_16x16x32_bf16 a[240:243], v[28:31], a[224:227], a[240:243]
    v_mfma_f32_16x16x32_bf16 v[252:255], a[228:231], a[156:159], v[252:255]
    s_waitcnt vmcnt(16) lgkmcnt(0)
    s_barrier
    v_mfma_f32_16x16x32_bf16 a[64:67], a[232:235], a[96:99], 0
    ds_read_b64_tr_b16 a[224:225], v3 offset:20480
    v_mfma_f32_16x16x32_bf16 a[64:67], a[236:239], a[100:103], a[64:67]
    ds_read_b64_tr_b16 a[226:227], v3 offset:20992
    v_mfma_f32_16x16x32_bf16 a[68:71], a[232:235], a[104:107], 0
    ds_read_b64_tr_b16 a[228:229], v5 offset:20480
    v_mfma_f32_16x16x32_bf16 a[68:71], a[236:239], a[108:111], a[68:71]
    ds_read_b64_tr_b16 a[230:231], v5 offset:20992
    v_mfma_f32_16x16x32_bf16 a[72:75], a[232:235], a[112:115], 0
    ds_read_b128 a[200:203], v1 offset:43008
    v_mfma_f32_16x16x32_bf16 a[72:75], a[236:239], a[116:119], a[72:75]
    ds_read_b128 a[204:207], v2 offset:43008
    v_mfma_f32_16x16x32_bf16 a[76:79], a[232:235], a[120:123], 0
    ds_read_b128 a[208:211], v1 offset:45056
    v_mfma_f32_16x16x32_bf16 a[76:79], a[236:239], a[124:127], a[76:79]
    ds_read_b128 a[212:215], v2 offset:45056
    v_mfma_f32_16x16x32_bf16 a[80:83], a[232:235], a[128:131], 0
    ds_read_b128 a[216:219], v1 offset:47104
    v_mov_b32_dpp v28, v28 row_ror:1 row_mask:0xf bank_mask:0xf
    v_mfma_f32_16x16x32_bf16 a[80:83], a[236:239], a[132:135], a[80:83]
    ds_read_b128 a[220:223], v2 offset:47104
    v_mov_b32_dpp v29, v29 row_ror:1 row_mask:0xf bank_mask:0xf
    v_mfma_f32_16x16x32_bf16 a[84:87], a[232:235], a[136:139], 0
    v_mov_b32_dpp v30, v30 row_ror:1 row_mask:0xf bank_mask:0xf
    s_add_u32 m0, s68, 22528
    v_mfma_f32_16x16x32_bf16 a[84:87], a[236:239], a[140:143], a[84:87]
    v_mov_b32_dpp v31, v31 row_ror:1 row_mask:0xf bank_mask:0xf
    v_mfma_f32_16x16x32_bf16 a[88:91], a[232:235], a[144:147], 0
    buffer_load_dwordx4 v12, s[16:19], s74 offen lds
    s_add_u32 m0, s67, 6144
    s_mov_b32 s74, 98560
    v_mfma_f32_16x16x32_bf16 a[88:91], a[236:239], a[148:151], a[88:91]
    s_cmp_eq_u32 s46, 0
    s_cselect_b32 s70, s81, s82
    s_cselect_b32 s71, s83, s50
    s_cmp_eq_u32 s45, 0
    s_cselect_b32 s70, s70, s71
    s_mov_b64 exec, 1
    buffer_store_dword v26, off, s[20:23], s70 sc1
    buffer_store_dword v26, off, s[20:23], s84 sc1
    s_mov_b64 exec, -1
    v_mfma_f32_16x16x32_bf16 a[92:95], a[232:235], a[152:155], 0
    v_mfma_f32_16x16x32_bf16 a[240:243], v[28:31], a[232:235], a[240:243]
    v_mfma_f32_16x16x32_bf16 a[92:95], a[236:239], a[156:159], a[92:95]
    buffer_load_dwordx4 v9, s[4:7], s74 offen lds
    s_add_u32 m0, s67, 8192
    s_waitcnt lgkmcnt(0)
    v_mfma_f32_16x16x32_bf16 v[32:35], a[224:227], a[160:163], v[32:35]
    ds_read_b64_tr_b16 a[232:233], v4 offset:20480
    v_mov_b32_dpp v28, v28 row_ror:7 row_mask:0xf bank_mask:0xf
    s_waitcnt vmcnt(18)
    v_lshlrev_b32 v27, 16, v27
    s_waitcnt vmcnt(17)
    v_and_b32 v25, 0xffff0000, v14
    v_mfma_f32_16x16x32_bf16 v[32:35], a[228:231], a[164:167], v[32:35]
    ds_read_b64_tr_b16 a[234:235], v4 offset:20992
    v_mov_b32_dpp v29, v29 row_ror:7 row_mask:0xf bank_mask:0xf
    v_mfma_f32_16x16x32_bf16 v[36:39], a[224:227], a[168:171], v[36:39]
    ds_read_b64_tr_b16 a[236:237], v6 offset:20480
    v_mov_b32_dpp v30, v30 row_ror:7 row_mask:0xf bank_mask:0xf
    v_mfma_f32_16x16x32_bf16 v[36:39], a[228:231], a[172:175], v[36:39]
    ds_read_b64_tr_b16 a[238:239], v6 offset:20992
    v_mov_b32_dpp v31, v31 row_ror:7 row_mask:0xf bank_mask:0xf
    v_mfma_f32_16x16x32_bf16 v[40:43], a[224:227], a[176:179], v[40:43]
    s_mov_b32 s74, 131328
    buffer_load_dwordx4 v9, s[4:7], s74 offen lds
    s_add_u32 m0, s67, 10240
    v_mfma_f32_16x16x32_bf16 v[40:43], a[228:231], a[180:183], v[40:43]
    s_mov_b32 s74, 164096
    v_lshlrev_b32 v24, 16, v14
    v_sub_f32 v24, v24, v27
    v_sub_f32 v25, v25, v27
    v_add_f32 v22, v24, v25
    v_mfma_f32_16x16x32_bf16 v[44:47], a[224:227], a[184:187], v[44:47]
    v_mul_f32 v23, v24, v24
    v_fmac_f32 v23, v25, v25
    v_mfma_f32_16x16x32_bf16 v[44:47], a[228:231], a[188:191], v[44:47]
    buffer_load_dwordx4 v9, s[4:7], s74 offen lds
    s_add_u32 m0, s67, 12288
    s_mov_b32 s74, 196864
    v_and_b32 v25, 0xffff0000, v15
    v_mfma_f32_16x16x32_bf16 v[48:51], a[224:227], a[192:195], v[48:51]
    v_lshlrev_b32 v24, 16, v15
    v_mfma_f32_16x16x32_bf16 v[48:51], a[228:231], a[196:199], v[48:51]
    v_sub_f32 v24, v24, v27
    v_mfma_f32_16x16x32_bf16 v[52:55], a[224:227], a[200:203], v[52:55]
    buffer_load_dwordx4 v9, s[4:7], s74 offen lds
    v_sub_f32 v25, v25, v27
    v_mfma_f32_16x16x32_bf16 v[52:55], a[228:231], a[204:207], v[52:55]
    v_add_f32 v22, v22, v24
    v_mfma_f32_16x16x32_bf16 v[56:59], a[224:227], a[208:211], v[56:59]
    v_fmac_f32 v23, v24, v24
    v_mfma_f32_16x16x32_bf16 v[56:59], a[228:231], a[212:215], v[56:59]
    s_add_u32 m0, s67, 14336
    s_mov_b32 s74, 229632
    buffer_load_dwordx4 v9, s[4:7], s74 offen lds
    v_mfma_f32_16x16x32_bf16 v[60:63], a[224:227], a[216:219], v[60:63]
    v_mfma_f32_16x16x32_bf16 a[240:243], v[28:31], a[224:227], a[240:243]
    v_add_f32 v22, v22, v25
    v_fmac_f32 v23, v25, v25
    v_mfma_f32_16x16x32_bf16 v[60:63], a[228:231], a[220:223], v[60:63]
    s_waitcnt vmcnt(20) lgkmcnt(0)
    s_barrier
    v_mfma_f32_16x16x32_bf16 v[64:67], a[232:235], a[160:163], v[64:67]
    ds_read_b64_tr_b16 a[224:225], v3 offset:24576
    v_mfma_f32_16x16x32_bf16 v[64:67], a[236:239], a[164:167], v[64:67]
    ds_read_b64_tr_b16 a[226:227], v3 offset:25088
    v_mfma_f32_16x16x32_bf16 v[68:71], a[232:235], a[168:171], v[68:71]
    ds_read_b64_tr_b16 a[228:229], v5 offset:24576
    v_mfma_f32_16x16x32_bf16 v[68:71], a[236:239], a[172:175], v[68:71]
    ds_read_b64_tr_b16 a[230:231], v5 offset:25088
    v_mfma_f32_16x16x32_bf16 v[72:75], a[232:235], a[176:179], v[72:75]
    v_mov_b32_dpp v28, v28 row_ror:1 row_mask:0xf bank_mask:0xf
    s_add_u32 m0, s66, 0
    v_and_b32 v25, 0xffff0000, v16
    v_lshlrev_b32 v24, 16, v16
    v_mfma_f32_16x16x32_bf16 v[72:75], a[236:239], a[180:183], v[72:75]
    s_add_u32 s74, s61, 786432
    buffer_load_dwordx4 v10, s[8:11], s74 offen lds
    v_sub_f32 v24, v24, v27
    v_mfma_f32_16x16x32_bf16 v[76:79], a[232:235], a[184:187], v[76:79]
    v_mov_b32_dpp v29, v29 row_ror:1 row_mask:0xf bank_mask:0xf
    v_sub_f32 v25, v25, v27
    v_add_f32 v22, v22, v24
    v_fmac_f32 v23, v24, v24
    v_mfma_f32_16x16x32_bf16 v[76:79], a[236:239], a[188:191], v[76:79]
    v_add_f32 v22, v22, v25
    v_fmac_f32 v23, v25, v25
    v_and_b32 v25, 0xffff0000, v17
    v_lshlrev_b32 v24, 16, v17
    v_mfma_f32_16x16x32_bf16 v[80:83], a[232:235], a[192:195], v[80:83]
    v_mov_b32_dpp v30, v30 row_ror:1 row_mask:0xf bank_mask:0xf
    s_add_u32 m0, s66, 40960
    v_mfma_f32_16x16x32_bf16 v[80:83], a[236:239], a[196:199], v[80:83]
    s_add_u32 s74, s74, 196608
    buffer_load_dwordx4 v10, s[8:11], s74 offen lds
    v_sub_f32 v24, v24, v27
    v_mfma_f32_16x16x32_bf16 v[84:87], a[232:235], a[200:203], v[84:87]
    v_mov_b32_dpp v31, v31 row_ror:1 row_mask:0xf bank_mask:0xf
    v_sub_f32 v25, v25, v27
    v_add_f32 v22, v22, v24
    v_mfma_f32_16x16x32_bf16 v[84:87], a[236:239], a[204:207], v[84:87]
    v_fmac_f32 v23, v24, v24
    v_mfma_f32_16x16x32_bf16 v[88:91], a[232:235], a[208:211], v[88:91]
    v_add_f32 v22, v22, v25
    v_mfma_f32_16x16x32_bf16 v[88:91], a[236:239], a[212:215], v[88:91]
    v_fmac_f32 v23, v25, v25
    v_mfma_f32_16x16x32_bf16 v[92:95], a[232:235], a[216:219], v[92:95]
    v_mfma_f32_16x16x32_bf16 a[240:243], v[28:31], a[232:235], a[240:243]
    s_add_u32 m0, s66, 4096
    s_add_u32 s74, s62, 786432
    buffer_load_dwordx4 v10, s[8:11], s74 offen lds
    s_waitcnt vmcnt(21)
    v_and_b32 v25, 0xffff0000, v18
    v_mfma_f32_16x16x32_bf16 v[92:95], a[236:239], a[220:223], v[92:95]
    v_lshlrev_b32 v24, 16, v18
    s_waitcnt lgkmcnt(0)
    v_mfma_f32_16x16x32_bf16 v[96:99], a[160:163], a[224:227], v[96:99]
    ds_read_b64_tr_b16 a[232:233], v4 offset:24576
    v_mov_b32_dpp v28, v28 row_ror:1 row_mask:0xf bank_mask:0xf
    v_mfma_f32_16x16x32_bf16 v[96:99], a[164:167], a[228:231], v[96:99]
    ds_read_b64_tr_b16 a[234:235], v4 offset:25088
    v_mov_b32_dpp v29, v29 row_ror:1 row_mask:0xf bank_mask:0xf
    v_mfma_f32_16x16x32_bf16 v[100:103], a[168:171], a[224:227], v[100:103]
    ds_read_b64_tr_b16 a[236:237], v6 offset:24576
    v_mov_b32_dpp v30, v30 row_ror:1 row_mask:0xf bank_mask:0xf
    v_mfma_f32_16x16x32_bf16 v[100:103], a[172:175], a[228:231], v[100:103]
    ds_read_b64_tr_b16 a[238:239], v6 offset:25088
    v_mov_b32_dpp v31, v31 row_ror:1 row_mask:0xf bank_mask:0xf
    v_mfma_f32_16x16x32_bf16 v[104:107], a[176:179], a[224:227], v[104:107]
    s_add_u32 m0, s66, 45056
    s_add_u32 s74, s74, 196608
    buffer_load_dwordx4 v10, s[8:11], s74 offen lds
    v_mfma_f32_16x16x32_bf16 v[104:107], a[180:183], a[228:231], v[104:107]
    v_sub_f32 v24, v24, v27
    v_sub_f32 v25, v25, v27
    v_add_f32 v22, v22, v24
    v_fmac_f32 v23, v24, v24
    v_mfma_f32_16x16x32_bf16 v[108:111], a[184:187], a[224:227], v[108:111]
    v_add_f32 v22, v22, v25
    v_fmac_f32 v23, v25, v25
    v_and_b32 v25, 0xffff0000, v19
    v_lshlrev_b32 v24, 16, v19
    v_mfma_f32_16x16x32_bf16 v[108:111], a[188:191], a[228:231], v[108:111]
    v_sub_f32 v24, v24, v27
    v_mfma_f32_16x16x32_bf16 v[112:115], a[192:195], a[224:227], v[112:115]
    v_sub_f32 v25, v25, v27
    v_mfma_f32_16x16x32_bf16 v[112:115], a[196:199], a[228:231], v[112:115]
    v_add_f32 v22, v22, v24
    v_mfma_f32_16x16x32_bf16 v[116:119], a[200:203], a[224:227], v[116:119]
    s_add_u32 m0, s66, 8192
    s_add_u32 s74, s63, 917504
    buffer_load_dwordx4 v11, s[12:15], s74 offen lds
    v_fmac_f32 v23, v24, v24
    v_mfma_f32_16x16x32_bf16 v[116:119], a[204:207], a[228:231], v[116:119]
    v_add_f32 v22, v22, v25
    v_mfma_f32_16x16x32_bf16 v[120:123], a[208:211], a[224:227], v[120:123]
    v_fmac_f32 v23, v25, v25
    v_mfma_f32_16x16x32_bf16 v[120:123], a[212:215], a[228:231], v[120:123]
    v_and_b32 v25, 0xffff0000, v20
    v_mfma_f32_16x16x32_bf16 v[124:127], a[216:219], a[224:227], v[124:127]
    v_mfma_f32_16x16x32_bf16 a[240:243], v[28:31], a[224:227], a[240:243]
    v_lshlrev_b32 v24, 16, v20
    v_mfma_f32_16x16x32_bf16 v[124:127], a[220:223], a[228:231], v[124:127]
    s_waitcnt vmcnt(16) lgkmcnt(0)
    s_barrier
    v_mfma_f32_16x16x32_bf16 v[128:131], a[160:163], a[232:235], v[128:131]
    ds_read_b64_tr_b16 a[224:225], v3 offset:28672
    v_mfma_f32_16x16x32_bf16 v[128:131], a[164:167], a[236:239], v[128:131]
    ds_read_b64_tr_b16 a[226:227], v3 offset:29184
    v_mfma_f32_16x16x32_bf16 v[132:135], a[168:171], a[232:235], v[132:135]
    ds_read_b64_tr_b16 a[228:229], v5 offset:28672
    v_mfma_f32_16x16x32_bf16 v[132:135], a[172:175], a[236:239], v[132:135]
    ds_read_b64_tr_b16 a[230:231], v5 offset:29184
    v_mfma_f32_16x16x32_bf16 v[136:139], a[176:179], a[232:235], v[136:139]
    ds_read_b128 a[96:99], v1
    v_mfma_f32_16x16x32_bf16 v[136:139], a[180:183], a[236:239], v[136:139]
    ds_read_b128 a[100:103], v2
    v_mfma_f32_16x16x32_bf16 v[140:143], a[184:187], a[232:235], v[140:143]
    ds_read_b128 a[104:107], v1 offset:2048
    v_mfma_f32_16x16x32_bf16 v[140:143], a[188:191], a[236:239], v[140:143]
    v_mov_b32_dpp v28, v28 row_ror:1 row_mask:0xf bank_mask:0xf
    s_add_u32 m0, s66, 49152
    v_mfma_f32_16x16x32_bf16 v[144:147], a[192:195], a[232:235], v[144:147]
    v_mov_b32_dpp v29, v29 row_ror:1 row_mask:0xf bank_mask:0xf
    s_add_u32 s74, s74, 229376
    v_mfma_f32_16x16x32_bf16 v[144:147], a[196:199], a[236:239], v[144:147]
    v_mov_b32_dpp v30, v30 row_ror:1 row_mask:0xf bank_mask:0xf
    v_sub_f32 v24, v24, v27
    v_mfma_f32_16x16x32_bf16 v[148:151], a[200:203], a[232:235], v[148:151]
    v_mov_b32_dpp v31, v31 row_ror:1 row_mask:0xf bank_mask:0xf
    v_sub_f32 v25, v25, v27
    v_add_f32 v22, v22, v24
    v_fmac_f32 v23, v24, v24
    v_mfma_f32_16x16x32_bf16 v[148:151], a[204:207], a[236:239], v[148:151]
    buffer_load_dwordx4 v11, s[12:15], s74 offen lds
    s_add_u32 m0, s66, 147456
    s_lshl2_add_u32 s73, s48, s44
    v_mfma_f32_16x16x32_bf16 v[152:155], a[208:211], a[232:235], v[152:155]
    s_lshl_b32 s73, s73, 10
    v_add_f32 v22, v22, v25
    v_fmac_f32 v23, v25, v25
    v_and_b32 v25, 0xffff0000, v21
    v_lshlrev_b32 v24, 16, v21
    v_mfma_f32_16x16x32_bf16 v[152:155], a[212:215], a[236:239], v[152:155]
    v_sub_f32 v24, v24, v27
    v_sub_f32 v25, v25, v27
    v_add_f32 v22, v22, v24
    v_fmac_f32 v23, v24, v24
    v_mfma_f32_16x16x32_bf16 v[156:159], a[216:219], a[232:235], v[156:159]
    v_mfma_f32_16x16x32_bf16 a[240:243], v[28:31], a[232:235], a[240:243]
    buffer_load_dwordx4 v13, s[40:43], s73 offen lds
    s_add_u32 m0, s67, 32768
    s_mov_b32 s74, 384
    v_mfma_f32_16x16x32_bf16 v[156:159], a[220:223], a[236:239], v[156:159]
    v_add_f32 v22, v22, v25
    s_waitcnt lgkmcnt(3)
    v_mfma_f32_16x16x32_bf16 v[160:163], a[224:227], a[160:163], v[160:163]
    ds_read_b64_tr_b16 a[232:233], v4 offset:28672
    v_mov_b32_dpp v28, v28 row_ror:1 row_mask:0xf bank_mask:0xf
    v_mfma_f32_16x16x32_bf16 v[160:163], a[228:231], a[164:167], v[160:163]
    ds_read_b64_tr_b16 a[234:235], v4 offset:29184
    v_mov_b32_dpp v29, v29 row_ror:1 row_mask:0xf bank_mask:0xf
    v_mfma_f32_16x16x32_bf16 v[164:167], a[224:227], a[168:171], v[164:167]
    ds_read_b64_tr_b16 a[236:237], v6 offset:28672
    v_mov_b32_dpp v30, v30 row_ror:1 row_mask:0xf bank_mask:0xf
    v_mfma_f32_16x16x32_bf16 v[164:167], a[228:231], a[172:175], v[164:167]
    ds_read_b64_tr_b16 a[238:239], v6 offset:29184
    v_mov_b32_dpp v31, v31 row_ror:1 row_mask:0xf bank_mask:0xf
    v_mfma_f32_16x16x32_bf16 v[168:171], a[224:227], a[176:179], v[168:171]
    ds_read_b128 a[108:111], v2 offset:2048
    buffer_load_dwordx4 v9, s[4:7], s74 offen lds
    v_mfma_f32_16x16x32_bf16 v[168:171], a[228:231], a[180:183], v[168:171]
    ds_read_b128 a[112:115], v1 offset:4096
    s_add_u32 m0, s67, 34816
    v_mfma_f32_16x16x32_bf16 v[172:175], a[224:227], a[184:187], v[172:175]
    ds_read_b128 a[116:119], v2 offset:4096
    s_mov_b32 s74, 33152
    v_mfma_f32_16x16x32_bf16 v[172:175], a[228:231], a[188:191], v[172:175]
    buffer_load_dwordx4 v9, s[4:7], s74 offen lds
    s_add_u32 m0, s67, 36864
    s_mov_b32 s74, 65920
    v_mfma_f32_16x16x32_bf16 v[176:179], a[224:227], a[192:195], v[176:179]
    v_fmac_f32 v23, v25, v25
    v_accvgpr_read_b32 v24, a244
    v_and_b32 v25, 0xffff0000, v24
    v_mfma_f32_16x16x32_bf16 v[176:179], a[228:231], a[196:199], v[176:179]
    v_lshlrev_b32 v24, 16, v24
    v_sub_f32 v24, v24, v27
    v_sub_f32 v25, v25, v27
    v_add_f32 v22, v22, v24
    v_mfma_f32_16x16x32_bf16 v[180:183], a[224:227], a[200:203], v[180:183]
    buffer_load_dwordx4 v9, s[4:7], s74 offen lds
    v_fmac_f32 v23, v24, v24
    v_add_f32 v22, v22, v25
    v_fmac_f32 v23, v25, v25
    v_accvgpr_read_b32 v24, a245
    v_mfma_f32_16x16x32_bf16 v[180:183], a[228:231], a[204:207], v[180:183]
    v_and_b32 v25, 0xffff0000, v24
    v_lshlrev_b32 v24, 16, v24
    v_sub_f32 v24, v24, v27
    v_sub_f32 v25, v25, v27
    v_mfma_f32_16x16x32_bf16 v[184:187], a[224:227], a[208:211], v[184:187]
    s_add_u32 m0, s66, 12288
    s_add_u32 s74, s64, 917504
    v_add_f32 v22, v22, v24
    v_mfma_f32_16x16x32_bf16 v[184:187], a[228:231], a[212:215], v[184:187]
    buffer_load_dwordx4 v11, s[16:19], s74 offen lds
    v_fmac_f32 v23, v24, v24
    v_add_f32 v22, v22, v25
    v_fmac_f32 v23, v25, v25
    v_mfma_f32_16x16x32_bf16 v[188:191], a[224:227], a[216:219], v[188:191]
    v_mfma_f32_16x16x32_bf16 a[240:243], v[28:31], a[224:227], a[240:243]
    v_accvgpr_read_b32 v24, a246
    v_and_b32 v25, 0xffff0000, v24
    v_mfma_f32_16x16x32_bf16 v[188:191], a[228:231], a[220:223], v[188:191]
    s_waitcnt vmcnt(11) lgkmcnt(0)
    s_barrier
    v_mfma_f32_16x16x32_bf16 v[192:195], a[232:235], a[160:163], v[192:195]
    ds_read_b64_tr_b16 a[224:225], v3 offset:32768
    v_mfma_f32_16x16x32_bf16 v[192:195], a[236:239], a[164:167], v[192:195]
    ds_read_b64_tr_b16 a[226:227], v3 offset:33280
    v_mfma_f32_16x16x32_bf16 v[196:199], a[232:235], a[168:171], v[196:199]
    ds_read_b64_tr_b16 a[228:229], v5 offset:32768
    v_mfma_f32_16x16x32_bf16 v[196:199], a[236:239], a[172:175], v[196:199]
    ds_read_b64_tr_b16 a[230:231], v5 offset:33280
    v_mfma_f32_16x16x32_bf16 v[200:203], a[232:235], a[176:179], v[200:203]
    ds_read_b128 a[120:123], v1 offset:6144
    v_mfma_f32_16x16x32_bf16 v[200:203], a[236:239], a[180:183], v[200:203]
    ds_read_b128 a[124:127], v2 offset:6144
    v_mfma_f32_16x16x32_bf16 v[204:207], a[232:235], a[184:187], v[204:207]
    ds_read_b128 a[128:131], v1 offset:8192
    v_mfma_f32_16x16x32_bf16 v[204:207], a[236:239], a[188:191], v[204:207]
    v_mov_b32_dpp v28, v28 row_ror:1 row_mask:0xf bank_mask:0xf
    s_add_u32 m0, s66, 53248
    v_lshlrev_b32 v24, 16, v24
    v_sub_f32 v24, v24, v27
    v_mfma_f32_16x16x32_bf16 v[208:211], a[232:235], a[192:195], v[208:211]
    v_mov_b32_dpp v29, v29 row_ror:1 row_mask:0xf bank_mask:0xf
    s_add_u32 s74, s74, 229376
    v_mfma_f32_16x16x32_bf16 v[208:211], a[236:239], a[196:199], v[208:211]
    v_mov_b32_dpp v30, v30 row_ror:1 row_mask:0xf bank_mask:0xf
    v_sub_f32 v25, v25, v27
    v_mfma_f32_16x16x32_bf16 v[212:215], a[232:235], a[200:203], v[212:215]
    v_mov_b32_dpp v31, v31 row_ror:1 row_mask:0xf bank_mask:0xf
    v_add_f32 v22, v22, v24
    v_fmac_f32 v23, v24, v24
    v_add_f32 v22, v22, v25
    v_mfma_f32_16x16x32_bf16 v[212:215], a[236:239], a[204:207], v[212:215]
    buffer_load_dwordx4 v11, s[16:19], s74 offen lds
    s_add_u32 m0, s68, 0
    s_add_u32 s74, s65, 917504
    v_mfma_f32_16x16x32_bf16 v[216:219], a[232:235], a[208:211], v[216:219]
    v_fmac_f32 v23, v25, v25
    v_accvgpr_read_b32 v24, a247
    v_and_b32 v25, 0xffff0000, v24
    v_lshlrev_b32 v24, 16, v24
    v_mfma_f32_16x16x32_bf16 v[216:219], a[236:239], a[212:215], v[216:219]
    v_sub_f32 v24, v24, v27
    v_sub_f32 v25, v25, v27
    v_add_f32 v22, v22, v24
    v_fmac_f32 v23, v24, v24
    v_mfma_f32_16x16x32_bf16 v[220:223], a[232:235], a[216:219], v[220:223]
    v_mfma_f32_16x16x32_bf16 a[240:243], v[28:31], a[232:235], a[240:243]
    buffer_load_dwordx4 v12, s[12:15], s74 offen lds
    s_add_u32 m0, s68, 2048
    v_add_f32 v22, v22, v25
    v_mfma_f32_16x16x32_bf16 v[220:223], a[236:239], a[220:223], v[220:223]
    v_fmac_f32 v23, v25, v25
    v_accvgpr_read_b32 v24, a248
    v_and_b32 v25, 0xffff0000, v24
    s_waitcnt lgkmcnt(3)
    v_mfma_f32_16x16x32_bf16 a[0:3], a[224:227], a[160:163], a[0:3]
    ds_read_b64_tr_b16 a[232:233], v4 offset:32768
    v_mov_b32_dpp v28, v28 row_ror:1 row_mask:0xf bank_mask:0xf
    v_mfma_f32_16x16x32_bf16 a[0:3], a[228:231], a[164:167], a[0:3]
    ds_read_b64_tr_b16 a[234:235], v4 offset:33280
    v_mov_b32_dpp v29, v29 row_ror:1 row_mask:0xf bank_mask:0xf
    v_mfma_f32_16x16x32_bf16 a[4:7], a[224:227], a[168:171], a[4:7]
    ds_read_b64_tr_b16 a[236:237], v6 offset:32768
    v_mov_b32_dpp v30, v30 row_ror:1 row_mask:0xf bank_mask:0xf
    v_mfma_f32_16x16x32_bf16 a[4:7], a[228:231], a[172:175], a[4:7]
    ds_read_b64_tr_b16 a[238:239], v6 offset:33280
    v_mov_b32_dpp v31, v31 row_ror:1 row_mask:0xf bank_mask:0xf
    v_mfma_f32_16x16x32_bf16 a[8:11], a[224:227], a[176:179], a[8:11]
    ds_read_b128 a[132:135], v2 offset:8192
    buffer_load_dwordx4 v12, s[16:19], s74 offen lds
    v_mfma_f32_16x16x32_bf16 a[8:11], a[228:231], a[180:183], a[8:11]
    ds_read_b128 a[136:139], v1 offset:10240
    s_add_u32 m0, s67, 38912
    v_mfma_f32_16x16x32_bf16 a[12:15], a[224:227], a[184:187], a[12:15]
    ds_read_b128 a[140:143], v2 offset:10240
    s_mov_b32 s74, 98688
    v_mfma_f32_16x16x32_bf16 a[12:15], a[228:231], a[188:191], a[12:15]
    buffer_load_dwordx4 v9, s[4:7], s74 offen lds
    v_lshlrev_b32 v24, 16, v24
    v_sub_f32 v24, v24, v27
    v_sub_f32 v25, v25, v27
    v_add_f32 v22, v22, v24
    v_mfma_f32_16x16x32_bf16 a[16:19], a[224:227], a[192:195], a[16:19]
    v_fmac_f32 v23, v24, v24
    v_add_f32 v22, v22, v25
    v_fmac_f32 v23, v25, v25
    v_accvgpr_read_b32 v24, a249
    v_mfma_f32_16x16x32_bf16 a[16:19], a[228:231], a[196:199], a[16:19]
    s_add_u32 m0, s67, 40960
    s_mov_b32 s74, 131456
    v_and_b32 v25, 0xffff0000, v24
    v_mfma_f32_16x16x32_bf16 a[20:23], a[224:227], a[200:203], a[20:23]
    buffer_load_dwordx4 v9, s[4:7], s74 offen lds
    v_lshlrev_b32 v24, 16, v24
    v_sub_f32 v24, v24, v27
    v_sub_f32 v25, v25, v27
    v_mfma_f32_16x16x32_bf16 a[20:23], a[228:231], a[204:207], a[20:23]
    v_add_f32 v22, v22, v24
    s_mov_b32 s42, 0
    v_mfma_f32_16x16x32_bf16 a[24:27], a[224:227], a[208:211], a[24:27]
    v_fmac_f32 v23, v24, v24
    s_lshl1_add_u32 s70, s49, s46
    v_mfma_f32_16x16x32_bf16 a[24:27], a[228:231], a[212:215], a[24:27]
    v_add_f32 v22, v22, v25
    v_mfma_f32_16x16x32_bf16 a[28:31], a[224:227], a[216:219], a[28:31]
    v_mfma_f32_16x16x32_bf16 a[240:243], v[28:31], a[224:227], a[240:243]
    v_fmac_f32 v23, v25, v25
    s_lshl1_add_u32 s70, s70, s45
    v_mfma_f32_16x16x32_bf16 a[28:31], a[228:231], a[220:223], a[28:31]
    s_add_u32 m0, s67, 43008
    s_mov_b32 s74, 164224
    s_waitcnt lgkmcnt(3)
    v_mfma_f32_16x16x32_bf16 a[32:35], a[232:235], a[160:163], a[32:35]
    ds_read_b64_tr_b16 a[224:225], v7 offset:36864
    v_mov_b32_dpp v28, v28 row_ror:1 row_mask:0xf bank_mask:0xf
    v_mfma_f32_16x16x32_bf16 a[32:35], a[236:239], a[164:167], a[32:35]
    ds_read_b64_tr_b16 a[226:227], v7 offset:37120
    v_mov_b32_dpp v29, v29 row_ror:1 row_mask:0xf bank_mask:0xf
    v_mfma_f32_16x16x32_bf16 a[36:39], a[232:235], a[168:171], a[36:39]
    ds_read_b64_tr_b16 a[228:229], v8 offset:36864
    v_mov_b32_dpp v30, v30 row_ror:1 row_mask:0xf bank_mask:0xf
    v_mfma_f32_16x16x32_bf16 a[36:39], a[236:239], a[172:175], a[36:39]
    ds_read_b64_tr_b16 a[230:231], v8 offset:37120
    v_mov_b32_dpp v31, v31 row_ror:1 row_mask:0xf bank_mask:0xf
    v_mfma_f32_16x16x32_bf16 a[40:43], a[232:235], a[176:179], a[40:43]
    ds_read_b128 a[144:147], v1 offset:12288
    buffer_load_dwordx4 v9, s[4:7], s74 offen lds
    v_mfma_f32_16x16x32_bf16 a[40:43], a[236:239], a[180:183], a[40:43]
    ds_read_b128 a[148:151], v2 offset:12288
    s_add_u32 m0, s67, 45056
    v_mfma_f32_16x16x32_bf16 a[44:47], a[232:235], a[184:187], a[44:47]
    ds_read_b128 a[152:155], v1 offset:14336
    s_mov_b32 s74, 196992
    v_mfma_f32_16x16x32_bf16 a[44:47], a[236:239], a[188:191], a[44:47]
    buffer_load_dwordx4 v9, s[4:7], s74 offen lds
    v_accvgpr_read_b32 v24, a250
    v_and_b32 v25, 0xffff0000, v24
    v_lshlrev_b32 v24, 16, v24
    v_sub_f32 v24, v24, v27
L_pad0_19:
    s_cbranch_execz L_back0
    v_mfma_f32_16x16x32_bf16 a[48:51], a[232:235], a[192:195], a[48:51]
    v_sub_f32 v25, v25, v27
    v_add_f32 v22, v22, v24
    v_fmac_f32 v23, v24, v24
    v_add_f32 v22, v22, v25
    v_mfma_f32_16x16x32_bf16 a[48:51], a[236:239], a[196:199], a[48:51]
    v_fmac_f32 v23, v25, v25
    v_accvgpr_read_b32 v24, a251
    v_and_b32 v25, 0xffff0000, v24
    v_mfma_f32_16x16x32_bf16 a[52:55], a[232:235], a[200:203], a[52:55]
    v_lshlrev_b32 v24, 16, v24
    s_lshl3_add_u32 s70, s70, s47
    v_mfma_f32_16x16x32_bf16 a[52:55], a[236:239], a[204:207], a[52:55]
    s_add_u32 m0, s67, 47104
    s_mov_b32 s74, 229760
    buffer_load_dwordx4 v9, s[4:7], s74 offen lds
    v_mfma_f32_16x16x32_bf16 a[56:59], a[232:235], a[208:211], a[56:59]
    v_sub_f32 v24, v24, v27
    v_sub_f32 v25, v25, v27
    v_add_f32 v22, v22, v24
    v_mfma_f32_16x16x32_bf16 a[56:59], a[236:239], a[212:215], a[56:59]
    v_fmac_f32 v23, v24, v24
    v_mfma_f32_16x16x32_bf16 a[60:63], a[232:235], a[216:219], a[60:63]
    v_mfma_f32_16x16x32_bf16 a[240:243], v[28:31], a[232:235], a[240:243]
    v_add_f32 v22, v22, v25
    v_mfma_f32_16x16x32_bf16 a[60:63], a[236:239], a[220:223], a[60:63]
    v_fmac_f32 v23, v25, v25
    s_waitcnt lgkmcnt(3)
    v_mfma_f32_16x16x32_bf16 v[224:227], a[224:227], a[160:163], v[224:227]
    ds_read_b64_tr_b16 a[232:233], v7 offset:38912
    v_mov_b32_dpp v28, v28 row_ror:1 row_mask:0xf bank_mask:0xf
    v_add_f32_dpp v22, v22, v22 row_ror:8 row_mask:0xf bank_mask:0xf
    v_mfma_f32_16x16x32_bf16 v[224:227], a[228:231], a[164:167], v[224:227]
    ds_read_b64_tr_b16 a[234:235], v7 offset:39168
    v_mov_b32_dpp v29, v29 row_ror:1 row_mask:0xf bank_mask:0xf
    v_add_f32_dpp v23, v23, v23 row_ror:8 row_mask:0xf bank_mask:0xf
    v_mfma_f32_16x16x32_bf16 v[228:231], a[224:227], a[168:171], v[228:231]
    ds_read_b64_tr_b16 a[236:237], v8 offset:38912
    v_mov_b32_dpp v30, v30 row_ror:1 row_mask:0xf bank_mask:0xf
    v_mfma_f32_16x16x32_bf16 v[228:231], a[228:231], a[172:175], v[228:231]
    ds_read_b64_tr_b16 a[238:239], v8 offset:39168
    v_mov_b32_dpp v31, v31 row_ror:1 row_mask:0xf bank_mask:0xf
    v_mfma_f32_16x16x32_bf16 v[232:235], a[224:227], a[176:179], v[232:235]
    ds_read_b128 a[156:159], v2 offset:14336
    v_add_f32_dpp v22, v22, v22 row_ror:4 row_mask:0xf bank_mask:0xf
    v_mfma_f32_16x16x32_bf16 v[232:235], a[228:231], a[180:183], v[232:235]
    v_add_f32_dpp v23, v23, v23 row_ror:4 row_mask:0xf bank_mask:0xf
    v_add_f32_dpp v22, v22, v22 row_ror:2 row_mask:0xf bank_mask:0xf
    s_nop 0
    v_add_f32_dpp v23, v23, v23 row_ror:2 row_mask:0xf bank_mask:0xf
    v_mfma_f32_16x16x32_bf16 v[236:239], a[224:227], a[184:187], v[236:239]
    v_add_f32_dpp v22, v22, v22 row_ror:1 row_mask:0xf bank_mask:0xf
    s_lshl_b32 s70, s70, 10
    v_mfma_f32_16x16x32_bf16 v[236:239], a[228:231], a[188:191], v[236:239]
    v_add_f32_dpp v23, v23, v23 row_ror:1 row_mask:0xf bank_mask:0xf
    v_mfma_f32_16x16x32_bf16 v[240:243], a[224:227], a[192:195], v[240:243]
    v_mov_b32 v24, v22
    v_mfma_f32_16x16x32_bf16 v[240:243], a[228:231], a[196:199], v[240:243]
    v_mov_b32 v25, v23
    v_mfma_f32_16x16x32_bf16 v[244:247], a[224:227], a[200:203], v[244:247]
    v_permlane16_swap_b32 v24, v22
    v_mfma_f32_16x16x32_bf16 v[244:247], a[228:231], a[204:207], v[244:247]
    v_permlane16_swap_b32 v25, v23
    v_mfma_f32_16x16x32_bf16 v[248:251], a[224:227], a[208:211], v[248:251]
    v_add_f32 v22, v22, v24
    v_mfma_f32_16x16x32_bf16 v[248:251], a[228:231], a[212:215], v[248:251]
    v_add_f32 v23, v23, v25
    s_add_u32 s70, s70, 33030144
    v_mfma_f32_16x16x32_bf16 v[252:255], a[224:227], a[216:219], v[252:255]
    v_mfma_f32_16x16x32_bf16 a[240:243], v[28:31], a[224:227], a[240:243]
    v_mul_f32 v22, 0xba800000, v22
    v_mul_f32 v23, 0x3a800000, v23
    v_mfma_f32_16x16x32_bf16 v[252:255], a[228:231], a[220:223], v[252:255]
    s_waitcnt vmcnt(9) lgkmcnt(0)
    s_barrier
    v_mfma_f32_16x16x32_bf16 a[64:67], a[232:235], a[160:163], a[64:67]
    ds_read_b64_tr_b16 a[224:225], v3
    v_mfma_f32_16x16x32_bf16 a[64:67], a[236:239], a[164:167], a[64:67]
    ds_read_b64_tr_b16 a[226:227], v3 offset:512
    v_mfma_f32_16x16x32_bf16 a[68:71], a[232:235], a[168:171], a[68:71]
    ds_read_b64_tr_b16 a[228:229], v5
    v_mfma_f32_16x16x32_bf16 a[68:71], a[236:239], a[172:175], a[68:71]
    ds_read_b64_tr_b16 a[230:231], v5 offset:512
    v_mfma_f32_16x16x32_bf16 a[72:75], a[232:235], a[176:179], a[72:75]
    v_mov_b32_dpp v28, v28 row_ror:1 row_mask:0xf bank_mask:0xf
    v_mov_b32_dpp v29, v29 row_ror:1 row_mask:0xf bank_mask:0xf
    v_fma_f32 v23, -v22, v22, v23
    v_max_f32 v23, 0, v23
    v_mfma_f32_16x16x32_bf16 a[72:75], a[236:239], a[180:183], a[72:75]
    v_mov_b32_dpp v30, v30 row_ror:1 row_mask:0xf bank_mask:0xf
    v_mov_b32_dpp v31, v31 row_ror:1 row_mask:0xf bank_mask:0xf
    v_mfma_f32_16x16x32_bf16 a[76:79], a[232:235], a[184:187], a[76:79]
    s_add_u32 m0, s66, 20480
    s_add_u32 s74, s61, 1179648
    buffer_load_dwordx4 v10, s[8:11], s74 offen lds
    v_mfma_f32_16x16x32_bf16 a[76:79], a[236:239], a[188:191], a[76:79]
    s_add_u32 m0, s66, 61440
    s_add_u32 s74, s74, 196608
    v_sub_f32_e64 v22, v22, v27
    v_mfma_f32_16x16x32_bf16 a[80:83], a[232:235], a[192:195], a[80:83]
    v_cvt_pk_bf16_f32 v23, v23, v23
    v_lshlrev_b32 v23, 16, v23
    v_add_f32 v23, 0x3727c5ac, v23
    v_mfma_f32_16x16x32_bf16 a[80:83], a[236:239], a[196:199], a[80:83]
    v_mfma_f32_16x16x32_bf16 a[240:243], v[28:31], a[232:235], a[240:243]
    buffer_load_dwordx4 v10, s[8:11], s74 offen lds
    v_cvt_pk_bf16_f32 v23, v23, v23
    v_lshlrev_b32 v23, 16, v23
    v_mfma_f32_16x16x32_bf16 a[84:87], a[232:235], a[200:203], a[84:87]
    v_sqrt_f32 v23, v23
    v_cvt_pk_bf16_f32 v24, v22, v22
    v_mfma_f32_16x16x32_bf16 a[84:87], a[236:239], a[204:207], a[84:87]
    v_cvt_pk_bf16_f32 v25, v22, v22
    v_cvt_pk_bf16_f32 v22, v23, v23
    v_lshlrev_b32 v23, 16, v22
    v_mfma_f32_16x16x32_bf16 a[88:91], a[232:235], a[208:211], a[88:91]
    v_lshrrev_b32 v14, 6, v13
    v_mfma_f32_16x16x32_bf16 a[88:91], a[236:239], a[212:215], a[88:91]
    v_lshrrev_b32 v15, 4, v13
    v_mfma_f32_16x16x32_bf16 a[92:95], a[232:235], a[216:219], a[92:95]
    v_lshrrev_b32 v16, 8, v13
    v_mfma_f32_16x16x32_bf16 a[92:95], a[236:239], a[220:223], a[92:95]
    s_mov_b32 exec_lo, 1
    s_mov_b32 exec_hi, 1
    buffer_store_dwordx2 v[24:25], v14, s[20:23], s85 offen sc1
    buffer_store_dword v23, v15, s[20:23], s99 offen sc1
    buffer_store_short v22, v16, s[20:23], s100 offen sc1
    s_mov_b64 exec, -1
    buffer_store_dwordx4 a[240:243], v13, s[20:23], s70 offen sc1
    s_branch L_next0
.p2align 12
L_type1:
    s_lshl_b32 s70, s48, 7
    s_lshl_b32 s71, s51, 7
    s_add_u32 s62, s71, s72
    s_mov_b32 s63, s62
    s_add_u32 s64, s62, 512
    s_mov_b32 s65, s64
    s_cmp_eq_u32 s44, 0
    s_cselect_b32 s70, s61, s62
    s_cselect_b32 s71, s61, s64
    s_cselect_b32 s72, 6, 7
    s_lshl_b32 s79, s72, 16
    s_lshl_b32 s72, s72, 10
    s_sub_u32 s71, s71, s70
    v_lshrrev_b32 v22, 2, v0
    s_and_b32 s73, s47, 3
    v_lshl_add_u32 v22, v22, 2, s73
    v_mul_lo_u32 v22, v22, s72
    v_bfe_u32 v23, v0, 1, 1
    v_mad_u32_u24 v22, v23, s71, v22
    v_add_u32 v22, s70, v22
    s_lshl_b32 s73, s47, 5
    s_add_u32 s73, s73, s49
    s_lshl_b32 s73, s73, 14
    v_lshrrev_b32 v23, 3, v0
    v_lshl_add_u32 v23, v23, 11, s73
    v_bfe_u32 v24, v0, 1, 2
    v_min_u32 v24, 1, v24
    v_lshl_add_u32 v23, v24, 7, v23
    s_lshr_b32 s70, s47, 2
    s_mul_i32 s69, s70, s79
    s_lshl_b32 s76, s79, 1
    s_mul_i32 s70, s69, 14
    s_add_u32 s76, s76, s70
    s_mul_i32 s70, s69, 9
    s_sub_u32 s77, s79, s70
    s_add_u32 s69, s69, s79
    s_cmp_ge_u32 s47, 5
    s_cselect_b32 s71, 7, 2
    s_mov_b32 s70, 2
    s_lshl_b32 s70, s70, 7
    s_lshl_b32 s71, s71, 7
    s_cmp_eq_u32 s44, 3
    s_cselect_b64 vcc, -1, 0
    s_cselect_b32 s69, 128, s69
    s_cselect_b32 s79, 256, s79
    s_cselect_b32 s76, s70, s76
    s_cselect_b32 s77, s71, s77
    s_cselect_b32 s3, 0x7ff, -1
    v_cndmask_b32 v28, v22, v23, vcc
    s_mov_b64 s[92:93], s[8:9]
    s_mov_b32 s94, s10
    s_cmp_ge_u32 s44, 1
    s_cselect_b64 s[92:93], s[12:13], s[92:93]
    s_cselect_b32 s94, s14, s94
    s_cmp_ge_u32 s44, 2
    s_cselect_b64 s[92:93], s[16:17], s[92:93]
    s_cselect_b32 s94, s18, s94
    s_cmp_ge_u32 s44, 3
    s_cselect_b64 s[92:93], s[4:5], s[92:93]
    s_cselect_b32 s94, s6, s94
    s_mov_b32 s95, 0x00020000
    s_lshl_b32 s70, s45, 2
    v_add_u32 v22, s70, v15
    v_bfe_u32 v23, v0, 1, 3
    v_xor_b32 v22, v22, v23
    v_and_b32 v23, 15, v0
    v_lshlrev_b32 v23, 7, v23
    v_lshl_add_u32 v22, v22, 4, v23
    s_lshl_b32 s70, s45, 14
    s_add_u32 s70, s70, 81920
    v_add_u32 v1, s70, v22
    v_xor_b32 v2, 64, v1
    v_bfe_u32 v22, v0, 2, 2
    v_lshl_add_u32 v22, v15, 3, v22
    v_and_b32 v23, 3, v0
    v_lshlrev_b32 v23, 3, v23
    v_bfe_u32 v24, v0, 3, 2
    s_lshl_b32 s70, s46, 1
    v_xor_b32_e64 v24, s70, v24
    v_lshl_add_u32 v24, v24, 5, v23
    v_lshl_add_u32 v24, v22, 7, v24
    s_mul_i32 s70, s45, 40960
    s_sub_u32 s71, 40960, s70
    v_add_u32 v3, s70, v24
    v_add_u32 v5, s71, v24
    v_xor_b32 v4, 32, v3
    v_xor_b32 v6, 32, v5
    v_and_b32 v25, 1, v15
    v_xor_b32 v25, s46, v25
    v_lshl_add_u32 v25, v25, 5, v23
    v_lshl_add_u32 v25, v22, 6, v25
    v_add_u32 v7, s70, v25
    v_add_u32 v8, s71, v25
    s_cmp_ge_u32 s47, 5
    s_cselect_b32 s70, 3, 0
    s_sub_u32 s54, s47, s70
    s_lshl1_add_u32 s60, s70, 4
    s_lshl_b32 s57, s60, 7
    s_mov_b32 s58, 1179648
    s_mov_b32 s59, 1376256
    s_mov_b32 s53, 1
    s_cmp_eq_u32 s44, 0
    s_cselect_b32 s70, 5, 1
    s_lshl_b32 s70, s70, s54
    s_or_b32 s56, s70, 0x90
    v_mov_b32 v0, v28
    v_and_b32 v14, 0xf0, v13
    v_cmp_eq_u32 vcc, 0x90, v14
    v_mov_b32 v14, 0x3f803f80
    s_nop 0
    v_cndmask_b32 v28, 0, v14, vcc
    v_cndmask_b32 v29, 0, v14, vcc
    v_cndmask_b32 v30, 0, v14, vcc
    v_cndmask_b32 v31, 0, v14, vcc
    v_mov_b32 v26, 0
    s_add_u32 m0, s66, 4096
    s_add_u32 s74, s62, 0
    buffer_load_dwordx4 v11, s[12:15], s74 offen lds
    s_add_u32 m0, s66, 45056
    s_add_u32 s74, s74, 229376
    buffer_load_dwordx4 v11, s[12:15], s74 offen lds
    s_add_u32 m0, s66, 8192
    s_add_u32 s74, s63, 0
    buffer_load_dwordx4 v11, s[16:19], s74 offen lds
    s_add_u32 m0, s66, 49152
    s_add_u32 s74, s74, 229376
    buffer_load_dwordx4 v11, s[16:19], s74 offen lds
    buffer_load_dword a254, v0, s[92:95], s69 offen
    s_add_u32 s69, s69, s76
    s_and_b32 s69, s69, s3
    s_mov_b64 exec, 0
    s_cmp_eq_u32 s44, 0
    s_cbranch_scc1 L_chain1_0
    s_cmp_eq_u32 s44, 1
    s_cbranch_scc1 L_chain1_1
    s_cmp_eq_u32 s44, 2
    s_cbranch_scc1 L_chain1_2
    s_branch L_chain1_3
L_back1:
    s_mov_b64 exec, -1
    s_waitcnt vmcnt(5)
    s_barrier
    s_nop 0
    ds_read_b64_tr_b16 a[224:225], v3
    ds_read_b64_tr_b16 a[226:227], v3 offset:512
    ds_read_b64_tr_b16 a[228:229], v5
    ds_read_b64_tr_b16 a[230:231], v5 offset:512
    ds_read_b128 a[96:99], v1
    ds_read_b128 a[100:103], v2
    ds_read_b128 a[104:107], v1 offset:2048
    ds_read_b128 a[108:111], v2 offset:2048
    ds_read_b128 a[112:115], v1 offset:4096
    ds_read_b128 a[116:119], v2 offset:4096
    ds_read_b128 a[120:123], v1 offset:6144
    ds_read_b128 a[124:127], v2 offset:6144
    ds_read_b128 a[128:131], v1 offset:8192
    ds_read_b128 a[132:135], v2 offset:8192
    ds_read_b128 a[136:139], v1 offset:10240
    ds_read_b128 a[140:143], v2 offset:10240
    ds_read_b128 a[144:147], v1 offset:12288
    ds_read_b128 a[148:151], v2 offset:12288
    ds_read_b128 a[152:155], v1 offset:14336
    ds_read_b128 a[156:159], v2 offset:14336
    s_cmp_eq_u32 s47, 0
    s_cbranch_scc1 L_first1
    s_waitcnt lgkmcnt(15)
    v_mfma_f32_16x16x32_bf16 a[0:3], a[224:227], a[96:99], 0
    ds_read_b64_tr_b16 a[232:233], v4
    s_add_u32 m0, s66, 12288
    s_waitcnt lgkmcnt(15)
    v_mfma_f32_16x16x32_bf16 a[0:3], a[228:231], a[100:103], a[0:3]
    ds_read_b64_tr_b16 a[234:235], v4 offset:512
    s_add_u32 s74, s64, 0
    s_waitcnt lgkmcnt(15)
    v_mfma_f32_16x16x32_bf16 a[4:7], a[224:227], a[104:107], 0
    ds_read_b64_tr_b16 a[236:237], v6
    buffer_load_dwordx4 v11, s[12:15], s74 offen lds
    s_waitcnt lgkmcnt(15)
    v_mfma_f32_16x16x32_bf16 a[4:7], a[228:231], a[108:111], a[4:7]
    ds_read_b64_tr_b16 a[238:239], v6 offset:512
    s_waitcnt lgkmcnt(15)
    v_mfma_f32_16x16x32_bf16 a[8:11], a[224:227], a[112:115], 0
    s_add_u32 m0, s66, 53248
    s_add_u32 s74, s74, 229376
    s_lshl2_add_u32 s70, s47, s50
    s_waitcnt lgkmcnt(14)
    v_mfma_f32_16x16x32_bf16 a[8:11], a[228:231], a[116:119], a[8:11]
    buffer_load_dwordx4 v11, s[12:15], s74 offen lds
    s_lshl_b32 s70, s70, 7
    s_waitcnt lgkmcnt(13)
    v_mfma_f32_16x16x32_bf16 a[12:15], a[224:227], a[120:123], 0
    s_waitcnt lgkmcnt(12)
    v_mfma_f32_16x16x32_bf16 a[12:15], a[228:231], a[124:127], a[12:15]
    s_lshl2_add_u32 s70, s51, s70
    s_waitcnt lgkmcnt(11)
    v_mfma_f32_16x16x32_bf16 a[16:19], a[224:227], a[128:131], 0
    s_add_u32 s81, s70, 34148352
    s_waitcnt lgkmcnt(10)
    v_mfma_f32_16x16x32_bf16 a[16:19], a[228:231], a[132:135], a[16:19]
    s_waitcnt lgkmcnt(9)
    v_mfma_f32_16x16x32_bf16 a[20:23], a[224:227], a[136:139], 0
    s_add_u32 m0, s66, 16384
    s_add_u32 s74, s65, 0
    buffer_load_dwordx4 v11, s[16:19], s74 offen lds
    s_waitcnt lgkmcnt(8)
    v_mfma_f32_16x16x32_bf16 a[20:23], a[228:231], a[140:143], a[20:23]
    s_lshl_b32 s70, s47, 7
    s_waitcnt lgkmcnt(7)
    v_mfma_f32_16x16x32_bf16 a[24:27], a[224:227], a[144:147], 0
    s_lshl2_add_u32 s70, s48, s70
    s_waitcnt lgkmcnt(6)
    v_mfma_f32_16x16x32_bf16 a[24:27], a[228:231], a[148:151], a[24:27]
    s_add_u32 s82, s70, 34160640
    s_waitcnt lgkmcnt(5)
    v_mfma_f32_16x16x32_bf16 a[28:31], a[224:227], a[152:155], 0
    s_waitcnt lgkmcnt(4)
    v_mfma_f32_16x16x32_bf16 a[28:31], a[228:231], a[156:159], a[28:31]
    s_waitcnt vmcnt(6) lgkmcnt(0)
    s_barrier
    v_mfma_f32_16x16x32_bf16 a[32:35], a[232:235], a[96:99], 0
    ds_read_b64_tr_b16 a[224:225], v3 offset:4096
    v_mfma_f32_16x16x32_bf16 a[32:35], a[236:239], a[100:103], a[32:35]
    ds_read_b64_tr_b16 a[226:227], v3 offset:4608
    v_mfma_f32_16x16x32_bf16 a[36:39], a[232:235], a[104:107], 0
    ds_read_b64_tr_b16 a[228:229], v5 offset:4096
    v_mfma_f32_16x16x32_bf16 a[36:39], a[236:239], a[108:111], a[36:39]
    ds_read_b64_tr_b16 a[230:231], v5 offset:4608
    v_mfma_f32_16x16x32_bf16 a[40:43], a[232:235], a[112:115], 0
    s_add_u32 m0, s66, 57344
    s_add_u32 s74, s74, 229376
    buffer_load_dwordx4 v11, s[16:19], s74 offen lds
    v_mfma_f32_16x16x32_bf16 a[40:43], a[236:239], a[116:119], a[40:43]
    s_lshl_b32 s70, s48, 7
    s_lshl2_add_u32 s70, s47, s70
    s_add_u32 s83, s70, 34156544
    v_mfma_f32_16x16x32_bf16 a[44:47], a[232:235], a[120:123], 0
    s_add_u32 m0, s67, 32768
    s_mov_b32 s74, 128
    s_lshl_b32 s70, s2, 7
    v_mfma_f32_16x16x32_bf16 a[44:47], a[236:239], a[124:127], a[44:47]
    buffer_load_dwordx4 v9, s[4:7], s74 offen lds
    s_lshl2_add_u32 s70, s44, s70
    s_add_u32 s84, s70, 34177024
    v_mfma_f32_16x16x32_bf16 a[48:51], a[232:235], a[128:131], 0
    v_mfma_f32_16x16x32_bf16 a[48:51], a[236:239], a[132:135], a[48:51]
    s_and_b32 s70, s2, 31
    v_mfma_f32_16x16x32_bf16 a[52:55], a[232:235], a[136:139], 0
    s_lshl_b32 s70, s70, 7
    v_mfma_f32_16x16x32_bf16 a[52:55], a[236:239], a[140:143], a[52:55]
    v_mfma_f32_16x16x32_bf16 a[56:59], a[232:235], a[144:147], 0
    s_add_u32 m0, s67, 34816
    s_mov_b32 s74, 32896
    buffer_load_dwordx4 v9, s[4:7], s74 offen lds
    v_mfma_f32_16x16x32_bf16 a[56:59], a[236:239], a[148:151], a[56:59]
    s_lshl2_add_u32 s70, s47, s70
    v_mfma_f32_16x16x32_bf16 a[60:63], a[232:235], a[152:155], 0
    s_add_u32 s50, s70, 34164736
    v_mfma_f32_16x16x32_bf16 a[60:63], a[236:239], a[156:159], a[60:63]
    s_lshl_b32 s70, s2, 3
    s_waitcnt lgkmcnt(0)
    v_mfma_f32_16x16x32_bf16 v[32:35], a[224:227], a[96:99], 0
    ds_read_b64_tr_b16 a[232:233], v4 offset:4096
    v_mfma_f32_16x16x32_bf16 v[32:35], a[228:231], a[100:103], v[32:35]
    ds_read_b64_tr_b16 a[234:235], v4 offset:4608
    s_add_u32 m0, s67, 36864
    v_mfma_f32_16x16x32_bf16 v[36:39], a[224:227], a[104:107], 0
    ds_read_b64_tr_b16 a[236:237], v6 offset:4096
    s_mov_b32 s74, 65664
    v_mfma_f32_16x16x32_bf16 v[36:39], a[228:231], a[108:111], v[36:39]
    ds_read_b64_tr_b16 a[238:239], v6 offset:4608
    buffer_load_dwordx4 v9, s[4:7], s74 offen lds
    v_mfma_f32_16x16x32_bf16 v[40:43], a[224:227], a[112:115], 0
    s_lshl1_add_u32 s70, s44, s70
    s_lshl_b32 s101, s70, 11
    s_lshl_b32 s71, s70, 3
    v_mfma_f32_16x16x32_bf16 v[40:43], a[228:231], a[116:119], v[40:43]
    v_mfma_f32_16x16x32_bf16 v[44:47], a[224:227], a[120:123], 0
    s_add_u32 s85, s71, 34111488
    v_mfma_f32_16x16x32_bf16 v[44:47], a[228:231], a[124:127], v[44:47]
    s_add_u32 m0, s67, 38912
    s_mov_b32 s74, 98432
    buffer_load_dwordx4 v9, s[4:7], s74 offen lds
    v_mfma_f32_16x16x32_bf16 v[48:51], a[224:227], a[128:131], 0
    s_lshr_b32 s71, s70, 7
    v_mfma_f32_16x16x32_bf16 v[48:51], a[228:231], a[132:135], v[48:51]
    s_lshl_b32 s71, s71, 4
    v_mfma_f32_16x16x32_bf16 v[52:55], a[224:227], a[136:139], 0
    v_mfma_f32_16x16x32_bf16 v[52:55], a[228:231], a[140:143], v[52:55]
    s_and_b32 s72, s70, 15
    v_mfma_f32_16x16x32_bf16 v[56:59], a[224:227], a[144:147], 0
    v_mfma_f32_16x16x32_bf16 v[56:59], a[228:231], a[148:151], v[56:59]
    s_add_u32 m0, s67, 40960
    s_mov_b32 s74, 131200
    buffer_load_dwordx4 v9, s[4:7], s74 offen lds
    v_mfma_f32_16x16x32_bf16 v[60:63], a[224:227], a[152:155], 0
    s_add_u32 s71, s71, s72
    s_bfe_u32 s72, s70, 0x30004
    v_mfma_f32_16x16x32_bf16 v[60:63], a[228:231], a[156:159], v[60:63]
    s_waitcnt vmcnt(10) lgkmcnt(0)
    s_barrier
    v_mfma_f32_16x16x32_bf16 v[64:67], a[232:235], a[96:99], 0
    ds_read_b64_tr_b16 a[224:225], v3 offset:8192
    v_mfma_f32_16x16x32_bf16 v[64:67], a[236:239], a[100:103], v[64:67]
    ds_read_b64_tr_b16 a[226:227], v3 offset:8704
    v_mfma_f32_16x16x32_bf16 v[68:71], a[232:235], a[104:107], 0
    ds_read_b64_tr_b16 a[228:229], v5 offset:8192
    v_mfma_f32_16x16x32_bf16 v[68:71], a[236:239], a[108:111], v[68:71]
    ds_read_b64_tr_b16 a[230:231], v5 offset:8704
    v_mfma_f32_16x16x32_bf16 v[72:75], a[232:235], a[112:115], 0
    s_add_u32 m0, s67, 43008
    s_mov_b32 s74, 163968
    buffer_load_dwordx4 v9, s[4:7], s74 offen lds
    v_mfma_f32_16x16x32_bf16 v[72:75], a[236:239], a[116:119], v[72:75]
    s_lshl3_add_u32 s71, s71, s72
    s_lshl_b32 s71, s71, 2
    s_add_u32 s99, s71, 34086912
    v_mfma_f32_16x16x32_bf16 v[76:79], a[232:235], a[120:123], 0
    s_lshr_b32 s71, s70, 5
    s_bfe_u32 s72, s70, 0x20002
    v_mfma_f32_16x16x32_bf16 v[76:79], a[236:239], a[124:127], v[76:79]
    v_mfma_f32_16x16x32_bf16 v[80:83], a[232:235], a[128:131], 0
    s_lshl2_add_u32 s71, s71, s72
    v_mfma_f32_16x16x32_bf16 v[80:83], a[236:239], a[132:135], v[80:83]
    s_add_u32 m0, s67, 45056
    s_mov_b32 s74, 196736
    buffer_load_dwordx4 v9, s[4:7], s74 offen lds
    v_mfma_f32_16x16x32_bf16 v[84:87], a[232:235], a[136:139], 0
    s_bfe_u32 s72, s70, 0x10004
    v_mfma_f32_16x16x32_bf16 v[84:87], a[236:239], a[140:143], v[84:87]
    s_lshl1_add_u32 s71, s71, s72
    v_mfma_f32_16x16x32_bf16 v[88:91], a[232:235], a[144:147], 0
    v_mfma_f32_16x16x32_bf16 v[88:91], a[236:239], a[148:151], v[88:91]
    s_and_b32 s72, s70, 3
    v_mfma_f32_16x16x32_bf16 v[92:95], a[232:235], a[152:155], 0
    s_add_u32 m0, s67, 47104
    s_mov_b32 s74, 229504
    buffer_load_dwordx4 v9, s[4:7], s74 offen lds
    v_mfma_f32_16x16x32_bf16 v[92:95], a[236:239], a[156:159], v[92:95]
    s_lshl2_add_u32 s71, s71, s72
    s_waitcnt lgkmcnt(0)
    v_mfma_f32_16x16x32_bf16 v[96:99], a[224:227], a[96:99], 0
    ds_read_b64_tr_b16 a[232:233], v4 offset:8192
    s_lshl_b32 s71, s71, 1
    v_mfma_f32_16x16x32_bf16 v[96:99], a[228:231], a[100:103], v[96:99]
    ds_read_b64_tr_b16 a[234:235], v4 offset:8704
    v_mfma_f32_16x16x32_bf16 v[100:103], a[224:227], a[104:107], 0
    ds_read_b64_tr_b16 a[236:237], v6 offset:8192
    s_add_u32 s100, s71, 34095104
    v_mfma_f32_16x16x32_bf16 v[100:103], a[228:231], a[108:111], v[100:103]
    ds_read_b64_tr_b16 a[238:239], v6 offset:8704
    v_mfma_f32_16x16x32_bf16 v[104:107], a[224:227], a[112:115], 0
    s_add_u32 m0, s66, 20480
    s_add_u32 s74, s61, 393216
    buffer_load_dwordx4 v10, s[8:11], s74 offen lds
    v_mfma_f32_16x16x32_bf16 v[104:107], a[228:231], a[116:119], v[104:107]
    v_mfma_f32_16x16x32_bf16 v[108:111], a[224:227], a[120:123], 0
    v_mfma_f32_16x16x32_bf16 v[108:111], a[228:231], a[124:127], v[108:111]
    v_mfma_f32_16x16x32_bf16 v[112:115], a[224:227], a[128:131], 0
    v_mfma_f32_16x16x32_bf16 v[112:115], a[228:231], a[132:135], v[112:115]
    v_mfma_f32_16x16x32_bf16 v[116:119], a[224:227], a[136:139], 0
    s_add_u32 m0, s66, 61440
    s_add_u32 s74, s74, 196608
    buffer_load_dwordx4 v10, s[8:11], s74 offen lds
    v_mfma_f32_16x16x32_bf16 v[116:119], a[228:231], a[140:143], v[116:119]
    v_mfma_f32_16x16x32_bf16 v[120:123], a[224:227], a[144:147], 0
    v_mfma_f32_16x16x32_bf16 v[120:123], a[228:231], a[148:151], v[120:123]
    v_mfma_f32_16x16x32_bf16 v[124:127], a[224:227], a[152:155], 0
    v_mfma_f32_16x16x32_bf16 v[124:127], a[228:231], a[156:159], v[124:127]
    s_waitcnt vmcnt(12) lgkmcnt(0)
    s_barrier
    v_mfma_f32_16x16x32_bf16 v[128:131], a[232:235], a[96:99], 0
    ds_read_b64_tr_b16 a[224:225], v3 offset:12288
    v_mfma_f32_16x16x32_bf16 v[128:131], a[236:239], a[100:103], v[128:131]
    ds_read_b64_tr_b16 a[226:227], v3 offset:12800
    v_mfma_f32_16x16x32_bf16 v[132:135], a[232:235], a[104:107], 0
    ds_read_b64_tr_b16 a[228:229], v5 offset:12288
    v_mfma_f32_16x16x32_bf16 v[132:135], a[236:239], a[108:111], v[132:135]
    ds_read_b64_tr_b16 a[230:231], v5 offset:12800
    v_mfma_f32_16x16x32_bf16 v[136:139], a[232:235], a[112:115], 0
    s_add_u32 m0, s66, 24576
    s_add_u32 s74, s62, 458752
    buffer_load_dwordx4 v11, s[12:15], s74 offen lds
    v_mfma_f32_16x16x32_bf16 v[136:139], a[236:239], a[116:119], v[136:139]
    v_mfma_f32_16x16x32_bf16 v[140:143], a[232:235], a[120:123], 0
    s_add_u32 m0, s66, 65536
    s_add_u32 s74, s74, 229376
    v_mfma_f32_16x16x32_bf16 v[140:143], a[236:239], a[124:127], v[140:143]
    buffer_load_dwordx4 v11, s[12:15], s74 offen lds
    v_mfma_f32_16x16x32_bf16 v[144:147], a[232:235], a[128:131], 0
    v_mfma_f32_16x16x32_bf16 v[144:147], a[236:239], a[132:135], v[144:147]
    v_mfma_f32_16x16x32_bf16 v[148:151], a[232:235], a[136:139], 0
    v_mfma_f32_16x16x32_bf16 v[148:151], a[236:239], a[140:143], v[148:151]
    s_add_u32 m0, s66, 28672
    s_add_u32 s74, s63, 458752
    buffer_load_dwordx4 v11, s[16:19], s74 offen lds
    v_mfma_f32_16x16x32_bf16 v[152:155], a[232:235], a[144:147], 0
    v_mfma_f32_16x16x32_bf16 v[152:155], a[236:239], a[148:151], v[152:155]
    v_mfma_f32_16x16x32_bf16 v[156:159], a[232:235], a[152:155], 0
    v_mfma_f32_16x16x32_bf16 v[156:159], a[236:239], a[156:159], v[156:159]
    s_waitcnt lgkmcnt(0)
    v_mfma_f32_16x16x32_bf16 v[160:163], a[224:227], a[96:99], 0
    ds_read_b64_tr_b16 a[232:233], v4 offset:12288
    v_mfma_f32_16x16x32_bf16 v[160:163], a[228:231], a[100:103], v[160:163]
    ds_read_b64_tr_b16 a[234:235], v4 offset:12800
    s_add_u32 m0, s66, 69632
    v_mfma_f32_16x16x32_bf16 v[164:167], a[224:227], a[104:107], 0
    ds_read_b64_tr_b16 a[236:237], v6 offset:12288
    s_add_u32 s74, s74, 229376
    v_mfma_f32_16x16x32_bf16 v[164:167], a[228:231], a[108:111], v[164:167]
    ds_read_b64_tr_b16 a[238:239], v6 offset:12800
    buffer_load_dwordx4 v11, s[16:19], s74 offen lds
    v_mfma_f32_16x16x32_bf16 v[168:171], a[224:227], a[112:115], 0
    v_mfma_f32_16x16x32_bf16 v[168:171], a[228:231], a[116:119], v[168:171]
    v_mfma_f32_16x16x32_bf16 v[172:175], a[224:227], a[120:123], 0
    v_mfma_f32_16x16x32_bf16 v[172:175], a[228:231], a[124:127], v[172:175]
    s_add_u32 m0, s67, 0
    s_mov_b32 s74, 256
    buffer_load_dwordx4 v9, s[4:7], s74 offen lds
    v_mfma_f32_16x16x32_bf16 v[176:179], a[224:227], a[128:131], 0
    v_mfma_f32_16x16x32_bf16 v[176:179], a[228:231], a[132:135], v[176:179]
    v_mfma_f32_16x16x32_bf16 v[180:183], a[224:227], a[136:139], 0
    v_mfma_f32_16x16x32_bf16 v[180:183], a[228:231], a[140:143], v[180:183]
    v_mfma_f32_16x16x32_bf16 v[184:187], a[224:227], a[144:147], 0
    v_mfma_f32_16x16x32_bf16 v[184:187], a[228:231], a[148:151], v[184:187]
    s_add_u32 m0, s67, 2048
    s_mov_b32 s74, 33024
    buffer_load_dwordx4 v9, s[4:7], s74 offen lds
    v_mfma_f32_16x16x32_bf16 v[188:191], a[224:227], a[152:155], 0
    v_mfma_f32_16x16x32_bf16 v[188:191], a[228:231], a[156:159], v[188:191]
    s_waitcnt vmcnt(11) lgkmcnt(0)
    s_barrier
    v_mfma_f32_16x16x32_bf16 v[192:195], a[232:235], a[96:99], 0
    ds_read_b64_tr_b16 a[224:225], v3 offset:16384
    v_mfma_f32_16x16x32_bf16 v[192:195], a[236:239], a[100:103], v[192:195]
    ds_read_b64_tr_b16 a[226:227], v3 offset:16896
    v_mfma_f32_16x16x32_bf16 v[196:199], a[232:235], a[104:107], 0
    ds_read_b64_tr_b16 a[228:229], v5 offset:16384
    v_mfma_f32_16x16x32_bf16 v[196:199], a[236:239], a[108:111], v[196:199]
    ds_read_b64_tr_b16 a[230:231], v5 offset:16896
    v_mfma_f32_16x16x32_bf16 v[200:203], a[232:235], a[112:115], 0
    ds_read_b128 a[160:163], v1 offset:32768
    v_mfma_f32_16x16x32_bf16 v[200:203], a[236:239], a[116:119], v[200:203]
    ds_read_b128 a[164:167], v2 offset:32768
    v_mfma_f32_16x16x32_bf16 v[204:207], a[232:235], a[120:123], 0
    ds_read_b128 a[168:171], v1 offset:34816
    v_mfma_f32_16x16x32_bf16 v[204:207], a[236:239], a[124:127], v[204:207]
    ds_read_b128 a[172:175], v2 offset:34816
    v_mfma_f32_16x16x32_bf16 v[208:211], a[232:235], a[128:131], 0
    ds_read_b128 a[176:179], v1 offset:36864
    buffer_load_dword a254, v0, s[92:95], s69 offen
    v_mfma_f32_16x16x32_bf16 v[208:211], a[236:239], a[132:135], v[208:211]
    s_add_u32 s69, s69, s77
    s_and_b32 s69, s69, s3
    s_add_u32 m0, s67, 4096
    v_mfma_f32_16x16x32_bf16 v[212:215], a[232:235], a[136:139], 0
    s_mov_b32 s74, 65792
    buffer_load_dwordx4 v9, s[4:7], s74 offen lds
    v_mfma_f32_16x16x32_bf16 v[212:215], a[236:239], a[140:143], v[212:215]
    v_mfma_f32_16x16x32_bf16 v[216:219], a[232:235], a[144:147], 0
    v_mfma_f32_16x16x32_bf16 v[216:219], a[236:239], a[148:151], v[216:219]
    v_mfma_f32_16x16x32_bf16 v[220:223], a[232:235], a[152:155], 0
    s_add_u32 m0, s66, 32768
    s_add_u32 s74, s64, 458752
    buffer_load_dwordx4 v11, s[12:15], s74 offen lds
    v_mfma_f32_16x16x32_bf16 v[220:223], a[236:239], a[156:159], v[220:223]
    s_waitcnt lgkmcnt(5)
    v_mfma_f32_16x16x32_bf16 v[224:227], a[224:227], a[96:99], 0
    ds_read_b64_tr_b16 a[232:233], v4 offset:16384
    v_mfma_f32_16x16x32_bf16 v[224:227], a[228:231], a[100:103], v[224:227]
    ds_read_b64_tr_b16 a[234:235], v4 offset:16896
    v_mfma_f32_16x16x32_bf16 v[228:231], a[224:227], a[104:107], 0
    ds_read_b64_tr_b16 a[236:237], v6 offset:16384
    v_mfma_f32_16x16x32_bf16 v[228:231], a[228:231], a[108:111], v[228:231]
    ds_read_b64_tr_b16 a[238:239], v6 offset:16896
    v_mfma_f32_16x16x32_bf16 v[232:235], a[224:227], a[112:115], 0
    ds_read_b128 a[180:183], v2 offset:36864
    s_add_u32 m0, s66, 73728
    v_mfma_f32_16x16x32_bf16 v[232:235], a[228:231], a[116:119], v[232:235]
    ds_read_b128 a[184:187], v1 offset:38912
    s_add_u32 s74, s74, 229376
    v_mfma_f32_16x16x32_bf16 v[236:239], a[224:227], a[120:123], 0
    ds_read_b128 a[188:191], v2 offset:38912
    buffer_load_dwordx4 v11, s[12:15], s74 offen lds
    v_mfma_f32_16x16x32_bf16 v[236:239], a[228:231], a[124:127], v[236:239]
    ds_read_b128 a[192:195], v1 offset:40960
    v_mfma_f32_16x16x32_bf16 v[240:243], a[224:227], a[128:131], 0
    ds_read_b128 a[196:199], v2 offset:40960
    v_mfma_f32_16x16x32_bf16 v[240:243], a[228:231], a[132:135], v[240:243]
    v_mfma_f32_16x16x32_bf16 v[244:247], a[224:227], a[136:139], 0
    s_add_u32 m0, s66, 36864
    s_add_u32 s74, s65, 458752
    buffer_load_dwordx4 v11, s[16:19], s74 offen lds
    v_mfma_f32_16x16x32_bf16 v[244:247], a[228:231], a[140:143], v[244:247]
    v_mfma_f32_16x16x32_bf16 v[248:251], a[224:227], a[144:147], 0
    v_mfma_f32_16x16x32_bf16 v[248:251], a[228:231], a[148:151], v[248:251]
    v_mfma_f32_16x16x32_bf16 v[252:255], a[224:227], a[152:155], 0
    v_mfma_f32_16x16x32_bf16 v[252:255], a[228:231], a[156:159], v[252:255]
    s_waitcnt vmcnt(11) lgkmcnt(0)
    s_barrier
    v_mfma_f32_16x16x32_bf16 a[64:67], a[232:235], a[96:99], 0
    ds_read_b64_tr_b16 a[224:225], v3 offset:20480
    v_mfma_f32_16x16x32_bf16 a[64:67], a[236:239], a[100:103], a[64:67]
    ds_read_b64_tr_b16 a[226:227], v3 offset:20992
    v_mfma_f32_16x16x32_bf16 a[68:71], a[232:235], a[104:107], 0
    ds_read_b64_tr_b16 a[228:229], v5 offset:20480
    v_mfma_f32_16x16x32_bf16 a[68:71], a[236:239], a[108:111], a[68:71]
    ds_read_b64_tr_b16 a[230:231], v5 offset:20992
    v_mfma_f32_16x16x32_bf16 a[72:75], a[232:235], a[112:115], 0
    ds_read_b128 a[200:203], v1 offset:43008
    v_mfma_f32_16x16x32_bf16 a[72:75], a[236:239], a[116:119], a[72:75]
    ds_read_b128 a[204:207], v2 offset:43008
    v_mfma_f32_16x16x32_bf16 a[76:79], a[232:235], a[120:123], 0
    ds_read_b128 a[208:211], v1 offset:45056
    v_mfma_f32_16x16x32_bf16 a[76:79], a[236:239], a[124:127], a[76:79]
    ds_read_b128 a[212:215], v2 offset:45056
    v_mfma_f32_16x16x32_bf16 a[80:83], a[232:235], a[128:131], 0
    ds_read_b128 a[216:219], v1 offset:47104
    s_add_u32 m0, s66, 77824
    v_mfma_f32_16x16x32_bf16 a[80:83], a[236:239], a[132:135], a[80:83]
    ds_read_b128 a[220:223], v2 offset:47104
    s_add_u32 s74, s74, 229376
    v_mfma_f32_16x16x32_bf16 a[84:87], a[232:235], a[136:139], 0
    buffer_load_dwordx4 v11, s[16:19], s74 offen lds
    s_add_u32 m0, s67, 6144
    s_mov_b32 s74, 98560
    v_mfma_f32_16x16x32_bf16 a[84:87], a[236:239], a[140:143], a[84:87]
    s_cmp_eq_u32 s46, 0
    s_cselect_b32 s70, s81, s82
    s_cselect_b32 s71, s83, s50
    s_cmp_eq_u32 s45, 0
    s_cselect_b32 s70, s70, s71
    s_mov_b64 exec, 1
    buffer_store_dword v26, off, s[20:23], s70 sc1
    buffer_store_dword v26, off, s[20:23], s84 sc1
    s_mov_b64 exec, -1
    v_mfma_f32_16x16x32_bf16 a[88:91], a[232:235], a[144:147], 0
    v_mfma_f32_16x16x32_bf16 a[88:91], a[236:239], a[148:151], a[88:91]
    buffer_load_dwordx4 v9, s[4:7], s74 offen lds
    s_add_u32 m0, s67, 8192
    s_mov_b32 s74, 131328
    v_mfma_f32_16x16x32_bf16 a[92:95], a[232:235], a[152:155], 0
    v_mfma_f32_16x16x32_bf16 a[92:95], a[236:239], a[156:159], a[92:95]
    s_waitcnt lgkmcnt(0)
    v_mfma_f32_16x16x32_bf16 a[0:3], a[224:227], a[160:163], a[0:3]
    ds_read_b64_tr_b16 a[232:233], v4 offset:20480
    buffer_load_dwordx4 v9, s[4:7], s74 offen lds
    v_mfma_f32_16x16x32_bf16 a[0:3], a[228:231], a[164:167], a[0:3]
    ds_read_b64_tr_b16 a[234:235], v4 offset:20992
    s_add_u32 m0, s67, 10240
    v_mfma_f32_16x16x32_bf16 a[4:7], a[224:227], a[168:171], a[4:7]
    ds_read_b64_tr_b16 a[236:237], v6 offset:20480
    s_mov_b32 s74, 164096
    v_mfma_f32_16x16x32_bf16 a[4:7], a[228:231], a[172:175], a[4:7]
    ds_read_b64_tr_b16 a[238:239], v6 offset:20992
    buffer_load_dwordx4 v9, s[4:7], s74 offen lds
    v_mfma_f32_16x16x32_bf16 a[8:11], a[224:227], a[176:179], a[8:11]
    v_mfma_f32_16x16x32_bf16 a[8:11], a[228:231], a[180:183], a[8:11]
    v_mfma_f32_16x16x32_bf16 a[12:15], a[224:227], a[184:187], a[12:15]
    v_mfma_f32_16x16x32_bf16 a[12:15], a[228:231], a[188:191], a[12:15]
    s_add_u32 m0, s67, 12288
    s_mov_b32 s74, 196864
    buffer_load_dwordx4 v9, s[4:7], s74 offen lds
    v_mfma_f32_16x16x32_bf16 a[16:19], a[224:227], a[192:195], a[16:19]
    v_mfma_f32_16x16x32_bf16 a[16:19], a[228:231], a[196:199], a[16:19]
    v_mfma_f32_16x16x32_bf16 a[20:23], a[224:227], a[200:203], a[20:23]
    v_mfma_f32_16x16x32_bf16 a[20:23], a[228:231], a[204:207], a[20:23]
    v_mfma_f32_16x16x32_bf16 a[24:27], a[224:227], a[208:211], a[24:27]
    v_mfma_f32_16x16x32_bf16 a[24:27], a[228:231], a[212:215], a[24:27]
    s_add_u32 m0, s67, 14336
    s_mov_b32 s74, 229632
    buffer_load_dwordx4 v9, s[4:7], s74 offen lds
    v_mfma_f32_16x16x32_bf16 a[28:31], a[224:227], a[216:219], a[28:31]
    v_mfma_f32_16x16x32_bf16 a[28:31], a[228:231], a[220:223], a[28:31]
    s_waitcnt vmcnt(17) lgkmcnt(0)
    s_barrier
    v_mfma_f32_16x16x32_bf16 a[32:35], a[232:235], a[160:163], a[32:35]
    ds_read_b64_tr_b16 a[224:225], v3 offset:24576
    v_mfma_f32_16x16x32_bf16 a[32:35], a[236:239], a[164:167], a[32:35]
    ds_read_b64_tr_b16 a[226:227], v3 offset:25088
    v_mfma_f32_16x16x32_bf16 a[36:39], a[232:235], a[168:171], a[36:39]
    ds_read_b64_tr_b16 a[228:229], v5 offset:24576
    v_mfma_f32_16x16x32_bf16 a[36:39], a[236:239], a[172:175], a[36:39]
    ds_read_b64_tr_b16 a[230:231], v5 offset:25088
    v_mfma_f32_16x16x32_bf16 a[40:43], a[232:235], a[176:179], a[40:43]
    s_add_u32 m0, s66, 0
    s_add_u32 s74, s61, 786432
    buffer_load_dwordx4 v10, s[8:11], s74 offen lds
    v_mfma_f32_16x16x32_bf16 a[40:43], a[236:239], a[180:183], a[40:43]
    v_mfma_f32_16x16x32_bf16 a[44:47], a[232:235], a[184:187], a[44:47]
    v_mfma_f32_16x16x32_bf16 a[44:47], a[236:239], a[188:191], a[44:47]
    v_mfma_f32_16x16x32_bf16 a[48:51], a[232:235], a[192:195], a[48:51]
    s_add_u32 m0, s66, 40960
    s_add_u32 s74, s74, 196608
    buffer_load_dwordx4 v10, s[8:11], s74 offen lds
    v_mfma_f32_16x16x32_bf16 a[48:51], a[236:239], a[196:199], a[48:51]
    v_mfma_f32_16x16x32_bf16 a[52:55], a[232:235], a[200:203], a[52:55]
    v_mfma_f32_16x16x32_bf16 a[52:55], a[236:239], a[204:207], a[52:55]
    v_mfma_f32_16x16x32_bf16 a[56:59], a[232:235], a[208:211], a[56:59]
    v_mfma_f32_16x16x32_bf16 a[56:59], a[236:239], a[212:215], a[56:59]
    v_mfma_f32_16x16x32_bf16 a[60:63], a[232:235], a[216:219], a[60:63]
    s_add_u32 m0, s66, 4096
L_chain1_0:
L_pad1_0:
    s_cbranch_execz L_pad1_4
    s_add_u32 s74, s62, 917504
    buffer_load_dwordx4 v11, s[12:15], s74 offen lds
    v_mfma_f32_16x16x32_bf16 a[60:63], a[236:239], a[220:223], a[60:63]
    s_waitcnt lgkmcnt(0)
    v_mfma_f32_16x16x32_bf16 v[32:35], a[224:227], a[160:163], v[32:35]
    ds_read_b64_tr_b16 a[232:233], v4 offset:24576
    v_mfma_f32_16x16x32_bf16 v[32:35], a[228:231], a[164:167], v[32:35]
    ds_read_b64_tr_b16 a[234:235], v4 offset:25088
    v_mfma_f32_16x16x32_bf16 v[36:39], a[224:227], a[168:171], v[36:39]
    ds_read_b64_tr_b16 a[236:237], v6 offset:24576
    v_mfma_f32_16x16x32_bf16 v[36:39], a[228:231], a[172:175], v[36:39]
    ds_read_b64_tr_b16 a[238:239], v6 offset:25088
    v_mfma_f32_16x16x32_bf16 v[40:43], a[224:227], a[176:179], v[40:43]
    s_add_u32 m0, s66, 45056
    s_add_u32 s74, s74, 229376
    buffer_load_dwordx4 v11, s[12:15], s74 offen lds
    v_mfma_f32_16x16x32_bf16 v[40:43], a[228:231], a[180:183], v[40:43]
    v_mfma_f32_16x16x32_bf16 v[44:47], a[224:227], a[184:187], v[44:47]
    v_mfma_f32_16x16x32_bf16 v[44:47], a[228:231], a[188:191], v[44:47]
    v_mfma_f32_16x16x32_bf16 v[48:51], a[224:227], a[192:195], v[48:51]
    v_mfma_f32_16x16x32_bf16 v[48:51], a[228:231], a[196:199], v[48:51]
    v_mfma_f32_16x16x32_bf16 v[52:55], a[224:227], a[200:203], v[52:55]
    s_add_u32 m0, s66, 8192
    s_add_u32 s74, s63, 917504
    buffer_load_dwordx4 v11, s[16:19], s74 offen lds
    v_mfma_f32_16x16x32_bf16 v[52:55], a[228:231], a[204:207], v[52:55]
    v_mfma_f32_16x16x32_bf16 v[56:59], a[224:227], a[208:211], v[56:59]
    v_mfma_f32_16x16x32_bf16 v[56:59], a[228:231], a[212:215], v[56:59]
    v_mfma_f32_16x16x32_bf16 v[60:63], a[224:227], a[216:219], v[60:63]
    v_mfma_f32_16x16x32_bf16 v[60:63], a[228:231], a[220:223], v[60:63]
    s_waitcnt vmcnt(16) lgkmcnt(0)
    s_barrier
    v_mfma_f32_16x16x32_bf16 v[64:67], a[232:235], a[160:163], v[64:67]
    ds_read_b64_tr_b16 a[224:225], v3 offset:28672
    v_mfma_f32_16x16x32_bf16 v[64:67], a[236:239], a[164:167], v[64:67]
    ds_read_b64_tr_b16 a[226:227], v3 offset:29184
    v_mfma_f32_16x16x32_bf16 v[68:71], a[232:235], a[168:171], v[68:71]
    ds_read_b64_tr_b16 a[228:229], v5 offset:28672
    v_mfma_f32_16x16x32_bf16 v[68:71], a[236:239], a[172:175], v[68:71]
    ds_read_b64_tr_b16 a[230:231], v5 offset:29184
    v_mfma_f32_16x16x32_bf16 v[72:75], a[232:235], a[176:179], v[72:75]
    ds_read_b128 a[96:99], v1
    v_mfma_f32_16x16x32_bf16 v[72:75], a[236:239], a[180:183], v[72:75]
    ds_read_b128 a[100:103], v2
    v_mfma_f32_16x16x32_bf16 v[76:79], a[232:235], a[184:187], v[76:79]
    ds_read_b128 a[104:107], v1 offset:2048
    v_mfma_f32_16x16x32_bf16 v[76:79], a[236:239], a[188:191], v[76:79]
    s_add_u32 m0, s66, 49152
    s_add_u32 s74, s74, 229376
    buffer_load_dwordx4 v11, s[16:19], s74 offen lds
    v_mfma_f32_16x16x32_bf16 v[80:83], a[232:235], a[192:195], v[80:83]
    s_add_u32 m0, s66, 147456
    s_lshl2_add_u32 s73, s48, s44
    s_lshl_b32 s73, s73, 10
    v_mfma_f32_16x16x32_bf16 v[80:83], a[236:239], a[196:199], v[80:83]
    v_mfma_f32_16x16x32_bf16 v[84:87], a[232:235], a[200:203], v[84:87]
    buffer_load_dwordx4 v13, s[40:43], s73 offen lds
    v_mfma_f32_16x16x32_bf16 v[84:87], a[236:239], a[204:207], v[84:87]
    s_add_u32 m0, s67, 32768
    s_mov_b32 s74, 384
    v_mfma_f32_16x16x32_bf16 v[88:91], a[232:235], a[208:211], v[88:91]
    v_mfma_f32_16x16x32_bf16 v[88:91], a[236:239], a[212:215], v[88:91]
    buffer_load_dwordx4 v9, s[4:7], s74 offen lds
    v_mfma_f32_16x16x32_bf16 v[92:95], a[232:235], a[216:219], v[92:95]
    v_mfma_f32_16x16x32_bf16 v[92:95], a[236:239], a[220:223], v[92:95]
    s_waitcnt lgkmcnt(3)
    v_mfma_f32_16x16x32_bf16 v[96:99], a[224:227], a[160:163], v[96:99]
    ds_read_b64_tr_b16 a[232:233], v4 offset:28672
    v_mfma_f32_16x16x32_bf16 v[96:99], a[228:231], a[164:167], v[96:99]
    ds_read_b64_tr_b16 a[234:235], v4 offset:29184
    s_add_u32 m0, s67, 34816
    v_mfma_f32_16x16x32_bf16 v[100:103], a[224:227], a[168:171], v[100:103]
    ds_read_b64_tr_b16 a[236:237], v6 offset:28672
    s_mov_b32 s74, 33152
    v_mfma_f32_16x16x32_bf16 v[100:103], a[228:231], a[172:175], v[100:103]
    ds_read_b64_tr_b16 a[238:239], v6 offset:29184
    buffer_load_dwordx4 v9, s[4:7], s74 offen lds
    v_mfma_f32_16x16x32_bf16 v[104:107], a[224:227], a[176:179], v[104:107]
    ds_read_b128 a[108:111], v2 offset:2048
    v_mfma_f32_16x16x32_bf16 v[104:107], a[228:231], a[180:183], v[104:107]
    ds_read_b128 a[112:115], v1 offset:4096
    v_mfma_f32_16x16x32_bf16 v[108:111], a[224:227], a[184:187], v[108:111]
    ds_read_b128 a[116:119], v2 offset:4096
    v_mfma_f32_16x16x32_bf16 v[108:111], a[228:231], a[188:191], v[108:111]
    s_add_u32 m0, s67, 36864
    s_mov_b32 s74, 65920
    buffer_load_dwordx4 v9, s[4:7], s74 offen lds
    v_mfma_f32_16x16x32_bf16 v[112:115], a[224:227], a[192:195], v[112:115]
    v_mfma_f32_16x16x32_bf16 v[112:115], a[228:231], a[196:199], v[112:115]
    v_mfma_f32_16x16x32_bf16 v[116:119], a[224:227], a[200:203], v[116:119]
    v_mfma_f32_16x16x32_bf16 v[116:119], a[228:231], a[204:207], v[116:119]
    v_mfma_f32_16x16x32_bf16 v[120:123], a[224:227], a[208:211], v[120:123]
    s_add_u32 m0, s66, 12288
    s_add_u32 s74, s64, 917504
    buffer_load_dwordx4 v11, s[12:15], s74 offen lds
    v_mfma_f32_16x16x32_bf16 v[120:123], a[228:231], a[212:215], v[120:123]
    v_mfma_f32_16x16x32_bf16 v[124:127], a[224:227], a[216:219], v[124:127]
    v_mfma_f32_16x16x32_bf16 v[124:127], a[228:231], a[220:223], v[124:127]
    s_waitcnt vmcnt(11) lgkmcnt(0)
    s_barrier
    v_mfma_f32_16x16x32_bf16 v[128:131], a[232:235], a[160:163], v[128:131]
    ds_read_b64_tr_b16 a[224:225], v3 offset:32768
    v_mfma_f32_16x16x32_bf16 v[128:131], a[236:239], a[164:167], v[128:131]
    ds_read_b64_tr_b16 a[226:227], v3 offset:33280
    v_mfma_f32_16x16x32_bf16 v[132:135], a[232:235], a[168:171], v[132:135]
    ds_read_b64_tr_b16 a[228:229], v5 offset:32768
    v_mfma_f32_16x16x32_bf16 v[132:135], a[236:239], a[172:175], v[132:135]
    ds_read_b64_tr_b16 a[230:231], v5 offset:33280
    v_mfma_f32_16x16x32_bf16 v[136:139], a[232:235], a[176:179], v[136:139]
    ds_read_b128 a[120:123], v1 offset:6144
    v_mfma_f32_16x16x32_bf16 v[136:139], a[236:239], a[180:183], v[136:139]
    ds_read_b128 a[124:127], v2 offset:6144
    v_mfma_f32_16x16x32_bf16 v[140:143], a[232:235], a[184:187], v[140:143]
    ds_read_b128 a[128:131], v1 offset:8192
    v_mfma_f32_16x16x32_bf16 v[140:143], a[236:239], a[188:191], v[140:143]
    s_add_u32 m0, s66, 53248
    s_add_u32 s74, s74, 229376
    buffer_load_dwordx4 v11, s[12:15], s74 offen lds
    v_mfma_f32_16x16x32_bf16 v[144:147], a[232:235], a[192:195], v[144:147]
    s_add_u32 m0, s66, 16384
    s_add_u32 s74, s65, 917504
    v_mfma_f32_16x16x32_bf16 v[144:147], a[236:239], a[196:199], v[144:147]
    v_mfma_f32_16x16x32_bf16 v[148:151], a[232:235], a[200:203], v[148:151]
    buffer_load_dwordx4 v11, s[16:19], s74 offen lds
    s_mov_b32 s42, 0
    v_mfma_f32_16x16x32_bf16 v[148:151], a[236:239], a[204:207], v[148:151]
    v_mfma_f32_16x16x32_bf16 v[152:155], a[232:235], a[208:211], v[152:155]
    v_mfma_f32_16x16x32_bf16 v[152:155], a[236:239], a[212:215], v[152:155]
    v_mfma_f32_16x16x32_bf16 v[156:159], a[232:235], a[216:219], v[156:159]
    s_add_u32 m0, s66, 57344
    s_add_u32 s74, s74, 229376
    buffer_load_dwordx4 v11, s[16:19], s74 offen lds
    v_mfma_f32_16x16x32_bf16 v[156:159], a[236:239], a[220:223], v[156:159]
    s_waitcnt lgkmcnt(3)
    v_mfma_f32_16x16x32_bf16 v[160:163], a[224:227], a[160:163], v[160:163]
    ds_read_b64_tr_b16 a[232:233], v4 offset:32768
    v_mfma_f32_16x16x32_bf16 v[160:163], a[228:231], a[164:167], v[160:163]
    ds_read_b64_tr_b16 a[234:235], v4 offset:33280
    v_mfma_f32_16x16x32_bf16 v[164:167], a[224:227], a[168:171], v[164:167]
    ds_read_b64_tr_b16 a[236:237], v6 offset:32768
    v_mfma_f32_16x16x32_bf16 v[164:167], a[228:231], a[172:175], v[164:167]
    ds_read_b64_tr_b16 a[238:239], v6 offset:33280
    v_mfma_f32_16x16x32_bf16 v[168:171], a[224:227], a[176:179], v[168:171]
    ds_read_b128 a[132:135], v2 offset:8192
    s_add_u32 m0, s67, 38912
    v_mfma_f32_16x16x32_bf16 v[168:171], a[228:231], a[180:183], v[168:171]
    ds_read_b128 a[136:139], v1 offset:10240
    s_mov_b32 s74, 98688
    v_mfma_f32_16x16x32_bf16 v[172:175], a[224:227], a[184:187], v[172:175]
    ds_read_b128 a[140:143], v2 offset:10240
    buffer_load_dwordx4 v9, s[4:7], s74 offen lds
    v_mfma_f32_16x16x32_bf16 v[172:175], a[228:231], a[188:191], v[172:175]
    v_mfma_f32_16x16x32_bf16 v[176:179], a[224:227], a[192:195], v[176:179]
    v_mfma_f32_16x16x32_bf16 v[176:179], a[228:231], a[196:199], v[176:179]
    s_add_u32 m0, s67, 40960
    s_mov_b32 s74, 131456
    buffer_load_dwordx4 v9, s[4:7], s74 offen lds
    v_mfma_f32_16x16x32_bf16 v[180:183], a[224:227], a[200:203], v[180:183]
    v_mfma_f32_16x16x32_bf16 v[180:183], a[228:231], a[204:207], v[180:183]
    v_mfma_f32_16x16x32_bf16 v[184:187], a[224:227], a[208:211], v[184:187]
    v_mfma_f32_16x16x32_bf16 v[184:187], a[228:231], a[212:215], v[184:187]
    v_mfma_f32_16x16x32_bf16 v[188:191], a[224:227], a[216:219], v[188:191]
    v_mfma_f32_16x16x32_bf16 v[188:191], a[228:231], a[220:223], v[188:191]
    s_add_u32 m0, s67, 43008
    s_mov_b32 s74, 164224
    s_waitcnt lgkmcnt(3)
    v_mfma_f32_16x16x32_bf16 v[192:195], a[232:235], a[160:163], v[192:195]
    ds_read_b64_tr_b16 a[224:225], v3 offset:36864
    buffer_load_dwordx4 v9, s[4:7], s74 offen lds
    v_mfma_f32_16x16x32_bf16 v[192:195], a[236:239], a[164:167], v[192:195]
    ds_read_b64_tr_b16 a[226:227], v3 offset:37376
    v_mfma_f32_16x16x32_bf16 v[196:199], a[232:235], a[168:171], v[196:199]
    ds_read_b64_tr_b16 a[228:229], v5 offset:36864
    v_mfma_f32_16x16x32_bf16 v[196:199], a[236:239], a[172:175], v[196:199]
    ds_read_b64_tr_b16 a[230:231], v5 offset:37376
    v_mfma_f32_16x16x32_bf16 v[200:203], a[232:235], a[176:179], v[200:203]
    ds_read_b128 a[144:147], v1 offset:12288
    v_mfma_f32_16x16x32_bf16 v[200:203], a[236:239], a[180:183], v[200:203]
    ds_read_b128 a[148:151], v2 offset:12288
    s_add_u32 m0, s67, 45056
    v_mfma_f32_16x16x32_bf16 v[204:207], a[232:235], a[184:187], v[204:207]
    ds_read_b128 a[152:155], v1 offset:14336
    s_mov_b32 s74, 196992
    v_mfma_f32_16x16x32_bf16 v[204:207], a[236:239], a[188:191], v[204:207]
    buffer_load_dwordx4 v9, s[4:7], s74 offen lds
    v_mfma_f32_16x16x32_bf16 v[208:211], a[232:235], a[192:195], v[208:211]
    v_mfma_f32_16x16x32_bf16 v[208:211], a[236:239], a[196:199], v[208:211]
    v_mfma_f32_16x16x32_bf16 v[212:215], a[232:235], a[200:203], v[212:215]
    v_mfma_f32_16x16x32_bf16 v[212:215], a[236:239], a[204:207], v[212:215]
    s_add_u32 m0, s67, 47104
    s_mov_b32 s74, 229760
    buffer_load_dwordx4 v9, s[4:7], s74 offen lds
    v_mfma_f32_16x16x32_bf16 v[216:219], a[232:235], a[208:211], v[216:219]
    v_mfma_f32_16x16x32_bf16 v[216:219], a[236:239], a[212:215], v[216:219]
    v_mfma_f32_16x16x32_bf16 v[220:223], a[232:235], a[216:219], v[220:223]
    v_mfma_f32_16x16x32_bf16 v[220:223], a[236:239], a[220:223], v[220:223]
    s_waitcnt lgkmcnt(3)
    v_mfma_f32_16x16x32_bf16 v[224:227], a[224:227], a[160:163], v[224:227]
    ds_read_b64_tr_b16 a[232:233], v4 offset:36864
    v_mfma_f32_16x16x32_bf16 v[224:227], a[228:231], a[164:167], v[224:227]
    ds_read_b64_tr_b16 a[234:235], v4 offset:37376
    v_mfma_f32_16x16x32_bf16 v[228:231], a[224:227], a[168:171], v[228:231]
    ds_read_b64_tr_b16 a[236:237], v6 offset:36864
    v_mfma_f32_16x16x32_bf16 v[228:231], a[228:231], a[172:175], v[228:231]
    ds_read_b64_tr_b16 a[238:239], v6 offset:37376
    v_mfma_f32_16x16x32_bf16 v[232:235], a[224:227], a[176:179], v[232:235]
    ds_read_b128 a[156:159], v2 offset:14336
    v_mfma_f32_16x16x32_bf16 v[232:235], a[228:231], a[180:183], v[232:235]
    v_mfma_f32_16x16x32_bf16 v[236:239], a[224:227], a[184:187], v[236:239]
    v_mfma_f32_16x16x32_bf16 v[236:239], a[228:231], a[188:191], v[236:239]
    v_mfma_f32_16x16x32_bf16 v[240:243], a[224:227], a[192:195], v[240:243]
    v_mfma_f32_16x16x32_bf16 v[240:243], a[228:231], a[196:199], v[240:243]
    v_mfma_f32_16x16x32_bf16 v[244:247], a[224:227], a[200:203], v[244:247]
    v_mfma_f32_16x16x32_bf16 v[244:247], a[228:231], a[204:207], v[244:247]
    v_mfma_f32_16x16x32_bf16 v[248:251], a[224:227], a[208:211], v[248:251]
    v_mfma_f32_16x16x32_bf16 v[248:251], a[228:231], a[212:215], v[248:251]
    v_mfma_f32_16x16x32_bf16 v[252:255], a[224:227], a[216:219], v[252:255]
    v_mfma_f32_16x16x32_bf16 v[252:255], a[228:231], a[220:223], v[252:255]
    s_waitcnt vmcnt(9) lgkmcnt(0)
    s_barrier
    v_mfma_f32_16x16x32_bf16 a[64:67], a[232:235], a[160:163], a[64:67]
    ds_read_b64_tr_b16 a[224:225], v3
    v_mfma_f32_16x16x32_bf16 a[64:67], a[236:239], a[164:167], a[64:67]
    ds_read_b64_tr_b16 a[226:227], v3 offset:512
    v_mfma_f32_16x16x32_bf16 a[68:71], a[232:235], a[168:171], a[68:71]
    ds_read_b64_tr_b16 a[228:229], v5
    v_mfma_f32_16x16x32_bf16 a[68:71], a[236:239], a[172:175], a[68:71]
    ds_read_b64_tr_b16 a[230:231], v5 offset:512
    v_mfma_f32_16x16x32_bf16 a[72:75], a[232:235], a[176:179], a[72:75]
    s_add_u32 m0, s66, 20480
    s_add_u32 s74, s61, 1179648
    buffer_load_dwordx4 v10, s[8:11], s74 offen lds
    v_mfma_f32_16x16x32_bf16 a[72:75], a[236:239], a[180:183], a[72:75]
    s_add_u32 m0, s66, 61440
    s_add_u32 s74, s74, 196608
    v_mfma_f32_16x16x32_bf16 a[76:79], a[232:235], a[184:187], a[76:79]
    v_mfma_f32_16x16x32_bf16 a[76:79], a[236:239], a[188:191], a[76:79]
    buffer_load_dwordx4 v10, s[8:11], s74 offen lds
    v_mfma_f32_16x16x32_bf16 a[80:83], a[232:235], a[192:195], a[80:83]
    v_mfma_f32_16x16x32_bf16 a[80:83], a[236:239], a[196:199], a[80:83]
    v_mfma_f32_16x16x32_bf16 a[84:87], a[232:235], a[200:203], a[84:87]
    v_mfma_f32_16x16x32_bf16 a[84:87], a[236:239], a[204:207], a[84:87]
    v_mfma_f32_16x16x32_bf16 a[88:91], a[232:235], a[208:211], a[88:91]
    v_mfma_f32_16x16x32_bf16 a[88:91], a[236:239], a[212:215], a[88:91]
    v_mfma_f32_16x16x32_bf16 a[92:95], a[232:235], a[216:219], a[92:95]
    v_mfma_f32_16x16x32_bf16 a[92:95], a[236:239], a[220:223], a[92:95]
    s_branch L_next1
    .p2align 3
L_main1:
    s_waitcnt lgkmcnt(0)
    v_mfma_f32_16x16x32_bf16 a[0:3], a[224:227], a[96:99], a[0:3]
    ds_read_b64_tr_b16 a[232:233], v4
    v_mfma_f32_16x16x32_bf16 a[0:3], a[228:231], a[100:103], a[0:3]
    ds_read_b64_tr_b16 a[234:235], v4 offset:512
    v_mfma_f32_16x16x32_bf16 a[4:7], a[224:227], a[104:107], a[4:7]
    ds_read_b64_tr_b16 a[236:237], v6
    v_mfma_f32_16x16x32_bf16 a[4:7], a[228:231], a[108:111], a[4:7]
    ds_read_b64_tr_b16 a[238:239], v6 offset:512
    v_mfma_f32_16x16x32_bf16 a[8:11], a[224:227], a[112:115], a[8:11]
    ds_read_b128 a[160:163], v1 offset:32768
    v_mfma_f32_16x16x32_bf16 a[8:11], a[228:231], a[116:119], a[8:11]
    ds_read_b128 a[164:167], v2 offset:32768
    v_mfma_f32_16x16x32_bf16 a[12:15], a[224:227], a[120:123], a[12:15]
    v_mfma_f32_16x16x32_bf16 a[12:15], a[228:231], a[124:127], a[12:15]
    s_add_u32 m0, s66, 24576
    s_add_u32 s74, s62, s59
    v_mfma_f32_16x16x32_bf16 a[16:19], a[224:227], a[128:131], a[16:19]
    buffer_load_dwordx4 v11, s[12:15], s74 offen lds
    v_mfma_f32_16x16x32_bf16 a[16:19], a[228:231], a[132:135], a[16:19]
    buffer_load_dword a254, v0, s[92:95], s69 offen
    v_mfma_f32_16x16x32_bf16 a[20:23], a[224:227], a[136:139], a[20:23]
    s_add_u32 s69, s69, s79
    v_mfma_f32_16x16x32_bf16 a[20:23], a[228:231], a[140:143], a[20:23]
    s_and_b32 s69, s69, s3
    v_mfma_f32_16x16x32_bf16 a[24:27], a[224:227], a[144:147], a[24:27]
    v_mfma_f32_16x16x32_bf16 a[24:27], a[228:231], a[148:151], a[24:27]
    s_add_u32 m0, s66, 65536
    s_add_u32 s74, s74, 229376
    v_mfma_f32_16x16x32_bf16 a[28:31], a[224:227], a[152:155], a[28:31]
    buffer_load_dwordx4 v11, s[12:15], s74 offen lds
    v_mfma_f32_16x16x32_bf16 a[28:31], a[228:231], a[156:159], a[28:31]
    s_waitcnt lgkmcnt(2)
    v_mfma_f32_16x16x32_bf16 a[32:35], a[232:235], a[96:99], a[32:35]
    ds_read_b64_tr_b16 a[224:225], v3 offset:4096
    v_mfma_f32_16x16x32_bf16 a[32:35], a[236:239], a[100:103], a[32:35]
    ds_read_b64_tr_b16 a[226:227], v3 offset:4608
    v_mfma_f32_16x16x32_bf16 a[36:39], a[232:235], a[104:107], a[36:39]
    ds_read_b64_tr_b16 a[228:229], v5 offset:4096
    v_mfma_f32_16x16x32_bf16 a[36:39], a[236:239], a[108:111], a[36:39]
    ds_read_b64_tr_b16 a[230:231], v5 offset:4608
    v_mfma_f32_16x16x32_bf16 a[40:43], a[232:235], a[112:115], a[40:43]
    ds_read_b128 a[168:171], v1 offset:34816
    v_mfma_f32_16x16x32_bf16 a[40:43], a[236:239], a[116:119], a[40:43]
    ds_read_b128 a[172:175], v2 offset:34816
    v_mfma_f32_16x16x32_bf16 a[44:47], a[232:235], a[120:123], a[44:47]
    v_mfma_f32_16x16x32_bf16 a[44:47], a[236:239], a[124:127], a[44:47]
    v_mfma_f32_16x16x32_bf16 a[48:51], a[232:235], a[128:131], a[48:51]
    v_mfma_f32_16x16x32_bf16 a[48:51], a[236:239], a[132:135], a[48:51]
    v_mfma_f32_16x16x32_bf16 a[52:55], a[232:235], a[136:139], a[52:55]
    s_add_u32 m0, s66, 28672
    s_add_u32 s74, s63, s59
    v_mfma_f32_16x16x32_bf16 a[52:55], a[236:239], a[140:143], a[52:55]
    buffer_load_dwordx4 v11, s[16:19], s74 offen lds
    v_mfma_f32_16x16x32_bf16 a[56:59], a[232:235], a[144:147], a[56:59]
    v_mfma_f32_16x16x32_bf16 a[56:59], a[236:239], a[148:151], a[56:59]
    v_mfma_f32_16x16x32_bf16 a[60:63], a[232:235], a[152:155], a[60:63]
    v_mfma_f32_16x16x32_bf16 a[60:63], a[236:239], a[156:159], a[60:63]
    s_waitcnt lgkmcnt(2)
    v_mfma_f32_16x16x32_bf16 v[32:35], a[224:227], a[96:99], v[32:35]
    ds_read_b64_tr_b16 a[232:233], v4 offset:4096
    v_mfma_f32_16x16x32_bf16 v[32:35], a[228:231], a[100:103], v[32:35]
    ds_read_b64_tr_b16 a[234:235], v4 offset:4608
    v_mfma_f32_16x16x32_bf16 v[36:39], a[224:227], a[104:107], v[36:39]
    ds_read_b64_tr_b16 a[236:237], v6 offset:4096
    v_mfma_f32_16x16x32_bf16 v[36:39], a[228:231], a[108:111], v[36:39]
    ds_read_b64_tr_b16 a[238:239], v6 offset:4608
    v_mfma_f32_16x16x32_bf16 v[40:43], a[224:227], a[112:115], v[40:43]
    ds_read_b128 a[176:179], v1 offset:36864
    v_mfma_f32_16x16x32_bf16 v[40:43], a[228:231], a[116:119], v[40:43]
    v_mfma_f32_16x16x32_bf16 v[44:47], a[224:227], a[120:123], v[44:47]
    v_mfma_f32_16x16x32_bf16 v[44:47], a[228:231], a[124:127], v[44:47]
    s_add_u32 m0, s66, 69632
    s_add_u32 s74, s74, 229376
    v_mfma_f32_16x16x32_bf16 v[48:51], a[224:227], a[128:131], v[48:51]
    buffer_load_dwordx4 v11, s[16:19], s74 offen lds
    v_mfma_f32_16x16x32_bf16 v[48:51], a[228:231], a[132:135], v[48:51]
    v_mfma_f32_16x16x32_bf16 v[52:55], a[224:227], a[136:139], v[52:55]
    v_mfma_f32_16x16x32_bf16 v[52:55], a[228:231], a[140:143], v[52:55]
    v_mfma_f32_16x16x32_bf16 v[56:59], a[224:227], a[144:147], v[56:59]
    v_mfma_f32_16x16x32_bf16 v[56:59], a[228:231], a[148:151], v[56:59]
    s_add_u32 m0, s67, 0
    s_add_u32 s74, s57, 0
    v_mfma_f32_16x16x32_bf16 v[60:63], a[224:227], a[152:155], v[60:63]
    buffer_load_dwordx4 v9, s[4:7], s74 offen lds
    v_mfma_f32_16x16x32_bf16 v[60:63], a[228:231], a[156:159], v[60:63]
    s_waitcnt lgkmcnt(1)
    v_mfma_f32_16x16x32_bf16 v[64:67], a[232:235], a[96:99], v[64:67]
    ds_read_b64_tr_b16 a[224:225], v3 offset:8192
    v_mfma_f32_16x16x32_bf16 v[64:67], a[236:239], a[100:103], v[64:67]
    ds_read_b64_tr_b16 a[226:227], v3 offset:8704
    v_mfma_f32_16x16x32_bf16 v[68:71], a[232:235], a[104:107], v[68:71]
    ds_read_b64_tr_b16 a[228:229], v5 offset:8192
    v_mfma_f32_16x16x32_bf16 v[68:71], a[236:239], a[108:111], v[68:71]
    ds_read_b64_tr_b16 a[230:231], v5 offset:8704
    v_mfma_f32_16x16x32_bf16 v[72:75], a[232:235], a[112:115], v[72:75]
    ds_read_b128 a[180:183], v2 offset:36864
    v_mfma_f32_16x16x32_bf16 v[72:75], a[236:239], a[116:119], v[72:75]
    v_mfma_f32_16x16x32_bf16 v[76:79], a[232:235], a[120:123], v[76:79]
    v_mfma_f32_16x16x32_bf16 v[76:79], a[236:239], a[124:127], v[76:79]
    v_mfma_f32_16x16x32_bf16 v[80:83], a[232:235], a[128:131], v[80:83]
    v_mfma_f32_16x16x32_bf16 v[80:83], a[236:239], a[132:135], v[80:83]
    v_mfma_f32_16x16x32_bf16 v[84:87], a[232:235], a[136:139], v[84:87]
    s_add_u32 m0, s67, 2048
    s_add_u32 s74, s57, 32768
    v_mfma_f32_16x16x32_bf16 v[84:87], a[236:239], a[140:143], v[84:87]
    buffer_load_dwordx4 v9, s[4:7], s74 offen lds
    v_mfma_f32_16x16x32_bf16 v[88:91], a[232:235], a[144:147], v[88:91]
    v_mfma_f32_16x16x32_bf16 v[88:91], a[236:239], a[148:151], v[88:91]
    v_mfma_f32_16x16x32_bf16 v[92:95], a[232:235], a[152:155], v[92:95]
    v_mfma_f32_16x16x32_bf16 v[92:95], a[236:239], a[156:159], v[92:95]
    s_waitcnt lgkmcnt(1)
    v_mfma_f32_16x16x32_bf16 v[96:99], a[224:227], a[96:99], v[96:99]
    ds_read_b64_tr_b16 a[232:233], v4 offset:8192
    v_mfma_f32_16x16x32_bf16 v[96:99], a[228:231], a[100:103], v[96:99]
    ds_read_b64_tr_b16 a[234:235], v4 offset:8704
    v_mfma_f32_16x16x32_bf16 v[100:103], a[224:227], a[104:107], v[100:103]
    ds_read_b64_tr_b16 a[236:237], v6 offset:8192
    v_mfma_f32_16x16x32_bf16 v[100:103], a[228:231], a[108:111], v[100:103]
    ds_read_b64_tr_b16 a[238:239], v6 offset:8704
    v_mfma_f32_16x16x32_bf16 v[104:107], a[224:227], a[112:115], v[104:107]
    v_mfma_f32_16x16x32_bf16 v[104:107], a[228:231], a[116:119], v[104:107]
    v_mfma_f32_16x16x32_bf16 v[108:111], a[224:227], a[120:123], v[108:111]
    v_mfma_f32_16x16x32_bf16 v[108:111], a[228:231], a[124:127], v[108:111]
    s_add_u32 m0, s67, 4096
    s_add_u32 s74, s57, 65536
    v_mfma_f32_16x16x32_bf16 v[112:115], a[224:227], a[128:131], v[112:115]
    buffer_load_dwordx4 v9, s[4:7], s74 offen lds
    v_mfma_f32_16x16x32_bf16 v[112:115], a[228:231], a[132:135], v[112:115]
    v_mfma_f32_16x16x32_bf16 v[116:119], a[224:227], a[136:139], v[116:119]
    v_mfma_f32_16x16x32_bf16 v[116:119], a[228:231], a[140:143], v[116:119]
    v_mfma_f32_16x16x32_bf16 v[120:123], a[224:227], a[144:147], v[120:123]
    v_mfma_f32_16x16x32_bf16 v[120:123], a[228:231], a[148:151], v[120:123]
    v_mfma_f32_16x16x32_bf16 v[124:127], a[224:227], a[152:155], v[124:127]
    v_mfma_f32_16x16x32_bf16 v[124:127], a[228:231], a[156:159], v[124:127]
    s_waitcnt vmcnt(10) lgkmcnt(0)
    s_barrier
    v_mfma_f32_16x16x32_bf16 v[128:131], a[232:235], a[96:99], v[128:131]
    ds_read_b64_tr_b16 a[224:225], v3 offset:12288
    v_mfma_f32_16x16x32_bf16 v[128:131], a[236:239], a[100:103], v[128:131]
    ds_read_b64_tr_b16 a[226:227], v3 offset:12800
    v_mfma_f32_16x16x32_bf16 v[132:135], a[232:235], a[104:107], v[132:135]
    ds_read_b64_tr_b16 a[228:229], v5 offset:12288
    v_mfma_f32_16x16x32_bf16 v[132:135], a[236:239], a[108:111], v[132:135]
    ds_read_b64_tr_b16 a[230:231], v5 offset:12800
    v_mfma_f32_16x16x32_bf16 v[136:139], a[232:235], a[112:115], v[136:139]
    ds_read_b128 a[184:187], v1 offset:38912
    v_mfma_f32_16x16x32_bf16 v[136:139], a[236:239], a[116:119], v[136:139]
    ds_read_b128 a[188:191], v2 offset:38912
    v_mfma_f32_16x16x32_bf16 v[140:143], a[232:235], a[120:123], v[140:143]
    ds_read_b128 a[192:195], v1 offset:40960
    v_mfma_f32_16x16x32_bf16 v[140:143], a[236:239], a[124:127], v[140:143]
    s_add_u32 m0, s66, 32768
    s_add_u32 s74, s64, s59
    v_mfma_f32_16x16x32_bf16 v[144:147], a[232:235], a[128:131], v[144:147]
    buffer_load_dwordx4 v11, s[12:15], s74 offen lds
    v_mfma_f32_16x16x32_bf16 v[144:147], a[236:239], a[132:135], v[144:147]
    v_mfma_f32_16x16x32_bf16 v[148:151], a[232:235], a[136:139], v[148:151]
    s_add_u32 m0, s66, 73728
    s_add_u32 s74, s74, 229376
    v_mfma_f32_16x16x32_bf16 v[148:151], a[236:239], a[140:143], v[148:151]
    buffer_load_dwordx4 v11, s[12:15], s74 offen lds
    v_mfma_f32_16x16x32_bf16 v[152:155], a[232:235], a[144:147], v[152:155]
    v_mfma_f32_16x16x32_bf16 v[152:155], a[236:239], a[148:151], v[152:155]
    s_add_u32 m0, s66, 36864
    s_add_u32 s74, s65, s59
    v_mfma_f32_16x16x32_bf16 v[156:159], a[232:235], a[152:155], v[156:159]
    buffer_load_dwordx4 v11, s[16:19], s74 offen lds
    v_mfma_f32_16x16x32_bf16 v[156:159], a[236:239], a[156:159], v[156:159]
    s_waitcnt lgkmcnt(3)
    v_mfma_f32_16x16x32_bf16 v[160:163], a[224:227], a[96:99], v[160:163]
    ds_read_b64_tr_b16 a[232:233], v4 offset:12288
    v_mfma_f32_16x16x32_bf16 v[160:163], a[228:231], a[100:103], v[160:163]
    ds_read_b64_tr_b16 a[234:235], v4 offset:12800
    v_mfma_f32_16x16x32_bf16 v[164:167], a[224:227], a[104:107], v[164:167]
    ds_read_b64_tr_b16 a[236:237], v6 offset:12288
    v_mfma_f32_16x16x32_bf16 v[164:167], a[228:231], a[108:111], v[164:167]
    ds_read_b64_tr_b16 a[238:239], v6 offset:12800
    v_mfma_f32_16x16x32_bf16 v[168:171], a[224:227], a[112:115], v[168:171]
    ds_read_b128 a[196:199], v2 offset:40960
    v_mfma_f32_16x16x32_bf16 v[168:171], a[228:231], a[116:119], v[168:171]
    ds_read_b128 a[200:203], v1 offset:43008
    v_mfma_f32_16x16x32_bf16 v[172:175], a[224:227], a[120:123], v[172:175]
    ds_read_b128 a[204:207], v2 offset:43008
    v_mfma_f32_16x16x32_bf16 v[172:175], a[228:231], a[124:127], v[172:175]
    s_add_u32 m0, s66, 77824
    s_add_u32 s74, s74, 229376
    v_mfma_f32_16x16x32_bf16 v[176:179], a[224:227], a[128:131], v[176:179]
    buffer_load_dwordx4 v11, s[16:19], s74 offen lds
    v_mfma_f32_16x16x32_bf16 v[176:179], a[228:231], a[132:135], v[176:179]
    v_mfma_f32_16x16x32_bf16 v[180:183], a[224:227], a[136:139], v[180:183]
    v_mfma_f32_16x16x32_bf16 v[180:183], a[228:231], a[140:143], v[180:183]
    v_mfma_f32_16x16x32_bf16 v[184:187], a[224:227], a[144:147], v[184:187]
    v_mfma_f32_16x16x32_bf16 v[184:187], a[228:231], a[148:151], v[184:187]
    s_add_u32 m0, s67, 6144
    s_add_u32 s74, s57, 98304
    v_mfma_f32_16x16x32_bf16 v[188:191], a[224:227], a[152:155], v[188:191]
    buffer_load_dwordx4 v9, s[4:7], s74 offen lds
    v_mfma_f32_16x16x32_bf16 v[188:191], a[228:231], a[156:159], v[188:191]
    s_waitcnt lgkmcnt(3)
    v_mfma_f32_16x16x32_bf16 v[192:195], a[232:235], a[96:99], v[192:195]
    ds_read_b64_tr_b16 a[224:225], v3 offset:16384
    v_mfma_f32_16x16x32_bf16 v[192:195], a[236:239], a[100:103], v[192:195]
    ds_read_b64_tr_b16 a[226:227], v3 offset:16896
    v_mfma_f32_16x16x32_bf16 v[196:199], a[232:235], a[104:107], v[196:199]
    ds_read_b64_tr_b16 a[228:229], v5 offset:16384
    v_mfma_f32_16x16x32_bf16 v[196:199], a[236:239], a[108:111], v[196:199]
    ds_read_b64_tr_b16 a[230:231], v5 offset:16896
    v_mfma_f32_16x16x32_bf16 v[200:203], a[232:235], a[112:115], v[200:203]
    ds_read_b128 a[208:211], v1 offset:45056
    v_mfma_f32_16x16x32_bf16 v[200:203], a[236:239], a[116:119], v[200:203]
    ds_read_b128 a[212:215], v2 offset:45056
    v_mfma_f32_16x16x32_bf16 v[204:207], a[232:235], a[120:123], v[204:207]
    v_mfma_f32_16x16x32_bf16 v[204:207], a[236:239], a[124:127], v[204:207]
    s_add_u32 m0, s67, 8192
    s_add_u32 s74, s57, 131072
    v_mfma_f32_16x16x32_bf16 v[208:211], a[232:235], a[128:131], v[208:211]
    buffer_load_dwordx4 v9, s[4:7], s74 offen lds
    v_mfma_f32_16x16x32_bf16 v[208:211], a[236:239], a[132:135], v[208:211]
    v_mfma_f32_16x16x32_bf16 v[212:215], a[232:235], a[136:139], v[212:215]
    s_mul_i32 s58, s60, 393216
    v_mfma_f32_16x16x32_bf16 v[212:215], a[236:239], a[140:143], v[212:215]
    s_mul_i32 s59, s60, 458752
    v_mfma_f32_16x16x32_bf16 v[216:219], a[232:235], a[144:147], v[216:219]
    v_mfma_f32_16x16x32_bf16 v[216:219], a[236:239], a[148:151], v[216:219]
    s_add_u32 m0, s67, 10240
    s_add_u32 s74, s57, 163840
    v_mfma_f32_16x16x32_bf16 v[220:223], a[232:235], a[152:155], v[220:223]
    buffer_load_dwordx4 v9, s[4:7], s74 offen lds
    v_mfma_f32_16x16x32_bf16 v[220:223], a[236:239], a[156:159], v[220:223]
    s_waitcnt lgkmcnt(2)
    v_mfma_f32_16x16x32_bf16 v[224:227], a[224:227], a[96:99], v[224:227]
    ds_read_b64_tr_b16 a[232:233], v4 offset:16384
    v_mfma_f32_16x16x32_bf16 v[224:227], a[228:231], a[100:103], v[224:227]
    ds_read_b64_tr_b16 a[234:235], v4 offset:16896
    v_mfma_f32_16x16x32_bf16 v[228:231], a[224:227], a[104:107], v[228:231]
    ds_read_b64_tr_b16 a[236:237], v6 offset:16384
    v_mfma_f32_16x16x32_bf16 v[228:231], a[228:231], a[108:111], v[228:231]
    ds_read_b64_tr_b16 a[238:239], v6 offset:16896
    v_mfma_f32_16x16x32_bf16 v[232:235], a[224:227], a[112:115], v[232:235]
    ds_read_b128 a[216:219], v1 offset:47104
    v_mfma_f32_16x16x32_bf16 v[232:235], a[228:231], a[116:119], v[232:235]
    ds_read_b128 a[220:223], v2 offset:47104
    v_mfma_f32_16x16x32_bf16 v[236:239], a[224:227], a[120:123], v[236:239]
    v_mfma_f32_16x16x32_bf16 v[236:239], a[228:231], a[124:127], v[236:239]
    s_add_u32 m0, s67, 12288
    s_add_u32 s74, s57, 196608
    v_mfma_f32_16x16x32_bf16 v[240:243], a[224:227], a[128:131], v[240:243]
    buffer_load_dwordx4 v9, s[4:7], s74 offen lds
    v_mfma_f32_16x16x32_bf16 v[240:243], a[228:231], a[132:135], v[240:243]
    v_mfma_f32_16x16x32_bf16 v[244:247], a[224:227], a[136:139], v[244:247]
    s_add_u32 s60, s60, 1
    v_mfma_f32_16x16x32_bf16 v[244:247], a[228:231], a[140:143], v[244:247]
    s_cmp_eq_u32 s60, 16
    s_cselect_b32 s60, 4, s60
    v_mfma_f32_16x16x32_bf16 v[248:251], a[224:227], a[144:147], v[248:251]
    v_mfma_f32_16x16x32_bf16 v[248:251], a[228:231], a[148:151], v[248:251]
    s_add_u32 m0, s67, 14336
    s_add_u32 s74, s57, 229376
    v_mfma_f32_16x16x32_bf16 v[252:255], a[224:227], a[152:155], v[252:255]
    buffer_load_dwordx4 v9, s[4:7], s74 offen lds
    v_mfma_f32_16x16x32_bf16 v[252:255], a[228:231], a[156:159], v[252:255]
    s_waitcnt vmcnt(9) lgkmcnt(0)
    s_barrier
    v_mfma_f32_16x16x32_bf16 a[64:67], a[232:235], a[96:99], a[64:67]
    ds_read_b64_tr_b16 a[224:225], v3 offset:20480
    v_mfma_f32_16x16x32_bf16 a[64:67], a[236:239], a[100:103], a[64:67]
    ds_read_b64_tr_b16 a[226:227], v3 offset:20992
    v_mfma_f32_16x16x32_bf16 a[68:71], a[232:235], a[104:107], a[68:71]
    ds_read_b64_tr_b16 a[228:229], v5 offset:20480
    v_mfma_f32_16x16x32_bf16 a[68:71], a[236:239], a[108:111], a[68:71]
    ds_read_b64_tr_b16 a[230:231], v5 offset:20992
    v_mfma_f32_16x16x32_bf16 a[72:75], a[232:235], a[112:115], a[72:75]
    v_mfma_f32_16x16x32_bf16 a[72:75], a[236:239], a[116:119], a[72:75]
    s_lshl_b32 s57, s60, 7
    v_mfma_f32_16x16x32_bf16 a[76:79], a[232:235], a[120:123], a[76:79]
    v_mfma_f32_16x16x32_bf16 a[76:79], a[236:239], a[124:127], a[76:79]
    s_add_u32 m0, s66, 0
    s_add_u32 s74, s61, s58
    v_mfma_f32_16x16x32_bf16 a[80:83], a[232:235], a[128:131], a[80:83]
    buffer_load_dwordx4 v10, s[8:11], s74 offen lds
    v_mfma_f32_16x16x32_bf16 a[80:83], a[236:239], a[132:135], a[80:83]
    v_mfma_f32_16x16x32_bf16 a[84:87], a[232:235], a[136:139], a[84:87]
    v_mfma_f32_16x16x32_bf16 a[84:87], a[236:239], a[140:143], a[84:87]
    v_mfma_f32_16x16x32_bf16 a[88:91], a[232:235], a[144:147], a[88:91]
L_chain1_1:
L_pad1_1:
    s_cbranch_execz L_pad1_5
    v_mfma_f32_16x16x32_bf16 a[88:91], a[236:239], a[148:151], a[88:91]
    s_add_u32 m0, s66, 40960
    s_add_u32 s74, s74, 196608
    v_mfma_f32_16x16x32_bf16 a[92:95], a[232:235], a[152:155], a[92:95]
    buffer_load_dwordx4 v10, s[8:11], s74 offen lds
    v_mfma_f32_16x16x32_bf16 a[92:95], a[236:239], a[156:159], a[92:95]
    s_waitcnt lgkmcnt(0)
    v_mfma_f32_16x16x32_bf16 a[0:3], a[224:227], a[160:163], a[0:3]
    ds_read_b64_tr_b16 a[232:233], v4 offset:20480
    v_mfma_f32_16x16x32_bf16 a[0:3], a[228:231], a[164:167], a[0:3]
    ds_read_b64_tr_b16 a[234:235], v4 offset:20992
    v_mfma_f32_16x16x32_bf16 a[4:7], a[224:227], a[168:171], a[4:7]
    ds_read_b64_tr_b16 a[236:237], v6 offset:20480
    v_mfma_f32_16x16x32_bf16 a[4:7], a[228:231], a[172:175], a[4:7]
    ds_read_b64_tr_b16 a[238:239], v6 offset:20992
    v_mfma_f32_16x16x32_bf16 a[8:11], a[224:227], a[176:179], a[8:11]
    ds_read_b128 a[96:99], v1
    v_mfma_f32_16x16x32_bf16 a[8:11], a[228:231], a[180:183], a[8:11]
    ds_read_b128 a[100:103], v2
    v_mfma_f32_16x16x32_bf16 a[12:15], a[224:227], a[184:187], a[12:15]
    v_mfma_f32_16x16x32_bf16 a[12:15], a[228:231], a[188:191], a[12:15]
    s_add_u32 m0, s66, 4096
    s_add_u32 s74, s62, s59
    v_mfma_f32_16x16x32_bf16 a[16:19], a[224:227], a[192:195], a[16:19]
    buffer_load_dwordx4 v11, s[12:15], s74 offen lds
    v_mfma_f32_16x16x32_bf16 a[16:19], a[228:231], a[196:199], a[16:19]
    buffer_load_dword a254, v0, s[92:95], s69 offen
    v_mfma_f32_16x16x32_bf16 a[20:23], a[224:227], a[200:203], a[20:23]
    s_add_u32 s69, s69, s79
    v_mfma_f32_16x16x32_bf16 a[20:23], a[228:231], a[204:207], a[20:23]
    s_and_b32 s69, s69, s3
    v_mfma_f32_16x16x32_bf16 a[24:27], a[224:227], a[208:211], a[24:27]
    v_mfma_f32_16x16x32_bf16 a[24:27], a[228:231], a[212:215], a[24:27]
    s_add_u32 m0, s66, 45056
    s_add_u32 s74, s74, 229376
    v_mfma_f32_16x16x32_bf16 a[28:31], a[224:227], a[216:219], a[28:31]
    buffer_load_dwordx4 v11, s[12:15], s74 offen lds
    v_mfma_f32_16x16x32_bf16 a[28:31], a[228:231], a[220:223], a[28:31]
    s_waitcnt lgkmcnt(2)
    v_mfma_f32_16x16x32_bf16 a[32:35], a[232:235], a[160:163], a[32:35]
    ds_read_b64_tr_b16 a[224:225], v3 offset:24576
    v_mfma_f32_16x16x32_bf16 a[32:35], a[236:239], a[164:167], a[32:35]
    ds_read_b64_tr_b16 a[226:227], v3 offset:25088
    v_mfma_f32_16x16x32_bf16 a[36:39], a[232:235], a[168:171], a[36:39]
    ds_read_b64_tr_b16 a[228:229], v5 offset:24576
    v_mfma_f32_16x16x32_bf16 a[36:39], a[236:239], a[172:175], a[36:39]
    ds_read_b64_tr_b16 a[230:231], v5 offset:25088
    v_mfma_f32_16x16x32_bf16 a[40:43], a[232:235], a[176:179], a[40:43]
    ds_read_b128 a[104:107], v1 offset:2048
    v_mfma_f32_16x16x32_bf16 a[40:43], a[236:239], a[180:183], a[40:43]
    ds_read_b128 a[108:111], v2 offset:2048
    v_mfma_f32_16x16x32_bf16 a[44:47], a[232:235], a[184:187], a[44:47]
    v_mfma_f32_16x16x32_bf16 a[44:47], a[236:239], a[188:191], a[44:47]
    v_mfma_f32_16x16x32_bf16 a[48:51], a[232:235], a[192:195], a[48:51]
    v_mfma_f32_16x16x32_bf16 a[48:51], a[236:239], a[196:199], a[48:51]
    v_mfma_f32_16x16x32_bf16 a[52:55], a[232:235], a[200:203], a[52:55]
    s_add_u32 m0, s66, 8192
    s_add_u32 s74, s63, s59
    v_mfma_f32_16x16x32_bf16 a[52:55], a[236:239], a[204:207], a[52:55]
    buffer_load_dwordx4 v11, s[16:19], s74 offen lds
    v_mfma_f32_16x16x32_bf16 a[56:59], a[232:235], a[208:211], a[56:59]
    v_mfma_f32_16x16x32_bf16 a[56:59], a[236:239], a[212:215], a[56:59]
    v_mfma_f32_16x16x32_bf16 a[60:63], a[232:235], a[216:219], a[60:63]
    v_mfma_f32_16x16x32_bf16 a[60:63], a[236:239], a[220:223], a[60:63]
    s_waitcnt lgkmcnt(2)
    v_mfma_f32_16x16x32_bf16 v[32:35], a[224:227], a[160:163], v[32:35]
    ds_read_b64_tr_b16 a[232:233], v4 offset:24576
    v_mfma_f32_16x16x32_bf16 v[32:35], a[228:231], a[164:167], v[32:35]
    ds_read_b64_tr_b16 a[234:235], v4 offset:25088
    v_mfma_f32_16x16x32_bf16 v[36:39], a[224:227], a[168:171], v[36:39]
    ds_read_b64_tr_b16 a[236:237], v6 offset:24576
    v_mfma_f32_16x16x32_bf16 v[36:39], a[228:231], a[172:175], v[36:39]
    ds_read_b64_tr_b16 a[238:239], v6 offset:25088
    v_mfma_f32_16x16x32_bf16 v[40:43], a[224:227], a[176:179], v[40:43]
    ds_read_b128 a[112:115], v1 offset:4096
    v_mfma_f32_16x16x32_bf16 v[40:43], a[228:231], a[180:183], v[40:43]
    v_mfma_f32_16x16x32_bf16 v[44:47], a[224:227], a[184:187], v[44:47]
    v_mfma_f32_16x16x32_bf16 v[44:47], a[228:231], a[188:191], v[44:47]
    s_add_u32 m0, s66, 49152
    s_add_u32 s74, s74, 229376
    v_mfma_f32_16x16x32_bf16 v[48:51], a[224:227], a[192:195], v[48:51]
    buffer_load_dwordx4 v11, s[16:19], s74 offen lds
    v_mfma_f32_16x16x32_bf16 v[48:51], a[228:231], a[196:199], v[48:51]
    v_mfma_f32_16x16x32_bf16 v[52:55], a[224:227], a[200:203], v[52:55]
    v_mfma_f32_16x16x32_bf16 v[52:55], a[228:231], a[204:207], v[52:55]
    v_mfma_f32_16x16x32_bf16 v[56:59], a[224:227], a[208:211], v[56:59]
    v_mfma_f32_16x16x32_bf16 v[56:59], a[228:231], a[212:215], v[56:59]
    s_add_u32 m0, s67, 32768
    s_add_u32 s74, s57, 0
    v_mfma_f32_16x16x32_bf16 v[60:63], a[224:227], a[216:219], v[60:63]
    buffer_load_dwordx4 v9, s[4:7], s74 offen lds
    v_mfma_f32_16x16x32_bf16 v[60:63], a[228:231], a[220:223], v[60:63]
    s_waitcnt lgkmcnt(1)
    v_mfma_f32_16x16x32_bf16 v[64:67], a[232:235], a[160:163], v[64:67]
    ds_read_b64_tr_b16 a[224:225], v3 offset:28672
    v_mfma_f32_16x16x32_bf16 v[64:67], a[236:239], a[164:167], v[64:67]
    ds_read_b64_tr_b16 a[226:227], v3 offset:29184
    v_mfma_f32_16x16x32_bf16 v[68:71], a[232:235], a[168:171], v[68:71]
    ds_read_b64_tr_b16 a[228:229], v5 offset:28672
    v_mfma_f32_16x16x32_bf16 v[68:71], a[236:239], a[172:175], v[68:71]
    ds_read_b64_tr_b16 a[230:231], v5 offset:29184
    v_mfma_f32_16x16x32_bf16 v[72:75], a[232:235], a[176:179], v[72:75]
    ds_read_b128 a[116:119], v2 offset:4096
    v_mfma_f32_16x16x32_bf16 v[72:75], a[236:239], a[180:183], v[72:75]
    v_mfma_f32_16x16x32_bf16 v[76:79], a[232:235], a[184:187], v[76:79]
    v_mfma_f32_16x16x32_bf16 v[76:79], a[236:239], a[188:191], v[76:79]
    v_mfma_f32_16x16x32_bf16 v[80:83], a[232:235], a[192:195], v[80:83]
    v_mfma_f32_16x16x32_bf16 v[80:83], a[236:239], a[196:199], v[80:83]
    v_mfma_f32_16x16x32_bf16 v[84:87], a[232:235], a[200:203], v[84:87]
    s_add_u32 m0, s67, 34816
    s_add_u32 s74, s57, 32768
    v_mfma_f32_16x16x32_bf16 v[84:87], a[236:239], a[204:207], v[84:87]
    buffer_load_dwordx4 v9, s[4:7], s74 offen lds
    v_mfma_f32_16x16x32_bf16 v[88:91], a[232:235], a[208:211], v[88:91]
    v_mfma_f32_16x16x32_bf16 v[88:91], a[236:239], a[212:215], v[88:91]
    v_mfma_f32_16x16x32_bf16 v[92:95], a[232:235], a[216:219], v[92:95]
    v_mfma_f32_16x16x32_bf16 v[92:95], a[236:239], a[220:223], v[92:95]
    s_waitcnt lgkmcnt(1)
    v_mfma_f32_16x16x32_bf16 v[96:99], a[224:227], a[160:163], v[96:99]
    ds_read_b64_tr_b16 a[232:233], v4 offset:28672
    v_mfma_f32_16x16x32_bf16 v[96:99], a[228:231], a[164:167], v[96:99]
    ds_read_b64_tr_b16 a[234:235], v4 offset:29184
    v_mfma_f32_16x16x32_bf16 v[100:103], a[224:227], a[168:171], v[100:103]
    ds_read_b64_tr_b16 a[236:237], v6 offset:28672
    v_mfma_f32_16x16x32_bf16 v[100:103], a[228:231], a[172:175], v[100:103]
    ds_read_b64_tr_b16 a[238:239], v6 offset:29184
    v_mfma_f32_16x16x32_bf16 v[104:107], a[224:227], a[176:179], v[104:107]
    v_mfma_f32_16x16x32_bf16 v[104:107], a[228:231], a[180:183], v[104:107]
    v_mfma_f32_16x16x32_bf16 v[108:111], a[224:227], a[184:187], v[108:111]
    v_mfma_f32_16x16x32_bf16 v[108:111], a[228:231], a[188:191], v[108:111]
    s_add_u32 m0, s67, 36864
    s_add_u32 s74, s57, 65536
    v_mfma_f32_16x16x32_bf16 v[112:115], a[224:227], a[192:195], v[112:115]
    buffer_load_dwordx4 v9, s[4:7], s74 offen lds
    v_mfma_f32_16x16x32_bf16 v[112:115], a[228:231], a[196:199], v[112:115]
    v_mfma_f32_16x16x32_bf16 v[116:119], a[224:227], a[200:203], v[116:119]
    v_mfma_f32_16x16x32_bf16 v[116:119], a[228:231], a[204:207], v[116:119]
    v_mfma_f32_16x16x32_bf16 v[120:123], a[224:227], a[208:211], v[120:123]
    v_mfma_f32_16x16x32_bf16 v[120:123], a[228:231], a[212:215], v[120:123]
    v_mfma_f32_16x16x32_bf16 v[124:127], a[224:227], a[216:219], v[124:127]
    v_mfma_f32_16x16x32_bf16 v[124:127], a[228:231], a[220:223], v[124:127]
    s_waitcnt vmcnt(10) lgkmcnt(0)
    s_barrier
    v_mfma_f32_16x16x32_bf16 v[128:131], a[232:235], a[160:163], v[128:131]
    ds_read_b64_tr_b16 a[224:225], v3 offset:32768
    v_mfma_f32_16x16x32_bf16 v[128:131], a[236:239], a[164:167], v[128:131]
    ds_read_b64_tr_b16 a[226:227], v3 offset:33280
    v_mfma_f32_16x16x32_bf16 v[132:135], a[232:235], a[168:171], v[132:135]
    ds_read_b64_tr_b16 a[228:229], v5 offset:32768
    v_mfma_f32_16x16x32_bf16 v[132:135], a[236:239], a[172:175], v[132:135]
    ds_read_b64_tr_b16 a[230:231], v5 offset:33280
    v_mfma_f32_16x16x32_bf16 v[136:139], a[232:235], a[176:179], v[136:139]
    ds_read_b128 a[120:123], v1 offset:6144
    v_mfma_f32_16x16x32_bf16 v[136:139], a[236:239], a[180:183], v[136:139]
    ds_read_b128 a[124:127], v2 offset:6144
    v_mfma_f32_16x16x32_bf16 v[140:143], a[232:235], a[184:187], v[140:143]
    ds_read_b128 a[128:131], v1 offset:8192
    v_mfma_f32_16x16x32_bf16 v[140:143], a[236:239], a[188:191], v[140:143]
    s_add_u32 m0, s66, 12288
    s_add_u32 s74, s64, s59
    v_mfma_f32_16x16x32_bf16 v[144:147], a[232:235], a[192:195], v[144:147]
    buffer_load_dwordx4 v11, s[12:15], s74 offen lds
    v_mfma_f32_16x16x32_bf16 v[144:147], a[236:239], a[196:199], v[144:147]
    v_mfma_f32_16x16x32_bf16 v[148:151], a[232:235], a[200:203], v[148:151]
    s_add_u32 m0, s66, 53248
    s_add_u32 s74, s74, 229376
    v_mfma_f32_16x16x32_bf16 v[148:151], a[236:239], a[204:207], v[148:151]
    buffer_load_dwordx4 v11, s[12:15], s74 offen lds
    v_mfma_f32_16x16x32_bf16 v[152:155], a[232:235], a[208:211], v[152:155]
    v_mfma_f32_16x16x32_bf16 v[152:155], a[236:239], a[212:215], v[152:155]
    s_add_u32 m0, s66, 16384
    s_add_u32 s74, s65, s59
    v_mfma_f32_16x16x32_bf16 v[156:159], a[232:235], a[216:219], v[156:159]
    buffer_load_dwordx4 v11, s[16:19], s74 offen lds
    v_mfma_f32_16x16x32_bf16 v[156:159], a[236:239], a[220:223], v[156:159]
    s_waitcnt lgkmcnt(3)
    v_mfma_f32_16x16x32_bf16 v[160:163], a[224:227], a[160:163], v[160:163]
    ds_read_b64_tr_b16 a[232:233], v4 offset:32768
    v_mfma_f32_16x16x32_bf16 v[160:163], a[228:231], a[164:167], v[160:163]
    ds_read_b64_tr_b16 a[234:235], v4 offset:33280
    v_mfma_f32_16x16x32_bf16 v[164:167], a[224:227], a[168:171], v[164:167]
    ds_read_b64_tr_b16 a[236:237], v6 offset:32768
    v_mfma_f32_16x16x32_bf16 v[164:167], a[228:231], a[172:175], v[164:167]
    ds_read_b64_tr_b16 a[238:239], v6 offset:33280
    v_mfma_f32_16x16x32_bf16 v[168:171], a[224:227], a[176:179], v[168:171]
    ds_read_b128 a[132:135], v2 offset:8192
    v_mfma_f32_16x16x32_bf16 v[168:171], a[228:231], a[180:183], v[168:171]
    ds_read_b128 a[136:139], v1 offset:10240
    v_mfma_f32_16x16x32_bf16 v[172:175], a[224:227], a[184:187], v[172:175]
    ds_read_b128 a[140:143], v2 offset:10240
    v_mfma_f32_16x16x32_bf16 v[172:175], a[228:231], a[188:191], v[172:175]
    s_add_u32 m0, s66, 57344
    s_add_u32 s74, s74, 229376
    v_mfma_f32_16x16x32_bf16 v[176:179], a[224:227], a[192:195], v[176:179]
    buffer_load_dwordx4 v11, s[16:19], s74 offen lds
    v_mfma_f32_16x16x32_bf16 v[176:179], a[228:231], a[196:199], v[176:179]
    v_mfma_f32_16x16x32_bf16 v[180:183], a[224:227], a[200:203], v[180:183]
    v_mfma_f32_16x16x32_bf16 v[180:183], a[228:231], a[204:207], v[180:183]
    v_mfma_f32_16x16x32_bf16 v[184:187], a[224:227], a[208:211], v[184:187]
    v_mfma_f32_16x16x32_bf16 v[184:187], a[228:231], a[212:215], v[184:187]
    s_add_u32 m0, s67, 38912
    s_add_u32 s74, s57, 98304
    v_mfma_f32_16x16x32_bf16 v[188:191], a[224:227], a[216:219], v[188:191]
    buffer_load_dwordx4 v9, s[4:7], s74 offen lds
    v_mfma_f32_16x16x32_bf16 v[188:191], a[228:231], a[220:223], v[188:191]
    s_waitcnt lgkmcnt(3)
    v_mfma_f32_16x16x32_bf16 v[192:195], a[232:235], a[160:163], v[192:195]
    ds_read_b64_tr_b16 a[224:225], v3 offset:36864
    v_mfma_f32_16x16x32_bf16 v[192:195], a[236:239], a[164:167], v[192:195]
    ds_read_b64_tr_b16 a[226:227], v3 offset:37376
    v_mfma_f32_16x16x32_bf16 v[196:199], a[232:235], a[168:171], v[196:199]
    ds_read_b64_tr_b16 a[228:229], v5 offset:36864
    v_mfma_f32_16x16x32_bf16 v[196:199], a[236:239], a[172:175], v[196:199]
    ds_read_b64_tr_b16 a[230:231], v5 offset:37376
    v_mfma_f32_16x16x32_bf16 v[200:203], a[232:235], a[176:179], v[200:203]
    ds_read_b128 a[144:147], v1 offset:12288
    v_mfma_f32_16x16x32_bf16 v[200:203], a[236:239], a[180:183], v[200:203]
    ds_read_b128 a[148:151], v2 offset:12288
    v_mfma_f32_16x16x32_bf16 v[204:207], a[232:235], a[184:187], v[204:207]
    v_mfma_f32_16x16x32_bf16 v[204:207], a[236:239], a[188:191], v[204:207]
    s_add_u32 m0, s67, 40960
    s_add_u32 s74, s57, 131072
    v_mfma_f32_16x16x32_bf16 v[208:211], a[232:235], a[192:195], v[208:211]
    buffer_load_dwordx4 v9, s[4:7], s74 offen lds
    v_mfma_f32_16x16x32_bf16 v[208:211], a[236:239], a[196:199], v[208:211]
    v_mfma_f32_16x16x32_bf16 v[212:215], a[232:235], a[200:203], v[212:215]
    s_mul_i32 s58, s60, 393216
    v_mfma_f32_16x16x32_bf16 v[212:215], a[236:239], a[204:207], v[212:215]
    s_mul_i32 s59, s60, 458752
    v_mfma_f32_16x16x32_bf16 v[216:219], a[232:235], a[208:211], v[216:219]
    v_mfma_f32_16x16x32_bf16 v[216:219], a[236:239], a[212:215], v[216:219]
    s_add_u32 m0, s67, 43008
    s_add_u32 s74, s57, 163840
    v_mfma_f32_16x16x32_bf16 v[220:223], a[232:235], a[216:219], v[220:223]
    buffer_load_dwordx4 v9, s[4:7], s74 offen lds
    v_mfma_f32_16x16x32_bf16 v[220:223], a[236:239], a[220:223], v[220:223]
    s_waitcnt lgkmcnt(2)
    v_mfma_f32_16x16x32_bf16 v[224:227], a[224:227], a[160:163], v[224:227]
    ds_read_b64_tr_b16 a[232:233], v4 offset:36864
    v_mfma_f32_16x16x32_bf16 v[224:227], a[228:231], a[164:167], v[224:227]
    ds_read_b64_tr_b16 a[234:235], v4 offset:37376
    v_mfma_f32_16x16x32_bf16 v[228:231], a[224:227], a[168:171], v[228:231]
    ds_read_b64_tr_b16 a[236:237], v6 offset:36864
    v_mfma_f32_16x16x32_bf16 v[228:231], a[228:231], a[172:175], v[228:231]
    ds_read_b64_tr_b16 a[238:239], v6 offset:37376
    v_mfma_f32_16x16x32_bf16 v[232:235], a[224:227], a[176:179], v[232:235]
    ds_read_b128 a[152:155], v1 offset:14336
    v_mfma_f32_16x16x32_bf16 v[232:235], a[228:231], a[180:183], v[232:235]
    ds_read_b128 a[156:159], v2 offset:14336
    v_mfma_f32_16x16x32_bf16 v[236:239], a[224:227], a[184:187], v[236:239]
    v_mfma_f32_16x16x32_bf16 v[236:239], a[228:231], a[188:191], v[236:239]
    s_add_u32 m0, s67, 45056
    s_add_u32 s74, s57, 196608
    v_mfma_f32_16x16x32_bf16 v[240:243], a[224:227], a[192:195], v[240:243]
    buffer_load_dwordx4 v9, s[4:7], s74 offen lds
    v_mfma_f32_16x16x32_bf16 v[240:243], a[228:231], a[196:199], v[240:243]
    v_mfma_f32_16x16x32_bf16 v[244:247], a[224:227], a[200:203], v[244:247]
    s_add_u32 s60, s60, 1
    v_mfma_f32_16x16x32_bf16 v[244:247], a[228:231], a[204:207], v[244:247]
    s_cmp_eq_u32 s60, 16
    s_cselect_b32 s60, 4, s60
    v_mfma_f32_16x16x32_bf16 v[248:251], a[224:227], a[208:211], v[248:251]
    v_mfma_f32_16x16x32_bf16 v[248:251], a[228:231], a[212:215], v[248:251]
    s_add_u32 m0, s67, 47104
    s_add_u32 s74, s57, 229376
    v_mfma_f32_16x16x32_bf16 v[252:255], a[224:227], a[216:219], v[252:255]
    buffer_load_dwordx4 v9, s[4:7], s74 offen lds
    v_mfma_f32_16x16x32_bf16 v[252:255], a[228:231], a[220:223], v[252:255]
    s_waitcnt vmcnt(9) lgkmcnt(0)
    s_barrier
    v_mfma_f32_16x16x32_bf16 a[64:67], a[232:235], a[160:163], a[64:67]
    ds_read_b64_tr_b16 a[224:225], v3
    v_mfma_f32_16x16x32_bf16 a[64:67], a[236:239], a[164:167], a[64:67]
    ds_read_b64_tr_b16 a[226:227], v3 offset:512
    v_mfma_f32_16x16x32_bf16 a[68:71], a[232:235], a[168:171], a[68:71]
    ds_read_b64_tr_b16 a[228:229], v5
    v_mfma_f32_16x16x32_bf16 a[68:71], a[236:239], a[172:175], a[68:71]
    ds_read_b64_tr_b16 a[230:231], v5 offset:512
    v_mfma_f32_16x16x32_bf16 a[72:75], a[232:235], a[176:179], a[72:75]
    v_mfma_f32_16x16x32_bf16 a[72:75], a[236:239], a[180:183], a[72:75]
    s_lshl_b32 s57, s60, 7
    v_mfma_f32_16x16x32_bf16 a[76:79], a[232:235], a[184:187], a[76:79]
    v_mfma_f32_16x16x32_bf16 a[76:79], a[236:239], a[188:191], a[76:79]
    s_add_u32 m0, s66, 20480
    s_add_u32 s74, s61, s58
    v_mfma_f32_16x16x32_bf16 a[80:83], a[232:235], a[192:195], a[80:83]
    buffer_load_dwordx4 v10, s[8:11], s74 offen lds
    v_mfma_f32_16x16x32_bf16 a[80:83], a[236:239], a[196:199], a[80:83]
    s_add_u32 s53, s53, 1
    v_mfma_f32_16x16x32_bf16 a[84:87], a[232:235], a[200:203], a[84:87]
    v_mfma_f32_16x16x32_bf16 a[84:87], a[236:239], a[204:207], a[84:87]
    v_mfma_f32_16x16x32_bf16 a[88:91], a[232:235], a[208:211], a[88:91]
    v_mfma_f32_16x16x32_bf16 a[88:91], a[236:239], a[212:215], a[88:91]
    s_add_u32 m0, s66, 61440
    s_add_u32 s74, s74, 196608
    v_mfma_f32_16x16x32_bf16 a[92:95], a[232:235], a[216:219], a[92:95]
    buffer_load_dwordx4 v10, s[8:11], s74 offen lds
    s_bitcmp0_b32 s56, s53
    v_mfma_f32_16x16x32_bf16 a[92:95], a[236:239], a[220:223], a[92:95]
    s_cbranch_scc1 L_main1
L_next1:
L_chain1_2:
L_pad1_2:
    s_cbranch_execz L_pad1_6
    s_cmp_eq_u32 s53, 4
    s_cbranch_scc1 L_sw1
L_swdone1:
    s_sub_u32 s70, s53, s54
    s_lshl4_add_u32 s71, s44, s70
    s_cmp_eq_u32 s71, 2
    s_cbranch_scc1 L_ev1
L_evdone1:
    s_cmp_eq_u32 s53, 7
    s_cbranch_scc1 L_tail1
    s_cmp_lg_u32 s70, 0
    s_cbranch_scc1 L_main1
    .p2align 3
L_cs1:
L_chain1_3:
L_pad1_3:
    s_cbranch_execz L_pad1_7
    s_waitcnt lgkmcnt(0)
    v_mfma_f32_16x16x32_bf16 a[0:3], a[224:227], a[96:99], a[0:3]
    ds_read_b64_tr_b16 a[232:233], v4
    v_mov_b32_dpp v28, v28 row_ror:7 row_mask:0xf bank_mask:0xf
    v_mfma_f32_16x16x32_bf16 a[0:3], a[228:231], a[100:103], a[0:3]
    ds_read_b64_tr_b16 a[234:235], v4 offset:512
    v_mov_b32_dpp v29, v29 row_ror:7 row_mask:0xf bank_mask:0xf
    v_mfma_f32_16x16x32_bf16 a[4:7], a[224:227], a[104:107], a[4:7]
    ds_read_b64_tr_b16 a[236:237], v6
    v_mov_b32_dpp v30, v30 row_ror:7 row_mask:0xf bank_mask:0xf
    v_mfma_f32_16x16x32_bf16 a[4:7], a[228:231], a[108:111], a[4:7]
    ds_read_b64_tr_b16 a[238:239], v6 offset:512
    v_mov_b32_dpp v31, v31 row_ror:7 row_mask:0xf bank_mask:0xf
    v_mfma_f32_16x16x32_bf16 a[8:11], a[224:227], a[112:115], a[8:11]
    ds_read_b128 a[160:163], v1 offset:32768
    v_lshrrev_b32 v27, 9, v13
    v_mfma_f32_16x16x32_bf16 a[8:11], a[228:231], a[116:119], a[8:11]
    ds_read_b128 a[164:167], v2 offset:32768
    v_mfma_f32_16x16x32_bf16 a[12:15], a[224:227], a[120:123], a[12:15]
    v_mfma_f32_16x16x32_bf16 a[12:15], a[228:231], a[124:127], a[12:15]
    s_add_u32 m0, s66, 24576
    s_add_u32 s74, s62, s59
    v_mfma_f32_16x16x32_bf16 a[16:19], a[224:227], a[128:131], a[16:19]
    buffer_load_dwordx4 v11, s[12:15], s74 offen lds
    v_mfma_f32_16x16x32_bf16 a[16:19], a[228:231], a[132:135], a[16:19]
    buffer_load_dword a254, v0, s[92:95], s69 offen
    v_mfma_f32_16x16x32_bf16 a[20:23], a[224:227], a[136:139], a[20:23]
    s_add_u32 s69, s69, s79
    v_mfma_f32_16x16x32_bf16 a[20:23], a[228:231], a[140:143], a[20:23]
    s_and_b32 s69, s69, s3
    v_mul_u32_u24 v22, 1536, v27
    v_mfma_f32_16x16x32_bf16 a[24:27], a[224:227], a[144:147], a[24:27]
    v_mfma_f32_16x16x32_bf16 a[24:27], a[228:231], a[148:151], a[24:27]
    s_add_u32 m0, s66, 65536
    s_add_u32 s74, s74, 229376
    v_mfma_f32_16x16x32_bf16 a[28:31], a[224:227], a[152:155], a[28:31]
    buffer_load_dwordx4 v11, s[12:15], s74 offen lds
    v_mfma_f32_16x16x32_bf16 a[240:243], v[28:31], a[224:227], 0
    v_mfma_f32_16x16x32_bf16 a[28:31], a[228:231], a[156:159], a[28:31]
    s_waitcnt lgkmcnt(2)
    v_mfma_f32_16x16x32_bf16 a[32:35], a[232:235], a[96:99], a[32:35]
    ds_read_b64_tr_b16 a[224:225], v3 offset:4096
    v_mov_b32_dpp v28, v28 row_ror:1 row_mask:0xf bank_mask:0xf
    v_mfma_f32_16x16x32_bf16 a[32:35], a[236:239], a[100:103], a[32:35]
    ds_read_b64_tr_b16 a[226:227], v3 offset:4608
    v_mov_b32_dpp v29, v29 row_ror:1 row_mask:0xf bank_mask:0xf
    v_mfma_f32_16x16x32_bf16 a[36:39], a[232:235], a[104:107], a[36:39]
    ds_read_b64_tr_b16 a[228:229], v5 offset:4096
    v_mov_b32_dpp v30, v30 row_ror:1 row_mask:0xf bank_mask:0xf
    v_mfma_f32_16x16x32_bf16 a[36:39], a[236:239], a[108:111], a[36:39]
    ds_read_b64_tr_b16 a[230:231], v5 offset:4608
    v_mov_b32_dpp v31, v31 row_ror:1 row_mask:0xf bank_mask:0xf
    v_mfma_f32_16x16x32_bf16 a[40:43], a[232:235], a[112:115], a[40:43]
    ds_read_b128 a[168:171], v1 offset:34816
    v_lshlrev_b32 v27, 11, v27
    v_mfma_f32_16x16x32_bf16 a[40:43], a[236:239], a[116:119], a[40:43]
    ds_read_b128 a[172:175], v2 offset:34816
    v_mfma_f32_16x16x32_bf16 a[44:47], a[232:235], a[120:123], a[44:47]
    v_mfma_f32_16x16x32_bf16 a[44:47], a[236:239], a[124:127], a[44:47]
    v_mfma_f32_16x16x32_bf16 a[48:51], a[232:235], a[128:131], a[48:51]
    v_mfma_f32_16x16x32_bf16 a[48:51], a[236:239], a[132:135], a[48:51]
    v_mfma_f32_16x16x32_bf16 a[52:55], a[232:235], a[136:139], a[52:55]
    s_add_u32 m0, s66, 28672
    s_add_u32 s74, s63, s59
    v_add_u32 v22, v22, v13
    v_mfma_f32_16x16x32_bf16 a[52:55], a[236:239], a[140:143], a[52:55]
    buffer_load_dwordx4 v11, s[16:19], s74 offen lds
    v_mfma_f32_16x16x32_bf16 a[56:59], a[232:235], a[144:147], a[56:59]
    v_mfma_f32_16x16x32_bf16 a[56:59], a[236:239], a[148:151], a[56:59]
    v_mfma_f32_16x16x32_bf16 a[60:63], a[232:235], a[152:155], a[60:63]
    v_mfma_f32_16x16x32_bf16 a[240:243], v[28:31], a[232:235], a[240:243]
    v_mfma_f32_16x16x32_bf16 a[60:63], a[236:239], a[156:159], a[60:63]
    s_waitcnt lgkmcnt(2)
    v_mfma_f32_16x16x32_bf16 v[32:35], a[224:227], a[96:99], v[32:35]
    ds_read_b64_tr_b16 a[232:233], v4 offset:4096
    v_mov_b32_dpp v28, v28 row_ror:1 row_mask:0xf bank_mask:0xf
    v_mfma_f32_16x16x32_bf16 v[32:35], a[228:231], a[100:103], v[32:35]
    ds_read_b64_tr_b16 a[234:235], v4 offset:4608
    v_mov_b32_dpp v29, v29 row_ror:1 row_mask:0xf bank_mask:0xf
    v_mfma_f32_16x16x32_bf16 v[36:39], a[224:227], a[104:107], v[36:39]
    ds_read_b64_tr_b16 a[236:237], v6 offset:4096
    v_mov_b32_dpp v30, v30 row_ror:1 row_mask:0xf bank_mask:0xf
    v_mfma_f32_16x16x32_bf16 v[36:39], a[228:231], a[108:111], v[36:39]
    ds_read_b64_tr_b16 a[238:239], v6 offset:4608
    v_mov_b32_dpp v31, v31 row_ror:1 row_mask:0xf bank_mask:0xf
    v_mfma_f32_16x16x32_bf16 v[40:43], a[224:227], a[112:115], v[40:43]
    ds_read_b128 a[176:179], v1 offset:36864
    buffer_load_ushort v27, v27, s[4:7], s101 offen
    v_mfma_f32_16x16x32_bf16 v[40:43], a[228:231], a[116:119], v[40:43]
    v_mfma_f32_16x16x32_bf16 v[44:47], a[224:227], a[120:123], v[44:47]
    v_mfma_f32_16x16x32_bf16 v[44:47], a[228:231], a[124:127], v[44:47]
    s_add_u32 m0, s66, 69632
    s_add_u32 s74, s74, 229376
    v_mfma_f32_16x16x32_bf16 v[48:51], a[224:227], a[128:131], v[48:51]
    buffer_load_dwordx4 v11, s[16:19], s74 offen lds
    v_mfma_f32_16x16x32_bf16 v[48:51], a[228:231], a[132:135], v[48:51]
    v_mfma_f32_16x16x32_bf16 v[52:55], a[224:227], a[136:139], v[52:55]
    buffer_load_dwordx4 v[14:17], v22, s[4:7], s101 offen
    v_mfma_f32_16x16x32_bf16 v[52:55], a[228:231], a[140:143], v[52:55]
    v_mfma_f32_16x16x32_bf16 v[56:59], a[224:227], a[144:147], v[56:59]
    v_mfma_f32_16x16x32_bf16 v[56:59], a[228:231], a[148:151], v[56:59]
    s_add_u32 m0, s67, 0
    s_add_u32 s74, s57, 0
    v_mfma_f32_16x16x32_bf16 v[60:63], a[224:227], a[152:155], v[60:63]
    buffer_load_dwordx4 v9, s[4:7], s74 offen lds
    v_mfma_f32_16x16x32_bf16 a[240:243], v[28:31], a[224:227], a[240:243]
    v_mfma_f32_16x16x32_bf16 v[60:63], a[228:231], a[156:159], v[60:63]
    s_waitcnt lgkmcnt(1)
    v_mfma_f32_16x16x32_bf16 v[64:67], a[232:235], a[96:99], v[64:67]
    ds_read_b64_tr_b16 a[224:225], v3 offset:8192
    v_mov_b32_dpp v28, v28 row_ror:1 row_mask:0xf bank_mask:0xf
    v_mfma_f32_16x16x32_bf16 v[64:67], a[236:239], a[100:103], v[64:67]
    ds_read_b64_tr_b16 a[226:227], v3 offset:8704
    v_mov_b32_dpp v29, v29 row_ror:1 row_mask:0xf bank_mask:0xf
    v_mfma_f32_16x16x32_bf16 v[68:71], a[232:235], a[104:107], v[68:71]
    ds_read_b64_tr_b16 a[228:229], v5 offset:8192
    v_mov_b32_dpp v30, v30 row_ror:1 row_mask:0xf bank_mask:0xf
    v_mfma_f32_16x16x32_bf16 v[68:71], a[236:239], a[108:111], v[68:71]
    ds_read_b64_tr_b16 a[230:231], v5 offset:8704
    v_mov_b32_dpp v31, v31 row_ror:1 row_mask:0xf bank_mask:0xf
    v_mfma_f32_16x16x32_bf16 v[72:75], a[232:235], a[112:115], v[72:75]
    ds_read_b128 a[180:183], v2 offset:36864
    buffer_load_dwordx4 v[18:21], v22, s[4:7], s101 offen offset:512
    v_mfma_f32_16x16x32_bf16 v[72:75], a[236:239], a[116:119], v[72:75]
    v_mfma_f32_16x16x32_bf16 v[76:79], a[232:235], a[120:123], v[76:79]
    v_mfma_f32_16x16x32_bf16 v[76:79], a[236:239], a[124:127], v[76:79]
    buffer_load_dwordx4 a[244:247], v22, s[4:7], s101 offen offset:1024
    v_mfma_f32_16x16x32_bf16 v[80:83], a[232:235], a[128:131], v[80:83]
    v_mfma_f32_16x16x32_bf16 v[80:83], a[236:239], a[132:135], v[80:83]
    v_mfma_f32_16x16x32_bf16 v[84:87], a[232:235], a[136:139], v[84:87]
    s_add_u32 m0, s67, 2048
    s_add_u32 s74, s57, 32768
    v_mfma_f32_16x16x32_bf16 v[84:87], a[236:239], a[140:143], v[84:87]
    buffer_load_dwordx4 v9, s[4:7], s74 offen lds
    v_mfma_f32_16x16x32_bf16 v[88:91], a[232:235], a[144:147], v[88:91]
    s_lshl1_add_u32 s70, s49, s46
    v_mfma_f32_16x16x32_bf16 v[88:91], a[236:239], a[148:151], v[88:91]
    v_mfma_f32_16x16x32_bf16 v[92:95], a[232:235], a[152:155], v[92:95]
    v_mfma_f32_16x16x32_bf16 a[240:243], v[28:31], a[232:235], a[240:243]
    buffer_load_dwordx4 a[248:251], v22, s[4:7], s101 offen offset:1536
    v_mfma_f32_16x16x32_bf16 v[92:95], a[236:239], a[156:159], v[92:95]
    s_waitcnt lgkmcnt(1)
    v_mfma_f32_16x16x32_bf16 v[96:99], a[224:227], a[96:99], v[96:99]
    ds_read_b64_tr_b16 a[232:233], v4 offset:8192
    v_mov_b32_dpp v28, v28 row_ror:1 row_mask:0xf bank_mask:0xf
    v_mfma_f32_16x16x32_bf16 v[96:99], a[228:231], a[100:103], v[96:99]
    ds_read_b64_tr_b16 a[234:235], v4 offset:8704
    v_mov_b32_dpp v29, v29 row_ror:1 row_mask:0xf bank_mask:0xf
    v_mfma_f32_16x16x32_bf16 v[100:103], a[224:227], a[104:107], v[100:103]
    ds_read_b64_tr_b16 a[236:237], v6 offset:8192
    v_mov_b32_dpp v30, v30 row_ror:1 row_mask:0xf bank_mask:0xf
    v_mfma_f32_16x16x32_bf16 v[100:103], a[228:231], a[108:111], v[100:103]
    ds_read_b64_tr_b16 a[238:239], v6 offset:8704
    v_mov_b32_dpp v31, v31 row_ror:1 row_mask:0xf bank_mask:0xf
    v_mfma_f32_16x16x32_bf16 v[104:107], a[224:227], a[112:115], v[104:107]
    s_lshl1_add_u32 s70, s70, s45
    v_mfma_f32_16x16x32_bf16 v[104:107], a[228:231], a[116:119], v[104:107]
    v_mfma_f32_16x16x32_bf16 v[108:111], a[224:227], a[120:123], v[108:111]
    v_mfma_f32_16x16x32_bf16 v[108:111], a[228:231], a[124:127], v[108:111]
    s_add_u32 m0, s67, 4096
    s_add_u32 s74, s57, 65536
    v_mfma_f32_16x16x32_bf16 v[112:115], a[224:227], a[128:131], v[112:115]
    buffer_load_dwordx4 v9, s[4:7], s74 offen lds
    v_mfma_f32_16x16x32_bf16 v[112:115], a[228:231], a[132:135], v[112:115]
    s_lshl3_add_u32 s70, s70, s47
    v_mfma_f32_16x16x32_bf16 v[116:119], a[224:227], a[136:139], v[116:119]
    v_mfma_f32_16x16x32_bf16 v[116:119], a[228:231], a[140:143], v[116:119]
    v_mfma_f32_16x16x32_bf16 v[120:123], a[224:227], a[144:147], v[120:123]
    v_mfma_f32_16x16x32_bf16 v[120:123], a[228:231], a[148:151], v[120:123]
    v_mfma_f32_16x16x32_bf16 v[124:127], a[224:227], a[152:155], v[124:127]
    v_mfma_f32_16x16x32_bf16 a[240:243], v[28:31], a[224:227], a[240:243]
    v_mfma_f32_16x16x32_bf16 v[124:127], a[228:231], a[156:159], v[124:127]
    s_waitcnt vmcnt(15) lgkmcnt(0)
    s_barrier
    v_mfma_f32_16x16x32_bf16 v[128:131], a[232:235], a[96:99], v[128:131]
    ds_read_b64_tr_b16 a[224:225], v3 offset:12288
    v_mfma_f32_16x16x32_bf16 v[128:131], a[236:239], a[100:103], v[128:131]
    ds_read_b64_tr_b16 a[226:227], v3 offset:12800
    v_mfma_f32_16x16x32_bf16 v[132:135], a[232:235], a[104:107], v[132:135]
    ds_read_b64_tr_b16 a[228:229], v5 offset:12288
    v_mfma_f32_16x16x32_bf16 v[132:135], a[236:239], a[108:111], v[132:135]
    ds_read_b64_tr_b16 a[230:231], v5 offset:12800
    v_mfma_f32_16x16x32_bf16 v[136:139], a[232:235], a[112:115], v[136:139]
    ds_read_b128 a[184:187], v1 offset:38912
    v_mfma_f32_16x16x32_bf16 v[136:139], a[236:239], a[116:119], v[136:139]
    ds_read_b128 a[188:191], v2 offset:38912
    v_mfma_f32_16x16x32_bf16 v[140:143], a[232:235], a[120:123], v[140:143]
    ds_read_b128 a[192:195], v1 offset:40960
    v_mfma_f32_16x16x32_bf16 v[140:143], a[236:239], a[124:127], v[140:143]
    s_add_u32 m0, s66, 32768
    s_add_u32 s74, s64, s59
    v_mov_b32_dpp v28, v28 row_ror:1 row_mask:0xf bank_mask:0xf
    v_mfma_f32_16x16x32_bf16 v[144:147], a[232:235], a[128:131], v[144:147]
    buffer_load_dwordx4 v11, s[12:15], s74 offen lds
    v_mov_b32_dpp v29, v29 row_ror:1 row_mask:0xf bank_mask:0xf
    s_lshl_b32 s70, s70, 10
    v_mfma_f32_16x16x32_bf16 v[144:147], a[236:239], a[132:135], v[144:147]
    v_mov_b32_dpp v30, v30 row_ror:1 row_mask:0xf bank_mask:0xf
    s_add_u32 s70, s70, 33030144
    v_mfma_f32_16x16x32_bf16 v[148:151], a[232:235], a[136:139], v[148:151]
    s_add_u32 m0, s66, 73728
    s_add_u32 s74, s74, 229376
    v_mov_b32_dpp v31, v31 row_ror:1 row_mask:0xf bank_mask:0xf
    v_mfma_f32_16x16x32_bf16 v[148:151], a[236:239], a[140:143], v[148:151]
    buffer_load_dwordx4 v11, s[12:15], s74 offen lds
    v_mfma_f32_16x16x32_bf16 v[152:155], a[232:235], a[144:147], v[152:155]
    v_mfma_f32_16x16x32_bf16 v[152:155], a[236:239], a[148:151], v[152:155]
    s_add_u32 m0, s66, 36864
    s_add_u32 s74, s65, s59
    s_add_u32 s53, s53, 1
    v_mfma_f32_16x16x32_bf16 v[156:159], a[232:235], a[152:155], v[156:159]
    buffer_load_dwordx4 v11, s[16:19], s74 offen lds
    v_mfma_f32_16x16x32_bf16 a[240:243], v[28:31], a[232:235], a[240:243]
    v_mfma_f32_16x16x32_bf16 v[156:159], a[236:239], a[156:159], v[156:159]
    s_waitcnt lgkmcnt(3)
    v_mfma_f32_16x16x32_bf16 v[160:163], a[224:227], a[96:99], v[160:163]
    ds_read_b64_tr_b16 a[232:233], v4 offset:12288
    v_mov_b32_dpp v28, v28 row_ror:1 row_mask:0xf bank_mask:0xf
    v_mfma_f32_16x16x32_bf16 v[160:163], a[228:231], a[100:103], v[160:163]
    ds_read_b64_tr_b16 a[234:235], v4 offset:12800
    v_mov_b32_dpp v29, v29 row_ror:1 row_mask:0xf bank_mask:0xf
    v_mfma_f32_16x16x32_bf16 v[164:167], a[224:227], a[104:107], v[164:167]
    ds_read_b64_tr_b16 a[236:237], v6 offset:12288
    v_mov_b32_dpp v30, v30 row_ror:1 row_mask:0xf bank_mask:0xf
    v_mfma_f32_16x16x32_bf16 v[164:167], a[228:231], a[108:111], v[164:167]
    ds_read_b64_tr_b16 a[238:239], v6 offset:12800
    v_mov_b32_dpp v31, v31 row_ror:1 row_mask:0xf bank_mask:0xf
    v_mfma_f32_16x16x32_bf16 v[168:171], a[224:227], a[112:115], v[168:171]
    ds_read_b128 a[196:199], v2 offset:40960
    s_waitcnt vmcnt(11)
    v_lshlrev_b32 v27, 16, v27
    v_mfma_f32_16x16x32_bf16 v[168:171], a[228:231], a[116:119], v[168:171]
L_pad1_4:
    s_cbranch_execz L_pad1_8
    ds_read_b128 a[200:203], v1 offset:43008
    s_waitcnt vmcnt(9)
    v_and_b32 v25, 0xffff0000, v14
    v_mfma_f32_16x16x32_bf16 v[172:175], a[224:227], a[120:123], v[172:175]
    ds_read_b128 a[204:207], v2 offset:43008
    v_lshlrev_b32 v24, 16, v14
    v_mfma_f32_16x16x32_bf16 v[172:175], a[228:231], a[124:127], v[172:175]
    s_add_u32 m0, s66, 77824
    s_add_u32 s74, s74, 229376
    v_sub_f32 v24, v24, v27
    v_mfma_f32_16x16x32_bf16 v[176:179], a[224:227], a[128:131], v[176:179]
    buffer_load_dwordx4 v11, s[16:19], s74 offen lds
    v_sub_f32 v25, v25, v27
    v_mfma_f32_16x16x32_bf16 v[176:179], a[228:231], a[132:135], v[176:179]
    v_add_f32 v22, v24, v25
    v_mfma_f32_16x16x32_bf16 v[180:183], a[224:227], a[136:139], v[180:183]
    v_mfma_f32_16x16x32_bf16 v[180:183], a[228:231], a[140:143], v[180:183]
    v_mul_f32 v23, v24, v24
    v_mfma_f32_16x16x32_bf16 v[184:187], a[224:227], a[144:147], v[184:187]
    v_fmac_f32 v23, v25, v25
    v_mfma_f32_16x16x32_bf16 v[184:187], a[228:231], a[148:151], v[184:187]
    s_add_u32 m0, s67, 6144
    s_add_u32 s74, s57, 98304
    v_and_b32 v25, 0xffff0000, v15
    v_mfma_f32_16x16x32_bf16 v[188:191], a[224:227], a[152:155], v[188:191]
    buffer_load_dwordx4 v9, s[4:7], s74 offen lds
    v_mfma_f32_16x16x32_bf16 a[240:243], v[28:31], a[224:227], a[240:243]
    v_lshlrev_b32 v24, 16, v15
    v_mfma_f32_16x16x32_bf16 v[188:191], a[228:231], a[156:159], v[188:191]
    v_sub_f32 v24, v24, v27
    s_waitcnt lgkmcnt(3)
    v_mfma_f32_16x16x32_bf16 v[192:195], a[232:235], a[96:99], v[192:195]
    ds_read_b64_tr_b16 a[224:225], v3 offset:16384
    v_mov_b32_dpp v28, v28 row_ror:1 row_mask:0xf bank_mask:0xf
    v_mfma_f32_16x16x32_bf16 v[192:195], a[236:239], a[100:103], v[192:195]
    ds_read_b64_tr_b16 a[226:227], v3 offset:16896
    v_mov_b32_dpp v29, v29 row_ror:1 row_mask:0xf bank_mask:0xf
    v_mfma_f32_16x16x32_bf16 v[196:199], a[232:235], a[104:107], v[196:199]
    ds_read_b64_tr_b16 a[228:229], v5 offset:16384
    v_mov_b32_dpp v30, v30 row_ror:1 row_mask:0xf bank_mask:0xf
    v_mfma_f32_16x16x32_bf16 v[196:199], a[236:239], a[108:111], v[196:199]
    ds_read_b64_tr_b16 a[230:231], v5 offset:16896
    v_mov_b32_dpp v31, v31 row_ror:1 row_mask:0xf bank_mask:0xf
    v_mfma_f32_16x16x32_bf16 v[200:203], a[232:235], a[112:115], v[200:203]
    ds_read_b128 a[208:211], v1 offset:45056
    v_sub_f32 v25, v25, v27
    v_mfma_f32_16x16x32_bf16 v[200:203], a[236:239], a[116:119], v[200:203]
    ds_read_b128 a[212:215], v2 offset:45056
    v_add_f32 v22, v22, v24
    v_mfma_f32_16x16x32_bf16 v[204:207], a[232:235], a[120:123], v[204:207]
    v_fmac_f32 v23, v24, v24
    v_mfma_f32_16x16x32_bf16 v[204:207], a[236:239], a[124:127], v[204:207]
    s_add_u32 m0, s67, 8192
    s_add_u32 s74, s57, 131072
    v_add_f32 v22, v22, v25
    v_mfma_f32_16x16x32_bf16 v[208:211], a[232:235], a[128:131], v[208:211]
    buffer_load_dwordx4 v9, s[4:7], s74 offen lds
    v_fmac_f32 v23, v25, v25
    v_and_b32 v25, 0xffff0000, v16
    v_mfma_f32_16x16x32_bf16 v[208:211], a[236:239], a[132:135], v[208:211]
    v_lshlrev_b32 v24, 16, v16
    v_mfma_f32_16x16x32_bf16 v[212:215], a[232:235], a[136:139], v[212:215]
    s_mul_i32 s58, s60, 393216
    v_sub_f32 v24, v24, v27
    v_mfma_f32_16x16x32_bf16 v[212:215], a[236:239], a[140:143], v[212:215]
    s_mul_i32 s59, s60, 458752
    v_sub_f32 v25, v25, v27
    v_add_f32 v22, v22, v24
    v_mfma_f32_16x16x32_bf16 v[216:219], a[232:235], a[144:147], v[216:219]
    v_fmac_f32 v23, v24, v24
    v_mfma_f32_16x16x32_bf16 v[216:219], a[236:239], a[148:151], v[216:219]
    s_add_u32 m0, s67, 10240
    s_add_u32 s74, s57, 163840
    v_add_f32 v22, v22, v25
    v_mfma_f32_16x16x32_bf16 v[220:223], a[232:235], a[152:155], v[220:223]
    buffer_load_dwordx4 v9, s[4:7], s74 offen lds
    v_mfma_f32_16x16x32_bf16 a[240:243], v[28:31], a[232:235], a[240:243]
    v_fmac_f32 v23, v25, v25
    v_mfma_f32_16x16x32_bf16 v[220:223], a[236:239], a[156:159], v[220:223]
    s_waitcnt lgkmcnt(2)
    v_mfma_f32_16x16x32_bf16 v[224:227], a[224:227], a[96:99], v[224:227]
    ds_read_b64_tr_b16 a[232:233], v4 offset:16384
    v_mov_b32_dpp v28, v28 row_ror:1 row_mask:0xf bank_mask:0xf
    v_mfma_f32_16x16x32_bf16 v[224:227], a[228:231], a[100:103], v[224:227]
    ds_read_b64_tr_b16 a[234:235], v4 offset:16896
    v_mov_b32_dpp v29, v29 row_ror:1 row_mask:0xf bank_mask:0xf
    v_mfma_f32_16x16x32_bf16 v[228:231], a[224:227], a[104:107], v[228:231]
    ds_read_b64_tr_b16 a[236:237], v6 offset:16384
    v_mov_b32_dpp v30, v30 row_ror:1 row_mask:0xf bank_mask:0xf
    v_mfma_f32_16x16x32_bf16 v[228:231], a[228:231], a[108:111], v[228:231]
    ds_read_b64_tr_b16 a[238:239], v6 offset:16896
    v_mov_b32_dpp v31, v31 row_ror:1 row_mask:0xf bank_mask:0xf
    v_mfma_f32_16x16x32_bf16 v[232:235], a[224:227], a[112:115], v[232:235]
    ds_read_b128 a[216:219], v1 offset:47104
    v_and_b32 v25, 0xffff0000, v17
    v_mfma_f32_16x16x32_bf16 v[232:235], a[228:231], a[116:119], v[232:235]
    ds_read_b128 a[220:223], v2 offset:47104
    v_lshlrev_b32 v24, 16, v17
    v_mfma_f32_16x16x32_bf16 v[236:239], a[224:227], a[120:123], v[236:239]
    v_sub_f32 v24, v24, v27
    v_mfma_f32_16x16x32_bf16 v[236:239], a[228:231], a[124:127], v[236:239]
    s_add_u32 m0, s67, 12288
    s_add_u32 s74, s57, 196608
    v_sub_f32 v25, v25, v27
    v_mfma_f32_16x16x32_bf16 v[240:243], a[224:227], a[128:131], v[240:243]
    buffer_load_dwordx4 v9, s[4:7], s74 offen lds
    v_add_f32 v22, v22, v24
    v_mfma_f32_16x16x32_bf16 v[240:243], a[228:231], a[132:135], v[240:243]
    v_fmac_f32 v23, v24, v24
    v_mfma_f32_16x16x32_bf16 v[244:247], a[224:227], a[136:139], v[244:247]
    s_add_u32 s60, s60, 1
    v_add_f32 v22, v22, v25
    v_mfma_f32_16x16x32_bf16 v[244:247], a[228:231], a[140:143], v[244:247]
    s_cmp_eq_u32 s60, 16
    s_cselect_b32 s60, 4, s60
    v_fmac_f32 v23, v25, v25
    v_mfma_f32_16x16x32_bf16 v[248:251], a[224:227], a[144:147], v[248:251]
    s_waitcnt vmcnt(12)
    v_and_b32 v25, 0xffff0000, v18
    v_mfma_f32_16x16x32_bf16 v[248:251], a[228:231], a[148:151], v[248:251]
    s_add_u32 m0, s67, 14336
    s_add_u32 s74, s57, 229376
    v_lshlrev_b32 v24, 16, v18
    v_mfma_f32_16x16x32_bf16 v[252:255], a[224:227], a[152:155], v[252:255]
    buffer_load_dwordx4 v9, s[4:7], s74 offen lds
    v_mfma_f32_16x16x32_bf16 a[240:243], v[28:31], a[224:227], a[240:243]
    v_sub_f32 v24, v24, v27
    v_mfma_f32_16x16x32_bf16 v[252:255], a[228:231], a[156:159], v[252:255]
    s_waitcnt vmcnt(9) lgkmcnt(0)
    s_barrier
    v_mfma_f32_16x16x32_bf16 a[64:67], a[232:235], a[96:99], a[64:67]
    ds_read_b64_tr_b16 a[224:225], v3 offset:20480
    v_mfma_f32_16x16x32_bf16 a[64:67], a[236:239], a[100:103], a[64:67]
    ds_read_b64_tr_b16 a[226:227], v3 offset:20992
    v_mfma_f32_16x16x32_bf16 a[68:71], a[232:235], a[104:107], a[68:71]
    ds_read_b64_tr_b16 a[228:229], v5 offset:20480
    v_mfma_f32_16x16x32_bf16 a[68:71], a[236:239], a[108:111], a[68:71]
    ds_read_b64_tr_b16 a[230:231], v5 offset:20992
    v_mfma_f32_16x16x32_bf16 a[72:75], a[232:235], a[112:115], a[72:75]
    v_mov_b32_dpp v28, v28 row_ror:1 row_mask:0xf bank_mask:0xf
    v_mfma_f32_16x16x32_bf16 a[72:75], a[236:239], a[116:119], a[72:75]
    s_lshl_b32 s57, s60, 7
    v_sub_f32 v25, v25, v27
    v_add_f32 v22, v22, v24
    v_mfma_f32_16x16x32_bf16 a[76:79], a[232:235], a[120:123], a[76:79]
    v_mov_b32_dpp v29, v29 row_ror:1 row_mask:0xf bank_mask:0xf
    v_mfma_f32_16x16x32_bf16 a[76:79], a[236:239], a[124:127], a[76:79]
    s_add_u32 m0, s66, 0
    s_add_u32 s74, s61, s58
    v_fmac_f32 v23, v24, v24
    v_mfma_f32_16x16x32_bf16 a[80:83], a[232:235], a[128:131], a[80:83]
    buffer_load_dwordx4 v10, s[8:11], s74 offen lds
    v_mov_b32_dpp v30, v30 row_ror:1 row_mask:0xf bank_mask:0xf
    v_mfma_f32_16x16x32_bf16 a[80:83], a[236:239], a[132:135], a[80:83]
    v_add_f32 v22, v22, v25
    v_mfma_f32_16x16x32_bf16 a[84:87], a[232:235], a[136:139], a[84:87]
    v_mov_b32_dpp v31, v31 row_ror:1 row_mask:0xf bank_mask:0xf
    v_mfma_f32_16x16x32_bf16 a[84:87], a[236:239], a[140:143], a[84:87]
    v_fmac_f32 v23, v25, v25
    v_and_b32 v25, 0xffff0000, v19
    v_mfma_f32_16x16x32_bf16 a[88:91], a[232:235], a[144:147], a[88:91]
    v_lshlrev_b32 v24, 16, v19
    v_mfma_f32_16x16x32_bf16 a[88:91], a[236:239], a[148:151], a[88:91]
    s_add_u32 m0, s66, 40960
    s_add_u32 s74, s74, 196608
    v_sub_f32 v24, v24, v27
    v_mfma_f32_16x16x32_bf16 a[92:95], a[232:235], a[152:155], a[92:95]
    buffer_load_dwordx4 v10, s[8:11], s74 offen lds
    v_mfma_f32_16x16x32_bf16 a[240:243], v[28:31], a[232:235], a[240:243]
    v_sub_f32 v25, v25, v27
    v_add_f32 v22, v22, v24
    v_mfma_f32_16x16x32_bf16 a[92:95], a[236:239], a[156:159], a[92:95]
    v_fmac_f32 v23, v24, v24
    s_waitcnt lgkmcnt(0)
    v_mfma_f32_16x16x32_bf16 a[0:3], a[224:227], a[160:163], a[0:3]
    ds_read_b64_tr_b16 a[232:233], v4 offset:20480
    v_mov_b32_dpp v28, v28 row_ror:7 row_mask:0xf bank_mask:0xf
    v_mfma_f32_16x16x32_bf16 a[0:3], a[228:231], a[164:167], a[0:3]
    ds_read_b64_tr_b16 a[234:235], v4 offset:20992
    v_mov_b32_dpp v29, v29 row_ror:7 row_mask:0xf bank_mask:0xf
    v_mfma_f32_16x16x32_bf16 a[4:7], a[224:227], a[168:171], a[4:7]
    ds_read_b64_tr_b16 a[236:237], v6 offset:20480
    v_mov_b32_dpp v30, v30 row_ror:7 row_mask:0xf bank_mask:0xf
    v_mfma_f32_16x16x32_bf16 a[4:7], a[228:231], a[172:175], a[4:7]
    ds_read_b64_tr_b16 a[238:239], v6 offset:20992
    v_mov_b32_dpp v31, v31 row_ror:7 row_mask:0xf bank_mask:0xf
    v_mfma_f32_16x16x32_bf16 a[8:11], a[224:227], a[176:179], a[8:11]
    ds_read_b128 a[96:99], v1
    v_add_f32 v22, v22, v25
    v_mfma_f32_16x16x32_bf16 a[8:11], a[228:231], a[180:183], a[8:11]
    ds_read_b128 a[100:103], v2
    v_fmac_f32 v23, v25, v25
    v_mfma_f32_16x16x32_bf16 a[12:15], a[224:227], a[184:187], a[12:15]
    v_and_b32 v25, 0xffff0000, v20
    v_mfma_f32_16x16x32_bf16 a[12:15], a[228:231], a[188:191], a[12:15]
    s_add_u32 m0, s66, 4096
    s_add_u32 s74, s62, s59
    v_lshlrev_b32 v24, 16, v20
    v_mfma_f32_16x16x32_bf16 a[16:19], a[224:227], a[192:195], a[16:19]
    buffer_load_dwordx4 v11, s[12:15], s74 offen lds
    v_sub_f32 v24, v24, v27
    v_mfma_f32_16x16x32_bf16 a[16:19], a[228:231], a[196:199], a[16:19]
    buffer_load_dword a254, v0, s[92:95], s69 offen
    v_sub_f32 v25, v25, v27
    v_add_f32 v22, v22, v24
    v_mfma_f32_16x16x32_bf16 a[20:23], a[224:227], a[200:203], a[20:23]
    s_add_u32 s69, s69, s79
    v_fmac_f32 v23, v24, v24
    v_mfma_f32_16x16x32_bf16 a[20:23], a[228:231], a[204:207], a[20:23]
    s_and_b32 s69, s69, s3
    v_add_f32 v22, v22, v25
    v_mfma_f32_16x16x32_bf16 a[24:27], a[224:227], a[208:211], a[24:27]
    v_fmac_f32 v23, v25, v25
    v_and_b32 v25, 0xffff0000, v21
    v_mfma_f32_16x16x32_bf16 a[24:27], a[228:231], a[212:215], a[24:27]
    s_add_u32 m0, s66, 45056
    s_add_u32 s74, s74, 229376
    v_lshlrev_b32 v24, 16, v21
    v_mfma_f32_16x16x32_bf16 a[28:31], a[224:227], a[216:219], a[28:31]
    buffer_load_dwordx4 v11, s[12:15], s74 offen lds
    v_mfma_f32_16x16x32_bf16 a[240:243], v[28:31], a[224:227], a[240:243]
    v_sub_f32 v24, v24, v27
    v_mfma_f32_16x16x32_bf16 a[28:31], a[228:231], a[220:223], a[28:31]
    v_sub_f32 v25, v25, v27
    s_waitcnt lgkmcnt(2)
    v_mfma_f32_16x16x32_bf16 a[32:35], a[232:235], a[160:163], a[32:35]
    ds_read_b64_tr_b16 a[224:225], v3 offset:24576
    v_mov_b32_dpp v28, v28 row_ror:1 row_mask:0xf bank_mask:0xf
    v_mfma_f32_16x16x32_bf16 a[32:35], a[236:239], a[164:167], a[32:35]
    ds_read_b64_tr_b16 a[226:227], v3 offset:25088
    v_mov_b32_dpp v29, v29 row_ror:1 row_mask:0xf bank_mask:0xf
    v_mfma_f32_16x16x32_bf16 a[36:39], a[232:235], a[168:171], a[36:39]
    ds_read_b64_tr_b16 a[228:229], v5 offset:24576
    v_mov_b32_dpp v30, v30 row_ror:1 row_mask:0xf bank_mask:0xf
    v_mfma_f32_16x16x32_bf16 a[36:39], a[236:239], a[172:175], a[36:39]
    ds_read_b64_tr_b16 a[230:231], v5 offset:25088
    v_mov_b32_dpp v31, v31 row_ror:1 row_mask:0xf bank_mask:0xf
    v_mfma_f32_16x16x32_bf16 a[40:43], a[232:235], a[176:179], a[40:43]
    ds_read_b128 a[104:107], v1 offset:2048
    v_add_f32 v22, v22, v24
    v_mfma_f32_16x16x32_bf16 a[40:43], a[236:239], a[180:183], a[40:43]
    ds_read_b128 a[108:111], v2 offset:2048
    v_fmac_f32 v23, v24, v24
    v_mfma_f32_16x16x32_bf16 a[44:47], a[232:235], a[184:187], a[44:47]
    v_add_f32 v22, v22, v25
    v_mfma_f32_16x16x32_bf16 a[44:47], a[236:239], a[188:191], a[44:47]
    v_fmac_f32 v23, v25, v25
    v_accvgpr_read_b32 v24, a244
    v_mfma_f32_16x16x32_bf16 a[48:51], a[232:235], a[192:195], a[48:51]
    v_and_b32 v25, 0xffff0000, v24
    v_mfma_f32_16x16x32_bf16 a[48:51], a[236:239], a[196:199], a[48:51]
    v_lshlrev_b32 v24, 16, v24
    v_mfma_f32_16x16x32_bf16 a[52:55], a[232:235], a[200:203], a[52:55]
    s_add_u32 m0, s66, 8192
    s_add_u32 s74, s63, s59
    v_sub_f32 v24, v24, v27
    v_mfma_f32_16x16x32_bf16 a[52:55], a[236:239], a[204:207], a[52:55]
    buffer_load_dwordx4 v11, s[16:19], s74 offen lds
    v_sub_f32 v25, v25, v27
    v_mfma_f32_16x16x32_bf16 a[56:59], a[232:235], a[208:211], a[56:59]
    v_add_f32 v22, v22, v24
    v_mfma_f32_16x16x32_bf16 a[56:59], a[236:239], a[212:215], a[56:59]
    v_fmac_f32 v23, v24, v24
    v_mfma_f32_16x16x32_bf16 a[60:63], a[232:235], a[216:219], a[60:63]
    v_mfma_f32_16x16x32_bf16 a[240:243], v[28:31], a[232:235], a[240:243]
    v_add_f32 v22, v22, v25
    v_fmac_f32 v23, v25, v25
    v_mfma_f32_16x16x32_bf16 a[60:63], a[236:239], a[220:223], a[60:63]
    v_accvgpr_read_b32 v24, a245
    s_waitcnt lgkmcnt(2)
    v_mfma_f32_16x16x32_bf16 v[32:35], a[224:227], a[160:163], v[32:35]
    ds_read_b64_tr_b16 a[232:233], v4 offset:24576
    v_mov_b32_dpp v28, v28 row_ror:1 row_mask:0xf bank_mask:0xf
    v_mfma_f32_16x16x32_bf16 v[32:35], a[228:231], a[164:167], v[32:35]
    ds_read_b64_tr_b16 a[234:235], v4 offset:25088
    v_mov_b32_dpp v29, v29 row_ror:1 row_mask:0xf bank_mask:0xf
    v_mfma_f32_16x16x32_bf16 v[36:39], a[224:227], a[168:171], v[36:39]
    ds_read_b64_tr_b16 a[236:237], v6 offset:24576
    v_mov_b32_dpp v30, v30 row_ror:1 row_mask:0xf bank_mask:0xf
    v_mfma_f32_16x16x32_bf16 v[36:39], a[228:231], a[172:175], v[36:39]
    ds_read_b64_tr_b16 a[238:239], v6 offset:25088
    v_mov_b32_dpp v31, v31 row_ror:1 row_mask:0xf bank_mask:0xf
    v_mfma_f32_16x16x32_bf16 v[40:43], a[224:227], a[176:179], v[40:43]
    ds_read_b128 a[112:115], v1 offset:4096
    v_and_b32 v25, 0xffff0000, v24
    v_mfma_f32_16x16x32_bf16 v[40:43], a[228:231], a[180:183], v[40:43]
    v_lshlrev_b32 v24, 16, v24
    v_sub_f32 v24, v24, v27
    v_mfma_f32_16x16x32_bf16 v[44:47], a[224:227], a[184:187], v[44:47]
    v_sub_f32 v25, v25, v27
    v_mfma_f32_16x16x32_bf16 v[44:47], a[228:231], a[188:191], v[44:47]
    s_add_u32 m0, s66, 49152
    s_add_u32 s74, s74, 229376
    v_add_f32 v22, v22, v24
    v_mfma_f32_16x16x32_bf16 v[48:51], a[224:227], a[192:195], v[48:51]
    buffer_load_dwordx4 v11, s[16:19], s74 offen lds
    v_fmac_f32 v23, v24, v24
    v_add_f32 v22, v22, v25
    v_mfma_f32_16x16x32_bf16 v[48:51], a[228:231], a[196:199], v[48:51]
    v_fmac_f32 v23, v25, v25
    v_mfma_f32_16x16x32_bf16 v[52:55], a[224:227], a[200:203], v[52:55]
    v_accvgpr_read_b32 v24, a246
    v_mfma_f32_16x16x32_bf16 v[52:55], a[228:231], a[204:207], v[52:55]
    v_and_b32 v25, 0xffff0000, v24
    v_lshlrev_b32 v24, 16, v24
    v_mfma_f32_16x16x32_bf16 v[56:59], a[224:227], a[208:211], v[56:59]
    v_sub_f32 v24, v24, v27
    v_mfma_f32_16x16x32_bf16 v[56:59], a[228:231], a[212:215], v[56:59]
    s_add_u32 m0, s67, 32768
    s_add_u32 s74, s57, 0
    v_sub_f32 v25, v25, v27
    v_mfma_f32_16x16x32_bf16 v[60:63], a[224:227], a[216:219], v[60:63]
    buffer_load_dwordx4 v9, s[4:7], s74 offen lds
    v_mfma_f32_16x16x32_bf16 a[240:243], v[28:31], a[224:227], a[240:243]
    v_add_f32 v22, v22, v24
    v_fmac_f32 v23, v24, v24
    v_mfma_f32_16x16x32_bf16 v[60:63], a[228:231], a[220:223], v[60:63]
    v_add_f32 v22, v22, v25
    s_waitcnt lgkmcnt(1)
    v_mfma_f32_16x16x32_bf16 v[64:67], a[232:235], a[160:163], v[64:67]
    ds_read_b64_tr_b16 a[224:225], v3 offset:28672
    v_mov_b32_dpp v28, v28 row_ror:1 row_mask:0xf bank_mask:0xf
    v_mfma_f32_16x16x32_bf16 v[64:67], a[236:239], a[164:167], v[64:67]
    ds_read_b64_tr_b16 a[226:227], v3 offset:29184
    v_mov_b32_dpp v29, v29 row_ror:1 row_mask:0xf bank_mask:0xf
    v_mfma_f32_16x16x32_bf16 v[68:71], a[232:235], a[168:171], v[68:71]
    ds_read_b64_tr_b16 a[228:229], v5 offset:28672
    v_mov_b32_dpp v30, v30 row_ror:1 row_mask:0xf bank_mask:0xf
    v_mfma_f32_16x16x32_bf16 v[68:71], a[236:239], a[172:175], v[68:71]
    ds_read_b64_tr_b16 a[230:231], v5 offset:29184
    v_mov_b32_dpp v31, v31 row_ror:1 row_mask:0xf bank_mask:0xf
    v_mfma_f32_16x16x32_bf16 v[72:75], a[232:235], a[176:179], v[72:75]
    ds_read_b128 a[116:119], v2 offset:4096
    v_fmac_f32 v23, v25, v25
    v_mfma_f32_16x16x32_bf16 v[72:75], a[236:239], a[180:183], v[72:75]
    v_accvgpr_read_b32 v24, a247
    v_and_b32 v25, 0xffff0000, v24
    v_mfma_f32_16x16x32_bf16 v[76:79], a[232:235], a[184:187], v[76:79]
    v_lshlrev_b32 v24, 16, v24
    v_mfma_f32_16x16x32_bf16 v[76:79], a[236:239], a[188:191], v[76:79]
    v_sub_f32 v24, v24, v27
    v_mfma_f32_16x16x32_bf16 v[80:83], a[232:235], a[192:195], v[80:83]
    v_sub_f32 v25, v25, v27
    v_add_f32 v22, v22, v24
    v_mfma_f32_16x16x32_bf16 v[80:83], a[236:239], a[196:199], v[80:83]
    v_fmac_f32 v23, v24, v24
    v_mfma_f32_16x16x32_bf16 v[84:87], a[232:235], a[200:203], v[84:87]
    s_add_u32 m0, s67, 34816
    s_add_u32 s74, s57, 32768
    v_add_f32 v22, v22, v25
    v_mfma_f32_16x16x32_bf16 v[84:87], a[236:239], a[204:207], v[84:87]
    buffer_load_dwordx4 v9, s[4:7], s74 offen lds
    v_fmac_f32 v23, v25, v25
    v_accvgpr_read_b32 v24, a248
    v_mfma_f32_16x16x32_bf16 v[88:91], a[232:235], a[208:211], v[88:91]
    v_and_b32 v25, 0xffff0000, v24
    v_mfma_f32_16x16x32_bf16 v[88:91], a[236:239], a[212:215], v[88:91]
    v_lshlrev_b32 v24, 16, v24
    v_mfma_f32_16x16x32_bf16 v[92:95], a[232:235], a[216:219], v[92:95]
    v_mfma_f32_16x16x32_bf16 a[240:243], v[28:31], a[232:235], a[240:243]
    v_sub_f32 v24, v24, v27
    v_sub_f32 v25, v25, v27
    v_mfma_f32_16x16x32_bf16 v[92:95], a[236:239], a[220:223], v[92:95]
    v_add_f32 v22, v22, v24
    s_waitcnt lgkmcnt(1)
    v_mfma_f32_16x16x32_bf16 v[96:99], a[224:227], a[160:163], v[96:99]
    ds_read_b64_tr_b16 a[232:233], v4 offset:28672
    v_mov_b32_dpp v28, v28 row_ror:1 row_mask:0xf bank_mask:0xf
    v_mfma_f32_16x16x32_bf16 v[96:99], a[228:231], a[164:167], v[96:99]
    ds_read_b64_tr_b16 a[234:235], v4 offset:29184
    v_mov_b32_dpp v29, v29 row_ror:1 row_mask:0xf bank_mask:0xf
    v_mfma_f32_16x16x32_bf16 v[100:103], a[224:227], a[168:171], v[100:103]
    ds_read_b64_tr_b16 a[236:237], v6 offset:28672
    v_mov_b32_dpp v30, v30 row_ror:1 row_mask:0xf bank_mask:0xf
    v_mfma_f32_16x16x32_bf16 v[100:103], a[228:231], a[172:175], v[100:103]
    ds_read_b64_tr_b16 a[238:239], v6 offset:29184
    v_mov_b32_dpp v31, v31 row_ror:1 row_mask:0xf bank_mask:0xf
    v_mfma_f32_16x16x32_bf16 v[104:107], a[224:227], a[176:179], v[104:107]
    v_fmac_f32 v23, v24, v24
    v_mfma_f32_16x16x32_bf16 v[104:107], a[228:231], a[180:183], v[104:107]
    v_add_f32 v22, v22, v25
    v_fmac_f32 v23, v25, v25
    v_mfma_f32_16x16x32_bf16 v[108:111], a[224:227], a[184:187], v[108:111]
    v_accvgpr_read_b32 v24, a249
    v_mfma_f32_16x16x32_bf16 v[108:111], a[228:231], a[188:191], v[108:111]
    s_add_u32 m0, s67, 36864
    s_add_u32 s74, s57, 65536
    v_and_b32 v25, 0xffff0000, v24
    v_mfma_f32_16x16x32_bf16 v[112:115], a[224:227], a[192:195], v[112:115]
    buffer_load_dwordx4 v9, s[4:7], s74 offen lds
    v_lshlrev_b32 v24, 16, v24
    v_sub_f32 v24, v24, v27
    v_mfma_f32_16x16x32_bf16 v[112:115], a[228:231], a[196:199], v[112:115]
    v_sub_f32 v25, v25, v27
    v_mfma_f32_16x16x32_bf16 v[116:119], a[224:227], a[200:203], v[116:119]
    v_add_f32 v22, v22, v24
    v_mfma_f32_16x16x32_bf16 v[116:119], a[228:231], a[204:207], v[116:119]
    v_fmac_f32 v23, v24, v24
    v_add_f32 v22, v22, v25
    v_mfma_f32_16x16x32_bf16 v[120:123], a[224:227], a[208:211], v[120:123]
    v_mfma_f32_16x16x32_bf16 v[120:123], a[228:231], a[212:215], v[120:123]
    v_fmac_f32 v23, v25, v25
    v_mfma_f32_16x16x32_bf16 v[124:127], a[224:227], a[216:219], v[124:127]
    v_mfma_f32_16x16x32_bf16 a[240:243], v[28:31], a[224:227], a[240:243]
    v_accvgpr_read_b32 v24, a250
    v_mfma_f32_16x16x32_bf16 v[124:127], a[228:231], a[220:223], v[124:127]
    s_waitcnt vmcnt(10) lgkmcnt(0)
    s_barrier
    v_mfma_f32_16x16x32_bf16 v[128:131], a[232:235], a[160:163], v[128:131]
    ds_read_b64_tr_b16 a[224:225], v3 offset:32768
    v_mfma_f32_16x16x32_bf16 v[128:131], a[236:239], a[164:167], v[128:131]
    ds_read_b64_tr_b16 a[226:227], v3 offset:33280
    v_mfma_f32_16x16x32_bf16 v[132:135], a[232:235], a[168:171], v[132:135]
    ds_read_b64_tr_b16 a[228:229], v5 offset:32768
    v_mfma_f32_16x16x32_bf16 v[132:135], a[236:239], a[172:175], v[132:135]
    ds_read_b64_tr_b16 a[230:231], v5 offset:33280
    v_mfma_f32_16x16x32_bf16 v[136:139], a[232:235], a[176:179], v[136:139]
    ds_read_b128 a[120:123], v1 offset:6144
    v_mfma_f32_16x16x32_bf16 v[136:139], a[236:239], a[180:183], v[136:139]
    ds_read_b128 a[124:127], v2 offset:6144
    v_mfma_f32_16x16x32_bf16 v[140:143], a[232:235], a[184:187], v[140:143]
    ds_read_b128 a[128:131], v1 offset:8192
    v_mfma_f32_16x16x32_bf16 v[140:143], a[236:239], a[188:191], v[140:143]
    s_add_u32 m0, s66, 12288
    s_add_u32 s74, s64, s59
    v_mov_b32_dpp v28, v28 row_ror:1 row_mask:0xf bank_mask:0xf
    v_mfma_f32_16x16x32_bf16 v[144:147], a[232:235], a[192:195], v[144:147]
    buffer_load_dwordx4 v11, s[12:15], s74 offen lds
    v_mov_b32_dpp v29, v29 row_ror:1 row_mask:0xf bank_mask:0xf
    v_mfma_f32_16x16x32_bf16 v[144:147], a[236:239], a[196:199], v[144:147]
    v_mov_b32_dpp v30, v30 row_ror:1 row_mask:0xf bank_mask:0xf
    v_mfma_f32_16x16x32_bf16 v[148:151], a[232:235], a[200:203], v[148:151]
    s_add_u32 m0, s66, 53248
    s_add_u32 s74, s74, 229376
    v_mov_b32_dpp v31, v31 row_ror:1 row_mask:0xf bank_mask:0xf
    v_mfma_f32_16x16x32_bf16 v[148:151], a[236:239], a[204:207], v[148:151]
    buffer_load_dwordx4 v11, s[12:15], s74 offen lds
    v_and_b32 v25, 0xffff0000, v24
    v_lshlrev_b32 v24, 16, v24
    v_mfma_f32_16x16x32_bf16 v[152:155], a[232:235], a[208:211], v[152:155]
    v_sub_f32 v24, v24, v27
    v_mfma_f32_16x16x32_bf16 v[152:155], a[236:239], a[212:215], v[152:155]
    s_add_u32 m0, s66, 16384
    s_add_u32 s74, s65, s59
    v_sub_f32 v25, v25, v27
    v_mfma_f32_16x16x32_bf16 v[156:159], a[232:235], a[216:219], v[156:159]
    buffer_load_dwordx4 v11, s[16:19], s74 offen lds
    v_mfma_f32_16x16x32_bf16 a[240:243], v[28:31], a[232:235], a[240:243]
    v_add_f32 v22, v22, v24
    v_fmac_f32 v23, v24, v24
    v_mfma_f32_16x16x32_bf16 v[156:159], a[236:239], a[220:223], v[156:159]
    v_add_f32 v22, v22, v25
    s_waitcnt lgkmcnt(3)
    v_mfma_f32_16x16x32_bf16 v[160:163], a[224:227], a[160:163], v[160:163]
    ds_read_b64_tr_b16 a[232:233], v4 offset:32768
    v_mov_b32_dpp v28, v28 row_ror:1 row_mask:0xf bank_mask:0xf
    v_mfma_f32_16x16x32_bf16 v[160:163], a[228:231], a[164:167], v[160:163]
    ds_read_b64_tr_b16 a[234:235], v4 offset:33280
    v_mov_b32_dpp v29, v29 row_ror:1 row_mask:0xf bank_mask:0xf
    v_mfma_f32_16x16x32_bf16 v[164:167], a[224:227], a[168:171], v[164:167]
    ds_read_b64_tr_b16 a[236:237], v6 offset:32768
    v_mov_b32_dpp v30, v30 row_ror:1 row_mask:0xf bank_mask:0xf
    v_mfma_f32_16x16x32_bf16 v[164:167], a[228:231], a[172:175], v[164:167]
    ds_read_b64_tr_b16 a[238:239], v6 offset:33280
    v_mov_b32_dpp v31, v31 row_ror:1 row_mask:0xf bank_mask:0xf
    v_mfma_f32_16x16x32_bf16 v[168:171], a[224:227], a[176:179], v[168:171]
    ds_read_b128 a[132:135], v2 offset:8192
    v_fmac_f32 v23, v25, v25
    v_mfma_f32_16x16x32_bf16 v[168:171], a[228:231], a[180:183], v[168:171]
    ds_read_b128 a[136:139], v1 offset:10240
    v_accvgpr_read_b32 v24, a251
    v_mfma_f32_16x16x32_bf16 v[172:175], a[224:227], a[184:187], v[172:175]
    ds_read_b128 a[140:143], v2 offset:10240
    v_and_b32 v25, 0xffff0000, v24
    v_mfma_f32_16x16x32_bf16 v[172:175], a[228:231], a[188:191], v[172:175]
    s_add_u32 m0, s66, 57344
    s_add_u32 s74, s74, 229376
    v_lshlrev_b32 v24, 16, v24
    v_mfma_f32_16x16x32_bf16 v[176:179], a[224:227], a[192:195], v[176:179]
    buffer_load_dwordx4 v11, s[16:19], s74 offen lds
    v_sub_f32 v24, v24, v27
    v_mfma_f32_16x16x32_bf16 v[176:179], a[228:231], a[196:199], v[176:179]
    v_sub_f32 v25, v25, v27
    v_add_f32 v22, v22, v24
    v_mfma_f32_16x16x32_bf16 v[180:183], a[224:227], a[200:203], v[180:183]
    v_fmac_f32 v23, v24, v24
    v_mfma_f32_16x16x32_bf16 v[180:183], a[228:231], a[204:207], v[180:183]
    v_add_f32 v22, v22, v25
    v_mfma_f32_16x16x32_bf16 v[184:187], a[224:227], a[208:211], v[184:187]
    v_fmac_f32 v23, v25, v25
    v_add_f32_dpp v22, v22, v22 row_ror:8 row_mask:0xf bank_mask:0xf
    v_mfma_f32_16x16x32_bf16 v[184:187], a[228:231], a[212:215], v[184:187]
    s_add_u32 m0, s67, 38912
    s_add_u32 s74, s57, 98304
    v_add_f32_dpp v23, v23, v23 row_ror:8 row_mask:0xf bank_mask:0xf
    v_mfma_f32_16x16x32_bf16 v[188:191], a[224:227], a[216:219], v[188:191]
    buffer_load_dwordx4 v9, s[4:7], s74 offen lds
    v_mfma_f32_16x16x32_bf16 a[240:243], v[28:31], a[224:227], a[240:243]
    v_add_f32_dpp v22, v22, v22 row_ror:4 row_mask:0xf bank_mask:0xf
    v_mfma_f32_16x16x32_bf16 v[188:191], a[228:231], a[220:223], v[188:191]
    v_add_f32_dpp v23, v23, v23 row_ror:4 row_mask:0xf bank_mask:0xf
    s_waitcnt lgkmcnt(3)
    v_mfma_f32_16x16x32_bf16 v[192:195], a[232:235], a[160:163], v[192:195]
    ds_read_b64_tr_b16 a[224:225], v3 offset:36864
    v_mov_b32_dpp v28, v28 row_ror:1 row_mask:0xf bank_mask:0xf
    v_mfma_f32_16x16x32_bf16 v[192:195], a[236:239], a[164:167], v[192:195]
    ds_read_b64_tr_b16 a[226:227], v3 offset:37376
    v_mov_b32_dpp v29, v29 row_ror:1 row_mask:0xf bank_mask:0xf
    v_mfma_f32_16x16x32_bf16 v[196:199], a[232:235], a[168:171], v[196:199]
    ds_read_b64_tr_b16 a[228:229], v5 offset:36864
    v_mov_b32_dpp v30, v30 row_ror:1 row_mask:0xf bank_mask:0xf
    v_mfma_f32_16x16x32_bf16 v[196:199], a[236:239], a[172:175], v[196:199]
    ds_read_b64_tr_b16 a[230:231], v5 offset:37376
    v_mov_b32_dpp v31, v31 row_ror:1 row_mask:0xf bank_mask:0xf
    v_mfma_f32_16x16x32_bf16 v[200:203], a[232:235], a[176:179], v[200:203]
    ds_read_b128 a[144:147], v1 offset:12288
    v_add_f32_dpp v22, v22, v22 row_ror:2 row_mask:0xf bank_mask:0xf
    v_mfma_f32_16x16x32_bf16 v[200:203], a[236:239], a[180:183], v[200:203]
    ds_read_b128 a[148:151], v2 offset:12288
    v_add_f32_dpp v23, v23, v23 row_ror:2 row_mask:0xf bank_mask:0xf
    v_mfma_f32_16x16x32_bf16 v[204:207], a[232:235], a[184:187], v[204:207]
    v_add_f32_dpp v22, v22, v22 row_ror:1 row_mask:0xf bank_mask:0xf
    v_mfma_f32_16x16x32_bf16 v[204:207], a[236:239], a[188:191], v[204:207]
    s_add_u32 m0, s67, 40960
    s_add_u32 s74, s57, 131072
    v_add_f32_dpp v23, v23, v23 row_ror:1 row_mask:0xf bank_mask:0xf
    v_mfma_f32_16x16x32_bf16 v[208:211], a[232:235], a[192:195], v[208:211]
    buffer_load_dwordx4 v9, s[4:7], s74 offen lds
    v_mov_b32 v24, v22
    v_mfma_f32_16x16x32_bf16 v[208:211], a[236:239], a[196:199], v[208:211]
    v_mov_b32 v25, v23
    v_mfma_f32_16x16x32_bf16 v[212:215], a[232:235], a[200:203], v[212:215]
    s_mul_i32 s58, s60, 393216
    v_permlane16_swap_b32 v24, v22
    v_mfma_f32_16x16x32_bf16 v[212:215], a[236:239], a[204:207], v[212:215]
    s_mul_i32 s59, s60, 458752
    v_permlane16_swap_b32 v25, v23
    v_mfma_f32_16x16x32_bf16 v[216:219], a[232:235], a[208:211], v[216:219]
    v_add_f32 v22, v22, v24
    v_mfma_f32_16x16x32_bf16 v[216:219], a[236:239], a[212:215], v[216:219]
    s_add_u32 m0, s67, 43008
    s_add_u32 s74, s57, 163840
    v_add_f32 v23, v23, v25
    v_mfma_f32_16x16x32_bf16 v[220:223], a[232:235], a[216:219], v[220:223]
    buffer_load_dwordx4 v9, s[4:7], s74 offen lds
    v_mfma_f32_16x16x32_bf16 a[240:243], v[28:31], a[232:235], a[240:243]
    v_mul_f32 v22, 0xba800000, v22
    v_mfma_f32_16x16x32_bf16 v[220:223], a[236:239], a[220:223], v[220:223]
    v_mul_f32 v23, 0x3a800000, v23
    s_waitcnt lgkmcnt(2)
    v_mfma_f32_16x16x32_bf16 v[224:227], a[224:227], a[160:163], v[224:227]
    ds_read_b64_tr_b16 a[232:233], v4 offset:36864
    v_mov_b32_dpp v28, v28 row_ror:1 row_mask:0xf bank_mask:0xf
    v_mfma_f32_16x16x32_bf16 v[224:227], a[228:231], a[164:167], v[224:227]
    ds_read_b64_tr_b16 a[234:235], v4 offset:37376
    v_mov_b32_dpp v29, v29 row_ror:1 row_mask:0xf bank_mask:0xf
    v_mfma_f32_16x16x32_bf16 v[228:231], a[224:227], a[168:171], v[228:231]
    ds_read_b64_tr_b16 a[236:237], v6 offset:36864
    v_mov_b32_dpp v30, v30 row_ror:1 row_mask:0xf bank_mask:0xf
    v_mfma_f32_16x16x32_bf16 v[228:231], a[228:231], a[172:175], v[228:231]
    ds_read_b64_tr_b16 a[238:239], v6 offset:37376
    v_mov_b32_dpp v31, v31 row_ror:1 row_mask:0xf bank_mask:0xf
    v_mfma_f32_16x16x32_bf16 v[232:235], a[224:227], a[176:179], v[232:235]
    ds_read_b128 a[152:155], v1 offset:14336
    v_fma_f32 v23, -v22, v22, v23
    v_mfma_f32_16x16x32_bf16 v[232:235], a[228:231], a[180:183], v[232:235]
    ds_read_b128 a[156:159], v2 offset:14336
    v_max_f32 v23, 0, v23
    v_mfma_f32_16x16x32_bf16 v[236:239], a[224:227], a[184:187], v[236:239]
    v_sub_f32_e64 v22, v22, v27
    v_mfma_f32_16x16x32_bf16 v[236:239], a[228:231], a[188:191], v[236:239]
    s_add_u32 m0, s67, 45056
    s_add_u32 s74, s57, 196608
    v_cvt_pk_bf16_f32 v23, v23, v23
    v_mfma_f32_16x16x32_bf16 v[240:243], a[224:227], a[192:195], v[240:243]
    buffer_load_dwordx4 v9, s[4:7], s74 offen lds
    v_lshlrev_b32 v23, 16, v23
    v_mfma_f32_16x16x32_bf16 v[240:243], a[228:231], a[196:199], v[240:243]
    v_add_f32 v23, 0x3727c5ac, v23
    v_mfma_f32_16x16x32_bf16 v[244:247], a[224:227], a[200:203], v[244:247]
    s_add_u32 s60, s60, 1
    v_cvt_pk_bf16_f32 v23, v23, v23
    v_mfma_f32_16x16x32_bf16 v[244:247], a[228:231], a[204:207], v[244:247]
    s_cmp_eq_u32 s60, 16
    s_cselect_b32 s60, 4, s60
    v_lshlrev_b32 v23, 16, v23
    v_mfma_f32_16x16x32_bf16 v[248:251], a[224:227], a[208:211], v[248:251]
L_pad1_5:
    s_cbranch_execz L_pad1_9
    v_sqrt_f32 v23, v23
    v_mfma_f32_16x16x32_bf16 v[248:251], a[228:231], a[212:215], v[248:251]
    s_add_u32 m0, s67, 47104
    s_add_u32 s74, s57, 229376
    v_cvt_pk_bf16_f32 v24, v22, v22
    v_mfma_f32_16x16x32_bf16 v[252:255], a[224:227], a[216:219], v[252:255]
    buffer_load_dwordx4 v9, s[4:7], s74 offen lds
    v_mfma_f32_16x16x32_bf16 a[240:243], v[28:31], a[224:227], a[240:243]
    v_cvt_pk_bf16_f32 v25, v22, v22
    v_mfma_f32_16x16x32_bf16 v[252:255], a[228:231], a[220:223], v[252:255]
    s_waitcnt vmcnt(9) lgkmcnt(0)
    s_barrier
    v_mfma_f32_16x16x32_bf16 a[64:67], a[232:235], a[160:163], a[64:67]
    ds_read_b64_tr_b16 a[224:225], v3
    v_mfma_f32_16x16x32_bf16 a[64:67], a[236:239], a[164:167], a[64:67]
    ds_read_b64_tr_b16 a[226:227], v3 offset:512
    v_mfma_f32_16x16x32_bf16 a[68:71], a[232:235], a[168:171], a[68:71]
    ds_read_b64_tr_b16 a[228:229], v5
    v_mfma_f32_16x16x32_bf16 a[68:71], a[236:239], a[172:175], a[68:71]
    ds_read_b64_tr_b16 a[230:231], v5 offset:512
    v_mfma_f32_16x16x32_bf16 a[72:75], a[232:235], a[176:179], a[72:75]
    v_mov_b32_dpp v28, v28 row_ror:1 row_mask:0xf bank_mask:0xf
    v_mov_b32_dpp v29, v29 row_ror:1 row_mask:0xf bank_mask:0xf
    v_mfma_f32_16x16x32_bf16 a[72:75], a[236:239], a[180:183], a[72:75]
    s_lshl_b32 s57, s60, 7
    v_mov_b32_dpp v30, v30 row_ror:1 row_mask:0xf bank_mask:0xf
    v_mov_b32_dpp v31, v31 row_ror:1 row_mask:0xf bank_mask:0xf
    v_mfma_f32_16x16x32_bf16 a[76:79], a[232:235], a[184:187], a[76:79]
    v_cvt_pk_bf16_f32 v22, v23, v23
    v_lshlrev_b32 v23, 16, v22
    v_mfma_f32_16x16x32_bf16 a[76:79], a[236:239], a[188:191], a[76:79]
    s_add_u32 m0, s66, 20480
    s_add_u32 s74, s61, s58
    v_lshrrev_b32 v14, 6, v13
    v_mfma_f32_16x16x32_bf16 a[80:83], a[232:235], a[192:195], a[80:83]
    buffer_load_dwordx4 v10, s[8:11], s74 offen lds
    v_lshrrev_b32 v15, 4, v13
    v_mfma_f32_16x16x32_bf16 a[80:83], a[236:239], a[196:199], a[80:83]
    v_mfma_f32_16x16x32_bf16 a[240:243], v[28:31], a[232:235], a[240:243]
    v_lshrrev_b32 v16, 8, v13
    v_mfma_f32_16x16x32_bf16 a[84:87], a[232:235], a[200:203], a[84:87]
    s_mov_b32 exec_lo, 1
    s_mov_b32 exec_hi, 1
    buffer_store_dwordx2 v[24:25], v14, s[20:23], s85 offen sc1
    buffer_store_dword v23, v15, s[20:23], s99 offen sc1
    buffer_store_short v22, v16, s[20:23], s100 offen sc1
    s_mov_b64 exec, -1
    v_mfma_f32_16x16x32_bf16 a[84:87], a[236:239], a[204:207], a[84:87]
    v_mfma_f32_16x16x32_bf16 a[88:91], a[232:235], a[208:211], a[88:91]
    v_mfma_f32_16x16x32_bf16 a[88:91], a[236:239], a[212:215], a[88:91]
    s_add_u32 m0, s66, 61440
    s_add_u32 s74, s74, 196608
    v_mfma_f32_16x16x32_bf16 a[92:95], a[232:235], a[216:219], a[92:95]
    buffer_load_dwordx4 v10, s[8:11], s74 offen lds
    v_mfma_f32_16x16x32_bf16 a[92:95], a[236:239], a[220:223], a[92:95]
    buffer_store_dwordx4 a[240:243], v13, s[20:23], s70 offen sc1
    s_branch L_next1
    .p2align 3
L_tail1:
L_pad1_6:
    s_cbranch_execz L_pad1_10
    s_waitcnt lgkmcnt(0)
    v_mfma_f32_16x16x32_bf16 a[0:3], a[224:227], a[96:99], a[0:3]
    ds_read_b64_tr_b16 a[232:233], v4
    v_mfma_f32_16x16x32_bf16 a[0:3], a[228:231], a[100:103], a[0:3]
    ds_read_b64_tr_b16 a[234:235], v4 offset:512
    v_mfma_f32_16x16x32_bf16 a[4:7], a[224:227], a[104:107], a[4:7]
    ds_read_b64_tr_b16 a[236:237], v6
    v_mfma_f32_16x16x32_bf16 a[4:7], a[228:231], a[108:111], a[4:7]
    ds_read_b64_tr_b16 a[238:239], v6 offset:512
    v_mfma_f32_16x16x32_bf16 a[8:11], a[224:227], a[112:115], a[8:11]
    ds_read_b128 a[160:163], v1 offset:32768
    v_mfma_f32_16x16x32_bf16 a[8:11], a[228:231], a[116:119], a[8:11]
    ds_read_b128 a[164:167], v2 offset:32768
    v_mfma_f32_16x16x32_bf16 a[12:15], a[224:227], a[120:123], a[12:15]
    v_mfma_f32_16x16x32_bf16 a[12:15], a[228:231], a[124:127], a[12:15]
    s_add_u32 m0, s66, 24576
    s_add_u32 s74, s62, s59
    v_mfma_f32_16x16x32_bf16 a[16:19], a[224:227], a[128:131], a[16:19]
    buffer_load_dwordx4 v11, s[12:15], s74 offen lds
    v_mfma_f32_16x16x32_bf16 a[16:19], a[228:231], a[132:135], a[16:19]
    buffer_load_dword v27, off, s[36:39], 0 sc1
    v_mfma_f32_16x16x32_bf16 a[20:23], a[224:227], a[136:139], a[20:23]
    s_add_u32 m0, s66, 65536
    s_add_u32 s74, s74, 229376
    v_mfma_f32_16x16x32_bf16 a[20:23], a[228:231], a[140:143], a[20:23]
    buffer_load_dwordx4 v11, s[12:15], s74 offen lds
    v_mfma_f32_16x16x32_bf16 a[24:27], a[224:227], a[144:147], a[24:27]
    v_mfma_f32_16x16x32_bf16 a[24:27], a[228:231], a[148:151], a[24:27]
    s_add_u32 m0, s66, 28672
    s_add_u32 s74, s63, s59
    v_mfma_f32_16x16x32_bf16 a[28:31], a[224:227], a[152:155], a[28:31]
    buffer_load_dwordx4 v11, s[16:19], s74 offen lds
    v_mfma_f32_16x16x32_bf16 a[28:31], a[228:231], a[156:159], a[28:31]
    s_waitcnt lgkmcnt(2)
    v_mfma_f32_16x16x32_bf16 a[32:35], a[232:235], a[96:99], a[32:35]
    ds_read_b64_tr_b16 a[224:225], v3 offset:4096
    v_mfma_f32_16x16x32_bf16 a[32:35], a[236:239], a[100:103], a[32:35]
    ds_read_b64_tr_b16 a[226:227], v3 offset:4608
    v_mfma_f32_16x16x32_bf16 a[36:39], a[232:235], a[104:107], a[36:39]
    ds_read_b64_tr_b16 a[228:229], v5 offset:4096
    v_mfma_f32_16x16x32_bf16 a[36:39], a[236:239], a[108:111], a[36:39]
    ds_read_b64_tr_b16 a[230:231], v5 offset:4608
    v_mfma_f32_16x16x32_bf16 a[40:43], a[232:235], a[112:115], a[40:43]
    ds_read_b128 a[168:171], v1 offset:34816
    v_mfma_f32_16x16x32_bf16 a[40:43], a[236:239], a[116:119], a[40:43]
    ds_read_b128 a[172:175], v2 offset:34816
    v_mfma_f32_16x16x32_bf16 a[44:47], a[232:235], a[120:123], a[44:47]
    v_mfma_f32_16x16x32_bf16 a[44:47], a[236:239], a[124:127], a[44:47]
    s_add_u32 m0, s66, 69632
    s_add_u32 s74, s74, 229376
    v_mfma_f32_16x16x32_bf16 a[48:51], a[232:235], a[128:131], a[48:51]
    buffer_load_dwordx4 v11, s[16:19], s74 offen lds
    v_mfma_f32_16x16x32_bf16 a[48:51], a[236:239], a[132:135], a[48:51]
    v_mfma_f32_16x16x32_bf16 a[52:55], a[232:235], a[136:139], a[52:55]
    s_add_u32 m0, s66, 32768
    s_add_u32 s74, s64, s59
    v_mfma_f32_16x16x32_bf16 a[52:55], a[236:239], a[140:143], a[52:55]
    buffer_load_dwordx4 v11, s[12:15], s74 offen lds
    v_mfma_f32_16x16x32_bf16 a[56:59], a[232:235], a[144:147], a[56:59]
    v_mfma_f32_16x16x32_bf16 a[56:59], a[236:239], a[148:151], a[56:59]
    s_add_u32 m0, s66, 73728
    s_add_u32 s74, s74, 229376
    v_mfma_f32_16x16x32_bf16 a[60:63], a[232:235], a[152:155], a[60:63]
    buffer_load_dwordx4 v11, s[12:15], s74 offen lds
    v_mfma_f32_16x16x32_bf16 a[60:63], a[236:239], a[156:159], a[60:63]
    s_waitcnt lgkmcnt(2)
    v_mfma_f32_16x16x32_bf16 v[32:35], a[224:227], a[96:99], v[32:35]
    ds_read_b64_tr_b16 a[232:233], v4 offset:4096
    v_mfma_f32_16x16x32_bf16 v[32:35], a[228:231], a[100:103], v[32:35]
    ds_read_b64_tr_b16 a[234:235], v4 offset:4608
    v_mfma_f32_16x16x32_bf16 v[36:39], a[224:227], a[104:107], v[36:39]
    ds_read_b64_tr_b16 a[236:237], v6 offset:4096
    v_mfma_f32_16x16x32_bf16 v[36:39], a[228:231], a[108:111], v[36:39]
    ds_read_b64_tr_b16 a[238:239], v6 offset:4608
    v_mfma_f32_16x16x32_bf16 v[40:43], a[224:227], a[112:115], v[40:43]
    ds_read_b128 a[176:179], v1 offset:36864
    v_mfma_f32_16x16x32_bf16 v[40:43], a[228:231], a[116:119], v[40:43]
    v_mfma_f32_16x16x32_bf16 v[44:47], a[224:227], a[120:123], v[44:47]
    v_mfma_f32_16x16x32_bf16 v[44:47], a[228:231], a[124:127], v[44:47]
    s_add_u32 m0, s66, 36864
    s_add_u32 s74, s65, s59
    v_mfma_f32_16x16x32_bf16 v[48:51], a[224:227], a[128:131], v[48:51]
    buffer_load_dwordx4 v11, s[16:19], s74 offen lds
    v_mfma_f32_16x16x32_bf16 v[48:51], a[228:231], a[132:135], v[48:51]
    v_mfma_f32_16x16x32_bf16 v[52:55], a[224:227], a[136:139], v[52:55]
    s_add_u32 m0, s66, 77824
    s_add_u32 s74, s74, 229376
    v_mfma_f32_16x16x32_bf16 v[52:55], a[228:231], a[140:143], v[52:55]
    buffer_load_dwordx4 v11, s[16:19], s74 offen lds
    v_mfma_f32_16x16x32_bf16 v[56:59], a[224:227], a[144:147], v[56:59]
    v_mfma_f32_16x16x32_bf16 v[56:59], a[228:231], a[148:151], v[56:59]
    s_bfe_u32 s70, s2, 0x20001
    s_xor_b32 s60, s70, 2
    v_mfma_f32_16x16x32_bf16 v[60:63], a[224:227], a[152:155], v[60:63]
    s_and_b32 s70, s2, 1
    s_bfe_u32 s71, s2, 0x20003
    v_mfma_f32_16x16x32_bf16 v[60:63], a[228:231], a[156:159], v[60:63]
    s_lshl2_add_u32 s58, s70, s71
    s_lshr_b32 s70, s2, 5
    s_waitcnt lgkmcnt(1)
    v_mfma_f32_16x16x32_bf16 v[64:67], a[232:235], a[96:99], v[64:67]
    ds_read_b64_tr_b16 a[224:225], v3 offset:8192
    s_and_b32 s71, s60, 1
    v_mfma_f32_16x16x32_bf16 v[64:67], a[236:239], a[100:103], v[64:67]
    ds_read_b64_tr_b16 a[226:227], v3 offset:8704
    s_lshl1_add_u32 s70, s70, s71
    v_mfma_f32_16x16x32_bf16 v[68:71], a[232:235], a[104:107], v[68:71]
    ds_read_b64_tr_b16 a[228:229], v5 offset:8192
    s_lshl_b32 s54, s70, 7
    v_mfma_f32_16x16x32_bf16 v[68:71], a[236:239], a[108:111], v[68:71]
    ds_read_b64_tr_b16 a[230:231], v5 offset:8704
    s_lshl_b32 s70, s44, 16
    v_mfma_f32_16x16x32_bf16 v[72:75], a[232:235], a[112:115], v[72:75]
    ds_read_b128 a[180:183], v2 offset:36864
    s_add_u32 s55, s54, s70
    v_mfma_f32_16x16x32_bf16 v[72:75], a[236:239], a[116:119], v[72:75]
    s_lshl_b32 s70, s46, 7
    s_xor_b32 s53, s54, s70
    s_mul_i32 s70, s60, 28
    v_mfma_f32_16x16x32_bf16 v[76:79], a[232:235], a[120:123], v[76:79]
    s_add_u32 s71, s70, s45
    s_lshl_b32 s71, s71, 16
    s_add_u32 s53, s53, s71
    v_mfma_f32_16x16x32_bf16 v[76:79], a[236:239], a[124:127], v[76:79]
    s_mul_i32 s70, s70, 131072
    s_lshl2_add_u32 s71, s58, s44
    v_mfma_f32_16x16x32_bf16 v[80:83], a[232:235], a[128:131], v[80:83]
    s_lshr_b32 s57, s60, 1
    s_lshl1_add_u32 s71, s71, s57
    v_mfma_f32_16x16x32_bf16 v[80:83], a[236:239], a[132:135], v[80:83]
    s_mul_i32 s56, s71, 4096
    s_add_u32 s56, s56, s70
    v_mfma_f32_16x16x32_bf16 v[84:87], a[232:235], a[136:139], v[84:87]
    s_xor_b32 s85, s71, 1
    s_mul_i32 s85, s85, 4096
    v_mfma_f32_16x16x32_bf16 v[84:87], a[236:239], a[140:143], v[84:87]
    s_add_u32 s85, s85, s70
    v_mfma_f32_16x16x32_bf16 v[88:91], a[232:235], a[144:147], v[88:91]
    s_mul_i32 s57, s71, 4096
    s_add_u32 s57, s57, 15728640
    v_mfma_f32_16x16x32_bf16 v[88:91], a[236:239], a[148:151], v[88:91]
    s_lshl_b32 s71, s71, 16
    s_add_u32 s54, s54, s71
    v_mfma_f32_16x16x32_bf16 v[92:95], a[232:235], a[152:155], v[92:95]
    s_lshl_b32 s59, s44, 12
    s_lshl2_add_u32 s70, s58, s60
    v_mfma_f32_16x16x32_bf16 v[92:95], a[236:239], a[156:159], v[92:95]
    s_lshl_b32 s70, s70, 7
    s_waitcnt lgkmcnt(1)
    v_mfma_f32_16x16x32_bf16 v[96:99], a[224:227], a[96:99], v[96:99]
    ds_read_b64_tr_b16 a[232:233], v4 offset:8192
    s_add_u32 s76, s70, 34148352
    v_mfma_f32_16x16x32_bf16 v[96:99], a[228:231], a[100:103], v[96:99]
    ds_read_b64_tr_b16 a[234:235], v4 offset:8704
    s_lshl_b32 s70, s48, 7
    v_mfma_f32_16x16x32_bf16 v[100:103], a[224:227], a[104:107], v[100:103]
    ds_read_b64_tr_b16 a[236:237], v6 offset:8192
    s_add_u32 s77, s70, 34152448
    v_mfma_f32_16x16x32_bf16 v[100:103], a[228:231], a[108:111], v[100:103]
    ds_read_b64_tr_b16 a[238:239], v6 offset:8704
    s_lshl2_add_u32 s70, s47, s44
    v_mfma_f32_16x16x32_bf16 v[104:107], a[224:227], a[112:115], v[104:107]
    s_mul_i32 s68, s70, 20
    s_mul_i32 s71, s48, 10240
    s_lshl4_add_u32 s66, s71, 27262976
    v_mfma_f32_16x16x32_bf16 v[104:107], a[228:231], a[116:119], v[104:107]
    s_lshl4_add_u32 s70, s68, s71
    s_add_u32 s67, s70, 32505856
    s_lshl1_add_u32 s71, s48, s46
    v_mfma_f32_16x16x32_bf16 v[108:111], a[224:227], a[120:123], v[108:111]
    s_mul_i32 s99, s71, 5120
    s_add_u32 s99, s99, 32505856
    v_mfma_f32_16x16x32_bf16 v[108:111], a[228:231], a[124:127], v[108:111]
    s_lshl1_add_u32 s70, s47, s45
    s_mul_i32 s70, s70, 16384
    v_mfma_f32_16x16x32_bf16 v[112:115], a[224:227], a[128:131], v[112:115]
    s_mul_i32 s71, s48, 262144
    s_add_u32 s70, s70, s71
    v_mfma_f32_16x16x32_bf16 v[112:115], a[228:231], a[132:135], v[112:115]
    s_lshl_b32 s71, s46, 11
    s_add_u32 s70, s70, s71
    v_mfma_f32_16x16x32_bf16 v[116:119], a[224:227], a[136:139], v[116:119]
    s_add_u32 s100, s70, 15728640
    v_mfma_f32_16x16x32_bf16 v[116:119], a[228:231], a[140:143], v[116:119]
    s_lshl1_add_u32 s70, s49, s46
    s_lshl1_add_u32 s70, s70, s45
    v_mfma_f32_16x16x32_bf16 v[120:123], a[224:227], a[144:147], v[120:123]
    s_lshl_b32 s70, s70, 13
    s_add_u32 s72, s70, 33030144
    v_mfma_f32_16x16x32_bf16 v[120:123], a[228:231], a[148:151], v[120:123]
    s_add_u32 s73, s72, 4096
    v_mfma_f32_16x16x32_bf16 v[124:127], a[224:227], a[152:155], v[124:127]
    v_lshrrev_b32 v0, 4, v13
    v_mfma_f32_16x16x32_bf16 v[124:127], a[228:231], a[156:159], v[124:127]
    s_waitcnt vmcnt(11) lgkmcnt(0)
    s_barrier
    v_mfma_f32_16x16x32_bf16 v[128:131], a[232:235], a[96:99], v[128:131]
    ds_read_b64_tr_b16 a[224:225], v3 offset:12288
    v_mfma_f32_16x16x32_bf16 v[128:131], a[236:239], a[100:103], v[128:131]
    ds_read_b64_tr_b16 a[226:227], v3 offset:12800
    v_mfma_f32_16x16x32_bf16 v[132:135], a[232:235], a[104:107], v[132:135]
    ds_read_b64_tr_b16 a[228:229], v5 offset:12288
    v_mfma_f32_16x16x32_bf16 v[132:135], a[236:239], a[108:111], v[132:135]
    ds_read_b64_tr_b16 a[230:231], v5 offset:12800
    v_mfma_f32_16x16x32_bf16 v[136:139], a[232:235], a[112:115], v[136:139]
    ds_read_b128 a[184:187], v1 offset:38912
    v_mfma_f32_16x16x32_bf16 v[136:139], a[236:239], a[116:119], v[136:139]
    ds_read_b128 a[188:191], v2 offset:38912
    v_mfma_f32_16x16x32_bf16 v[140:143], a[232:235], a[120:123], v[140:143]
    ds_read_b128 a[192:195], v1 offset:40960
    v_mfma_f32_16x16x32_bf16 v[140:143], a[236:239], a[124:127], v[140:143]
    s_waitcnt vmcnt(7)
    v_cmp_le_u32 vcc, 0x100, v27
    s_nop 0
    s_cmp_eq_u64 vcc, -1
    s_cbranch_scc0 L_pc1_spin
L_pc1_ok:
    v_mfma_f32_16x16x32_bf16 v[144:147], a[232:235], a[128:131], v[144:147]
    buffer_load_dwordx4 v[28:31], v13, s[20:23], s72 offen sc1
    v_lshrrev_b32 v27, 5, v13
    v_mfma_f32_16x16x32_bf16 v[144:147], a[236:239], a[132:135], v[144:147]
    v_lshlrev_b32 v27, 13, v27
    v_mfma_f32_16x16x32_bf16 v[148:151], a[232:235], a[136:139], v[148:151]
    v_mfma_f32_16x16x32_bf16 v[148:151], a[236:239], a[140:143], v[148:151]
    v_bfe_u32 v26, v13, 4, 1
    v_mfma_f32_16x16x32_bf16 v[152:155], a[232:235], a[144:147], v[152:155]
    buffer_load_dwordx4 v[14:17], v13, s[20:23], s72 offen offset:1024 sc1
    v_mfma_f32_16x16x32_bf16 v[152:155], a[236:239], a[148:151], v[152:155]
    v_lshl_add_u32 v27, v26, 7, v27
    v_mfma_f32_16x16x32_bf16 v[156:159], a[232:235], a[152:155], v[156:159]
    v_mfma_f32_16x16x32_bf16 v[156:159], a[236:239], a[156:159], v[156:159]
    s_mul_i32 s69, s60, 7
    s_waitcnt lgkmcnt(3)
    v_mfma_f32_16x16x32_bf16 v[160:163], a[224:227], a[96:99], v[160:163]
    ds_read_b64_tr_b16 a[232:233], v4 offset:12288
    buffer_load_dwordx4 v[18:21], v13, s[20:23], s72 offen offset:2048 sc1
    v_mfma_f32_16x16x32_bf16 v[160:163], a[228:231], a[100:103], v[160:163]
    ds_read_b64_tr_b16 a[234:235], v4 offset:12800
    s_add_u32 s69, s69, s44
    v_mfma_f32_16x16x32_bf16 v[164:167], a[224:227], a[104:107], v[164:167]
    ds_read_b64_tr_b16 a[236:237], v6 offset:12288
    s_add_u32 s69, s69, 2
    v_mfma_f32_16x16x32_bf16 v[164:167], a[228:231], a[108:111], v[164:167]
    ds_read_b64_tr_b16 a[238:239], v6 offset:12800
    v_mfma_f32_16x16x32_bf16 v[168:171], a[224:227], a[112:115], v[168:171]
    ds_read_b128 a[196:199], v2 offset:40960
    s_lshl_b32 s69, s69, 7
    v_mfma_f32_16x16x32_bf16 v[168:171], a[228:231], a[116:119], v[168:171]
    ds_read_b128 a[200:203], v1 offset:43008
    buffer_load_dwordx4 v[22:25], v13, s[20:23], s72 offen offset:3072 sc1
    v_mfma_f32_16x16x32_bf16 v[172:175], a[224:227], a[120:123], v[172:175]
    ds_read_b128 a[204:207], v2 offset:43008
    s_and_b32 s70, s58, 3
    v_mfma_f32_16x16x32_bf16 v[172:175], a[228:231], a[124:127], v[172:175]
    s_add_u32 s69, s69, s70
    v_mfma_f32_16x16x32_bf16 v[176:179], a[224:227], a[128:131], v[176:179]
    v_mfma_f32_16x16x32_bf16 v[176:179], a[228:231], a[132:135], v[176:179]
    buffer_load_dwordx4 a[240:243], v13, s[20:23], s73 offen sc1
    s_lshr_b32 s70, s2, 5
    v_mfma_f32_16x16x32_bf16 v[180:183], a[224:227], a[136:139], v[180:183]
    v_mfma_f32_16x16x32_bf16 v[180:183], a[228:231], a[140:143], v[180:183]
    s_lshl3_add_u32 s69, s69, s70
    v_mfma_f32_16x16x32_bf16 v[184:187], a[224:227], a[144:147], v[184:187]
    v_mfma_f32_16x16x32_bf16 v[184:187], a[228:231], a[148:151], v[184:187]
    buffer_load_dwordx4 a[244:247], v13, s[20:23], s73 offen offset:1024 sc1
    s_lshl_b32 s69, s69, 8
    v_mfma_f32_16x16x32_bf16 v[188:191], a[224:227], a[152:155], v[188:191]
    v_mfma_f32_16x16x32_bf16 v[188:191], a[228:231], a[156:159], v[188:191]
    s_waitcnt lgkmcnt(3)
    v_mfma_f32_16x16x32_bf16 v[192:195], a[232:235], a[96:99], v[192:195]
    ds_read_b64_tr_b16 a[224:225], v3 offset:16384
    v_mfma_f32_16x16x32_bf16 v[192:195], a[236:239], a[100:103], v[192:195]
    ds_read_b64_tr_b16 a[226:227], v3 offset:16896
    v_mfma_f32_16x16x32_bf16 v[196:199], a[232:235], a[104:107], v[196:199]
    ds_read_b64_tr_b16 a[228:229], v5 offset:16384
    buffer_load_dwordx4 a[248:251], v13, s[20:23], s73 offen offset:2048 sc1
    v_mfma_f32_16x16x32_bf16 v[196:199], a[236:239], a[108:111], v[196:199]
    ds_read_b64_tr_b16 a[230:231], v5 offset:16896
    v_mfma_f32_16x16x32_bf16 v[200:203], a[232:235], a[112:115], v[200:203]
    ds_read_b128 a[208:211], v1 offset:45056
    v_mfma_f32_16x16x32_bf16 v[200:203], a[236:239], a[116:119], v[200:203]
    ds_read_b128 a[212:215], v2 offset:45056
    v_mfma_f32_16x16x32_bf16 v[204:207], a[232:235], a[120:123], v[204:207]
    buffer_load_dwordx4 a[252:255], v13, s[20:23], s73 offen offset:3072 sc1
    v_mfma_f32_16x16x32_bf16 v[204:207], a[236:239], a[124:127], v[204:207]
    v_mfma_f32_16x16x32_bf16 v[208:211], a[232:235], a[128:131], v[208:211]
    v_bfe_u32 v9, v13, 8, 2
    v_mfma_f32_16x16x32_bf16 v[208:211], a[236:239], a[132:135], v[208:211]
    v_mfma_f32_16x16x32_bf16 v[212:215], a[232:235], a[136:139], v[212:215]
    v_lshlrev_b32 v9, 5, v9
    v_mfma_f32_16x16x32_bf16 v[212:215], a[236:239], a[140:143], v[212:215]
    v_mfma_f32_16x16x32_bf16 v[216:219], a[232:235], a[144:147], v[216:219]
    v_mfma_f32_16x16x32_bf16 v[216:219], a[236:239], a[148:151], v[216:219]
    v_and_b32 v10, 0x70, v13
    v_mfma_f32_16x16x32_bf16 v[220:223], a[232:235], a[152:155], v[220:223]
    buffer_load_dword v27, v27, s[24:27], s69 offen
    v_mfma_f32_16x16x32_bf16 v[220:223], a[236:239], a[156:159], v[220:223]
    s_waitcnt lgkmcnt(2)
    v_mfma_f32_16x16x32_bf16 v[224:227], a[224:227], a[96:99], v[224:227]
    ds_read_b64_tr_b16 a[232:233], v4 offset:16384
    v_xor_b32 v9, v9, v10
    v_mfma_f32_16x16x32_bf16 v[224:227], a[228:231], a[100:103], v[224:227]
    ds_read_b64_tr_b16 a[234:235], v4 offset:16896
    v_mfma_f32_16x16x32_bf16 v[228:231], a[224:227], a[104:107], v[228:231]
    ds_read_b64_tr_b16 a[236:237], v6 offset:16384
    v_lshrrev_b32 v10, 7, v13
    v_mfma_f32_16x16x32_bf16 v[228:231], a[228:231], a[108:111], v[228:231]
    ds_read_b64_tr_b16 a[238:239], v6 offset:16896
    v_mfma_f32_16x16x32_bf16 v[232:235], a[224:227], a[112:115], v[232:235]
    ds_read_b128 a[216:219], v1 offset:47104
    v_mfma_f32_16x16x32_bf16 v[232:235], a[228:231], a[116:119], v[232:235]
    ds_read_b128 a[220:223], v2 offset:47104
    v_lshl_add_u32 v9, v10, 11, v9
    v_mfma_f32_16x16x32_bf16 v[236:239], a[224:227], a[120:123], v[236:239]
    v_mfma_f32_16x16x32_bf16 v[236:239], a[228:231], a[124:127], v[236:239]
    v_mfma_f32_16x16x32_bf16 v[240:243], a[224:227], a[128:131], v[240:243]
    v_add_u32 v10, 15360, v9
    v_mfma_f32_16x16x32_bf16 v[240:243], a[228:231], a[132:135], v[240:243]
    v_mfma_f32_16x16x32_bf16 v[244:247], a[224:227], a[136:139], v[244:247]
    v_add_u32 v11, 30720, v9
    v_mfma_f32_16x16x32_bf16 v[244:247], a[228:231], a[140:143], v[244:247]
    v_mfma_f32_16x16x32_bf16 v[248:251], a[224:227], a[144:147], v[248:251]
    v_mfma_f32_16x16x32_bf16 v[248:251], a[228:231], a[148:151], v[248:251]
    v_add_u32 v12, 46080, v9
    v_mfma_f32_16x16x32_bf16 v[252:255], a[224:227], a[152:155], v[252:255]
    v_mfma_f32_16x16x32_bf16 v[252:255], a[228:231], a[156:159], v[252:255]
    s_waitcnt vmcnt(9) lgkmcnt(0)
    s_barrier
    v_mfma_f32_16x16x32_bf16 a[64:67], a[232:235], a[96:99], a[64:67]
    ds_read_b64_tr_b16 a[224:225], v3 offset:20480
    v_mfma_f32_16x16x32_bf16 a[64:67], a[236:239], a[100:103], a[64:67]
    ds_read_b64_tr_b16 a[226:227], v3 offset:20992
    v_mfma_f32_16x16x32_bf16 a[68:71], a[232:235], a[104:107], a[68:71]
    ds_read_b64_tr_b16 a[228:229], v5 offset:20480
    v_mfma_f32_16x16x32_bf16 a[68:71], a[236:239], a[108:111], a[68:71]
    ds_read_b64_tr_b16 a[230:231], v5 offset:20992
    v_mfma_f32_16x16x32_bf16 a[72:75], a[232:235], a[112:115], a[72:75]
    s_add_u32 m0, s59, 81920
    v_mfma_f32_16x16x32_bf16 a[72:75], a[236:239], a[116:119], a[72:75]
    v_mfma_f32_16x16x32_bf16 a[76:79], a[232:235], a[120:123], a[76:79]
    v_mfma_f32_16x16x32_bf16 a[76:79], a[236:239], a[124:127], a[76:79]
    v_mfma_f32_16x16x32_bf16 a[80:83], a[232:235], a[128:131], a[80:83]
    v_mfma_f32_16x16x32_bf16 a[80:83], a[236:239], a[132:135], a[80:83]
    v_mfma_f32_16x16x32_bf16 a[84:87], a[232:235], a[136:139], a[84:87]
    v_mfma_f32_16x16x32_bf16 a[84:87], a[236:239], a[140:143], a[84:87]
    s_add_u32 s74, s53, 0
    v_mfma_f32_16x16x32_bf16 a[88:91], a[232:235], a[144:147], a[88:91]
    v_mfma_f32_16x16x32_bf16 a[88:91], a[236:239], a[148:151], a[88:91]
    v_mfma_f32_16x16x32_bf16 a[92:95], a[232:235], a[152:155], a[92:95]
    v_mfma_f32_16x16x32_bf16 a[92:95], a[236:239], a[156:159], a[92:95]
    s_waitcnt lgkmcnt(0)
    v_mfma_f32_16x16x32_bf16 a[0:3], a[224:227], a[160:163], a[0:3]
    ds_read_b64_tr_b16 a[232:233], v4 offset:20480
    v_mfma_f32_16x16x32_bf16 a[0:3], a[228:231], a[164:167], a[0:3]
    ds_read_b64_tr_b16 a[234:235], v4 offset:20992
    s_lshl1_add_u32 s71, s47, s45
    v_mfma_f32_16x16x32_bf16 a[4:7], a[224:227], a[168:171], a[4:7]
    ds_read_b64_tr_b16 a[236:237], v6 offset:20480
    buffer_load_dwordx4 v9, s[24:27], s74 offen lds
    v_mfma_f32_16x16x32_bf16 a[4:7], a[228:231], a[172:175], a[4:7]
    ds_read_b64_tr_b16 a[238:239], v6 offset:20992
    s_lshl_b32 s71, s71, 9
    v_mfma_f32_16x16x32_bf16 a[8:11], a[224:227], a[176:179], a[8:11]
    v_and_b32 v2, 0xf0, v13
    v_mfma_f32_16x16x32_bf16 a[8:11], a[228:231], a[180:183], a[8:11]
    v_lshlrev_b32 v2, 1, v2
    v_lshrrev_b32 v1, 1, v13
    v_mfma_f32_16x16x32_bf16 a[12:15], a[224:227], a[184:187], a[12:15]
    s_waitcnt vmcnt(8)
    v_add_f32 v28, v28, v14
    v_mfma_f32_16x16x32_bf16 a[12:15], a[228:231], a[188:191], a[12:15]
    v_add_f32 v29, v29, v15
    v_mfma_f32_16x16x32_bf16 a[16:19], a[224:227], a[192:195], a[16:19]
    v_add_f32 v30, v30, v16
    v_add_f32 v31, v31, v17
    v_mfma_f32_16x16x32_bf16 a[16:19], a[228:231], a[196:199], a[16:19]
    s_waitcnt vmcnt(7)
    v_add_f32 v28, v28, v18
    v_mfma_f32_16x16x32_bf16 a[20:23], a[224:227], a[200:203], a[20:23]
    buffer_load_dwordx4 v10, s[24:27], s74 offen offset:1024 lds
    v_add_f32 v29, v29, v19
    v_mfma_f32_16x16x32_bf16 a[20:23], a[228:231], a[204:207], a[20:23]
    v_add_f32 v30, v30, v20
    v_add_f32 v31, v31, v21
    v_mfma_f32_16x16x32_bf16 a[24:27], a[224:227], a[208:211], a[24:27]
    s_waitcnt vmcnt(7)
    v_add_f32 v28, v28, v22
    v_mfma_f32_16x16x32_bf16 a[24:27], a[228:231], a[212:215], a[24:27]
    v_add_f32 v29, v29, v23
    v_mfma_f32_16x16x32_bf16 a[28:31], a[224:227], a[216:219], a[28:31]
    v_add_f32 v30, v30, v24
    v_add_f32 v31, v31, v25
    v_mfma_f32_16x16x32_bf16 a[28:31], a[228:231], a[220:223], a[28:31]
    s_add_u32 s70, s71, 34086912
    buffer_load_dwordx4 v[14:17], v2, s[20:23], s70 offen sc1
    s_waitcnt lgkmcnt(0)
    v_mfma_f32_16x16x32_bf16 a[32:35], a[232:235], a[160:163], a[32:35]
    ds_read_b64_tr_b16 a[224:225], v3 offset:24576
    v_mfma_f32_16x16x32_bf16 a[32:35], a[236:239], a[164:167], a[32:35]
    ds_read_b64_tr_b16 a[226:227], v3 offset:25088
    v_mfma_f32_16x16x32_bf16 a[36:39], a[232:235], a[168:171], a[36:39]
    ds_read_b64_tr_b16 a[228:229], v5 offset:24576
    buffer_load_dwordx4 v11, s[24:27], s74 offen offset:2048 lds
    v_mfma_f32_16x16x32_bf16 a[36:39], a[236:239], a[172:175], a[36:39]
    ds_read_b64_tr_b16 a[230:231], v5 offset:25088
    v_mfma_f32_16x16x32_bf16 a[40:43], a[232:235], a[176:179], a[40:43]
    v_mfma_f32_16x16x32_bf16 a[40:43], a[236:239], a[180:183], a[40:43]
    buffer_load_dwordx4 v[18:21], v2, s[20:23], s70 offen offset:16 sc1
    s_waitcnt vmcnt(9)
    v_accvgpr_read_b32 v26, a240
    v_add_f32 v28, v28, v26
    v_mfma_f32_16x16x32_bf16 a[44:47], a[232:235], a[184:187], a[44:47]
    v_accvgpr_read_b32 v26, a241
    v_mfma_f32_16x16x32_bf16 a[44:47], a[236:239], a[188:191], a[44:47]
    v_add_f32 v29, v29, v26
    v_accvgpr_read_b32 v26, a242
    v_mfma_f32_16x16x32_bf16 a[48:51], a[232:235], a[192:195], a[48:51]
    v_add_f32 v30, v30, v26
    v_mfma_f32_16x16x32_bf16 a[48:51], a[236:239], a[196:199], a[48:51]
    v_accvgpr_read_b32 v26, a243
    v_mfma_f32_16x16x32_bf16 a[52:55], a[232:235], a[200:203], a[52:55]
    buffer_load_dwordx4 v12, s[24:27], s74 offen offset:3072 lds
    v_add_f32 v31, v31, v26
    s_lshl1_add_u32 s70, s71, 34111488
    v_mfma_f32_16x16x32_bf16 a[52:55], a[236:239], a[204:207], a[52:55]
    buffer_load_dwordx2 a[240:241], v1, s[20:23], s70 offen sc1
    buffer_load_dwordx2 a[242:243], v1, s[20:23], s70 offen offset:512 sc1
    s_waitcnt vmcnt(11)
    v_accvgpr_read_b32 v26, a244
    v_mfma_f32_16x16x32_bf16 a[56:59], a[232:235], a[208:211], a[56:59]
    v_add_f32 v28, v28, v26
    v_accvgpr_read_b32 v26, a245
    v_mfma_f32_16x16x32_bf16 a[56:59], a[236:239], a[212:215], a[56:59]
    v_add_f32 v29, v29, v26
    v_mfma_f32_16x16x32_bf16 a[60:63], a[232:235], a[216:219], a[60:63]
    s_add_u32 m0, s59, 98304
    v_accvgpr_read_b32 v26, a246
    v_add_f32 v30, v30, v26
    v_mfma_f32_16x16x32_bf16 a[60:63], a[236:239], a[220:223], a[60:63]
    v_accvgpr_read_b32 v26, a247
    s_waitcnt lgkmcnt(0)
    v_mfma_f32_16x16x32_bf16 v[32:35], a[224:227], a[160:163], v[32:35]
    ds_read_b64_tr_b16 a[232:233], v4 offset:24576
    v_add_f32 v31, v31, v26
    v_mfma_f32_16x16x32_bf16 v[32:35], a[228:231], a[164:167], v[32:35]
    ds_read_b64_tr_b16 a[234:235], v4 offset:25088
    s_waitcnt vmcnt(10)
    v_accvgpr_read_b32 v26, a248
    v_mfma_f32_16x16x32_bf16 v[36:39], a[224:227], a[168:171], v[36:39]
    ds_read_b64_tr_b16 a[236:237], v6 offset:24576
    v_add_f32 v28, v28, v26
    v_mfma_f32_16x16x32_bf16 v[36:39], a[228:231], a[172:175], v[36:39]
    ds_read_b64_tr_b16 a[238:239], v6 offset:25088
    v_accvgpr_read_b32 v26, a249
    v_mfma_f32_16x16x32_bf16 v[40:43], a[224:227], a[176:179], v[40:43]
    v_add_f32 v29, v29, v26
    v_mfma_f32_16x16x32_bf16 v[40:43], a[228:231], a[180:183], v[40:43]
    s_add_u32 s74, s53, 131072
    v_accvgpr_read_b32 v26, a250
    v_add_f32 v30, v30, v26
    v_mfma_f32_16x16x32_bf16 v[44:47], a[224:227], a[184:187], v[44:47]
    v_accvgpr_read_b32 v26, a251
    v_mfma_f32_16x16x32_bf16 v[44:47], a[228:231], a[188:191], v[44:47]
    v_add_f32 v31, v31, v26
    v_mfma_f32_16x16x32_bf16 v[48:51], a[224:227], a[192:195], v[48:51]
    s_waitcnt vmcnt(9)
    v_accvgpr_read_b32 v26, a252
    v_add_f32 v28, v28, v26
    v_mfma_f32_16x16x32_bf16 v[48:51], a[228:231], a[196:199], v[48:51]
    v_accvgpr_read_b32 v26, a253
    v_mfma_f32_16x16x32_bf16 v[52:55], a[224:227], a[200:203], v[52:55]
    v_add_f32 v29, v29, v26
    v_mfma_f32_16x16x32_bf16 v[52:55], a[228:231], a[204:207], v[52:55]
    v_accvgpr_read_b32 v26, a254
    v_add_f32 v30, v30, v26
    v_mfma_f32_16x16x32_bf16 v[56:59], a[224:227], a[208:211], v[56:59]
    buffer_load_dwordx4 v9, s[24:27], s74 offen lds
    v_accvgpr_read_b32 v26, a255
    v_mfma_f32_16x16x32_bf16 v[56:59], a[228:231], a[212:215], v[56:59]
    v_add_f32 v31, v31, v26
    v_mfma_f32_16x16x32_bf16 v[60:63], a[224:227], a[216:219], v[60:63]
    v_cvt_pk_bf16_f32 v26, v28, v28
    v_lshlrev_b32 v26, 16, v26
    v_mfma_f32_16x16x32_bf16 v[60:63], a[228:231], a[220:223], v[60:63]
    v_sub_f32 v26, v28, v26
    s_waitcnt lgkmcnt(0)
    v_mfma_f32_16x16x32_bf16 v[64:67], a[232:235], a[160:163], v[64:67]
    ds_read_b64_tr_b16 a[224:225], v3 offset:28672
    v_cvt_pk_bf16_f32 v28, v28, v26
    v_mfma_f32_16x16x32_bf16 v[64:67], a[236:239], a[164:167], v[64:67]
    ds_read_b64_tr_b16 a[226:227], v3 offset:29184
    v_cvt_pk_bf16_f32 v26, v29, v29
    v_mfma_f32_16x16x32_bf16 v[68:71], a[232:235], a[168:171], v[68:71]
    ds_read_b64_tr_b16 a[228:229], v5 offset:28672
    v_lshlrev_b32 v26, 16, v26
    v_mfma_f32_16x16x32_bf16 v[68:71], a[236:239], a[172:175], v[68:71]
    ds_read_b64_tr_b16 a[230:231], v5 offset:29184
    v_sub_f32 v26, v29, v26
    v_mfma_f32_16x16x32_bf16 v[72:75], a[232:235], a[176:179], v[72:75]
    buffer_load_dwordx4 v10, s[24:27], s74 offen offset:1024 lds
    v_cvt_pk_bf16_f32 v29, v29, v26
    v_mfma_f32_16x16x32_bf16 v[72:75], a[236:239], a[180:183], v[72:75]
    v_cvt_pk_bf16_f32 v26, v30, v30
    v_lshlrev_b32 v26, 16, v26
    v_mfma_f32_16x16x32_bf16 v[76:79], a[232:235], a[184:187], v[76:79]
    v_sub_f32 v26, v30, v26
    v_mfma_f32_16x16x32_bf16 v[76:79], a[236:239], a[188:191], v[76:79]
    v_cvt_pk_bf16_f32 v30, v30, v26
    v_mfma_f32_16x16x32_bf16 v[80:83], a[232:235], a[192:195], v[80:83]
    v_cvt_pk_bf16_f32 v26, v31, v31
    v_lshlrev_b32 v26, 16, v26
    v_mfma_f32_16x16x32_bf16 v[80:83], a[236:239], a[196:199], v[80:83]
    v_sub_f32 v26, v31, v26
    v_mfma_f32_16x16x32_bf16 v[84:87], a[232:235], a[200:203], v[84:87]
    v_cvt_pk_bf16_f32 v31, v31, v26
    s_lshl_b32 s70, s46, 10
    v_mfma_f32_16x16x32_bf16 v[84:87], a[236:239], a[204:207], v[84:87]
    s_add_u32 s71, s70, 151552
    v_lshrrev_b32 v2, 1, v2
    v_mfma_f32_16x16x32_bf16 v[88:91], a[232:235], a[208:211], v[88:91]
    buffer_load_dwordx4 v11, s[24:27], s74 offen offset:2048 lds
    v_add_u32 v2, s71, v2
    s_lshl_b32 s70, s44, 10
    v_mfma_f32_16x16x32_bf16 v[88:91], a[236:239], a[212:215], v[88:91]
    s_add_u32 s71, s70, 151552
    v_add_u32 v26, s71, v13
    v_mfma_f32_16x16x32_bf16 v[92:95], a[232:235], a[216:219], v[92:95]
L_pad1_7:
    s_cbranch_execz L_pad1_11
    ds_write_b128 v26, v[28:31]
    v_mfma_f32_16x16x32_bf16 v[92:95], a[236:239], a[220:223], v[92:95]
    s_lshl_b32 s70, s46, 11
    s_waitcnt lgkmcnt(1)
    v_mfma_f32_16x16x32_bf16 v[96:99], a[224:227], a[160:163], v[96:99]
    ds_read_b64_tr_b16 a[232:233], v4 offset:28672
    v_mfma_f32_16x16x32_bf16 v[96:99], a[228:231], a[164:167], v[96:99]
    ds_read_b64_tr_b16 a[234:235], v4 offset:29184
    v_mfma_f32_16x16x32_bf16 v[100:103], a[224:227], a[168:171], v[100:103]
    ds_read_b64_tr_b16 a[236:237], v6 offset:28672
    v_mfma_f32_16x16x32_bf16 v[100:103], a[228:231], a[172:175], v[100:103]
    ds_read_b64_tr_b16 a[238:239], v6 offset:29184
    v_mfma_f32_16x16x32_bf16 v[104:107], a[224:227], a[176:179], v[104:107]
    buffer_load_dwordx4 v12, s[24:27], s74 offen offset:3072 lds
    v_mfma_f32_16x16x32_bf16 v[104:107], a[228:231], a[180:183], v[104:107]
    v_mfma_f32_16x16x32_bf16 v[108:111], a[224:227], a[184:187], v[108:111]
    v_mfma_f32_16x16x32_bf16 v[108:111], a[228:231], a[188:191], v[108:111]
    v_mfma_f32_16x16x32_bf16 v[112:115], a[224:227], a[192:195], v[112:115]
    s_add_u32 m0, s59, 114688
    v_mfma_f32_16x16x32_bf16 v[112:115], a[228:231], a[196:199], v[112:115]
    v_mfma_f32_16x16x32_bf16 v[116:119], a[224:227], a[200:203], v[116:119]
    v_mfma_f32_16x16x32_bf16 v[116:119], a[228:231], a[204:207], v[116:119]
    v_mfma_f32_16x16x32_bf16 v[120:123], a[224:227], a[208:211], v[120:123]
    v_mfma_f32_16x16x32_bf16 v[120:123], a[228:231], a[212:215], v[120:123]
    v_mfma_f32_16x16x32_bf16 v[124:127], a[224:227], a[216:219], v[124:127]
    v_mfma_f32_16x16x32_bf16 v[124:127], a[228:231], a[220:223], v[124:127]
    s_waitcnt lgkmcnt(0)
    s_barrier
    v_mfma_f32_16x16x32_bf16 v[128:131], a[232:235], a[160:163], v[128:131]
    ds_read_b64_tr_b16 a[224:225], v3 offset:32768
    v_mfma_f32_16x16x32_bf16 v[128:131], a[236:239], a[164:167], v[128:131]
    ds_read_b64_tr_b16 a[226:227], v3 offset:33280
    v_mfma_f32_16x16x32_bf16 v[132:135], a[232:235], a[168:171], v[132:135]
    ds_read_b64_tr_b16 a[228:229], v5 offset:32768
    v_mfma_f32_16x16x32_bf16 v[132:135], a[236:239], a[172:175], v[132:135]
    ds_read_b64_tr_b16 a[230:231], v5 offset:33280
    v_mfma_f32_16x16x32_bf16 v[136:139], a[232:235], a[176:179], v[136:139]
    s_add_u32 s74, s53, 262144
    ds_read2st64_b32 a[96:97], v2 offset0:0 offset1:8
    v_mfma_f32_16x16x32_bf16 v[136:139], a[236:239], a[180:183], v[136:139]
    ds_read2st64_b32 a[104:105], v2 offset0:1 offset1:9
    v_mfma_f32_16x16x32_bf16 v[140:143], a[232:235], a[184:187], v[140:143]
    buffer_load_dwordx4 v9, s[24:27], s74 offen lds
    ds_read2st64_b32 a[112:113], v2 offset0:2 offset1:10
    v_mfma_f32_16x16x32_bf16 v[140:143], a[236:239], a[188:191], v[140:143]
    v_add_u32 v2, 4, v2
    v_mfma_f32_16x16x32_bf16 v[144:147], a[232:235], a[192:195], v[144:147]
    v_mfma_f32_16x16x32_bf16 v[144:147], a[236:239], a[196:199], v[144:147]
    ds_read2st64_b32 a[98:99], v2 offset0:0 offset1:8
    v_mfma_f32_16x16x32_bf16 v[148:151], a[232:235], a[200:203], v[148:151]
    ds_read2st64_b32 a[106:107], v2 offset0:1 offset1:9
    v_mfma_f32_16x16x32_bf16 v[148:151], a[236:239], a[204:207], v[148:151]
    ds_read2st64_b32 a[114:115], v2 offset0:2 offset1:10
    v_mfma_f32_16x16x32_bf16 v[152:155], a[232:235], a[208:211], v[152:155]
    v_add_u32 v2, 4, v2
    v_mfma_f32_16x16x32_bf16 v[152:155], a[236:239], a[212:215], v[152:155]
    v_mfma_f32_16x16x32_bf16 v[156:159], a[232:235], a[216:219], v[156:159]
    buffer_load_dwordx4 v10, s[24:27], s74 offen offset:1024 lds
    ds_read2st64_b32 a[100:101], v2 offset0:0 offset1:8
    v_mfma_f32_16x16x32_bf16 v[156:159], a[236:239], a[220:223], v[156:159]
    ds_read2st64_b32 a[108:109], v2 offset0:1 offset1:9
    s_waitcnt lgkmcnt(8)
    v_mfma_f32_16x16x32_bf16 v[160:163], a[224:227], a[160:163], v[160:163]
    ds_read_b64_tr_b16 a[232:233], v4 offset:32768
    v_add_u32 v2, 4, v2
    v_mfma_f32_16x16x32_bf16 v[160:163], a[228:231], a[164:167], v[160:163]
    ds_read_b64_tr_b16 a[234:235], v4 offset:33280
    v_mfma_f32_16x16x32_bf16 v[164:167], a[224:227], a[168:171], v[164:167]
    ds_read_b64_tr_b16 a[236:237], v6 offset:32768
    v_mfma_f32_16x16x32_bf16 v[164:167], a[228:231], a[172:175], v[164:167]
    ds_read_b64_tr_b16 a[238:239], v6 offset:33280
    v_mfma_f32_16x16x32_bf16 v[168:171], a[224:227], a[176:179], v[168:171]
    ds_read2st64_b32 a[102:103], v2 offset0:0 offset1:8
    v_mfma_f32_16x16x32_bf16 v[168:171], a[228:231], a[180:183], v[168:171]
    ds_read2st64_b32 a[110:111], v2 offset0:1 offset1:9
    v_lshrrev_b32 v1, 2, v0
    v_mfma_f32_16x16x32_bf16 v[172:175], a[224:227], a[184:187], v[172:175]
    buffer_load_dwordx4 v11, s[24:27], s74 offen offset:2048 lds
    v_lshlrev_b32 v1, 6, v1
    v_mfma_f32_16x16x32_bf16 v[172:175], a[228:231], a[188:191], v[172:175]
    v_and_b32 v2, 3, v0
    v_mfma_f32_16x16x32_bf16 v[176:179], a[224:227], a[192:195], v[176:179]
    v_lshl_add_u32 v1, v2, 3, v1
    v_mfma_f32_16x16x32_bf16 v[176:179], a[228:231], a[196:199], v[176:179]
    s_add_u32 s70, s70, 147456
    v_mfma_f32_16x16x32_bf16 v[180:183], a[224:227], a[200:203], v[180:183]
    v_add_u32 v1, s70, v1
    v_mfma_f32_16x16x32_bf16 v[180:183], a[228:231], a[204:207], v[180:183]
    v_mfma_f32_16x16x32_bf16 v[184:187], a[224:227], a[208:211], v[184:187]
    v_bfe_u32 v30, v13, 4, 4
    v_mfma_f32_16x16x32_bf16 v[184:187], a[228:231], a[212:215], v[184:187]
    v_lshl_add_u32 v30, v30, 11, s54
    v_mfma_f32_16x16x32_bf16 v[188:191], a[224:227], a[216:219], v[188:191]
    buffer_load_dwordx4 v12, s[24:27], s74 offen offset:3072 lds
    v_bfe_u32 v31, v13, 8, 1
    v_mfma_f32_16x16x32_bf16 v[188:191], a[228:231], a[220:223], v[188:191]
    v_lshl_add_u32 v30, v31, 5, v30
    s_waitcnt lgkmcnt(2)
    v_mfma_f32_16x16x32_bf16 v[192:195], a[232:235], a[160:163], v[192:195]
    ds_read_b64_tr_b16 a[224:225], v3 offset:36864
    v_lshrrev_b32 v31, 9, v13
    v_mfma_f32_16x16x32_bf16 v[192:195], a[236:239], a[164:167], v[192:195]
    ds_read_b64_tr_b16 a[226:227], v3 offset:37376
    v_lshl_add_u32 v30, v31, 4, v30
    v_mfma_f32_16x16x32_bf16 v[196:199], a[232:235], a[168:171], v[196:199]
    ds_read_b64_tr_b16 a[228:229], v5 offset:36864
    s_add_u32 m0, s59, 131072
    v_mfma_f32_16x16x32_bf16 v[196:199], a[236:239], a[172:175], v[196:199]
    ds_read_b64_tr_b16 a[230:231], v5 offset:37376
    s_mov_b32 s75, 32768
    v_mfma_f32_16x16x32_bf16 v[200:203], a[232:235], a[176:179], v[200:203]
    buffer_load_dwordx4 a[144:147], v30, s[4:7], 0 offen
    v_mfma_f32_16x16x32_bf16 v[200:203], a[236:239], a[180:183], v[200:203]
    v_mfma_f32_16x16x32_bf16 v[204:207], a[232:235], a[184:187], v[204:207]
    v_mfma_f32_16x16x32_bf16 v[204:207], a[236:239], a[188:191], v[204:207]
    v_mfma_f32_16x16x32_bf16 v[208:211], a[232:235], a[192:195], v[208:211]
    buffer_load_dwordx4 a[148:151], v30, s[4:7], 0 offen offset:64
    v_mfma_f32_16x16x32_bf16 v[208:211], a[236:239], a[196:199], v[208:211]
    s_add_u32 s74, s53, 393216
    v_mfma_f32_16x16x32_bf16 v[212:215], a[232:235], a[200:203], v[212:215]
    v_mfma_f32_16x16x32_bf16 v[212:215], a[236:239], a[204:207], v[212:215]
    v_mfma_f32_16x16x32_bf16 v[216:219], a[232:235], a[208:211], v[216:219]
    buffer_load_dwordx4 a[152:155], v30, s[4:7], s75 offen
    v_mfma_f32_16x16x32_bf16 v[216:219], a[236:239], a[212:215], v[216:219]
    v_mfma_f32_16x16x32_bf16 v[220:223], a[232:235], a[216:219], v[220:223]
    v_mfma_f32_16x16x32_bf16 v[220:223], a[236:239], a[220:223], v[220:223]
    s_waitcnt lgkmcnt(0)
    v_mfma_f32_16x16x32_bf16 v[224:227], a[224:227], a[160:163], v[224:227]
    ds_read_b64_tr_b16 a[232:233], v4 offset:36864
    buffer_load_dwordx4 v9, s[24:27], s74 offen lds
    v_mfma_f32_16x16x32_bf16 v[224:227], a[228:231], a[164:167], v[224:227]
    ds_read_b64_tr_b16 a[234:235], v4 offset:37376
    v_mfma_f32_16x16x32_bf16 v[228:231], a[224:227], a[168:171], v[228:231]
    ds_read_b64_tr_b16 a[236:237], v6 offset:36864
    v_mfma_f32_16x16x32_bf16 v[228:231], a[228:231], a[172:175], v[228:231]
    ds_read_b64_tr_b16 a[238:239], v6 offset:37376
    v_mfma_f32_16x16x32_bf16 v[232:235], a[224:227], a[176:179], v[232:235]
    buffer_load_dwordx4 a[156:159], v30, s[4:7], s75 offen offset:64
    s_lshl1_add_u32 s70, s47, s45
    s_mul_i32 s70, s70, 16384
    v_mfma_f32_16x16x32_bf16 v[232:235], a[228:231], a[180:183], v[232:235]
    s_lshl_b32 s71, s46, 11
    s_mul_i32 s90, s62, 2048
    s_add_u32 s90, s90, s70
    v_mfma_f32_16x16x32_bf16 v[236:239], a[224:227], a[184:187], v[236:239]
    s_add_u32 s90, s90, s71
    s_lshr_b32 s91, s64, 7
    s_mul_i32 s91, s91, 262144
    v_mfma_f32_16x16x32_bf16 v[236:239], a[228:231], a[188:191], v[236:239]
    s_add_u32 s91, s91, s70
    s_add_u32 s91, s91, s71
    s_mov_b32 s86, 0x3c0a3963
    v_mfma_f32_16x16x32_bf16 v[240:243], a[224:227], a[192:195], v[240:243]
    buffer_load_dwordx4 v10, s[24:27], s74 offen offset:1024 lds
    s_mov_b32 s88, 0xbf206c99
    v_mfma_f32_16x16x32_bf16 v[240:243], a[228:231], a[196:199], v[240:243]
    s_waitcnt vmcnt(19)
    v_rcp_f32 v22, v14
    v_mfma_f32_16x16x32_bf16 v[244:247], a[224:227], a[200:203], v[244:247]
    v_rcp_f32 v23, v15
    v_mfma_f32_16x16x32_bf16 v[244:247], a[228:231], a[204:207], v[244:247]
    v_rcp_f32 v24, v16
    v_mfma_f32_16x16x32_bf16 v[248:251], a[224:227], a[208:211], v[248:251]
    v_rcp_f32 v25, v17
    v_mfma_f32_16x16x32_bf16 v[248:251], a[228:231], a[212:215], v[248:251]
    s_waitcnt vmcnt(17)
    v_rcp_f32 v26, v18
    v_mfma_f32_16x16x32_bf16 v[252:255], a[224:227], a[216:219], v[252:255]
    v_rcp_f32 v27, v19
    v_mfma_f32_16x16x32_bf16 v[252:255], a[228:231], a[220:223], v[252:255]
    s_waitcnt lgkmcnt(0)
    v_mfma_f32_16x16x32_bf16 a[64:67], a[232:235], a[160:163], a[64:67]
    buffer_load_dwordx4 v11, s[24:27], s74 offen offset:2048 lds
    ds_read_b64_tr_b16 a[244:245], v1
    v_mfma_f32_16x16x32_bf16 a[64:67], a[236:239], a[164:167], a[64:67]
    ds_read_b64_tr_b16 a[246:247], v1 offset:1024
    v_mfma_f32_16x16x32_bf16 a[68:71], a[232:235], a[168:171], a[68:71]
    ds_read_b64_tr_b16 a[248:249], v1 offset:32
    v_mfma_f32_16x16x32_bf16 a[68:71], a[236:239], a[172:175], a[68:71]
    ds_read_b64_tr_b16 a[250:251], v1 offset:1056
    v_mfma_f32_16x16x32_bf16 a[72:75], a[232:235], a[176:179], a[72:75]
    v_rcp_f32 v28, v20
    v_mfma_f32_16x16x32_bf16 a[72:75], a[236:239], a[180:183], a[72:75]
    v_rcp_f32 v29, v21
    v_mfma_f32_16x16x32_bf16 a[76:79], a[232:235], a[184:187], a[76:79]
    v_mul_f32 v22, 0xc0135761, v22
    v_mul_f32 v14, v14, v14
    v_mfma_f32_16x16x32_bf16 a[76:79], a[236:239], a[188:191], a[76:79]
    v_mul_f32 v23, 0xc0135761, v23
    v_mul_f32 v15, v15, v15
    v_mfma_f32_16x16x32_bf16 a[80:83], a[232:235], a[192:195], a[80:83]
    buffer_load_dwordx4 v12, s[24:27], s74 offen offset:3072 lds
    v_mul_f32 v24, 0xc0135761, v24
    v_mul_f32 v16, v16, v16
    v_mfma_f32_16x16x32_bf16 a[80:83], a[236:239], a[196:199], a[80:83]
    v_mul_f32 v25, 0xc0135761, v25
    v_mul_f32 v17, v17, v17
    v_mfma_f32_16x16x32_bf16 a[84:87], a[232:235], a[200:203], a[84:87]
    v_mul_f32 v26, 0xc0135761, v26
    v_mul_f32 v18, v18, v18
    v_mfma_f32_16x16x32_bf16 a[84:87], a[236:239], a[204:207], a[84:87]
    v_mul_f32 v27, 0xc0135761, v27
    v_mul_f32 v19, v19, v19
    v_mfma_f32_16x16x32_bf16 a[88:91], a[232:235], a[208:211], a[88:91]
    v_mul_f32 v28, 0xc0135761, v28
    v_mul_f32 v20, v20, v20
    v_mfma_f32_16x16x32_bf16 a[88:91], a[236:239], a[212:215], a[88:91]
    v_mul_f32 v29, 0xc0135761, v29
    v_mul_f32 v21, v21, v21
    v_mfma_f32_16x16x32_bf16 a[92:95], a[232:235], a[216:219], a[92:95]
    v_mfma_f32_16x16x32_bf16 a[92:95], a[236:239], a[220:223], a[92:95]
    s_waitcnt vmcnt(17)
    v_mfma_f32_16x16x4_4b_bf16 v[32:47], a[100:101], a[240:241], v[32:47]
    v_mfma_f32_16x16x4_4b_bf16 v[64:79], a[102:103], a[240:241], v[64:79]
    v_mfma_f32_16x16x4_4b_bf16 v[96:111], a[104:105], a[240:241], v[96:111]
    v_mfma_f32_16x16x4_4b_bf16 v[128:143], a[106:107], a[240:241], v[128:143]
    v_pk_mul_f32 v[30:31], v[22:23], s[86:87] op_sel_hi:[1,0]
    v_pk_mul_f32 v[30:31], v[30:31], v[22:23]
    v_pk_mul_f32 v[30:31], v[30:31], v[22:23]
    s_nop 5
    s_nop 0
    v_pk_mul_f32 v[0:1], v[32:33], v[32:33]
    v_pk_mul_f32 v[2:3], v[34:35], v[34:35]
    v_pk_mul_f32 v[4:5], v[64:65], v[64:65]
    v_pk_mul_f32 v[6:7], v[66:67], v[66:67]
    v_pk_fma_f32 v[0:1], v[0:1], v[30:31], v[22:23] op_sel:[0,0,0] op_sel_hi:[1,0,0]
    v_pk_fma_f32 v[2:3], v[2:3], v[30:31], v[22:23] op_sel:[0,0,0] op_sel_hi:[1,0,0]
    v_pk_fma_f32 v[4:5], v[4:5], v[30:31], v[22:23] op_sel:[0,0,0] op_sel_hi:[1,0,0]
    v_pk_fma_f32 v[6:7], v[6:7], v[30:31], v[22:23] op_sel:[0,0,0] op_sel_hi:[1,0,0]
    v_pk_mul_f32 v[0:1], v[0:1], v[32:33]
    v_pk_mul_f32 v[2:3], v[2:3], v[34:35]
    v_pk_mul_f32 v[4:5], v[4:5], v[64:65]
    v_pk_mul_f32 v[6:7], v[6:7], v[66:67]
    v_exp_f32 v0, v0
    v_exp_f32 v1, v1
    s_waitcnt vmcnt(16)
    v_mfma_f32_16x16x4_4b_bf16 v[48:63], a[100:101], a[242:243], v[48:63]
    v_exp_f32 v2, v2
    v_exp_f32 v3, v3
    v_exp_f32 v4, v4
    v_exp_f32 v5, v5
    v_exp_f32 v6, v6
    v_exp_f32_e64 v7, v7
    v_pk_mul_f32 v[96:97], v[32:33], v[96:97]
    v_pk_mul_f32 v[98:99], v[34:35], v[98:99]
    v_pk_mul_f32 v[128:129], v[64:65], v[128:129]
    v_pk_mul_f32 v[130:131], v[66:67], v[130:131]
    v_pk_fma_f32 v[0:1], v[0:1], v[14:15], v[14:15] op_sel:[0,0,0] op_sel_hi:[1,0,0]
    v_pk_fma_f32 v[2:3], v[2:3], v[14:15], v[14:15] op_sel:[0,0,0] op_sel_hi:[1,0,0]
    v_pk_fma_f32 v[4:5], v[4:5], v[14:15], v[14:15] op_sel:[0,0,0] op_sel_hi:[1,0,0]
    v_pk_fma_f32 v[6:7], v[6:7], v[14:15], v[14:15] op_sel:[0,0,0] op_sel_hi:[1,0,0]
    v_rcp_f32 v0, v0
    v_rcp_f32 v1, v1
    v_mfma_f32_16x16x4_4b_bf16 v[80:95], a[102:103], a[242:243], v[80:95]
    v_rcp_f32 v2, v2
    v_rcp_f32 v3, v3
    v_rcp_f32 v4, v4
    v_rcp_f32 v5, v5
    v_rcp_f32 v6, v6
    v_rcp_f32 v7, v7
    v_pk_mul_f32 v[96:97], v[96:97], v[0:1]
    v_pk_mul_f32 v[98:99], v[98:99], v[2:3]
    v_pk_mul_f32 v[128:129], v[128:129], v[4:5]
    v_pk_mul_f32 v[130:131], v[130:131], v[6:7]
    v_cvt_pk_bf16_f32 v32, v96, v97
    v_cvt_pk_bf16_f32 v33, v98, v99
    v_cvt_pk_bf16_f32 v34, v128, v129
    v_cvt_pk_bf16_f32 v35, v130, v131
    buffer_store_dwordx4 v[32:35], v13, s[20:23], s90 offen sc1
    s_waitcnt lgkmcnt(0)
    s_barrier
    s_add_u32 m0, s59, 0
    s_nop 0
    s_add_u32 s74, s53, 524288
    buffer_load_dwordx4 v9, s[24:27], s74 offen lds
    v_pk_mul_f32 v[0:1], v[36:37], v[36:37]
    v_pk_mul_f32 v[2:3], v[38:39], v[38:39]
    v_pk_mul_f32 v[4:5], v[68:69], v[68:69]
    v_pk_mul_f32 v[6:7], v[70:71], v[70:71]
    v_pk_fma_f32 v[0:1], v[0:1], v[30:31], v[22:23] op_sel:[0,1,1] op_sel_hi:[1,1,1]
    v_pk_fma_f32 v[2:3], v[2:3], v[30:31], v[22:23] op_sel:[0,1,1] op_sel_hi:[1,1,1]
    v_pk_fma_f32 v[4:5], v[4:5], v[30:31], v[22:23] op_sel:[0,1,1] op_sel_hi:[1,1,1]
    v_pk_fma_f32 v[6:7], v[6:7], v[30:31], v[22:23] op_sel:[0,1,1] op_sel_hi:[1,1,1]
    v_pk_mul_f32 v[0:1], v[0:1], v[36:37]
    v_pk_mul_f32 v[2:3], v[2:3], v[38:39]
    v_pk_mul_f32 v[4:5], v[4:5], v[68:69]
    v_pk_mul_f32 v[6:7], v[6:7], v[70:71]
    v_exp_f32 v0, v0
    v_exp_f32 v1, v1
    v_mfma_f32_16x16x4_4b_bf16 v[112:127], a[104:105], a[242:243], v[112:127]
    v_exp_f32 v2, v2
    v_exp_f32 v3, v3
    v_exp_f32 v4, v4
    v_exp_f32 v5, v5
    v_exp_f32 v6, v6
    v_exp_f32 v7, v7
    v_pk_mul_f32 v[100:101], v[36:37], v[100:101]
    v_pk_mul_f32 v[102:103], v[38:39], v[102:103]
    v_pk_mul_f32 v[132:133], v[68:69], v[132:133]
    v_pk_mul_f32 v[134:135], v[70:71], v[134:135]
    v_pk_fma_f32 v[0:1], v[0:1], v[14:15], v[14:15] op_sel:[0,1,1] op_sel_hi:[1,1,1]
    v_pk_fma_f32 v[2:3], v[2:3], v[14:15], v[14:15] op_sel:[0,1,1] op_sel_hi:[1,1,1]
    v_pk_fma_f32 v[4:5], v[4:5], v[14:15], v[14:15] op_sel:[0,1,1] op_sel_hi:[1,1,1]
    v_pk_fma_f32 v[6:7], v[6:7], v[14:15], v[14:15] op_sel:[0,1,1] op_sel_hi:[1,1,1]
    v_rcp_f32 v0, v0
    v_rcp_f32 v1, v1
    v_mfma_f32_16x16x4_4b_bf16 v[144:159], a[106:107], a[242:243], v[144:159]
    v_rcp_f32 v2, v2
    v_rcp_f32 v3, v3
    v_rcp_f32 v4, v4
    v_rcp_f32 v5, v5
    v_rcp_f32 v6, v6
    v_rcp_f32 v7, v7
    v_pk_mul_f32 v[100:101], v[100:101], v[0:1]
    v_pk_mul_f32 v[102:103], v[102:103], v[2:3]
    v_pk_mul_f32 v[132:133], v[132:133], v[4:5]
    v_pk_mul_f32 v[134:135], v[134:135], v[6:7]
    v_cvt_pk_bf16_f32 v36, v100, v101
    v_cvt_pk_bf16_f32 v37, v102, v103
    v_cvt_pk_bf16_f32 v38, v132, v133
    v_cvt_pk_bf16_f32 v39, v134, v135
    buffer_store_dwordx4 v[36:39], v13, s[20:23], s90 offen offset:1024 sc1
    buffer_load_dwordx4 v10, s[24:27], s74 offen offset:1024 lds
    s_add_u32 s90, s90, 4096
    v_pk_mul_f32 v[30:31], v[24:25], s[86:87] op_sel_hi:[1,0]
    v_pk_mul_f32 v[30:31], v[30:31], v[24:25]
    v_pk_mul_f32 v[30:31], v[30:31], v[24:25]
    v_pk_mul_f32 v[0:1], v[40:41], v[40:41]
    v_pk_mul_f32 v[2:3], v[42:43], v[42:43]
    v_pk_mul_f32 v[4:5], v[72:73], v[72:73]
    v_pk_mul_f32 v[6:7], v[74:75], v[74:75]
    v_pk_fma_f32 v[0:1], v[0:1], v[30:31], v[24:25] op_sel:[0,0,0] op_sel_hi:[1,0,0]
    v_pk_fma_f32 v[2:3], v[2:3], v[30:31], v[24:25] op_sel:[0,0,0] op_sel_hi:[1,0,0]
    v_pk_fma_f32 v[4:5], v[4:5], v[30:31], v[24:25] op_sel:[0,0,0] op_sel_hi:[1,0,0]
    v_pk_fma_f32 v[6:7], v[6:7], v[30:31], v[24:25] op_sel:[0,0,0] op_sel_hi:[1,0,0]
    v_pk_mul_f32 v[0:1], v[0:1], v[40:41]
    v_pk_mul_f32 v[2:3], v[2:3], v[42:43]
    v_pk_mul_f32 v[4:5], v[4:5], v[72:73]
    v_pk_mul_f32 v[6:7], v[6:7], v[74:75]
    v_exp_f32 v0, v0
    v_exp_f32 v1, v1
    v_mfma_f32_16x16x4_4b_bf16 v[160:175], a[108:109], a[240:241], v[160:175]
    v_exp_f32 v2, v2
    v_exp_f32 v3, v3
    v_exp_f32 v4, v4
    v_exp_f32 v5, v5
    v_exp_f32 v6, v6
    v_exp_f32 v7, v7
    v_pk_mul_f32 v[104:105], v[40:41], v[104:105]
    v_pk_mul_f32 v[106:107], v[42:43], v[106:107]
    v_pk_mul_f32 v[136:137], v[72:73], v[136:137]
    v_pk_mul_f32 v[138:139], v[74:75], v[138:139]
    v_pk_fma_f32 v[0:1], v[0:1], v[16:17], v[16:17] op_sel:[0,0,0] op_sel_hi:[1,0,0]
    v_pk_fma_f32 v[2:3], v[2:3], v[16:17], v[16:17] op_sel:[0,0,0] op_sel_hi:[1,0,0]
    v_pk_fma_f32 v[4:5], v[4:5], v[16:17], v[16:17] op_sel:[0,0,0] op_sel_hi:[1,0,0]
    v_pk_fma_f32 v[6:7], v[6:7], v[16:17], v[16:17] op_sel:[0,0,0] op_sel_hi:[1,0,0]
    v_rcp_f32 v0, v0
    v_rcp_f32 v1, v1
    v_mfma_f32_16x16x4_4b_bf16 v[192:207], a[110:111], a[240:241], v[192:207]
    v_rcp_f32 v2, v2
    v_rcp_f32 v3, v3
    v_rcp_f32 v4, v4
    v_rcp_f32 v5, v5
    v_rcp_f32 v6, v6
    v_rcp_f32 v7, v7
    v_pk_mul_f32 v[104:105], v[104:105], v[0:1]
    v_pk_mul_f32 v[106:107], v[106:107], v[2:3]
    v_pk_mul_f32 v[136:137], v[136:137], v[4:5]
    v_pk_mul_f32 v[138:139], v[138:139], v[6:7]
    v_cvt_pk_bf16_f32 v40, v104, v105
    v_cvt_pk_bf16_f32 v41, v106, v107
    v_cvt_pk_bf16_f32 v42, v136, v137
    v_cvt_pk_bf16_f32 v43, v138, v139
    buffer_store_dwordx4 v[40:43], v13, s[20:23], s90 offen sc1
    buffer_load_dwordx4 v11, s[24:27], s74 offen offset:2048 lds
    v_pk_mul_f32 v[0:1], v[44:45], v[44:45]
    v_pk_mul_f32 v[2:3], v[46:47], v[46:47]
    v_pk_mul_f32 v[4:5], v[76:77], v[76:77]
    v_pk_mul_f32 v[6:7], v[78:79], v[78:79]
    v_pk_fma_f32 v[0:1], v[0:1], v[30:31], v[24:25] op_sel:[0,1,1] op_sel_hi:[1,1,1]
    v_pk_fma_f32 v[2:3], v[2:3], v[30:31], v[24:25] op_sel:[0,1,1] op_sel_hi:[1,1,1]
    v_pk_fma_f32 v[4:5], v[4:5], v[30:31], v[24:25] op_sel:[0,1,1] op_sel_hi:[1,1,1]
    v_pk_fma_f32 v[6:7], v[6:7], v[30:31], v[24:25] op_sel:[0,1,1] op_sel_hi:[1,1,1]
    v_pk_mul_f32 v[0:1], v[0:1], v[44:45]
    v_pk_mul_f32 v[2:3], v[2:3], v[46:47]
    v_pk_mul_f32 v[4:5], v[4:5], v[76:77]
    v_pk_mul_f32 v[6:7], v[6:7], v[78:79]
    v_exp_f32 v0, v0
    v_exp_f32 v1, v1
    v_mfma_f32_16x16x4_4b_bf16 v[224:239], a[112:113], a[240:241], v[224:239]
    v_exp_f32 v2, v2
    v_exp_f32 v3, v3
    v_exp_f32 v4, v4
    v_exp_f32 v5, v5
    v_exp_f32 v6, v6
    v_exp_f32 v7, v7
    v_pk_mul_f32 v[108:109], v[44:45], v[108:109]
    v_pk_mul_f32 v[110:111], v[46:47], v[110:111]
    v_pk_mul_f32 v[140:141], v[76:77], v[140:141]
    v_pk_mul_f32 v[142:143], v[78:79], v[142:143]
    v_pk_fma_f32 v[0:1], v[0:1], v[16:17], v[16:17] op_sel:[0,1,1] op_sel_hi:[1,1,1]
    v_pk_fma_f32 v[2:3], v[2:3], v[16:17], v[16:17] op_sel:[0,1,1] op_sel_hi:[1,1,1]
    v_pk_fma_f32 v[4:5], v[4:5], v[16:17], v[16:17] op_sel:[0,1,1] op_sel_hi:[1,1,1]
    v_pk_fma_f32 v[6:7], v[6:7], v[16:17], v[16:17] op_sel:[0,1,1] op_sel_hi:[1,1,1]
    v_rcp_f32 v0, v0
    v_rcp_f32 v1, v1
    v_mfma_f32_16x16x4_4b_bf16 a[64:79], a[114:115], a[240:241], a[64:79]
    v_rcp_f32 v2, v2
    v_rcp_f32 v3, v3
    v_rcp_f32 v4, v4
    v_rcp_f32 v5, v5
    v_rcp_f32 v6, v6
    v_rcp_f32 v7, v7
    v_pk_mul_f32 v[108:109], v[108:109], v[0:1]
    v_pk_mul_f32 v[110:111], v[110:111], v[2:3]
    v_pk_mul_f32 v[140:141], v[140:141], v[4:5]
    v_pk_mul_f32 v[142:143], v[142:143], v[6:7]
    v_cvt_pk_bf16_f32 v44, v108, v109
    v_cvt_pk_bf16_f32 v45, v110, v111
    v_cvt_pk_bf16_f32 v46, v140, v141
    v_cvt_pk_bf16_f32 v47, v142, v143
    buffer_store_dwordx4 v[44:47], v13, s[20:23], s90 offen offset:1024 sc1
    buffer_load_dwordx4 v12, s[24:27], s74 offen offset:3072 lds
    s_add_u32 s90, s90, 4096
    v_pk_mul_f32 v[30:31], v[26:27], s[86:87] op_sel_hi:[1,0]
    v_pk_mul_f32 v[30:31], v[30:31], v[26:27]
    v_pk_mul_f32 v[30:31], v[30:31], v[26:27]
    v_pk_mul_f32 v[0:1], v[48:49], v[48:49]
    v_pk_mul_f32 v[2:3], v[50:51], v[50:51]
    v_pk_mul_f32 v[4:5], v[80:81], v[80:81]
    v_pk_mul_f32 v[6:7], v[82:83], v[82:83]
    v_pk_fma_f32 v[0:1], v[0:1], v[30:31], v[26:27] op_sel:[0,0,0] op_sel_hi:[1,0,0]
    v_pk_fma_f32 v[2:3], v[2:3], v[30:31], v[26:27] op_sel:[0,0,0] op_sel_hi:[1,0,0]
    v_pk_fma_f32 v[4:5], v[4:5], v[30:31], v[26:27] op_sel:[0,0,0] op_sel_hi:[1,0,0]
    v_pk_fma_f32 v[6:7], v[6:7], v[30:31], v[26:27] op_sel:[0,0,0] op_sel_hi:[1,0,0]
    v_pk_mul_f32 v[0:1], v[0:1], v[48:49]
    v_pk_mul_f32 v[2:3], v[2:3], v[50:51]
    v_pk_mul_f32 v[4:5], v[4:5], v[80:81]
    v_pk_mul_f32 v[6:7], v[6:7], v[82:83]
    v_exp_f32 v0, v0
    v_exp_f32 v1, v1
    v_mfma_f32_16x16x4_4b_bf16 v[176:191], a[108:109], a[242:243], v[176:191]
    v_exp_f32 v2, v2
    v_exp_f32 v3, v3
    v_exp_f32 v4, v4
    v_exp_f32 v5, v5
    v_exp_f32 v6, v6
    v_exp_f32 v7, v7
    v_pk_mul_f32 v[112:113], v[48:49], v[112:113]
    v_pk_mul_f32 v[114:115], v[50:51], v[114:115]
    v_pk_mul_f32 v[144:145], v[80:81], v[144:145]
    v_pk_mul_f32 v[146:147], v[82:83], v[146:147]
    v_pk_fma_f32 v[0:1], v[0:1], v[18:19], v[18:19] op_sel:[0,0,0] op_sel_hi:[1,0,0]
    v_pk_fma_f32 v[2:3], v[2:3], v[18:19], v[18:19] op_sel:[0,0,0] op_sel_hi:[1,0,0]
    v_pk_fma_f32 v[4:5], v[4:5], v[18:19], v[18:19] op_sel:[0,0,0] op_sel_hi:[1,0,0]
    v_pk_fma_f32 v[6:7], v[6:7], v[18:19], v[18:19] op_sel:[0,0,0] op_sel_hi:[1,0,0]
    v_rcp_f32 v0, v0
    v_rcp_f32 v1, v1
    v_mfma_f32_16x16x4_4b_bf16 v[208:223], a[110:111], a[242:243], v[208:223]
    v_rcp_f32 v2, v2
    v_rcp_f32 v3, v3
    v_rcp_f32 v4, v4
    v_rcp_f32 v5, v5
    v_rcp_f32 v6, v6
    v_rcp_f32 v7, v7
    v_pk_mul_f32 v[112:113], v[112:113], v[0:1]
    v_pk_mul_f32 v[114:115], v[114:115], v[2:3]
    v_pk_mul_f32 v[144:145], v[144:145], v[4:5]
    v_pk_mul_f32 v[146:147], v[146:147], v[6:7]
    v_cvt_pk_bf16_f32 v48, v112, v113
    v_cvt_pk_bf16_f32 v49, v114, v115
    v_cvt_pk_bf16_f32 v50, v144, v145
    v_cvt_pk_bf16_f32 v51, v146, v147
    buffer_store_dwordx4 v[48:51], v13, s[20:23], s90 offen sc1
    s_add_u32 m0, s59, 16384
    s_add_u32 s74, s53, 655360
    buffer_load_dwordx4 v9, s[24:27], s74 offen lds
    v_pk_mul_f32 v[0:1], v[52:53], v[52:53]
    v_pk_mul_f32 v[2:3], v[54:55], v[54:55]
    v_pk_mul_f32 v[4:5], v[84:85], v[84:85]
    v_pk_mul_f32 v[6:7], v[86:87], v[86:87]
    v_pk_fma_f32 v[0:1], v[0:1], v[30:31], v[26:27] op_sel:[0,1,1] op_sel_hi:[1,1,1]
    v_pk_fma_f32 v[2:3], v[2:3], v[30:31], v[26:27] op_sel:[0,1,1] op_sel_hi:[1,1,1]
    v_pk_fma_f32 v[4:5], v[4:5], v[30:31], v[26:27] op_sel:[0,1,1] op_sel_hi:[1,1,1]
    v_pk_fma_f32 v[6:7], v[6:7], v[30:31], v[26:27] op_sel:[0,1,1] op_sel_hi:[1,1,1]
    v_pk_mul_f32 v[0:1], v[0:1], v[52:53]
    v_pk_mul_f32 v[2:3], v[2:3], v[54:55]
    v_pk_mul_f32 v[4:5], v[4:5], v[84:85]
    v_pk_mul_f32 v[6:7], v[6:7], v[86:87]
    v_exp_f32 v0, v0
    v_exp_f32 v1, v1
    v_mfma_f32_16x16x4_4b_bf16 v[240:255], a[112:113], a[242:243], v[240:255]
    v_exp_f32 v2, v2
    v_exp_f32 v3, v3
    v_exp_f32 v4, v4
    v_exp_f32 v5, v5
    v_exp_f32 v6, v6
    v_exp_f32 v7, v7
    v_pk_mul_f32 v[116:117], v[52:53], v[116:117]
    v_pk_mul_f32 v[118:119], v[54:55], v[118:119]
    v_pk_mul_f32 v[148:149], v[84:85], v[148:149]
    v_pk_mul_f32 v[150:151], v[86:87], v[150:151]
    v_pk_fma_f32 v[0:1], v[0:1], v[18:19], v[18:19] op_sel:[0,1,1] op_sel_hi:[1,1,1]
    v_pk_fma_f32 v[2:3], v[2:3], v[18:19], v[18:19] op_sel:[0,1,1] op_sel_hi:[1,1,1]
    v_pk_fma_f32 v[4:5], v[4:5], v[18:19], v[18:19] op_sel:[0,1,1] op_sel_hi:[1,1,1]
    v_pk_fma_f32 v[6:7], v[6:7], v[18:19], v[18:19] op_sel:[0,1,1] op_sel_hi:[1,1,1]
    v_rcp_f32 v0, v0
    v_rcp_f32 v1, v1
    v_mfma_f32_16x16x4_4b_bf16 a[80:95], a[114:115], a[242:243], a[80:95]
    v_rcp_f32 v2, v2
    v_rcp_f32 v3, v3
    v_rcp_f32 v4, v4
    v_rcp_f32 v5, v5
    v_rcp_f32 v6, v6
    v_rcp_f32 v7, v7
    v_pk_mul_f32 v[116:117], v[116:117], v[0:1]
    v_pk_mul_f32 v[118:119], v[118:119], v[2:3]
    v_pk_mul_f32 v[148:149], v[148:149], v[4:5]
    v_pk_mul_f32 v[150:151], v[150:151], v[6:7]
    v_cvt_pk_bf16_f32 v52, v116, v117
    v_cvt_pk_bf16_f32 v53, v118, v119
    v_cvt_pk_bf16_f32 v54, v148, v149
    v_cvt_pk_bf16_f32 v55, v150, v151
    buffer_store_dwordx4 v[52:55], v13, s[20:23], s90 offen offset:1024 sc1
    buffer_load_dwordx4 v10, s[24:27], s74 offen offset:1024 lds
    s_add_u32 s90, s90, 4096
    v_pk_mul_f32 v[30:31], v[28:29], s[86:87] op_sel_hi:[1,0]
    v_pk_mul_f32 v[30:31], v[30:31], v[28:29]
    v_pk_mul_f32 v[30:31], v[30:31], v[28:29]
    v_pk_mul_f32 v[0:1], v[56:57], v[56:57]
    v_pk_mul_f32 v[2:3], v[58:59], v[58:59]
    v_pk_mul_f32 v[4:5], v[88:89], v[88:89]
    v_pk_mul_f32 v[6:7], v[90:91], v[90:91]
    v_pk_fma_f32 v[0:1], v[0:1], v[30:31], v[28:29] op_sel:[0,0,0] op_sel_hi:[1,0,0]
    v_pk_fma_f32 v[2:3], v[2:3], v[30:31], v[28:29] op_sel:[0,0,0] op_sel_hi:[1,0,0]
    v_pk_fma_f32 v[4:5], v[4:5], v[30:31], v[28:29] op_sel:[0,0,0] op_sel_hi:[1,0,0]
    v_pk_fma_f32 v[6:7], v[6:7], v[30:31], v[28:29] op_sel:[0,0,0] op_sel_hi:[1,0,0]
    v_pk_mul_f32 v[0:1], v[0:1], v[56:57]
    v_pk_mul_f32 v[2:3], v[2:3], v[58:59]
    v_pk_mul_f32 v[4:5], v[4:5], v[88:89]
    v_pk_mul_f32 v[6:7], v[6:7], v[90:91]
    v_exp_f32 v0, v0
    v_exp_f32 v1, v1
    v_mfma_f32_16x16x4_4b_bf16 a[0:15], a[96:97], a[240:241], a[0:15]
    v_exp_f32 v2, v2
    v_exp_f32 v3, v3
    v_exp_f32 v4, v4
    v_exp_f32 v5, v5
    v_exp_f32 v6, v6
    v_exp_f32 v7, v7
    v_pk_mul_f32 v[120:121], v[56:57], v[120:121]
    v_pk_mul_f32 v[122:123], v[58:59], v[122:123]
    v_pk_mul_f32 v[152:153], v[88:89], v[152:153]
    v_pk_mul_f32 v[154:155], v[90:91], v[154:155]
    v_pk_fma_f32 v[0:1], v[0:1], v[20:21], v[20:21] op_sel:[0,0,0] op_sel_hi:[1,0,0]
    v_pk_fma_f32 v[2:3], v[2:3], v[20:21], v[20:21] op_sel:[0,0,0] op_sel_hi:[1,0,0]
    v_pk_fma_f32 v[4:5], v[4:5], v[20:21], v[20:21] op_sel:[0,0,0] op_sel_hi:[1,0,0]
    v_pk_fma_f32 v[6:7], v[6:7], v[20:21], v[20:21] op_sel:[0,0,0] op_sel_hi:[1,0,0]
    v_rcp_f32 v0, v0
    v_rcp_f32 v1, v1
    v_mfma_f32_16x16x4_4b_bf16 a[32:47], a[98:99], a[240:241], a[32:47]
    v_rcp_f32 v2, v2
    v_rcp_f32 v3, v3
    v_rcp_f32 v4, v4
    v_rcp_f32 v5, v5
    v_rcp_f32 v6, v6
    v_rcp_f32 v7, v7
    v_pk_mul_f32 v[120:121], v[120:121], v[0:1]
    v_pk_mul_f32 v[122:123], v[122:123], v[2:3]
    v_pk_mul_f32 v[152:153], v[152:153], v[4:5]
    v_pk_mul_f32 v[154:155], v[154:155], v[6:7]
    v_cvt_pk_bf16_f32 v56, v120, v121
    v_cvt_pk_bf16_f32 v57, v122, v123
    v_cvt_pk_bf16_f32 v58, v152, v153
    v_cvt_pk_bf16_f32 v59, v154, v155
    buffer_store_dwordx4 v[56:59], v13, s[20:23], s90 offen sc1
    buffer_load_dwordx4 v11, s[24:27], s74 offen offset:2048 lds
    v_pk_mul_f32 v[0:1], v[60:61], v[60:61]
    v_pk_mul_f32 v[2:3], v[62:63], v[62:63]
    v_pk_mul_f32 v[4:5], v[92:93], v[92:93]
    v_pk_mul_f32 v[6:7], v[94:95], v[94:95]
    v_pk_fma_f32 v[0:1], v[0:1], v[30:31], v[28:29] op_sel:[0,1,1] op_sel_hi:[1,1,1]
    v_pk_fma_f32 v[2:3], v[2:3], v[30:31], v[28:29] op_sel:[0,1,1] op_sel_hi:[1,1,1]
    v_pk_fma_f32 v[4:5], v[4:5], v[30:31], v[28:29] op_sel:[0,1,1] op_sel_hi:[1,1,1]
    v_pk_fma_f32 v[6:7], v[6:7], v[30:31], v[28:29] op_sel:[0,1,1] op_sel_hi:[1,1,1]
    v_pk_mul_f32 v[0:1], v[0:1], v[60:61]
    v_pk_mul_f32 v[2:3], v[2:3], v[62:63]
    v_pk_mul_f32 v[4:5], v[4:5], v[92:93]
    v_pk_mul_f32 v[6:7], v[6:7], v[94:95]
    v_exp_f32 v0, v0
    v_exp_f32 v1, v1
    v_mfma_f32_16x16x4_4b_bf16 a[16:31], a[96:97], a[242:243], a[16:31]
L_pad1_8:
    s_cbranch_execz L_pad1_12
    v_exp_f32 v2, v2
    v_exp_f32 v3, v3
    v_exp_f32 v4, v4
    v_exp_f32 v5, v5
    v_exp_f32 v6, v6
    v_exp_f32_e64 v7, v7
    v_pk_mul_f32 v[124:125], v[60:61], v[124:125]
    v_pk_mul_f32 v[126:127], v[62:63], v[126:127]
    v_pk_mul_f32 v[156:157], v[92:93], v[156:157]
    v_pk_mul_f32 v[158:159], v[94:95], v[158:159]
    v_pk_fma_f32 v[0:1], v[0:1], v[20:21], v[20:21] op_sel:[0,1,1] op_sel_hi:[1,1,1]
    v_pk_fma_f32 v[2:3], v[2:3], v[20:21], v[20:21] op_sel:[0,1,1] op_sel_hi:[1,1,1]
    v_pk_fma_f32 v[4:5], v[4:5], v[20:21], v[20:21] op_sel:[0,1,1] op_sel_hi:[1,1,1]
    v_pk_fma_f32 v[6:7], v[6:7], v[20:21], v[20:21] op_sel:[0,1,1] op_sel_hi:[1,1,1]
    v_rcp_f32 v0, v0
    v_rcp_f32 v1, v1
    v_mfma_f32_16x16x4_4b_bf16 a[48:63], a[98:99], a[242:243], a[48:63]
    v_rcp_f32 v2, v2
    v_rcp_f32 v3, v3
    v_rcp_f32 v4, v4
    v_rcp_f32 v5, v5
    v_rcp_f32 v6, v6
    v_rcp_f32 v7, v7
    v_pk_mul_f32 v[124:125], v[124:125], v[0:1]
    v_pk_mul_f32 v[126:127], v[126:127], v[2:3]
    v_pk_mul_f32 v[156:157], v[156:157], v[4:5]
    v_pk_mul_f32 v[158:159], v[158:159], v[6:7]
    v_cvt_pk_bf16_f32 v60, v124, v125
    v_cvt_pk_bf16_f32 v61, v126, v127
    v_cvt_pk_bf16_f32 v62, v156, v157
    v_cvt_pk_bf16_f32 v63, v158, v159
    buffer_store_dwordx4 v[60:63], v13, s[20:23], s90 offen offset:1024 sc1
    buffer_load_dwordx4 v12, s[24:27], s74 offen offset:3072 lds
    v_pk_mul_f32 v[30:31], v[22:23], s[86:87] op_sel_hi:[1,0]
    v_pk_mul_f32 v[30:31], v[30:31], v[22:23]
    v_pk_mul_f32 v[30:31], v[30:31], v[22:23]
    v_pk_mul_f32 v[0:1], v[160:161], v[160:161]
    v_pk_mul_f32 v[2:3], v[162:163], v[162:163]
    v_pk_mul_f32 v[4:5], v[192:193], v[192:193]
    v_pk_mul_f32 v[6:7], v[194:195], v[194:195]
    v_pk_fma_f32 v[0:1], v[0:1], v[30:31], v[22:23] op_sel:[0,0,0] op_sel_hi:[1,0,0]
    v_pk_fma_f32 v[2:3], v[2:3], v[30:31], v[22:23] op_sel:[0,0,0] op_sel_hi:[1,0,0]
    v_pk_fma_f32 v[4:5], v[4:5], v[30:31], v[22:23] op_sel:[0,0,0] op_sel_hi:[1,0,0]
    v_pk_fma_f32 v[6:7], v[6:7], v[30:31], v[22:23] op_sel:[0,0,0] op_sel_hi:[1,0,0]
    v_pk_mul_f32 v[0:1], v[0:1], v[160:161]
    v_pk_mul_f32 v[2:3], v[2:3], v[162:163]
    v_pk_mul_f32 v[4:5], v[4:5], v[192:193]
    v_pk_mul_f32 v[6:7], v[6:7], v[194:195]
    v_exp_f32 v0, v0
    v_exp_f32 v1, v1
    v_exp_f32 v2, v2
    v_exp_f32 v3, v3
    v_exp_f32 v4, v4
    v_exp_f32 v5, v5
    v_exp_f32 v6, v6
    v_exp_f32 v7, v7
    v_accvgpr_read_b32 v64, a64
    v_accvgpr_read_b32 v65, a65
    v_accvgpr_read_b32 v66, a66
    v_accvgpr_read_b32 v67, a67
    v_pk_mul_f32 v[224:225], v[160:161], v[224:225]
    v_pk_mul_f32 v[226:227], v[162:163], v[226:227]
    v_pk_mul_f32 v[64:65], v[192:193], v[64:65]
    v_pk_mul_f32 v[66:67], v[194:195], v[66:67]
    v_pk_fma_f32 v[0:1], v[0:1], v[14:15], v[14:15] op_sel:[0,0,0] op_sel_hi:[1,0,0]
    v_pk_fma_f32 v[2:3], v[2:3], v[14:15], v[14:15] op_sel:[0,0,0] op_sel_hi:[1,0,0]
    v_pk_fma_f32 v[4:5], v[4:5], v[14:15], v[14:15] op_sel:[0,0,0] op_sel_hi:[1,0,0]
    v_pk_fma_f32 v[6:7], v[6:7], v[14:15], v[14:15] op_sel:[0,0,0] op_sel_hi:[1,0,0]
    v_rcp_f32 v0, v0
    v_rcp_f32 v1, v1
    v_rcp_f32 v2, v2
    v_rcp_f32 v3, v3
    v_rcp_f32 v4, v4
    v_rcp_f32 v5, v5
    v_rcp_f32 v6, v6
    v_rcp_f32 v7, v7
    v_pk_mul_f32 v[224:225], v[224:225], v[0:1]
    v_pk_mul_f32 v[226:227], v[226:227], v[2:3]
    v_pk_mul_f32 v[64:65], v[64:65], v[4:5]
    v_pk_mul_f32 v[66:67], v[66:67], v[6:7]
    v_cvt_pk_bf16_f32 v160, v224, v225
    v_cvt_pk_bf16_f32 v161, v226, v227
    v_cvt_pk_bf16_f32 v162, v64, v65
    v_cvt_pk_bf16_f32 v163, v66, v67
    buffer_store_dwordx4 v[160:163], v13, s[20:23], s91 offen sc1
    s_add_u32 m0, s59, 32768
    s_add_u32 s74, s53, 786432
    buffer_load_dwordx4 v9, s[24:27], s74 offen lds
    v_pk_mul_f32 v[0:1], v[164:165], v[164:165]
    v_pk_mul_f32 v[2:3], v[166:167], v[166:167]
    v_pk_mul_f32 v[4:5], v[196:197], v[196:197]
    v_pk_mul_f32 v[6:7], v[198:199], v[198:199]
    v_pk_fma_f32 v[0:1], v[0:1], v[30:31], v[22:23] op_sel:[0,1,1] op_sel_hi:[1,1,1]
    v_pk_fma_f32 v[2:3], v[2:3], v[30:31], v[22:23] op_sel:[0,1,1] op_sel_hi:[1,1,1]
    v_pk_fma_f32 v[4:5], v[4:5], v[30:31], v[22:23] op_sel:[0,1,1] op_sel_hi:[1,1,1]
    v_pk_fma_f32 v[6:7], v[6:7], v[30:31], v[22:23] op_sel:[0,1,1] op_sel_hi:[1,1,1]
    v_pk_mul_f32 v[0:1], v[0:1], v[164:165]
    v_pk_mul_f32 v[2:3], v[2:3], v[166:167]
    v_pk_mul_f32 v[4:5], v[4:5], v[196:197]
    v_pk_mul_f32 v[6:7], v[6:7], v[198:199]
    v_exp_f32 v0, v0
    v_exp_f32 v1, v1
    v_exp_f32 v2, v2
    v_exp_f32 v3, v3
    v_exp_f32 v4, v4
    v_exp_f32 v5, v5
    v_exp_f32 v6, v6
    v_exp_f32 v7, v7
    v_accvgpr_read_b32 v68, a68
    v_accvgpr_read_b32 v69, a69
    v_accvgpr_read_b32 v70, a70
    v_accvgpr_read_b32 v71, a71
    v_pk_mul_f32 v[228:229], v[164:165], v[228:229]
    v_pk_mul_f32 v[230:231], v[166:167], v[230:231]
    v_pk_mul_f32 v[68:69], v[196:197], v[68:69]
    v_pk_mul_f32 v[70:71], v[198:199], v[70:71]
    v_pk_fma_f32 v[0:1], v[0:1], v[14:15], v[14:15] op_sel:[0,1,1] op_sel_hi:[1,1,1]
    v_pk_fma_f32 v[2:3], v[2:3], v[14:15], v[14:15] op_sel:[0,1,1] op_sel_hi:[1,1,1]
    v_pk_fma_f32 v[4:5], v[4:5], v[14:15], v[14:15] op_sel:[0,1,1] op_sel_hi:[1,1,1]
    v_pk_fma_f32 v[6:7], v[6:7], v[14:15], v[14:15] op_sel:[0,1,1] op_sel_hi:[1,1,1]
    v_rcp_f32 v0, v0
    v_rcp_f32 v1, v1
    v_rcp_f32 v2, v2
    v_rcp_f32 v3, v3
    v_rcp_f32 v4, v4
    v_rcp_f32 v5, v5
    v_rcp_f32 v6, v6
    v_rcp_f32 v7, v7
    v_pk_mul_f32 v[228:229], v[228:229], v[0:1]
    v_pk_mul_f32 v[230:231], v[230:231], v[2:3]
    v_pk_mul_f32 v[68:69], v[68:69], v[4:5]
    v_pk_mul_f32 v[70:71], v[70:71], v[6:7]
    v_cvt_pk_bf16_f32 v164, v228, v229
    v_cvt_pk_bf16_f32 v165, v230, v231
    v_cvt_pk_bf16_f32 v166, v68, v69
    v_cvt_pk_bf16_f32 v167, v70, v71
    buffer_store_dwordx4 v[164:167], v13, s[20:23], s91 offen offset:1024 sc1
    buffer_load_dwordx4 v10, s[24:27], s74 offen offset:1024 lds
    s_add_u32 s91, s91, 4096
    v_pk_mul_f32 v[30:31], v[24:25], s[86:87] op_sel_hi:[1,0]
    v_pk_mul_f32 v[30:31], v[30:31], v[24:25]
    v_pk_mul_f32 v[30:31], v[30:31], v[24:25]
    v_pk_mul_f32 v[0:1], v[168:169], v[168:169]
    v_pk_mul_f32 v[2:3], v[170:171], v[170:171]
    v_pk_mul_f32 v[4:5], v[200:201], v[200:201]
    v_pk_mul_f32 v[6:7], v[202:203], v[202:203]
    v_pk_fma_f32 v[0:1], v[0:1], v[30:31], v[24:25] op_sel:[0,0,0] op_sel_hi:[1,0,0]
    v_pk_fma_f32 v[2:3], v[2:3], v[30:31], v[24:25] op_sel:[0,0,0] op_sel_hi:[1,0,0]
    v_pk_fma_f32 v[4:5], v[4:5], v[30:31], v[24:25] op_sel:[0,0,0] op_sel_hi:[1,0,0]
    v_pk_fma_f32 v[6:7], v[6:7], v[30:31], v[24:25] op_sel:[0,0,0] op_sel_hi:[1,0,0]
    v_pk_mul_f32 v[0:1], v[0:1], v[168:169]
    v_pk_mul_f32 v[2:3], v[2:3], v[170:171]
    v_pk_mul_f32 v[4:5], v[4:5], v[200:201]
    v_pk_mul_f32 v[6:7], v[6:7], v[202:203]
    v_exp_f32 v0, v0
    v_exp_f32 v1, v1
    v_exp_f32 v2, v2
    v_exp_f32 v3, v3
    v_exp_f32 v4, v4
    v_exp_f32 v5, v5
    v_exp_f32 v6, v6
    v_exp_f32 v7, v7
    v_accvgpr_read_b32 v72, a72
    v_accvgpr_read_b32 v73, a73
    v_accvgpr_read_b32 v74, a74
    v_accvgpr_read_b32 v75, a75
    v_pk_mul_f32 v[232:233], v[168:169], v[232:233]
    v_pk_mul_f32 v[234:235], v[170:171], v[234:235]
    v_pk_mul_f32 v[72:73], v[200:201], v[72:73]
    v_pk_mul_f32 v[74:75], v[202:203], v[74:75]
    v_pk_fma_f32 v[0:1], v[0:1], v[16:17], v[16:17] op_sel:[0,0,0] op_sel_hi:[1,0,0]
    v_pk_fma_f32 v[2:3], v[2:3], v[16:17], v[16:17] op_sel:[0,0,0] op_sel_hi:[1,0,0]
    v_pk_fma_f32 v[4:5], v[4:5], v[16:17], v[16:17] op_sel:[0,0,0] op_sel_hi:[1,0,0]
    v_pk_fma_f32 v[6:7], v[6:7], v[16:17], v[16:17] op_sel:[0,0,0] op_sel_hi:[1,0,0]
    v_rcp_f32 v0, v0
    v_rcp_f32 v1, v1
    v_rcp_f32 v2, v2
    v_rcp_f32 v3, v3
    v_rcp_f32 v4, v4
    v_rcp_f32 v5, v5
    v_rcp_f32 v6, v6
    v_rcp_f32 v7, v7
    v_pk_mul_f32 v[232:233], v[232:233], v[0:1]
    v_pk_mul_f32 v[234:235], v[234:235], v[2:3]
    v_pk_mul_f32 v[72:73], v[72:73], v[4:5]
    v_pk_mul_f32 v[74:75], v[74:75], v[6:7]
    v_cvt_pk_bf16_f32 v168, v232, v233
    v_cvt_pk_bf16_f32 v169, v234, v235
    v_cvt_pk_bf16_f32 v170, v72, v73
    v_cvt_pk_bf16_f32 v171, v74, v75
    buffer_store_dwordx4 v[168:171], v13, s[20:23], s91 offen sc1
    buffer_load_dwordx4 v11, s[24:27], s74 offen offset:2048 lds
    v_pk_mul_f32 v[0:1], v[172:173], v[172:173]
    v_pk_mul_f32 v[2:3], v[174:175], v[174:175]
    v_pk_mul_f32 v[4:5], v[204:205], v[204:205]
    v_pk_mul_f32 v[6:7], v[206:207], v[206:207]
    v_pk_fma_f32 v[0:1], v[0:1], v[30:31], v[24:25] op_sel:[0,1,1] op_sel_hi:[1,1,1]
    v_pk_fma_f32 v[2:3], v[2:3], v[30:31], v[24:25] op_sel:[0,1,1] op_sel_hi:[1,1,1]
    v_pk_fma_f32 v[4:5], v[4:5], v[30:31], v[24:25] op_sel:[0,1,1] op_sel_hi:[1,1,1]
    v_pk_fma_f32 v[6:7], v[6:7], v[30:31], v[24:25] op_sel:[0,1,1] op_sel_hi:[1,1,1]
    v_pk_mul_f32 v[0:1], v[0:1], v[172:173]
    v_pk_mul_f32 v[2:3], v[2:3], v[174:175]
    v_pk_mul_f32 v[4:5], v[4:5], v[204:205]
    v_pk_mul_f32 v[6:7], v[6:7], v[206:207]
    v_exp_f32 v0, v0
    v_exp_f32 v1, v1
    v_exp_f32 v2, v2
    v_exp_f32 v3, v3
    v_exp_f32 v4, v4
    v_exp_f32 v5, v5
    v_exp_f32 v6, v6
    v_exp_f32 v7, v7
    v_accvgpr_read_b32 v76, a76
    v_accvgpr_read_b32 v77, a77
    v_accvgpr_read_b32 v78, a78
    v_accvgpr_read_b32 v79, a79
    v_pk_mul_f32 v[236:237], v[172:173], v[236:237]
    v_pk_mul_f32 v[238:239], v[174:175], v[238:239]
    v_pk_mul_f32 v[76:77], v[204:205], v[76:77]
    v_pk_mul_f32 v[78:79], v[206:207], v[78:79]
    v_pk_fma_f32 v[0:1], v[0:1], v[16:17], v[16:17] op_sel:[0,1,1] op_sel_hi:[1,1,1]
    v_pk_fma_f32 v[2:3], v[2:3], v[16:17], v[16:17] op_sel:[0,1,1] op_sel_hi:[1,1,1]
    v_pk_fma_f32 v[4:5], v[4:5], v[16:17], v[16:17] op_sel:[0,1,1] op_sel_hi:[1,1,1]
    v_pk_fma_f32 v[6:7], v[6:7], v[16:17], v[16:17] op_sel:[0,1,1] op_sel_hi:[1,1,1]
    v_rcp_f32 v0, v0
    v_rcp_f32 v1, v1
    v_rcp_f32 v2, v2
    v_rcp_f32 v3, v3
    v_rcp_f32 v4, v4
    v_rcp_f32 v5, v5
    v_rcp_f32 v6, v6
    v_rcp_f32 v7, v7
    v_pk_mul_f32 v[236:237], v[236:237], v[0:1]
    v_pk_mul_f32 v[238:239], v[238:239], v[2:3]
    v_pk_mul_f32 v[76:77], v[76:77], v[4:5]
    v_pk_mul_f32 v[78:79], v[78:79], v[6:7]
    v_cvt_pk_bf16_f32 v172, v236, v237
    v_cvt_pk_bf16_f32 v173, v238, v239
    v_cvt_pk_bf16_f32 v174, v76, v77
    v_cvt_pk_bf16_f32 v175, v78, v79
    buffer_store_dwordx4 v[172:175], v13, s[20:23], s91 offen offset:1024 sc1
    buffer_load_dwordx4 v12, s[24:27], s74 offen offset:3072 lds
    s_add_u32 s91, s91, 4096
    v_pk_mul_f32 v[30:31], v[26:27], s[86:87] op_sel_hi:[1,0]
    v_pk_mul_f32 v[30:31], v[30:31], v[26:27]
    v_pk_mul_f32 v[30:31], v[30:31], v[26:27]
    v_pk_mul_f32 v[0:1], v[176:177], v[176:177]
    v_pk_mul_f32 v[2:3], v[178:179], v[178:179]
    v_pk_mul_f32 v[4:5], v[208:209], v[208:209]
    v_pk_mul_f32 v[6:7], v[210:211], v[210:211]
    v_pk_fma_f32 v[0:1], v[0:1], v[30:31], v[26:27] op_sel:[0,0,0] op_sel_hi:[1,0,0]
    v_pk_fma_f32 v[2:3], v[2:3], v[30:31], v[26:27] op_sel:[0,0,0] op_sel_hi:[1,0,0]
    v_pk_fma_f32 v[4:5], v[4:5], v[30:31], v[26:27] op_sel:[0,0,0] op_sel_hi:[1,0,0]
    v_pk_fma_f32 v[6:7], v[6:7], v[30:31], v[26:27] op_sel:[0,0,0] op_sel_hi:[1,0,0]
    v_pk_mul_f32 v[0:1], v[0:1], v[176:177]
    v_pk_mul_f32 v[2:3], v[2:3], v[178:179]
    v_pk_mul_f32 v[4:5], v[4:5], v[208:209]
    v_pk_mul_f32 v[6:7], v[6:7], v[210:211]
    v_exp_f32 v0, v0
    v_exp_f32 v1, v1
    v_exp_f32 v2, v2
    v_exp_f32 v3, v3
    v_exp_f32 v4, v4
    v_exp_f32 v5, v5
    v_exp_f32 v6, v6
    v_exp_f32 v7, v7
    v_accvgpr_read_b32 v80, a80
    v_accvgpr_read_b32 v81, a81
    v_accvgpr_read_b32 v82, a82
    v_accvgpr_read_b32 v83, a83
    v_pk_mul_f32 v[240:241], v[176:177], v[240:241]
    v_pk_mul_f32 v[242:243], v[178:179], v[242:243]
    v_pk_mul_f32 v[80:81], v[208:209], v[80:81]
    v_pk_mul_f32 v[82:83], v[210:211], v[82:83]
    v_pk_fma_f32 v[0:1], v[0:1], v[18:19], v[18:19] op_sel:[0,0,0] op_sel_hi:[1,0,0]
    v_pk_fma_f32 v[2:3], v[2:3], v[18:19], v[18:19] op_sel:[0,0,0] op_sel_hi:[1,0,0]
    v_pk_fma_f32 v[4:5], v[4:5], v[18:19], v[18:19] op_sel:[0,0,0] op_sel_hi:[1,0,0]
    v_pk_fma_f32 v[6:7], v[6:7], v[18:19], v[18:19] op_sel:[0,0,0] op_sel_hi:[1,0,0]
    v_rcp_f32 v0, v0
    v_rcp_f32 v1, v1
    v_rcp_f32 v2, v2
    v_rcp_f32 v3, v3
    v_rcp_f32 v4, v4
    v_rcp_f32 v5, v5
    v_rcp_f32 v6, v6
    v_rcp_f32 v7, v7
    v_pk_mul_f32 v[240:241], v[240:241], v[0:1]
    v_pk_mul_f32 v[242:243], v[242:243], v[2:3]
    v_pk_mul_f32 v[80:81], v[80:81], v[4:5]
    v_pk_mul_f32 v[82:83], v[82:83], v[6:7]
    v_cvt_pk_bf16_f32 v176, v240, v241
    v_cvt_pk_bf16_f32 v177, v242, v243
    v_cvt_pk_bf16_f32 v178, v80, v81
    v_cvt_pk_bf16_f32 v179, v82, v83
    buffer_store_dwordx4 v[176:179], v13, s[20:23], s91 offen sc1
    s_add_u32 m0, s59, 49152
    s_add_u32 s74, s53, 917504
    buffer_load_dwordx4 v9, s[24:27], s74 offen lds
    v_pk_mul_f32 v[0:1], v[180:181], v[180:181]
    v_pk_mul_f32 v[2:3], v[182:183], v[182:183]
    v_pk_mul_f32 v[4:5], v[212:213], v[212:213]
    v_pk_mul_f32 v[6:7], v[214:215], v[214:215]
    v_pk_fma_f32 v[0:1], v[0:1], v[30:31], v[26:27] op_sel:[0,1,1] op_sel_hi:[1,1,1]
    v_pk_fma_f32 v[2:3], v[2:3], v[30:31], v[26:27] op_sel:[0,1,1] op_sel_hi:[1,1,1]
    v_pk_fma_f32 v[4:5], v[4:5], v[30:31], v[26:27] op_sel:[0,1,1] op_sel_hi:[1,1,1]
    v_pk_fma_f32 v[6:7], v[6:7], v[30:31], v[26:27] op_sel:[0,1,1] op_sel_hi:[1,1,1]
    v_pk_mul_f32 v[0:1], v[0:1], v[180:181]
    v_pk_mul_f32 v[2:3], v[2:3], v[182:183]
    v_pk_mul_f32 v[4:5], v[4:5], v[212:213]
    v_pk_mul_f32 v[6:7], v[6:7], v[214:215]
    v_exp_f32 v0, v0
    v_exp_f32 v1, v1
    v_exp_f32 v2, v2
    v_exp_f32 v3, v3
    v_exp_f32 v4, v4
    v_exp_f32 v5, v5
    v_exp_f32 v6, v6
    v_exp_f32 v7, v7
    v_accvgpr_read_b32 v84, a84
    v_accvgpr_read_b32 v85, a85
    v_accvgpr_read_b32 v86, a86
    v_accvgpr_read_b32 v87, a87
    v_pk_mul_f32 v[244:245], v[180:181], v[244:245]
    v_pk_mul_f32 v[246:247], v[182:183], v[246:247]
    v_pk_mul_f32 v[84:85], v[212:213], v[84:85]
    v_pk_mul_f32 v[86:87], v[214:215], v[86:87]
    v_pk_fma_f32 v[0:1], v[0:1], v[18:19], v[18:19] op_sel:[0,1,1] op_sel_hi:[1,1,1]
    v_pk_fma_f32 v[2:3], v[2:3], v[18:19], v[18:19] op_sel:[0,1,1] op_sel_hi:[1,1,1]
    v_pk_fma_f32 v[4:5], v[4:5], v[18:19], v[18:19] op_sel:[0,1,1] op_sel_hi:[1,1,1]
    v_pk_fma_f32 v[6:7], v[6:7], v[18:19], v[18:19] op_sel:[0,1,1] op_sel_hi:[1,1,1]
    v_rcp_f32 v0, v0
    v_rcp_f32 v1, v1
    v_rcp_f32 v2, v2
    v_rcp_f32 v3, v3
    v_rcp_f32 v4, v4
    v_rcp_f32 v5, v5
    v_rcp_f32 v6, v6
    v_rcp_f32 v7, v7
    v_pk_mul_f32 v[244:245], v[244:245], v[0:1]
    v_pk_mul_f32 v[246:247], v[246:247], v[2:3]
    v_pk_mul_f32 v[84:85], v[84:85], v[4:5]
    v_pk_mul_f32 v[86:87], v[86:87], v[6:7]
    v_cvt_pk_bf16_f32 v180, v244, v245
    v_cvt_pk_bf16_f32 v181, v246, v247
    v_cvt_pk_bf16_f32 v182, v84, v85
    v_cvt_pk_bf16_f32 v183, v86, v87
    buffer_store_dwordx4 v[180:183], v13, s[20:23], s91 offen offset:1024 sc1
    buffer_load_dwordx4 v10, s[24:27], s74 offen offset:1024 lds
    s_add_u32 s91, s91, 4096
    s_waitcnt vmcnt(13)
    s_barrier
    s_cmp_lg_u32 s44, 0
    s_cbranch_scc1 L_fhb1_skip
    v_accvgpr_write_b32 a254, 1
    s_mov_b64 exec, 1
    buffer_store_dword a254, off, s[20:23], s81 sc1
    s_mov_b64 exec, -1
L_fhb1_skip:
    v_pk_mul_f32 v[30:31], v[28:29], s[86:87] op_sel_hi:[1,0]
    v_pk_mul_f32 v[30:31], v[30:31], v[28:29]
    v_pk_mul_f32 v[30:31], v[30:31], v[28:29]
    v_pk_mul_f32 v[0:1], v[184:185], v[184:185]
    v_pk_mul_f32 v[2:3], v[186:187], v[186:187]
    v_pk_mul_f32 v[4:5], v[216:217], v[216:217]
    v_pk_mul_f32 v[6:7], v[218:219], v[218:219]
    v_pk_fma_f32 v[0:1], v[0:1], v[30:31], v[28:29] op_sel:[0,0,0] op_sel_hi:[1,0,0]
    v_pk_fma_f32 v[2:3], v[2:3], v[30:31], v[28:29] op_sel:[0,0,0] op_sel_hi:[1,0,0]
    v_pk_fma_f32 v[4:5], v[4:5], v[30:31], v[28:29] op_sel:[0,0,0] op_sel_hi:[1,0,0]
    v_pk_fma_f32 v[6:7], v[6:7], v[30:31], v[28:29] op_sel:[0,0,0] op_sel_hi:[1,0,0]
    v_pk_mul_f32 v[0:1], v[0:1], v[184:185]
    v_pk_mul_f32 v[2:3], v[2:3], v[186:187]
    v_pk_mul_f32 v[4:5], v[4:5], v[216:217]
    v_pk_mul_f32 v[6:7], v[6:7], v[218:219]
    v_exp_f32 v0, v0
    v_exp_f32 v1, v1
    v_exp_f32 v2, v2
    v_exp_f32 v3, v3
    v_exp_f32 v4, v4
    v_exp_f32 v5, v5
    v_exp_f32 v6, v6
    v_exp_f32 v7, v7
    v_accvgpr_read_b32 v88, a88
    v_accvgpr_read_b32 v89, a89
    v_accvgpr_read_b32 v90, a90
    v_accvgpr_read_b32 v91, a91
    v_pk_mul_f32 v[248:249], v[184:185], v[248:249]
    v_pk_mul_f32 v[250:251], v[186:187], v[250:251]
    v_pk_mul_f32 v[88:89], v[216:217], v[88:89]
    v_pk_mul_f32 v[90:91], v[218:219], v[90:91]
    v_pk_fma_f32 v[0:1], v[0:1], v[20:21], v[20:21] op_sel:[0,0,0] op_sel_hi:[1,0,0]
    v_pk_fma_f32 v[2:3], v[2:3], v[20:21], v[20:21] op_sel:[0,0,0] op_sel_hi:[1,0,0]
    v_pk_fma_f32 v[4:5], v[4:5], v[20:21], v[20:21] op_sel:[0,0,0] op_sel_hi:[1,0,0]
    v_pk_fma_f32 v[6:7], v[6:7], v[20:21], v[20:21] op_sel:[0,0,0] op_sel_hi:[1,0,0]
    v_rcp_f32 v0, v0
    v_rcp_f32 v1, v1
    v_rcp_f32 v2, v2
    v_rcp_f32 v3, v3
    v_rcp_f32 v4, v4
    v_rcp_f32 v5, v5
    v_rcp_f32 v6, v6
    v_rcp_f32 v7, v7
    v_pk_mul_f32 v[248:249], v[248:249], v[0:1]
    v_pk_mul_f32 v[250:251], v[250:251], v[2:3]
    v_pk_mul_f32 v[88:89], v[88:89], v[4:5]
    v_pk_mul_f32 v[90:91], v[90:91], v[6:7]
    v_cvt_pk_bf16_f32 v184, v248, v249
    v_cvt_pk_bf16_f32 v185, v250, v251
    v_cvt_pk_bf16_f32 v186, v88, v89
    v_cvt_pk_bf16_f32 v187, v90, v91
    buffer_store_dwordx4 v[184:187], v13, s[20:23], s91 offen sc1
    buffer_load_dwordx4 v11, s[24:27], s74 offen offset:2048 lds
    v_pk_mul_f32 v[0:1], v[188:189], v[188:189]
    v_pk_mul_f32 v[2:3], v[190:191], v[190:191]
    v_pk_mul_f32 v[4:5], v[220:221], v[220:221]
    v_pk_mul_f32 v[6:7], v[222:223], v[222:223]
    v_pk_fma_f32 v[0:1], v[0:1], v[30:31], v[28:29] op_sel:[0,1,1] op_sel_hi:[1,1,1]
    v_pk_fma_f32 v[2:3], v[2:3], v[30:31], v[28:29] op_sel:[0,1,1] op_sel_hi:[1,1,1]
    v_pk_fma_f32 v[4:5], v[4:5], v[30:31], v[28:29] op_sel:[0,1,1] op_sel_hi:[1,1,1]
    v_pk_fma_f32 v[6:7], v[6:7], v[30:31], v[28:29] op_sel:[0,1,1] op_sel_hi:[1,1,1]
    v_pk_mul_f32 v[0:1], v[0:1], v[188:189]
    v_pk_mul_f32 v[2:3], v[2:3], v[190:191]
    v_pk_mul_f32 v[4:5], v[4:5], v[220:221]
    v_pk_mul_f32 v[6:7], v[6:7], v[222:223]
    v_exp_f32 v0, v0
    v_exp_f32 v1, v1
    v_exp_f32 v2, v2
    v_exp_f32 v3, v3
    v_exp_f32 v4, v4
    v_exp_f32 v5, v5
    v_exp_f32 v6, v6
    v_exp_f32 v7, v7
    v_accvgpr_read_b32 v92, a92
    v_accvgpr_read_b32 v93, a93
    v_accvgpr_read_b32 v94, a94
    v_accvgpr_read_b32 v95, a95
    v_pk_mul_f32 v[252:253], v[188:189], v[252:253]
    v_pk_mul_f32 v[254:255], v[190:191], v[254:255]
    v_pk_mul_f32 v[92:93], v[220:221], v[92:93]
    v_pk_mul_f32 v[94:95], v[222:223], v[94:95]
    v_pk_fma_f32 v[0:1], v[0:1], v[20:21], v[20:21] op_sel:[0,1,1] op_sel_hi:[1,1,1]
    v_pk_fma_f32 v[2:3], v[2:3], v[20:21], v[20:21] op_sel:[0,1,1] op_sel_hi:[1,1,1]
    v_pk_fma_f32 v[4:5], v[4:5], v[20:21], v[20:21] op_sel:[0,1,1] op_sel_hi:[1,1,1]
    v_pk_fma_f32 v[6:7], v[6:7], v[20:21], v[20:21] op_sel:[0,1,1] op_sel_hi:[1,1,1]
    v_rcp_f32 v0, v0
    v_rcp_f32 v1, v1
    v_rcp_f32 v2, v2
    v_rcp_f32 v3, v3
    v_rcp_f32 v4, v4
    v_rcp_f32 v5, v5
    v_rcp_f32 v6, v6
    v_rcp_f32 v7, v7
    v_pk_mul_f32 v[252:253], v[252:253], v[0:1]
    v_pk_mul_f32 v[254:255], v[254:255], v[2:3]
    v_pk_mul_f32 v[92:93], v[92:93], v[4:5]
    v_pk_mul_f32 v[94:95], v[94:95], v[6:7]
    v_cvt_pk_bf16_f32 v188, v252, v253
    v_cvt_pk_bf16_f32 v189, v254, v255
    v_cvt_pk_bf16_f32 v190, v92, v93
    v_cvt_pk_bf16_f32 v191, v94, v95
    buffer_store_dwordx4 v[188:191], v13, s[20:23], s91 offen offset:1024 sc1
    buffer_load_dwordx4 v12, s[24:27], s74 offen offset:3072 lds
    v_pk_mul_f32 v[22:23], v[22:23], s[88:89] op_sel_hi:[1,0]
    v_pk_mul_f32 v[24:25], v[24:25], s[88:89] op_sel_hi:[1,0]
    v_pk_mul_f32 v[26:27], v[26:27], s[88:89] op_sel_hi:[1,0]
    v_pk_mul_f32 v[28:29], v[28:29], s[88:89] op_sel_hi:[1,0]
    v_accvgpr_read_b32 v208, a0
    v_accvgpr_read_b32 v209, a1
    v_accvgpr_read_b32 v210, a2
    v_accvgpr_read_b32 v211, a3
    v_accvgpr_read_b32 v212, a32
    v_accvgpr_read_b32 v213, a33
    v_accvgpr_read_b32 v214, a34
    v_accvgpr_read_b32 v215, a35
    v_accvgpr_read_b32 v216, a4
    v_accvgpr_read_b32 v217, a5
    v_accvgpr_read_b32 v218, a6
    v_accvgpr_read_b32 v219, a7
    v_accvgpr_read_b32 v220, a36
    v_accvgpr_read_b32 v221, a37
    v_accvgpr_read_b32 v222, a38
    v_accvgpr_read_b32 v223, a39
    v_cvt_pk_bf16_f32 v208, v208, v209
    v_cvt_pk_bf16_f32 v209, v210, v211
    v_cvt_pk_bf16_f32 v210, v212, v213
    v_cvt_pk_bf16_f32 v211, v214, v215
    v_cvt_pk_bf16_f32 v216, v216, v217
    v_cvt_pk_bf16_f32 v217, v218, v219
    v_cvt_pk_bf16_f32 v218, v220, v221
    v_cvt_pk_bf16_f32 v219, v222, v223
    v_mfma_f32_16x16x32_bf16 v[160:163], a[244:247], v[208:211], 0
    v_mfma_f32_16x16x32_bf16 v[164:167], a[248:251], v[208:211], 0
    v_mfma_f32_16x16x32_bf16 v[168:171], a[244:247], v[216:219], 0
    v_mfma_f32_16x16x32_bf16 v[172:175], a[248:251], v[216:219], 0
    v_accvgpr_read_b32 v208, a8
    v_accvgpr_read_b32 v209, a9
    v_accvgpr_read_b32 v210, a10
    v_accvgpr_read_b32 v211, a11
    v_accvgpr_read_b32 v212, a40
    v_max3_f32 v4, v160, v161, v162
    v_max3_f32 v6, -v160, -v161, -v162
    v_max3_f32 v5, v168, v169, v170
    v_max3_f32 v7, -v168, -v169, -v170
    v_max3_f32 v4, v4, v163, v164
    v_max3_f32 v6, v6, -v163, -v164
    v_max3_f32 v5, v5, v171, v172
    v_max3_f32 v7, v7, -v171, -v172
    v_max3_f32 v4, v4, v165, v166
    v_max3_f32 v6, v6, -v165, -v166
    v_max3_f32 v5, v5, v173, v174
    v_max3_f32 v7, v7, -v173, -v174
    v_max_f32_e64 v4, v4, v167
    v_max_f32_e64 v6, v6, -v167
    v_max_f32_e64 v5, v5, v175
    v_max_f32_e64 v7, v7, -v175
    v_accvgpr_read_b32 v213, a41
    v_permlane32_swap_b32 v4, v5
    v_permlane32_swap_b32 v6, v7
    v_max_f32 v4, v4, v5
    v_max_f32 v6, v6, v7
    v_accvgpr_read_b32 v214, a42
    v_accvgpr_read_b32 v215, a43
    v_permlane16_swap_b32 v4, v6
    v_max_f32 v4, v4, v6
    v_mov_b32 v6, v4
    v_accvgpr_read_b32 v216, a12
    v_accvgpr_read_b32 v217, a13
    v_permlane16_swap_b32 v4, v6
    v_mov_b32 v5, v4
    v_mov_b32 v7, v6
    v_accvgpr_read_b32 v218, a14
    v_permlane32_swap_b32 v4, v5
    v_permlane32_swap_b32 v6, v7
    v_accvgpr_read_b32 v219, a15
    v_accvgpr_read_b32 v220, a44
    v_accvgpr_read_b32 v221, a45
    v_accvgpr_read_b32 v222, a46
    v_accvgpr_read_b32 v223, a47
    v_cvt_pk_bf16_f32 v208, v208, v209
    v_cvt_pk_bf16_f32 v209, v210, v211
    v_cvt_pk_bf16_f32 v210, v212, v213
    v_cvt_pk_bf16_f32 v211, v214, v215
    v_cvt_pk_bf16_f32 v216, v216, v217
    v_cvt_pk_bf16_f32 v217, v218, v219
    v_cvt_pk_bf16_f32 v218, v220, v221
    v_cvt_pk_bf16_f32 v219, v222, v223
    v_pk_mul_f32 v[4:5], v[4:5], v[22:23] neg_lo:[1,0] neg_hi:[1,0]
    v_pk_mul_f32 v[6:7], v[6:7], v[22:23] neg_lo:[1,0] neg_hi:[1,0]
    v_pk_fma_f32 v[192:193], v[160:161], v[22:23], v[4:5] op_sel:[0,0,0] op_sel_hi:[1,0,0]
    v_pk_fma_f32 v[194:195], v[162:163], v[22:23], v[4:5] op_sel:[0,0,0] op_sel_hi:[1,0,0]
    v_pk_fma_f32 v[196:197], v[164:165], v[22:23], v[4:5] op_sel:[0,0,0] op_sel_hi:[1,0,0]
    v_pk_fma_f32 v[198:199], v[166:167], v[22:23], v[4:5] op_sel:[0,0,0] op_sel_hi:[1,0,0]
    v_pk_fma_f32 v[200:201], v[168:169], v[22:23], v[4:5] op_sel:[0,1,1] op_sel_hi:[1,1,1]
    v_pk_fma_f32 v[202:203], v[170:171], v[22:23], v[4:5] op_sel:[0,1,1] op_sel_hi:[1,1,1]
    v_pk_fma_f32 v[204:205], v[172:173], v[22:23], v[4:5] op_sel:[0,1,1] op_sel_hi:[1,1,1]
    v_pk_fma_f32 v[206:207], v[174:175], v[22:23], v[4:5] op_sel:[0,1,1] op_sel_hi:[1,1,1]
    v_pk_fma_f32 v[160:161], v[160:161], v[22:23], v[6:7] op_sel:[0,0,0] op_sel_hi:[1,0,0] neg_lo:[1,0,0] neg_hi:[1,0,0]
    v_pk_fma_f32 v[162:163], v[162:163], v[22:23], v[6:7] op_sel:[0,0,0] op_sel_hi:[1,0,0] neg_lo:[1,0,0] neg_hi:[1,0,0]
    v_pk_fma_f32 v[164:165], v[164:165], v[22:23], v[6:7] op_sel:[0,0,0] op_sel_hi:[1,0,0] neg_lo:[1,0,0] neg_hi:[1,0,0]
    v_pk_fma_f32 v[166:167], v[166:167], v[22:23], v[6:7] op_sel:[0,0,0] op_sel_hi:[1,0,0] neg_lo:[1,0,0] neg_hi:[1,0,0]
    v_pk_fma_f32 v[168:169], v[168:169], v[22:23], v[6:7] op_sel:[0,1,1] op_sel_hi:[1,1,1] neg_lo:[1,0,0] neg_hi:[1,0,0]
    v_pk_fma_f32 v[170:171], v[170:171], v[22:23], v[6:7] op_sel:[0,1,1] op_sel_hi:[1,1,1] neg_lo:[1,0,0] neg_hi:[1,0,0]
    v_pk_fma_f32 v[172:173], v[172:173], v[22:23], v[6:7] op_sel:[0,1,1] op_sel_hi:[1,1,1] neg_lo:[1,0,0] neg_hi:[1,0,0]
    v_pk_fma_f32 v[174:175], v[174:175], v[22:23], v[6:7] op_sel:[0,1,1] op_sel_hi:[1,1,1] neg_lo:[1,0,0] neg_hi:[1,0,0]
    v_exp_f32 v192, v192
    v_exp_f32 v193, v193
    v_mfma_f32_16x16x32_bf16 v[176:179], a[244:247], v[208:211], 0
    v_exp_f32 v194, v194
    v_mfma_f32_16x16x32_bf16 v[180:183], a[248:251], v[208:211], 0
    v_exp_f32 v195, v195
    v_mfma_f32_16x16x32_bf16 v[184:187], a[244:247], v[216:219], 0
    v_exp_f32 v196, v196
    v_mfma_f32_16x16x32_bf16 v[188:191], a[248:251], v[216:219], 0
    v_exp_f32 v197, v197
    v_exp_f32 v198, v198
    v_exp_f32 v199, v199
    v_exp_f32 v200, v200
    v_exp_f32 v201, v201
    v_exp_f32 v202, v202
    v_exp_f32 v203, v203
    v_exp_f32 v204, v204
    v_exp_f32 v205, v205
    v_exp_f32 v206, v206
    v_exp_f32 v207, v207
    v_exp_f32 v160, v160
    v_exp_f32 v161, v161
    v_exp_f32 v162, v162
    v_exp_f32 v163, v163
    v_exp_f32 v164, v164
    v_exp_f32 v165, v165
    v_exp_f32 v166, v166
    v_exp_f32 v167, v167
    v_exp_f32 v168, v168
    v_exp_f32 v169, v169
    v_exp_f32 v170, v170
    v_exp_f32 v171, v171
    v_exp_f32 v172, v172
    v_exp_f32 v173, v173
    v_exp_f32 v174, v174
    v_exp_f32 v175, v175
    v_pk_add_f32 v[0:1], v[192:193], v[194:195]
    v_pk_add_f32 v[2:3], v[200:201], v[202:203]
    v_pk_add_f32 v[4:5], v[160:161], v[162:163]
    v_pk_add_f32 v[6:7], v[168:169], v[170:171]
    v_pk_add_f32 v[0:1], v[0:1], v[196:197]
    v_pk_add_f32 v[2:3], v[2:3], v[204:205]
    v_pk_add_f32 v[4:5], v[4:5], v[164:165]
    v_pk_add_f32 v[6:7], v[6:7], v[172:173]
    v_pk_add_f32 v[0:1], v[0:1], v[198:199]
L_pad1_9:
    s_cbranch_execz L_pad1_13
    v_pk_add_f32 v[2:3], v[2:3], v[206:207]
    v_pk_add_f32 v[4:5], v[4:5], v[166:167]
    v_pk_add_f32 v[6:7], v[6:7], v[174:175]
    v_add_f32 v0, v0, v1
    v_add_f32 v1, v2, v3
    v_add_f32 v2, v4, v5
    v_add_f32 v3, v6, v7
    v_permlane32_swap_b32 v0, v1
    v_max3_f32 v4, v176, v177, v178
    v_permlane32_swap_b32 v2, v3
    v_add_f32 v0, v0, v1
    v_add_f32 v2, v2, v3
    v_max3_f32 v6, -v176, -v177, -v178
    v_max3_f32 v5, v184, v185, v186
    v_permlane16_swap_b32 v0, v2
    v_add_f32 v0, v0, v2
    v_rcp_f32 v0, v0
    v_max3_f32 v7, -v184, -v185, -v186
    v_mov_b32 v2, v0
    v_max3_f32 v4, v4, v179, v180
    v_max3_f32 v6, v6, -v179, -v180
    v_permlane16_swap_b32 v0, v2
    v_mov_b32 v1, v0
    v_mov_b32 v3, v2
    v_max3_f32 v5, v5, v187, v188
    v_permlane32_swap_b32 v0, v1
    v_permlane32_swap_b32 v2, v3
    v_max3_f32 v7, v7, -v187, -v188
    v_max3_f32 v4, v4, v181, v182
    v_max3_f32 v6, v6, -v181, -v182
    v_max3_f32 v5, v5, v189, v190
    v_max3_f32 v7, v7, -v189, -v190
    v_max_f32_e64 v4, v4, v183
    v_max_f32_e64 v6, v6, -v183
    v_max_f32_e64 v5, v5, v191
    v_max_f32_e64 v7, v7, -v191
    v_pk_mul_f32 v[192:193], v[192:193], v[0:1] op_sel:[0,0] op_sel_hi:[1,0]
    v_permlane32_swap_b32 v4, v5
    v_permlane32_swap_b32 v6, v7
    v_max_f32 v4, v4, v5
    v_max_f32 v6, v6, v7
    v_pk_mul_f32 v[194:195], v[194:195], v[0:1] op_sel:[0,0] op_sel_hi:[1,0]
    v_pk_mul_f32 v[196:197], v[196:197], v[0:1] op_sel:[0,0] op_sel_hi:[1,0]
    v_permlane16_swap_b32 v4, v6
    v_max_f32 v4, v4, v6
    v_mov_b32 v6, v4
    v_pk_mul_f32 v[198:199], v[198:199], v[0:1] op_sel:[0,0] op_sel_hi:[1,0]
    v_pk_mul_f32 v[200:201], v[200:201], v[0:1] op_sel:[0,1] op_sel_hi:[1,1]
    v_permlane16_swap_b32 v4, v6
    v_mov_b32 v5, v4
    v_mov_b32 v7, v6
    v_pk_mul_f32 v[202:203], v[202:203], v[0:1] op_sel:[0,1] op_sel_hi:[1,1]
    v_permlane32_swap_b32 v4, v5
    v_permlane32_swap_b32 v6, v7
    v_pk_mul_f32 v[204:205], v[204:205], v[0:1] op_sel:[0,1] op_sel_hi:[1,1]
    v_pk_mul_f32 v[206:207], v[206:207], v[0:1] op_sel:[0,1] op_sel_hi:[1,1]
    v_pk_mul_f32 v[160:161], v[160:161], v[2:3] op_sel:[0,0] op_sel_hi:[1,0]
    v_pk_mul_f32 v[162:163], v[162:163], v[2:3] op_sel:[0,0] op_sel_hi:[1,0]
    v_pk_mul_f32 v[164:165], v[164:165], v[2:3] op_sel:[0,0] op_sel_hi:[1,0]
    v_pk_mul_f32 v[166:167], v[166:167], v[2:3] op_sel:[0,0] op_sel_hi:[1,0]
    v_pk_mul_f32 v[168:169], v[168:169], v[2:3] op_sel:[0,1] op_sel_hi:[1,1]
    v_pk_mul_f32 v[170:171], v[170:171], v[2:3] op_sel:[0,1] op_sel_hi:[1,1]
    v_pk_mul_f32 v[172:173], v[172:173], v[2:3] op_sel:[0,1] op_sel_hi:[1,1]
    v_pk_mul_f32 v[174:175], v[174:175], v[2:3] op_sel:[0,1] op_sel_hi:[1,1]
    v_cvt_pk_bf16_f32 v32, v192, v193
    v_cvt_pk_bf16_f32 v33, v194, v195
    v_cvt_pk_bf16_f32 v34, v196, v197
    v_cvt_pk_bf16_f32 v35, v198, v199
    v_cvt_pk_bf16_f32 v40, v200, v201
    v_cvt_pk_bf16_f32 v41, v202, v203
    v_cvt_pk_bf16_f32 v42, v204, v205
    v_cvt_pk_bf16_f32 v43, v206, v207
    v_cvt_pk_bf16_f32 v36, v160, v161
    v_cvt_pk_bf16_f32 v37, v162, v163
    v_cvt_pk_bf16_f32 v38, v164, v165
    v_cvt_pk_bf16_f32 v39, v166, v167
    v_cvt_pk_bf16_f32 v44, v168, v169
    v_cvt_pk_bf16_f32 v45, v170, v171
    v_cvt_pk_bf16_f32 v46, v172, v173
    v_cvt_pk_bf16_f32 v47, v174, v175
    v_accvgpr_read_b32 v208, a16
    v_accvgpr_read_b32 v209, a17
    v_accvgpr_read_b32 v210, a18
    v_accvgpr_read_b32 v211, a19
    v_accvgpr_read_b32 v212, a48
    v_accvgpr_read_b32 v213, a49
    v_accvgpr_read_b32 v214, a50
    v_accvgpr_read_b32 v215, a51
    v_accvgpr_read_b32 v216, a20
    v_accvgpr_read_b32 v217, a21
    v_accvgpr_read_b32 v218, a22
    v_accvgpr_read_b32 v219, a23
    v_accvgpr_read_b32 v220, a52
    v_accvgpr_read_b32 v221, a53
    v_accvgpr_read_b32 v222, a54
    v_accvgpr_read_b32 v223, a55
    v_cvt_pk_bf16_f32 v208, v208, v209
    v_cvt_pk_bf16_f32 v209, v210, v211
    v_cvt_pk_bf16_f32 v210, v212, v213
    v_cvt_pk_bf16_f32 v211, v214, v215
    v_cvt_pk_bf16_f32 v216, v216, v217
    v_cvt_pk_bf16_f32 v217, v218, v219
    v_cvt_pk_bf16_f32 v218, v220, v221
    v_cvt_pk_bf16_f32 v219, v222, v223
    s_waitcnt vmcnt(1)
    s_barrier
    s_cmp_lg_u32 s44, 0
    s_cbranch_scc1 L_fhb_skip
    v_accvgpr_write_b32 a254, 2
    s_mov_b64 exec, 1
    buffer_store_dword a254, off, s[20:23], s81 sc1
    s_mov_b64 exec, -1
L_fhb_skip:
    v_bfe_u32 v224, v13, 4, 2
    v_lshlrev_b32_e64 v224, 2, v224
    buffer_load_dword v225, v224, s[20:23], s76 offen sc1
    v_pk_mul_f32 v[4:5], v[4:5], v[24:25] neg_lo:[1,0] neg_hi:[1,0]
    v_pk_mul_f32 v[6:7], v[6:7], v[24:25] neg_lo:[1,0] neg_hi:[1,0]
    v_pk_fma_f32 v[192:193], v[176:177], v[24:25], v[4:5] op_sel:[0,0,0] op_sel_hi:[1,0,0]
    v_pk_fma_f32 v[194:195], v[178:179], v[24:25], v[4:5] op_sel:[0,0,0] op_sel_hi:[1,0,0]
    v_pk_fma_f32 v[196:197], v[180:181], v[24:25], v[4:5] op_sel:[0,0,0] op_sel_hi:[1,0,0]
    v_pk_fma_f32 v[198:199], v[182:183], v[24:25], v[4:5] op_sel:[0,0,0] op_sel_hi:[1,0,0]
    v_pk_fma_f32 v[200:201], v[184:185], v[24:25], v[4:5] op_sel:[0,1,1] op_sel_hi:[1,1,1]
    v_pk_fma_f32 v[202:203], v[186:187], v[24:25], v[4:5] op_sel:[0,1,1] op_sel_hi:[1,1,1]
    v_pk_fma_f32 v[204:205], v[188:189], v[24:25], v[4:5] op_sel:[0,1,1] op_sel_hi:[1,1,1]
    v_pk_fma_f32 v[206:207], v[190:191], v[24:25], v[4:5] op_sel:[0,1,1] op_sel_hi:[1,1,1]
    v_pk_fma_f32 v[176:177], v[176:177], v[24:25], v[6:7] op_sel:[0,0,0] op_sel_hi:[1,0,0] neg_lo:[1,0,0] neg_hi:[1,0,0]
    v_pk_fma_f32 v[178:179], v[178:179], v[24:25], v[6:7] op_sel:[0,0,0] op_sel_hi:[1,0,0] neg_lo:[1,0,0] neg_hi:[1,0,0]
    v_pk_fma_f32 v[180:181], v[180:181], v[24:25], v[6:7] op_sel:[0,0,0] op_sel_hi:[1,0,0] neg_lo:[1,0,0] neg_hi:[1,0,0]
    v_pk_fma_f32 v[182:183], v[182:183], v[24:25], v[6:7] op_sel:[0,0,0] op_sel_hi:[1,0,0] neg_lo:[1,0,0] neg_hi:[1,0,0]
    v_pk_fma_f32 v[184:185], v[184:185], v[24:25], v[6:7] op_sel:[0,1,1] op_sel_hi:[1,1,1] neg_lo:[1,0,0] neg_hi:[1,0,0]
    v_pk_fma_f32 v[186:187], v[186:187], v[24:25], v[6:7] op_sel:[0,1,1] op_sel_hi:[1,1,1] neg_lo:[1,0,0] neg_hi:[1,0,0]
    v_pk_fma_f32 v[188:189], v[188:189], v[24:25], v[6:7] op_sel:[0,1,1] op_sel_hi:[1,1,1] neg_lo:[1,0,0] neg_hi:[1,0,0]
    v_pk_fma_f32 v[190:191], v[190:191], v[24:25], v[6:7] op_sel:[0,1,1] op_sel_hi:[1,1,1] neg_lo:[1,0,0] neg_hi:[1,0,0]
    v_exp_f32 v192, v192
    v_exp_f32 v193, v193
    v_mfma_f32_16x16x32_bf16 v[160:163], a[244:247], v[208:211], 0
    v_exp_f32 v194, v194
    v_mfma_f32_16x16x32_bf16 v[164:167], a[248:251], v[208:211], 0
    v_exp_f32 v195, v195
    v_mfma_f32_16x16x32_bf16 v[168:171], a[244:247], v[216:219], 0
    v_exp_f32 v196, v196
    v_mfma_f32_16x16x32_bf16 v[172:175], a[248:251], v[216:219], 0
    v_exp_f32 v197, v197
    v_exp_f32 v198, v198
    v_exp_f32 v199, v199
    v_exp_f32 v200, v200
    v_exp_f32 v201, v201
    v_exp_f32 v202, v202
    v_exp_f32 v203, v203
    v_exp_f32 v204, v204
    v_exp_f32 v205, v205
    v_exp_f32 v206, v206
    v_exp_f32 v207, v207
    v_exp_f32 v176, v176
    v_exp_f32 v177, v177
    v_exp_f32 v178, v178
    v_exp_f32 v179, v179
    v_exp_f32 v180, v180
    v_exp_f32 v181, v181
    v_exp_f32 v182, v182
    v_exp_f32 v183, v183
    v_exp_f32 v184, v184
    v_exp_f32 v185, v185
    v_exp_f32 v186, v186
    v_exp_f32 v187, v187
    v_exp_f32 v188, v188
    v_exp_f32 v189, v189
    v_exp_f32 v190, v190
    v_exp_f32 v191, v191
    v_pk_add_f32 v[0:1], v[192:193], v[194:195]
    v_pk_add_f32 v[2:3], v[200:201], v[202:203]
    v_pk_add_f32 v[4:5], v[176:177], v[178:179]
    v_pk_add_f32 v[6:7], v[184:185], v[186:187]
    v_pk_add_f32 v[0:1], v[0:1], v[196:197]
    v_pk_add_f32 v[2:3], v[2:3], v[204:205]
    v_pk_add_f32 v[4:5], v[4:5], v[180:181]
    v_pk_add_f32 v[6:7], v[6:7], v[188:189]
    v_pk_add_f32 v[0:1], v[0:1], v[198:199]
    v_pk_add_f32 v[2:3], v[2:3], v[206:207]
    v_pk_add_f32 v[4:5], v[4:5], v[182:183]
    v_pk_add_f32 v[6:7], v[6:7], v[190:191]
    v_add_f32 v0, v0, v1
    v_add_f32 v1, v2, v3
    v_add_f32 v2, v4, v5
    v_add_f32 v3, v6, v7
    v_permlane32_swap_b32 v0, v1
    v_max3_f32 v4, v160, v161, v162
    v_permlane32_swap_b32 v2, v3
    v_add_f32 v0, v0, v1
    v_add_f32 v2, v2, v3
    v_max3_f32 v6, -v160, -v161, -v162
    v_max3_f32 v5, v168, v169, v170
    v_permlane16_swap_b32 v0, v2
    v_add_f32 v0, v0, v2
    v_rcp_f32 v0, v0
    v_max3_f32 v7, -v168, -v169, -v170
    v_mov_b32 v2, v0
    v_max3_f32 v4, v4, v163, v164
    v_max3_f32 v6, v6, -v163, -v164
    v_permlane16_swap_b32 v0, v2
    v_mov_b32 v1, v0
    v_mov_b32 v3, v2
    v_max3_f32 v5, v5, v171, v172
    v_permlane32_swap_b32 v0, v1
    v_permlane32_swap_b32_e64 v2, v3
    v_max3_f32 v7, v7, -v171, -v172
    v_max3_f32 v4, v4, v165, v166
    v_max3_f32 v6, v6, -v165, -v166
    v_max3_f32 v5, v5, v173, v174
    v_max3_f32 v7, v7, -v173, -v174
    v_max_f32_e64 v4, v4, v167
    v_max_f32_e64 v6, v6, -v167
    v_max_f32_e64 v5, v5, v175
    v_max_f32_e64 v7, v7, -v175
    v_pk_mul_f32 v[192:193], v[192:193], v[0:1] op_sel:[0,0] op_sel_hi:[1,0]
    v_permlane32_swap_b32 v4, v5
    v_permlane32_swap_b32 v6, v7
    v_max_f32 v4, v4, v5
    v_max_f32 v6, v6, v7
    v_pk_mul_f32 v[194:195], v[194:195], v[0:1] op_sel:[0,0] op_sel_hi:[1,0]
    v_pk_mul_f32 v[196:197], v[196:197], v[0:1] op_sel:[0,0] op_sel_hi:[1,0]
    v_permlane16_swap_b32 v4, v6
    v_max_f32 v4, v4, v6
    v_mov_b32 v6, v4
    v_pk_mul_f32 v[198:199], v[198:199], v[0:1] op_sel:[0,0] op_sel_hi:[1,0]
    v_pk_mul_f32 v[200:201], v[200:201], v[0:1] op_sel:[0,1] op_sel_hi:[1,1]
    v_permlane16_swap_b32 v4, v6
    v_mov_b32 v5, v4
    v_mov_b32 v7, v6
    v_pk_mul_f32 v[202:203], v[202:203], v[0:1] op_sel:[0,1] op_sel_hi:[1,1]
    v_permlane32_swap_b32 v4, v5
    v_permlane32_swap_b32 v6, v7
    v_pk_mul_f32 v[204:205], v[204:205], v[0:1] op_sel:[0,1] op_sel_hi:[1,1]
    v_pk_mul_f32 v[206:207], v[206:207], v[0:1] op_sel:[0,1] op_sel_hi:[1,1]
    v_pk_mul_f32 v[176:177], v[176:177], v[2:3] op_sel:[0,0] op_sel_hi:[1,0]
    v_pk_mul_f32 v[178:179], v[178:179], v[2:3] op_sel:[0,0] op_sel_hi:[1,0]
    v_pk_mul_f32 v[180:181], v[180:181], v[2:3] op_sel:[0,0] op_sel_hi:[1,0]
    v_pk_mul_f32 v[182:183], v[182:183], v[2:3] op_sel:[0,0] op_sel_hi:[1,0]
    v_pk_mul_f32 v[184:185], v[184:185], v[2:3] op_sel:[0,1] op_sel_hi:[1,1]
    v_pk_mul_f32 v[186:187], v[186:187], v[2:3] op_sel:[0,1] op_sel_hi:[1,1]
    v_pk_mul_f32 v[188:189], v[188:189], v[2:3] op_sel:[0,1] op_sel_hi:[1,1]
    v_pk_mul_f32 v[190:191], v[190:191], v[2:3] op_sel:[0,1] op_sel_hi:[1,1]
    v_cvt_pk_bf16_f32 v48, v192, v193
    v_cvt_pk_bf16_f32 v49, v194, v195
    v_cvt_pk_bf16_f32 v50, v196, v197
    v_cvt_pk_bf16_f32 v51, v198, v199
    v_cvt_pk_bf16_f32 v56, v200, v201
    v_cvt_pk_bf16_f32 v57, v202, v203
    v_cvt_pk_bf16_f32 v58, v204, v205
    v_cvt_pk_bf16_f32 v59, v206, v207
    v_cvt_pk_bf16_f32 v52, v176, v177
    v_cvt_pk_bf16_f32 v53, v178, v179
    v_cvt_pk_bf16_f32 v54, v180, v181
    v_cvt_pk_bf16_f32 v55, v182, v183
    v_cvt_pk_bf16_f32 v60, v184, v185
    v_cvt_pk_bf16_f32 v61, v186, v187
    v_cvt_pk_bf16_f32 v62, v188, v189
    v_cvt_pk_bf16_f32 v63, v190, v191
    v_accvgpr_read_b32 v208, a24
    v_accvgpr_read_b32 v209, a25
    v_accvgpr_read_b32 v210, a26
    v_accvgpr_read_b32 v211, a27
    v_accvgpr_read_b32 v212, a56
    v_accvgpr_read_b32 v213, a57
    v_accvgpr_read_b32 v214, a58
    v_accvgpr_read_b32 v215, a59
    v_accvgpr_read_b32 v216, a28
    v_accvgpr_read_b32 v217, a29
    v_accvgpr_read_b32 v218, a30
    v_accvgpr_read_b32 v219, a31
    v_accvgpr_read_b32 v220, a60
    v_accvgpr_read_b32 v221, a61
    v_accvgpr_read_b32 v222, a62
    v_accvgpr_read_b32 v223, a63
    v_cvt_pk_bf16_f32 v208, v208, v209
    v_cvt_pk_bf16_f32 v209, v210, v211
    v_cvt_pk_bf16_f32 v210, v212, v213
    v_cvt_pk_bf16_f32 v211, v214, v215
    v_cvt_pk_bf16_f32 v216, v216, v217
    v_cvt_pk_bf16_f32 v217, v218, v219
    v_cvt_pk_bf16_f32 v218, v220, v221
    v_cvt_pk_bf16_f32 v219, v222, v223
    s_waitcnt vmcnt(0)
    v_cmp_le_u32 vcc, 1, v225
    s_nop 0
    s_cmp_eq_u64 vcc, -1
    s_cbranch_scc0 L_phbb_spin
L_phbb_ok:
    s_nop 0
    v_pk_mul_f32 v[4:5], v[4:5], v[26:27] neg_lo:[1,0] neg_hi:[1,0]
    v_pk_mul_f32 v[6:7], v[6:7], v[26:27] neg_lo:[1,0] neg_hi:[1,0]
    v_pk_fma_f32 v[192:193], v[160:161], v[26:27], v[4:5] op_sel:[0,0,0] op_sel_hi:[1,0,0]
    v_pk_fma_f32 v[194:195], v[162:163], v[26:27], v[4:5] op_sel:[0,0,0] op_sel_hi:[1,0,0]
    v_pk_fma_f32 v[196:197], v[164:165], v[26:27], v[4:5] op_sel:[0,0,0] op_sel_hi:[1,0,0]
    v_pk_fma_f32 v[198:199], v[166:167], v[26:27], v[4:5] op_sel:[0,0,0] op_sel_hi:[1,0,0]
    v_pk_fma_f32 v[200:201], v[168:169], v[26:27], v[4:5] op_sel:[0,1,1] op_sel_hi:[1,1,1]
    v_pk_fma_f32 v[202:203], v[170:171], v[26:27], v[4:5] op_sel:[0,1,1] op_sel_hi:[1,1,1]
    v_pk_fma_f32 v[204:205], v[172:173], v[26:27], v[4:5] op_sel:[0,1,1] op_sel_hi:[1,1,1]
    v_pk_fma_f32 v[206:207], v[174:175], v[26:27], v[4:5] op_sel:[0,1,1] op_sel_hi:[1,1,1]
    v_pk_fma_f32 v[160:161], v[160:161], v[26:27], v[6:7] op_sel:[0,0,0] op_sel_hi:[1,0,0] neg_lo:[1,0,0] neg_hi:[1,0,0]
    v_pk_fma_f32 v[162:163], v[162:163], v[26:27], v[6:7] op_sel:[0,0,0] op_sel_hi:[1,0,0] neg_lo:[1,0,0] neg_hi:[1,0,0]
    v_pk_fma_f32 v[164:165], v[164:165], v[26:27], v[6:7] op_sel:[0,0,0] op_sel_hi:[1,0,0] neg_lo:[1,0,0] neg_hi:[1,0,0]
    v_pk_fma_f32 v[166:167], v[166:167], v[26:27], v[6:7] op_sel:[0,0,0] op_sel_hi:[1,0,0] neg_lo:[1,0,0] neg_hi:[1,0,0]
    v_pk_fma_f32 v[168:169], v[168:169], v[26:27], v[6:7] op_sel:[0,1,1] op_sel_hi:[1,1,1] neg_lo:[1,0,0] neg_hi:[1,0,0]
    v_pk_fma_f32 v[170:171], v[170:171], v[26:27], v[6:7] op_sel:[0,1,1] op_sel_hi:[1,1,1] neg_lo:[1,0,0] neg_hi:[1,0,0]
    v_pk_fma_f32 v[172:173], v[172:173], v[26:27], v[6:7] op_sel:[0,1,1] op_sel_hi:[1,1,1] neg_lo:[1,0,0] neg_hi:[1,0,0]
    v_pk_fma_f32 v[174:175], v[174:175], v[26:27], v[6:7] op_sel:[0,1,1] op_sel_hi:[1,1,1] neg_lo:[1,0,0] neg_hi:[1,0,0]
    v_exp_f32 v192, v192
    v_exp_f32 v193, v193
    v_mfma_f32_16x16x32_bf16 v[176:179], a[244:247], v[208:211], 0
    s_add_u32 s75, s56, 0
    buffer_load_dwordx4 a[160:163], v13, s[20:23], s75 offen sc1
    v_exp_f32 v194, v194
    v_exp_f32 v195, v195
    v_exp_f32 v196, v196
    v_exp_f32 v197, v197
    v_mfma_f32_16x16x32_bf16 v[180:183], a[248:251], v[208:211], 0
    buffer_load_dwordx4 a[164:167], v13, s[20:23], s75 offen offset:1024 sc1
    v_exp_f32 v198, v198
    v_exp_f32 v199, v199
    v_exp_f32 v200, v200
    v_exp_f32 v201, v201
    v_mfma_f32_16x16x32_bf16 v[184:187], a[244:247], v[216:219], 0
    buffer_load_dwordx4 a[168:171], v13, s[20:23], s75 offen offset:2048 sc1
    v_exp_f32 v202, v202
    v_exp_f32 v203, v203
    v_exp_f32 v204, v204
    v_exp_f32 v205, v205
    v_mfma_f32_16x16x32_bf16 v[188:191], a[248:251], v[216:219], 0
    buffer_load_dwordx4 a[172:175], v13, s[20:23], s75 offen offset:3072 sc1
    v_exp_f32 v206, v206
    v_exp_f32 v207, v207
    v_exp_f32 v160, v160
    v_exp_f32 v161, v161
    s_add_u32 s75, s85, 0
    buffer_load_dwordx4 a[176:179], v13, s[20:23], s75 offen sc1
    v_exp_f32 v162, v162
    v_exp_f32 v163, v163
    v_exp_f32 v164, v164
    v_exp_f32 v165, v165
    buffer_load_dwordx4 a[180:183], v13, s[20:23], s75 offen offset:1024 sc1
    v_exp_f32 v166, v166
    v_exp_f32 v167, v167
    v_exp_f32 v168, v168
    v_exp_f32 v169, v169
    buffer_load_dwordx4 a[184:187], v13, s[20:23], s75 offen offset:2048 sc1
    v_exp_f32 v170, v170
    v_exp_f32 v171, v171
    v_exp_f32 v172, v172
    v_exp_f32 v173, v173
    buffer_load_dwordx4 a[188:191], v13, s[20:23], s75 offen offset:3072 sc1
    v_exp_f32 v174, v174
    v_exp_f32 v175, v175
    v_pk_add_f32 v[0:1], v[192:193], v[194:195]
    v_pk_add_f32 v[2:3], v[200:201], v[202:203]
    v_pk_add_f32 v[4:5], v[160:161], v[162:163]
    v_pk_add_f32 v[6:7], v[168:169], v[170:171]
    v_pk_add_f32 v[0:1], v[0:1], v[196:197]
    v_pk_add_f32 v[2:3], v[2:3], v[204:205]
    v_pk_add_f32 v[4:5], v[4:5], v[164:165]
    v_pk_add_f32 v[6:7], v[6:7], v[172:173]
    v_pk_add_f32 v[0:1], v[0:1], v[198:199]
    v_pk_add_f32 v[2:3], v[2:3], v[206:207]
    v_pk_add_f32 v[4:5], v[4:5], v[166:167]
    v_pk_add_f32 v[6:7], v[6:7], v[174:175]
    v_add_f32 v0, v0, v1
    v_add_f32 v1, v2, v3
    v_add_f32 v2, v4, v5
    v_add_f32 v3, v6, v7
    v_permlane32_swap_b32 v0, v1
    v_max3_f32 v212, v176, v177, v178
    v_permlane32_swap_b32 v2, v3
    v_add_f32 v0, v0, v1
    v_add_f32 v2, v2, v3
    v_max3_f32 v214, -v176, -v177, -v178
    v_max3_f32 v213, v184, v185, v186
    v_permlane16_swap_b32 v0, v2
    v_add_f32 v0, v0, v2
    v_rcp_f32 v0, v0
    v_max3_f32 v215, -v184, -v185, -v186
    v_mov_b32 v2, v0
    v_max3_f32 v212, v212, v179, v180
    v_max3_f32 v214, v214, -v179, -v180
    v_permlane16_swap_b32 v0, v2
    v_mov_b32 v1, v0
    v_mov_b32 v3, v2
    v_max3_f32 v213, v213, v187, v188
    v_permlane32_swap_b32 v0, v1
    v_permlane32_swap_b32_e64 v2, v3
    v_max3_f32 v215, v215, -v187, -v188
    v_max3_f32 v212, v212, v181, v182
    v_max3_f32 v214, v214, -v181, -v182
    v_max3_f32 v213, v213, v189, v190
    v_max3_f32 v215, v215, -v189, -v190
    v_max_f32_e64 v212, v212, v183
    v_max_f32_e64 v214, v214, -v183
    v_max_f32_e64 v213, v213, v191
    v_max_f32_e64 v215, v215, -v191
    v_pk_mul_f32 v[192:193], v[192:193], v[0:1] op_sel:[0,0] op_sel_hi:[1,0]
    v_permlane32_swap_b32 v212, v213
    v_permlane32_swap_b32 v214, v215
    v_max_f32 v212, v212, v213
    v_max_f32 v214, v214, v215
    v_pk_mul_f32 v[194:195], v[194:195], v[0:1] op_sel:[0,0] op_sel_hi:[1,0]
    v_pk_mul_f32 v[196:197], v[196:197], v[0:1] op_sel:[0,0] op_sel_hi:[1,0]
    v_permlane16_swap_b32 v212, v214
    v_max_f32 v212, v212, v214
    v_mov_b32 v214, v212
    v_pk_mul_f32 v[198:199], v[198:199], v[0:1] op_sel:[0,0] op_sel_hi:[1,0]
    v_pk_mul_f32 v[200:201], v[200:201], v[0:1] op_sel:[0,1] op_sel_hi:[1,1]
    v_permlane16_swap_b32 v212, v214
    v_mov_b32 v213, v212
    v_mov_b32 v215, v214
    v_pk_mul_f32 v[202:203], v[202:203], v[0:1] op_sel:[0,1] op_sel_hi:[1,1]
    v_permlane32_swap_b32 v212, v213
    v_permlane32_swap_b32 v214, v215
    v_pk_mul_f32 v[204:205], v[204:205], v[0:1] op_sel:[0,1] op_sel_hi:[1,1]
    v_pk_mul_f32 v[206:207], v[206:207], v[0:1] op_sel:[0,1] op_sel_hi:[1,1]
    v_pk_mul_f32 v[160:161], v[160:161], v[2:3] op_sel:[0,0] op_sel_hi:[1,0]
    v_pk_mul_f32 v[162:163], v[162:163], v[2:3] op_sel:[0,0] op_sel_hi:[1,0]
    v_pk_mul_f32 v[164:165], v[164:165], v[2:3] op_sel:[0,0] op_sel_hi:[1,0]
    v_pk_mul_f32 v[166:167], v[166:167], v[2:3] op_sel:[0,0] op_sel_hi:[1,0]
    v_pk_mul_f32 v[168:169], v[168:169], v[2:3] op_sel:[0,1] op_sel_hi:[1,1]
    v_pk_mul_f32 v[170:171], v[170:171], v[2:3] op_sel:[0,1] op_sel_hi:[1,1]
    v_pk_mul_f32 v[172:173], v[172:173], v[2:3] op_sel:[0,1] op_sel_hi:[1,1]
    v_pk_mul_f32 v[174:175], v[174:175], v[2:3] op_sel:[0,1] op_sel_hi:[1,1]
    v_cvt_pk_bf16_f32 v64, v192, v193
    v_cvt_pk_bf16_f32 v65, v194, v195
    v_cvt_pk_bf16_f32 v66, v196, v197
    v_cvt_pk_bf16_f32 v67, v198, v199
    v_cvt_pk_bf16_f32 v72, v200, v201
    v_cvt_pk_bf16_f32 v73, v202, v203
    v_cvt_pk_bf16_f32 v74, v204, v205
    v_cvt_pk_bf16_f32 v75, v206, v207
    v_cvt_pk_bf16_f32 v68, v160, v161
    v_cvt_pk_bf16_f32 v69, v162, v163
    v_cvt_pk_bf16_f32 v70, v164, v165
    v_cvt_pk_bf16_f32 v71, v166, v167
    v_cvt_pk_bf16_f32 v76, v168, v169
    v_cvt_pk_bf16_f32 v77, v170, v171
    v_cvt_pk_bf16_f32 v78, v172, v173
    v_cvt_pk_bf16_f32 v79, v174, v175
    v_lshrrev_b32 v2, 6, v13
    v_lshlrev_b32 v2, 7, v2
    v_bfe_u32 v3, v13, 4, 2
    v_lshl_add_u32 v2, v3, 3, v2
    v_bfe_u32 v3, v13, 7, 2
    v_lshl_add_u32 v14, v3, 5, v2
    v_xor_b32 v18, 65536, v14
    v_xor_b32 v19, 65568, v14
    v_xor_b32 v20, 65600, v14
    v_xor_b32 v21, 65632, v14
    s_add_u32 s75, s56, 262144
    ds_read_b64_tr_b16 a[0:1], v18 offset:16384
    buffer_load_dwordx4 a[192:195], v13, s[20:23], s75 offen sc1
    ds_read_b64_tr_b16 a[2:3], v18 offset:18432
    ds_read_b64_tr_b16 a[4:5], v18 offset:24576
    ds_read_b64_tr_b16 a[6:7], v18 offset:26624
    buffer_load_dwordx4 a[196:199], v13, s[20:23], s75 offen offset:1024 sc1
    ds_read_b64_tr_b16 a[8:9], v19 offset:16384
    ds_read_b64_tr_b16 a[10:11], v19 offset:18432
    buffer_load_dwordx4 a[200:203], v13, s[20:23], s75 offen offset:2048 sc1
    ds_read_b64_tr_b16 a[12:13], v19 offset:24576
    ds_read_b64_tr_b16 a[14:15], v19 offset:26624
    buffer_load_dwordx4 a[204:207], v13, s[20:23], s75 offen offset:3072 sc1
    ds_read_b64_tr_b16 a[16:17], v20 offset:16384
    s_add_u32 s75, s85, 262144
    s_waitcnt vmcnt(4) lgkmcnt(5)
    v_mfma_f32_16x16x32_bf16 v[96:99], a[0:3], a[160:163], 0
    ds_read_b64_tr_b16 a[18:19], v20 offset:18432
    v_bfe_u32 v23, v13, 4, 3
    v_mfma_f32_16x16x32_bf16 v[96:99], a[4:7], a[168:171], v[96:99]
    buffer_load_dwordx4 a[208:211], v13, s[20:23], s75 offen sc1
    v_accvgpr_read_b32 v228, a144
    v_mfma_f32_16x16x32_bf16 v[100:103], a[0:3], a[164:167], 0
    ds_read_b64_tr_b16 a[20:21], v20 offset:24576
    v_lshlrev_b32 v23, 2, v23
    v_mfma_f32_16x16x32_bf16 v[100:103], a[4:7], a[172:175], v[100:103]
    v_accvgpr_read_b32 v229, a145
    v_mfma_f32_16x16x32_bf16 a[88:91], a[0:3], a[176:179], 0
    ds_read_b64_tr_b16 a[22:23], v20 offset:26624
    v_accvgpr_read_b32 v230, a146
    v_mfma_f32_16x16x32_bf16 a[88:91], a[4:7], a[184:187], a[88:91]
    buffer_load_dwordx4 a[212:215], v13, s[20:23], s75 offen offset:1024 sc1
    v_and_b32 v22, 12, v23
    v_mfma_f32_16x16x32_bf16 a[92:95], a[0:3], a[180:183], 0
    ds_read_b64_tr_b16 a[24:25], v21 offset:16384
    v_accvgpr_read_b32 v231, a147
    v_mfma_f32_16x16x32_bf16 a[92:95], a[4:7], a[188:191], a[92:95]
    s_waitcnt lgkmcnt(5)
    v_accvgpr_read_b32 v236, a148
    v_mfma_f32_16x16x32_bf16 v[104:107], a[8:11], a[160:163], 0
    ds_read_b64_tr_b16 a[26:27], v21 offset:18432
    v_mfma_f32_16x16x32_bf16 v[104:107], a[12:15], a[168:171], v[104:107]
    buffer_load_dwordx4 a[216:219], v13, s[20:23], s75 offen offset:2048 sc1
    v_accvgpr_read_b32 v237, a149
    v_mfma_f32_16x16x32_bf16 v[108:111], a[8:11], a[164:167], 0
    ds_read_b64_tr_b16 a[28:29], v21 offset:24576
    v_mfma_f32_16x16x32_bf16 v[108:111], a[12:15], a[172:175], v[108:111]
    v_accvgpr_read_b32 v238, a150
    v_mfma_f32_16x16x32_bf16 a[96:99], a[8:11], a[176:179], 0
    ds_read_b64_tr_b16 a[30:31], v21 offset:26624
    v_mfma_f32_16x16x32_bf16 a[96:99], a[12:15], a[184:187], a[96:99]
    buffer_load_dwordx4 a[220:223], v13, s[20:23], s75 offen offset:3072 sc1
    v_accvgpr_read_b32 v239, a151
    v_mfma_f32_16x16x32_bf16 a[100:103], a[8:11], a[180:183], 0
    ds_read_b64_tr_b16 a[32:33], v18 offset:20480
    v_mfma_f32_16x16x32_bf16 a[100:103], a[12:15], a[188:191], a[100:103]
    s_waitcnt lgkmcnt(5)
    v_accvgpr_read_b32 v244, a152
    v_mfma_f32_16x16x32_bf16 v[112:115], a[16:19], a[160:163], 0
    ds_read_b64_tr_b16 a[34:35], v18 offset:22528
    v_accvgpr_read_b32 v245, a153
    v_mfma_f32_16x16x32_bf16 v[112:115], a[20:23], a[168:171], v[112:115]
    s_add_u32 s75, s56, 524288
    v_mfma_f32_16x16x32_bf16 v[116:119], a[16:19], a[164:167], 0
    ds_read_b64_tr_b16 a[36:37], v18 offset:28672
    v_accvgpr_read_b32 v246, a154
    v_mfma_f32_16x16x32_bf16 v[116:119], a[20:23], a[172:175], v[116:119]
    buffer_load_dwordx4 a[224:227], v13, s[20:23], s75 offen sc1
    v_mfma_f32_16x16x32_bf16 a[104:107], a[16:19], a[176:179], 0
    ds_read_b64_tr_b16 a[38:39], v18 offset:30720
    v_accvgpr_read_b32 v247, a155
    v_mfma_f32_16x16x32_bf16 a[104:107], a[20:23], a[184:187], a[104:107]
    v_mfma_f32_16x16x32_bf16 a[108:111], a[16:19], a[180:183], 0
    ds_read_b64_tr_b16 a[40:41], v19 offset:20480
    v_accvgpr_read_b32 v252, a156
    v_mfma_f32_16x16x32_bf16 a[108:111], a[20:23], a[188:191], a[108:111]
    s_waitcnt lgkmcnt(5)
    v_mfma_f32_16x16x32_bf16 v[120:123], a[24:27], a[160:163], 0
    ds_read_b64_tr_b16 a[42:43], v19 offset:22528
    v_accvgpr_read_b32 v253, a157
    v_mfma_f32_16x16x32_bf16 v[120:123], a[28:31], a[168:171], v[120:123]
    buffer_load_dwordx4 a[228:231], v13, s[20:23], s75 offen offset:1024 sc1
    v_mfma_f32_16x16x32_bf16 v[124:127], a[24:27], a[164:167], 0
    ds_read_b64_tr_b16 a[44:45], v19 offset:28672
    v_accvgpr_read_b32 v254, a158
    v_mfma_f32_16x16x32_bf16 v[124:127], a[28:31], a[172:175], v[124:127]
    buffer_load_dwordx4 a[232:235], v13, s[20:23], s75 offen offset:2048 sc1
    v_mfma_f32_16x16x32_bf16 a[112:115], a[24:27], a[176:179], 0
    ds_read_b64_tr_b16 a[46:47], v19 offset:30720
    v_accvgpr_read_b32 v255, a159
    v_mfma_f32_16x16x32_bf16 a[112:115], a[28:31], a[184:187], a[112:115]
    v_mfma_f32_16x16x32_bf16 a[116:119], a[24:27], a[180:183], 0
    ds_read_b64_tr_b16 a[48:49], v20 offset:20480
    v_min_u32 v218, 624, v13
    v_mfma_f32_16x16x32_bf16 a[116:119], a[28:31], a[188:191], a[116:119]
    s_waitcnt lgkmcnt(5)
    v_mfma_f32_16x16x32_bf16 v[128:131], a[32:35], a[160:163], 0
    ds_read_b64_tr_b16 a[50:51], v20 offset:22528
    v_mfma_f32_16x16x32_bf16 v[128:131], a[36:39], a[168:171], v[128:131]
    buffer_load_dwordx4 a[236:239], v13, s[20:23], s75 offen offset:3072 sc1
    v_mfma_f32_16x16x32_bf16 v[132:135], a[32:35], a[164:167], 0
    ds_read_b64_tr_b16 a[52:53], v20 offset:28672
    v_mfma_f32_16x16x32_bf16 v[132:135], a[36:39], a[172:175], v[132:135]
    s_add_u32 s75, s85, 524288
    v_mfma_f32_16x16x32_bf16 a[56:59], a[32:35], a[176:179], 0
    ds_read_b64_tr_b16 a[54:55], v20 offset:30720
    v_mfma_f32_16x16x32_bf16 a[56:59], a[36:39], a[184:187], a[56:59]
    buffer_load_dwordx4 a[128:131], v13, s[20:23], s75 offen sc1
    v_mfma_f32_16x16x32_bf16 a[60:63], a[32:35], a[180:183], 0
    ds_read_b64_tr_b16 a[0:1], v21 offset:20480
    v_mfma_f32_16x16x32_bf16 a[60:63], a[36:39], a[188:191], a[60:63]
    s_waitcnt lgkmcnt(5)
    v_mfma_f32_16x16x32_bf16 v[136:139], a[40:43], a[160:163], 0
    ds_read_b64_tr_b16 a[2:3], v21 offset:22528
    v_mfma_f32_16x16x32_bf16 v[136:139], a[44:47], a[168:171], v[136:139]
    buffer_load_dwordx4 a[132:135], v13, s[20:23], s75 offen offset:1024 sc1
    v_mfma_f32_16x16x32_bf16 v[140:143], a[40:43], a[164:167], 0
    ds_read_b64_tr_b16 a[4:5], v21 offset:28672
    v_mfma_f32_16x16x32_bf16 v[140:143], a[44:47], a[172:175], v[140:143]
    v_mfma_f32_16x16x32_bf16 a[64:67], a[40:43], a[176:179], 0
    ds_read_b64_tr_b16 a[6:7], v21 offset:30720
    v_lshrrev_b32 v217, 1, v218
    v_mfma_f32_16x16x32_bf16 a[64:67], a[44:47], a[184:187], a[64:67]
    buffer_load_dwordx4 a[136:139], v13, s[20:23], s75 offen offset:2048 sc1
    v_mfma_f32_16x16x32_bf16 a[68:71], a[40:43], a[180:183], 0
    ds_read_b64_tr_b16 a[8:9], v18 offset:32768
    v_mfma_f32_16x16x32_bf16 a[68:71], a[44:47], a[188:191], a[68:71]
    s_waitcnt lgkmcnt(5)
    v_mfma_f32_16x16x32_bf16 v[144:147], a[48:51], a[160:163], 0
    ds_read_b64_tr_b16 a[10:11], v18 offset:34816
    v_mfma_f32_16x16x32_bf16 v[144:147], a[52:55], a[168:171], v[144:147]
    buffer_load_dwordx4 a[140:143], v13, s[20:23], s75 offen offset:3072 sc1
    v_mfma_f32_16x16x32_bf16 v[148:151], a[48:51], a[164:167], 0
    ds_read_b64_tr_b16 a[12:13], v18 offset:40960
    v_pk_mul_f32 v[212:213], v[212:213], v[28:29] neg_lo:[1,0] neg_hi:[1,0]
    v_pk_mul_f32 v[214:215], v[214:215], v[28:29] neg_lo:[1,0] neg_hi:[1,0]
    v_pk_fma_f32 v[192:193], v[176:177], v[28:29], v[212:213] op_sel:[0,0,0] op_sel_hi:[1,0,0]
    v_pk_fma_f32 v[194:195], v[178:179], v[28:29], v[212:213] op_sel:[0,0,0] op_sel_hi:[1,0,0]
    v_pk_fma_f32 v[196:197], v[180:181], v[28:29], v[212:213] op_sel:[0,0,0] op_sel_hi:[1,0,0]
    v_pk_fma_f32 v[198:199], v[182:183], v[28:29], v[212:213] op_sel:[0,0,0] op_sel_hi:[1,0,0]
    v_pk_fma_f32 v[200:201], v[184:185], v[28:29], v[212:213] op_sel:[0,1,1] op_sel_hi:[1,1,1]
    v_pk_fma_f32 v[202:203], v[186:187], v[28:29], v[212:213] op_sel:[0,1,1] op_sel_hi:[1,1,1]
    v_pk_fma_f32 v[204:205], v[188:189], v[28:29], v[212:213] op_sel:[0,1,1] op_sel_hi:[1,1,1]
    v_pk_fma_f32 v[206:207], v[190:191], v[28:29], v[212:213] op_sel:[0,1,1] op_sel_hi:[1,1,1]
    v_pk_fma_f32 v[176:177], v[176:177], v[28:29], v[214:215] op_sel:[0,0,0] op_sel_hi:[1,0,0] neg_lo:[1,0,0] neg_hi:[1,0,0]
    v_pk_fma_f32 v[178:179], v[178:179], v[28:29], v[214:215] op_sel:[0,0,0] op_sel_hi:[1,0,0] neg_lo:[1,0,0] neg_hi:[1,0,0]
    v_pk_fma_f32 v[180:181], v[180:181], v[28:29], v[214:215] op_sel:[0,0,0] op_sel_hi:[1,0,0] neg_lo:[1,0,0] neg_hi:[1,0,0]
    v_pk_fma_f32 v[182:183], v[182:183], v[28:29], v[214:215] op_sel:[0,0,0] op_sel_hi:[1,0,0] neg_lo:[1,0,0] neg_hi:[1,0,0]
L_pad1_10:
    s_cbranch_execz L_pad1_14
    v_pk_fma_f32 v[184:185], v[184:185], v[28:29], v[214:215] op_sel:[0,1,1] op_sel_hi:[1,1,1] neg_lo:[1,0,0] neg_hi:[1,0,0]
    v_pk_fma_f32 v[186:187], v[186:187], v[28:29], v[214:215] op_sel:[0,1,1] op_sel_hi:[1,1,1] neg_lo:[1,0,0] neg_hi:[1,0,0]
    v_pk_fma_f32 v[188:189], v[188:189], v[28:29], v[214:215] op_sel:[0,1,1] op_sel_hi:[1,1,1] neg_lo:[1,0,0] neg_hi:[1,0,0]
    v_pk_fma_f32 v[190:191], v[190:191], v[28:29], v[214:215] op_sel:[0,1,1] op_sel_hi:[1,1,1] neg_lo:[1,0,0] neg_hi:[1,0,0]
    v_exp_f32 v192, v192
    v_exp_f32 v193, v193
    v_exp_f32 v194, v194
    v_exp_f32 v195, v195
    v_exp_f32 v196, v196
    v_exp_f32 v197, v197
    v_exp_f32 v198, v198
    v_exp_f32 v199, v199
    v_exp_f32 v200, v200
    v_exp_f32 v201, v201
    v_exp_f32 v202, v202
    v_exp_f32 v203, v203
    v_mfma_f32_16x16x32_bf16 v[148:151], a[52:55], a[172:175], v[148:151]
    s_add_u32 s75, s56, 786432
    v_mfma_f32_16x16x32_bf16 a[72:75], a[48:51], a[176:179], 0
    ds_read_b64_tr_b16 a[14:15], v18 offset:43008
    v_mfma_f32_16x16x32_bf16 a[72:75], a[52:55], a[184:187], a[72:75]
    buffer_load_dwordx4 a[240:243], v13, s[20:23], s75 offen sc1
    v_mfma_f32_16x16x32_bf16 a[76:79], a[48:51], a[180:183], 0
    ds_read_b64_tr_b16 a[16:17], v19 offset:32768
    v_mfma_f32_16x16x32_bf16 a[76:79], a[52:55], a[188:191], a[76:79]
    s_waitcnt lgkmcnt(5)
    v_mfma_f32_16x16x32_bf16 v[152:155], a[0:3], a[160:163], 0
    ds_read_b64_tr_b16 a[18:19], v19 offset:34816
    v_mfma_f32_16x16x32_bf16 v[152:155], a[4:7], a[168:171], v[152:155]
    buffer_load_dwordx4 a[244:247], v13, s[20:23], s75 offen offset:1024 sc1
    v_mfma_f32_16x16x32_bf16 v[156:159], a[0:3], a[164:167], 0
    ds_read_b64_tr_b16 a[20:21], v19 offset:40960
    v_mfma_f32_16x16x32_bf16 v[156:159], a[4:7], a[172:175], v[156:159]
    v_lshrrev_b32 v216, 5, v218
    v_mfma_f32_16x16x32_bf16 a[80:83], a[0:3], a[176:179], 0
    ds_read_b64_tr_b16 a[22:23], v19 offset:43008
    v_mfma_f32_16x16x32_bf16 a[80:83], a[4:7], a[184:187], a[80:83]
    v_mfma_f32_16x16x32_bf16 a[84:87], a[0:3], a[180:183], 0
    ds_read_b64_tr_b16 a[24:25], v20 offset:32768
    v_mfma_f32_16x16x32_bf16 a[84:87], a[4:7], a[188:191], a[84:87]
    s_waitcnt vmcnt(10) lgkmcnt(5)
    v_mfma_f32_16x16x32_bf16 v[96:99], a[8:11], a[192:195], v[96:99]
    ds_read_b64_tr_b16 a[26:27], v20 offset:34816
    v_mfma_f32_16x16x32_bf16 v[96:99], a[12:15], a[200:203], v[96:99]
    buffer_load_dwordx4 a[248:251], v13, s[20:23], s75 offen offset:2048 sc1
    v_mfma_f32_16x16x32_bf16 v[100:103], a[8:11], a[196:199], v[100:103]
    ds_read_b64_tr_b16 a[28:29], v20 offset:40960
    v_mfma_f32_16x16x32_bf16 v[100:103], a[12:15], a[204:207], v[100:103]
    buffer_load_dwordx4 a[252:255], v13, s[20:23], s75 offen offset:3072 sc1
    v_mfma_f32_16x16x32_bf16 a[88:91], a[8:11], a[208:211], a[88:91]
    ds_read_b64_tr_b16 a[30:31], v20 offset:43008
    v_mfma_f32_16x16x32_bf16 a[88:91], a[12:15], a[216:219], a[88:91]
    s_add_u32 s75, s85, 786432
    v_mfma_f32_16x16x32_bf16 a[92:95], a[8:11], a[212:215], a[92:95]
    ds_read_b64_tr_b16 a[32:33], v21 offset:32768
    v_mfma_f32_16x16x32_bf16 a[92:95], a[12:15], a[220:223], a[92:95]
    s_waitcnt lgkmcnt(5)
    v_mfma_f32_16x16x32_bf16 v[104:107], a[16:19], a[192:195], v[104:107]
    ds_read_b64_tr_b16 a[34:35], v21 offset:34816
    v_mfma_f32_16x16x32_bf16 v[104:107], a[20:23], a[200:203], v[104:107]
    buffer_load_dwordx4 a[144:147], v13, s[20:23], s75 offen sc1
    v_mfma_f32_16x16x32_bf16 v[108:111], a[16:19], a[196:199], v[108:111]
    ds_read_b64_tr_b16 a[36:37], v21 offset:40960
    v_add_u32 v216, s68, v216
    v_mfma_f32_16x16x32_bf16 v[108:111], a[20:23], a[204:207], v[108:111]
    buffer_load_dwordx4 a[148:151], v13, s[20:23], s75 offen offset:1024 sc1
    v_mfma_f32_16x16x32_bf16 a[96:99], a[16:19], a[208:211], a[96:99]
    ds_read_b64_tr_b16 a[38:39], v21 offset:43008
    v_mfma_f32_16x16x32_bf16 a[96:99], a[20:23], a[216:219], a[96:99]
    v_mfma_f32_16x16x32_bf16 a[100:103], a[16:19], a[212:215], a[100:103]
    ds_read_b64_tr_b16 a[40:41], v18 offset:36864
    v_mfma_f32_16x16x32_bf16 a[100:103], a[20:23], a[220:223], a[100:103]
    s_waitcnt lgkmcnt(5)
    v_mfma_f32_16x16x32_bf16 v[112:115], a[24:27], a[192:195], v[112:115]
    ds_read_b64_tr_b16 a[42:43], v18 offset:38912
    v_mfma_f32_16x16x32_bf16 v[112:115], a[28:31], a[200:203], v[112:115]
    buffer_load_dwordx4 a[152:155], v13, s[20:23], s75 offen offset:2048 sc1
    v_mfma_f32_16x16x32_bf16 v[116:119], a[24:27], a[196:199], v[116:119]
    ds_read_b64_tr_b16 a[44:45], v18 offset:45056
    v_mfma_f32_16x16x32_bf16 v[116:119], a[28:31], a[204:207], v[116:119]
    v_mfma_f32_16x16x32_bf16 a[104:107], a[24:27], a[208:211], a[104:107]
    ds_read_b64_tr_b16 a[46:47], v18 offset:47104
    v_mfma_f32_16x16x32_bf16 a[104:107], a[28:31], a[216:219], a[104:107]
    buffer_load_dwordx4 a[156:159], v13, s[20:23], s75 offen offset:3072 sc1
    v_mfma_f32_16x16x32_bf16 a[108:111], a[24:27], a[212:215], a[108:111]
    ds_read_b64_tr_b16 a[48:49], v19 offset:36864
    v_exp_f32 v204, v204
    v_exp_f32 v205, v205
    v_exp_f32 v206, v206
    v_exp_f32 v207, v207
    v_exp_f32 v176, v176
    v_exp_f32 v177, v177
    v_exp_f32 v178, v178
    v_exp_f32 v179, v179
    v_exp_f32 v180, v180
    v_exp_f32 v181, v181
    v_exp_f32 v182, v182
    v_exp_f32 v183, v183
    v_exp_f32 v184, v184
    v_exp_f32 v185, v185
    v_exp_f32 v186, v186
    v_exp_f32 v187, v187
    v_exp_f32 v188, v188
    v_exp_f32 v189, v189
    v_exp_f32 v190, v190
    v_exp_f32 v191, v191
    v_mfma_f32_16x16x32_bf16 a[108:111], a[28:31], a[220:223], a[108:111]
    s_waitcnt lgkmcnt(5)
    v_mfma_f32_16x16x32_bf16 v[120:123], a[32:35], a[192:195], v[120:123]
    ds_read_b64_tr_b16 a[50:51], v19 offset:38912
    v_bfe_u32 v218, v218, 4, 1
    v_mfma_f32_16x16x32_bf16 v[120:123], a[36:39], a[200:203], v[120:123]
    s_add_u32 m0, s59, 65536
    v_mfma_f32_16x16x32_bf16 v[124:127], a[32:35], a[196:199], v[124:127]
    ds_read_b64_tr_b16 a[52:53], v19 offset:45056
    v_xor_b32 v0, 131072, v14
    v_mfma_f32_16x16x32_bf16 v[124:127], a[36:39], a[204:207], v[124:127]
    s_add_u32 s74, s53, 1048576
    v_mfma_f32_16x16x32_bf16 a[112:115], a[32:35], a[208:211], a[112:115]
    ds_read_b64_tr_b16 a[54:55], v19 offset:47104
    v_mfma_f32_16x16x32_bf16 a[112:115], a[36:39], a[216:219], a[112:115]
    buffer_load_dwordx4 v9, s[24:27], s74 offen lds
    v_mfma_f32_16x16x32_bf16 a[116:119], a[32:35], a[212:215], a[116:119]
    ds_read_b64_tr_b16 a[0:1], v20 offset:36864
    v_mfma_f32_16x16x32_bf16 a[116:119], a[36:39], a[220:223], a[116:119]
    s_waitcnt lgkmcnt(5)
    v_mfma_f32_16x16x32_bf16 v[128:131], a[40:43], a[192:195], v[128:131]
    ds_read_b64_tr_b16 a[2:3], v20 offset:38912
    v_mfma_f32_16x16x32_bf16 v[128:131], a[44:47], a[200:203], v[128:131]
    buffer_load_dwordx4 v10, s[24:27], s74 offen offset:1024 lds
    v_mfma_f32_16x16x32_bf16 v[132:135], a[40:43], a[196:199], v[132:135]
    ds_read_b64_tr_b16 a[4:5], v20 offset:45056
    v_mfma_f32_16x16x32_bf16 v[132:135], a[44:47], a[204:207], v[132:135]
    buffer_load_dwordx4 v11, s[24:27], s74 offen offset:2048 lds
    v_mfma_f32_16x16x32_bf16 a[56:59], a[40:43], a[208:211], a[56:59]
    ds_read_b64_tr_b16 a[6:7], v20 offset:47104
    v_xor_b32 v1, 131104, v14
    v_mfma_f32_16x16x32_bf16 a[56:59], a[44:47], a[216:219], a[56:59]
    buffer_load_dwordx4 v12, s[24:27], s74 offen offset:3072 lds
    v_mfma_f32_16x16x32_bf16 a[60:63], a[40:43], a[212:215], a[60:63]
    ds_read_b64_tr_b16 a[8:9], v21 offset:36864
    v_mfma_f32_16x16x32_bf16 a[60:63], a[44:47], a[220:223], a[60:63]
    s_waitcnt lgkmcnt(5)
    v_lshlrev_b32 v218, 10, v218
    v_mfma_f32_16x16x32_bf16 v[136:139], a[48:51], a[192:195], v[136:139]
    ds_read_b64_tr_b16 a[10:11], v21 offset:38912
    v_mfma_f32_16x16x32_bf16 v[136:139], a[52:55], a[200:203], v[136:139]
    s_add_u32 m0, s59, 147456
    v_mfma_f32_16x16x32_bf16 v[140:143], a[48:51], a[196:199], v[140:143]
    ds_read_b64_tr_b16 a[12:13], v21 offset:45056
    buffer_load_dword v24, v22, s[20:23], s76 offen sc1
    v_mfma_f32_16x16x32_bf16 v[140:143], a[52:55], a[204:207], v[140:143]
    s_add_u32 s74, s53, 1179648
    v_mfma_f32_16x16x32_bf16 a[64:67], a[48:51], a[208:211], a[64:67]
    ds_read_b64_tr_b16 a[14:15], v21 offset:47104
    v_mfma_f32_16x16x32_bf16 a[64:67], a[52:55], a[216:219], a[64:67]
    buffer_load_dwordx4 v9, s[24:27], s74 offen lds
    s_barrier
    v_mfma_f32_16x16x32_bf16 a[68:71], a[48:51], a[212:215], a[68:71]
    ds_read_b64_tr_b16 a[16:17], v18 offset:49152
    v_xor_b32 v8, 131136, v14
    v_mfma_f32_16x16x32_bf16 a[68:71], a[52:55], a[220:223], a[68:71]
    s_waitcnt lgkmcnt(5)
    v_mfma_f32_16x16x32_bf16 v[144:147], a[0:3], a[192:195], v[144:147]
    ds_read_b64_tr_b16 a[18:19], v18 offset:51200
    v_mfma_f32_16x16x32_bf16 v[144:147], a[4:7], a[200:203], v[144:147]
    buffer_load_dwordx4 v10, s[24:27], s74 offen offset:1024 lds
    v_mfma_f32_16x16x32_bf16 v[148:151], a[0:3], a[196:199], v[148:151]
    ds_read_b64_tr_b16 a[20:21], v18 offset:57344
    v_mfma_f32_16x16x32_bf16 v[148:151], a[4:7], a[204:207], v[148:151]
    buffer_load_dwordx4 v11, s[24:27], s74 offen offset:2048 lds
    v_mfma_f32_16x16x32_bf16 a[72:75], a[0:3], a[208:211], a[72:75]
    ds_read_b64_tr_b16 a[22:23], v18 offset:59392
    v_mfma_f32_16x16x32_bf16 a[72:75], a[4:7], a[216:219], a[72:75]
    v_mfma_f32_16x16x32_bf16 a[76:79], a[0:3], a[212:215], a[76:79]
    ds_read_b64_tr_b16 a[24:25], v19 offset:49152
    v_lshl_add_u32 v218, v216, 4, v218
    v_mfma_f32_16x16x32_bf16 a[76:79], a[4:7], a[220:223], a[76:79]
    s_waitcnt lgkmcnt(5)
    v_mfma_f32_16x16x32_bf16 v[152:155], a[8:11], a[192:195], v[152:155]
    ds_read_b64_tr_b16 a[26:27], v19 offset:51200
    buffer_load_dword v25, v23, s[20:23], s77 offen sc1
    v_mfma_f32_16x16x32_bf16 v[152:155], a[12:15], a[200:203], v[152:155]
    buffer_load_dwordx4 v12, s[24:27], s74 offen offset:3072 lds
    v_xor_b32 v31, 131168, v14
    v_mfma_f32_16x16x32_bf16 v[156:159], a[8:11], a[196:199], v[156:159]
    ds_read_b64_tr_b16 a[28:29], v19 offset:57344
    v_pk_add_f32 v[208:209], v[192:193], v[194:195]
    v_pk_add_f32 v[210:211], v[200:201], v[202:203]
    v_pk_add_f32 v[212:213], v[176:177], v[178:179]
    v_pk_add_f32 v[214:215], v[184:185], v[186:187]
    v_pk_add_f32 v[208:209], v[208:209], v[196:197]
    v_pk_add_f32 v[210:211], v[210:211], v[204:205]
    v_pk_add_f32 v[212:213], v[212:213], v[180:181]
    v_pk_add_f32 v[214:215], v[214:215], v[188:189]
    v_pk_add_f32 v[208:209], v[208:209], v[198:199]
    v_pk_add_f32 v[210:211], v[210:211], v[206:207]
    v_pk_add_f32 v[212:213], v[212:213], v[182:183]
    v_pk_add_f32 v[214:215], v[214:215], v[190:191]
    v_add_f32 v208, v208, v209
    v_add_f32 v209, v210, v211
    v_add_f32 v210, v212, v213
    v_add_f32 v211, v214, v215
    v_permlane32_swap_b32 v208, v209
    s_nop 0
    v_permlane32_swap_b32 v210, v211
    v_add_f32 v208, v208, v209
    v_add_f32 v210, v210, v211
    s_nop 1
    v_permlane16_swap_b32 v208, v210
    v_add_f32 v208, v208, v210
    v_rcp_f32 v208, v208
    s_nop 0
    v_mov_b32 v210, v208
    s_nop 1
    v_permlane16_swap_b32 v208, v210
    v_mov_b32 v209, v208
    v_mov_b32 v211, v210
    s_nop 0
    v_permlane32_swap_b32 v208, v209
    v_permlane32_swap_b32 v210, v211
    v_mfma_f32_16x16x32_bf16 v[156:159], a[12:15], a[204:207], v[156:159]
    s_add_u32 m0, s59, 81920
    v_mfma_f32_16x16x32_bf16 a[80:83], a[8:11], a[208:211], a[80:83]
    ds_read_b64_tr_b16 a[30:31], v19 offset:59392
    v_mfma_f32_16x16x32_bf16 a[80:83], a[12:15], a[216:219], a[80:83]
    s_add_u32 s74, s53, 1310720
    v_mfma_f32_16x16x32_bf16 a[84:87], a[8:11], a[212:215], a[84:87]
    ds_read_b64_tr_b16 a[32:33], v20 offset:49152
    v_mfma_f32_16x16x32_bf16 a[84:87], a[12:15], a[220:223], a[84:87]
    s_waitcnt vmcnt(18) lgkmcnt(5)
    v_mfma_f32_16x16x32_bf16 v[96:99], a[16:19], a[224:227], v[96:99]
    ds_read_b64_tr_b16 a[34:35], v20 offset:51200
    v_mfma_f32_16x16x32_bf16 v[96:99], a[20:23], a[232:235], v[96:99]
    buffer_load_dwordx4 v9, s[24:27], s74 offen lds
    v_mfma_f32_16x16x32_bf16 v[100:103], a[16:19], a[228:231], v[100:103]
    ds_read_b64_tr_b16 a[36:37], v20 offset:57344
    v_xor_b32 v15, 32, v14
    v_mfma_f32_16x16x32_bf16 v[100:103], a[20:23], a[236:239], v[100:103]
    buffer_load_dwordx4 v10, s[24:27], s74 offen offset:1024 lds
    v_mfma_f32_16x16x32_bf16 a[88:91], a[16:19], a[128:131], a[88:91]
    ds_read_b64_tr_b16 a[38:39], v20 offset:59392
    v_lshrrev_b32 v216, 6, v216
    v_mfma_f32_16x16x32_bf16 a[88:91], a[20:23], a[136:139], a[88:91]
    buffer_load_dwordx4 v11, s[24:27], s74 offen offset:2048 lds
    v_mfma_f32_16x16x32_bf16 a[92:95], a[16:19], a[132:135], a[92:95]
    ds_read_b64_tr_b16 a[40:41], v21 offset:49152
    v_mfma_f32_16x16x32_bf16 a[92:95], a[20:23], a[140:143], a[92:95]
    s_waitcnt lgkmcnt(5)
    v_mfma_f32_16x16x32_bf16 v[104:107], a[24:27], a[224:227], v[104:107]
    ds_read_b64_tr_b16 a[42:43], v21 offset:51200
    v_mfma_f32_16x16x32_bf16 v[104:107], a[28:31], a[232:235], v[104:107]
    buffer_load_dwordx4 v12, s[24:27], s74 offen offset:3072 lds
    v_mfma_f32_16x16x32_bf16 v[108:111], a[24:27], a[228:231], v[108:111]
    ds_read_b64_tr_b16 a[44:45], v21 offset:57344
    v_mfma_f32_16x16x32_bf16 v[108:111], a[28:31], a[236:239], v[108:111]
    v_mfma_f32_16x16x32_bf16 a[96:99], a[24:27], a[128:131], a[96:99]
    ds_read_b64_tr_b16 a[46:47], v21 offset:59392
    v_xor_b32 v16, 64, v14
    v_mfma_f32_16x16x32_bf16 a[96:99], a[28:31], a[136:139], a[96:99]
    v_mfma_f32_16x16x32_bf16 a[100:103], a[24:27], a[132:135], a[100:103]
    ds_read_b64_tr_b16 a[48:49], v18 offset:53248
    v_mfma_f32_16x16x32_bf16 a[100:103], a[28:31], a[140:143], a[100:103]
    s_waitcnt lgkmcnt(5)
    v_mfma_f32_16x16x32_bf16 v[112:115], a[32:35], a[224:227], v[112:115]
    ds_read_b64_tr_b16 a[50:51], v18 offset:55296
    v_mfma_f32_16x16x32_bf16 v[112:115], a[36:39], a[232:235], v[112:115]
    v_mfma_f32_16x16x32_bf16 v[116:119], a[32:35], a[228:231], v[116:119]
    ds_read_b64_tr_b16 a[52:53], v18 offset:61440
    v_mfma_f32_16x16x32_bf16 v[116:119], a[36:39], a[236:239], v[116:119]
    v_lshl_add_u32 v216, v216, 10, v218
    v_mfma_f32_16x16x32_bf16 a[104:107], a[32:35], a[128:131], a[104:107]
    ds_read_b64_tr_b16 a[54:55], v18 offset:63488
    v_mfma_f32_16x16x32_bf16 a[104:107], a[36:39], a[136:139], a[104:107]
    s_add_u32 s75, s56, 1048576
    v_mfma_f32_16x16x32_bf16 a[108:111], a[32:35], a[132:135], a[108:111]
    ds_read_b64_tr_b16 a[0:1], v19 offset:53248
    s_waitcnt vmcnt(9)
    v_cmp_le_u32 vcc, 2, v24
    s_nop 0
    s_cmp_eq_u64 vcc, -1
    s_cbranch_scc0 L_phb2b_spin
L_phb2b_ok:
    v_mfma_f32_16x16x32_bf16 a[108:111], a[36:39], a[140:143], a[108:111]
    s_waitcnt lgkmcnt(5)
    v_xor_b32 v17, 96, v14
    v_mfma_f32_16x16x32_bf16 v[120:123], a[40:43], a[224:227], v[120:123]
    ds_read_b64_tr_b16 a[2:3], v19 offset:55296
    v_mfma_f32_16x16x32_bf16 v[120:123], a[44:47], a[232:235], v[120:123]
    buffer_load_dwordx4 a[160:163], v13, s[20:23], s75 offen sc1
    v_mfma_f32_16x16x32_bf16 v[124:127], a[40:43], a[228:231], v[124:127]
    ds_read_b64_tr_b16 a[4:5], v19 offset:61440
    v_mfma_f32_16x16x32_bf16 v[124:127], a[44:47], a[236:239], v[124:127]
    buffer_load_dwordx4 a[164:167], v13, s[20:23], s75 offen offset:1024 sc1
    v_mfma_f32_16x16x32_bf16 a[112:115], a[40:43], a[128:131], a[112:115]
    ds_read_b64_tr_b16 a[6:7], v19 offset:63488
    v_mfma_f32_16x16x32_bf16 a[112:115], a[44:47], a[136:139], a[112:115]
    v_mfma_f32_16x16x32_bf16 a[116:119], a[40:43], a[132:135], a[116:119]
    ds_read_b64_tr_b16 a[8:9], v20 offset:53248
    v_pk_mul_f32 v[192:193], v[192:193], v[208:209] op_sel:[0,0] op_sel_hi:[1,0]
    v_pk_mul_f32 v[194:195], v[194:195], v[208:209] op_sel:[0,0] op_sel_hi:[1,0]
    v_pk_mul_f32 v[196:197], v[196:197], v[208:209] op_sel:[0,0] op_sel_hi:[1,0]
    v_pk_mul_f32 v[198:199], v[198:199], v[208:209] op_sel:[0,0] op_sel_hi:[1,0]
    v_pk_mul_f32 v[200:201], v[200:201], v[208:209] op_sel:[0,1] op_sel_hi:[1,1]
    v_pk_mul_f32 v[202:203], v[202:203], v[208:209] op_sel:[0,1] op_sel_hi:[1,1]
    v_pk_mul_f32 v[204:205], v[204:205], v[208:209] op_sel:[0,1] op_sel_hi:[1,1]
    v_pk_mul_f32 v[206:207], v[206:207], v[208:209] op_sel:[0,1] op_sel_hi:[1,1]
    v_pk_mul_f32 v[176:177], v[176:177], v[210:211] op_sel:[0,0] op_sel_hi:[1,0]
    v_pk_mul_f32 v[178:179], v[178:179], v[210:211] op_sel:[0,0] op_sel_hi:[1,0]
    v_pk_mul_f32 v[180:181], v[180:181], v[210:211] op_sel:[0,0] op_sel_hi:[1,0]
    v_pk_mul_f32 v[182:183], v[182:183], v[210:211] op_sel:[0,0] op_sel_hi:[1,0]
    v_pk_mul_f32 v[184:185], v[184:185], v[210:211] op_sel:[0,1] op_sel_hi:[1,1]
    v_pk_mul_f32 v[186:187], v[186:187], v[210:211] op_sel:[0,1] op_sel_hi:[1,1]
    v_pk_mul_f32 v[188:189], v[188:189], v[210:211] op_sel:[0,1] op_sel_hi:[1,1]
    v_pk_mul_f32 v[190:191], v[190:191], v[210:211] op_sel:[0,1] op_sel_hi:[1,1]
    v_cvt_pk_bf16_f32 v80, v192, v193
    v_cvt_pk_bf16_f32 v81, v194, v195
    v_cvt_pk_bf16_f32 v82, v196, v197
    v_cvt_pk_bf16_f32 v83, v198, v199
    v_cvt_pk_bf16_f32 v88, v200, v201
    v_cvt_pk_bf16_f32 v89, v202, v203
    v_cvt_pk_bf16_f32 v90, v204, v205
    v_cvt_pk_bf16_f32 v91, v206, v207
    v_cvt_pk_bf16_f32 v84, v176, v177
    v_cvt_pk_bf16_f32 v85, v178, v179
    v_cvt_pk_bf16_f32 v86, v180, v181
    v_cvt_pk_bf16_f32 v87, v182, v183
    v_cvt_pk_bf16_f32 v92, v184, v185
    v_cvt_pk_bf16_f32 v93, v186, v187
    v_cvt_pk_bf16_f32 v94, v188, v189
    v_cvt_pk_bf16_f32 v95, v190, v191
    v_mfma_f32_16x16x32_bf16 a[116:119], a[44:47], a[140:143], a[116:119]
    s_waitcnt lgkmcnt(5)
    v_mfma_f32_16x16x32_bf16 v[128:131], a[48:51], a[224:227], v[128:131]
    ds_read_b64_tr_b16 a[10:11], v20 offset:55296
    v_mfma_f32_16x16x32_bf16 v[128:131], a[52:55], a[232:235], v[128:131]
    buffer_load_dwordx4 a[168:171], v13, s[20:23], s75 offen offset:2048 sc1
    v_mfma_f32_16x16x32_bf16 v[132:135], a[48:51], a[228:231], v[132:135]
    ds_read_b64_tr_b16 a[12:13], v20 offset:61440
    v_mfma_f32_16x16x32_bf16 v[132:135], a[52:55], a[236:239], v[132:135]
    v_mfma_f32_16x16x32_bf16 a[56:59], a[48:51], a[128:131], a[56:59]
    ds_read_b64_tr_b16 a[14:15], v20 offset:63488
    s_waitcnt vmcnt(8)
    v_cmp_le_u32 vcc, 1, v25
    s_nop 0
    s_cmp_eq_u64 vcc, -1
    s_cbranch_scc0 L_prb_spin
L_prb_ok:
    v_mfma_f32_16x16x32_bf16 a[56:59], a[52:55], a[136:139], a[56:59]
    buffer_load_dwordx4 a[172:175], v13, s[20:23], s75 offen offset:3072 sc1
    v_mfma_f32_16x16x32_bf16 a[60:63], a[48:51], a[132:135], a[60:63]
    ds_read_b64_tr_b16 a[16:17], v21 offset:53248
    v_mfma_f32_16x16x32_bf16 a[60:63], a[52:55], a[140:143], a[60:63]
    s_waitcnt lgkmcnt(5)
    s_add_u32 s77, s77, 4096
    v_mfma_f32_16x16x32_bf16 v[136:139], a[0:3], a[224:227], v[136:139]
    ds_read_b64_tr_b16 a[18:19], v21 offset:55296
    v_mfma_f32_16x16x32_bf16 v[136:139], a[4:7], a[232:235], v[136:139]
    buffer_load_dwordx4 v[160:163], v216, s[20:23], s66 offen sc1
    v_mfma_f32_16x16x32_bf16 v[140:143], a[0:3], a[228:231], v[140:143]
    ds_read_b64_tr_b16 a[20:21], v21 offset:61440
    v_mfma_f32_16x16x32_bf16 v[140:143], a[4:7], a[236:239], v[140:143]
    s_add_u32 s66, s66, 20480
    v_mfma_f32_16x16x32_bf16 a[64:67], a[0:3], a[128:131], a[64:67]
    ds_read_b64_tr_b16 a[22:23], v21 offset:63488
    v_mfma_f32_16x16x32_bf16 a[64:67], a[4:7], a[136:139], a[64:67]
    buffer_load_dwordx4 v[164:167], v216, s[20:23], s66 offen sc1
    v_mfma_f32_16x16x32_bf16 a[68:71], a[0:3], a[132:135], a[68:71]
    ds_read_b64_tr_b16 a[24:25], v0
    v_mfma_f32_16x16x32_bf16 a[68:71], a[4:7], a[140:143], a[68:71]
    s_waitcnt lgkmcnt(5)
    v_mfma_f32_16x16x32_bf16 v[144:147], a[8:11], a[224:227], v[144:147]
    ds_read_b64_tr_b16 a[26:27], v0 offset:2048
    v_mfma_f32_16x16x32_bf16 v[144:147], a[12:15], a[232:235], v[144:147]
    s_add_u32 s66, s66, 20480
    v_mfma_f32_16x16x32_bf16 v[148:151], a[8:11], a[228:231], v[148:151]
    ds_read_b64_tr_b16 a[28:29], v0 offset:8192
    v_mfma_f32_16x16x32_bf16 v[148:151], a[12:15], a[236:239], v[148:151]
    buffer_load_dwordx4 v[168:171], v216, s[20:23], s66 offen sc1
    v_mfma_f32_16x16x32_bf16 a[72:75], a[8:11], a[128:131], a[72:75]
    ds_read_b64_tr_b16 a[30:31], v0 offset:10240
    s_lshl2_add_u32 s70, s58, s44
    v_mfma_f32_16x16x32_bf16 a[72:75], a[12:15], a[136:139], a[72:75]
    s_add_u32 s66, s66, 20480
    v_mfma_f32_16x16x32_bf16 a[76:79], a[8:11], a[132:135], a[76:79]
    ds_read_b64_tr_b16 a[32:33], v1
    v_mfma_f32_16x16x32_bf16 a[76:79], a[12:15], a[140:143], a[76:79]
    s_waitcnt lgkmcnt(5)
    s_mul_i32 s70, s70, 8192
    v_mfma_f32_16x16x32_bf16 v[152:155], a[16:19], a[224:227], v[152:155]
    ds_read_b64_tr_b16 a[34:35], v1 offset:2048
    v_mfma_f32_16x16x32_bf16 v[152:155], a[20:23], a[232:235], v[152:155]
    buffer_load_dwordx4 v[172:175], v216, s[20:23], s66 offen sc1
    v_mfma_f32_16x16x32_bf16 v[156:159], a[16:19], a[228:231], v[156:159]
    ds_read_b64_tr_b16 a[36:37], v1 offset:8192
    v_mfma_f32_16x16x32_bf16 v[156:159], a[20:23], a[236:239], v[156:159]
    s_add_u32 s66, s66, 20480
    s_mul_i32 s71, s47, 262144
    v_mfma_f32_16x16x32_bf16 a[80:83], a[16:19], a[128:131], a[80:83]
    ds_read_b64_tr_b16 a[38:39], v1 offset:10240
    v_mfma_f32_16x16x32_bf16 a[80:83], a[20:23], a[136:139], a[80:83]
    buffer_load_dwordx4 v[176:179], v216, s[20:23], s66 offen sc1
    v_mfma_f32_16x16x32_bf16 a[84:87], a[16:19], a[132:135], a[84:87]
    ds_read_b64_tr_b16 a[40:41], v8
    s_mov_b32 s73, 32768
    v_permlane16_swap_b32 v228, v230
    v_permlane16_swap_b32 v229, v231
    v_lshlrev_b32 v224, 16, v228
    v_and_b32 v225, 0xffff0000, v228
    v_lshlrev_b32 v226, 16, v229
    v_and_b32 v227, 0xffff0000, v229
    v_lshlrev_b32 v228, 16, v230
    v_and_b32 v229, 0xffff0000, v230
    v_lshlrev_b32 v230, 16, v231
    v_and_b32 v231, 0xffff0000, v231
    v_permlane16_swap_b32 v236, v238
    v_permlane16_swap_b32 v237, v239
    v_lshlrev_b32 v232, 16, v236
    v_and_b32 v233, 0xffff0000, v236
    v_lshlrev_b32 v234, 16, v237
    v_and_b32 v235, 0xffff0000, v237
    v_lshlrev_b32 v236, 16, v238
    v_and_b32 v237, 0xffff0000, v238
    v_lshlrev_b32 v238, 16, v239
    v_and_b32 v239, 0xffff0000, v239
    v_permlane16_swap_b32 v244, v246
    v_permlane16_swap_b32 v245, v247
    v_lshlrev_b32 v240, 16, v244
    v_and_b32 v241, 0xffff0000, v244
    v_lshlrev_b32 v242, 16, v245
    v_and_b32 v243, 0xffff0000, v245
    v_lshlrev_b32 v244, 16, v246
    v_and_b32 v245, 0xffff0000, v246
    v_lshlrev_b32 v246, 16, v247
    v_mfma_f32_16x16x32_bf16 a[84:87], a[20:23], a[140:143], a[84:87]
    s_waitcnt lgkmcnt(5)
    s_add_u32 s70, s70, s71
    v_mfma_f32_16x16x32_bf16 v[96:99], a[24:27], a[240:243], v[96:99]
    ds_read_b64_tr_b16 a[42:43], v8 offset:2048
    v_mfma_f32_16x16x32_bf16 v[96:99], a[28:31], a[248:251], v[96:99]
    s_add_u32 s66, s66, 20480
    v_mfma_f32_16x16x32_bf16 v[100:103], a[24:27], a[244:247], v[100:103]
    ds_read_b64_tr_b16 a[44:45], v8 offset:8192
    v_mfma_f32_16x16x32_bf16 v[100:103], a[28:31], a[252:255], v[100:103]
    buffer_load_dwordx4 v[180:183], v216, s[20:23], s66 offen sc1
    s_xor_b32 s71, s60, 0
    v_mfma_f32_16x16x32_bf16 a[88:91], a[24:27], a[144:147], a[88:91]
    ds_read_b64_tr_b16 a[46:47], v8 offset:10240
    v_mfma_f32_16x16x32_bf16 a[88:91], a[28:31], a[152:155], a[88:91]
    s_add_u32 s66, s66, 20480
    v_mfma_f32_16x16x32_bf16 a[92:95], a[24:27], a[148:151], a[92:95]
    ds_read_b64_tr_b16 a[48:49], v31
    v_mfma_f32_16x16x32_bf16 a[92:95], a[28:31], a[156:159], a[92:95]
    s_waitcnt lgkmcnt(5)
    s_mul_i32 s71, s71, 3670016
    v_mfma_f32_16x16x32_bf16 v[104:107], a[32:35], a[240:243], v[104:107]
    ds_read_b64_tr_b16 a[50:51], v31 offset:2048
    v_bfe_u32 v27, v13, 4, 4
    v_mfma_f32_16x16x32_bf16 v[104:107], a[36:39], a[248:251], v[104:107]
    buffer_load_dwordx4 v[184:187], v216, s[20:23], s66 offen sc1
    v_mfma_f32_16x16x32_bf16 v[108:111], a[32:35], a[244:247], v[108:111]
    ds_read_b64_tr_b16 a[52:53], v31 offset:8192
    v_mfma_f32_16x16x32_bf16 v[108:111], a[36:39], a[252:255], v[108:111]
    s_add_u32 s66, s66, 20480
    s_add_u32 s62, s70, s71
    v_mfma_f32_16x16x32_bf16 a[96:99], a[32:35], a[144:147], a[96:99]
    ds_read_b64_tr_b16 a[54:55], v31 offset:10240
    v_mfma_f32_16x16x32_bf16 a[96:99], a[36:39], a[152:155], a[96:99]
    buffer_load_dwordx4 v[188:191], v216, s[20:23], s66 offen sc1
    v_mfma_f32_16x16x32_bf16 a[100:103], a[32:35], a[148:151], a[100:103]
    ds_read_b64_tr_b16 a[0:1], v0 offset:4096
    s_xor_b32 s71, s60, 3
    v_mfma_f32_16x16x32_bf16 a[100:103], a[36:39], a[156:159], a[100:103]
    s_waitcnt lgkmcnt(5)
    v_mfma_f32_16x16x32_bf16 v[112:115], a[40:43], a[240:243], v[112:115]
    ds_read_b64_tr_b16 a[2:3], v0 offset:6144
    v_mfma_f32_16x16x32_bf16 v[112:115], a[44:47], a[248:251], v[112:115]
    s_add_u32 s75, s85, 1048576
    v_mfma_f32_16x16x32_bf16 v[116:119], a[40:43], a[244:247], v[116:119]
    ds_read_b64_tr_b16 a[4:5], v0 offset:12288
    s_mul_i32 s71, s71, 3670016
    v_mfma_f32_16x16x32_bf16 v[116:119], a[44:47], a[252:255], v[116:119]
    buffer_load_dwordx4 a[176:179], v13, s[20:23], s75 offen sc1
    v_mfma_f32_16x16x32_bf16 a[104:107], a[40:43], a[144:147], a[104:107]
    ds_read_b64_tr_b16 a[6:7], v0 offset:14336
    v_mfma_f32_16x16x32_bf16 a[104:107], a[44:47], a[152:155], a[104:107]
    buffer_load_dwordx4 a[180:183], v13, s[20:23], s75 offen offset:1024 sc1
    v_mfma_f32_16x16x32_bf16 a[108:111], a[40:43], a[148:151], a[108:111]
    ds_read_b64_tr_b16 a[8:9], v1 offset:4096
    s_add_u32 s63, s70, s71
    v_mfma_f32_16x16x32_bf16 a[108:111], a[44:47], a[156:159], a[108:111]
    s_waitcnt lgkmcnt(5)
    v_mfma_f32_16x16x32_bf16 v[120:123], a[48:51], a[240:243], v[120:123]
    ds_read_b64_tr_b16 a[10:11], v1 offset:6144
    v_lshl_add_u32 v27, v27, 11, s54
    v_mfma_f32_16x16x32_bf16 v[120:123], a[52:55], a[248:251], v[120:123]
    buffer_load_dwordx4 a[184:187], v13, s[20:23], s75 offen offset:2048 sc1
    v_mfma_f32_16x16x32_bf16 v[124:127], a[48:51], a[244:247], v[124:127]
    ds_read_b64_tr_b16 a[12:13], v1 offset:12288
    s_xor_b32 s71, s60, 2
    v_mfma_f32_16x16x32_bf16 v[124:127], a[52:55], a[252:255], v[124:127]
    buffer_load_dwordx4 a[188:191], v13, s[20:23], s75 offen offset:3072 sc1
    v_mfma_f32_16x16x32_bf16 a[112:115], a[48:51], a[144:147], a[112:115]
    ds_read_b64_tr_b16 a[14:15], v1 offset:14336
    v_mfma_f32_16x16x32_bf16 a[112:115], a[52:55], a[152:155], a[112:115]
    s_add_u32 s75, s56, 1310720
    v_mfma_f32_16x16x32_bf16 a[116:119], a[48:51], a[148:151], a[116:119]
    ds_read_b64_tr_b16 a[16:17], v8 offset:4096
    s_mul_i32 s71, s71, 3670016
    v_mfma_f32_16x16x32_bf16 a[116:119], a[52:55], a[156:159], a[116:119]
    s_waitcnt lgkmcnt(5)
    v_mfma_f32_16x16x32_bf16 v[128:131], a[0:3], a[240:243], v[128:131]
    ds_read_b64_tr_b16 a[18:19], v8 offset:6144
    v_mfma_f32_16x16x32_bf16 v[128:131], a[4:7], a[248:251], v[128:131]
    buffer_load_dwordx4 a[192:195], v13, s[20:23], s75 offen sc1
    v_mfma_f32_16x16x32_bf16 v[132:135], a[0:3], a[244:247], v[132:135]
    ds_read_b64_tr_b16 a[20:21], v8 offset:12288
    s_add_u32 s64, s70, s71
    v_mfma_f32_16x16x32_bf16 v[132:135], a[4:7], a[252:255], v[132:135]
    buffer_load_dwordx4 a[196:199], v13, s[20:23], s75 offen offset:1024 sc1
    v_mfma_f32_16x16x32_bf16 a[56:59], a[0:3], a[144:147], a[56:59]
    ds_read_b64_tr_b16 a[22:23], v8 offset:14336
    v_mfma_f32_16x16x32_bf16 a[56:59], a[4:7], a[152:155], a[56:59]
    v_mfma_f32_16x16x32_bf16 a[60:63], a[0:3], a[148:151], a[60:63]
    ds_read_b64_tr_b16 a[24:25], v31 offset:4096
    v_and_b32 v247, 0xffff0000, v247
    v_permlane16_swap_b32 v252, v254
    v_permlane16_swap_b32 v253, v255
    v_lshlrev_b32 v248, 16, v252
    v_and_b32 v249, 0xffff0000, v252
    v_lshlrev_b32 v250, 16, v253
    v_and_b32 v251, 0xffff0000, v253
    v_lshlrev_b32 v252, 16, v254
    v_and_b32 v253, 0xffff0000, v254
    v_lshlrev_b32 v254, 16, v255
    v_and_b32 v255, 0xffff0000, v255
    v_bfe_u32 v2, v13, 5, 3
    v_lshrrev_b32 v3, 8, v13
    v_lshlrev_b32 v3, 1, v3
    v_sub_u32 v2, v2, v3
    v_and_b32 v3, 16, v13
    v_mov_b32 v6, 0x3f80
    v_lshlrev_b32 v6, v3, v6
    v_cmp_eq_u32 vcc, 0, v2
    s_nop 1
    v_cndmask_b32 v4, 0, v6, vcc
    v_cmp_eq_u32 vcc, 1, v2
    s_nop 1
    v_cndmask_b32 v5, 0, v6, vcc
    v_mov_b32 v2, 0
    v_mov_b32 v3, 0
    v_mov_b32 v6, 0
    v_mov_b32 v7, 0
    s_lshl2_add_u32 s72, s2, s44
    s_lshl_b32 s72, s72, 12
    s_add_u32 s72, s72, 50331648
    v_mfma_f32_16x16x32_bf16 a[60:63], a[4:7], a[156:159], a[60:63]
    s_waitcnt lgkmcnt(5)
    v_mfma_f32_16x16x32_bf16 v[136:139], a[8:11], a[240:243], v[136:139]
    ds_read_b64_tr_b16 a[26:27], v31 offset:6144
    v_mfma_f32_16x16x32_bf16 v[136:139], a[12:15], a[248:251], v[136:139]
    buffer_load_dwordx4 a[200:203], v13, s[20:23], s75 offen offset:2048 sc1
    v_bfe_u32 v24, v13, 8, 1
    v_mfma_f32_16x16x32_bf16 v[140:143], a[8:11], a[244:247], v[140:143]
    ds_read_b64_tr_b16 a[28:29], v31 offset:12288
    v_mfma_f32_16x16x32_bf16 v[140:143], a[12:15], a[252:255], v[140:143]
    buffer_load_dwordx4 a[204:207], v13, s[20:23], s75 offen offset:3072 sc1
    v_mfma_f32_16x16x32_bf16 a[64:67], a[8:11], a[144:147], a[64:67]
    ds_read_b64_tr_b16 a[30:31], v31 offset:14336
    v_mfma_f32_16x16x32_bf16 a[64:67], a[12:15], a[152:155], a[64:67]
    s_add_u32 s75, s85, 1310720
    s_barrier
    v_mfma_f32_16x16x32_bf16 a[68:71], a[8:11], a[148:151], a[68:71]
    ds_read_b64_tr_b16 a[32:33], v14
    v_mfma_f32_16x16x32_bf16 a[68:71], a[12:15], a[156:159], a[68:71]
    s_waitcnt lgkmcnt(5)
    v_mfma_f32_16x16x32_bf16 v[144:147], a[16:19], a[240:243], v[144:147]
    ds_read_b64_tr_b16 a[34:35], v14 offset:2048
    v_mfma_f32_16x16x32_bf16 v[144:147], a[20:23], a[248:251], v[144:147]
    buffer_load_dwordx4 a[208:211], v13, s[20:23], s75 offen sc1
    v_mfma_f32_16x16x32_bf16 v[148:151], a[16:19], a[244:247], v[148:151]
    ds_read_b64_tr_b16 a[36:37], v14 offset:8192
    s_waitcnt vmcnt(15)
    v_add_f32 v160, v160, v164
    v_add_f32 v161, v161, v165
    v_add_f32 v162, v162, v166
    v_add_f32 v163, v163, v167
    s_waitcnt vmcnt(14)
    v_add_f32 v160, v160, v168
    v_add_f32 v161, v161, v169
L_pad1_11:
    s_cbranch_execz L_pad1_15
    v_add_f32 v162, v162, v170
    v_add_f32 v163, v163, v171
    s_waitcnt vmcnt(13)
    v_add_f32 v160, v160, v172
    v_add_f32 v161, v161, v173
    v_add_f32 v162, v162, v174
    v_add_f32 v163, v163, v175
    s_waitcnt vmcnt(12)
    v_add_f32 v160, v160, v176
    v_add_f32 v161, v161, v177
    v_add_f32 v162, v162, v178
    v_add_f32 v163, v163, v179
    s_waitcnt vmcnt(11)
    v_add_f32 v160, v160, v180
    v_add_f32 v161, v161, v181
    v_add_f32 v162, v162, v182
    v_add_f32 v163, v163, v183
    s_waitcnt vmcnt(10)
    v_add_f32 v160, v160, v184
    v_add_f32 v161, v161, v185
    v_add_f32 v162, v162, v186
    v_add_f32 v163, v163, v187
    s_waitcnt vmcnt(9)
    v_add_f32 v160, v160, v188
    v_add_f32 v161, v161, v189
    v_add_f32 v162, v162, v190
    v_add_f32 v163, v163, v191
    v_cvt_pk_bf16_f32 v160, v160, v161
    v_cvt_pk_bf16_f32 v161, v162, v163
    buffer_store_dwordx2 v[160:161], v217, s[20:23], s67 offen sc1
    v_mfma_f32_16x16x32_bf16 v[148:151], a[20:23], a[252:255], v[148:151]
    buffer_load_dwordx4 a[212:215], v13, s[20:23], s75 offen offset:1024 sc1
    v_mfma_f32_16x16x32_bf16 a[72:75], a[16:19], a[144:147], a[72:75]
    ds_read_b64_tr_b16 a[38:39], v14 offset:10240
    v_mfma_f32_16x16x32_bf16 a[72:75], a[20:23], a[152:155], a[72:75]
    v_mfma_f32_16x16x32_bf16 a[76:79], a[16:19], a[148:151], a[76:79]
    ds_read_b64_tr_b16 a[40:41], v15
    v_mfma_f32_16x16x32_bf16 a[76:79], a[20:23], a[156:159], a[76:79]
    s_waitcnt lgkmcnt(5)
    v_mfma_f32_16x16x32_bf16 v[152:155], a[24:27], a[240:243], v[152:155]
    ds_read_b64_tr_b16 a[42:43], v15 offset:2048
    v_mfma_f32_16x16x32_bf16 v[152:155], a[28:31], a[248:251], v[152:155]
    buffer_load_dwordx4 a[216:219], v13, s[20:23], s75 offen offset:2048 sc1
    v_mfma_f32_16x16x32_bf16 v[156:159], a[24:27], a[244:247], v[156:159]
    ds_read_b64_tr_b16 a[44:45], v15 offset:8192
    v_lshl_add_u32 v27, v24, 5, v27
    v_mfma_f32_16x16x32_bf16 v[156:159], a[28:31], a[252:255], v[156:159]
    v_mfma_f32_16x16x32_bf16 a[80:83], a[24:27], a[144:147], a[80:83]
    ds_read_b64_tr_b16 a[46:47], v15 offset:10240
    v_mfma_f32_16x16x32_bf16 a[80:83], a[28:31], a[152:155], a[80:83]
    buffer_load_dwordx4 a[220:223], v13, s[20:23], s75 offen offset:3072 sc1
    v_mfma_f32_16x16x32_bf16 a[84:87], a[24:27], a[148:151], a[84:87]
    ds_read_b64_tr_b16 a[48:49], v16
    v_mfma_f32_16x16x32_bf16 a[84:87], a[28:31], a[156:159], a[84:87]
    s_waitcnt vmcnt(9) lgkmcnt(5)
    v_mfma_f32_16x16x32_bf16 v[96:99], a[32:35], a[160:163], v[96:99]
    ds_read_b64_tr_b16 a[50:51], v16 offset:2048
    v_mfma_f32_16x16x32_bf16 v[96:99], a[36:39], a[168:171], v[96:99]
    s_add_u32 s75, s56, 1572864
    v_mfma_f32_16x16x32_bf16 v[100:103], a[32:35], a[164:167], v[100:103]
    ds_read_b64_tr_b16 a[52:53], v16 offset:8192
    v_mfma_f32_16x16x32_bf16 v[100:103], a[36:39], a[172:175], v[100:103]
    buffer_load_dwordx4 a[224:227], v13, s[20:23], s75 offen sc1
    v_mfma_f32_16x16x32_bf16 a[88:91], a[32:35], a[176:179], a[88:91]
    ds_read_b64_tr_b16 a[54:55], v16 offset:10240
    v_mfma_f32_16x16x32_bf16 a[88:91], a[36:39], a[184:187], a[88:91]
    buffer_load_dwordx4 a[228:231], v13, s[20:23], s75 offen offset:1024 sc1
    v_mfma_f32_16x16x32_bf16 a[92:95], a[32:35], a[180:183], a[92:95]
    ds_read_b64_tr_b16 a[0:1], v17
    v_mfma_f32_16x16x32_bf16 a[92:95], a[36:39], a[188:191], a[92:95]
    s_waitcnt lgkmcnt(5)
    v_mfma_f32_16x16x32_bf16 v[104:107], a[40:43], a[160:163], v[104:107]
    ds_read_b64_tr_b16 a[2:3], v17 offset:2048
    v_mfma_f32_16x16x32_bf16 v[104:107], a[44:47], a[168:171], v[104:107]
    buffer_load_dwordx4 a[232:235], v13, s[20:23], s75 offen offset:2048 sc1
    v_mfma_f32_16x16x32_bf16 v[108:111], a[40:43], a[164:167], v[108:111]
    ds_read_b64_tr_b16 a[4:5], v17 offset:8192
    v_lshrrev_b32 v24, 9, v13
    v_mfma_f32_16x16x32_bf16 v[108:111], a[44:47], a[172:175], v[108:111]
    v_mfma_f32_16x16x32_bf16 a[96:99], a[40:43], a[176:179], a[96:99]
    ds_read_b64_tr_b16 a[6:7], v17 offset:10240
    v_mfma_f32_16x16x32_bf16 a[96:99], a[44:47], a[184:187], a[96:99]
    v_mfma_f32_16x16x32_bf16 a[100:103], a[40:43], a[180:183], a[100:103]
    ds_read_b64_tr_b16 a[8:9], v14 offset:4096
    v_mfma_f32_16x16x32_bf16 a[100:103], a[44:47], a[188:191], a[100:103]
    s_waitcnt lgkmcnt(5)
    v_mfma_f32_16x16x32_bf16 v[112:115], a[48:51], a[160:163], v[112:115]
    ds_read_b64_tr_b16 a[10:11], v14 offset:6144
    v_mfma_f32_16x16x32_bf16 v[112:115], a[52:55], a[168:171], v[112:115]
    buffer_load_dwordx4 a[236:239], v13, s[20:23], s75 offen offset:3072 sc1
    v_mfma_f32_16x16x32_bf16 v[116:119], a[48:51], a[164:167], v[116:119]
    ds_read_b64_tr_b16 a[12:13], v14 offset:12288
    v_mfma_f32_16x16x32_bf16 v[116:119], a[52:55], a[172:175], v[116:119]
    s_add_u32 s75, s85, 1572864
    v_mfma_f32_16x16x32_bf16 a[104:107], a[48:51], a[176:179], a[104:107]
    ds_read_b64_tr_b16 a[14:15], v14 offset:14336
    v_mfma_f32_16x16x32_bf16 a[104:107], a[52:55], a[184:187], a[104:107]
    buffer_load_dwordx4 a[128:131], v13, s[20:23], s75 offen sc1
    v_mfma_f32_16x16x32_bf16 a[108:111], a[48:51], a[180:183], a[108:111]
    ds_read_b64_tr_b16 a[16:17], v15 offset:4096
    v_mfma_f32_16x16x32_bf16 a[108:111], a[52:55], a[188:191], a[108:111]
    s_waitcnt lgkmcnt(5)
    v_mfma_f32_16x16x32_bf16 v[120:123], a[0:3], a[160:163], v[120:123]
    ds_read_b64_tr_b16 a[18:19], v15 offset:6144
    v_mfma_f32_16x16x32_bf16 v[120:123], a[4:7], a[168:171], v[120:123]
    buffer_load_dwordx4 a[132:135], v13, s[20:23], s75 offen offset:1024 sc1
    v_mfma_f32_16x16x32_bf16 v[124:127], a[0:3], a[164:167], v[124:127]
    ds_read_b64_tr_b16 a[20:21], v15 offset:12288
    v_mfma_f32_16x16x32_bf16 v[124:127], a[4:7], a[172:175], v[124:127]
    buffer_load_dwordx4 a[136:139], v13, s[20:23], s75 offen offset:2048 sc1
    v_lshl_add_u32 v27, v24, 4, v27
    v_mfma_f32_16x16x32_bf16 a[112:115], a[0:3], a[176:179], a[112:115]
    ds_read_b64_tr_b16 a[22:23], v15 offset:14336
    v_mfma_f32_16x16x32_bf16 a[112:115], a[4:7], a[184:187], a[112:115]
    v_mfma_f32_16x16x32_bf16 a[116:119], a[0:3], a[180:183], a[116:119]
    ds_read_b64_tr_b16 a[24:25], v16 offset:4096
    v_mfma_f32_16x16x32_bf16 a[116:119], a[4:7], a[188:191], a[116:119]
    s_waitcnt lgkmcnt(5)
    v_mfma_f32_16x16x32_bf16 v[128:131], a[8:11], a[160:163], v[128:131]
    ds_read_b64_tr_b16 a[26:27], v16 offset:6144
    v_mfma_f32_16x16x32_bf16 v[128:131], a[12:15], a[168:171], v[128:131]
    buffer_load_dwordx4 a[140:143], v13, s[20:23], s75 offen offset:3072 sc1
    v_mfma_f32_16x16x32_bf16 v[132:135], a[8:11], a[164:167], v[132:135]
    ds_read_b64_tr_b16 a[28:29], v16 offset:12288
    v_mfma_f32_16x16x32_bf16 v[132:135], a[12:15], a[172:175], v[132:135]
    s_add_u32 s75, s56, 1835008
    v_mfma_f32_16x16x32_bf16 a[56:59], a[8:11], a[176:179], a[56:59]
    ds_read_b64_tr_b16 a[30:31], v16 offset:14336
    v_mfma_f32_16x16x32_bf16 a[56:59], a[12:15], a[184:187], a[56:59]
    buffer_load_dwordx4 a[240:243], v13, s[20:23], s75 offen sc1
    v_mfma_f32_16x16x32_bf16 a[60:63], a[8:11], a[180:183], a[60:63]
    ds_read_b64_tr_b16 a[32:33], v17 offset:4096
    v_mfma_f32_16x16x32_bf16 a[60:63], a[12:15], a[188:191], a[60:63]
    s_waitcnt lgkmcnt(5)
    v_mfma_f32_16x16x32_bf16 v[136:139], a[16:19], a[160:163], v[136:139]
    ds_read_b64_tr_b16 a[34:35], v17 offset:6144
    v_mfma_f32_16x16x32_bf16 v[136:139], a[20:23], a[168:171], v[136:139]
    buffer_load_dwordx4 a[244:247], v13, s[20:23], s75 offen offset:1024 sc1
    v_mfma_f32_16x16x32_bf16 v[140:143], a[16:19], a[164:167], v[140:143]
    ds_read_b64_tr_b16 a[36:37], v17 offset:12288
    v_mfma_f32_16x16x32_bf16 v[140:143], a[20:23], a[172:175], v[140:143]
    v_mfma_f32_16x16x32_bf16 a[64:67], a[16:19], a[176:179], a[64:67]
    ds_read_b64_tr_b16 a[38:39], v17 offset:14336
    v_mfma_f32_16x16x32_bf16 a[64:67], a[20:23], a[184:187], a[64:67]
    buffer_load_dwordx4 a[248:251], v13, s[20:23], s75 offen offset:2048 sc1
    v_mfma_f32_16x16x32_bf16 a[68:71], a[16:19], a[180:183], a[68:71]
    ds_read_b64_tr_b16 a[40:41], v14 offset:16384
    v_mfma_f32_16x16x32_bf16 a[68:71], a[20:23], a[188:191], a[68:71]
    s_waitcnt lgkmcnt(5)
    v_mfma_f32_16x16x32_bf16 v[144:147], a[24:27], a[160:163], v[144:147]
    ds_read_b64_tr_b16 a[42:43], v14 offset:18432
    v_mfma_f32_16x16x32_bf16 v[144:147], a[28:31], a[168:171], v[144:147]
    buffer_load_dwordx4 a[252:255], v13, s[20:23], s75 offen offset:3072 sc1
    v_mfma_f32_16x16x32_bf16 v[148:151], a[24:27], a[164:167], v[148:151]
    ds_read_b64_tr_b16 a[44:45], v14 offset:24576
    v_mfma_f32_16x16x32_bf16 v[148:151], a[28:31], a[172:175], v[148:151]
    s_add_u32 s75, s85, 1835008
    v_mfma_f32_16x16x32_bf16 a[72:75], a[24:27], a[176:179], a[72:75]
    ds_read_b64_tr_b16 a[46:47], v14 offset:26624
    v_mfma_f32_16x16x32_bf16 a[72:75], a[28:31], a[184:187], a[72:75]
    buffer_load_dwordx4 a[144:147], v13, s[20:23], s75 offen sc1
    v_mfma_f32_16x16x32_bf16 a[76:79], a[24:27], a[180:183], a[76:79]
    ds_read_b64_tr_b16 a[48:49], v15 offset:16384
    v_mfma_f32_16x16x32_bf16 a[76:79], a[28:31], a[188:191], a[76:79]
    s_waitcnt lgkmcnt(5)
    v_mfma_f32_16x16x32_bf16 v[152:155], a[32:35], a[160:163], v[152:155]
    ds_read_b64_tr_b16 a[50:51], v15 offset:18432
    v_mfma_f32_16x16x32_bf16 v[152:155], a[36:39], a[168:171], v[152:155]
    v_mfma_f32_16x16x32_bf16 v[156:159], a[32:35], a[164:167], v[156:159]
    ds_read_b64_tr_b16 a[52:53], v15 offset:24576
    s_waitcnt vmcnt(16)
    s_barrier
    s_cmp_lg_u32 s44, 0
    s_cbranch_scc1 L_fredb_skip
    v_accvgpr_write_b32 a124, 1
    s_mov_b64 exec, 1
    buffer_store_dword a124, off, s[20:23], s83 sc1
    s_mov_b64 exec, -1
L_fredb_skip:
    v_mfma_f32_16x16x32_bf16 v[156:159], a[36:39], a[172:175], v[156:159]
    buffer_load_dwordx4 a[148:151], v13, s[20:23], s75 offen offset:1024 sc1
    v_mfma_f32_16x16x32_bf16 a[80:83], a[32:35], a[176:179], a[80:83]
    ds_read_b64_tr_b16 a[54:55], v15 offset:26624
    v_mfma_f32_16x16x32_bf16 a[80:83], a[36:39], a[184:187], a[80:83]
    v_mfma_f32_16x16x32_bf16 a[84:87], a[32:35], a[180:183], a[84:87]
    ds_read_b64_tr_b16 a[0:1], v16 offset:16384
    v_mfma_f32_16x16x32_bf16 a[84:87], a[36:39], a[188:191], a[84:87]
    s_waitcnt vmcnt(14) lgkmcnt(5)
    v_mfma_f32_16x16x32_bf16 v[96:99], a[40:43], a[192:195], v[96:99]
    ds_read_b64_tr_b16 a[2:3], v16 offset:18432
    v_mfma_f32_16x16x32_bf16 v[96:99], a[44:47], a[200:203], v[96:99]
    buffer_load_dwordx4 a[152:155], v13, s[20:23], s75 offen offset:2048 sc1
    v_mfma_f32_16x16x32_bf16 v[100:103], a[40:43], a[196:199], v[100:103]
    ds_read_b64_tr_b16 a[4:5], v16 offset:24576
    v_mfma_f32_16x16x32_bf16 v[100:103], a[44:47], a[204:207], v[100:103]
    buffer_load_dwordx4 a[156:159], v13, s[20:23], s75 offen offset:3072 sc1
    v_mfma_f32_16x16x32_bf16 a[88:91], a[40:43], a[208:211], a[88:91]
    ds_read_b64_tr_b16 a[6:7], v16 offset:26624
    v_mfma_f32_16x16x32_bf16 a[88:91], a[44:47], a[216:219], a[88:91]
    s_add_u32 m0, s59, 98304
    v_mfma_f32_16x16x32_bf16 a[92:95], a[40:43], a[212:215], a[92:95]
    ds_read_b64_tr_b16 a[8:9], v17 offset:16384
    v_mfma_f32_16x16x32_bf16 a[92:95], a[44:47], a[220:223], a[92:95]
    s_waitcnt lgkmcnt(5)
    v_mfma_f32_16x16x32_bf16 v[104:107], a[48:51], a[192:195], v[104:107]
    ds_read_b64_tr_b16 a[10:11], v17 offset:18432
    v_mfma_f32_16x16x32_bf16 v[104:107], a[52:55], a[200:203], v[104:107]
    s_add_u32 s74, s53, 1441792
    v_mfma_f32_16x16x32_bf16 v[108:111], a[48:51], a[196:199], v[108:111]
    ds_read_b64_tr_b16 a[12:13], v17 offset:24576
    v_mfma_f32_16x16x32_bf16 v[108:111], a[52:55], a[204:207], v[108:111]
    buffer_load_dwordx4 v9, s[24:27], s74 offen lds
    v_mfma_f32_16x16x32_bf16 a[96:99], a[48:51], a[208:211], a[96:99]
    ds_read_b64_tr_b16 a[14:15], v17 offset:26624
    v_mfma_f32_16x16x32_bf16 a[96:99], a[52:55], a[216:219], a[96:99]
    buffer_load_dwordx4 v10, s[24:27], s74 offen offset:1024 lds
    v_mfma_f32_16x16x32_bf16 a[100:103], a[48:51], a[212:215], a[100:103]
    ds_read_b64_tr_b16 a[16:17], v14 offset:20480
    v_mfma_f32_16x16x32_bf16 a[100:103], a[52:55], a[220:223], a[100:103]
    s_waitcnt lgkmcnt(5)
    s_add_u32 s76, s76, 32
    v_mfma_f32_16x16x32_bf16 v[112:115], a[0:3], a[192:195], v[112:115]
    ds_read_b64_tr_b16 a[18:19], v14 offset:22528
    buffer_load_dword v24, v22, s[20:23], s76 offen sc1
    v_mfma_f32_16x16x32_bf16 v[112:115], a[4:7], a[200:203], v[112:115]
    buffer_load_dwordx4 v11, s[24:27], s74 offen offset:2048 lds
    v_mfma_f32_16x16x32_bf16 v[116:119], a[0:3], a[196:199], v[116:119]
    ds_read_b64_tr_b16 a[20:21], v14 offset:28672
    v_mfma_f32_16x16x32_bf16 v[116:119], a[4:7], a[204:207], v[116:119]
    v_mfma_f32_16x16x32_bf16 a[104:107], a[0:3], a[208:211], a[104:107]
    ds_read_b64_tr_b16 a[22:23], v14 offset:30720
    v_mfma_f32_16x16x32_bf16 a[104:107], a[4:7], a[216:219], a[104:107]
    buffer_load_dwordx4 v12, s[24:27], s74 offen offset:3072 lds
    v_mfma_f32_16x16x32_bf16 a[108:111], a[0:3], a[212:215], a[108:111]
    ds_read_b64_tr_b16 a[24:25], v15 offset:20480
    v_mfma_f32_16x16x32_bf16 a[108:111], a[4:7], a[220:223], a[108:111]
    s_waitcnt lgkmcnt(5)
    v_mfma_f32_16x16x32_bf16 v[120:123], a[8:11], a[192:195], v[120:123]
    ds_read_b64_tr_b16 a[26:27], v15 offset:22528
    v_mfma_f32_16x16x32_bf16 v[120:123], a[12:15], a[200:203], v[120:123]
    s_add_u32 m0, s59, 114688
    v_mfma_f32_16x16x32_bf16 v[124:127], a[8:11], a[196:199], v[124:127]
    ds_read_b64_tr_b16 a[28:29], v15 offset:28672
    v_mfma_f32_16x16x32_bf16 v[124:127], a[12:15], a[204:207], v[124:127]
    s_add_u32 s74, s53, 1572864
    v_mfma_f32_16x16x32_bf16 a[112:115], a[8:11], a[208:211], a[112:115]
    ds_read_b64_tr_b16 a[30:31], v15 offset:30720
    v_mfma_f32_16x16x32_bf16 a[112:115], a[12:15], a[216:219], a[112:115]
    buffer_load_dwordx4 v9, s[24:27], s74 offen lds
    v_mfma_f32_16x16x32_bf16 a[116:119], a[8:11], a[212:215], a[116:119]
    ds_read_b64_tr_b16 a[32:33], v16 offset:20480
    v_mfma_f32_16x16x32_bf16 a[116:119], a[12:15], a[220:223], a[116:119]
    s_waitcnt lgkmcnt(5)
    v_mfma_f32_16x16x32_bf16 v[128:131], a[16:19], a[192:195], v[128:131]
    ds_read_b64_tr_b16 a[34:35], v16 offset:22528
    v_mfma_f32_16x16x32_bf16 v[128:131], a[20:23], a[200:203], v[128:131]
    buffer_load_dwordx4 v10, s[24:27], s74 offen offset:1024 lds
    v_mfma_f32_16x16x32_bf16 v[132:135], a[16:19], a[196:199], v[132:135]
    ds_read_b64_tr_b16 a[36:37], v16 offset:28672
    v_mfma_f32_16x16x32_bf16 v[132:135], a[20:23], a[204:207], v[132:135]
    buffer_load_dwordx4 v11, s[24:27], s74 offen offset:2048 lds
    v_mfma_f32_16x16x32_bf16 a[56:59], a[16:19], a[208:211], a[56:59]
    ds_read_b64_tr_b16 a[38:39], v16 offset:30720
    v_mfma_f32_16x16x32_bf16 a[56:59], a[20:23], a[216:219], a[56:59]
    v_mfma_f32_16x16x32_bf16 a[60:63], a[16:19], a[212:215], a[60:63]
    ds_read_b64_tr_b16 a[40:41], v17 offset:20480
    v_mfma_f32_16x16x32_bf16 a[60:63], a[20:23], a[220:223], a[60:63]
    s_waitcnt lgkmcnt(5)
    v_mfma_f32_16x16x32_bf16 v[136:139], a[24:27], a[192:195], v[136:139]
    ds_read_b64_tr_b16 a[42:43], v17 offset:22528
    v_mfma_f32_16x16x32_bf16 v[136:139], a[28:31], a[200:203], v[136:139]
    buffer_load_dwordx4 v12, s[24:27], s74 offen offset:3072 lds
    v_mfma_f32_16x16x32_bf16 v[140:143], a[24:27], a[196:199], v[140:143]
    ds_read_b64_tr_b16 a[44:45], v17 offset:28672
    v_mfma_f32_16x16x32_bf16 v[140:143], a[28:31], a[204:207], v[140:143]
    v_mfma_f32_16x16x32_bf16 a[64:67], a[24:27], a[208:211], a[64:67]
    ds_read_b64_tr_b16 a[46:47], v17 offset:30720
    v_mfma_f32_16x16x32_bf16 a[64:67], a[28:31], a[216:219], a[64:67]
    s_add_u32 m0, s59, 131072
    s_barrier
    v_mfma_f32_16x16x32_bf16 a[68:71], a[24:27], a[212:215], a[68:71]
    ds_read_b64_tr_b16 a[48:49], v14 offset:32768
    v_mfma_f32_16x16x32_bf16 a[68:71], a[28:31], a[220:223], a[68:71]
    s_waitcnt lgkmcnt(5)
    v_mfma_f32_16x16x32_bf16 v[144:147], a[32:35], a[192:195], v[144:147]
    ds_read_b64_tr_b16 a[50:51], v14 offset:34816
    v_mfma_f32_16x16x32_bf16 v[144:147], a[36:39], a[200:203], v[144:147]
    s_add_u32 s74, s53, 1703936
    v_mfma_f32_16x16x32_bf16 v[148:151], a[32:35], a[196:199], v[148:151]
    ds_read_b64_tr_b16 a[52:53], v14 offset:40960
    v_mfma_f32_16x16x32_bf16 v[148:151], a[36:39], a[204:207], v[148:151]
    buffer_load_dwordx4 v9, s[24:27], s74 offen lds
    v_mfma_f32_16x16x32_bf16 a[72:75], a[32:35], a[208:211], a[72:75]
    ds_read_b64_tr_b16 a[54:55], v14 offset:43008
    v_mfma_f32_16x16x32_bf16 a[72:75], a[36:39], a[216:219], a[72:75]
    buffer_load_dwordx4 v10, s[24:27], s74 offen offset:1024 lds
    v_mfma_f32_16x16x32_bf16 a[76:79], a[32:35], a[212:215], a[76:79]
    ds_read_b64_tr_b16 a[0:1], v15 offset:32768
    v_mfma_f32_16x16x32_bf16 a[76:79], a[36:39], a[220:223], a[76:79]
    s_waitcnt lgkmcnt(5)
    v_mfma_f32_16x16x32_bf16 v[152:155], a[40:43], a[192:195], v[152:155]
    ds_read_b64_tr_b16 a[2:3], v15 offset:34816
    v_mfma_f32_16x16x32_bf16 v[152:155], a[44:47], a[200:203], v[152:155]
    buffer_load_dwordx4 v11, s[24:27], s74 offen offset:2048 lds
    v_mfma_f32_16x16x32_bf16 v[156:159], a[40:43], a[196:199], v[156:159]
    ds_read_b64_tr_b16 a[4:5], v15 offset:40960
    v_mfma_f32_16x16x32_bf16 v[156:159], a[44:47], a[204:207], v[156:159]
    s_add_u32 s75, s56, 2097152
    v_mfma_f32_16x16x32_bf16 a[80:83], a[40:43], a[208:211], a[80:83]
    ds_read_b64_tr_b16 a[6:7], v15 offset:43008
    s_waitcnt vmcnt(9)
    v_cmp_le_u32 vcc, 1, v24
    s_nop 0
    s_cmp_eq_u64 vcc, -1
    s_cbranch_scc0 L_phab_spin
L_phab_ok:
    v_mfma_f32_16x16x32_bf16 a[80:83], a[44:47], a[216:219], a[80:83]
    buffer_load_dwordx4 a[160:163], v13, s[20:23], s75 offen sc1
    v_mfma_f32_16x16x32_bf16 a[84:87], a[40:43], a[212:215], a[84:87]
    ds_read_b64_tr_b16 a[8:9], v16 offset:32768
    v_mfma_f32_16x16x32_bf16 a[84:87], a[44:47], a[220:223], a[84:87]
    s_waitcnt lgkmcnt(5)
    v_mfma_f32_16x16x32_bf16 v[96:99], a[48:51], a[224:227], v[96:99]
    ds_read_b64_tr_b16 a[10:11], v16 offset:34816
    v_mfma_f32_16x16x32_bf16 v[96:99], a[52:55], a[232:235], v[96:99]
    v_mfma_f32_16x16x32_bf16 v[100:103], a[48:51], a[228:231], v[100:103]
    ds_read_b64_tr_b16 a[12:13], v16 offset:40960
    v_mfma_f32_16x16x32_bf16 v[100:103], a[52:55], a[236:239], v[100:103]
    buffer_load_dwordx4 a[164:167], v13, s[20:23], s75 offen offset:1024 sc1
    v_mfma_f32_16x16x32_bf16 a[88:91], a[48:51], a[128:131], a[88:91]
    ds_read_b64_tr_b16 a[14:15], v16 offset:43008
    v_mfma_f32_16x16x32_bf16 a[88:91], a[52:55], a[136:139], a[88:91]
    v_mfma_f32_16x16x32_bf16 a[92:95], a[48:51], a[132:135], a[92:95]
    ds_read_b64_tr_b16 a[16:17], v17 offset:32768
    buffer_load_dword v25, v23, s[20:23], s77 offen sc1
    v_mfma_f32_16x16x32_bf16 a[92:95], a[52:55], a[140:143], a[92:95]
    s_waitcnt lgkmcnt(5)
    v_mfma_f32_16x16x32_bf16 v[104:107], a[0:3], a[224:227], v[104:107]
    ds_read_b64_tr_b16 a[18:19], v17 offset:34816
    v_mfma_f32_16x16x32_bf16 v[104:107], a[4:7], a[232:235], v[104:107]
    buffer_load_dwordx4 a[168:171], v13, s[20:23], s75 offen offset:2048 sc1
    v_mfma_f32_16x16x32_bf16 v[108:111], a[0:3], a[228:231], v[108:111]
    ds_read_b64_tr_b16 a[20:21], v17 offset:40960
    v_mfma_f32_16x16x32_bf16 v[108:111], a[4:7], a[236:239], v[108:111]
    buffer_load_dwordx4 a[172:175], v13, s[20:23], s75 offen offset:3072 sc1
    v_mfma_f32_16x16x32_bf16 a[96:99], a[0:3], a[128:131], a[96:99]
    ds_read_b64_tr_b16 a[22:23], v17 offset:43008
    v_mfma_f32_16x16x32_bf16 a[96:99], a[4:7], a[136:139], a[96:99]
    s_add_u32 s75, s85, 2097152
    v_mfma_f32_16x16x32_bf16 a[100:103], a[0:3], a[132:135], a[100:103]
    ds_read_b64_tr_b16 a[24:25], v14 offset:36864
    v_mfma_f32_16x16x32_bf16 a[100:103], a[4:7], a[140:143], a[100:103]
    s_waitcnt lgkmcnt(5)
    v_mfma_f32_16x16x32_bf16 v[112:115], a[8:11], a[224:227], v[112:115]
    ds_read_b64_tr_b16 a[26:27], v14 offset:38912
    v_mfma_f32_16x16x32_bf16 v[112:115], a[12:15], a[232:235], v[112:115]
    buffer_load_dwordx4 a[176:179], v13, s[20:23], s75 offen sc1
    v_mfma_f32_16x16x32_bf16 v[116:119], a[8:11], a[228:231], v[116:119]
    ds_read_b64_tr_b16 a[28:29], v14 offset:45056
    v_mfma_f32_16x16x32_bf16 v[116:119], a[12:15], a[236:239], v[116:119]
    buffer_load_dwordx4 a[180:183], v13, s[20:23], s75 offen offset:1024 sc1
    v_mfma_f32_16x16x32_bf16 a[104:107], a[8:11], a[128:131], a[104:107]
    ds_read_b64_tr_b16 a[30:31], v14 offset:47104
    v_mfma_f32_16x16x32_bf16 a[104:107], a[12:15], a[136:139], a[104:107]
    v_mfma_f32_16x16x32_bf16 a[108:111], a[8:11], a[132:135], a[108:111]
    ds_read_b64_tr_b16 a[32:33], v15 offset:36864
    v_mfma_f32_16x16x32_bf16 a[108:111], a[12:15], a[140:143], a[108:111]
    s_waitcnt lgkmcnt(5)
    v_mfma_f32_16x16x32_bf16 v[120:123], a[16:19], a[224:227], v[120:123]
    ds_read_b64_tr_b16 a[34:35], v15 offset:38912
    v_mfma_f32_16x16x32_bf16 v[120:123], a[20:23], a[232:235], v[120:123]
    buffer_load_dwordx4 a[184:187], v13, s[20:23], s75 offen offset:2048 sc1
    v_mfma_f32_16x16x32_bf16 v[124:127], a[16:19], a[228:231], v[124:127]
    ds_read_b64_tr_b16 a[36:37], v15 offset:45056
    v_mfma_f32_16x16x32_bf16 v[124:127], a[20:23], a[236:239], v[124:127]
    v_mfma_f32_16x16x32_bf16 a[112:115], a[16:19], a[128:131], a[112:115]
    ds_read_b64_tr_b16 a[38:39], v15 offset:47104
    v_mfma_f32_16x16x32_bf16 a[112:115], a[20:23], a[136:139], a[112:115]
    buffer_load_dwordx4 a[188:191], v13, s[20:23], s75 offen offset:3072 sc1
    v_mfma_f32_16x16x32_bf16 a[116:119], a[16:19], a[132:135], a[116:119]
    ds_read_b64_tr_b16 a[40:41], v16 offset:36864
    v_mfma_f32_16x16x32_bf16 a[116:119], a[20:23], a[140:143], a[116:119]
    s_waitcnt lgkmcnt(5)
    v_mfma_f32_16x16x32_bf16 v[128:131], a[24:27], a[224:227], v[128:131]
    ds_read_b64_tr_b16 a[42:43], v16 offset:38912
    v_mfma_f32_16x16x32_bf16 v[128:131], a[28:31], a[232:235], v[128:131]
    s_add_u32 s75, s56, 2359296
    v_mfma_f32_16x16x32_bf16 v[132:135], a[24:27], a[228:231], v[132:135]
    ds_read_b64_tr_b16 a[44:45], v16 offset:45056
    v_mfma_f32_16x16x32_bf16 v[132:135], a[28:31], a[236:239], v[132:135]
    buffer_load_dwordx4 a[192:195], v13, s[20:23], s75 offen sc1
    v_mfma_f32_16x16x32_bf16 a[56:59], a[24:27], a[128:131], a[56:59]
    ds_read_b64_tr_b16 a[46:47], v16 offset:47104
    v_mfma_f32_16x16x32_bf16 a[56:59], a[28:31], a[136:139], a[56:59]
    buffer_load_dwordx4 a[196:199], v13, s[20:23], s75 offen offset:1024 sc1
    v_mfma_f32_16x16x32_bf16 a[60:63], a[24:27], a[132:135], a[60:63]
    ds_read_b64_tr_b16 a[48:49], v17 offset:36864
    v_mfma_f32_16x16x32_bf16 a[60:63], a[28:31], a[140:143], a[60:63]
    s_waitcnt lgkmcnt(5)
    v_mfma_f32_16x16x32_bf16 v[136:139], a[32:35], a[224:227], v[136:139]
    ds_read_b64_tr_b16 a[50:51], v17 offset:38912
    v_mfma_f32_16x16x32_bf16 v[136:139], a[36:39], a[232:235], v[136:139]
    buffer_load_dwordx4 a[200:203], v13, s[20:23], s75 offen offset:2048 sc1
    v_mfma_f32_16x16x32_bf16 v[140:143], a[32:35], a[228:231], v[140:143]
    ds_read_b64_tr_b16 a[52:53], v17 offset:45056
    v_mfma_f32_16x16x32_bf16 v[140:143], a[36:39], a[236:239], v[140:143]
    v_mfma_f32_16x16x32_bf16 a[64:67], a[32:35], a[128:131], a[64:67]
    ds_read_b64_tr_b16 a[54:55], v17 offset:47104
    v_mfma_f32_16x16x32_bf16 a[64:67], a[36:39], a[136:139], a[64:67]
    v_mfma_f32_16x16x32_bf16 a[68:71], a[32:35], a[132:135], a[68:71]
    ds_read_b64_tr_b16 a[0:1], v14 offset:49152
    v_mfma_f32_16x16x32_bf16 a[68:71], a[36:39], a[140:143], a[68:71]
    s_waitcnt lgkmcnt(5)
    v_mfma_f32_16x16x32_bf16 v[144:147], a[40:43], a[224:227], v[144:147]
    ds_read_b64_tr_b16 a[2:3], v14 offset:51200
    v_mfma_f32_16x16x32_bf16 v[144:147], a[44:47], a[232:235], v[144:147]
    buffer_load_dwordx4 a[204:207], v13, s[20:23], s75 offen offset:3072 sc1
    v_mfma_f32_16x16x32_bf16 v[148:151], a[40:43], a[228:231], v[148:151]
    ds_read_b64_tr_b16 a[4:5], v14 offset:57344
    s_waitcnt vmcnt(10)
    v_cmp_le_u32 vcc, 1, v25
    s_nop 0
    s_cmp_eq_u64 vcc, -1
    s_cbranch_scc0 L_peb_spin
L_peb_ok:
    v_mfma_f32_16x16x32_bf16 v[148:151], a[44:47], a[236:239], v[148:151]
    s_add_u32 s75, s85, 2359296
    v_mfma_f32_16x16x32_bf16 a[72:75], a[40:43], a[128:131], a[72:75]
    ds_read_b64_tr_b16 a[6:7], v14 offset:59392
    v_mfma_f32_16x16x32_bf16 a[72:75], a[44:47], a[136:139], a[72:75]
    buffer_load_dwordx4 a[208:211], v13, s[20:23], s75 offen sc1
    v_mfma_f32_16x16x32_bf16 a[76:79], a[40:43], a[132:135], a[76:79]
    ds_read_b64_tr_b16 a[8:9], v15 offset:49152
    v_mfma_f32_16x16x32_bf16 a[76:79], a[44:47], a[140:143], a[76:79]
    s_waitcnt lgkmcnt(5)
    v_mfma_f32_16x16x32_bf16 v[152:155], a[48:51], a[224:227], v[152:155]
    ds_read_b64_tr_b16 a[10:11], v15 offset:51200
    v_mfma_f32_16x16x32_bf16 v[152:155], a[52:55], a[232:235], v[152:155]
    buffer_load_dwordx4 v[160:163], v13, s[20:23], s99 offen sc1
    v_mfma_f32_16x16x32_bf16 v[156:159], a[48:51], a[228:231], v[156:159]
    ds_read_b64_tr_b16 a[12:13], v15 offset:57344
    v_mfma_f32_16x16x32_bf16 v[156:159], a[52:55], a[236:239], v[156:159]
    buffer_load_dwordx4 v[164:167], v13, s[20:23], s99 offen offset:1024 sc1
    v_mfma_f32_16x16x32_bf16 a[80:83], a[48:51], a[128:131], a[80:83]
    ds_read_b64_tr_b16 a[14:15], v15 offset:59392
    v_mfma_f32_16x16x32_bf16 a[80:83], a[52:55], a[136:139], a[80:83]
    v_mfma_f32_16x16x32_bf16 a[84:87], a[48:51], a[132:135], a[84:87]
    ds_read_b64_tr_b16 a[16:17], v16 offset:49152
    v_mfma_f32_16x16x32_bf16 a[84:87], a[52:55], a[140:143], a[84:87]
    s_waitcnt lgkmcnt(5)
    v_mfma_f32_16x16x32_bf16 v[96:99], a[0:3], a[240:243], v[96:99]
    ds_read_b64_tr_b16 a[18:19], v16 offset:51200
    v_mfma_f32_16x16x32_bf16 v[96:99], a[4:7], a[248:251], v[96:99]
    buffer_load_dwordx4 v[168:171], v13, s[20:23], s99 offen offset:2048 sc1
    v_mfma_f32_16x16x32_bf16 v[100:103], a[0:3], a[244:247], v[100:103]
    ds_read_b64_tr_b16 a[20:21], v16 offset:57344
    v_mfma_f32_16x16x32_bf16 v[100:103], a[4:7], a[252:255], v[100:103]
    v_mfma_f32_16x16x32_bf16 a[88:91], a[0:3], a[144:147], a[88:91]
    ds_read_b64_tr_b16 a[22:23], v16 offset:59392
    v_mfma_f32_16x16x32_bf16 a[88:91], a[4:7], a[152:155], a[88:91]
    buffer_load_dwordx4 v[172:175], v13, s[20:23], s99 offen offset:3072 sc1
    v_mfma_f32_16x16x32_bf16 a[92:95], a[0:3], a[148:151], a[92:95]
    ds_read_b64_tr_b16 a[24:25], v17 offset:49152
    v_mfma_f32_16x16x32_bf16 a[92:95], a[4:7], a[156:159], a[92:95]
    s_waitcnt lgkmcnt(5)
    v_mfma_f32_16x16x32_bf16 v[104:107], a[8:11], a[240:243], v[104:107]
    ds_read_b64_tr_b16 a[26:27], v17 offset:51200
    v_mfma_f32_16x16x32_bf16 v[104:107], a[12:15], a[248:251], v[104:107]
    s_add_u32 s99, s99, 4096
    v_mfma_f32_16x16x32_bf16 v[108:111], a[8:11], a[244:247], v[108:111]
    ds_read_b64_tr_b16 a[28:29], v17 offset:57344
    v_mfma_f32_16x16x32_bf16 v[108:111], a[12:15], a[252:255], v[108:111]
    buffer_load_dwordx4 v[176:179], v13, s[20:23], s99 offen sc1
    v_mfma_f32_16x16x32_bf16 a[96:99], a[8:11], a[144:147], a[96:99]
    ds_read_b64_tr_b16 a[30:31], v17 offset:59392
    v_mfma_f32_16x16x32_bf16 a[96:99], a[12:15], a[152:155], a[96:99]
    buffer_load_dwordx4 a[212:215], v13, s[20:23], s75 offen offset:1024 sc1
    v_mfma_f32_16x16x32_bf16 a[100:103], a[8:11], a[148:151], a[100:103]
    ds_read_b64_tr_b16 a[32:33], v14 offset:53248
    v_mfma_f32_16x16x32_bf16 a[100:103], a[12:15], a[156:159], a[100:103]
    s_waitcnt lgkmcnt(5)
    v_mfma_f32_16x16x32_bf16 v[112:115], a[16:19], a[240:243], v[112:115]
    ds_read_b64_tr_b16 a[34:35], v14 offset:55296
    v_mfma_f32_16x16x32_bf16 v[112:115], a[20:23], a[248:251], v[112:115]
    buffer_load_dwordx4 a[216:219], v13, s[20:23], s75 offen offset:2048 sc1
    v_mfma_f32_16x16x32_bf16 v[116:119], a[16:19], a[244:247], v[116:119]
    ds_read_b64_tr_b16 a[36:37], v14 offset:61440
    v_mfma_f32_16x16x32_bf16 v[116:119], a[20:23], a[252:255], v[116:119]
    v_mfma_f32_16x16x32_bf16 a[104:107], a[16:19], a[144:147], a[104:107]
    ds_read_b64_tr_b16 a[38:39], v14 offset:63488
    v_mfma_f32_16x16x32_bf16 a[104:107], a[20:23], a[152:155], a[104:107]
    buffer_load_dwordx4 a[220:223], v13, s[20:23], s75 offen offset:3072 sc1
    v_mfma_f32_16x16x32_bf16 a[108:111], a[16:19], a[148:151], a[108:111]
    ds_read_b64_tr_b16 a[40:41], v15 offset:53248
    v_mfma_f32_16x16x32_bf16 a[108:111], a[20:23], a[156:159], a[108:111]
    s_waitcnt lgkmcnt(5)
    v_mfma_f32_16x16x32_bf16 v[120:123], a[24:27], a[240:243], v[120:123]
    ds_read_b64_tr_b16 a[42:43], v15 offset:55296
    v_mfma_f32_16x16x32_bf16 v[120:123], a[28:31], a[248:251], v[120:123]
    v_mfma_f32_16x16x32_bf16 v[124:127], a[24:27], a[244:247], v[124:127]
    ds_read_b64_tr_b16 a[44:45], v15 offset:61440
    v_mfma_f32_16x16x32_bf16 v[124:127], a[28:31], a[252:255], v[124:127]
    buffer_load_dwordx4 v12, s[24:27], s74 offen offset:3072 lds
    v_mfma_f32_16x16x32_bf16 a[112:115], a[24:27], a[144:147], a[112:115]
    ds_read_b64_tr_b16 a[46:47], v15 offset:63488
    v_mfma_f32_16x16x32_bf16 a[112:115], a[28:31], a[152:155], a[112:115]
    s_add_u32 s75, s85, 2621440
    v_mfma_f32_16x16x32_bf16 a[116:119], a[24:27], a[148:151], a[116:119]
    ds_read_b64_tr_b16 a[48:49], v16 offset:53248
    v_mfma_f32_16x16x32_bf16 a[116:119], a[28:31], a[156:159], a[116:119]
    s_waitcnt lgkmcnt(5)
    v_mfma_f32_16x16x32_bf16 v[128:131], a[32:35], a[240:243], v[128:131]
    ds_read_b64_tr_b16 a[50:51], v16 offset:55296
    v_mfma_f32_16x16x32_bf16 v[128:131], a[36:39], a[248:251], v[128:131]
    buffer_load_dwordx4 a[224:227], v13, s[20:23], s75 offen sc1
    v_mfma_f32_16x16x32_bf16 v[132:135], a[32:35], a[244:247], v[132:135]
    ds_read_b64_tr_b16 a[52:53], v16 offset:61440
    v_mfma_f32_16x16x32_bf16 v[132:135], a[36:39], a[252:255], v[132:135]
    buffer_load_dwordx4 a[228:231], v13, s[20:23], s75 offen offset:1024 sc1
    v_mfma_f32_16x16x32_bf16 a[56:59], a[32:35], a[144:147], a[56:59]
    ds_read_b64_tr_b16 a[54:55], v16 offset:63488
    v_mfma_f32_16x16x32_bf16 a[56:59], a[36:39], a[152:155], a[56:59]
    v_mfma_f32_16x16x32_bf16 a[60:63], a[32:35], a[148:151], a[60:63]
    ds_read_b64_tr_b16 a[0:1], v17 offset:53248
    v_mfma_f32_16x16x32_bf16 a[60:63], a[36:39], a[156:159], a[60:63]
    s_waitcnt lgkmcnt(5)
    v_mfma_f32_16x16x32_bf16 v[136:139], a[40:43], a[240:243], v[136:139]
    ds_read_b64_tr_b16 a[2:3], v17 offset:55296
    v_mfma_f32_16x16x32_bf16 v[136:139], a[44:47], a[248:251], v[136:139]
    buffer_load_dwordx4 a[232:235], v13, s[20:23], s75 offen offset:2048 sc1
    v_mfma_f32_16x16x32_bf16 v[140:143], a[40:43], a[244:247], v[140:143]
    ds_read_b64_tr_b16 a[4:5], v17 offset:61440
    v_mfma_f32_16x16x32_bf16 v[140:143], a[44:47], a[252:255], v[140:143]
    buffer_load_dwordx4 a[236:239], v13, s[20:23], s75 offen offset:3072 sc1
    v_mfma_f32_16x16x32_bf16 a[64:67], a[40:43], a[144:147], a[64:67]
    ds_read_b64_tr_b16 a[6:7], v17 offset:63488
    v_mfma_f32_16x16x32_bf16 a[64:67], a[44:47], a[152:155], a[64:67]
    s_barrier
    s_cmp_lg_u32 s44, 0
    s_cbranch_scc1 L_fdb_skip
    v_accvgpr_write_b32 a124, 1
    s_mov_b64 exec, 1
    buffer_store_dword a124, off, s[20:23], s50 sc1
    s_mov_b64 exec, -1
L_fdb_skip:
    v_mfma_f32_16x16x32_bf16 a[68:71], a[40:43], a[148:151], a[68:71]
    ds_read_b64_tr_b16 a[8:9], v18
    v_mov_b32 v184, 0x358637bd
    v_mfma_f32_16x16x32_bf16 a[68:71], a[44:47], a[156:159], a[68:71]
    s_waitcnt lgkmcnt(5)
    v_mov_b32 v185, 0x358637bd
    v_mfma_f32_16x16x32_bf16 v[144:147], a[48:51], a[240:243], v[144:147]
    ds_read_b64_tr_b16 a[10:11], v18 offset:2048
    s_andn2_b32 s65, s50, 31
    v_mfma_f32_16x16x32_bf16 v[144:147], a[52:55], a[248:251], v[144:147]
    s_add_u32 s75, s85, 2883584
    v_mov_b32 v186, 0x358637bd
    v_mfma_f32_16x16x32_bf16 v[148:151], a[48:51], a[244:247], v[148:151]
L_pad1_12:
    s_cbranch_execz L_pad1_16
    ds_read_b64_tr_b16 a[12:13], v18 offset:8192
    v_mov_b32 v187, 0x358637bd
    v_mfma_f32_16x16x32_bf16 v[148:151], a[52:55], a[252:255], v[148:151]
    buffer_load_dwordx4 a[128:131], v13, s[20:23], s75 offen sc1
    s_waitcnt vmcnt(9)
    v_mov_b32_dpp v180, v176 quad_perm:[2,3,0,1] row_mask:0xf bank_mask:0xf
    v_mov_b32_dpp v181, v177 quad_perm:[2,3,0,1] row_mask:0xf bank_mask:0xf
    v_mfma_f32_16x16x32_bf16 a[72:75], a[48:51], a[144:147], a[72:75]
    ds_read_b64_tr_b16 a[14:15], v18 offset:10240
    v_mov_b32_dpp v182, v178 quad_perm:[2,3,0,1] row_mask:0xf bank_mask:0xf
    v_mfma_f32_16x16x32_bf16 a[72:75], a[52:55], a[152:155], a[72:75]
    buffer_load_dwordx4 a[132:135], v13, s[20:23], s75 offen offset:1024 sc1
    v_mov_b32_dpp v183, v179 quad_perm:[2,3,0,1] row_mask:0xf bank_mask:0xf
    v_mfma_f32_16x16x32_bf16 v[204:207], v[160:163], v[32:35], 0
    v_mfma_f32_16x16x32_bf16 v[204:207], v[168:171], v[36:39], v[204:207]
    v_mfma_f32_16x16x32_bf16 v[220:223], v[176:179], v[32:35], v[184:187]
    v_mfma_f32_16x16x32_bf16 v[220:223], v[180:183], v[36:39], v[220:223]
    v_mfma_f32_16x16x32_bf16 v[208:211], v[164:167], v[32:35], 0
    v_mfma_f32_16x16x32_bf16 v[208:211], v[172:175], v[36:39], v[208:211]
    v_mfma_f32_16x16x32_bf16 v[212:215], v[160:163], v[40:43], 0
    s_nop 4
    v_rcp_f32 v28, v220
    v_mfma_f32_16x16x32_bf16 a[76:79], a[48:51], a[148:151], a[76:79]
    ds_read_b64_tr_b16 a[16:17], v19
    v_mul_f32 v204, v204, v28
    v_mfma_f32_16x16x32_bf16 v[212:215], v[168:171], v[44:47], v[212:215]
    v_mul_f32 v205, v205, v28
    v_mfma_f32_16x16x32_bf16 a[76:79], a[52:55], a[156:159], a[76:79]
    s_waitcnt lgkmcnt(5)
    v_mul_f32 v206, v206, v28
    v_mfma_f32_16x16x32_bf16 v[220:223], v[176:179], v[40:43], v[184:187]
    v_mul_f32 v207, v207, v28
    v_mfma_f32_16x16x32_bf16 v[152:155], a[0:3], a[240:243], v[152:155]
    ds_read_b64_tr_b16 a[18:19], v19 offset:2048
    v_mul_f32 v208, v208, v28
    v_mfma_f32_16x16x32_bf16 v[220:223], v[180:183], v[44:47], v[220:223]
    v_mul_f32 v209, v209, v28
    v_mul_f32 v210, v210, v28
    v_mfma_f32_16x16x32_bf16 v[216:219], v[164:167], v[40:43], 0
    v_mul_f32 v211, v211, v28
    v_cvt_pk_bf16_f32 v32, v204, v205
    v_mfma_f32_16x16x32_bf16 v[216:219], v[172:175], v[44:47], v[216:219]
    v_cvt_pk_bf16_f32 v33, v206, v207
    v_mfma_f32_16x16x32_bf16 v[152:155], a[4:7], a[248:251], v[152:155]
    buffer_load_dwordx4 a[136:139], v13, s[20:23], s75 offen offset:2048 sc1
    v_cvt_pk_bf16_f32 v34, v208, v209
    v_cvt_pk_bf16_f32 v35, v210, v211
    v_mfma_f32_16x16x32_bf16 v[156:159], a[0:3], a[244:247], v[156:159]
    ds_read_b64_tr_b16 a[20:21], v19 offset:8192
    buffer_store_dwordx4 v[32:35], v13, s[20:23], s100 offen sc1
    v_mfma_f32_16x16x32_bf16 v[204:207], v[160:163], v[48:51], 0
    v_rcp_f32 v28, v220
    v_mfma_f32_16x16x32_bf16 v[156:159], a[4:7], a[252:255], v[156:159]
    v_mul_f32 v212, v212, v28
    v_mfma_f32_16x16x32_bf16 v[204:207], v[168:171], v[52:55], v[204:207]
    v_mul_f32 v213, v213, v28
    v_mfma_f32_16x16x32_bf16 a[80:83], a[0:3], a[144:147], a[80:83]
    ds_read_b64_tr_b16 a[22:23], v19 offset:10240
    v_mul_f32 v214, v214, v28
    v_mfma_f32_16x16x32_bf16 v[220:223], v[176:179], v[48:51], v[184:187]
    v_mul_f32 v215, v215, v28
    v_mfma_f32_16x16x32_bf16 a[80:83], a[4:7], a[152:155], a[80:83]
    buffer_load_dwordx4 a[140:143], v13, s[20:23], s75 offen offset:3072 sc1
    v_mul_f32 v216, v216, v28
    v_mfma_f32_16x16x32_bf16 v[220:223], v[180:183], v[52:55], v[220:223]
    v_mul_f32 v217, v217, v28
    v_mul_f32 v218, v218, v28
    v_mfma_f32_16x16x32_bf16 v[208:211], v[164:167], v[48:51], 0
    v_mul_f32 v219, v219, v28
    v_cvt_pk_bf16_f32 v40, v212, v213
    v_mfma_f32_16x16x32_bf16 v[208:211], v[172:175], v[52:55], v[208:211]
    v_cvt_pk_bf16_f32 v41, v214, v215
    v_mfma_f32_16x16x32_bf16 a[84:87], a[0:3], a[148:151], a[84:87]
    ds_read_b64_tr_b16 a[24:25], v20
    v_cvt_pk_bf16_f32 v42, v216, v217
    v_mfma_f32_16x16x32_bf16 a[84:87], a[4:7], a[156:159], a[84:87]
    s_waitcnt lgkmcnt(5)
    v_cvt_pk_bf16_f32 v43, v218, v219
    v_mfma_f32_16x16x32_bf16 v[96:99], a[8:11], a[160:163], v[96:99]
    ds_read_b64_tr_b16 a[26:27], v20 offset:2048
    buffer_store_dwordx4 v[40:43], v13, s[20:23], s100 offen offset:1024 sc1
    v_mfma_f32_16x16x32_bf16 v[96:99], a[12:15], a[168:171], v[96:99]
    s_add_u32 m0, s59, 0
    s_add_u32 s100, s100, 4096
    v_mfma_f32_16x16x32_bf16 v[212:215], v[160:163], v[56:59], 0
    v_rcp_f32 v28, v220
    v_mfma_f32_16x16x32_bf16 v[100:103], a[8:11], a[164:167], v[100:103]
    ds_read_b64_tr_b16 a[28:29], v20 offset:8192
    v_mul_f32 v204, v204, v28
    v_mfma_f32_16x16x32_bf16 v[212:215], v[168:171], v[60:63], v[212:215]
    v_mul_f32 v205, v205, v28
    v_mul_f32 v206, v206, v28
    v_mfma_f32_16x16x32_bf16 v[220:223], v[176:179], v[56:59], v[184:187]
    v_mul_f32 v207, v207, v28
    v_mfma_f32_16x16x32_bf16 v[100:103], a[12:15], a[172:175], v[100:103]
    s_add_u32 s74, s55, 0
    v_mul_f32 v208, v208, v28
    v_mfma_f32_16x16x32_bf16 v[220:223], v[180:183], v[60:63], v[220:223]
    v_mul_f32 v209, v209, v28
    v_mfma_f32_16x16x32_bf16 a[88:91], a[8:11], a[176:179], a[88:91]
    ds_read_b64_tr_b16 a[30:31], v20 offset:10240
    v_mul_f32 v210, v210, v28
    v_mfma_f32_16x16x32_bf16 v[216:219], v[164:167], v[56:59], 0
    v_mul_f32 v211, v211, v28
    v_cvt_pk_bf16_f32 v48, v204, v205
    v_mfma_f32_16x16x32_bf16 v[216:219], v[172:175], v[60:63], v[216:219]
    v_cvt_pk_bf16_f32 v49, v206, v207
    v_cvt_pk_bf16_f32 v50, v208, v209
    v_mfma_f32_16x16x32_bf16 a[88:91], a[12:15], a[184:187], a[88:91]
    buffer_load_dwordx4 v9, s[28:31], s74 offen lds
    v_cvt_pk_bf16_f32 v51, v210, v211
    v_mfma_f32_16x16x32_bf16 a[92:95], a[8:11], a[180:183], a[92:95]
    ds_read_b64_tr_b16 a[32:33], v21
    buffer_load_dword v24, v22, s[20:23], s76 offen sc1
    v_mfma_f32_16x16x32_bf16 a[92:95], a[12:15], a[188:191], a[92:95]
    s_waitcnt lgkmcnt(5)
    buffer_store_dwordx4 v[48:51], v13, s[20:23], s100 offen sc1
    v_mfma_f32_16x16x32_bf16 v[204:207], v[160:163], v[64:67], 0
    v_rcp_f32 v28, v220
    v_mfma_f32_16x16x32_bf16 v[104:107], a[16:19], a[160:163], v[104:107]
    ds_read_b64_tr_b16 a[34:35], v21 offset:2048
    v_mul_f32 v212, v212, v28
    v_mfma_f32_16x16x32_bf16 v[204:207], v[168:171], v[68:71], v[204:207]
    v_mul_f32 v213, v213, v28
    v_mul_f32 v214, v214, v28
    v_mfma_f32_16x16x32_bf16 v[220:223], v[176:179], v[64:67], v[184:187]
    v_mul_f32 v215, v215, v28
    v_mfma_f32_16x16x32_bf16 v[104:107], a[20:23], a[168:171], v[104:107]
    buffer_load_dwordx4 v10, s[28:31], s74 offen offset:1024 lds
    v_mul_f32 v216, v216, v28
    v_mfma_f32_16x16x32_bf16 v[220:223], v[180:183], v[68:71], v[220:223]
    v_mul_f32 v217, v217, v28
    v_mfma_f32_16x16x32_bf16 v[108:111], a[16:19], a[164:167], v[108:111]
    ds_read_b64_tr_b16 a[36:37], v21 offset:8192
    v_mul_f32 v218, v218, v28
    v_mfma_f32_16x16x32_bf16 v[208:211], v[164:167], v[64:67], 0
    v_mul_f32 v219, v219, v28
    v_cvt_pk_bf16_f32 v56, v212, v213
    v_mfma_f32_16x16x32_bf16 v[208:211], v[172:175], v[68:71], v[208:211]
    v_cvt_pk_bf16_f32 v57, v214, v215
    v_cvt_pk_bf16_f32 v58, v216, v217
    v_mfma_f32_16x16x32_bf16 v[108:111], a[20:23], a[172:175], v[108:111]
    buffer_load_dwordx4 v11, s[28:31], s74 offen offset:2048 lds
    v_cvt_pk_bf16_f32 v59, v218, v219
    v_mfma_f32_16x16x32_bf16 a[96:99], a[16:19], a[176:179], a[96:99]
    ds_read_b64_tr_b16 a[38:39], v21 offset:10240
    buffer_store_dwordx4 v[56:59], v13, s[20:23], s100 offen offset:1024 sc1
    v_mfma_f32_16x16x32_bf16 a[96:99], a[20:23], a[184:187], a[96:99]
    s_add_u32 s100, s100, 4096
    v_mfma_f32_16x16x32_bf16 v[212:215], v[160:163], v[72:75], 0
    v_rcp_f32 v28, v220
    v_mfma_f32_16x16x32_bf16 a[100:103], a[16:19], a[180:183], a[100:103]
    ds_read_b64_tr_b16 a[40:41], v18 offset:4096
    v_mul_f32 v204, v204, v28
    v_mfma_f32_16x16x32_bf16 v[212:215], v[168:171], v[76:79], v[212:215]
    v_mul_f32 v205, v205, v28
    v_mul_f32 v206, v206, v28
    v_mfma_f32_16x16x32_bf16 v[220:223], v[176:179], v[72:75], v[184:187]
    v_mul_f32 v207, v207, v28
    v_mul_f32 v208, v208, v28
    v_mfma_f32_16x16x32_bf16 v[220:223], v[180:183], v[76:79], v[220:223]
    v_mul_f32 v209, v209, v28
    v_mfma_f32_16x16x32_bf16 a[100:103], a[20:23], a[188:191], a[100:103]
    s_waitcnt lgkmcnt(5)
    v_mul_f32 v210, v210, v28
    v_mfma_f32_16x16x32_bf16 v[216:219], v[164:167], v[72:75], 0
    v_mul_f32 v211, v211, v28
    v_mfma_f32_16x16x32_bf16 v[112:115], a[24:27], a[160:163], v[112:115]
    ds_read_b64_tr_b16 a[42:43], v18 offset:6144
    v_cvt_pk_bf16_f32 v64, v204, v205
    v_mfma_f32_16x16x32_bf16 v[216:219], v[172:175], v[76:79], v[216:219]
    v_cvt_pk_bf16_f32 v65, v206, v207
    v_cvt_pk_bf16_f32 v66, v208, v209
    v_mfma_f32_16x16x32_bf16 v[112:115], a[28:31], a[168:171], v[112:115]
    buffer_load_dwordx4 v12, s[28:31], s74 offen offset:3072 lds
    v_cvt_pk_bf16_f32 v67, v210, v211
    v_mfma_f32_16x16x32_bf16 v[116:119], a[24:27], a[164:167], v[116:119]
    ds_read_b64_tr_b16 a[44:45], v18 offset:12288
    buffer_store_dwordx4 v[64:67], v13, s[20:23], s100 offen sc1
    v_mfma_f32_16x16x32_bf16 v[204:207], v[160:163], v[80:83], 0
    v_rcp_f32 v28, v220
    v_mfma_f32_16x16x32_bf16 v[116:119], a[28:31], a[172:175], v[116:119]
    s_add_u32 m0, s59, 16384
    v_mul_f32 v212, v212, v28
    v_mfma_f32_16x16x32_bf16 v[204:207], v[168:171], v[84:87], v[204:207]
    v_mul_f32 v213, v213, v28
    v_mul_f32 v214, v214, v28
    v_mfma_f32_16x16x32_bf16 v[220:223], v[176:179], v[80:83], v[184:187]
    v_mul_f32 v215, v215, v28
    v_mul_f32 v216, v216, v28
    v_mfma_f32_16x16x32_bf16 v[220:223], v[180:183], v[84:87], v[220:223]
    v_mul_f32 v217, v217, v28
    v_mfma_f32_16x16x32_bf16 a[104:107], a[24:27], a[176:179], a[104:107]
    ds_read_b64_tr_b16 a[46:47], v18 offset:14336
    v_mul_f32 v218, v218, v28
    v_mfma_f32_16x16x32_bf16 v[208:211], v[164:167], v[80:83], 0
    v_mul_f32 v219, v219, v28
    v_mfma_f32_16x16x32_bf16 a[104:107], a[28:31], a[184:187], a[104:107]
    s_add_u32 s74, s55, 262144
    v_cvt_pk_bf16_f32 v72, v212, v213
    v_mfma_f32_16x16x32_bf16 v[208:211], v[172:175], v[84:87], v[208:211]
    v_cvt_pk_bf16_f32 v73, v214, v215
    v_cvt_pk_bf16_f32 v74, v216, v217
    v_mfma_f32_16x16x32_bf16 a[108:111], a[24:27], a[180:183], a[108:111]
    ds_read_b64_tr_b16 a[48:49], v19 offset:4096
    v_cvt_pk_bf16_f32 v75, v218, v219
    v_mfma_f32_16x16x32_bf16 a[108:111], a[28:31], a[188:191], a[108:111]
    s_waitcnt lgkmcnt(5)
    buffer_store_dwordx4 v[72:75], v13, s[20:23], s100 offen offset:1024 sc1
    s_add_u32 s100, s100, 4096
    v_mfma_f32_16x16x32_bf16 v[212:215], v[160:163], v[88:91], 0
    v_rcp_f32 v28, v220
    v_mfma_f32_16x16x32_bf16 v[120:123], a[32:35], a[160:163], v[120:123]
    ds_read_b64_tr_b16 a[50:51], v19 offset:6144
    v_mul_f32 v204, v204, v28
    v_mfma_f32_16x16x32_bf16 v[212:215], v[168:171], v[92:95], v[212:215]
    v_mul_f32 v205, v205, v28
    v_mfma_f32_16x16x32_bf16 v[120:123], a[36:39], a[168:171], v[120:123]
    buffer_load_dwordx4 v9, s[28:31], s74 offen lds
    v_mul_f32 v206, v206, v28
    v_mfma_f32_16x16x32_bf16 v[220:223], v[176:179], v[88:91], v[184:187]
    v_mul_f32 v207, v207, v28
    v_mul_f32 v208, v208, v28
    v_mfma_f32_16x16x32_bf16 v[220:223], v[180:183], v[92:95], v[220:223]
    v_mul_f32 v209, v209, v28
    v_mfma_f32_16x16x32_bf16 v[124:127], a[32:35], a[164:167], v[124:127]
    ds_read_b64_tr_b16 a[52:53], v19 offset:12288
    v_mul_f32 v210, v210, v28
    v_mfma_f32_16x16x32_bf16 v[216:219], v[164:167], v[88:91], 0
    v_mul_f32 v211, v211, v28
    v_mfma_f32_16x16x32_bf16 v[124:127], a[36:39], a[172:175], v[124:127]
    buffer_load_dwordx4 v10, s[28:31], s74 offen offset:1024 lds
    v_cvt_pk_bf16_f32 v80, v204, v205
    v_mfma_f32_16x16x32_bf16 v[216:219], v[172:175], v[92:95], v[216:219]
    v_cvt_pk_bf16_f32 v81, v206, v207
    v_mfma_f32_16x16x32_bf16 a[112:115], a[32:35], a[176:179], a[112:115]
    ds_read_b64_tr_b16 a[54:55], v19 offset:14336
    v_cvt_pk_bf16_f32 v82, v208, v209
    v_mfma_f32_16x16x32_bf16 a[112:115], a[36:39], a[184:187], a[112:115]
    buffer_load_dwordx4 v11, s[28:31], s74 offen offset:2048 lds
    v_cvt_pk_bf16_f32 v83, v210, v211
    v_mfma_f32_16x16x32_bf16 a[116:119], a[32:35], a[180:183], a[116:119]
    ds_read_b64_tr_b16 a[0:1], v20 offset:4096
    buffer_store_dwordx4 v[80:83], v13, s[20:23], s100 offen sc1
    v_mfma_f32_16x16x32_bf16 a[116:119], a[36:39], a[188:191], a[116:119]
    s_waitcnt lgkmcnt(5)
    v_rcp_f32 v28, v220
    v_mfma_f32_16x16x32_bf16 v[128:131], a[40:43], a[160:163], v[128:131]
    ds_read_b64_tr_b16 a[2:3], v20 offset:6144
    v_mul_f32 v212, v212, v28
    v_mfma_f32_16x16x32_bf16 v[128:131], a[44:47], a[168:171], v[128:131]
    buffer_load_dwordx4 v12, s[28:31], s74 offen offset:3072 lds
    v_mul_f32 v213, v213, v28
    v_mul_f32 v214, v214, v28
    v_mfma_f32_16x16x32_bf16 v[132:135], a[40:43], a[164:167], v[132:135]
    ds_read_b64_tr_b16 a[4:5], v20 offset:12288
    v_mul_f32 v215, v215, v28
    v_mfma_f32_16x16x32_bf16 v[132:135], a[44:47], a[172:175], v[132:135]
    s_add_u32 m0, s59, 32768
    v_mul_f32 v216, v216, v28
    v_mfma_f32_16x16x32_bf16 a[56:59], a[40:43], a[176:179], a[56:59]
    ds_read_b64_tr_b16 a[6:7], v20 offset:14336
    v_mul_f32 v217, v217, v28
    v_mfma_f32_16x16x32_bf16 a[56:59], a[44:47], a[184:187], a[56:59]
    s_add_u32 s74, s55, 524288
    v_mul_f32 v218, v218, v28
    v_mul_f32 v219, v219, v28
    v_mfma_f32_16x16x32_bf16 a[60:63], a[40:43], a[180:183], a[60:63]
    ds_read_b64_tr_b16 a[8:9], v21 offset:4096
    v_cvt_pk_bf16_f32 v88, v212, v213
    v_mfma_f32_16x16x32_bf16 a[60:63], a[44:47], a[188:191], a[60:63]
    s_waitcnt lgkmcnt(5)
    v_cvt_pk_bf16_f32 v89, v214, v215
    v_cvt_pk_bf16_f32 v90, v216, v217
    v_mfma_f32_16x16x32_bf16 v[136:139], a[48:51], a[160:163], v[136:139]
    ds_read_b64_tr_b16 a[10:11], v21 offset:6144
    v_cvt_pk_bf16_f32 v91, v218, v219
    v_mfma_f32_16x16x32_bf16 v[136:139], a[52:55], a[168:171], v[136:139]
    buffer_load_dwordx4 v9, s[28:31], s74 offen lds
    buffer_store_dwordx4 v[88:91], v13, s[20:23], s100 offen offset:1024 sc1
    s_add_u32 s100, s100, 4096
    v_mfma_f32_16x16x32_bf16 v[140:143], a[48:51], a[164:167], v[140:143]
    ds_read_b64_tr_b16 a[12:13], v21 offset:12288
    v_mfma_f32_16x16x32_bf16 v[140:143], a[52:55], a[172:175], v[140:143]
    buffer_load_dwordx4 v10, s[28:31], s74 offen offset:1024 lds
    v_mfma_f32_16x16x32_bf16 a[64:67], a[48:51], a[176:179], a[64:67]
    ds_read_b64_tr_b16 a[14:15], v21 offset:14336
    v_mfma_f32_16x16x32_bf16 a[64:67], a[52:55], a[184:187], a[64:67]
    buffer_load_dwordx4 v11, s[28:31], s74 offen offset:2048 lds
    v_mfma_f32_16x16x32_bf16 a[68:71], a[48:51], a[180:183], a[68:71]
    ds_read_b64_tr_b16 a[16:17], v0 offset:16384
    v_mfma_f32_16x16x32_bf16 a[68:71], a[52:55], a[188:191], a[68:71]
    s_waitcnt lgkmcnt(5)
    v_mfma_f32_16x16x32_bf16 v[144:147], a[0:3], a[160:163], v[144:147]
    ds_read_b64_tr_b16 a[18:19], v0 offset:18432
    v_mfma_f32_16x16x32_bf16 v[144:147], a[4:7], a[168:171], v[144:147]
    v_mfma_f32_16x16x32_bf16 v[148:151], a[0:3], a[164:167], v[148:151]
    ds_read_b64_tr_b16 a[20:21], v0 offset:24576
    s_waitcnt vmcnt(16)
    v_cmp_le_u32 vcc, 2, v24
    s_nop 0
    s_cmp_eq_u64 vcc, -1
    s_cbranch_scc0 L_pha2b_spin
L_pha2b_ok:
    v_mfma_f32_16x16x32_bf16 v[148:151], a[4:7], a[172:175], v[148:151]
    buffer_load_dwordx4 v12, s[28:31], s74 offen offset:3072 lds
    v_mfma_f32_16x16x32_bf16 a[72:75], a[0:3], a[176:179], a[72:75]
    ds_read_b64_tr_b16 a[22:23], v0 offset:26624
    s_lshl_b32 s76, s58, 7
    v_mfma_f32_16x16x32_bf16 a[72:75], a[4:7], a[184:187], a[72:75]
    s_add_u32 s75, s85, 3145728
    v_mfma_f32_16x16x32_bf16 a[76:79], a[0:3], a[180:183], a[76:79]
    ds_read_b64_tr_b16 a[24:25], v1 offset:16384
    v_mfma_f32_16x16x32_bf16 a[76:79], a[4:7], a[188:191], a[76:79]
    s_waitcnt lgkmcnt(5)
    s_add_u32 s76, s76, 34160640
    v_mfma_f32_16x16x32_bf16 v[152:155], a[8:11], a[160:163], v[152:155]
    ds_read_b64_tr_b16 a[26:27], v1 offset:18432
    v_mfma_f32_16x16x32_bf16 v[152:155], a[12:15], a[168:171], v[152:155]
    buffer_load_dwordx4 a[240:243], v13, s[20:23], s75 offen sc1
    v_mfma_f32_16x16x32_bf16 v[156:159], a[8:11], a[164:167], v[156:159]
    ds_read_b64_tr_b16 a[28:29], v1 offset:24576
    v_bfe_u32 v22, v13, 4, 4
    v_mfma_f32_16x16x32_bf16 v[156:159], a[12:15], a[172:175], v[156:159]
    buffer_load_dwordx4 a[244:247], v13, s[20:23], s75 offen offset:1024 sc1
    v_mfma_f32_16x16x32_bf16 a[80:83], a[8:11], a[176:179], a[80:83]
    ds_read_b64_tr_b16 a[30:31], v1 offset:26624
    v_mfma_f32_16x16x32_bf16 a[80:83], a[12:15], a[184:187], a[80:83]
    v_lshlrev_b32 v22, 2, v22
    v_mfma_f32_16x16x32_bf16 a[84:87], a[8:11], a[180:183], a[84:87]
    ds_read_b64_tr_b16 a[32:33], v8 offset:16384
    v_mfma_f32_16x16x32_bf16 a[84:87], a[12:15], a[188:191], a[84:87]
    s_waitcnt lgkmcnt(5)
    v_mfma_f32_16x16x32_bf16 v[96:99], a[16:19], a[192:195], v[96:99]
    ds_read_b64_tr_b16 a[34:35], v8 offset:18432
    v_mfma_f32_16x16x32_bf16 v[96:99], a[20:23], a[200:203], v[96:99]
    buffer_load_dwordx4 a[248:251], v13, s[20:23], s75 offen offset:2048 sc1
    v_mfma_f32_16x16x32_bf16 v[100:103], a[16:19], a[196:199], v[100:103]
    ds_read_b64_tr_b16 a[36:37], v8 offset:24576
    v_mfma_f32_16x16x32_bf16 v[100:103], a[20:23], a[204:207], v[100:103]
    buffer_load_dwordx4 a[252:255], v13, s[20:23], s75 offen offset:3072 sc1
    v_mfma_f32_16x16x32_bf16 a[88:91], a[16:19], a[208:211], a[88:91]
    ds_read_b64_tr_b16 a[38:39], v8 offset:26624
    v_mfma_f32_16x16x32_bf16 a[88:91], a[20:23], a[216:219], a[88:91]
    v_mfma_f32_16x16x32_bf16 a[92:95], a[16:19], a[212:215], a[92:95]
    ds_read_b64_tr_b16 a[40:41], v31 offset:16384
    v_mfma_f32_16x16x32_bf16 a[92:95], a[20:23], a[220:223], a[92:95]
    s_waitcnt lgkmcnt(5)
    v_mfma_f32_16x16x32_bf16 v[104:107], a[24:27], a[192:195], v[104:107]
    ds_read_b64_tr_b16 a[42:43], v31 offset:18432
    v_mfma_f32_16x16x32_bf16 v[104:107], a[28:31], a[200:203], v[104:107]
    s_add_u32 s75, s85, 3407872
    v_mfma_f32_16x16x32_bf16 v[108:111], a[24:27], a[196:199], v[108:111]
    ds_read_b64_tr_b16 a[44:45], v31 offset:24576
    v_mfma_f32_16x16x32_bf16 v[108:111], a[28:31], a[204:207], v[108:111]
    buffer_load_dwordx4 a[144:147], v13, s[20:23], s75 offen sc1
    v_mfma_f32_16x16x32_bf16 a[96:99], a[24:27], a[208:211], a[96:99]
    ds_read_b64_tr_b16 a[46:47], v31 offset:26624
    v_mfma_f32_16x16x32_bf16 a[96:99], a[28:31], a[216:219], a[96:99]
    buffer_load_dwordx4 a[148:151], v13, s[20:23], s75 offen offset:1024 sc1
    v_mfma_f32_16x16x32_bf16 a[100:103], a[24:27], a[212:215], a[100:103]
    ds_read_b64_tr_b16 a[48:49], v0 offset:20480
    v_mfma_f32_16x16x32_bf16 a[100:103], a[28:31], a[220:223], a[100:103]
    s_waitcnt lgkmcnt(5)
    v_mfma_f32_16x16x32_bf16 v[112:115], a[32:35], a[192:195], v[112:115]
    ds_read_b64_tr_b16 a[50:51], v0 offset:22528
    v_mfma_f32_16x16x32_bf16 v[112:115], a[36:39], a[200:203], v[112:115]
    buffer_load_dwordx4 a[152:155], v13, s[20:23], s75 offen offset:2048 sc1
    v_mfma_f32_16x16x32_bf16 v[116:119], a[32:35], a[196:199], v[116:119]
    ds_read_b64_tr_b16 a[52:53], v0 offset:28672
    v_mfma_f32_16x16x32_bf16 v[116:119], a[36:39], a[204:207], v[116:119]
    v_mfma_f32_16x16x32_bf16 a[104:107], a[32:35], a[208:211], a[104:107]
    ds_read_b64_tr_b16 a[54:55], v0 offset:30720
    v_mfma_f32_16x16x32_bf16 a[104:107], a[36:39], a[216:219], a[104:107]
    buffer_load_dwordx4 a[156:159], v13, s[20:23], s75 offen offset:3072 sc1
    v_mfma_f32_16x16x32_bf16 a[108:111], a[32:35], a[212:215], a[108:111]
    ds_read_b64_tr_b16 a[0:1], v1 offset:20480
    v_mfma_f32_16x16x32_bf16 a[108:111], a[36:39], a[220:223], a[108:111]
    s_waitcnt lgkmcnt(5)
    v_mfma_f32_16x16x32_bf16 v[120:123], a[40:43], a[192:195], v[120:123]
    ds_read_b64_tr_b16 a[2:3], v1 offset:22528
    v_mfma_f32_16x16x32_bf16 v[120:123], a[44:47], a[200:203], v[120:123]
    s_add_u32 s75, s56, 2621440
    v_mfma_f32_16x16x32_bf16 v[124:127], a[40:43], a[196:199], v[124:127]
    ds_read_b64_tr_b16 a[4:5], v1 offset:28672
    v_mfma_f32_16x16x32_bf16 v[124:127], a[44:47], a[204:207], v[124:127]
    buffer_load_dwordx4 a[160:163], v13, s[20:23], s75 offen sc1
    v_mfma_f32_16x16x32_bf16 a[112:115], a[40:43], a[208:211], a[112:115]
    ds_read_b64_tr_b16 a[6:7], v1 offset:30720
    v_mfma_f32_16x16x32_bf16 a[112:115], a[44:47], a[216:219], a[112:115]
    v_mfma_f32_16x16x32_bf16 a[116:119], a[40:43], a[212:215], a[116:119]
    ds_read_b64_tr_b16 a[8:9], v8 offset:20480
    v_mfma_f32_16x16x32_bf16 a[116:119], a[44:47], a[220:223], a[116:119]
    s_waitcnt lgkmcnt(5)
    v_mfma_f32_16x16x32_bf16 v[128:131], a[48:51], a[192:195], v[128:131]
    ds_read_b64_tr_b16 a[10:11], v8 offset:22528
    v_mfma_f32_16x16x32_bf16 v[128:131], a[52:55], a[200:203], v[128:131]
    buffer_load_dwordx4 a[164:167], v13, s[20:23], s75 offen offset:1024 sc1
    v_mfma_f32_16x16x32_bf16 v[132:135], a[48:51], a[196:199], v[132:135]
    ds_read_b64_tr_b16 a[12:13], v8 offset:28672
    v_mfma_f32_16x16x32_bf16 v[132:135], a[52:55], a[204:207], v[132:135]
    buffer_load_dwordx4 a[168:171], v13, s[20:23], s75 offen offset:2048 sc1
    v_mfma_f32_16x16x32_bf16 a[56:59], a[48:51], a[208:211], a[56:59]
    ds_read_b64_tr_b16 a[14:15], v8 offset:30720
    v_mfma_f32_16x16x32_bf16 a[56:59], a[52:55], a[216:219], a[56:59]
    v_mfma_f32_16x16x32_bf16 a[60:63], a[48:51], a[212:215], a[60:63]
    ds_read_b64_tr_b16 a[16:17], v31 offset:20480
    v_mfma_f32_16x16x32_bf16 a[60:63], a[52:55], a[220:223], a[60:63]
    s_waitcnt lgkmcnt(5)
    v_mfma_f32_16x16x32_bf16 v[136:139], a[0:3], a[192:195], v[136:139]
    ds_read_b64_tr_b16 a[18:19], v31 offset:22528
    v_mfma_f32_16x16x32_bf16 v[136:139], a[4:7], a[200:203], v[136:139]
    buffer_load_dwordx4 a[172:175], v13, s[20:23], s75 offen offset:3072 sc1
    v_mfma_f32_16x16x32_bf16 v[140:143], a[0:3], a[196:199], v[140:143]
    ds_read_b64_tr_b16 a[20:21], v31 offset:28672
    s_waitcnt vmcnt(15)
    s_barrier
    s_cmp_lg_u32 s44, 0
    s_cbranch_scc1 L_fevb_skip
    v_accvgpr_write_b32 a124, 1
    s_mov_b64 exec, 1
    buffer_store_dword a124, off, s[20:23], s82 sc1
    s_mov_b64 exec, -1
L_fevb_skip:
    v_mfma_f32_16x16x32_bf16 v[140:143], a[4:7], a[204:207], v[140:143]
    s_add_u32 s75, s56, 2883584
    v_mfma_f32_16x16x32_bf16 a[64:67], a[0:3], a[208:211], a[64:67]
    ds_read_b64_tr_b16 a[22:23], v31 offset:30720
    v_mfma_f32_16x16x32_bf16 a[64:67], a[4:7], a[216:219], a[64:67]
    buffer_load_dwordx4 a[176:179], v13, s[20:23], s75 offen sc1
    s_barrier
    v_mfma_f32_16x16x32_bf16 a[68:71], a[0:3], a[212:215], a[68:71]
    ds_read_b64_tr_b16 a[24:25], v18 offset:20480
    v_mfma_f32_16x16x32_bf16 a[68:71], a[4:7], a[220:223], a[68:71]
    ds_read_b64_tr_b16 a[26:27], v18 offset:22528
    s_waitcnt lgkmcnt(6)
    v_mfma_f32_16x16x32_bf16 v[144:147], a[8:11], a[192:195], v[144:147]
    ds_read_b64_tr_b16 a[28:29], v18 offset:28672
    buffer_load_dwordx4 a[180:183], v13, s[20:23], s75 offen offset:1024 sc1
    v_mfma_f32_16x16x32_bf16 v[144:147], a[12:15], a[200:203], v[144:147]
    ds_read_b64_tr_b16 a[30:31], v18 offset:30720
    v_mfma_f32_16x16x32_bf16 v[148:151], a[8:11], a[196:199], v[148:151]
    ds_read_b64_tr_b16 a[32:33], v19 offset:20480
    v_mfma_f32_16x16x32_bf16 v[148:151], a[12:15], a[204:207], v[148:151]
    ds_read_b64_tr_b16 a[34:35], v19 offset:22528
    v_mfma_f32_16x16x32_bf16 a[72:75], a[8:11], a[208:211], a[72:75]
    ds_read_b64_tr_b16 a[36:37], v19 offset:28672
    buffer_load_dwordx4 a[184:187], v13, s[20:23], s75 offen offset:2048 sc1
    s_waitcnt vmcnt(11)
    v_mfma_f32_16x16x32_bf16 a[72:75], a[12:15], a[216:219], a[72:75]
    ds_read_b64_tr_b16 a[38:39], v19 offset:30720
    v_accvgpr_mov_b32 a120, a242
    v_mfma_f32_16x16x32_bf16 a[76:79], a[8:11], a[212:215], a[76:79]
    ds_read_b64_tr_b16 a[40:41], v20 offset:20480
    v_mfma_f32_16x16x32_bf16 a[76:79], a[12:15], a[220:223], a[76:79]
    ds_read_b64_tr_b16 a[42:43], v20 offset:22528
    s_waitcnt lgkmcnt(10)
    v_mfma_f32_16x16x32_bf16 v[152:155], a[16:19], a[192:195], v[152:155]
    ds_read_b64_tr_b16 a[44:45], v20 offset:28672
    buffer_load_dwordx4 a[188:191], v13, s[20:23], s75 offen offset:3072 sc1
    v_mfma_f32_16x16x32_bf16 v[152:155], a[20:23], a[200:203], v[152:155]
    ds_read_b64_tr_b16 a[46:47], v20 offset:30720
    v_accvgpr_mov_b32 a121, a243
    v_mfma_f32_16x16x32_bf16 v[156:159], a[16:19], a[196:199], v[156:159]
    ds_read_b64_tr_b16 a[48:49], v21 offset:20480
    v_accvgpr_mov_b32 a242, a244
    v_accvgpr_mov_b32 a243, a245
    v_mfma_f32_16x16x32_bf16 v[156:159], a[20:23], a[204:207], v[156:159]
    ds_read_b64_tr_b16 a[50:51], v21 offset:22528
    s_add_u32 s75, s56, 3145728
    v_mfma_f32_16x16x32_bf16 a[80:83], a[16:19], a[208:211], a[80:83]
    ds_read_b64_tr_b16 a[52:53], v21 offset:28672
    buffer_load_dwordx4 a[192:195], v13, s[20:23], s75 offen sc1
    v_mfma_f32_16x16x32_bf16 a[80:83], a[20:23], a[216:219], a[80:83]
    ds_read_b64_tr_b16 a[54:55], v21 offset:30720
    v_accvgpr_mov_b32 a244, a120
    v_mfma_f32_16x16x32_bf16 a[84:87], a[16:19], a[212:215], a[84:87]
    ds_read_b64_tr_b16 a[0:1], v18 offset:36864
    v_accvgpr_mov_b32 a245, a121
    v_mfma_f32_16x16x32_bf16 a[84:87], a[20:23], a[220:223], a[84:87]
    ds_read_b64_tr_b16 a[2:3], v18 offset:38912
    s_waitcnt lgkmcnt(10)
    v_mfma_f32_16x16x32_bf16 a[56:59], a[24:27], a[224:227], a[56:59]
    ds_read_b64_tr_b16 a[4:5], v18 offset:45056
    v_accvgpr_mov_b32 a120, a250
    v_accvgpr_mov_b32 a121, a251
    v_mfma_f32_16x16x32_bf16 a[56:59], a[28:31], a[232:235], a[56:59]
    ds_read_b64_tr_b16 a[6:7], v18 offset:47104
    buffer_load_dwordx4 a[196:199], v13, s[20:23], s75 offen offset:1024 sc1
    v_mfma_f32_16x16x32_bf16 a[60:63], a[24:27], a[228:231], a[60:63]
    ds_read_b64_tr_b16 a[8:9], v19 offset:36864
    v_accvgpr_mov_b32 a250, a252
    v_mfma_f32_16x16x32_bf16 a[60:63], a[28:31], a[236:239], a[60:63]
    ds_read_b64_tr_b16 a[10:11], v19 offset:38912
    v_accvgpr_mov_b32 a251, a253
    v_mfma_f32_16x16x32_bf16 a[64:67], a[32:35], a[224:227], a[64:67]
    ds_read_b64_tr_b16 a[12:13], v19 offset:45056
    v_accvgpr_mov_b32 a252, a120
    v_mfma_f32_16x16x32_bf16 a[64:67], a[36:39], a[232:235], a[64:67]
    ds_read_b64_tr_b16 a[14:15], v19 offset:47104
    buffer_load_dwordx4 a[200:203], v13, s[20:23], s75 offen offset:2048 sc1
    v_mfma_f32_16x16x32_bf16 a[68:71], a[32:35], a[228:231], a[68:71]
    ds_read_b64_tr_b16 a[16:17], v20 offset:36864
    v_accvgpr_mov_b32 a253, a121
    v_mfma_f32_16x16x32_bf16 a[68:71], a[36:39], a[236:239], a[68:71]
    ds_read_b64_tr_b16 a[18:19], v20 offset:38912
    s_waitcnt lgkmcnt(10)
    v_mfma_f32_16x16x32_bf16 a[72:75], a[40:43], a[224:227], a[72:75]
    ds_read_b64_tr_b16 a[20:21], v20 offset:45056
    s_waitcnt vmcnt(11)
    v_mfma_f32_16x16x32_bf16 a[72:75], a[44:47], a[232:235], a[72:75]
    ds_read_b64_tr_b16 a[22:23], v20 offset:47104
    v_accvgpr_mov_b32 a120, a146
    v_mfma_f32_16x16x32_bf16 a[76:79], a[40:43], a[228:231], a[76:79]
    ds_read_b64_tr_b16 a[24:25], v21 offset:36864
    buffer_load_dword v24, v23, s[20:23], s65 offen sc1
    v_mfma_f32_16x16x32_bf16 a[76:79], a[44:47], a[236:239], a[76:79]
    ds_read_b64_tr_b16 a[26:27], v21 offset:38912
    buffer_load_dwordx4 a[204:207], v13, s[20:23], s75 offen offset:3072 sc1
    v_mfma_f32_16x16x32_bf16 a[80:83], a[48:51], a[224:227], a[80:83]
    ds_read_b64_tr_b16 a[28:29], v21 offset:45056
    v_accvgpr_mov_b32 a121, a147
    v_mfma_f32_16x16x32_bf16 a[80:83], a[52:55], a[232:235], a[80:83]
    ds_read_b64_tr_b16 a[30:31], v21 offset:47104
    s_add_u32 s75, s56, 3407872
    v_mfma_f32_16x16x32_bf16 a[84:87], a[48:51], a[228:231], a[84:87]
    ds_read_b64_tr_b16 a[32:33], v18 offset:53248
    buffer_load_dwordx4 a[208:211], v13, s[20:23], s75 offen sc1
    v_mfma_f32_16x16x32_bf16 a[84:87], a[52:55], a[236:239], a[84:87]
    ds_read_b64_tr_b16 a[34:35], v18 offset:55296
    s_waitcnt lgkmcnt(10)
    v_mfma_f32_16x16x32_bf16 a[56:59], a[0:3], a[128:131], a[56:59]
    ds_read_b64_tr_b16 a[36:37], v18 offset:61440
    v_accvgpr_mov_b32 a146, a148
    v_accvgpr_mov_b32 a147, a149
    v_mfma_f32_16x16x32_bf16 a[56:59], a[4:7], a[136:139], a[56:59]
    ds_read_b64_tr_b16 a[38:39], v18 offset:63488
    v_accvgpr_mov_b32 a148, a120
    v_mfma_f32_16x16x32_bf16 a[60:63], a[0:3], a[132:135], a[60:63]
    ds_read_b64_tr_b16 a[40:41], v19 offset:53248
    buffer_load_dwordx4 a[212:215], v13, s[20:23], s75 offen offset:1024 sc1
    v_mfma_f32_16x16x32_bf16 a[60:63], a[4:7], a[140:143], a[60:63]
    ds_read_b64_tr_b16 a[42:43], v19 offset:55296
    v_accvgpr_mov_b32 a149, a121
    v_mfma_f32_16x16x32_bf16 a[64:67], a[8:11], a[128:131], a[64:67]
    ds_read_b64_tr_b16 a[44:45], v19 offset:61440
    v_accvgpr_mov_b32 a120, a154
    v_accvgpr_mov_b32 a121, a155
    v_mfma_f32_16x16x32_bf16 a[64:67], a[12:15], a[136:139], a[64:67]
    ds_read_b64_tr_b16 a[46:47], v19 offset:63488
    v_accvgpr_mov_b32 a154, a156
    v_mfma_f32_16x16x32_bf16 a[68:71], a[8:11], a[132:135], a[68:71]
    ds_read_b64_tr_b16 a[48:49], v20 offset:53248
    v_mfma_f32_16x16x32_bf16 a[68:71], a[12:15], a[140:143], a[68:71]
    ds_read_b64_tr_b16 a[50:51], v20 offset:55296
    s_waitcnt lgkmcnt(10)
    v_mfma_f32_16x16x32_bf16 a[72:75], a[16:19], a[128:131], a[72:75]
    ds_read_b64_tr_b16 a[52:53], v20 offset:61440
    buffer_load_dwordx4 a[216:219], v13, s[20:23], s75 offen offset:2048 sc1
    v_mfma_f32_16x16x32_bf16 a[72:75], a[20:23], a[136:139], a[72:75]
    ds_read_b64_tr_b16 a[54:55], v20 offset:63488
    v_accvgpr_mov_b32 a155, a157
    v_mfma_f32_16x16x32_bf16 a[76:79], a[16:19], a[132:135], a[76:79]
    ds_read_b64_tr_b16 a[0:1], v21 offset:53248
    v_accvgpr_mov_b32 a156, a120
    v_accvgpr_mov_b32 a157, a121
    v_mfma_f32_16x16x32_bf16 a[76:79], a[20:23], a[140:143], a[76:79]
    ds_read_b64_tr_b16 a[2:3], v21 offset:55296
    buffer_load_dwordx4 a[220:223], v13, s[20:23], s75 offen offset:3072 sc1
    v_mfma_f32_16x16x32_bf16 a[80:83], a[24:27], a[128:131], a[80:83]
    ds_read_b64_tr_b16 a[4:5], v21 offset:61440
    v_mfma_f32_16x16x32_bf16 a[80:83], a[28:31], a[136:139], a[80:83]
    ds_read_b64_tr_b16 a[6:7], v21 offset:63488
    v_mfma_f32_16x16x32_bf16 a[84:87], a[24:27], a[132:135], a[84:87]
    ds_read_b64_tr_b16 a[8:9], v0 offset:4096
    s_add_u32 m0, s59, 49152
    v_mfma_f32_16x16x32_bf16 a[84:87], a[28:31], a[140:143], a[84:87]
    ds_read_b64_tr_b16 a[10:11], v0 offset:6144
    s_waitcnt lgkmcnt(10)
    v_mfma_f32_16x16x32_bf16 a[56:59], a[32:35], a[240:243], a[56:59]
    ds_read_b64_tr_b16 a[12:13], v0 offset:12288
    s_add_u32 s74, s55, 786432
L_pad1_13:
    s_cbranch_execz L_pad1_17
    v_mfma_f32_16x16x32_bf16 a[56:59], a[36:39], a[248:251], a[56:59]
    ds_read_b64_tr_b16 a[14:15], v0 offset:14336
    buffer_load_dwordx4 v9, s[28:31], s74 offen lds
    v_mfma_f32_16x16x32_bf16 a[60:63], a[32:35], a[244:247], a[60:63]
    ds_read_b64_tr_b16 a[16:17], v1 offset:4096
    v_mfma_f32_16x16x32_bf16 a[60:63], a[36:39], a[252:255], a[60:63]
    ds_read_b64_tr_b16 a[18:19], v1 offset:6144
    v_mfma_f32_16x16x32_bf16 a[64:67], a[40:43], a[240:243], a[64:67]
    ds_read_b64_tr_b16 a[20:21], v1 offset:12288
    buffer_load_dwordx4 v10, s[28:31], s74 offen offset:1024 lds
    v_mfma_f32_16x16x32_bf16 a[64:67], a[44:47], a[248:251], a[64:67]
    ds_read_b64_tr_b16 a[22:23], v1 offset:14336
    v_mfma_f32_16x16x32_bf16 a[68:71], a[40:43], a[244:247], a[68:71]
    ds_read_b64_tr_b16 a[24:25], v8 offset:4096
    v_mfma_f32_16x16x32_bf16 a[68:71], a[44:47], a[252:255], a[68:71]
    ds_read_b64_tr_b16 a[26:27], v8 offset:6144
    s_waitcnt lgkmcnt(10)
    v_mfma_f32_16x16x32_bf16 a[72:75], a[48:51], a[240:243], a[72:75]
    ds_read_b64_tr_b16 a[28:29], v8 offset:12288
    buffer_load_dwordx4 v11, s[28:31], s74 offen offset:2048 lds
    v_mfma_f32_16x16x32_bf16 a[72:75], a[52:55], a[248:251], a[72:75]
    ds_read_b64_tr_b16 a[30:31], v8 offset:14336
    v_mfma_f32_16x16x32_bf16 a[76:79], a[48:51], a[244:247], a[76:79]
    ds_read_b64_tr_b16 a[32:33], v31 offset:4096
    v_mfma_f32_16x16x32_bf16 a[76:79], a[52:55], a[252:255], a[76:79]
    ds_read_b64_tr_b16 a[34:35], v31 offset:6144
    v_mfma_f32_16x16x32_bf16 a[80:83], a[0:3], a[240:243], a[80:83]
    ds_read_b64_tr_b16 a[36:37], v31 offset:12288
    v_mfma_f32_16x16x32_bf16 a[80:83], a[4:7], a[248:251], a[80:83]
    ds_read_b64_tr_b16 a[38:39], v31 offset:14336
    buffer_load_dwordx4 v12, s[28:31], s74 offen offset:3072 lds
    v_mfma_f32_16x16x32_bf16 a[84:87], a[0:3], a[244:247], a[84:87]
    ds_read_b64_tr_b16 a[40:41], v18 offset:16384
    v_mfma_f32_16x16x32_bf16 a[84:87], a[4:7], a[252:255], a[84:87]
    ds_read_b64_tr_b16 a[42:43], v18 offset:18432
    s_waitcnt lgkmcnt(10)
    v_mfma_f32_16x16x32_bf16 a[56:59], a[8:11], a[144:147], a[56:59]
    ds_read_b64_tr_b16 a[44:45], v18 offset:24576
    s_add_u32 m0, s59, 65536
    v_mfma_f32_16x16x32_bf16 a[56:59], a[12:15], a[152:155], a[56:59]
    ds_read_b64_tr_b16 a[46:47], v18 offset:26624
    s_add_u32 s74, s55, 1048576
    v_mfma_f32_16x16x32_bf16 a[60:63], a[8:11], a[148:151], a[60:63]
    ds_read_b64_tr_b16 a[48:49], v19 offset:16384
    buffer_load_dwordx4 v9, s[28:31], s74 offen lds
    v_mfma_f32_16x16x32_bf16 a[60:63], a[12:15], a[156:159], a[60:63]
    ds_read_b64_tr_b16 a[50:51], v19 offset:18432
    v_mfma_f32_16x16x32_bf16 a[64:67], a[16:19], a[144:147], a[64:67]
    ds_read_b64_tr_b16 a[52:53], v19 offset:24576
    v_mfma_f32_16x16x32_bf16 a[64:67], a[20:23], a[152:155], a[64:67]
    ds_read_b64_tr_b16 a[54:55], v19 offset:26624
    v_mfma_f32_16x16x32_bf16 a[68:71], a[16:19], a[148:151], a[68:71]
    ds_read_b64_tr_b16 a[0:1], v20 offset:16384
    s_waitcnt vmcnt(10)
    v_cmp_le_u32 vcc, 1, v24
    s_nop 0
    s_cmp_eq_u64 vcc, -1
    s_cbranch_scc0 L_pdb_spin
L_pdb_ok:
    v_mfma_f32_16x16x32_bf16 a[68:71], a[20:23], a[156:159], a[68:71]
    ds_read_b64_tr_b16 a[2:3], v20 offset:18432
    s_waitcnt lgkmcnt(10)
    v_mfma_f32_16x16x32_bf16 a[72:75], a[24:27], a[144:147], a[72:75]
    ds_read_b64_tr_b16 a[4:5], v20 offset:24576
    buffer_load_dwordx4 v10, s[28:31], s74 offen offset:1024 lds
    s_add_u32 s61, s62, 0
    v_mfma_f32_16x16x32_bf16 a[72:75], a[28:31], a[152:155], a[72:75]
    ds_read_b64_tr_b16 a[6:7], v20 offset:26624
    v_accvgpr_read_b32 v188, a56
    v_mfma_f32_16x16x32_bf16 a[76:79], a[24:27], a[148:151], a[76:79]
    ds_read_b64_tr_b16 a[8:9], v21 offset:16384
    buffer_load_dwordx4 v11, s[28:31], s74 offen offset:2048 lds
    v_mfma_f32_16x16x32_bf16 a[76:79], a[28:31], a[156:159], a[76:79]
    ds_read_b64_tr_b16 a[10:11], v21 offset:18432
    v_accvgpr_read_b32 v189, a57
    v_mfma_f32_16x16x32_bf16 a[80:83], a[32:35], a[144:147], a[80:83]
    ds_read_b64_tr_b16 a[12:13], v21 offset:24576
    v_accvgpr_read_b32 v190, a58
    v_accvgpr_read_b32 v191, a59
    v_mfma_f32_16x16x32_bf16 a[80:83], a[36:39], a[152:155], a[80:83]
    ds_read_b64_tr_b16 a[14:15], v21 offset:26624
    v_accvgpr_read_b32 v192, a64
    v_mfma_f32_16x16x32_bf16 a[84:87], a[32:35], a[148:151], a[84:87]
    ds_read_b64_tr_b16 a[16:17], v18 offset:32768
    buffer_load_dwordx4 v12, s[28:31], s74 offen offset:3072 lds
    v_mfma_f32_16x16x32_bf16 a[84:87], a[36:39], a[156:159], a[84:87]
    ds_read_b64_tr_b16 a[18:19], v18 offset:34816
    s_waitcnt lgkmcnt(10)
    v_mfma_f32_16x16x32_bf16 a[88:91], a[40:43], a[224:227], a[88:91]
    ds_read_b64_tr_b16 a[20:21], v18 offset:40960
    v_accvgpr_read_b32 v193, a65
    v_mfma_f32_16x16x32_bf16 a[88:91], a[44:47], a[232:235], a[88:91]
    ds_read_b64_tr_b16 a[22:23], v18 offset:43008
    v_accvgpr_read_b32 v194, a66
    v_accvgpr_read_b32 v195, a67
    v_mfma_f32_16x16x32_bf16 a[92:95], a[40:43], a[228:231], a[92:95]
    ds_read_b64_tr_b16 a[24:25], v19 offset:32768
    v_cvt_pk_bf16_f32 v188, v188, v189
    v_mfma_f32_16x16x32_bf16 a[92:95], a[44:47], a[236:239], a[92:95]
    ds_read_b64_tr_b16 a[26:27], v19 offset:34816
    v_cvt_pk_bf16_f32 v189, v190, v191
    v_mfma_f32_16x16x32_bf16 a[96:99], a[48:51], a[224:227], a[96:99]
    ds_read_b64_tr_b16 a[28:29], v19 offset:40960
    v_cvt_pk_bf16_f32 v190, v192, v193
    v_cvt_pk_bf16_f32 v191, v194, v195
    v_mfma_f32_16x16x32_bf16 a[96:99], a[52:55], a[232:235], a[96:99]
    ds_read_b64_tr_b16 a[30:31], v19 offset:43008
    buffer_store_dwordx4 v[188:191], v13, s[20:23], s61 offen sc1
    v_mfma_f32_16x16x32_bf16 a[100:103], a[48:51], a[228:231], a[100:103]
    ds_read_b64_tr_b16 a[32:33], v20 offset:32768
    v_accvgpr_read_b32 v196, a60
    v_mfma_f32_16x16x32_bf16 a[100:103], a[52:55], a[236:239], a[100:103]
    ds_read_b64_tr_b16 a[34:35], v20 offset:34816
    s_waitcnt lgkmcnt(10)
    v_mfma_f32_16x16x32_bf16 a[104:107], a[0:3], a[224:227], a[104:107]
    ds_read_b64_tr_b16 a[36:37], v20 offset:40960
    v_accvgpr_read_b32 v197, a61
    v_accvgpr_read_b32 v198, a62
    v_mfma_f32_16x16x32_bf16 a[104:107], a[4:7], a[232:235], a[104:107]
    ds_read_b64_tr_b16 a[38:39], v20 offset:43008
    v_accvgpr_read_b32 v199, a63
    v_mfma_f32_16x16x32_bf16 a[108:111], a[0:3], a[228:231], a[108:111]
    ds_read_b64_tr_b16 a[40:41], v21 offset:32768
    v_accvgpr_read_b32 v200, a68
    v_mfma_f32_16x16x32_bf16 a[108:111], a[4:7], a[236:239], a[108:111]
    ds_read_b64_tr_b16 a[42:43], v21 offset:34816
    v_accvgpr_read_b32 v201, a69
    v_accvgpr_read_b32 v202, a70
    v_mfma_f32_16x16x32_bf16 a[112:115], a[8:11], a[224:227], a[112:115]
    ds_read_b64_tr_b16 a[44:45], v21 offset:40960
    v_accvgpr_read_b32 v203, a71
    v_mfma_f32_16x16x32_bf16 a[112:115], a[12:15], a[232:235], a[112:115]
    ds_read_b64_tr_b16 a[46:47], v21 offset:43008
    v_cvt_pk_bf16_f32 v196, v196, v197
    v_mfma_f32_16x16x32_bf16 a[116:119], a[8:11], a[228:231], a[116:119]
    ds_read_b64_tr_b16 a[48:49], v18 offset:49152
    v_cvt_pk_bf16_f32 v197, v198, v199
    v_mfma_f32_16x16x32_bf16 a[116:119], a[12:15], a[236:239], a[116:119]
    ds_read_b64_tr_b16 a[50:51], v18 offset:51200
    v_cvt_pk_bf16_f32 v198, v200, v201
    s_waitcnt lgkmcnt(10)
    v_mfma_f32_16x16x32_bf16 a[88:91], a[16:19], a[128:131], a[88:91]
    ds_read_b64_tr_b16 a[52:53], v18 offset:57344
    v_cvt_pk_bf16_f32 v199, v202, v203
    v_mfma_f32_16x16x32_bf16 a[88:91], a[20:23], a[136:139], a[88:91]
    ds_read_b64_tr_b16 a[54:55], v18 offset:59392
    buffer_store_dwordx4 v[196:199], v13, s[20:23], s61 offen offset:1024 sc1
    v_mfma_f32_16x16x32_bf16 a[92:95], a[16:19], a[132:135], a[92:95]
    ds_read_b64_tr_b16 a[0:1], v19 offset:49152
    v_accvgpr_read_b32 v188, a72
    v_mfma_f32_16x16x32_bf16 a[92:95], a[20:23], a[140:143], a[92:95]
    ds_read_b64_tr_b16 a[2:3], v19 offset:51200
    v_accvgpr_read_b32 v189, a73
    v_mfma_f32_16x16x32_bf16 a[96:99], a[24:27], a[128:131], a[96:99]
    ds_read_b64_tr_b16 a[4:5], v19 offset:57344
    v_accvgpr_read_b32 v190, a74
    v_mfma_f32_16x16x32_bf16 a[96:99], a[28:31], a[136:139], a[96:99]
    ds_read_b64_tr_b16 a[6:7], v19 offset:59392
    v_accvgpr_read_b32 v191, a75
    v_mfma_f32_16x16x32_bf16 a[100:103], a[24:27], a[132:135], a[100:103]
    ds_read_b64_tr_b16 a[8:9], v20 offset:49152
    v_accvgpr_read_b32 v192, a80
    v_mfma_f32_16x16x32_bf16 a[100:103], a[28:31], a[140:143], a[100:103]
    ds_read_b64_tr_b16 a[10:11], v20 offset:51200
    v_accvgpr_read_b32 v193, a81
    s_waitcnt lgkmcnt(10)
    v_mfma_f32_16x16x32_bf16 a[104:107], a[32:35], a[128:131], a[104:107]
    ds_read_b64_tr_b16 a[12:13], v20 offset:57344
    v_accvgpr_read_b32 v194, a82
    v_mfma_f32_16x16x32_bf16 a[104:107], a[36:39], a[136:139], a[104:107]
    ds_read_b64_tr_b16 a[14:15], v20 offset:59392
    v_accvgpr_read_b32 v195, a83
    v_mfma_f32_16x16x32_bf16 a[108:111], a[32:35], a[132:135], a[108:111]
    ds_read_b64_tr_b16 a[16:17], v21 offset:49152
    v_cvt_pk_bf16_f32 v188, v188, v189
    v_mfma_f32_16x16x32_bf16 a[108:111], a[36:39], a[140:143], a[108:111]
    ds_read_b64_tr_b16 a[18:19], v21 offset:51200
    v_cvt_pk_bf16_f32 v189, v190, v191
    v_mfma_f32_16x16x32_bf16 a[112:115], a[40:43], a[128:131], a[112:115]
    ds_read_b64_tr_b16 a[20:21], v21 offset:57344
    v_cvt_pk_bf16_f32 v190, v192, v193
    v_mfma_f32_16x16x32_bf16 a[112:115], a[44:47], a[136:139], a[112:115]
    ds_read_b64_tr_b16 a[22:23], v21 offset:59392
    v_cvt_pk_bf16_f32 v191, v194, v195
    v_mfma_f32_16x16x32_bf16 a[116:119], a[40:43], a[132:135], a[116:119]
    ds_read_b64_tr_b16 a[24:25], v0
    buffer_store_dwordx4 v[188:191], v13, s[20:23], s61 offen offset:2048 sc1
    v_mfma_f32_16x16x32_bf16 a[116:119], a[44:47], a[140:143], a[116:119]
    ds_read_b64_tr_b16 a[26:27], v0 offset:2048
    v_accvgpr_read_b32 v196, a76
    s_waitcnt lgkmcnt(10)
    v_mfma_f32_16x16x32_bf16 a[88:91], a[48:51], a[240:243], a[88:91]
    ds_read_b64_tr_b16 a[28:29], v0 offset:8192
    v_accvgpr_read_b32 v197, a77
    v_mfma_f32_16x16x32_bf16 a[88:91], a[52:55], a[248:251], a[88:91]
    ds_read_b64_tr_b16 a[30:31], v0 offset:10240
    v_accvgpr_read_b32 v198, a78
    v_mfma_f32_16x16x32_bf16 a[92:95], a[48:51], a[244:247], a[92:95]
    ds_read_b64_tr_b16 a[32:33], v1
    v_accvgpr_read_b32 v199, a79
    v_mfma_f32_16x16x32_bf16 a[92:95], a[52:55], a[252:255], a[92:95]
    ds_read_b64_tr_b16 a[34:35], v1 offset:2048
    v_accvgpr_read_b32 v200, a84
    v_mfma_f32_16x16x32_bf16 a[96:99], a[0:3], a[240:243], a[96:99]
    ds_read_b64_tr_b16 a[36:37], v1 offset:8192
    v_accvgpr_read_b32 v201, a85
    v_mfma_f32_16x16x32_bf16 a[96:99], a[4:7], a[248:251], a[96:99]
    ds_read_b64_tr_b16 a[38:39], v1 offset:10240
    v_accvgpr_read_b32 v202, a86
    v_mfma_f32_16x16x32_bf16 a[100:103], a[0:3], a[244:247], a[100:103]
    ds_read_b64_tr_b16 a[40:41], v8
    v_accvgpr_read_b32 v203, a87
    v_mfma_f32_16x16x32_bf16 a[100:103], a[4:7], a[252:255], a[100:103]
    ds_read_b64_tr_b16 a[42:43], v8 offset:2048
    v_cvt_pk_bf16_f32 v196, v196, v197
    s_waitcnt lgkmcnt(10)
    v_mfma_f32_16x16x32_bf16 a[104:107], a[8:11], a[240:243], a[104:107]
    ds_read_b64_tr_b16 a[44:45], v8 offset:8192
    v_cvt_pk_bf16_f32 v197, v198, v199
    v_mfma_f32_16x16x32_bf16 a[104:107], a[12:15], a[248:251], a[104:107]
    ds_read_b64_tr_b16 a[46:47], v8 offset:10240
    v_cvt_pk_bf16_f32 v198, v200, v201
    v_mfma_f32_16x16x32_bf16 a[108:111], a[8:11], a[244:247], a[108:111]
    ds_read_b64_tr_b16 a[48:49], v31
    v_cvt_pk_bf16_f32 v199, v202, v203
    v_mfma_f32_16x16x32_bf16 a[108:111], a[12:15], a[252:255], a[108:111]
    ds_read_b64_tr_b16 a[50:51], v31 offset:2048
    buffer_store_dwordx4 v[196:199], v13, s[20:23], s61 offen offset:3072 sc1
    v_mfma_f32_16x16x32_bf16 a[112:115], a[16:19], a[240:243], a[112:115]
    ds_read_b64_tr_b16 a[52:53], v31 offset:8192
    v_mfma_f32_16x16x32_bf16 a[112:115], a[20:23], a[248:251], a[112:115]
    ds_read_b64_tr_b16 a[54:55], v31 offset:10240
    s_barrier
    v_mfma_f32_16x16x32_bf16 a[116:119], a[16:19], a[244:247], a[116:119]
    ds_read_b64_tr_b16 a[0:1], v18 offset:20480
    s_add_u32 m0, s59, 147456
    v_mfma_f32_16x16x32_bf16 a[116:119], a[20:23], a[252:255], a[116:119]
    ds_read_b64_tr_b16 a[2:3], v18 offset:22528
    s_waitcnt lgkmcnt(10)
    v_mfma_f32_16x16x32_bf16 a[88:91], a[24:27], a[144:147], a[88:91]
    ds_read_b64_tr_b16 a[4:5], v18 offset:28672
    s_add_u32 s74, s55, 1310720
    v_mfma_f32_16x16x32_bf16 a[88:91], a[28:31], a[152:155], a[88:91]
    ds_read_b64_tr_b16 a[6:7], v18 offset:30720
    buffer_load_dwordx4 v9, s[28:31], s74 offen lds
    v_mfma_f32_16x16x32_bf16 a[92:95], a[24:27], a[148:151], a[92:95]
    ds_read_b64_tr_b16 a[8:9], v19 offset:20480
    v_mfma_f32_16x16x32_bf16 a[92:95], a[28:31], a[156:159], a[92:95]
    ds_read_b64_tr_b16 a[10:11], v19 offset:22528
    v_mfma_f32_16x16x32_bf16 a[96:99], a[32:35], a[144:147], a[96:99]
    ds_read_b64_tr_b16 a[12:13], v19 offset:28672
    buffer_load_dwordx4 v10, s[28:31], s74 offen offset:1024 lds
    v_mfma_f32_16x16x32_bf16 a[96:99], a[36:39], a[152:155], a[96:99]
    ds_read_b64_tr_b16 a[14:15], v19 offset:30720
    s_waitcnt vmcnt(18)
    v_mfma_f32_16x16x32_bf16 a[100:103], a[32:35], a[148:151], a[100:103]
    ds_read_b64_tr_b16 a[16:17], v20 offset:20480
    v_accvgpr_mov_b32 a120, a194
    v_mfma_f32_16x16x32_bf16 a[100:103], a[36:39], a[156:159], a[100:103]
    ds_read_b64_tr_b16 a[18:19], v20 offset:22528
    s_waitcnt lgkmcnt(10)
    v_mfma_f32_16x16x32_bf16 a[104:107], a[40:43], a[144:147], a[104:107]
    ds_read_b64_tr_b16 a[20:21], v20 offset:28672
    v_accvgpr_mov_b32 a121, a195
    s_add_u32 s61, s62, 4096
    v_mfma_f32_16x16x32_bf16 a[104:107], a[44:47], a[152:155], a[104:107]
    ds_read_b64_tr_b16 a[22:23], v20 offset:30720
    buffer_load_dwordx4 v11, s[28:31], s74 offen offset:2048 lds
    v_accvgpr_read_b32 v188, a88
    v_mfma_f32_16x16x32_bf16 a[108:111], a[40:43], a[148:151], a[108:111]
    ds_read_b64_tr_b16 a[24:25], v21 offset:20480
    v_accvgpr_mov_b32 a194, a196
    v_accvgpr_read_b32 v189, a89
    v_mfma_f32_16x16x32_bf16 a[108:111], a[44:47], a[156:159], a[108:111]
    ds_read_b64_tr_b16 a[26:27], v21 offset:22528
    v_accvgpr_mov_b32 a195, a197
    v_accvgpr_read_b32 v190, a90
    v_mfma_f32_16x16x32_bf16 a[112:115], a[48:51], a[144:147], a[112:115]
    ds_read_b64_tr_b16 a[28:29], v21 offset:28672
    v_accvgpr_mov_b32 a196, a120
    v_accvgpr_read_b32 v191, a91
    v_mfma_f32_16x16x32_bf16 a[112:115], a[52:55], a[152:155], a[112:115]
    ds_read_b64_tr_b16 a[30:31], v21 offset:30720
    buffer_load_dwordx4 v12, s[28:31], s74 offen offset:3072 lds
    v_accvgpr_read_b32 v192, a96
    v_mfma_f32_16x16x32_bf16 a[116:119], a[48:51], a[148:151], a[116:119]
    ds_read_b64_tr_b16 a[32:33], v18 offset:36864
    v_accvgpr_mov_b32 a197, a121
    v_accvgpr_read_b32 v193, a97
    v_mfma_f32_16x16x32_bf16 a[116:119], a[52:55], a[156:159], a[116:119]
    ds_read_b64_tr_b16 a[34:35], v18 offset:38912
    v_accvgpr_read_b32 v194, a98
    s_waitcnt lgkmcnt(10)
    v_mfma_f32_16x16x32_bf16 v[128:131], a[0:3], a[160:163], v[128:131]
    ds_read_b64_tr_b16 a[36:37], v18 offset:45056
    v_accvgpr_mov_b32 a120, a202
    v_accvgpr_read_b32 v195, a99
    v_mfma_f32_16x16x32_bf16 v[128:131], a[4:7], a[168:171], v[128:131]
    ds_read_b64_tr_b16 a[38:39], v18 offset:47104
    v_accvgpr_mov_b32 a121, a203
    v_cvt_pk_bf16_f32 v188, v188, v189
    v_mfma_f32_16x16x32_bf16 v[132:135], a[0:3], a[164:167], v[132:135]
    ds_read_b64_tr_b16 a[40:41], v19 offset:36864
    v_accvgpr_mov_b32 a202, a204
    v_cvt_pk_bf16_f32 v189, v190, v191
    v_mfma_f32_16x16x32_bf16 v[132:135], a[4:7], a[172:175], v[132:135]
    ds_read_b64_tr_b16 a[42:43], v19 offset:38912
    v_accvgpr_mov_b32 a203, a205
    v_mfma_f32_16x16x32_bf16 v[136:139], a[8:11], a[160:163], v[136:139]
    ds_read_b64_tr_b16 a[44:45], v19 offset:45056
    v_accvgpr_mov_b32 a204, a120
    v_cvt_pk_bf16_f32 v190, v192, v193
    v_mfma_f32_16x16x32_bf16 v[136:139], a[12:15], a[168:171], v[136:139]
    ds_read_b64_tr_b16 a[46:47], v19 offset:47104
    v_cvt_pk_bf16_f32 v191, v194, v195
    v_mfma_f32_16x16x32_bf16 v[140:143], a[8:11], a[164:167], v[140:143]
    ds_read_b64_tr_b16 a[48:49], v20 offset:36864
    v_accvgpr_mov_b32 a205, a121
    v_mfma_f32_16x16x32_bf16 v[140:143], a[12:15], a[172:175], v[140:143]
    ds_read_b64_tr_b16 a[50:51], v20 offset:38912
    buffer_store_dwordx4 v[188:191], v13, s[20:23], s61 offen sc1
    v_accvgpr_read_b32 v196, a92
    s_waitcnt lgkmcnt(10)
    v_mfma_f32_16x16x32_bf16 v[144:147], a[16:19], a[160:163], v[144:147]
    ds_read_b64_tr_b16 a[52:53], v20 offset:45056
    s_waitcnt vmcnt(17)
    v_accvgpr_read_b32 v197, a93
    v_mfma_f32_16x16x32_bf16 v[144:147], a[20:23], a[168:171], v[144:147]
    ds_read_b64_tr_b16 a[54:55], v20 offset:47104
    v_accvgpr_mov_b32 a120, a210
    v_accvgpr_read_b32 v198, a94
    v_mfma_f32_16x16x32_bf16 v[148:151], a[16:19], a[164:167], v[148:151]
    ds_read_b64_tr_b16 a[0:1], v21 offset:36864
    v_accvgpr_read_b32 v199, a95
    v_mfma_f32_16x16x32_bf16 v[148:151], a[20:23], a[172:175], v[148:151]
    ds_read_b64_tr_b16 a[2:3], v21 offset:38912
    v_accvgpr_mov_b32 a121, a211
    v_accvgpr_read_b32 v200, a100
    v_mfma_f32_16x16x32_bf16 v[152:155], a[24:27], a[160:163], v[152:155]
    ds_read_b64_tr_b16 a[4:5], v21 offset:45056
    v_accvgpr_mov_b32 a210, a212
    v_accvgpr_read_b32 v201, a101
    v_mfma_f32_16x16x32_bf16 v[152:155], a[28:31], a[168:171], v[152:155]
    ds_read_b64_tr_b16 a[6:7], v21 offset:47104
    v_accvgpr_read_b32 v202, a102
    v_mfma_f32_16x16x32_bf16 v[156:159], a[24:27], a[164:167], v[156:159]
    ds_read_b64_tr_b16 a[8:9], v18 offset:53248
    v_accvgpr_mov_b32 a211, a213
    v_accvgpr_read_b32 v203, a103
    v_mfma_f32_16x16x32_bf16 v[156:159], a[28:31], a[172:175], v[156:159]
    ds_read_b64_tr_b16 a[10:11], v18 offset:55296
    s_waitcnt lgkmcnt(10)
    v_mfma_f32_16x16x32_bf16 v[128:131], a[32:35], a[176:179], v[128:131]
    ds_read_b64_tr_b16 a[12:13], v18 offset:61440
    v_accvgpr_mov_b32 a212, a120
    v_cvt_pk_bf16_f32 v196, v196, v197
    v_mfma_f32_16x16x32_bf16 v[128:131], a[36:39], a[184:187], v[128:131]
    ds_read_b64_tr_b16 a[14:15], v18 offset:63488
    v_accvgpr_mov_b32 a213, a121
    v_cvt_pk_bf16_f32 v197, v198, v199
    v_mfma_f32_16x16x32_bf16 v[132:135], a[32:35], a[180:183], v[132:135]
    ds_read_b64_tr_b16 a[16:17], v19 offset:53248
    v_accvgpr_mov_b32 a120, a218
    v_cvt_pk_bf16_f32 v198, v200, v201
    v_mfma_f32_16x16x32_bf16 v[132:135], a[36:39], a[188:191], v[132:135]
    ds_read_b64_tr_b16 a[18:19], v19 offset:55296
    v_cvt_pk_bf16_f32 v199, v202, v203
    v_mfma_f32_16x16x32_bf16 v[136:139], a[40:43], a[176:179], v[136:139]
    ds_read_b64_tr_b16 a[20:21], v19 offset:61440
    v_accvgpr_mov_b32 a121, a219
    v_mfma_f32_16x16x32_bf16 v[136:139], a[44:47], a[184:187], v[136:139]
    ds_read_b64_tr_b16 a[22:23], v19 offset:63488
    v_accvgpr_mov_b32 a218, a220
    v_mfma_f32_16x16x32_bf16 v[140:143], a[40:43], a[180:183], v[140:143]
    ds_read_b64_tr_b16 a[24:25], v20 offset:53248
    buffer_store_dwordx4 v[196:199], v13, s[20:23], s61 offen offset:1024 sc1
    v_accvgpr_read_b32 v188, a104
    v_accvgpr_read_b32 v189, a105
    v_mfma_f32_16x16x32_bf16 v[140:143], a[44:47], a[188:191], v[140:143]
    ds_read_b64_tr_b16 a[26:27], v20 offset:55296
    v_accvgpr_read_b32 v190, a106
    s_waitcnt lgkmcnt(10)
    v_mfma_f32_16x16x32_bf16 v[144:147], a[48:51], a[176:179], v[144:147]
    ds_read_b64_tr_b16 a[28:29], v20 offset:61440
    buffer_load_dword v24, v22, s[20:23], s76 offen sc1
    v_accvgpr_read_b32 v191, a107
    v_mfma_f32_16x16x32_bf16 v[144:147], a[52:55], a[184:187], v[144:147]
    ds_read_b64_tr_b16 a[30:31], v20 offset:63488
    v_accvgpr_mov_b32 a219, a221
    v_accvgpr_read_b32 v192, a112
    v_mfma_f32_16x16x32_bf16 v[148:151], a[48:51], a[180:183], v[148:151]
    ds_read_b64_tr_b16 a[32:33], v21 offset:53248
    v_accvgpr_mov_b32 a220, a120
    v_mfma_f32_16x16x32_bf16 v[148:151], a[52:55], a[188:191], v[148:151]
    ds_read_b64_tr_b16 a[34:35], v21 offset:55296
    v_accvgpr_mov_b32 a221, a121
    v_accvgpr_read_b32 v193, a113
    v_mfma_f32_16x16x32_bf16 v[152:155], a[0:3], a[176:179], v[152:155]
    ds_read_b64_tr_b16 a[36:37], v21 offset:61440
    v_accvgpr_read_b32 v194, a114
    v_mfma_f32_16x16x32_bf16 v[152:155], a[4:7], a[184:187], v[152:155]
    ds_read_b64_tr_b16 a[38:39], v21 offset:63488
    v_accvgpr_read_b32 v195, a115
    v_mfma_f32_16x16x32_bf16 v[156:159], a[0:3], a[180:183], v[156:159]
    ds_read_b64_tr_b16 a[40:41], v0 offset:4096
    v_cvt_pk_bf16_f32 v188, v188, v189
    v_mfma_f32_16x16x32_bf16 v[156:159], a[4:7], a[188:191], v[156:159]
    ds_read_b64_tr_b16 a[42:43], v0 offset:6144
    v_cvt_pk_bf16_f32 v189, v190, v191
    s_waitcnt lgkmcnt(10)
    v_mfma_f32_16x16x32_bf16 v[128:131], a[8:11], a[192:195], v[128:131]
    ds_read_b64_tr_b16 a[44:45], v0 offset:12288
    v_cvt_pk_bf16_f32 v190, v192, v193
    v_mfma_f32_16x16x32_bf16 v[128:131], a[12:15], a[200:203], v[128:131]
    ds_read_b64_tr_b16 a[46:47], v0 offset:14336
    v_cvt_pk_bf16_f32 v191, v194, v195
    v_mfma_f32_16x16x32_bf16 v[132:135], a[8:11], a[196:199], v[132:135]
    ds_read_b64_tr_b16 a[48:49], v1 offset:4096
    buffer_store_dwordx4 v[188:191], v13, s[20:23], s61 offen offset:2048 sc1
    v_mfma_f32_16x16x32_bf16 v[132:135], a[12:15], a[204:207], v[132:135]
    ds_read_b64_tr_b16 a[50:51], v1 offset:6144
    v_accvgpr_read_b32 v196, a108
    v_mfma_f32_16x16x32_bf16 v[136:139], a[16:19], a[192:195], v[136:139]
    ds_read_b64_tr_b16 a[52:53], v1 offset:12288
    v_accvgpr_read_b32 v197, a109
    v_mfma_f32_16x16x32_bf16 v[136:139], a[20:23], a[200:203], v[136:139]
    ds_read_b64_tr_b16 a[54:55], v1 offset:14336
    v_accvgpr_read_b32 v198, a110
    v_mfma_f32_16x16x32_bf16 v[140:143], a[16:19], a[196:199], v[140:143]
    ds_read_b64_tr_b16 a[0:1], v8 offset:4096
    v_mfma_f32_16x16x32_bf16 v[140:143], a[20:23], a[204:207], v[140:143]
    ds_read_b64_tr_b16 a[2:3], v8 offset:6144
    v_accvgpr_read_b32 v199, a111
    s_waitcnt lgkmcnt(10)
    v_mfma_f32_16x16x32_bf16 v[144:147], a[24:27], a[192:195], v[144:147]
    ds_read_b64_tr_b16 a[4:5], v8 offset:12288
    v_accvgpr_read_b32 v200, a116
    v_mfma_f32_16x16x32_bf16 v[144:147], a[28:31], a[200:203], v[144:147]
    ds_read_b64_tr_b16 a[6:7], v8 offset:14336
    v_accvgpr_read_b32 v201, a117
    v_mfma_f32_16x16x32_bf16 v[148:151], a[24:27], a[196:199], v[148:151]
    ds_read_b64_tr_b16 a[8:9], v31 offset:4096
    v_accvgpr_read_b32 v202, a118
    v_mfma_f32_16x16x32_bf16 v[148:151], a[28:31], a[204:207], v[148:151]
    ds_read_b64_tr_b16 a[10:11], v31 offset:6144
    v_accvgpr_read_b32 v203, a119
    v_mfma_f32_16x16x32_bf16 v[152:155], a[32:35], a[192:195], v[152:155]
    ds_read_b64_tr_b16 a[12:13], v31 offset:12288
    v_cvt_pk_bf16_f32 v196, v196, v197
    v_mfma_f32_16x16x32_bf16 v[152:155], a[36:39], a[200:203], v[152:155]
    ds_read_b64_tr_b16 a[14:15], v31 offset:14336
    v_cvt_pk_bf16_f32 v197, v198, v199
    v_mfma_f32_16x16x32_bf16 v[156:159], a[32:35], a[196:199], v[156:159]
    ds_read_b64_tr_b16 a[16:17], v18 offset:16384
    s_waitcnt vmcnt(8)
    v_accvgpr_write_b32 a124, 1
    s_mov_b64 exec, 1
    buffer_store_dword a124, off, s[20:23], s84 sc1
    s_mov_b64 exec, -1
    v_cvt_pk_bf16_f32 v198, v200, v201
    v_mfma_f32_16x16x32_bf16 v[156:159], a[36:39], a[204:207], v[156:159]
    ds_read_b64_tr_b16 a[18:19], v18 offset:18432
    v_cvt_pk_bf16_f32 v199, v202, v203
    s_waitcnt lgkmcnt(10)
    v_mfma_f32_16x16x32_bf16 v[128:131], a[40:43], a[208:211], v[128:131]
    ds_read_b64_tr_b16 a[20:21], v18 offset:24576
    buffer_store_dwordx4 v[196:199], v13, s[20:23], s61 offen offset:3072 sc1
    v_mfma_f32_16x16x32_bf16 v[128:131], a[44:47], a[216:219], v[128:131]
    ds_read_b64_tr_b16 a[22:23], v18 offset:26624
    v_mfma_f32_16x16x32_bf16 v[132:135], a[40:43], a[212:215], v[132:135]
    ds_read_b64_tr_b16 a[24:25], v19 offset:16384
    v_mfma_f32_16x16x32_bf16 v[132:135], a[44:47], a[220:223], v[132:135]
    ds_read_b64_tr_b16 a[26:27], v19 offset:18432
    v_mfma_f32_16x16x32_bf16 v[136:139], a[48:51], a[208:211], v[136:139]
    ds_read_b64_tr_b16 a[28:29], v19 offset:24576
    v_mfma_f32_16x16x32_bf16 v[136:139], a[52:55], a[216:219], v[136:139]
    ds_read_b64_tr_b16 a[30:31], v19 offset:26624
    v_mfma_f32_16x16x32_bf16 v[140:143], a[48:51], a[212:215], v[140:143]
    ds_read_b64_tr_b16 a[32:33], v20 offset:16384
    v_mfma_f32_16x16x32_bf16 v[140:143], a[52:55], a[220:223], v[140:143]
    ds_read_b64_tr_b16 a[34:35], v20 offset:18432
    s_waitcnt lgkmcnt(10)
    v_mfma_f32_16x16x32_bf16 v[144:147], a[0:3], a[208:211], v[144:147]
    ds_read_b64_tr_b16 a[36:37], v20 offset:24576
    s_xor_b32 s61, s54, 128
    v_mfma_f32_16x16x32_bf16 v[144:147], a[4:7], a[216:219], v[144:147]
    ds_read_b64_tr_b16 a[38:39], v20 offset:26624
    v_cvt_pk_bf16_f32 v128, v128, v129
    v_mfma_f32_16x16x32_bf16 v[148:151], a[0:3], a[212:215], v[148:151]
    ds_read_b64_tr_b16 a[40:41], v21 offset:16384
    v_cvt_pk_bf16_f32 v129, v130, v131
    v_mfma_f32_16x16x32_bf16 v[148:151], a[4:7], a[220:223], v[148:151]
    ds_read_b64_tr_b16 a[42:43], v21 offset:18432
    v_cvt_pk_bf16_f32 v130, v136, v137
    v_mfma_f32_16x16x32_bf16 v[152:155], a[8:11], a[208:211], v[152:155]
    ds_read_b64_tr_b16 a[44:45], v21 offset:24576
    v_cvt_pk_bf16_f32 v131, v138, v139
    v_mfma_f32_16x16x32_bf16 v[152:155], a[12:15], a[216:219], v[152:155]
    ds_read_b64_tr_b16 a[46:47], v21 offset:26624
    buffer_store_dwordx4 v[128:131], v9, s[32:35], s61 offen sc1
    v_mfma_f32_16x16x32_bf16 v[156:159], a[8:11], a[212:215], v[156:159]
    ds_read_b64_tr_b16 a[48:49], v18 offset:32768
    v_cvt_pk_bf16_f32 v132, v132, v133
    v_mfma_f32_16x16x32_bf16 v[156:159], a[12:15], a[220:223], v[156:159]
    ds_read_b64_tr_b16 a[50:51], v18 offset:34816
    s_waitcnt lgkmcnt(10)
    v_mfma_f32_16x16x32_bf16 v[96:99], a[16:19], a[160:163], v[96:99]
    ds_read_b64_tr_b16 a[52:53], v18 offset:40960
    v_cvt_pk_bf16_f32 v133, v134, v135
    v_mfma_f32_16x16x32_bf16 v[96:99], a[20:23], a[168:171], v[96:99]
    ds_read_b64_tr_b16 a[54:55], v18 offset:43008
    v_cvt_pk_bf16_f32 v134, v140, v141
    v_mfma_f32_16x16x32_bf16 v[100:103], a[16:19], a[164:167], v[100:103]
    ds_read_b64_tr_b16 a[0:1], v19 offset:32768
    v_cvt_pk_bf16_f32 v135, v142, v143
    v_mfma_f32_16x16x32_bf16 v[100:103], a[20:23], a[172:175], v[100:103]
    ds_read_b64_tr_b16 a[2:3], v19 offset:34816
    buffer_store_dwordx4 v[132:135], v10, s[32:35], s61 offen offset:1024 sc1
    v_mfma_f32_16x16x32_bf16 v[104:107], a[24:27], a[160:163], v[104:107]
    ds_read_b64_tr_b16 a[4:5], v19 offset:40960
    s_waitcnt vmcnt(5)
    v_cmp_le_u32 vcc, 1, v24
    s_nop 0
    s_cmp_eq_u64 vcc, -1
    s_cbranch_scc0 L_pob_spin
L_pob_ok:
    v_mfma_f32_16x16x32_bf16 v[104:107], a[28:31], a[168:171], v[104:107]
    ds_read_b64_tr_b16 a[6:7], v19 offset:43008
    s_add_u32 s75, s57, 0
    v_mfma_f32_16x16x32_bf16 v[108:111], a[24:27], a[164:167], v[108:111]
    ds_read_b64_tr_b16 a[8:9], v20 offset:32768
    buffer_load_dwordx4 a[224:227], v13, s[20:23], s75 offen sc1
    v_mfma_f32_16x16x32_bf16 v[108:111], a[28:31], a[172:175], v[108:111]
    ds_read_b64_tr_b16 a[10:11], v20 offset:34816
    s_waitcnt lgkmcnt(10)
    v_mfma_f32_16x16x32_bf16 v[112:115], a[32:35], a[160:163], v[112:115]
    ds_read_b64_tr_b16 a[12:13], v20 offset:40960
    v_cvt_pk_bf16_f32 v144, v144, v145
    v_mfma_f32_16x16x32_bf16 v[112:115], a[36:39], a[168:171], v[112:115]
    ds_read_b64_tr_b16 a[14:15], v20 offset:43008
    buffer_load_dwordx4 a[228:231], v13, s[20:23], s75 offen offset:1024 sc1
    v_mfma_f32_16x16x32_bf16 v[116:119], a[32:35], a[164:167], v[116:119]
    ds_read_b64_tr_b16 a[16:17], v21 offset:32768
    v_cvt_pk_bf16_f32 v145, v146, v147
    v_mfma_f32_16x16x32_bf16 v[116:119], a[36:39], a[172:175], v[116:119]
L_pad1_14:
    s_cbranch_execz L_pad1_18
    ds_read_b64_tr_b16 a[18:19], v21 offset:34816
    v_cvt_pk_bf16_f32 v146, v152, v153
    v_mfma_f32_16x16x32_bf16 v[120:123], a[40:43], a[160:163], v[120:123]
    ds_read_b64_tr_b16 a[20:21], v21 offset:40960
    buffer_load_dwordx4 a[232:235], v13, s[20:23], s75 offen offset:2048 sc1
    v_mfma_f32_16x16x32_bf16 v[120:123], a[44:47], a[168:171], v[120:123]
    ds_read_b64_tr_b16 a[22:23], v21 offset:43008
    v_cvt_pk_bf16_f32 v147, v154, v155
    v_mfma_f32_16x16x32_bf16 v[124:127], a[40:43], a[164:167], v[124:127]
    ds_read_b64_tr_b16 a[24:25], v18 offset:49152
    buffer_store_dwordx4 v[144:147], v11, s[32:35], s61 offen offset:2048 sc1
    v_mfma_f32_16x16x32_bf16 v[124:127], a[44:47], a[172:175], v[124:127]
    ds_read_b64_tr_b16 a[26:27], v18 offset:51200
    s_waitcnt lgkmcnt(10)
    v_mfma_f32_16x16x32_bf16 v[96:99], a[48:51], a[176:179], v[96:99]
    ds_read_b64_tr_b16 a[28:29], v18 offset:57344
    buffer_load_dwordx4 a[236:239], v13, s[20:23], s75 offen offset:3072 sc1
    v_mfma_f32_16x16x32_bf16 v[96:99], a[52:55], a[184:187], v[96:99]
    ds_read_b64_tr_b16 a[30:31], v18 offset:59392
    s_add_u32 s75, s57, 262144
    v_mfma_f32_16x16x32_bf16 v[100:103], a[48:51], a[180:183], v[100:103]
    ds_read_b64_tr_b16 a[32:33], v19 offset:49152
    buffer_load_dwordx4 a[128:131], v13, s[20:23], s75 offen sc1
    v_mfma_f32_16x16x32_bf16 v[100:103], a[52:55], a[188:191], v[100:103]
    ds_read_b64_tr_b16 a[34:35], v19 offset:51200
    v_cvt_pk_bf16_f32 v148, v148, v149
    v_mfma_f32_16x16x32_bf16 v[104:107], a[0:3], a[176:179], v[104:107]
    ds_read_b64_tr_b16 a[36:37], v19 offset:57344
    v_cvt_pk_bf16_f32 v149, v150, v151
    v_mfma_f32_16x16x32_bf16 v[104:107], a[4:7], a[184:187], v[104:107]
    ds_read_b64_tr_b16 a[38:39], v19 offset:59392
    buffer_load_dwordx4 a[132:135], v13, s[20:23], s75 offen offset:1024 sc1
    v_mfma_f32_16x16x32_bf16 v[108:111], a[0:3], a[180:183], v[108:111]
    ds_read_b64_tr_b16 a[40:41], v20 offset:49152
    v_cvt_pk_bf16_f32 v150, v156, v157
    v_mfma_f32_16x16x32_bf16 v[108:111], a[4:7], a[188:191], v[108:111]
    ds_read_b64_tr_b16 a[42:43], v20 offset:51200
    s_waitcnt lgkmcnt(10)
    v_mfma_f32_16x16x32_bf16 v[112:115], a[8:11], a[176:179], v[112:115]
    ds_read_b64_tr_b16 a[44:45], v20 offset:57344
    buffer_load_dwordx4 a[136:139], v13, s[20:23], s75 offen offset:2048 sc1
    v_mfma_f32_16x16x32_bf16 v[112:115], a[12:15], a[184:187], v[112:115]
    ds_read_b64_tr_b16 a[46:47], v20 offset:59392
    v_cvt_pk_bf16_f32 v151, v158, v159
    v_mfma_f32_16x16x32_bf16 v[116:119], a[8:11], a[180:183], v[116:119]
    ds_read_b64_tr_b16 a[48:49], v21 offset:49152
    buffer_store_dwordx4 v[148:151], v12, s[32:35], s61 offen offset:3072 sc1
    v_mfma_f32_16x16x32_bf16 v[116:119], a[12:15], a[188:191], v[116:119]
    ds_read_b64_tr_b16 a[50:51], v21 offset:51200
    buffer_load_dwordx4 a[140:143], v13, s[20:23], s75 offen offset:3072 sc1
    v_mfma_f32_16x16x32_bf16 v[120:123], a[16:19], a[176:179], v[120:123]
    ds_read_b64_tr_b16 a[52:53], v21 offset:57344
    v_mfma_f32_16x16x32_bf16 v[120:123], a[20:23], a[184:187], v[120:123]
    ds_read_b64_tr_b16 a[54:55], v21 offset:59392
    s_add_u32 s75, s57, 524288
    v_mfma_f32_16x16x32_bf16 v[124:127], a[16:19], a[180:183], v[124:127]
    ds_read_b64_tr_b16 a[0:1], v0
    buffer_load_dwordx4 a[240:243], v13, s[20:23], s75 offen sc1
    v_mfma_f32_16x16x32_bf16 v[124:127], a[20:23], a[188:191], v[124:127]
    ds_read_b64_tr_b16 a[2:3], v0 offset:2048
    s_xor_b32 s77, s84, 768
    s_waitcnt lgkmcnt(10)
    v_mfma_f32_16x16x32_bf16 v[96:99], a[24:27], a[192:195], v[96:99]
    ds_read_b64_tr_b16 a[4:5], v0 offset:8192
    buffer_load_dword v25, off, s[20:23], s77 sc1
    v_mfma_f32_16x16x32_bf16 v[96:99], a[28:31], a[200:203], v[96:99]
    ds_read_b64_tr_b16 a[6:7], v0 offset:10240
    buffer_load_dwordx4 a[244:247], v13, s[20:23], s75 offen offset:1024 sc1
    v_mfma_f32_16x16x32_bf16 v[100:103], a[24:27], a[196:199], v[100:103]
    ds_read_b64_tr_b16 a[8:9], v1
    v_mfma_f32_16x16x32_bf16 v[100:103], a[28:31], a[204:207], v[100:103]
    ds_read_b64_tr_b16 a[10:11], v1 offset:2048
    v_mfma_f32_16x16x32_bf16 v[104:107], a[32:35], a[192:195], v[104:107]
    ds_read_b64_tr_b16 a[12:13], v1 offset:8192
    buffer_load_dwordx4 a[248:251], v13, s[20:23], s75 offen offset:2048 sc1
    v_mfma_f32_16x16x32_bf16 v[104:107], a[36:39], a[200:203], v[104:107]
    ds_read_b64_tr_b16 a[14:15], v1 offset:10240
    v_mfma_f32_16x16x32_bf16 v[108:111], a[32:35], a[196:199], v[108:111]
    ds_read_b64_tr_b16 a[16:17], v8
    v_mfma_f32_16x16x32_bf16 v[108:111], a[36:39], a[204:207], v[108:111]
    ds_read_b64_tr_b16 a[18:19], v8 offset:2048
    s_waitcnt lgkmcnt(10)
    v_mfma_f32_16x16x32_bf16 v[112:115], a[40:43], a[192:195], v[112:115]
    ds_read_b64_tr_b16 a[20:21], v8 offset:8192
    buffer_load_dwordx4 a[252:255], v13, s[20:23], s75 offen offset:3072 sc1
    v_mfma_f32_16x16x32_bf16 v[112:115], a[44:47], a[200:203], v[112:115]
    ds_read_b64_tr_b16 a[22:23], v8 offset:10240
    v_mfma_f32_16x16x32_bf16 v[116:119], a[40:43], a[196:199], v[116:119]
    ds_read_b64_tr_b16 a[24:25], v31
    s_add_u32 s75, s57, 786432
    v_mfma_f32_16x16x32_bf16 v[116:119], a[44:47], a[204:207], v[116:119]
    ds_read_b64_tr_b16 a[26:27], v31 offset:2048
    buffer_load_dwordx4 a[144:147], v13, s[20:23], s75 offen sc1
    v_mfma_f32_16x16x32_bf16 v[120:123], a[48:51], a[192:195], v[120:123]
    ds_read_b64_tr_b16 a[28:29], v31 offset:8192
    v_mfma_f32_16x16x32_bf16 v[120:123], a[52:55], a[200:203], v[120:123]
    ds_read_b64_tr_b16 a[30:31], v31 offset:10240
    s_barrier
    v_mfma_f32_16x16x32_bf16 v[124:127], a[48:51], a[196:199], v[124:127]
    ds_read_b64_tr_b16 a[32:33], v14
    s_waitcnt vmcnt(18)
    v_accvgpr_write_b32 a124, 2
    s_mov_b64 exec, 1
    buffer_store_dword a124, off, s[20:23], s84 sc1
    s_mov_b64 exec, -1
    v_mfma_f32_16x16x32_bf16 v[124:127], a[52:55], a[204:207], v[124:127]
    ds_read_b64_tr_b16 a[34:35], v14 offset:2048
    s_waitcnt lgkmcnt(10)
    v_mfma_f32_16x16x32_bf16 v[96:99], a[0:3], a[208:211], v[96:99]
    ds_read_b64_tr_b16 a[36:37], v14 offset:4096
    buffer_load_dwordx4 a[148:151], v13, s[20:23], s75 offen offset:1024 sc1
    v_mfma_f32_16x16x32_bf16 v[96:99], a[4:7], a[216:219], v[96:99]
    ds_read_b64_tr_b16 a[38:39], v14 offset:6144
    buffer_load_dwordx4 a[152:155], v13, s[20:23], s75 offen offset:2048 sc1
    v_mfma_f32_16x16x32_bf16 v[100:103], a[0:3], a[212:215], v[100:103]
    ds_read_b64_tr_b16 a[40:41], v15
    v_mfma_f32_16x16x32_bf16 v[100:103], a[4:7], a[220:223], v[100:103]
    ds_read_b64_tr_b16 a[42:43], v15 offset:2048
    v_mfma_f32_16x16x32_bf16 v[104:107], a[8:11], a[208:211], v[104:107]
    ds_read_b64_tr_b16 a[44:45], v15 offset:4096
    buffer_load_dwordx4 a[156:159], v13, s[20:23], s75 offen offset:3072 sc1
    v_mfma_f32_16x16x32_bf16 v[104:107], a[12:15], a[216:219], v[104:107]
    ds_read_b64_tr_b16 a[46:47], v15 offset:6144
    v_mfma_f32_16x16x32_bf16 v[108:111], a[8:11], a[212:215], v[108:111]
    ds_read_b64_tr_b16 a[48:49], v16
    s_add_u32 s75, s57, 1048576
    v_mfma_f32_16x16x32_bf16 v[108:111], a[12:15], a[220:223], v[108:111]
    ds_read_b64_tr_b16 a[50:51], v16 offset:2048
    s_waitcnt lgkmcnt(10)
    v_mfma_f32_16x16x32_bf16 v[112:115], a[16:19], a[208:211], v[112:115]
    ds_read_b64_tr_b16 a[52:53], v16 offset:4096
    buffer_load_dwordx4 a[160:163], v13, s[20:23], s75 offen sc1
    v_mfma_f32_16x16x32_bf16 v[112:115], a[20:23], a[216:219], v[112:115]
    ds_read_b64_tr_b16 a[54:55], v16 offset:6144
    v_mfma_f32_16x16x32_bf16 v[116:119], a[16:19], a[212:215], v[116:119]
    ds_read_b64_tr_b16 a[0:1], v17
    buffer_load_dwordx4 a[164:167], v13, s[20:23], s75 offen offset:1024 sc1
    v_mfma_f32_16x16x32_bf16 v[116:119], a[20:23], a[220:223], v[116:119]
    ds_read_b64_tr_b16 a[2:3], v17 offset:2048
    v_mfma_f32_16x16x32_bf16 v[120:123], a[24:27], a[208:211], v[120:123]
    ds_read_b64_tr_b16 a[4:5], v17 offset:4096
    v_mfma_f32_16x16x32_bf16 v[120:123], a[28:31], a[216:219], v[120:123]
    ds_read_b64_tr_b16 a[6:7], v17 offset:6144
    buffer_load_dwordx4 a[168:171], v13, s[20:23], s75 offen offset:2048 sc1
    v_mfma_f32_16x16x32_bf16 v[124:127], a[24:27], a[212:215], v[124:127]
    ds_read_b64_tr_b16 a[8:9], v14 offset:8192
    v_mfma_f32_16x16x32_bf16 v[124:127], a[28:31], a[220:223], v[124:127]
    ds_read_b64_tr_b16 a[10:11], v14 offset:10240
    s_waitcnt vmcnt(18) lgkmcnt(10)
    v_mfma_f32_16x16x32_bf16 v[160:163], a[32:35], a[224:227], 0
    ds_read_b64_tr_b16 a[12:13], v14 offset:12288
    buffer_load_dwordx4 a[172:175], v13, s[20:23], s75 offen offset:3072 sc1
    v_mfma_f32_16x16x32_bf16 v[160:163], a[36:39], a[232:235], v[160:163]
    ds_read_b64_tr_b16 a[14:15], v14 offset:14336
    v_mfma_f32_16x16x32_bf16 v[164:167], a[32:35], a[228:231], 0
    ds_read_b64_tr_b16 a[16:17], v15 offset:8192
    s_add_u32 s75, s57, 1310720
    v_mfma_f32_16x16x32_bf16 v[164:167], a[36:39], a[236:239], v[164:167]
    ds_read_b64_tr_b16 a[18:19], v15 offset:10240
    buffer_load_dwordx4 a[176:179], v13, s[20:23], s75 offen sc1
    v_mfma_f32_16x16x32_bf16 v[168:171], a[40:43], a[224:227], 0
    ds_read_b64_tr_b16 a[20:21], v15 offset:12288
    v_mfma_f32_16x16x32_bf16 v[168:171], a[44:47], a[232:235], v[168:171]
    ds_read_b64_tr_b16 a[22:23], v15 offset:14336
    v_mfma_f32_16x16x32_bf16 v[172:175], a[40:43], a[228:231], 0
    ds_read_b64_tr_b16 a[24:25], v16 offset:8192
    v_mfma_f32_16x16x32_bf16 v[172:175], a[44:47], a[236:239], v[172:175]
    ds_read_b64_tr_b16 a[26:27], v16 offset:10240
    s_waitcnt lgkmcnt(10)
    v_mfma_f32_16x16x32_bf16 v[176:179], a[48:51], a[224:227], 0
    ds_read_b64_tr_b16 a[28:29], v16 offset:12288
    buffer_load_dwordx4 a[180:183], v13, s[20:23], s75 offen offset:1024 sc1
    v_mfma_f32_16x16x32_bf16 v[176:179], a[52:55], a[232:235], v[176:179]
    ds_read_b64_tr_b16 a[30:31], v16 offset:14336
    v_mfma_f32_16x16x32_bf16 v[180:183], a[48:51], a[228:231], 0
    ds_read_b64_tr_b16 a[32:33], v17 offset:8192
    buffer_load_dwordx4 a[184:187], v13, s[20:23], s75 offen offset:2048 sc1
    v_mfma_f32_16x16x32_bf16 v[180:183], a[52:55], a[236:239], v[180:183]
    ds_read_b64_tr_b16 a[34:35], v17 offset:10240
    v_mfma_f32_16x16x32_bf16 v[184:187], a[0:3], a[224:227], 0
    ds_read_b64_tr_b16 a[36:37], v17 offset:12288
    s_waitcnt vmcnt(15)
    v_cmp_le_u32 vcc, 1, v25
    s_nop 0
    s_cmp_eq_u64 vcc, -1
    s_cbranch_scc0 L_px1b_spin
L_px1b_ok:
    v_mfma_f32_16x16x32_bf16 v[184:187], a[4:7], a[232:235], v[184:187]
    ds_read_b64_tr_b16 a[38:39], v17 offset:14336
    s_add_u32 s100, s63, 0
    v_mfma_f32_16x16x32_bf16 v[188:191], a[0:3], a[228:231], 0
    ds_read_b64_tr_b16 a[40:41], v14 offset:16384
    buffer_load_dwordx4 v[32:35], v13, s[20:23], s100 offen sc1
    v_mfma_f32_16x16x32_bf16 v[188:191], a[4:7], a[236:239], v[188:191]
    ds_read_b64_tr_b16 a[42:43], v14 offset:18432
    s_waitcnt lgkmcnt(10)
    v_mfma_f32_16x16x32_bf16 v[160:163], a[8:11], a[128:131], v[160:163]
    ds_read_b64_tr_b16 a[44:45], v14 offset:20480
    buffer_load_dwordx4 v[36:39], v13, s[20:23], s100 offen offset:1024 sc1
    v_mfma_f32_16x16x32_bf16 v[160:163], a[12:15], a[136:139], v[160:163]
    ds_read_b64_tr_b16 a[46:47], v14 offset:22528
    v_mfma_f32_16x16x32_bf16 v[164:167], a[8:11], a[132:135], v[164:167]
    ds_read_b64_tr_b16 a[48:49], v15 offset:16384
    v_mfma_f32_16x16x32_bf16 v[164:167], a[12:15], a[140:143], v[164:167]
    ds_read_b64_tr_b16 a[50:51], v15 offset:18432
    buffer_load_dwordx4 v[40:43], v13, s[20:23], s100 offen offset:2048 sc1
    v_mfma_f32_16x16x32_bf16 v[168:171], a[16:19], a[128:131], v[168:171]
    ds_read_b64_tr_b16 a[52:53], v15 offset:20480
    v_mfma_f32_16x16x32_bf16 v[168:171], a[20:23], a[136:139], v[168:171]
    ds_read_b64_tr_b16 a[54:55], v15 offset:22528
    v_mfma_f32_16x16x32_bf16 v[172:175], a[16:19], a[132:135], v[172:175]
    ds_read_b64_tr_b16 a[0:1], v16 offset:16384
    buffer_load_dwordx4 v[44:47], v13, s[20:23], s100 offen offset:3072 sc1
    v_mfma_f32_16x16x32_bf16 v[172:175], a[20:23], a[140:143], v[172:175]
    ds_read_b64_tr_b16 a[2:3], v16 offset:18432
    s_waitcnt lgkmcnt(10)
    v_mfma_f32_16x16x32_bf16 v[176:179], a[24:27], a[128:131], v[176:179]
    ds_read_b64_tr_b16 a[4:5], v16 offset:20480
    v_mfma_f32_16x16x32_bf16 v[176:179], a[28:31], a[136:139], v[176:179]
    ds_read_b64_tr_b16 a[6:7], v16 offset:22528
    buffer_load_dwordx4 a[188:191], v13, s[20:23], s75 offen offset:3072 sc1
    v_mfma_f32_16x16x32_bf16 v[180:183], a[24:27], a[132:135], v[180:183]
    ds_read_b64_tr_b16 a[8:9], v17 offset:16384
    v_mfma_f32_16x16x32_bf16 v[180:183], a[28:31], a[140:143], v[180:183]
    ds_read_b64_tr_b16 a[10:11], v17 offset:18432
    s_add_u32 s75, s57, 1572864
    v_mfma_f32_16x16x32_bf16 v[184:187], a[32:35], a[128:131], v[184:187]
    ds_read_b64_tr_b16 a[12:13], v17 offset:20480
    buffer_load_dwordx4 a[192:195], v13, s[20:23], s75 offen sc1
    v_mfma_f32_16x16x32_bf16 v[184:187], a[36:39], a[136:139], v[184:187]
    ds_read_b64_tr_b16 a[14:15], v17 offset:22528
    v_mfma_f32_16x16x32_bf16 v[188:191], a[32:35], a[132:135], v[188:191]
    ds_read_b64_tr_b16 a[16:17], v14 offset:24576
    v_accvgpr_write_b32 a124, 3
    s_mov_b64 exec, 1
    buffer_store_dword a124, off, s[20:23], s84 sc1
    s_mov_b64 exec, -1
    v_mfma_f32_16x16x32_bf16 v[188:191], a[36:39], a[140:143], v[188:191]
    ds_read_b64_tr_b16 a[18:19], v14 offset:26624
    s_xor_b32 s77, s84, 512
    s_waitcnt vmcnt(19) lgkmcnt(10)
    v_mfma_f32_16x16x32_bf16 v[160:163], a[40:43], a[240:243], v[160:163]
    ds_read_b64_tr_b16 a[20:21], v14 offset:28672
    buffer_load_dword v25, off, s[20:23], s77 sc1
    v_mfma_f32_16x16x32_bf16 v[160:163], a[44:47], a[248:251], v[160:163]
    ds_read_b64_tr_b16 a[22:23], v14 offset:30720
    buffer_load_dwordx4 a[196:199], v13, s[20:23], s75 offen offset:1024 sc1
    v_mfma_f32_16x16x32_bf16 v[164:167], a[40:43], a[244:247], v[164:167]
    ds_read_b64_tr_b16 a[24:25], v15 offset:24576
    buffer_load_dwordx4 a[200:203], v13, s[20:23], s75 offen offset:2048 sc1
    v_mfma_f32_16x16x32_bf16 v[164:167], a[44:47], a[252:255], v[164:167]
    ds_read_b64_tr_b16 a[26:27], v15 offset:26624
    v_mfma_f32_16x16x32_bf16 v[168:171], a[48:51], a[240:243], v[168:171]
    ds_read_b64_tr_b16 a[28:29], v15 offset:28672
    v_mfma_f32_16x16x32_bf16 v[168:171], a[52:55], a[248:251], v[168:171]
    ds_read_b64_tr_b16 a[30:31], v15 offset:30720
    v_mfma_f32_16x16x32_bf16 v[172:175], a[48:51], a[244:247], v[172:175]
    ds_read_b64_tr_b16 a[32:33], v16 offset:24576
    buffer_load_dwordx4 a[204:207], v13, s[20:23], s75 offen offset:3072 sc1
    v_mfma_f32_16x16x32_bf16 v[172:175], a[52:55], a[252:255], v[172:175]
    ds_read_b64_tr_b16 a[34:35], v16 offset:26624
    s_waitcnt lgkmcnt(10)
    v_mfma_f32_16x16x32_bf16 v[176:179], a[0:3], a[240:243], v[176:179]
    ds_read_b64_tr_b16 a[36:37], v16 offset:28672
    s_add_u32 s75, s57, 1835008
    v_mfma_f32_16x16x32_bf16 v[176:179], a[4:7], a[248:251], v[176:179]
    ds_read_b64_tr_b16 a[38:39], v16 offset:30720
    buffer_load_dwordx4 a[208:211], v13, s[20:23], s75 offen sc1
    v_mfma_f32_16x16x32_bf16 v[180:183], a[0:3], a[244:247], v[180:183]
    ds_read_b64_tr_b16 a[40:41], v17 offset:24576
    v_mfma_f32_16x16x32_bf16 v[180:183], a[4:7], a[252:255], v[180:183]
    ds_read_b64_tr_b16 a[42:43], v17 offset:26624
    v_mfma_f32_16x16x32_bf16 v[184:187], a[8:11], a[240:243], v[184:187]
    ds_read_b64_tr_b16 a[44:45], v17 offset:28672
    v_mfma_f32_16x16x32_bf16 v[184:187], a[12:15], a[248:251], v[184:187]
    ds_read_b64_tr_b16 a[46:47], v17 offset:30720
    s_barrier
    v_mfma_f32_16x16x32_bf16 v[188:191], a[8:11], a[244:247], v[188:191]
    ds_read_b64_tr_b16 a[48:49], v14 offset:32768
    buffer_load_dwordx4 a[212:215], v13, s[20:23], s75 offen offset:1024 sc1
    v_mfma_f32_16x16x32_bf16 v[188:191], a[12:15], a[252:255], v[188:191]
    ds_read_b64_tr_b16 a[50:51], v14 offset:34816
    s_waitcnt vmcnt(20) lgkmcnt(10)
    v_mfma_f32_16x16x32_bf16 v[160:163], a[16:19], a[144:147], v[160:163]
    ds_read_b64_tr_b16 a[52:53], v14 offset:36864
    buffer_load_dwordx4 a[216:219], v13, s[20:23], s75 offen offset:2048 sc1
    v_mfma_f32_16x16x32_bf16 v[160:163], a[20:23], a[152:155], v[160:163]
    ds_read_b64_tr_b16 a[54:55], v14 offset:38912
    v_mfma_f32_16x16x32_bf16 v[164:167], a[16:19], a[148:151], v[164:167]
    ds_read_b64_tr_b16 a[0:1], v15 offset:32768
    buffer_load_dwordx4 a[220:223], v13, s[20:23], s75 offen offset:3072 sc1
    v_mfma_f32_16x16x32_bf16 v[164:167], a[20:23], a[156:159], v[164:167]
    ds_read_b64_tr_b16 a[2:3], v15 offset:34816
    v_mfma_f32_16x16x32_bf16 v[168:171], a[24:27], a[144:147], v[168:171]
    ds_read_b64_tr_b16 a[4:5], v15 offset:36864
    s_add_u32 s75, s57, 2097152
    v_mfma_f32_16x16x32_bf16 v[168:171], a[28:31], a[152:155], v[168:171]
    ds_read_b64_tr_b16 a[6:7], v15 offset:38912
    buffer_load_dwordx4 a[224:227], v13, s[20:23], s75 offen sc1
    v_mfma_f32_16x16x32_bf16 v[172:175], a[24:27], a[148:151], v[172:175]
    ds_read_b64_tr_b16 a[8:9], v16 offset:32768
    v_mfma_f32_16x16x32_bf16 v[172:175], a[28:31], a[156:159], v[172:175]
    ds_read_b64_tr_b16 a[10:11], v16 offset:34816
    s_waitcnt lgkmcnt(10)
    v_mfma_f32_16x16x32_bf16 v[176:179], a[32:35], a[144:147], v[176:179]
    ds_read_b64_tr_b16 a[12:13], v16 offset:36864
    buffer_load_dwordx4 a[228:231], v13, s[20:23], s75 offen offset:1024 sc1
    v_mfma_f32_16x16x32_bf16 v[176:179], a[36:39], a[152:155], v[176:179]
    ds_read_b64_tr_b16 a[14:15], v16 offset:38912
    v_mfma_f32_16x16x32_bf16 v[180:183], a[32:35], a[148:151], v[180:183]
    ds_read_b64_tr_b16 a[16:17], v17 offset:32768
    v_mfma_f32_16x16x32_bf16 v[180:183], a[36:39], a[156:159], v[180:183]
    ds_read_b64_tr_b16 a[18:19], v17 offset:34816
    buffer_load_dwordx4 a[232:235], v13, s[20:23], s75 offen offset:2048 sc1
    v_mfma_f32_16x16x32_bf16 v[184:187], a[40:43], a[144:147], v[184:187]
    ds_read_b64_tr_b16 a[20:21], v17 offset:36864
    v_mfma_f32_16x16x32_bf16 v[184:187], a[44:47], a[152:155], v[184:187]
    ds_read_b64_tr_b16 a[22:23], v17 offset:38912
    v_mfma_f32_16x16x32_bf16 v[188:191], a[40:43], a[148:151], v[188:191]
    ds_read_b64_tr_b16 a[24:25], v14 offset:40960
    buffer_load_dwordx4 a[236:239], v13, s[20:23], s75 offen offset:3072 sc1
    v_mfma_f32_16x16x32_bf16 v[188:191], a[44:47], a[156:159], v[188:191]
    ds_read_b64_tr_b16 a[26:27], v14 offset:43008
    s_waitcnt vmcnt(22) lgkmcnt(10)
    v_mfma_f32_16x16x32_bf16 v[160:163], a[48:51], a[160:163], v[160:163]
    ds_read_b64_tr_b16 a[28:29], v14 offset:45056
    s_add_u32 s75, s57, 2359296
    v_mfma_f32_16x16x32_bf16 v[160:163], a[52:55], a[168:171], v[160:163]
    ds_read_b64_tr_b16 a[30:31], v14 offset:47104
    buffer_load_dwordx4 a[128:131], v13, s[20:23], s75 offen sc1
    v_mfma_f32_16x16x32_bf16 v[164:167], a[48:51], a[164:167], v[164:167]
    ds_read_b64_tr_b16 a[32:33], v15 offset:40960
    v_mfma_f32_16x16x32_bf16 v[164:167], a[52:55], a[172:175], v[164:167]
    ds_read_b64_tr_b16 a[34:35], v15 offset:43008
    v_mfma_f32_16x16x32_bf16 v[168:171], a[0:3], a[160:163], v[168:171]
    ds_read_b64_tr_b16 a[36:37], v15 offset:45056
    s_waitcnt vmcnt(19)
    v_mfma_f32_16x16x32_bf16 v[96:99], v[4:7], v[32:35], v[96:99]
    v_mfma_f32_16x16x32_bf16 v[168:171], a[4:7], a[168:171], v[168:171]
    ds_read_b64_tr_b16 a[38:39], v15 offset:47104
    buffer_load_dwordx4 a[132:135], v13, s[20:23], s75 offen offset:1024 sc1
    v_mfma_f32_16x16x32_bf16 v[104:107], v[2:5], v[32:35], v[104:107]
    v_mfma_f32_16x16x32_bf16 v[172:175], a[0:3], a[164:167], v[172:175]
    ds_read_b64_tr_b16 a[40:41], v16 offset:40960
    v_mfma_f32_16x16x32_bf16 v[172:175], a[4:7], a[172:175], v[172:175]
    ds_read_b64_tr_b16 a[42:43], v16 offset:43008
    s_waitcnt vmcnt(19)
    v_mfma_f32_16x16x32_bf16 v[100:103], v[4:7], v[36:39], v[100:103]
    s_waitcnt lgkmcnt(10)
    v_mfma_f32_16x16x32_bf16 v[176:179], a[8:11], a[160:163], v[176:179]
    ds_read_b64_tr_b16 a[44:45], v16 offset:45056
    buffer_load_dwordx4 a[136:139], v13, s[20:23], s75 offen offset:2048 sc1
    v_mfma_f32_16x16x32_bf16 v[108:111], v[2:5], v[36:39], v[108:111]
    v_mfma_f32_16x16x32_bf16 v[176:179], a[12:15], a[168:171], v[176:179]
    ds_read_b64_tr_b16 a[46:47], v16 offset:47104
    v_mfma_f32_16x16x32_bf16 v[180:183], a[8:11], a[164:167], v[180:183]
    ds_read_b64_tr_b16 a[48:49], v17 offset:40960
    s_waitcnt vmcnt(19)
    v_mfma_f32_16x16x32_bf16 v[112:115], v[4:7], v[40:43], v[112:115]
    v_mfma_f32_16x16x32_bf16 v[180:183], a[12:15], a[172:175], v[180:183]
    ds_read_b64_tr_b16 a[50:51], v17 offset:43008
    buffer_load_dwordx4 a[140:143], v13, s[20:23], s75 offen offset:3072 sc1
    v_mfma_f32_16x16x32_bf16 v[120:123], v[2:5], v[40:43], v[120:123]
    v_mfma_f32_16x16x32_bf16 v[184:187], a[16:19], a[160:163], v[184:187]
    ds_read_b64_tr_b16 a[52:53], v17 offset:45056
    s_waitcnt vmcnt(15)
    v_cmp_le_u32 vcc, 2, v25
    s_nop 0
    s_cmp_eq_u64 vcc, -1
    s_cbranch_scc0 L_px2b_spin
L_px2b_ok:
    v_mfma_f32_16x16x32_bf16 v[184:187], a[20:23], a[168:171], v[184:187]
    ds_read_b64_tr_b16 a[54:55], v17 offset:47104
    s_add_u32 s100, s64, 4096
    v_mfma_f32_16x16x32_bf16 v[116:119], v[4:7], v[44:47], v[116:119]
    v_mfma_f32_16x16x32_bf16 v[188:191], a[16:19], a[164:167], v[188:191]
    ds_read_b64_tr_b16 a[0:1], v14 offset:49152
    buffer_load_dwordx4 v[48:51], v13, s[20:23], s100 offen sc1
    v_mfma_f32_16x16x32_bf16 v[124:127], v[2:5], v[44:47], v[124:127]
    v_mfma_f32_16x16x32_bf16 v[188:191], a[20:23], a[172:175], v[188:191]
    ds_read_b64_tr_b16 a[2:3], v14 offset:51200
    s_waitcnt lgkmcnt(10)
    v_mfma_f32_16x16x32_bf16 v[160:163], a[24:27], a[176:179], v[160:163]
    ds_read_b64_tr_b16 a[4:5], v14 offset:53248
    v_mfma_f32_16x16x32_bf16 v[160:163], a[28:31], a[184:187], v[160:163]
    ds_read_b64_tr_b16 a[6:7], v14 offset:55296
    buffer_load_dwordx4 v[52:55], v13, s[20:23], s100 offen offset:1024 sc1
    v_mfma_f32_16x16x32_bf16 v[164:167], a[24:27], a[180:183], v[164:167]
    ds_read_b64_tr_b16 a[8:9], v15 offset:49152
    v_mfma_f32_16x16x32_bf16 v[164:167], a[28:31], a[188:191], v[164:167]
    ds_read_b64_tr_b16 a[10:11], v15 offset:51200
    v_mfma_f32_16x16x32_bf16 v[168:171], a[32:35], a[176:179], v[168:171]
    ds_read_b64_tr_b16 a[12:13], v15 offset:53248
    buffer_load_dwordx4 v[56:59], v13, s[20:23], s100 offen offset:2048 sc1
    v_mfma_f32_16x16x32_bf16 v[168:171], a[36:39], a[184:187], v[168:171]
    ds_read_b64_tr_b16 a[14:15], v15 offset:55296
    s_xor_b32 s77, s84, 256
    v_mfma_f32_16x16x32_bf16 v[172:175], a[32:35], a[180:183], v[172:175]
    ds_read_b64_tr_b16 a[16:17], v16 offset:49152
    buffer_load_dword v25, off, s[20:23], s77 sc1
    v_mfma_f32_16x16x32_bf16 v[172:175], a[36:39], a[188:191], v[172:175]
    ds_read_b64_tr_b16 a[18:19], v16 offset:51200
    s_waitcnt lgkmcnt(10)
    v_mfma_f32_16x16x32_bf16 v[176:179], a[40:43], a[176:179], v[176:179]
    ds_read_b64_tr_b16 a[20:21], v16 offset:53248
    buffer_load_dwordx4 v[60:63], v13, s[20:23], s100 offen offset:3072 sc1
    v_mfma_f32_16x16x32_bf16 v[176:179], a[44:47], a[184:187], v[176:179]
    ds_read_b64_tr_b16 a[22:23], v16 offset:55296
    s_add_u32 s75, s57, 2621440
    v_mfma_f32_16x16x32_bf16 v[180:183], a[40:43], a[180:183], v[180:183]
    ds_read_b64_tr_b16 a[24:25], v17 offset:49152
    buffer_load_dwordx4 a[240:243], v13, s[20:23], s75 offen sc1
    v_mfma_f32_16x16x32_bf16 v[180:183], a[44:47], a[188:191], v[180:183]
    ds_read_b64_tr_b16 a[26:27], v17 offset:51200
    v_mfma_f32_16x16x32_bf16 v[184:187], a[48:51], a[176:179], v[184:187]
    ds_read_b64_tr_b16 a[28:29], v17 offset:53248
    v_mfma_f32_16x16x32_bf16 v[184:187], a[52:55], a[184:187], v[184:187]
    ds_read_b64_tr_b16 a[30:31], v17 offset:55296
    buffer_load_dwordx4 a[244:247], v13, s[20:23], s75 offen offset:1024 sc1
    v_mfma_f32_16x16x32_bf16 v[188:191], a[48:51], a[180:183], v[188:191]
    ds_read_b64_tr_b16 a[32:33], v14 offset:57344
    v_mfma_f32_16x16x32_bf16 v[188:191], a[52:55], a[188:191], v[188:191]
    ds_read_b64_tr_b16 a[34:35], v14 offset:59392
    s_waitcnt vmcnt(19) lgkmcnt(10)
    v_mfma_f32_16x16x32_bf16 v[160:163], a[0:3], a[192:195], v[160:163]
    ds_read_b64_tr_b16 a[36:37], v14 offset:61440
    buffer_load_dwordx4 a[248:251], v13, s[20:23], s75 offen offset:2048 sc1
    v_mfma_f32_16x16x32_bf16 v[160:163], a[4:7], a[200:203], v[160:163]
    ds_read_b64_tr_b16 a[38:39], v14 offset:63488
    v_mfma_f32_16x16x32_bf16 v[164:167], a[0:3], a[196:199], v[164:167]
    ds_read_b64_tr_b16 a[40:41], v15 offset:57344
    v_mfma_f32_16x16x32_bf16 v[164:167], a[4:7], a[204:207], v[164:167]
    ds_read_b64_tr_b16 a[42:43], v15 offset:59392
    v_mfma_f32_16x16x32_bf16 v[168:171], a[8:11], a[192:195], v[168:171]
    ds_read_b64_tr_b16 a[44:45], v15 offset:61440
    buffer_load_dwordx4 a[252:255], v13, s[20:23], s75 offen offset:3072 sc1
    v_mfma_f32_16x16x32_bf16 v[168:171], a[12:15], a[200:203], v[168:171]
    ds_read_b64_tr_b16 a[46:47], v15 offset:63488
    s_add_u32 m0, s59, 81920
    v_mfma_f32_16x16x32_bf16 v[172:175], a[8:11], a[196:199], v[172:175]
    ds_read_b64_tr_b16 a[48:49], v16 offset:57344
    s_add_u32 s74, s55, 1572864
    v_mfma_f32_16x16x32_bf16 v[172:175], a[12:15], a[204:207], v[172:175]
    ds_read_b64_tr_b16 a[50:51], v16 offset:59392
    s_waitcnt lgkmcnt(10)
    v_mfma_f32_16x16x32_bf16 v[176:179], a[16:19], a[192:195], v[176:179]
    ds_read_b64_tr_b16 a[52:53], v16 offset:61440
    buffer_load_dwordx4 v9, s[28:31], s74 offen lds
    v_mfma_f32_16x16x32_bf16 v[176:179], a[20:23], a[200:203], v[176:179]
    ds_read_b64_tr_b16 a[54:55], v16 offset:63488
    v_mfma_f32_16x16x32_bf16 v[180:183], a[16:19], a[196:199], v[180:183]
    ds_read_b64_tr_b16 a[0:1], v17 offset:57344
    buffer_load_dwordx4 v10, s[28:31], s74 offen offset:1024 lds
    v_mfma_f32_16x16x32_bf16 v[180:183], a[20:23], a[204:207], v[180:183]
    ds_read_b64_tr_b16 a[2:3], v17 offset:59392
    v_mfma_f32_16x16x32_bf16 v[184:187], a[24:27], a[192:195], v[184:187]
    ds_read_b64_tr_b16 a[4:5], v17 offset:61440
    v_mfma_f32_16x16x32_bf16 v[184:187], a[28:31], a[200:203], v[184:187]
    ds_read_b64_tr_b16 a[6:7], v17 offset:63488
    s_barrier
    v_mfma_f32_16x16x32_bf16 v[188:191], a[24:27], a[196:199], v[188:191]
    ds_read_b64_tr_b16 a[8:9], v18
    buffer_load_dwordx4 v11, s[28:31], s74 offen offset:2048 lds
    v_mfma_f32_16x16x32_bf16 v[188:191], a[28:31], a[204:207], v[188:191]
    ds_read_b64_tr_b16 a[10:11], v18 offset:2048
    s_waitcnt vmcnt(20) lgkmcnt(10)
    v_mfma_f32_16x16x32_bf16 v[160:163], a[32:35], a[208:211], v[160:163]
    ds_read_b64_tr_b16 a[12:13], v18 offset:4096
    buffer_load_dwordx4 v12, s[28:31], s74 offen offset:3072 lds
    v_mfma_f32_16x16x32_bf16 v[160:163], a[36:39], a[216:219], v[160:163]
    ds_read_b64_tr_b16 a[14:15], v18 offset:6144
    s_add_u32 m0, s59, 98304
    v_mfma_f32_16x16x32_bf16 v[164:167], a[32:35], a[212:215], v[164:167]
    ds_read_b64_tr_b16 a[16:17], v19
    s_add_u32 s74, s55, 1835008
    v_mfma_f32_16x16x32_bf16 v[164:167], a[36:39], a[220:223], v[164:167]
    ds_read_b64_tr_b16 a[18:19], v19 offset:2048
    buffer_load_dwordx4 v9, s[28:31], s74 offen lds
    v_mfma_f32_16x16x32_bf16 v[168:171], a[40:43], a[208:211], v[168:171]
    ds_read_b64_tr_b16 a[20:21], v19 offset:4096
    v_mfma_f32_16x16x32_bf16 v[168:171], a[44:47], a[216:219], v[168:171]
    ds_read_b64_tr_b16 a[22:23], v19 offset:6144
    v_mfma_f32_16x16x32_bf16 v[172:175], a[40:43], a[212:215], v[172:175]
    ds_read_b64_tr_b16 a[24:25], v20
    buffer_load_dwordx4 v10, s[28:31], s74 offen offset:1024 lds
    v_mfma_f32_16x16x32_bf16 v[172:175], a[44:47], a[220:223], v[172:175]
    ds_read_b64_tr_b16 a[26:27], v20 offset:2048
    s_waitcnt lgkmcnt(10)
    v_mfma_f32_16x16x32_bf16 v[176:179], a[48:51], a[208:211], v[176:179]
    ds_read_b64_tr_b16 a[28:29], v20 offset:4096
    v_mfma_f32_16x16x32_bf16 v[176:179], a[52:55], a[216:219], v[176:179]
    ds_read_b64_tr_b16 a[30:31], v20 offset:6144
    buffer_load_dwordx4 v11, s[28:31], s74 offen offset:2048 lds
    v_mfma_f32_16x16x32_bf16 v[180:183], a[48:51], a[212:215], v[180:183]
    ds_read_b64_tr_b16 a[32:33], v21
    v_mfma_f32_16x16x32_bf16 v[180:183], a[52:55], a[220:223], v[180:183]
    ds_read_b64_tr_b16 a[34:35], v21 offset:2048
    v_mfma_f32_16x16x32_bf16 v[184:187], a[0:3], a[208:211], v[184:187]
    ds_read_b64_tr_b16 a[36:37], v21 offset:4096
    buffer_load_dwordx4 v12, s[28:31], s74 offen offset:3072 lds
    v_mfma_f32_16x16x32_bf16 v[184:187], a[4:7], a[216:219], v[184:187]
    ds_read_b64_tr_b16 a[38:39], v21 offset:6144
    v_mfma_f32_16x16x32_bf16 v[188:191], a[0:3], a[212:215], v[188:191]
    ds_read_b64_tr_b16 a[40:41], v18 offset:8192
    s_add_u32 s75, s57, 2883584
    v_mfma_f32_16x16x32_bf16 v[188:191], a[4:7], a[220:223], v[188:191]
    ds_read_b64_tr_b16 a[42:43], v18 offset:10240
    s_waitcnt vmcnt(21) lgkmcnt(10)
    v_mfma_f32_16x16x32_bf16 v[160:163], a[8:11], a[224:227], v[160:163]
    ds_read_b64_tr_b16 a[44:45], v18 offset:12288
    buffer_load_dwordx4 a[144:147], v13, s[20:23], s75 offen sc1
    v_mfma_f32_16x16x32_bf16 v[160:163], a[12:15], a[232:235], v[160:163]
    ds_read_b64_tr_b16 a[46:47], v18 offset:14336
    v_mfma_f32_16x16x32_bf16 v[164:167], a[8:11], a[228:231], v[164:167]
    ds_read_b64_tr_b16 a[48:49], v19 offset:8192
    s_waitcnt vmcnt(14)
    v_cmp_le_u32 vcc, 3, v25
    s_nop 0
    s_cmp_eq_u64 vcc, -1
    s_cbranch_scc0 L_px3b_spin
L_px3b_ok:
    v_mfma_f32_16x16x32_bf16 v[164:167], a[12:15], a[236:239], v[164:167]
    ds_read_b64_tr_b16 a[50:51], v19 offset:10240
    s_mov_b32 s100, s54
    v_mfma_f32_16x16x32_bf16 v[168:171], a[16:19], a[224:227], v[168:171]
    ds_read_b64_tr_b16 a[52:53], v19 offset:12288
    buffer_load_dwordx4 v[64:67], v9, s[32:35], s100 offen sc1
    v_mfma_f32_16x16x32_bf16 v[96:99], v[4:7], v[48:51], v[96:99]
    v_mfma_f32_16x16x32_bf16 v[168:171], a[20:23], a[232:235], v[168:171]
    ds_read_b64_tr_b16 a[54:55], v19 offset:14336
    v_mfma_f32_16x16x32_bf16 v[104:107], v[2:5], v[48:51], v[104:107]
    v_mfma_f32_16x16x32_bf16 v[172:175], a[16:19], a[228:231], v[172:175]
    ds_read_b64_tr_b16 a[0:1], v20 offset:8192
    buffer_load_dwordx4 v[68:71], v10, s[32:35], s100 offen offset:1024 sc1
    v_mfma_f32_16x16x32_bf16 v[172:175], a[20:23], a[236:239], v[172:175]
    ds_read_b64_tr_b16 a[2:3], v20 offset:10240
    v_mfma_f32_16x16x32_bf16 v[100:103], v[4:7], v[52:55], v[100:103]
    s_waitcnt lgkmcnt(10)
    v_mfma_f32_16x16x32_bf16 v[176:179], a[24:27], a[224:227], v[176:179]
    ds_read_b64_tr_b16 a[4:5], v20 offset:12288
    v_mfma_f32_16x16x32_bf16 v[108:111], v[2:5], v[52:55], v[108:111]
L_pad1_15:
    s_cbranch_execz L_pad1_19
    v_mfma_f32_16x16x32_bf16 v[176:179], a[28:31], a[232:235], v[176:179]
    ds_read_b64_tr_b16 a[6:7], v20 offset:14336
    buffer_load_dwordx4 v[72:75], v11, s[32:35], s100 offen offset:2048 sc1
    v_mfma_f32_16x16x32_bf16 v[180:183], a[24:27], a[228:231], v[180:183]
    ds_read_b64_tr_b16 a[8:9], v21 offset:8192
    v_mfma_f32_16x16x32_bf16 v[112:115], v[4:7], v[56:59], v[112:115]
    v_mfma_f32_16x16x32_bf16 v[180:183], a[28:31], a[236:239], v[180:183]
    ds_read_b64_tr_b16 a[10:11], v21 offset:10240
    v_mfma_f32_16x16x32_bf16 v[120:123], v[2:5], v[56:59], v[120:123]
    v_mfma_f32_16x16x32_bf16 v[184:187], a[32:35], a[224:227], v[184:187]
    ds_read_b64_tr_b16 a[12:13], v21 offset:12288
    buffer_load_dwordx4 v[76:79], v12, s[32:35], s100 offen offset:3072 sc1
    v_mfma_f32_16x16x32_bf16 v[184:187], a[36:39], a[232:235], v[184:187]
    ds_read_b64_tr_b16 a[14:15], v21 offset:14336
    s_waitcnt vmcnt(17)
    v_mfma_f32_16x16x32_bf16 v[116:119], v[4:7], v[60:63], v[116:119]
    v_mfma_f32_16x16x32_bf16 v[188:191], a[32:35], a[228:231], v[188:191]
    ds_read_b64_tr_b16 a[16:17], v0 offset:16384
    v_mfma_f32_16x16x32_bf16 v[124:127], v[2:5], v[60:63], v[124:127]
    v_mfma_f32_16x16x32_bf16 v[188:191], a[36:39], a[236:239], v[188:191]
    ds_read_b64_tr_b16 a[18:19], v0 offset:18432
    s_waitcnt lgkmcnt(10)
    v_mfma_f32_16x16x32_bf16 v[160:163], a[40:43], a[128:131], v[160:163]
    ds_read_b64_tr_b16 a[20:21], v0 offset:20480
    buffer_load_dwordx4 a[148:151], v13, s[20:23], s75 offen offset:1024 sc1
    v_mfma_f32_16x16x32_bf16 v[160:163], a[44:47], a[136:139], v[160:163]
    ds_read_b64_tr_b16 a[22:23], v0 offset:22528
    v_mfma_f32_16x16x32_bf16 v[164:167], a[40:43], a[132:135], v[164:167]
    ds_read_b64_tr_b16 a[24:25], v1 offset:16384
    buffer_load_dwordx4 a[152:155], v13, s[20:23], s75 offen offset:2048 sc1
    v_mfma_f32_16x16x32_bf16 v[164:167], a[44:47], a[140:143], v[164:167]
    ds_read_b64_tr_b16 a[26:27], v1 offset:18432
    v_mfma_f32_16x16x32_bf16 v[168:171], a[48:51], a[128:131], v[168:171]
    ds_read_b64_tr_b16 a[28:29], v1 offset:20480
    v_mfma_f32_16x16x32_bf16 v[168:171], a[52:55], a[136:139], v[168:171]
    ds_read_b64_tr_b16 a[30:31], v1 offset:22528
    buffer_load_dwordx4 a[156:159], v13, s[20:23], s75 offen offset:3072 sc1
    v_mfma_f32_16x16x32_bf16 v[172:175], a[48:51], a[132:135], v[172:175]
    ds_read_b64_tr_b16 a[32:33], v8 offset:16384
    v_mfma_f32_16x16x32_bf16 v[172:175], a[52:55], a[140:143], v[172:175]
    ds_read_b64_tr_b16 a[34:35], v8 offset:18432
    s_waitcnt lgkmcnt(10)
    v_mfma_f32_16x16x32_bf16 v[176:179], a[0:3], a[128:131], v[176:179]
    ds_read_b64_tr_b16 a[36:37], v8 offset:20480
    s_add_u32 s75, s57, 3145728
    v_mfma_f32_16x16x32_bf16 v[176:179], a[4:7], a[136:139], v[176:179]
    ds_read_b64_tr_b16 a[38:39], v8 offset:22528
    buffer_load_dwordx4 a[160:163], v13, s[20:23], s75 offen sc1
    v_mfma_f32_16x16x32_bf16 v[180:183], a[0:3], a[132:135], v[180:183]
    ds_read_b64_tr_b16 a[40:41], v31 offset:16384
    v_mfma_f32_16x16x32_bf16 v[180:183], a[4:7], a[140:143], v[180:183]
    ds_read_b64_tr_b16 a[42:43], v31 offset:18432
    buffer_load_dwordx4 a[164:167], v13, s[20:23], s75 offen offset:1024 sc1
    v_mfma_f32_16x16x32_bf16 v[184:187], a[8:11], a[128:131], v[184:187]
    ds_read_b64_tr_b16 a[44:45], v31 offset:20480
    v_mfma_f32_16x16x32_bf16 v[184:187], a[12:15], a[136:139], v[184:187]
    ds_read_b64_tr_b16 a[46:47], v31 offset:22528
    v_mfma_f32_16x16x32_bf16 v[188:191], a[8:11], a[132:135], v[188:191]
    ds_read_b64_tr_b16 a[48:49], v0 offset:24576
    buffer_load_dwordx4 a[168:171], v13, s[20:23], s75 offen offset:2048 sc1
    v_mfma_f32_16x16x32_bf16 v[188:191], a[12:15], a[140:143], v[188:191]
    ds_read_b64_tr_b16 a[50:51], v0 offset:26624
    s_waitcnt vmcnt(19) lgkmcnt(10)
    v_mfma_f32_16x16x32_bf16 v[160:163], a[16:19], a[240:243], v[160:163]
    ds_read_b64_tr_b16 a[52:53], v0 offset:28672
    v_mfma_f32_16x16x32_bf16 v[160:163], a[20:23], a[248:251], v[160:163]
    ds_read_b64_tr_b16 a[54:55], v0 offset:30720
    v_mfma_f32_16x16x32_bf16 v[164:167], a[16:19], a[244:247], v[164:167]
    ds_read_b64_tr_b16 a[0:1], v1 offset:24576
    buffer_load_dwordx4 a[172:175], v13, s[20:23], s75 offen offset:3072 sc1
    v_mfma_f32_16x16x32_bf16 v[164:167], a[20:23], a[252:255], v[164:167]
    ds_read_b64_tr_b16 a[2:3], v1 offset:26624
    v_mfma_f32_16x16x32_bf16 v[168:171], a[24:27], a[240:243], v[168:171]
    ds_read_b64_tr_b16 a[4:5], v1 offset:28672
    s_add_u32 s75, s57, 3407872
    v_mfma_f32_16x16x32_bf16 v[168:171], a[28:31], a[248:251], v[168:171]
    ds_read_b64_tr_b16 a[6:7], v1 offset:30720
    buffer_load_dwordx4 a[176:179], v13, s[20:23], s75 offen sc1
    v_mfma_f32_16x16x32_bf16 v[172:175], a[24:27], a[244:247], v[172:175]
    ds_read_b64_tr_b16 a[8:9], v8 offset:24576
    v_mfma_f32_16x16x32_bf16 v[172:175], a[28:31], a[252:255], v[172:175]
    ds_read_b64_tr_b16 a[10:11], v8 offset:26624
    s_waitcnt lgkmcnt(10)
    v_mfma_f32_16x16x32_bf16 v[176:179], a[32:35], a[240:243], v[176:179]
    ds_read_b64_tr_b16 a[12:13], v8 offset:28672
    buffer_load_dwordx4 a[180:183], v13, s[20:23], s75 offen offset:1024 sc1
    v_mfma_f32_16x16x32_bf16 v[176:179], a[36:39], a[248:251], v[176:179]
    ds_read_b64_tr_b16 a[14:15], v8 offset:30720
    v_mfma_f32_16x16x32_bf16 v[180:183], a[32:35], a[244:247], v[180:183]
    ds_read_b64_tr_b16 a[16:17], v31 offset:24576
    v_mfma_f32_16x16x32_bf16 v[180:183], a[36:39], a[252:255], v[180:183]
    ds_read_b64_tr_b16 a[18:19], v31 offset:26624
    buffer_load_dwordx4 a[184:187], v13, s[20:23], s75 offen offset:2048 sc1
    v_mfma_f32_16x16x32_bf16 v[184:187], a[40:43], a[240:243], v[184:187]
    ds_read_b64_tr_b16 a[20:21], v31 offset:28672
    s_waitcnt vmcnt(15)
    v_mfma_f32_16x16x32_bf16 v[184:187], a[44:47], a[248:251], v[184:187]
    ds_read_b64_tr_b16 a[22:23], v31 offset:30720
    s_barrier
    v_mfma_f32_16x16x32_bf16 v[188:191], a[40:43], a[244:247], v[188:191]
    ds_read_b64_tr_b16 a[24:25], v18 offset:16384
    buffer_load_dwordx4 a[188:191], v13, s[20:23], s75 offen offset:3072 sc1
    v_mfma_f32_16x16x32_bf16 v[188:191], a[44:47], a[252:255], v[188:191]
    ds_read_b64_tr_b16 a[26:27], v18 offset:18432
    s_waitcnt vmcnt(8) lgkmcnt(10)
    v_mfma_f32_16x16x32_bf16 v[160:163], a[48:51], a[144:147], v[160:163]
    ds_read_b64_tr_b16 a[28:29], v18 offset:20480
    s_add_u32 s75, s57, 3670016
    v_mfma_f32_16x16x32_bf16 v[160:163], a[52:55], a[152:155], v[160:163]
    ds_read_b64_tr_b16 a[30:31], v18 offset:22528
    buffer_load_dwordx4 a[192:195], v13, s[20:23], s75 offen sc1
    v_mfma_f32_16x16x32_bf16 v[164:167], a[48:51], a[148:151], v[164:167]
    ds_read_b64_tr_b16 a[32:33], v19 offset:16384
    v_mfma_f32_16x16x32_bf16 v[164:167], a[52:55], a[156:159], v[164:167]
    ds_read_b64_tr_b16 a[34:35], v19 offset:18432
    v_mfma_f32_16x16x32_bf16 v[168:171], a[0:3], a[144:147], v[168:171]
    ds_read_b64_tr_b16 a[36:37], v19 offset:20480
    buffer_load_dwordx4 a[196:199], v13, s[20:23], s75 offen offset:1024 sc1
    v_mfma_f32_16x16x32_bf16 v[168:171], a[4:7], a[152:155], v[168:171]
    ds_read_b64_tr_b16 a[38:39], v19 offset:22528
    v_mfma_f32_16x16x32_bf16 v[172:175], a[0:3], a[148:151], v[172:175]
    ds_read_b64_tr_b16 a[40:41], v20 offset:16384
    v_mfma_f32_16x16x32_bf16 v[172:175], a[4:7], a[156:159], v[172:175]
    ds_read_b64_tr_b16 a[42:43], v20 offset:18432
    s_waitcnt lgkmcnt(10)
    v_mfma_f32_16x16x32_bf16 v[176:179], a[8:11], a[144:147], v[176:179]
    ds_read_b64_tr_b16 a[44:45], v20 offset:20480
    buffer_load_dwordx4 a[200:203], v13, s[20:23], s75 offen offset:2048 sc1
    v_mfma_f32_16x16x32_bf16 v[176:179], a[12:15], a[152:155], v[176:179]
    ds_read_b64_tr_b16 a[46:47], v20 offset:22528
    v_mfma_f32_16x16x32_bf16 v[180:183], a[8:11], a[148:151], v[180:183]
    ds_read_b64_tr_b16 a[48:49], v21 offset:16384
    buffer_load_dwordx4 a[204:207], v13, s[20:23], s75 offen offset:3072 sc1
    v_mfma_f32_16x16x32_bf16 v[96:99], v[4:7], v[64:67], v[96:99]
    v_mfma_f32_16x16x32_bf16 v[180:183], a[12:15], a[156:159], v[180:183]
    ds_read_b64_tr_b16 a[50:51], v21 offset:18432
    v_mfma_f32_16x16x32_bf16 v[104:107], v[2:5], v[64:67], v[104:107]
    v_mfma_f32_16x16x32_bf16 v[184:187], a[16:19], a[144:147], v[184:187]
    ds_read_b64_tr_b16 a[52:53], v21 offset:20480
    s_add_u32 s75, s57, 3932160
    v_mfma_f32_16x16x32_bf16 v[184:187], a[20:23], a[152:155], v[184:187]
    ds_read_b64_tr_b16 a[54:55], v21 offset:22528
    buffer_load_dwordx4 a[208:211], v13, s[20:23], s75 offen sc1
    v_mfma_f32_16x16x32_bf16 v[100:103], v[4:7], v[68:71], v[100:103]
    v_mfma_f32_16x16x32_bf16 v[188:191], a[16:19], a[148:151], v[188:191]
    ds_read_b64_tr_b16 a[0:1], v18 offset:24576
    v_mfma_f32_16x16x32_bf16 v[108:111], v[2:5], v[68:71], v[108:111]
    v_mfma_f32_16x16x32_bf16 v[188:191], a[20:23], a[156:159], v[188:191]
    ds_read_b64_tr_b16 a[2:3], v18 offset:26624
    s_waitcnt vmcnt(9) lgkmcnt(10)
    v_mfma_f32_16x16x32_bf16 v[160:163], a[24:27], a[160:163], v[160:163]
    ds_read_b64_tr_b16 a[4:5], v18 offset:28672
    v_mfma_f32_16x16x32_bf16 v[112:115], v[4:7], v[72:75], v[112:115]
    v_mfma_f32_16x16x32_bf16 v[160:163], a[28:31], a[168:171], v[160:163]
    ds_read_b64_tr_b16 a[6:7], v18 offset:30720
    buffer_load_dwordx4 a[212:215], v13, s[20:23], s75 offen offset:1024 sc1
    v_mfma_f32_16x16x32_bf16 v[120:123], v[2:5], v[72:75], v[120:123]
    v_mfma_f32_16x16x32_bf16 v[164:167], a[24:27], a[164:167], v[164:167]
    ds_read_b64_tr_b16 a[8:9], v19 offset:24576
    v_mfma_f32_16x16x32_bf16 v[164:167], a[28:31], a[172:175], v[164:167]
    ds_read_b64_tr_b16 a[10:11], v19 offset:26624
    v_mfma_f32_16x16x32_bf16 v[116:119], v[4:7], v[76:79], v[116:119]
    v_mfma_f32_16x16x32_bf16 v[168:171], a[32:35], a[160:163], v[168:171]
    ds_read_b64_tr_b16 a[12:13], v19 offset:28672
    buffer_load_dwordx4 a[216:219], v13, s[20:23], s75 offen offset:2048 sc1
    v_mfma_f32_16x16x32_bf16 v[124:127], v[2:5], v[76:79], v[124:127]
    v_mfma_f32_16x16x32_bf16 v[168:171], a[36:39], a[168:171], v[168:171]
    ds_read_b64_tr_b16 a[14:15], v19 offset:30720
    v_mfma_f32_16x16x32_bf16 v[172:175], a[32:35], a[164:167], v[172:175]
    ds_read_b64_tr_b16 a[16:17], v20 offset:24576
    v_mfma_f32_16x16x32_bf16 v[172:175], a[36:39], a[172:175], v[172:175]
    ds_read_b64_tr_b16 a[18:19], v20 offset:26624
    s_waitcnt lgkmcnt(10)
    v_mfma_f32_16x16x32_bf16 v[176:179], a[40:43], a[160:163], v[176:179]
    ds_read_b64_tr_b16 a[20:21], v20 offset:28672
    buffer_load_dwordx4 a[220:223], v13, s[20:23], s75 offen offset:3072 sc1
    v_mfma_f32_16x16x32_bf16 v[176:179], a[44:47], a[168:171], v[176:179]
    ds_read_b64_tr_b16 a[22:23], v20 offset:30720
    s_mov_b32 s70, 0xbfb8aa3b
    v_mfma_f32_16x16x32_bf16 v[180:183], a[40:43], a[164:167], v[180:183]
    ds_read_b64_tr_b16 a[24:25], v21 offset:24576
    v_mfma_f32_16x16x32_bf16 v[180:183], a[44:47], a[172:175], v[180:183]
    ds_read_b64_tr_b16 a[26:27], v21 offset:26624
    v_mfma_f32_16x16x32_bf16 v[184:187], a[48:51], a[160:163], v[184:187]
    ds_read_b64_tr_b16 a[28:29], v21 offset:28672
    v_mfma_f32_16x16x32_bf16 v[184:187], a[52:55], a[168:171], v[184:187]
    ds_read_b64_tr_b16 a[30:31], v21 offset:30720
    v_mfma_f32_16x16x32_bf16 v[188:191], a[48:51], a[164:167], v[188:191]
    ds_read_b64_tr_b16 a[32:33], v18 offset:32768
    v_mfma_f32_16x16x32_bf16 v[188:191], a[52:55], a[172:175], v[188:191]
    ds_read_b64_tr_b16 a[34:35], v18 offset:34816
    s_waitcnt vmcnt(8) lgkmcnt(10)
    v_mfma_f32_16x16x32_bf16 v[160:163], a[0:3], a[176:179], v[160:163]
    ds_read_b64_tr_b16 a[36:37], v18 offset:36864
    v_mfma_f32_16x16x32_bf16 v[160:163], a[4:7], a[184:187], v[160:163]
    ds_read_b64_tr_b16 a[38:39], v18 offset:38912
    v_mfma_f32_16x16x32_bf16 v[164:167], a[0:3], a[180:183], v[164:167]
    ds_read_b64_tr_b16 a[40:41], v19 offset:32768
    v_mfma_f32_16x16x32_bf16 v[164:167], a[4:7], a[188:191], v[164:167]
    ds_read_b64_tr_b16 a[42:43], v19 offset:34816
    v_mfma_f32_16x16x32_bf16 v[168:171], a[8:11], a[176:179], v[168:171]
    ds_read_b64_tr_b16 a[44:45], v19 offset:36864
    v_mfma_f32_16x16x32_bf16 v[168:171], a[12:15], a[184:187], v[168:171]
    ds_read_b64_tr_b16 a[46:47], v19 offset:38912
    v_mfma_f32_16x16x32_bf16 v[172:175], a[8:11], a[180:183], v[172:175]
    ds_read_b64_tr_b16 a[48:49], v20 offset:32768
    v_mfma_f32_16x16x32_bf16 v[172:175], a[12:15], a[188:191], v[172:175]
    ds_read_b64_tr_b16 a[50:51], v20 offset:34816
    s_waitcnt lgkmcnt(10)
    v_mfma_f32_16x16x32_bf16 v[176:179], a[16:19], a[176:179], v[176:179]
    ds_read_b64_tr_b16 a[52:53], v20 offset:36864
    v_mfma_f32_16x16x32_bf16 v[176:179], a[20:23], a[184:187], v[176:179]
    ds_read_b64_tr_b16 a[54:55], v20 offset:38912
    v_mfma_f32_16x16x32_bf16 v[180:183], a[16:19], a[180:183], v[180:183]
    ds_read_b64_tr_b16 a[0:1], v21 offset:32768
    v_mfma_f32_16x16x32_bf16 v[180:183], a[20:23], a[188:191], v[180:183]
    ds_read_b64_tr_b16 a[2:3], v21 offset:34816
    v_mfma_f32_16x16x32_bf16 v[184:187], a[24:27], a[176:179], v[184:187]
    ds_read_b64_tr_b16 a[4:5], v21 offset:36864
    v_mfma_f32_16x16x32_bf16 v[184:187], a[28:31], a[184:187], v[184:187]
    ds_read_b64_tr_b16 a[6:7], v21 offset:38912
    v_mfma_f32_16x16x32_bf16 v[188:191], a[24:27], a[180:183], v[188:191]
    ds_read_b64_tr_b16 a[8:9], v18 offset:40960
    v_mfma_f32_16x16x32_bf16 v[188:191], a[28:31], a[188:191], v[188:191]
    ds_read_b64_tr_b16 a[10:11], v18 offset:43008
    s_waitcnt vmcnt(4) lgkmcnt(10)
    v_mfma_f32_16x16x32_bf16 v[160:163], a[32:35], a[192:195], v[160:163]
    ds_read_b64_tr_b16 a[12:13], v18 offset:45056
    v_mfma_f32_16x16x32_bf16 v[160:163], a[36:39], a[200:203], v[160:163]
    ds_read_b64_tr_b16 a[14:15], v18 offset:47104
    v_mfma_f32_16x16x32_bf16 v[164:167], a[32:35], a[196:199], v[164:167]
    ds_read_b64_tr_b16 a[16:17], v19 offset:40960
    v_mfma_f32_16x16x32_bf16 v[164:167], a[36:39], a[204:207], v[164:167]
    ds_read_b64_tr_b16 a[18:19], v19 offset:43008
    v_mfma_f32_16x16x32_bf16 v[168:171], a[40:43], a[192:195], v[168:171]
    ds_read_b64_tr_b16 a[20:21], v19 offset:45056
    v_mfma_f32_16x16x32_bf16 v[168:171], a[44:47], a[200:203], v[168:171]
    ds_read_b64_tr_b16 a[22:23], v19 offset:47104
    v_mfma_f32_16x16x32_bf16 v[172:175], a[40:43], a[196:199], v[172:175]
    ds_read_b64_tr_b16 a[24:25], v20 offset:40960
    v_mfma_f32_16x16x32_bf16 v[172:175], a[44:47], a[204:207], v[172:175]
    ds_read_b64_tr_b16 a[26:27], v20 offset:43008
    s_waitcnt lgkmcnt(10)
    v_mfma_f32_16x16x32_bf16 v[176:179], a[48:51], a[192:195], v[176:179]
    ds_read_b64_tr_b16 a[28:29], v20 offset:45056
    v_mfma_f32_16x16x32_bf16 v[176:179], a[52:55], a[200:203], v[176:179]
    ds_read_b64_tr_b16 a[30:31], v20 offset:47104
    v_mfma_f32_16x16x32_bf16 v[180:183], a[48:51], a[196:199], v[180:183]
    ds_read_b64_tr_b16 a[32:33], v21 offset:40960
    v_mfma_f32_16x16x32_bf16 v[180:183], a[52:55], a[204:207], v[180:183]
    ds_read_b64_tr_b16 a[34:35], v21 offset:43008
    v_mfma_f32_16x16x32_bf16 v[184:187], a[0:3], a[192:195], v[184:187]
    ds_read_b64_tr_b16 a[36:37], v21 offset:45056
    v_mfma_f32_16x16x32_bf16 v[184:187], a[4:7], a[200:203], v[184:187]
    ds_read_b64_tr_b16 a[38:39], v21 offset:47104
    v_mfma_f32_16x16x32_bf16 v[188:191], a[0:3], a[196:199], v[188:191]
    v_mfma_f32_16x16x32_bf16 v[188:191], a[4:7], a[204:207], v[188:191]
    s_waitcnt vmcnt(0) lgkmcnt(8)
    v_mfma_f32_16x16x32_bf16 v[160:163], a[8:11], a[208:211], v[160:163]
    v_mfma_f32_16x16x32_bf16 v[160:163], a[12:15], a[216:219], v[160:163]
    v_mfma_f32_16x16x32_bf16 v[164:167], a[8:11], a[212:215], v[164:167]
    v_mfma_f32_16x16x32_bf16 v[164:167], a[12:15], a[220:223], v[164:167]
    v_mfma_f32_16x16x32_bf16 v[168:171], a[16:19], a[208:211], v[168:171]
    v_mfma_f32_16x16x32_bf16 v[168:171], a[20:23], a[216:219], v[168:171]
    v_mfma_f32_16x16x32_bf16 v[172:175], a[16:19], a[212:215], v[172:175]
    v_mfma_f32_16x16x32_bf16 v[172:175], a[20:23], a[220:223], v[172:175]
    s_waitcnt lgkmcnt(0)
    v_mfma_f32_16x16x32_bf16 v[176:179], a[24:27], a[208:211], v[176:179]
    v_mfma_f32_16x16x32_bf16 v[176:179], a[28:31], a[216:219], v[176:179]
    v_mfma_f32_16x16x32_bf16 v[180:183], a[24:27], a[212:215], v[180:183]
    v_mfma_f32_16x16x32_bf16 v[180:183], a[28:31], a[220:223], v[180:183]
    v_mfma_f32_16x16x32_bf16 v[184:187], a[32:35], a[208:211], v[184:187]
    v_mfma_f32_16x16x32_bf16 v[184:187], a[36:39], a[216:219], v[184:187]
    v_mfma_f32_16x16x32_bf16 v[188:191], a[32:35], a[212:215], v[188:191]
    v_mfma_f32_16x16x32_bf16 v[188:191], a[36:39], a[220:223], v[188:191]
    v_pk_mul_f32 v[128:129], v[96:97], s[70:71] op_sel_hi:[1,0]
    v_pk_mul_f32 v[130:131], v[98:99], s[70:71] op_sel_hi:[1,0]
    v_pk_mul_f32 v[136:137], v[104:105], s[70:71] op_sel_hi:[1,0]
    v_pk_mul_f32 v[138:139], v[106:107], s[70:71] op_sel_hi:[1,0]
    v_exp_f32 v128, v128
    v_exp_f32 v129, v129
    v_exp_f32 v130, v130
    v_exp_f32 v131, v131
    v_exp_f32 v136, v136
    v_exp_f32 v137, v137
    v_exp_f32 v138, v138
    v_exp_f32_e64 v139, v139
    v_pk_mul_f32 v[160:161], v[160:161], v[96:97]
    v_pk_mul_f32 v[162:163], v[162:163], v[98:99]
    v_pk_mul_f32 v[168:169], v[168:169], v[104:105]
    v_pk_mul_f32 v[170:171], v[170:171], v[106:107]
    v_pk_add_f32 v[128:129], v[128:129], 1.0 op_sel_hi:[1,0]
    v_pk_add_f32 v[130:131], v[130:131], 1.0 op_sel_hi:[1,0]
    v_pk_add_f32 v[136:137], v[136:137], 1.0 op_sel_hi:[1,0]
    v_pk_add_f32 v[138:139], v[138:139], 1.0 op_sel_hi:[1,0]
    v_rcp_f32 v128, v128
    v_rcp_f32 v129, v129
    v_rcp_f32 v130, v130
    v_rcp_f32 v131, v131
    v_rcp_f32 v136, v136
    v_rcp_f32 v137, v137
    v_rcp_f32 v138, v138
    v_rcp_f32 v139, v139
    v_pk_fma_f32 v[224:225], v[160:161], v[128:129], v[224:225]
    v_pk_fma_f32 v[226:227], v[162:163], v[130:131], v[226:227]
    v_pk_fma_f32 v[228:229], v[168:169], v[136:137], v[228:229]
    v_pk_fma_f32 v[230:231], v[170:171], v[138:139], v[230:231]
    v_cvt_pk_bf16_f32 v80, v224, v225
    v_cvt_pk_bf16_f32 v82, v228, v229
    v_cvt_pk_bf16_f32 v81, v226, v227
    v_cvt_pk_bf16_f32 v83, v230, v231
    v_permlane16_swap_b32 v80, v82
    s_nop 0
    v_permlane16_swap_b32_e64 v81, v83
    buffer_store_dwordx4 v[80:83], v27, s[32:35], 0 offen
    v_pk_mul_f32 v[132:133], v[100:101], s[70:71] op_sel_hi:[1,0]
    v_pk_mul_f32 v[134:135], v[102:103], s[70:71] op_sel_hi:[1,0]
    v_pk_mul_f32 v[140:141], v[108:109], s[70:71] op_sel_hi:[1,0]
    v_pk_mul_f32 v[142:143], v[110:111], s[70:71] op_sel_hi:[1,0]
    v_exp_f32 v132, v132
    v_exp_f32 v133, v133
    v_exp_f32 v134, v134
    v_exp_f32 v135, v135
    v_exp_f32 v140, v140
    v_exp_f32 v141, v141
    v_exp_f32 v142, v142
    v_exp_f32 v143, v143
    v_pk_mul_f32 v[164:165], v[164:165], v[100:101]
    v_pk_mul_f32 v[166:167], v[166:167], v[102:103]
    v_pk_mul_f32 v[172:173], v[172:173], v[108:109]
    v_pk_mul_f32 v[174:175], v[174:175], v[110:111]
    v_pk_add_f32 v[132:133], v[132:133], 1.0 op_sel_hi:[1,0]
    v_pk_add_f32 v[134:135], v[134:135], 1.0 op_sel_hi:[1,0]
    v_pk_add_f32 v[140:141], v[140:141], 1.0 op_sel_hi:[1,0]
    v_pk_add_f32 v[142:143], v[142:143], 1.0 op_sel_hi:[1,0]
    v_rcp_f32 v132, v132
    v_rcp_f32 v133, v133
    v_rcp_f32 v134, v134
    v_rcp_f32 v135, v135
    v_rcp_f32 v140, v140
    v_rcp_f32 v141, v141
    v_rcp_f32 v142, v142
    v_rcp_f32 v143, v143
    v_pk_fma_f32 v[240:241], v[164:165], v[132:133], v[240:241]
    v_pk_fma_f32 v[242:243], v[166:167], v[134:135], v[242:243]
    v_pk_fma_f32 v[244:245], v[172:173], v[140:141], v[244:245]
    v_pk_fma_f32 v[246:247], v[174:175], v[142:143], v[246:247]
    v_cvt_pk_bf16_f32 v88, v240, v241
    v_cvt_pk_bf16_f32 v90, v244, v245
    v_cvt_pk_bf16_f32 v89, v242, v243
    v_cvt_pk_bf16_f32 v91, v246, v247
    v_permlane16_swap_b32 v88, v90
    s_nop 0
    v_permlane16_swap_b32_e64 v89, v91
    buffer_store_dwordx4 v[88:91], v27, s[32:35], s73 offen
    v_pk_mul_f32 v[144:145], v[112:113], s[70:71] op_sel_hi:[1,0]
    v_pk_mul_f32 v[146:147], v[114:115], s[70:71] op_sel_hi:[1,0]
    v_pk_mul_f32 v[152:153], v[120:121], s[70:71] op_sel_hi:[1,0]
    v_pk_mul_f32 v[154:155], v[122:123], s[70:71] op_sel_hi:[1,0]
    v_exp_f32 v144, v144
    v_exp_f32 v145, v145
    v_exp_f32 v146, v146
    v_exp_f32 v147, v147
    v_exp_f32 v152, v152
    v_exp_f32 v153, v153
    v_exp_f32 v154, v154
    v_exp_f32 v155, v155
    v_pk_mul_f32 v[176:177], v[176:177], v[112:113]
    v_pk_mul_f32 v[178:179], v[178:179], v[114:115]
    v_pk_mul_f32 v[184:185], v[184:185], v[120:121]
    v_pk_mul_f32 v[186:187], v[186:187], v[122:123]
    v_pk_add_f32 v[144:145], v[144:145], 1.0 op_sel_hi:[1,0]
    v_pk_add_f32 v[146:147], v[146:147], 1.0 op_sel_hi:[1,0]
    v_pk_add_f32 v[152:153], v[152:153], 1.0 op_sel_hi:[1,0]
    v_pk_add_f32 v[154:155], v[154:155], 1.0 op_sel_hi:[1,0]
    v_rcp_f32 v144, v144
    v_rcp_f32 v145, v145
    v_rcp_f32 v146, v146
    v_rcp_f32 v147, v147
    v_rcp_f32 v152, v152
    v_rcp_f32 v153, v153
    v_rcp_f32 v154, v154
    v_rcp_f32 v155, v155
    v_pk_fma_f32 v[232:233], v[176:177], v[144:145], v[232:233]
    v_pk_fma_f32 v[234:235], v[178:179], v[146:147], v[234:235]
    v_pk_fma_f32 v[236:237], v[184:185], v[152:153], v[236:237]
    v_pk_fma_f32 v[238:239], v[186:187], v[154:155], v[238:239]
    v_cvt_pk_bf16_f32 v84, v232, v233
    v_cvt_pk_bf16_f32 v86, v236, v237
    v_cvt_pk_bf16_f32 v85, v234, v235
    v_cvt_pk_bf16_f32 v87, v238, v239
    v_permlane16_swap_b32 v84, v86
    s_nop 0
    v_permlane16_swap_b32_e64 v85, v87
    buffer_store_dwordx4 v[84:87], v27, s[32:35], 0 offen offset:64
    v_pk_mul_f32 v[148:149], v[116:117], s[70:71] op_sel_hi:[1,0]
    v_pk_mul_f32 v[150:151], v[118:119], s[70:71] op_sel_hi:[1,0]
    v_pk_mul_f32 v[156:157], v[124:125], s[70:71] op_sel_hi:[1,0]
    v_pk_mul_f32 v[158:159], v[126:127], s[70:71] op_sel_hi:[1,0]
    v_exp_f32 v148, v148
    v_exp_f32 v149, v149
    v_exp_f32 v150, v150
    v_exp_f32 v151, v151
    v_exp_f32 v156, v156
    v_exp_f32 v157, v157
    v_exp_f32 v158, v158
    v_exp_f32 v159, v159
    v_pk_mul_f32 v[180:181], v[180:181], v[116:117]
    v_pk_mul_f32 v[182:183], v[182:183], v[118:119]
    v_pk_mul_f32 v[188:189], v[188:189], v[124:125]
    v_pk_mul_f32 v[190:191], v[190:191], v[126:127]
    v_pk_add_f32 v[148:149], v[148:149], 1.0 op_sel_hi:[1,0]
    v_pk_add_f32 v[150:151], v[150:151], 1.0 op_sel_hi:[1,0]
    v_pk_add_f32 v[156:157], v[156:157], 1.0 op_sel_hi:[1,0]
    v_pk_add_f32 v[158:159], v[158:159], 1.0 op_sel_hi:[1,0]
    v_rcp_f32 v148, v148
    v_rcp_f32 v149, v149
    v_rcp_f32 v150, v150
    v_rcp_f32 v151, v151
    v_rcp_f32 v156, v156
    v_rcp_f32 v157, v157
    v_rcp_f32 v158, v158
    v_rcp_f32 v159, v159
    v_pk_fma_f32 v[248:249], v[180:181], v[148:149], v[248:249]
    v_pk_fma_f32 v[250:251], v[182:183], v[150:151], v[250:251]
    v_pk_fma_f32 v[252:253], v[188:189], v[156:157], v[252:253]
    v_pk_fma_f32 v[254:255], v[190:191], v[158:159], v[254:255]
    v_cvt_pk_bf16_f32 v92, v248, v249
    v_cvt_pk_bf16_f32 v94, v252, v253
    v_cvt_pk_bf16_f32 v93, v250, v251
    v_cvt_pk_bf16_f32 v95, v254, v255
    v_permlane16_swap_b32 v92, v94
    s_nop 0
    v_permlane16_swap_b32 v93, v95
    buffer_store_dwordx4 v[92:95], v27, s[32:35], s73 offen offset:64
    s_endpgm
L_ev1:
L_pad1_16:
    s_cbranch_execz L_back1
    v_mov_b32 v14, 1
    s_mov_b64 exec, 1
    buffer_atomic_add v14, off, s[36:39], 0 sc1
    s_mov_b64 exec, -1
    s_branch L_evdone1
L_sw1:
    s_mov_b64 s[92:93], s[24:25]
    s_mov_b32 s94, s26
    s_cmp_ge_u32 s44, 3
    s_cselect_b64 s[92:93], s[28:29], s[92:93]
    s_cselect_b32 s94, s30, s94
    s_mov_b32 s95, 0x00020000
    s_mul_i32 s70, s2, 3
    s_add_u32 s70, s70, s44
    s_mul_i32 s70, s70, 1664
    s_mul_i32 s71, s2, 1408
    s_cmp_eq_u32 s44, 3
    s_cselect_b32 s69, s71, s70
    s_cselect_b32 s79, 11, 39
    s_cselect_b32 s71, 10, 12
    s_mov_b32 s3, -1
    s_lshl_b32 s79, s79, 15
    s_lshl_b32 s71, s71, 4
    v_min_u32 v0, s71, v13
    v_lshlrev_b32 v0, 3, v0
    s_branch L_swdone1
L_pc1_spin:
    s_mov_b32 s78, 0
L_pc1_loop:
    s_add_u32 s78, s78, 1
    buffer_load_dword v27, off, s[36:39], 0 sc1
    s_waitcnt vmcnt(0)
    v_cmp_le_u32 vcc, 0x100, v27
    s_nop 0
    s_cmp_eq_u64 vcc, -1
    s_cbranch_scc1 L_pc1_ok
    s_sleep 8
    s_cmp_lt_u32 s78, 65536
    s_cbranch_scc1 L_pc1_loop
    s_branch L_pc1_ok
L_phbb_spin:
    s_mov_b32 s78, 0
L_phbb_loop:
    s_add_u32 s78, s78, 1
    buffer_load_dword v225, v224, s[20:23], s76 offen sc1
    s_waitcnt vmcnt(0)
    v_cmp_le_u32 vcc, 1, v225
    s_nop 0
    s_cmp_eq_u64 vcc, -1
    s_cbranch_scc1 L_phbb_ok
    s_sleep 8
    s_cmp_lt_u32 s78, 65536
    s_cbranch_scc1 L_phbb_loop
    s_branch L_phbb_ok
L_prb_spin:
    s_mov_b32 s78, 0
L_prb_loop:
    s_add_u32 s78, s78, 1
    buffer_load_dword v25, v23, s[20:23], s77 offen sc1
    s_waitcnt vmcnt(0)
    v_cmp_le_u32 vcc, 1, v25
    s_nop 0
    s_cmp_eq_u64 vcc, -1
    s_cbranch_scc1 L_prb_ok
    s_sleep 8
    s_cmp_lt_u32 s78, 65536
    s_cbranch_scc1 L_prb_loop
    s_branch L_prb_ok
L_peb_spin:
    s_mov_b32 s78, 0
L_peb_loop:
    s_add_u32 s78, s78, 1
    buffer_load_dword v25, v23, s[20:23], s77 offen sc1
    s_waitcnt vmcnt(0)
    v_cmp_le_u32 vcc, 1, v25
    s_nop 0
    s_cmp_eq_u64 vcc, -1
    s_cbranch_scc1 L_peb_ok
    s_sleep 8
    s_cmp_lt_u32 s78, 65536
    s_cbranch_scc1 L_peb_loop
    s_branch L_peb_ok
L_pdb_spin:
    s_mov_b32 s78, 0
L_pdb_loop:
    s_add_u32 s78, s78, 1
    buffer_load_dword v24, v23, s[20:23], s65 offen sc1
    s_waitcnt vmcnt(0)
    v_cmp_le_u32 vcc, 1, v24
    s_nop 0
    s_cmp_eq_u64 vcc, -1
    s_cbranch_scc1 L_pdb_ok
    s_sleep 8
    s_cmp_lt_u32 s78, 65536
    s_cbranch_scc1 L_pdb_loop
    s_branch L_pdb_ok
L_px1b_spin:
    s_mov_b32 s78, 0
L_px1b_loop:
    s_add_u32 s78, s78, 1
    buffer_load_dword v25, off, s[20:23], s77 sc1
    s_waitcnt vmcnt(0)
    v_cmp_le_u32 vcc, 1, v25
    s_nop 0
    s_cmp_eq_u64 vcc, -1
    s_cbranch_scc1 L_px1b_ok
    s_sleep 8
    s_cmp_lt_u32 s78, 65536
    s_cbranch_scc1 L_px1b_loop
    s_branch L_px1b_ok
L_px2b_spin:
    s_mov_b32 s78, 0
L_px2b_loop:
    s_add_u32 s78, s78, 1
    buffer_load_dword v25, off, s[20:23], s77 sc1
    s_waitcnt vmcnt(0)
    v_cmp_le_u32 vcc, 2, v25
    s_nop 0
    s_cmp_eq_u64 vcc, -1
    s_cbranch_scc1 L_px2b_ok
    s_sleep 8
    s_cmp_lt_u32 s78, 65536
    s_cbranch_scc1 L_px2b_loop
    s_branch L_px2b_ok
L_px3b_spin:
    s_mov_b32 s78, 0
L_px3b_loop:
    s_add_u32 s78, s78, 1
    buffer_load_dword v25, off, s[20:23], s77 sc1
    s_waitcnt vmcnt(0)
    v_cmp_le_u32 vcc, 3, v25
    s_nop 0
    s_cmp_eq_u64 vcc, -1
    s_cbranch_scc1 L_px3b_ok
    s_sleep 8
    s_cmp_lt_u32 s78, 65536
    s_cbranch_scc1 L_px3b_loop
    s_branch L_px3b_ok
L_phb2b_spin:
    s_mov_b32 s78, 0
L_phb2b_loop:
    s_add_u32 s78, s78, 1
    buffer_load_dword v24, v22, s[20:23], s76 offen sc1
    s_waitcnt vmcnt(0)
    v_cmp_le_u32 vcc, 2, v24
    s_nop 0
    s_cmp_eq_u64 vcc, -1
    s_cbranch_scc1 L_phb2b_ok
    s_sleep 8
    s_cmp_lt_u32 s78, 65536
    s_cbranch_scc1 L_phb2b_loop
    s_branch L_phb2b_ok
L_phab_spin:
    s_mov_b32 s78, 0
L_phab_loop:
    s_add_u32 s78, s78, 1
    buffer_load_dword v24, v22, s[20:23], s76 offen sc1
    s_waitcnt vmcnt(0)
    v_cmp_le_u32 vcc, 1, v24
    s_nop 0
    s_cmp_eq_u64 vcc, -1
    s_cbranch_scc1 L_phab_ok
    s_sleep 8
    s_cmp_lt_u32 s78, 65536
    s_cbranch_scc1 L_phab_loop
    s_branch L_phab_ok
L_pha2b_spin:
    s_mov_b32 s78, 0
L_pha2b_loop:
    s_add_u32 s78, s78, 1
    buffer_load_dword v24, v22, s[20:23], s76 offen sc1
    s_waitcnt vmcnt(0)
    v_cmp_le_u32 vcc, 2, v24
    s_nop 0
    s_cmp_eq_u64 vcc, -1
    s_cbranch_scc1 L_pha2b_ok
    s_sleep 8
    s_cmp_lt_u32 s78, 65536
    s_cbranch_scc1 L_pha2b_loop
    s_branch L_pha2b_ok
L_pob_spin:
    s_mov_b32 s78, 0
L_pob_loop:
    s_add_u32 s78, s78, 1
    buffer_load_dword v24, v22, s[20:23], s76 offen sc1
    s_waitcnt vmcnt(0)
    v_cmp_le_u32 vcc, 1, v24
    s_nop 0
    s_cmp_eq_u64 vcc, -1
    s_cbranch_scc1 L_pob_ok
    s_sleep 8
    s_cmp_lt_u32 s78, 65536
    s_cbranch_scc1 L_pob_loop
    s_branch L_pob_ok
L_first1:
L_pad1_17:
    s_cbranch_execz L_back1
    s_waitcnt lgkmcnt(15)
    v_mfma_f32_16x16x32_bf16 a[0:3], a[224:227], a[96:99], 0
    ds_read_b64_tr_b16 a[232:233], v4
    v_mov_b32_dpp v28, v28 row_ror:7 row_mask:0xf bank_mask:0xf
    s_waitcnt lgkmcnt(15)
    v_mfma_f32_16x16x32_bf16 a[0:3], a[228:231], a[100:103], a[0:3]
    ds_read_b64_tr_b16 a[234:235], v4 offset:512
    v_mov_b32_dpp v29, v29 row_ror:7 row_mask:0xf bank_mask:0xf
    s_waitcnt lgkmcnt(15)
    v_mfma_f32_16x16x32_bf16 a[4:7], a[224:227], a[104:107], 0
    ds_read_b64_tr_b16 a[236:237], v6
    v_mov_b32_dpp v30, v30 row_ror:7 row_mask:0xf bank_mask:0xf
    s_waitcnt lgkmcnt(15)
    v_mfma_f32_16x16x32_bf16 a[4:7], a[228:231], a[108:111], a[4:7]
    ds_read_b64_tr_b16 a[238:239], v6 offset:512
    v_mov_b32_dpp v31, v31 row_ror:7 row_mask:0xf bank_mask:0xf
    s_waitcnt lgkmcnt(15)
    v_mfma_f32_16x16x32_bf16 a[8:11], a[224:227], a[112:115], 0
    s_add_u32 m0, s66, 12288
    s_add_u32 s74, s64, 0
    buffer_load_dwordx4 v11, s[12:15], s74 offen lds
    s_waitcnt lgkmcnt(14)
    v_mfma_f32_16x16x32_bf16 a[8:11], a[228:231], a[116:119], a[8:11]
    s_add_u32 m0, s66, 53248
L_pad1_18:
    s_cbranch_execz L_back1
    s_add_u32 s74, s74, 229376
    s_lshl2_add_u32 s70, s47, s50
    s_waitcnt lgkmcnt(13)
    v_mfma_f32_16x16x32_bf16 a[12:15], a[224:227], a[120:123], 0
    s_lshl_b32 s70, s70, 7
    s_waitcnt lgkmcnt(12)
    v_mfma_f32_16x16x32_bf16 a[12:15], a[228:231], a[124:127], a[12:15]
    buffer_load_dwordx4 v11, s[12:15], s74 offen lds
    s_lshl2_add_u32 s70, s51, s70
    s_waitcnt lgkmcnt(11)
    v_mfma_f32_16x16x32_bf16 a[16:19], a[224:227], a[128:131], 0
    s_add_u32 s81, s70, 34148352
    s_waitcnt lgkmcnt(10)
    v_mfma_f32_16x16x32_bf16 a[16:19], a[228:231], a[132:135], a[16:19]
    s_waitcnt lgkmcnt(9)
    v_mfma_f32_16x16x32_bf16 a[20:23], a[224:227], a[136:139], 0
    s_add_u32 m0, s66, 16384
    s_add_u32 s74, s65, 0
    buffer_load_dwordx4 v11, s[16:19], s74 offen lds
    s_waitcnt lgkmcnt(8)
    v_mfma_f32_16x16x32_bf16 a[20:23], a[228:231], a[140:143], a[20:23]
    s_lshl_b32 s70, s47, 7
    s_lshl2_add_u32 s70, s48, s70
    s_waitcnt lgkmcnt(7)
    v_mfma_f32_16x16x32_bf16 a[24:27], a[224:227], a[144:147], 0
    s_waitcnt lgkmcnt(6)
    v_mfma_f32_16x16x32_bf16 a[24:27], a[228:231], a[148:151], a[24:27]
    s_add_u32 s82, s70, 34160640
    s_waitcnt lgkmcnt(5)
    v_mfma_f32_16x16x32_bf16 a[28:31], a[224:227], a[152:155], 0
    v_mfma_f32_16x16x32_bf16 a[240:243], v[28:31], a[224:227], 0
    s_lshl_b32 s70, s48, 7
    s_waitcnt lgkmcnt(4)
    v_mfma_f32_16x16x32_bf16 a[28:31], a[228:231], a[156:159], a[28:31]
    s_waitcnt vmcnt(6) lgkmcnt(0)
    s_barrier
    v_mfma_f32_16x16x32_bf16 a[32:35], a[232:235], a[96:99], 0
    ds_read_b64_tr_b16 a[224:225], v3 offset:4096
    v_mfma_f32_16x16x32_bf16 a[32:35], a[236:239], a[100:103], a[32:35]
    ds_read_b64_tr_b16 a[226:227], v3 offset:4608
    v_mfma_f32_16x16x32_bf16 a[36:39], a[232:235], a[104:107], 0
    ds_read_b64_tr_b16 a[228:229], v5 offset:4096
    v_mfma_f32_16x16x32_bf16 a[36:39], a[236:239], a[108:111], a[36:39]
    ds_read_b64_tr_b16 a[230:231], v5 offset:4608
    v_mfma_f32_16x16x32_bf16 a[40:43], a[232:235], a[112:115], 0
    v_mov_b32_dpp v28, v28 row_ror:1 row_mask:0xf bank_mask:0xf
    s_add_u32 m0, s66, 57344
    v_mfma_f32_16x16x32_bf16 a[40:43], a[236:239], a[116:119], a[40:43]
    s_add_u32 s74, s74, 229376
    buffer_load_dwordx4 v11, s[16:19], s74 offen lds
    s_lshl2_add_u32 s70, s47, s70
    v_mfma_f32_16x16x32_bf16 a[44:47], a[232:235], a[120:123], 0
    v_mov_b32_dpp v29, v29 row_ror:1 row_mask:0xf bank_mask:0xf
    s_add_u32 m0, s67, 32768
    v_mfma_f32_16x16x32_bf16 a[44:47], a[236:239], a[124:127], a[44:47]
    s_mov_b32 s74, 128
    s_add_u32 s83, s70, 34156544
    s_lshl_b32 s70, s2, 7
    v_mfma_f32_16x16x32_bf16 a[48:51], a[232:235], a[128:131], 0
    v_mov_b32_dpp v30, v30 row_ror:1 row_mask:0xf bank_mask:0xf
    s_lshl2_add_u32 s70, s44, s70
    v_mfma_f32_16x16x32_bf16 a[48:51], a[236:239], a[132:135], a[48:51]
    buffer_load_dwordx4 v9, s[4:7], s74 offen lds
    s_add_u32 s84, s70, 34177024
    s_and_b32 s70, s2, 31
    v_mfma_f32_16x16x32_bf16 a[52:55], a[232:235], a[136:139], 0
    v_mov_b32_dpp v31, v31 row_ror:1 row_mask:0xf bank_mask:0xf
    s_lshl_b32 s70, s70, 7
    v_mfma_f32_16x16x32_bf16 a[52:55], a[236:239], a[140:143], a[52:55]
    s_lshl2_add_u32 s70, s47, s70
    v_mfma_f32_16x16x32_bf16 a[56:59], a[232:235], a[144:147], 0
    s_add_u32 m0, s67, 34816
    s_mov_b32 s74, 32896
    buffer_load_dwordx4 v9, s[4:7], s74 offen lds
    v_mfma_f32_16x16x32_bf16 a[56:59], a[236:239], a[148:151], a[56:59]
    s_add_u32 s50, s70, 34164736
    v_mfma_f32_16x16x32_bf16 a[60:63], a[232:235], a[152:155], 0
    v_mfma_f32_16x16x32_bf16 a[240:243], v[28:31], a[232:235], a[240:243]
    s_lshl_b32 s70, s2, 3
    v_mfma_f32_16x16x32_bf16 a[60:63], a[236:239], a[156:159], a[60:63]
    s_waitcnt lgkmcnt(0)
    v_mfma_f32_16x16x32_bf16 v[32:35], a[224:227], a[96:99], 0
    ds_read_b64_tr_b16 a[232:233], v4 offset:4096
    v_mov_b32_dpp v28, v28 row_ror:1 row_mask:0xf bank_mask:0xf
    v_mfma_f32_16x16x32_bf16 v[32:35], a[228:231], a[100:103], v[32:35]
    ds_read_b64_tr_b16 a[234:235], v4 offset:4608
    v_mov_b32_dpp v29, v29 row_ror:1 row_mask:0xf bank_mask:0xf
    v_mfma_f32_16x16x32_bf16 v[36:39], a[224:227], a[104:107], 0
    ds_read_b64_tr_b16 a[236:237], v6 offset:4096
    v_mov_b32_dpp v30, v30 row_ror:1 row_mask:0xf bank_mask:0xf
    v_mfma_f32_16x16x32_bf16 v[36:39], a[228:231], a[108:111], v[36:39]
    ds_read_b64_tr_b16 a[238:239], v6 offset:4608
    v_mov_b32_dpp v31, v31 row_ror:1 row_mask:0xf bank_mask:0xf
    v_mfma_f32_16x16x32_bf16 v[40:43], a[224:227], a[112:115], 0
    s_add_u32 m0, s67, 36864
    s_mov_b32 s74, 65664
    buffer_load_dwordx4 v9, s[4:7], s74 offen lds
    v_mfma_f32_16x16x32_bf16 v[40:43], a[228:231], a[116:119], v[40:43]
    s_lshl1_add_u32 s70, s44, s70
    s_lshl_b32 s101, s70, 11
    s_lshl_b32 s71, s70, 3
    v_mfma_f32_16x16x32_bf16 v[44:47], a[224:227], a[120:123], 0
    s_add_u32 s85, s71, 34111488
    s_lshr_b32 s71, s70, 7
    v_mfma_f32_16x16x32_bf16 v[44:47], a[228:231], a[124:127], v[44:47]
    s_add_u32 m0, s67, 38912
    s_mov_b32 s74, 98432
    buffer_load_dwordx4 v9, s[4:7], s74 offen lds
    v_mfma_f32_16x16x32_bf16 v[48:51], a[224:227], a[128:131], 0
    s_lshl_b32 s71, s71, 4
    v_mfma_f32_16x16x32_bf16 v[48:51], a[228:231], a[132:135], v[48:51]
    s_and_b32 s72, s70, 15
    v_mfma_f32_16x16x32_bf16 v[52:55], a[224:227], a[136:139], 0
    s_add_u32 s71, s71, s72
    v_mfma_f32_16x16x32_bf16 v[52:55], a[228:231], a[140:143], v[52:55]
    v_mfma_f32_16x16x32_bf16 v[56:59], a[224:227], a[144:147], 0
    s_bfe_u32 s72, s70, 0x30004
    v_mfma_f32_16x16x32_bf16 v[56:59], a[228:231], a[148:151], v[56:59]
    s_add_u32 m0, s67, 40960
    s_mov_b32 s74, 131200
    buffer_load_dwordx4 v9, s[4:7], s74 offen lds
    v_mfma_f32_16x16x32_bf16 v[60:63], a[224:227], a[152:155], 0
    v_mfma_f32_16x16x32_bf16 a[240:243], v[28:31], a[224:227], a[240:243]
    s_lshl3_add_u32 s71, s71, s72
    v_mfma_f32_16x16x32_bf16 v[60:63], a[228:231], a[156:159], v[60:63]
    s_waitcnt vmcnt(10) lgkmcnt(0)
    s_barrier
    v_mfma_f32_16x16x32_bf16 v[64:67], a[232:235], a[96:99], 0
    ds_read_b64_tr_b16 a[224:225], v3 offset:8192
    v_mfma_f32_16x16x32_bf16 v[64:67], a[236:239], a[100:103], v[64:67]
    ds_read_b64_tr_b16 a[226:227], v3 offset:8704
    v_mfma_f32_16x16x32_bf16 v[68:71], a[232:235], a[104:107], 0
    ds_read_b64_tr_b16 a[228:229], v5 offset:8192
    v_mfma_f32_16x16x32_bf16 v[68:71], a[236:239], a[108:111], v[68:71]
    ds_read_b64_tr_b16 a[230:231], v5 offset:8704
    v_mfma_f32_16x16x32_bf16 v[72:75], a[232:235], a[112:115], 0
    v_mov_b32_dpp v28, v28 row_ror:1 row_mask:0xf bank_mask:0xf
    s_add_u32 m0, s67, 43008
    v_mfma_f32_16x16x32_bf16 v[72:75], a[236:239], a[116:119], v[72:75]
    s_mov_b32 s74, 163968
    buffer_load_dwordx4 v9, s[4:7], s74 offen lds
    s_lshl_b32 s71, s71, 2
    v_mfma_f32_16x16x32_bf16 v[76:79], a[232:235], a[120:123], 0
    v_mov_b32_dpp v29, v29 row_ror:1 row_mask:0xf bank_mask:0xf
    s_add_u32 s99, s71, 34086912
    v_mfma_f32_16x16x32_bf16 v[76:79], a[236:239], a[124:127], v[76:79]
    s_lshr_b32 s71, s70, 5
    s_bfe_u32 s72, s70, 0x20002
    s_lshl2_add_u32 s71, s71, s72
    v_mfma_f32_16x16x32_bf16 v[80:83], a[232:235], a[128:131], 0
    v_mov_b32_dpp v30, v30 row_ror:1 row_mask:0xf bank_mask:0xf
    s_bfe_u32 s72, s70, 0x10004
    v_mfma_f32_16x16x32_bf16 v[80:83], a[236:239], a[132:135], v[80:83]
    s_add_u32 m0, s67, 45056
    s_mov_b32 s74, 196736
    buffer_load_dwordx4 v9, s[4:7], s74 offen lds
    v_mfma_f32_16x16x32_bf16 v[84:87], a[232:235], a[136:139], 0
    v_mov_b32_dpp v31, v31 row_ror:1 row_mask:0xf bank_mask:0xf
    s_lshl1_add_u32 s71, s71, s72
    v_mfma_f32_16x16x32_bf16 v[84:87], a[236:239], a[140:143], v[84:87]
    s_and_b32 s72, s70, 3
    v_mfma_f32_16x16x32_bf16 v[88:91], a[232:235], a[144:147], 0
    s_lshl2_add_u32 s71, s71, s72
    v_mfma_f32_16x16x32_bf16 v[88:91], a[236:239], a[148:151], v[88:91]
    s_lshl_b32 s71, s71, 1
    v_mfma_f32_16x16x32_bf16 v[92:95], a[232:235], a[152:155], 0
    v_mfma_f32_16x16x32_bf16 a[240:243], v[28:31], a[232:235], a[240:243]
    s_add_u32 m0, s67, 47104
    s_mov_b32 s74, 229504
    buffer_load_dwordx4 v9, s[4:7], s74 offen lds
    v_mfma_f32_16x16x32_bf16 v[92:95], a[236:239], a[156:159], v[92:95]
    s_add_u32 s100, s71, 34095104
    s_waitcnt lgkmcnt(0)
    v_mfma_f32_16x16x32_bf16 v[96:99], a[224:227], a[96:99], 0
    ds_read_b64_tr_b16 a[232:233], v4 offset:8192
    v_mov_b32_dpp v28, v28 row_ror:1 row_mask:0xf bank_mask:0xf
    v_mfma_f32_16x16x32_bf16 v[96:99], a[228:231], a[100:103], v[96:99]
    ds_read_b64_tr_b16 a[234:235], v4 offset:8704
    v_mov_b32_dpp v29, v29 row_ror:1 row_mask:0xf bank_mask:0xf
    v_mfma_f32_16x16x32_bf16 v[100:103], a[224:227], a[104:107], 0
    ds_read_b64_tr_b16 a[236:237], v6 offset:8192
    v_mov_b32_dpp v30, v30 row_ror:1 row_mask:0xf bank_mask:0xf
    v_mfma_f32_16x16x32_bf16 v[100:103], a[228:231], a[108:111], v[100:103]
    ds_read_b64_tr_b16 a[238:239], v6 offset:8704
    v_mov_b32_dpp v31, v31 row_ror:1 row_mask:0xf bank_mask:0xf
    v_mfma_f32_16x16x32_bf16 v[104:107], a[224:227], a[112:115], 0
    s_add_u32 m0, s66, 20480
    s_add_u32 s74, s61, 393216
    buffer_load_dwordx4 v10, s[8:11], s74 offen lds
    v_mfma_f32_16x16x32_bf16 v[104:107], a[228:231], a[116:119], v[104:107]
    v_mfma_f32_16x16x32_bf16 v[108:111], a[224:227], a[120:123], 0
    v_lshrrev_b32 v27, 9, v13
    v_mfma_f32_16x16x32_bf16 v[108:111], a[228:231], a[124:127], v[108:111]
    v_mfma_f32_16x16x32_bf16 v[112:115], a[224:227], a[128:131], 0
    v_mfma_f32_16x16x32_bf16 v[112:115], a[228:231], a[132:135], v[112:115]
    v_mul_u32_u24 v22, 1536, v27
    v_mfma_f32_16x16x32_bf16 v[116:119], a[224:227], a[136:139], 0
    s_add_u32 m0, s66, 61440
    s_add_u32 s74, s74, 196608
    buffer_load_dwordx4 v10, s[8:11], s74 offen lds
    v_mfma_f32_16x16x32_bf16 v[116:119], a[228:231], a[140:143], v[116:119]
    v_mfma_f32_16x16x32_bf16 v[120:123], a[224:227], a[144:147], 0
    v_mfma_f32_16x16x32_bf16 v[120:123], a[228:231], a[148:151], v[120:123]
    v_lshlrev_b32 v27, 11, v27
    v_mfma_f32_16x16x32_bf16 v[124:127], a[224:227], a[152:155], 0
    v_mfma_f32_16x16x32_bf16 a[240:243], v[28:31], a[224:227], a[240:243]
    v_mfma_f32_16x16x32_bf16 v[124:127], a[228:231], a[156:159], v[124:127]
    s_waitcnt vmcnt(12) lgkmcnt(0)
    s_barrier
    v_mfma_f32_16x16x32_bf16 v[128:131], a[232:235], a[96:99], 0
    ds_read_b64_tr_b16 a[224:225], v3 offset:12288
    v_mfma_f32_16x16x32_bf16 v[128:131], a[236:239], a[100:103], v[128:131]
    ds_read_b64_tr_b16 a[226:227], v3 offset:12800
    v_mfma_f32_16x16x32_bf16 v[132:135], a[232:235], a[104:107], 0
    ds_read_b64_tr_b16 a[228:229], v5 offset:12288
    v_mfma_f32_16x16x32_bf16 v[132:135], a[236:239], a[108:111], v[132:135]
    ds_read_b64_tr_b16 a[230:231], v5 offset:12800
    v_mfma_f32_16x16x32_bf16 v[136:139], a[232:235], a[112:115], 0
    v_mov_b32_dpp v28, v28 row_ror:1 row_mask:0xf bank_mask:0xf
    s_add_u32 m0, s66, 24576
    v_mfma_f32_16x16x32_bf16 v[136:139], a[236:239], a[116:119], v[136:139]
    s_add_u32 s74, s62, 458752
    buffer_load_dwordx4 v11, s[12:15], s74 offen lds
    v_add_u32 v22, v22, v13
    v_mfma_f32_16x16x32_bf16 v[140:143], a[232:235], a[120:123], 0
    v_mov_b32_dpp v29, v29 row_ror:1 row_mask:0xf bank_mask:0xf
    s_add_u32 m0, s66, 65536
    v_mfma_f32_16x16x32_bf16 v[140:143], a[236:239], a[124:127], v[140:143]
    s_add_u32 s74, s74, 229376
    buffer_load_ushort v27, v27, s[4:7], s101 offen
    buffer_load_dwordx4 v[14:17], v22, s[4:7], s101 offen
    v_mfma_f32_16x16x32_bf16 v[144:147], a[232:235], a[128:131], 0
    v_mov_b32_dpp v30, v30 row_ror:1 row_mask:0xf bank_mask:0xf
    v_mfma_f32_16x16x32_bf16 v[144:147], a[236:239], a[132:135], v[144:147]
    buffer_load_dwordx4 v11, s[12:15], s74 offen lds
    v_mfma_f32_16x16x32_bf16 v[148:151], a[232:235], a[136:139], 0
    v_mov_b32_dpp v31, v31 row_ror:1 row_mask:0xf bank_mask:0xf
    v_mfma_f32_16x16x32_bf16 v[148:151], a[236:239], a[140:143], v[148:151]
    s_add_u32 m0, s66, 28672
    s_add_u32 s74, s63, 458752
    v_mfma_f32_16x16x32_bf16 v[152:155], a[232:235], a[144:147], 0
    buffer_load_dwordx4 v11, s[16:19], s74 offen lds
    v_mfma_f32_16x16x32_bf16 v[152:155], a[236:239], a[148:151], v[152:155]
    v_mfma_f32_16x16x32_bf16 v[156:159], a[232:235], a[152:155], 0
    v_mfma_f32_16x16x32_bf16 a[240:243], v[28:31], a[232:235], a[240:243]
    buffer_load_dwordx4 v[18:21], v22, s[4:7], s101 offen offset:512
    v_mfma_f32_16x16x32_bf16 v[156:159], a[236:239], a[156:159], v[156:159]
    s_waitcnt lgkmcnt(0)
    v_mfma_f32_16x16x32_bf16 v[160:163], a[224:227], a[96:99], 0
    ds_read_b64_tr_b16 a[232:233], v4 offset:12288
    v_mov_b32_dpp v28, v28 row_ror:1 row_mask:0xf bank_mask:0xf
    v_mfma_f32_16x16x32_bf16 v[160:163], a[228:231], a[100:103], v[160:163]
    ds_read_b64_tr_b16 a[234:235], v4 offset:12800
    v_mov_b32_dpp v29, v29 row_ror:1 row_mask:0xf bank_mask:0xf
    v_mfma_f32_16x16x32_bf16 v[164:167], a[224:227], a[104:107], 0
    ds_read_b64_tr_b16 a[236:237], v6 offset:12288
    v_mov_b32_dpp v30, v30 row_ror:1 row_mask:0xf bank_mask:0xf
    v_mfma_f32_16x16x32_bf16 v[164:167], a[228:231], a[108:111], v[164:167]
    ds_read_b64_tr_b16 a[238:239], v6 offset:12800
    v_mov_b32_dpp v31, v31 row_ror:1 row_mask:0xf bank_mask:0xf
    v_mfma_f32_16x16x32_bf16 v[168:171], a[224:227], a[112:115], 0
    s_add_u32 m0, s66, 69632
    s_add_u32 s74, s74, 229376
    buffer_load_dwordx4 v11, s[16:19], s74 offen lds
    v_mfma_f32_16x16x32_bf16 v[168:171], a[228:231], a[116:119], v[168:171]
    v_mfma_f32_16x16x32_bf16 v[172:175], a[224:227], a[120:123], 0
    v_mfma_f32_16x16x32_bf16 v[172:175], a[228:231], a[124:127], v[172:175]
    s_add_u32 m0, s67, 0
    s_mov_b32 s74, 256
    buffer_load_dwordx4 v9, s[4:7], s74 offen lds
    v_mfma_f32_16x16x32_bf16 v[176:179], a[224:227], a[128:131], 0
    v_mfma_f32_16x16x32_bf16 v[176:179], a[228:231], a[132:135], v[176:179]
    buffer_load_dwordx4 a[244:247], v22, s[4:7], s101 offen offset:1024
    v_mfma_f32_16x16x32_bf16 v[180:183], a[224:227], a[136:139], 0
    v_mfma_f32_16x16x32_bf16 v[180:183], a[228:231], a[140:143], v[180:183]
    buffer_load_dwordx4 a[248:251], v22, s[4:7], s101 offen offset:1536
    v_mfma_f32_16x16x32_bf16 v[184:187], a[224:227], a[144:147], 0
    v_mfma_f32_16x16x32_bf16 v[184:187], a[228:231], a[148:151], v[184:187]
    s_add_u32 m0, s67, 2048
    s_mov_b32 s74, 33024
    buffer_load_dwordx4 v9, s[4:7], s74 offen lds
    v_mfma_f32_16x16x32_bf16 v[188:191], a[224:227], a[152:155], 0
    v_mfma_f32_16x16x32_bf16 a[240:243], v[28:31], a[224:227], a[240:243]
    v_mfma_f32_16x16x32_bf16 v[188:191], a[228:231], a[156:159], v[188:191]
    s_waitcnt vmcnt(16) lgkmcnt(0)
    s_barrier
    v_mfma_f32_16x16x32_bf16 v[192:195], a[232:235], a[96:99], 0
    ds_read_b64_tr_b16 a[224:225], v3 offset:16384
    v_mfma_f32_16x16x32_bf16 v[192:195], a[236:239], a[100:103], v[192:195]
    ds_read_b64_tr_b16 a[226:227], v3 offset:16896
    v_mfma_f32_16x16x32_bf16 v[196:199], a[232:235], a[104:107], 0
    ds_read_b64_tr_b16 a[228:229], v5 offset:16384
    v_mfma_f32_16x16x32_bf16 v[196:199], a[236:239], a[108:111], v[196:199]
    ds_read_b64_tr_b16 a[230:231], v5 offset:16896
    v_mfma_f32_16x16x32_bf16 v[200:203], a[232:235], a[112:115], 0
    ds_read_b128 a[160:163], v1 offset:32768
    v_mfma_f32_16x16x32_bf16 v[200:203], a[236:239], a[116:119], v[200:203]
    ds_read_b128 a[164:167], v2 offset:32768
    v_mfma_f32_16x16x32_bf16 v[204:207], a[232:235], a[120:123], 0
    ds_read_b128 a[168:171], v1 offset:34816
    v_mfma_f32_16x16x32_bf16 v[204:207], a[236:239], a[124:127], v[204:207]
    ds_read_b128 a[172:175], v2 offset:34816
    v_mfma_f32_16x16x32_bf16 v[208:211], a[232:235], a[128:131], 0
    ds_read_b128 a[176:179], v1 offset:36864
    v_mov_b32_dpp v28, v28 row_ror:1 row_mask:0xf bank_mask:0xf
    v_mfma_f32_16x16x32_bf16 v[208:211], a[236:239], a[132:135], v[208:211]
    v_mov_b32_dpp v29, v29 row_ror:1 row_mask:0xf bank_mask:0xf
    v_mfma_f32_16x16x32_bf16 v[212:215], a[232:235], a[136:139], 0
    v_mov_b32_dpp v30, v30 row_ror:1 row_mask:0xf bank_mask:0xf
    v_mfma_f32_16x16x32_bf16 v[212:215], a[236:239], a[140:143], v[212:215]
    v_mov_b32_dpp v31, v31 row_ror:1 row_mask:0xf bank_mask:0xf
    v_mfma_f32_16x16x32_bf16 v[216:219], a[232:235], a[144:147], 0
    buffer_load_dword a254, v0, s[92:95], s69 offen
    s_add_u32 s69, s69, s77
    s_and_b32 s69, s69, s3
    v_mfma_f32_16x16x32_bf16 v[216:219], a[236:239], a[148:151], v[216:219]
    s_add_u32 m0, s67, 4096
    s_mov_b32 s74, 65792
    buffer_load_dwordx4 v9, s[4:7], s74 offen lds
    v_mfma_f32_16x16x32_bf16 v[220:223], a[232:235], a[152:155], 0
    v_mfma_f32_16x16x32_bf16 a[240:243], v[28:31], a[232:235], a[240:243]
    s_add_u32 m0, s66, 32768
    s_add_u32 s74, s64, 458752
    v_mfma_f32_16x16x32_bf16 v[220:223], a[236:239], a[156:159], v[220:223]
    s_waitcnt lgkmcnt(5)
    v_mfma_f32_16x16x32_bf16 v[224:227], a[224:227], a[96:99], 0
    ds_read_b64_tr_b16 a[232:233], v4 offset:16384
    v_mov_b32_dpp v28, v28 row_ror:1 row_mask:0xf bank_mask:0xf
    v_mfma_f32_16x16x32_bf16 v[224:227], a[228:231], a[100:103], v[224:227]
    ds_read_b64_tr_b16 a[234:235], v4 offset:16896
    v_mov_b32_dpp v29, v29 row_ror:1 row_mask:0xf bank_mask:0xf
    v_mfma_f32_16x16x32_bf16 v[228:231], a[224:227], a[104:107], 0
    ds_read_b64_tr_b16 a[236:237], v6 offset:16384
    v_mov_b32_dpp v30, v30 row_ror:1 row_mask:0xf bank_mask:0xf
    v_mfma_f32_16x16x32_bf16 v[228:231], a[228:231], a[108:111], v[228:231]
    ds_read_b64_tr_b16 a[238:239], v6 offset:16896
    v_mov_b32_dpp v31, v31 row_ror:1 row_mask:0xf bank_mask:0xf
    v_mfma_f32_16x16x32_bf16 v[232:235], a[224:227], a[112:115], 0
    ds_read_b128 a[180:183], v2 offset:36864
    buffer_load_dwordx4 v11, s[12:15], s74 offen lds
    v_mfma_f32_16x16x32_bf16 v[232:235], a[228:231], a[116:119], v[232:235]
    ds_read_b128 a[184:187], v1 offset:38912
    s_add_u32 m0, s66, 73728
    v_mfma_f32_16x16x32_bf16 v[236:239], a[224:227], a[120:123], 0
    ds_read_b128 a[188:191], v2 offset:38912
    s_add_u32 s74, s74, 229376
    v_mfma_f32_16x16x32_bf16 v[236:239], a[228:231], a[124:127], v[236:239]
    ds_read_b128 a[192:195], v1 offset:40960
    buffer_load_dwordx4 v11, s[12:15], s74 offen lds
    v_mfma_f32_16x16x32_bf16 v[240:243], a[224:227], a[128:131], 0
    ds_read_b128 a[196:199], v2 offset:40960
    v_mfma_f32_16x16x32_bf16 v[240:243], a[228:231], a[132:135], v[240:243]
    v_mfma_f32_16x16x32_bf16 v[244:247], a[224:227], a[136:139], 0
    s_add_u32 m0, s66, 36864
    s_add_u32 s74, s65, 458752
    buffer_load_dwordx4 v11, s[16:19], s74 offen lds
    v_mfma_f32_16x16x32_bf16 v[244:247], a[228:231], a[140:143], v[244:247]
    v_mfma_f32_16x16x32_bf16 v[248:251], a[224:227], a[144:147], 0
    v_mfma_f32_16x16x32_bf16 v[248:251], a[228:231], a[148:151], v[248:251]
    v_mfma_f32_16x16x32_bf16 v[252:255], a[224:227], a[152:155], 0
    v_mfma_f32_16x16x32_bf16 a[240:243], v[28:31], a[224:227], a[240:243]
    v_mfma_f32_16x16x32_bf16 v[252:255], a[228:231], a[156:159], v[252:255]
    s_waitcnt vmcnt(16) lgkmcnt(0)
    s_barrier
    v_mfma_f32_16x16x32_bf16 a[64:67], a[232:235], a[96:99], 0
    ds_read_b64_tr_b16 a[224:225], v3 offset:20480
    v_mfma_f32_16x16x32_bf16 a[64:67], a[236:239], a[100:103], a[64:67]
    ds_read_b64_tr_b16 a[226:227], v3 offset:20992
    v_mfma_f32_16x16x32_bf16 a[68:71], a[232:235], a[104:107], 0
    ds_read_b64_tr_b16 a[228:229], v5 offset:20480
    v_mfma_f32_16x16x32_bf16 a[68:71], a[236:239], a[108:111], a[68:71]
    ds_read_b64_tr_b16 a[230:231], v5 offset:20992
    v_mfma_f32_16x16x32_bf16 a[72:75], a[232:235], a[112:115], 0
    ds_read_b128 a[200:203], v1 offset:43008
    v_mfma_f32_16x16x32_bf16 a[72:75], a[236:239], a[116:119], a[72:75]
    ds_read_b128 a[204:207], v2 offset:43008
    v_mfma_f32_16x16x32_bf16 a[76:79], a[232:235], a[120:123], 0
    ds_read_b128 a[208:211], v1 offset:45056
    v_mfma_f32_16x16x32_bf16 a[76:79], a[236:239], a[124:127], a[76:79]
    ds_read_b128 a[212:215], v2 offset:45056
    v_mfma_f32_16x16x32_bf16 a[80:83], a[232:235], a[128:131], 0
    ds_read_b128 a[216:219], v1 offset:47104
    v_mov_b32_dpp v28, v28 row_ror:1 row_mask:0xf bank_mask:0xf
    v_mfma_f32_16x16x32_bf16 a[80:83], a[236:239], a[132:135], a[80:83]
    ds_read_b128 a[220:223], v2 offset:47104
    v_mov_b32_dpp v29, v29 row_ror:1 row_mask:0xf bank_mask:0xf
    v_mfma_f32_16x16x32_bf16 a[84:87], a[232:235], a[136:139], 0
    v_mov_b32_dpp v30, v30 row_ror:1 row_mask:0xf bank_mask:0xf
    s_add_u32 m0, s66, 77824
    v_mfma_f32_16x16x32_bf16 a[84:87], a[236:239], a[140:143], a[84:87]
    v_mov_b32_dpp v31, v31 row_ror:1 row_mask:0xf bank_mask:0xf
    s_add_u32 s74, s74, 229376
    v_mfma_f32_16x16x32_bf16 a[88:91], a[232:235], a[144:147], 0
    buffer_load_dwordx4 v11, s[16:19], s74 offen lds
    s_add_u32 m0, s67, 6144
    s_mov_b32 s74, 98560
    v_mfma_f32_16x16x32_bf16 a[88:91], a[236:239], a[148:151], a[88:91]
    s_cmp_eq_u32 s46, 0
    s_cselect_b32 s70, s81, s82
    s_cselect_b32 s71, s83, s50
    s_cmp_eq_u32 s45, 0
    s_cselect_b32 s70, s70, s71
    s_mov_b64 exec, 1
    buffer_store_dword v26, off, s[20:23], s70 sc1
    buffer_store_dword v26, off, s[20:23], s84 sc1
    s_mov_b64 exec, -1
    v_mfma_f32_16x16x32_bf16 a[92:95], a[232:235], a[152:155], 0
    v_mfma_f32_16x16x32_bf16 a[240:243], v[28:31], a[232:235], a[240:243]
    v_mfma_f32_16x16x32_bf16 a[92:95], a[236:239], a[156:159], a[92:95]
    buffer_load_dwordx4 v9, s[4:7], s74 offen lds
    s_add_u32 m0, s67, 8192
    s_waitcnt lgkmcnt(0)
    v_mfma_f32_16x16x32_bf16 a[0:3], a[224:227], a[160:163], a[0:3]
    ds_read_b64_tr_b16 a[232:233], v4 offset:20480
    v_mov_b32_dpp v28, v28 row_ror:7 row_mask:0xf bank_mask:0xf
    s_waitcnt vmcnt(18)
    v_lshlrev_b32 v27, 16, v27
    s_waitcnt vmcnt(17)
    v_and_b32 v25, 0xffff0000, v14
    v_mfma_f32_16x16x32_bf16 a[0:3], a[228:231], a[164:167], a[0:3]
    ds_read_b64_tr_b16 a[234:235], v4 offset:20992
    v_mov_b32_dpp v29, v29 row_ror:7 row_mask:0xf bank_mask:0xf
    v_mfma_f32_16x16x32_bf16 a[4:7], a[224:227], a[168:171], a[4:7]
    ds_read_b64_tr_b16 a[236:237], v6 offset:20480
    v_mov_b32_dpp v30, v30 row_ror:7 row_mask:0xf bank_mask:0xf
    v_mfma_f32_16x16x32_bf16 a[4:7], a[228:231], a[172:175], a[4:7]
    ds_read_b64_tr_b16 a[238:239], v6 offset:20992
    v_mov_b32_dpp v31, v31 row_ror:7 row_mask:0xf bank_mask:0xf
    v_mfma_f32_16x16x32_bf16 a[8:11], a[224:227], a[176:179], a[8:11]
    s_mov_b32 s74, 131328
    buffer_load_dwordx4 v9, s[4:7], s74 offen lds
    s_add_u32 m0, s67, 10240
    v_mfma_f32_16x16x32_bf16 a[8:11], a[228:231], a[180:183], a[8:11]
    s_mov_b32 s74, 164096
    v_lshlrev_b32 v24, 16, v14
    v_sub_f32 v24, v24, v27
    v_sub_f32 v25, v25, v27
    v_add_f32 v22, v24, v25
    v_mfma_f32_16x16x32_bf16 a[12:15], a[224:227], a[184:187], a[12:15]
    v_mul_f32 v23, v24, v24
    v_fmac_f32 v23, v25, v25
    v_mfma_f32_16x16x32_bf16 a[12:15], a[228:231], a[188:191], a[12:15]
    buffer_load_dwordx4 v9, s[4:7], s74 offen lds
    s_add_u32 m0, s67, 12288
    s_mov_b32 s74, 196864
    v_and_b32 v25, 0xffff0000, v15
    v_mfma_f32_16x16x32_bf16 a[16:19], a[224:227], a[192:195], a[16:19]
    v_lshlrev_b32 v24, 16, v15
    v_mfma_f32_16x16x32_bf16 a[16:19], a[228:231], a[196:199], a[16:19]
    v_sub_f32 v24, v24, v27
    v_mfma_f32_16x16x32_bf16 a[20:23], a[224:227], a[200:203], a[20:23]
    buffer_load_dwordx4 v9, s[4:7], s74 offen lds
    v_sub_f32 v25, v25, v27
    v_mfma_f32_16x16x32_bf16 a[20:23], a[228:231], a[204:207], a[20:23]
    v_add_f32 v22, v22, v24
    v_mfma_f32_16x16x32_bf16 a[24:27], a[224:227], a[208:211], a[24:27]
    v_fmac_f32 v23, v24, v24
    v_mfma_f32_16x16x32_bf16 a[24:27], a[228:231], a[212:215], a[24:27]
    s_add_u32 m0, s67, 14336
    s_mov_b32 s74, 229632
    buffer_load_dwordx4 v9, s[4:7], s74 offen lds
    v_mfma_f32_16x16x32_bf16 a[28:31], a[224:227], a[216:219], a[28:31]
    v_mfma_f32_16x16x32_bf16 a[240:243], v[28:31], a[224:227], a[240:243]
    v_add_f32 v22, v22, v25
    v_fmac_f32 v23, v25, v25
    v_mfma_f32_16x16x32_bf16 a[28:31], a[228:231], a[220:223], a[28:31]
    s_waitcnt vmcnt(20) lgkmcnt(0)
    s_barrier
    v_mfma_f32_16x16x32_bf16 a[32:35], a[232:235], a[160:163], a[32:35]
    ds_read_b64_tr_b16 a[224:225], v3 offset:24576
    v_mfma_f32_16x16x32_bf16 a[32:35], a[236:239], a[164:167], a[32:35]
    ds_read_b64_tr_b16 a[226:227], v3 offset:25088
    v_mfma_f32_16x16x32_bf16 a[36:39], a[232:235], a[168:171], a[36:39]
    ds_read_b64_tr_b16 a[228:229], v5 offset:24576
    v_mfma_f32_16x16x32_bf16 a[36:39], a[236:239], a[172:175], a[36:39]
    ds_read_b64_tr_b16 a[230:231], v5 offset:25088
    v_mfma_f32_16x16x32_bf16 a[40:43], a[232:235], a[176:179], a[40:43]
    v_mov_b32_dpp v28, v28 row_ror:1 row_mask:0xf bank_mask:0xf
    s_add_u32 m0, s66, 0
    v_and_b32 v25, 0xffff0000, v16
    v_lshlrev_b32 v24, 16, v16
    v_mfma_f32_16x16x32_bf16 a[40:43], a[236:239], a[180:183], a[40:43]
    s_add_u32 s74, s61, 786432
    buffer_load_dwordx4 v10, s[8:11], s74 offen lds
    v_sub_f32 v24, v24, v27
    v_mfma_f32_16x16x32_bf16 a[44:47], a[232:235], a[184:187], a[44:47]
    v_mov_b32_dpp v29, v29 row_ror:1 row_mask:0xf bank_mask:0xf
    v_sub_f32 v25, v25, v27
    v_add_f32 v22, v22, v24
    v_fmac_f32 v23, v24, v24
    v_mfma_f32_16x16x32_bf16 a[44:47], a[236:239], a[188:191], a[44:47]
    v_add_f32 v22, v22, v25
    v_fmac_f32 v23, v25, v25
    v_and_b32 v25, 0xffff0000, v17
    v_lshlrev_b32 v24, 16, v17
    v_mfma_f32_16x16x32_bf16 a[48:51], a[232:235], a[192:195], a[48:51]
    v_mov_b32_dpp v30, v30 row_ror:1 row_mask:0xf bank_mask:0xf
    s_add_u32 m0, s66, 40960
    v_mfma_f32_16x16x32_bf16 a[48:51], a[236:239], a[196:199], a[48:51]
    s_add_u32 s74, s74, 196608
    buffer_load_dwordx4 v10, s[8:11], s74 offen lds
    v_sub_f32 v24, v24, v27
    v_mfma_f32_16x16x32_bf16 a[52:55], a[232:235], a[200:203], a[52:55]
    v_mov_b32_dpp v31, v31 row_ror:1 row_mask:0xf bank_mask:0xf
    v_sub_f32 v25, v25, v27
    v_add_f32 v22, v22, v24
    v_mfma_f32_16x16x32_bf16 a[52:55], a[236:239], a[204:207], a[52:55]
    v_fmac_f32 v23, v24, v24
    v_mfma_f32_16x16x32_bf16 a[56:59], a[232:235], a[208:211], a[56:59]
    v_add_f32 v22, v22, v25
    v_mfma_f32_16x16x32_bf16 a[56:59], a[236:239], a[212:215], a[56:59]
    v_fmac_f32 v23, v25, v25
    v_mfma_f32_16x16x32_bf16 a[60:63], a[232:235], a[216:219], a[60:63]
    v_mfma_f32_16x16x32_bf16 a[240:243], v[28:31], a[232:235], a[240:243]
    s_add_u32 m0, s66, 4096
    s_add_u32 s74, s62, 917504
    buffer_load_dwordx4 v11, s[12:15], s74 offen lds
    s_waitcnt vmcnt(21)
    v_and_b32 v25, 0xffff0000, v18
    v_mfma_f32_16x16x32_bf16 a[60:63], a[236:239], a[220:223], a[60:63]
    v_lshlrev_b32 v24, 16, v18
    s_waitcnt lgkmcnt(0)
    v_mfma_f32_16x16x32_bf16 v[32:35], a[224:227], a[160:163], v[32:35]
    ds_read_b64_tr_b16 a[232:233], v4 offset:24576
    v_mov_b32_dpp v28, v28 row_ror:1 row_mask:0xf bank_mask:0xf
    v_mfma_f32_16x16x32_bf16 v[32:35], a[228:231], a[164:167], v[32:35]
    ds_read_b64_tr_b16 a[234:235], v4 offset:25088
    v_mov_b32_dpp v29, v29 row_ror:1 row_mask:0xf bank_mask:0xf
    v_mfma_f32_16x16x32_bf16 v[36:39], a[224:227], a[168:171], v[36:39]
    ds_read_b64_tr_b16 a[236:237], v6 offset:24576
    v_mov_b32_dpp v30, v30 row_ror:1 row_mask:0xf bank_mask:0xf
    v_mfma_f32_16x16x32_bf16 v[36:39], a[228:231], a[172:175], v[36:39]
    ds_read_b64_tr_b16 a[238:239], v6 offset:25088
    v_mov_b32_dpp v31, v31 row_ror:1 row_mask:0xf bank_mask:0xf
    v_mfma_f32_16x16x32_bf16 v[40:43], a[224:227], a[176:179], v[40:43]
    s_add_u32 m0, s66, 45056
    s_add_u32 s74, s74, 229376
    buffer_load_dwordx4 v11, s[12:15], s74 offen lds
    v_mfma_f32_16x16x32_bf16 v[40:43], a[228:231], a[180:183], v[40:43]
    v_sub_f32 v24, v24, v27
    v_sub_f32 v25, v25, v27
    v_add_f32 v22, v22, v24
    v_fmac_f32 v23, v24, v24
    v_mfma_f32_16x16x32_bf16 v[44:47], a[224:227], a[184:187], v[44:47]
    v_add_f32 v22, v22, v25
    v_fmac_f32 v23, v25, v25
    v_and_b32 v25, 0xffff0000, v19
    v_lshlrev_b32 v24, 16, v19
    v_mfma_f32_16x16x32_bf16 v[44:47], a[228:231], a[188:191], v[44:47]
    v_sub_f32 v24, v24, v27
    v_mfma_f32_16x16x32_bf16 v[48:51], a[224:227], a[192:195], v[48:51]
    v_sub_f32 v25, v25, v27
    v_mfma_f32_16x16x32_bf16 v[48:51], a[228:231], a[196:199], v[48:51]
    v_add_f32 v22, v22, v24
    v_mfma_f32_16x16x32_bf16 v[52:55], a[224:227], a[200:203], v[52:55]
    s_add_u32 m0, s66, 8192
    s_add_u32 s74, s63, 917504
    buffer_load_dwordx4 v11, s[16:19], s74 offen lds
    v_fmac_f32 v23, v24, v24
    v_mfma_f32_16x16x32_bf16 v[52:55], a[228:231], a[204:207], v[52:55]
    v_add_f32 v22, v22, v25
    v_mfma_f32_16x16x32_bf16 v[56:59], a[224:227], a[208:211], v[56:59]
    v_fmac_f32 v23, v25, v25
    v_mfma_f32_16x16x32_bf16 v[56:59], a[228:231], a[212:215], v[56:59]
    v_and_b32 v25, 0xffff0000, v20
    v_mfma_f32_16x16x32_bf16 v[60:63], a[224:227], a[216:219], v[60:63]
    v_mfma_f32_16x16x32_bf16 a[240:243], v[28:31], a[224:227], a[240:243]
    v_lshlrev_b32 v24, 16, v20
    v_mfma_f32_16x16x32_bf16 v[60:63], a[228:231], a[220:223], v[60:63]
    s_waitcnt vmcnt(16) lgkmcnt(0)
L_pad1_19:
    s_cbranch_execz L_back1
    s_barrier
    v_mfma_f32_16x16x32_bf16 v[64:67], a[232:235], a[160:163], v[64:67]
    ds_read_b64_tr_b16 a[224:225], v3 offset:28672
    v_mfma_f32_16x16x32_bf16 v[64:67], a[236:239], a[164:167], v[64:67]
    ds_read_b64_tr_b16 a[226:227], v3 offset:29184
    v_mfma_f32_16x16x32_bf16 v[68:71], a[232:235], a[168:171], v[68:71]
    ds_read_b64_tr_b16 a[228:229], v5 offset:28672
    v_mfma_f32_16x16x32_bf16 v[68:71], a[236:239], a[172:175], v[68:71]
    ds_read_b64_tr_b16 a[230:231], v5 offset:29184
    v_mfma_f32_16x16x32_bf16 v[72:75], a[232:235], a[176:179], v[72:75]
    ds_read_b128 a[96:99], v1
    v_mfma_f32_16x16x32_bf16 v[72:75], a[236:239], a[180:183], v[72:75]
    ds_read_b128 a[100:103], v2
    v_mfma_f32_16x16x32_bf16 v[76:79], a[232:235], a[184:187], v[76:79]
    ds_read_b128 a[104:107], v1 offset:2048
    v_mfma_f32_16x16x32_bf16 v[76:79], a[236:239], a[188:191], v[76:79]
    v_mov_b32_dpp v28, v28 row_ror:1 row_mask:0xf bank_mask:0xf
    s_add_u32 m0, s66, 49152
    v_mfma_f32_16x16x32_bf16 v[80:83], a[232:235], a[192:195], v[80:83]
    v_mov_b32_dpp v29, v29 row_ror:1 row_mask:0xf bank_mask:0xf
    s_add_u32 s74, s74, 229376
    v_mfma_f32_16x16x32_bf16 v[80:83], a[236:239], a[196:199], v[80:83]
    v_mov_b32_dpp v30, v30 row_ror:1 row_mask:0xf bank_mask:0xf
    v_sub_f32 v24, v24, v27
    v_mfma_f32_16x16x32_bf16 v[84:87], a[232:235], a[200:203], v[84:87]
    v_mov_b32_dpp v31, v31 row_ror:1 row_mask:0xf bank_mask:0xf
    v_sub_f32 v25, v25, v27
    v_add_f32 v22, v22, v24
    v_fmac_f32 v23, v24, v24
    v_mfma_f32_16x16x32_bf16 v[84:87], a[236:239], a[204:207], v[84:87]
    buffer_load_dwordx4 v11, s[16:19], s74 offen lds
    s_add_u32 m0, s66, 147456
    s_lshl2_add_u32 s73, s48, s44
    v_mfma_f32_16x16x32_bf16 v[88:91], a[232:235], a[208:211], v[88:91]
    s_lshl_b32 s73, s73, 10
    v_add_f32 v22, v22, v25
    v_fmac_f32 v23, v25, v25
    v_and_b32 v25, 0xffff0000, v21
    v_lshlrev_b32 v24, 16, v21
    v_mfma_f32_16x16x32_bf16 v[88:91], a[236:239], a[212:215], v[88:91]
    v_sub_f32 v24, v24, v27
    v_sub_f32 v25, v25, v27
    v_add_f32 v22, v22, v24
    v_fmac_f32 v23, v24, v24
    v_mfma_f32_16x16x32_bf16 v[92:95], a[232:235], a[216:219], v[92:95]
    v_mfma_f32_16x16x32_bf16 a[240:243], v[28:31], a[232:235], a[240:243]
    buffer_load_dwordx4 v13, s[40:43], s73 offen lds
    s_add_u32 m0, s67, 32768
    s_mov_b32 s74, 384
    v_mfma_f32_16x16x32_bf16 v[92:95], a[236:239], a[220:223], v[92:95]
    v_add_f32 v22, v22, v25
    s_waitcnt lgkmcnt(3)
    v_mfma_f32_16x16x32_bf16 v[96:99], a[224:227], a[160:163], v[96:99]
    ds_read_b64_tr_b16 a[232:233], v4 offset:28672
    v_mov_b32_dpp v28, v28 row_ror:1 row_mask:0xf bank_mask:0xf
    v_mfma_f32_16x16x32_bf16 v[96:99], a[228:231], a[164:167], v[96:99]
    ds_read_b64_tr_b16 a[234:235], v4 offset:29184
    v_mov_b32_dpp v29, v29 row_ror:1 row_mask:0xf bank_mask:0xf
    v_mfma_f32_16x16x32_bf16 v[100:103], a[224:227], a[168:171], v[100:103]
    ds_read_b64_tr_b16 a[236:237], v6 offset:28672
    v_mov_b32_dpp v30, v30 row_ror:1 row_mask:0xf bank_mask:0xf
    v_mfma_f32_16x16x32_bf16 v[100:103], a[228:231], a[172:175], v[100:103]
    ds_read_b64_tr_b16 a[238:239], v6 offset:29184
    v_mov_b32_dpp v31, v31 row_ror:1 row_mask:0xf bank_mask:0xf
    v_mfma_f32_16x16x32_bf16 v[104:107], a[224:227], a[176:179], v[104:107]
    ds_read_b128 a[108:111], v2 offset:2048
    buffer_load_dwordx4 v9, s[4:7], s74 offen lds
    v_mfma_f32_16x16x32_bf16 v[104:107], a[228:231], a[180:183], v[104:107]
    ds_read_b128 a[112:115], v1 offset:4096
    s_add_u32 m0, s67, 34816
    v_mfma_f32_16x16x32_bf16 v[108:111], a[224:227], a[184:187], v[108:111]
    ds_read_b128 a[116:119], v2 offset:4096
    s_mov_b32 s74, 33152
    v_mfma_f32_16x16x32_bf16 v[108:111], a[228:231], a[188:191], v[108:111]
    buffer_load_dwordx4 v9, s[4:7], s74 offen lds
    s_add_u32 m0, s67, 36864
    s_mov_b32 s74, 65920
    v_mfma_f32_16x16x32_bf16 v[112:115], a[224:227], a[192:195], v[112:115]
    v_fmac_f32 v23, v25, v25
    v_accvgpr_read_b32 v24, a244
    v_and_b32 v25, 0xffff0000, v24
    v_mfma_f32_16x16x32_bf16 v[112:115], a[228:231], a[196:199], v[112:115]
    v_lshlrev_b32 v24, 16, v24
    v_sub_f32 v24, v24, v27
    v_sub_f32 v25, v25, v27
    v_add_f32 v22, v22, v24
    v_mfma_f32_16x16x32_bf16 v[116:119], a[224:227], a[200:203], v[116:119]
    buffer_load_dwordx4 v9, s[4:7], s74 offen lds
    v_fmac_f32 v23, v24, v24
    v_add_f32 v22, v22, v25
    v_fmac_f32 v23, v25, v25
    v_accvgpr_read_b32 v24, a245
    v_mfma_f32_16x16x32_bf16 v[116:119], a[228:231], a[204:207], v[116:119]
    v_and_b32 v25, 0xffff0000, v24
    v_lshlrev_b32 v24, 16, v24
    v_sub_f32 v24, v24, v27
    v_sub_f32 v25, v25, v27
    v_mfma_f32_16x16x32_bf16 v[120:123], a[224:227], a[208:211], v[120:123]
    s_add_u32 m0, s66, 12288
    s_add_u32 s74, s64, 917504
    v_add_f32 v22, v22, v24
    v_mfma_f32_16x16x32_bf16 v[120:123], a[228:231], a[212:215], v[120:123]
    buffer_load_dwordx4 v11, s[12:15], s74 offen lds
    v_fmac_f32 v23, v24, v24
    v_add_f32 v22, v22, v25
    v_fmac_f32 v23, v25, v25
    v_mfma_f32_16x16x32_bf16 v[124:127], a[224:227], a[216:219], v[124:127]
    v_mfma_f32_16x16x32_bf16 a[240:243], v[28:31], a[224:227], a[240:243]
    v_accvgpr_read_b32 v24, a246
    v_and_b32 v25, 0xffff0000, v24
    v_mfma_f32_16x16x32_bf16 v[124:127], a[228:231], a[220:223], v[124:127]
    s_waitcnt vmcnt(11) lgkmcnt(0)
    s_barrier
    v_mfma_f32_16x16x32_bf16 v[128:131], a[232:235], a[160:163], v[128:131]
    ds_read_b64_tr_b16 a[224:225], v3 offset:32768
    v_mfma_f32_16x16x32_bf16 v[128:131], a[236:239], a[164:167], v[128:131]
    ds_read_b64_tr_b16 a[226:227], v3 offset:33280
    v_mfma_f32_16x16x32_bf16 v[132:135], a[232:235], a[168:171], v[132:135]
    ds_read_b64_tr_b16 a[228:229], v5 offset:32768
    v_mfma_f32_16x16x32_bf16 v[132:135], a[236:239], a[172:175], v[132:135]
    ds_read_b64_tr_b16 a[230:231], v5 offset:33280
    v_mfma_f32_16x16x32_bf16 v[136:139], a[232:235], a[176:179], v[136:139]
    ds_read_b128 a[120:123], v1 offset:6144
    v_mfma_f32_16x16x32_bf16 v[136:139], a[236:239], a[180:183], v[136:139]
    ds_read_b128 a[124:127], v2 offset:6144
    v_mfma_f32_16x16x32_bf16 v[140:143], a[232:235], a[184:187], v[140:143]
    ds_read_b128 a[128:131], v1 offset:8192
    v_mfma_f32_16x16x32_bf16 v[140:143], a[236:239], a[188:191], v[140:143]
    v_mov_b32_dpp v28, v28 row_ror:1 row_mask:0xf bank_mask:0xf
    s_add_u32 m0, s66, 53248
    v_lshlrev_b32 v24, 16, v24
    v_sub_f32 v24, v24, v27
    v_mfma_f32_16x16x32_bf16 v[144:147], a[232:235], a[192:195], v[144:147]
    v_mov_b32_dpp v29, v29 row_ror:1 row_mask:0xf bank_mask:0xf
    s_add_u32 s74, s74, 229376
    v_mfma_f32_16x16x32_bf16 v[144:147], a[236:239], a[196:199], v[144:147]
    v_mov_b32_dpp v30, v30 row_ror:1 row_mask:0xf bank_mask:0xf
    v_sub_f32 v25, v25, v27
    v_mfma_f32_16x16x32_bf16 v[148:151], a[232:235], a[200:203], v[148:151]
    v_mov_b32_dpp v31, v31 row_ror:1 row_mask:0xf bank_mask:0xf
    v_add_f32 v22, v22, v24
    v_fmac_f32 v23, v24, v24
    v_add_f32 v22, v22, v25
    v_mfma_f32_16x16x32_bf16 v[148:151], a[236:239], a[204:207], v[148:151]
    buffer_load_dwordx4 v11, s[12:15], s74 offen lds
    s_add_u32 m0, s66, 16384
    s_add_u32 s74, s65, 917504
    v_mfma_f32_16x16x32_bf16 v[152:155], a[232:235], a[208:211], v[152:155]
    v_fmac_f32 v23, v25, v25
    v_accvgpr_read_b32 v24, a247
    v_and_b32 v25, 0xffff0000, v24
    v_lshlrev_b32 v24, 16, v24
    v_mfma_f32_16x16x32_bf16 v[152:155], a[236:239], a[212:215], v[152:155]
    v_sub_f32 v24, v24, v27
    v_sub_f32 v25, v25, v27
    v_add_f32 v22, v22, v24
    v_fmac_f32 v23, v24, v24
    v_mfma_f32_16x16x32_bf16 v[156:159], a[232:235], a[216:219], v[156:159]
    v_mfma_f32_16x16x32_bf16 a[240:243], v[28:31], a[232:235], a[240:243]
    buffer_load_dwordx4 v11, s[16:19], s74 offen lds
    s_add_u32 m0, s66, 57344
    s_add_u32 s74, s74, 229376
    v_mfma_f32_16x16x32_bf16 v[156:159], a[236:239], a[220:223], v[156:159]
    v_add_f32 v22, v22, v25
    s_waitcnt lgkmcnt(3)
    v_mfma_f32_16x16x32_bf16 v[160:163], a[224:227], a[160:163], v[160:163]
    ds_read_b64_tr_b16 a[232:233], v4 offset:32768
    v_mov_b32_dpp v28, v28 row_ror:1 row_mask:0xf bank_mask:0xf
    v_mfma_f32_16x16x32_bf16 v[160:163], a[228:231], a[164:167], v[160:163]
    ds_read_b64_tr_b16 a[234:235], v4 offset:33280
    v_mov_b32_dpp v29, v29 row_ror:1 row_mask:0xf bank_mask:0xf
    v_mfma_f32_16x16x32_bf16 v[164:167], a[224:227], a[168:171], v[164:167]
    ds_read_b64_tr_b16 a[236:237], v6 offset:32768
    v_mov_b32_dpp v30, v30 row_ror:1 row_mask:0xf bank_mask:0xf
    v_mfma_f32_16x16x32_bf16 v[164:167], a[228:231], a[172:175], v[164:167]
    ds_read_b64_tr_b16 a[238:239], v6 offset:33280
    v_mov_b32_dpp v31, v31 row_ror:1 row_mask:0xf bank_mask:0xf
    v_mfma_f32_16x16x32_bf16 v[168:171], a[224:227], a[176:179], v[168:171]
    ds_read_b128 a[132:135], v2 offset:8192
    buffer_load_dwordx4 v11, s[16:19], s74 offen lds
    v_mfma_f32_16x16x32_bf16 v[168:171], a[228:231], a[180:183], v[168:171]
    ds_read_b128 a[136:139], v1 offset:10240
    s_add_u32 m0, s67, 38912
    v_mfma_f32_16x16x32_bf16 v[172:175], a[224:227], a[184:187], v[172:175]
    ds_read_b128 a[140:143], v2 offset:10240
    s_mov_b32 s74, 98688
    v_mfma_f32_16x16x32_bf16 v[172:175], a[228:231], a[188:191], v[172:175]
    buffer_load_dwordx4 v9, s[4:7], s74 offen lds
    v_fmac_f32 v23, v25, v25
    v_accvgpr_read_b32 v24, a248
    v_and_b32 v25, 0xffff0000, v24
    v_mfma_f32_16x16x32_bf16 v[176:179], a[224:227], a[192:195], v[176:179]
    v_lshlrev_b32 v24, 16, v24
    v_sub_f32 v24, v24, v27
    v_sub_f32 v25, v25, v27
    v_add_f32 v22, v22, v24
    v_mfma_f32_16x16x32_bf16 v[176:179], a[228:231], a[196:199], v[176:179]
    s_add_u32 m0, s67, 40960
    s_mov_b32 s74, 131456
    v_fmac_f32 v23, v24, v24
    v_mfma_f32_16x16x32_bf16 v[180:183], a[224:227], a[200:203], v[180:183]
    buffer_load_dwordx4 v9, s[4:7], s74 offen lds
    v_add_f32 v22, v22, v25
    v_fmac_f32 v23, v25, v25
    v_accvgpr_read_b32 v24, a249
    v_mfma_f32_16x16x32_bf16 v[180:183], a[228:231], a[204:207], v[180:183]
    v_and_b32 v25, 0xffff0000, v24
    v_lshlrev_b32 v24, 16, v24
    v_sub_f32 v24, v24, v27
    v_sub_f32 v25, v25, v27
    v_mfma_f32_16x16x32_bf16 v[184:187], a[224:227], a[208:211], v[184:187]
    v_add_f32 v22, v22, v24
    v_fmac_f32 v23, v24, v24
    v_mfma_f32_16x16x32_bf16 v[184:187], a[228:231], a[212:215], v[184:187]
    v_add_f32 v22, v22, v25
    s_mov_b32 s42, 0
    v_mfma_f32_16x16x32_bf16 v[188:191], a[224:227], a[216:219], v[188:191]
    v_mfma_f32_16x16x32_bf16 a[240:243], v[28:31], a[224:227], a[240:243]
    v_fmac_f32 v23, v25, v25
    s_lshl1_add_u32 s70, s49, s46
    v_mfma_f32_16x16x32_bf16 v[188:191], a[228:231], a[220:223], v[188:191]
    s_add_u32 m0, s67, 43008
    s_mov_b32 s74, 164224
    s_waitcnt lgkmcnt(3)
    v_mfma_f32_16x16x32_bf16 v[192:195], a[232:235], a[160:163], v[192:195]
    ds_read_b64_tr_b16 a[224:225], v3 offset:36864
    v_mov_b32_dpp v28, v28 row_ror:1 row_mask:0xf bank_mask:0xf
    v_mfma_f32_16x16x32_bf16 v[192:195], a[236:239], a[164:167], v[192:195]
    ds_read_b64_tr_b16 a[226:227], v3 offset:37376
    v_mov_b32_dpp v29, v29 row_ror:1 row_mask:0xf bank_mask:0xf
    v_mfma_f32_16x16x32_bf16 v[196:199], a[232:235], a[168:171], v[196:199]
    ds_read_b64_tr_b16 a[228:229], v5 offset:36864
    v_mov_b32_dpp v30, v30 row_ror:1 row_mask:0xf bank_mask:0xf
    v_mfma_f32_16x16x32_bf16 v[196:199], a[236:239], a[172:175], v[196:199]
    ds_read_b64_tr_b16 a[230:231], v5 offset:37376
    v_mov_b32_dpp v31, v31 row_ror:1 row_mask:0xf bank_mask:0xf
    v_mfma_f32_16x16x32_bf16 v[200:203], a[232:235], a[176:179], v[200:203]
    ds_read_b128 a[144:147], v1 offset:12288
    buffer_load_dwordx4 v9, s[4:7], s74 offen lds
    v_mfma_f32_16x16x32_bf16 v[200:203], a[236:239], a[180:183], v[200:203]
    ds_read_b128 a[148:151], v2 offset:12288
    s_add_u32 m0, s67, 45056
    v_mfma_f32_16x16x32_bf16 v[204:207], a[232:235], a[184:187], v[204:207]
    ds_read_b128 a[152:155], v1 offset:14336
    s_mov_b32 s74, 196992
    v_mfma_f32_16x16x32_bf16 v[204:207], a[236:239], a[188:191], v[204:207]
    buffer_load_dwordx4 v9, s[4:7], s74 offen lds
    v_accvgpr_read_b32 v24, a250
    v_and_b32 v25, 0xffff0000, v24
    v_lshlrev_b32 v24, 16, v24
    v_sub_f32 v24, v24, v27
    v_mfma_f32_16x16x32_bf16 v[208:211], a[232:235], a[192:195], v[208:211]
    v_sub_f32 v25, v25, v27
    v_add_f32 v22, v22, v24
    v_fmac_f32 v23, v24, v24
    v_add_f32 v22, v22, v25
    v_mfma_f32_16x16x32_bf16 v[208:211], a[236:239], a[196:199], v[208:211]
    v_fmac_f32 v23, v25, v25
    v_accvgpr_read_b32 v24, a251
    v_and_b32 v25, 0xffff0000, v24
    v_mfma_f32_16x16x32_bf16 v[212:215], a[232:235], a[200:203], v[212:215]
    v_lshlrev_b32 v24, 16, v24
    s_lshl1_add_u32 s70, s70, s45
    v_mfma_f32_16x16x32_bf16 v[212:215], a[236:239], a[204:207], v[212:215]
    s_add_u32 m0, s67, 47104
    s_mov_b32 s74, 229760
    buffer_load_dwordx4 v9, s[4:7], s74 offen lds
    v_mfma_f32_16x16x32_bf16 v[216:219], a[232:235], a[208:211], v[216:219]
    v_sub_f32 v24, v24, v27
    v_sub_f32 v25, v25, v27
    v_add_f32 v22, v22, v24
    v_mfma_f32_16x16x32_bf16 v[216:219], a[236:239], a[212:215], v[216:219]
    v_fmac_f32 v23, v24, v24
    s_lshl3_add_u32 s70, s70, s47
    v_mfma_f32_16x16x32_bf16 v[220:223], a[232:235], a[216:219], v[220:223]
    v_mfma_f32_16x16x32_bf16 a[240:243], v[28:31], a[232:235], a[240:243]
    v_add_f32 v22, v22, v25
    v_mfma_f32_16x16x32_bf16 v[220:223], a[236:239], a[220:223], v[220:223]
    v_fmac_f32 v23, v25, v25
    s_waitcnt lgkmcnt(3)
    v_mfma_f32_16x16x32_bf16 v[224:227], a[224:227], a[160:163], v[224:227]
    ds_read_b64_tr_b16 a[232:233], v4 offset:36864
    v_mov_b32_dpp v28, v28 row_ror:1 row_mask:0xf bank_mask:0xf
    v_add_f32_dpp v22, v22, v22 row_ror:8 row_mask:0xf bank_mask:0xf
    v_mfma_f32_16x16x32_bf16 v[224:227], a[228:231], a[164:167], v[224:227]
    ds_read_b64_tr_b16 a[234:235], v4 offset:37376
    v_mov_b32_dpp v29, v29 row_ror:1 row_mask:0xf bank_mask:0xf
    v_add_f32_dpp v23, v23, v23 row_ror:8 row_mask:0xf bank_mask:0xf
    v_mfma_f32_16x16x32_bf16 v[228:231], a[224:227], a[168:171], v[228:231]
    ds_read_b64_tr_b16 a[236:237], v6 offset:36864
    v_mov_b32_dpp v30, v30 row_ror:1 row_mask:0xf bank_mask:0xf
    v_mfma_f32_16x16x32_bf16 v[228:231], a[228:231], a[172:175], v[228:231]
    ds_read_b64_tr_b16 a[238:239], v6 offset:37376
    v_mov_b32_dpp v31, v31 row_ror:1 row_mask:0xf bank_mask:0xf
    v_mfma_f32_16x16x32_bf16 v[232:235], a[224:227], a[176:179], v[232:235]
    ds_read_b128 a[156:159], v2 offset:14336
    v_add_f32_dpp v22, v22, v22 row_ror:4 row_mask:0xf bank_mask:0xf
    v_mfma_f32_16x16x32_bf16 v[232:235], a[228:231], a[180:183], v[232:235]
    v_add_f32_dpp v23, v23, v23 row_ror:4 row_mask:0xf bank_mask:0xf
    v_add_f32_dpp v22, v22, v22 row_ror:2 row_mask:0xf bank_mask:0xf
    s_nop 0
    v_add_f32_dpp v23, v23, v23 row_ror:2 row_mask:0xf bank_mask:0xf
    v_mfma_f32_16x16x32_bf16 v[236:239], a[224:227], a[184:187], v[236:239]
    v_add_f32_dpp v22, v22, v22 row_ror:1 row_mask:0xf bank_mask:0xf
    s_lshl_b32 s70, s70, 10
    v_mfma_f32_16x16x32_bf16 v[236:239], a[228:231], a[188:191], v[236:239]
    v_add_f32_dpp v23, v23, v23 row_ror:1 row_mask:0xf bank_mask:0xf
    v_mfma_f32_16x16x32_bf16 v[240:243], a[224:227], a[192:195], v[240:243]
    v_mov_b32 v24, v22
    v_mfma_f32_16x16x32_bf16 v[240:243], a[228:231], a[196:199], v[240:243]
    v_mov_b32 v25, v23
    v_mfma_f32_16x16x32_bf16 v[244:247], a[224:227], a[200:203], v[244:247]
    v_permlane16_swap_b32 v24, v22
    v_mfma_f32_16x16x32_bf16 v[244:247], a[228:231], a[204:207], v[244:247]
    v_permlane16_swap_b32 v25, v23
    v_mfma_f32_16x16x32_bf16 v[248:251], a[224:227], a[208:211], v[248:251]
    v_add_f32 v22, v22, v24
    v_mfma_f32_16x16x32_bf16 v[248:251], a[228:231], a[212:215], v[248:251]
    v_add_f32 v23, v23, v25
    s_add_u32 s70, s70, 33030144
    v_mfma_f32_16x16x32_bf16 v[252:255], a[224:227], a[216:219], v[252:255]
    v_mfma_f32_16x16x32_bf16 a[240:243], v[28:31], a[224:227], a[240:243]
    v_mul_f32 v22, 0xba800000, v22
    v_mul_f32 v23, 0x3a800000, v23
    v_mfma_f32_16x16x32_bf16 v[252:255], a[228:231], a[220:223], v[252:255]
    s_waitcnt vmcnt(9) lgkmcnt(0)
    s_barrier
    v_mfma_f32_16x16x32_bf16 a[64:67], a[232:235], a[160:163], a[64:67]
    ds_read_b64_tr_b16 a[224:225], v3
    v_mfma_f32_16x16x32_bf16 a[64:67], a[236:239], a[164:167], a[64:67]
    ds_read_b64_tr_b16 a[226:227], v3 offset:512
    v_mfma_f32_16x16x32_bf16 a[68:71], a[232:235], a[168:171], a[68:71]
    ds_read_b64_tr_b16 a[228:229], v5
    v_mfma_f32_16x16x32_bf16 a[68:71], a[236:239], a[172:175], a[68:71]
    ds_read_b64_tr_b16 a[230:231], v5 offset:512
    v_mfma_f32_16x16x32_bf16 a[72:75], a[232:235], a[176:179], a[72:75]
    v_mov_b32_dpp v28, v28 row_ror:1 row_mask:0xf bank_mask:0xf
    v_mov_b32_dpp v29, v29 row_ror:1 row_mask:0xf bank_mask:0xf
    v_fma_f32 v23, -v22, v22, v23
    v_max_f32 v23, 0, v23
    v_mfma_f32_16x16x32_bf16 a[72:75], a[236:239], a[180:183], a[72:75]
    v_mov_b32_dpp v30, v30 row_ror:1 row_mask:0xf bank_mask:0xf
    v_mov_b32_dpp v31, v31 row_ror:1 row_mask:0xf bank_mask:0xf
    v_mfma_f32_16x16x32_bf16 a[76:79], a[232:235], a[184:187], a[76:79]
    s_add_u32 m0, s66, 20480
    s_add_u32 s74, s61, 1179648
    buffer_load_dwordx4 v10, s[8:11], s74 offen lds
    v_mfma_f32_16x16x32_bf16 a[76:79], a[236:239], a[188:191], a[76:79]
    s_add_u32 m0, s66, 61440
    s_add_u32 s74, s74, 196608
    v_sub_f32_e64 v22, v22, v27
    v_mfma_f32_16x16x32_bf16 a[80:83], a[232:235], a[192:195], a[80:83]
    v_cvt_pk_bf16_f32 v23, v23, v23
    v_lshlrev_b32 v23, 16, v23
    v_add_f32 v23, 0x3727c5ac, v23
    v_mfma_f32_16x16x32_bf16 a[80:83], a[236:239], a[196:199], a[80:83]
    v_mfma_f32_16x16x32_bf16 a[240:243], v[28:31], a[232:235], a[240:243]
    buffer_load_dwordx4 v10, s[8:11], s74 offen lds
    v_cvt_pk_bf16_f32 v23, v23, v23
    v_lshlrev_b32 v23, 16, v23
    v_mfma_f32_16x16x32_bf16 a[84:87], a[232:235], a[200:203], a[84:87]
    v_sqrt_f32 v23, v23
    v_cvt_pk_bf16_f32 v24, v22, v22
    v_mfma_f32_16x16x32_bf16 a[84:87], a[236:239], a[204:207], a[84:87]
    v_cvt_pk_bf16_f32 v25, v22, v22
    v_cvt_pk_bf16_f32 v22, v23, v23
    v_lshlrev_b32 v23, 16, v22
    v_mfma_f32_16x16x32_bf16 a[88:91], a[232:235], a[208:211], a[88:91]
    v_lshrrev_b32 v14, 6, v13
    v_mfma_f32_16x16x32_bf16 a[88:91], a[236:239], a[212:215], a[88:91]
    v_lshrrev_b32 v15, 4, v13
    v_mfma_f32_16x16x32_bf16 a[92:95], a[232:235], a[216:219], a[92:95]
    v_lshrrev_b32 v16, 8, v13
    v_mfma_f32_16x16x32_bf16 a[92:95], a[236:239], a[220:223], a[92:95]
    s_mov_b32 exec_lo, 1
    s_mov_b32 exec_hi, 1
    buffer_store_dwordx2 v[24:25], v14, s[20:23], s85 offen sc1
    buffer_store_dword v23, v15, s[20:23], s99 offen sc1
    buffer_store_short v22, v16, s[20:23], s100 offen sc1
    s_mov_b64 exec, -1
    buffer_store_dwordx4 a[240:243], v13, s[20:23], s70 offen sc1
    s_branch L_next1
L_code_end:
.section .rodata,"a"
.p2align 6
.amdhsa_kernel recurrent_scan__linear_kernel_hedgehog__glu_gated_geglu__prompt_kernel
  .amdhsa_next_free_vgpr 512
  .amdhsa_next_free_sgpr 102
  .amdhsa_accum_offset 256
  .amdhsa_group_segment_fixed_size 0
  .amdhsa_kernarg_size 88
  .amdhsa_user_sgpr_count 2
  .amdhsa_user_sgpr_kernarg_segment_ptr 1
  .amdhsa_system_sgpr_workgroup_id_x 1
.end_amdhsa_kernel
```
